```python
import torch

def _softmax(x, axis=-1):
    return torch.softmax(x, dim=axis)
def _gelu(x):
    return torch.nn.functional.gelu(x, approximate="tanh")
def _silu(x):
    return torch.nn.functional.silu(x)
def _sigmoid(x):
    return torch.sigmoid(x)
def _layernorm(x, axis=-1, eps=1e-5):
    m = x.mean(dim=axis, keepdim=True)
    v = x.var(dim=axis, keepdim=True, unbiased=False)
    return (x - m) / torch.sqrt(v + eps)
def _scatter_add(tgt, idx, src, axis=0):
    return tgt.clone().index_add_(axis, idx, src)
def _segment_sum(src, seg, n):
    out = torch.zeros((n,) + src.shape[1:], dtype=src.dtype)
    return out.index_add_(0, seg, src)
def _pad(x, pw):
    flat = tuple(v for pair in reversed(pw) for v in pair)
    return torch.nn.functional.pad(x, flat)

kernel_name = 'standalone__modern_conv_block_convnext_v2__vision'

def setup_inputs():

    _w = (lambda a: (lambda t: t.to(torch.bfloat16) if t.is_floating_point() else t)(torch.as_tensor(a)))
    H = W = 512
    C = 96
    K = 3
    return {
        "x": _w((lambda *s: torch.randn(*s, dtype=torch.bfloat16) * 0.05)(1, H, W, C)),
        "dw": _w((lambda *s: torch.randn(*s, dtype=torch.bfloat16) * 0.05)(K, K, C)),
        "w1": _w((lambda *s: torch.randn(*s, dtype=torch.bfloat16) * 0.05)(C, 4 * C)),
        "w2": _w((lambda *s: torch.randn(*s, dtype=torch.bfloat16) * 0.05)(4 * C, C)),
        "grn_gamma": _w((lambda *s: torch.randn(*s, dtype=torch.bfloat16) * 0.05)(4 * C)),
        "grn_beta": _w((lambda *s: torch.randn(*s, dtype=torch.bfloat16) * 0.05)(4 * C)),
    }

def reference(x, dw, w1, w2, grn_gamma, grn_beta):
    B, H, W, C = x.shape
    K = dw.shape[0]
    pad = K // 2
    xp = _pad(x, ((0,0),(pad,pad),(pad,pad),(0,0)))
    out = torch.zeros_like(x)
    for i in range(K):
        for j in range(K):
            out = out + xp[:, i:i+H, j:j+W, :] * dw[i, j][None, None, None, :]
    h = _layernorm(out, axis=-1)
    h = torch.einsum('bhwc,ce->bhwe', h, w1)
    h = _gelu(h)
    gx = torch.sqrt((h * h).sum(axis=(1, 2), keepdims=True) + 1e-6)
    nx = gx / (gx.mean(axis=-1, keepdims=True) + 1e-6)
    h = grn_gamma * (h * nx) + grn_beta + h
    h = torch.einsum('bhwe,ec->bhwc', h, w2)
    return x + h
```

```asm
; @launch grid=(256,1,1) block=(512,1,1) lds=163840
.amdgcn_target "amdgcn-amd-amdhsa--gfx950"
.text
.globl standalone__modern_conv_block_convnext_v2__vision_kernel
.p2align 8
.type standalone__modern_conv_block_convnext_v2__vision_kernel,@function
standalone__modern_conv_block_convnext_v2__vision_kernel:
s_cmp_ge_u32 s2, 256
s_cbranch_scc1 Lend
s_load_dwordx16 s[80:95], s[0:1], 0
s_load_dwordx2 s[96:97], s[0:1], 64
v_mov_b32 v119, v0
v_and_b32 v118, 63, v0
v_lshrrev_b32 v120, 6, v0
s_nop 0
v_readfirstlane_b32 s40, v120
s_getpc_b64 s[74:75]
Lpc:
s_lshr_b32 s43, s2, 3
s_and_b32 s43, s43, 15
s_lshl_b32 s43, s43, 13
v_lshrrev_b32_e64 v122, 3, v0
v_lshl_add_u32 v122, v122, 7, s43
v_min_u32 v122, Lend-Lpc, v122
global_load_dword v112, v122, s[74:75]
s_and_b32 s43, s2, 7
s_lshr_b32 s44, s2, 3
s_and_b32 s41, s43, 3
s_lshl_b32 s41, s41, 2
s_and_b32 s45, s44, 3
s_add_u32 s41, s41, s45
s_lshr_b32 s42, s43, 2
s_lshl_b32 s42, s42, 3
s_lshr_b32 s45, s44, 2
s_add_u32 s42, s42, s45
s_lshl_b32 s41, s41, 5
s_lshl_b32 s42, s42, 5
s_and_b32 s43, s40, 3
s_mul_i32 s43, s43, 1536
s_add_u32 s67, s43, 90112
s_mul_i32 s44, s41, 192
s_add_u32 s43, s43, s44
s_sub_u32 s43, s43, 192
v_lshl_add_u32 v121, v118, 4, s43
v_add_u32 v123, 896, v121
v_mov_b32 v122, 2147483648
s_mov_b32 s44, 98304
v_cmp_gt_u32 vcc, s44, v121
s_nop 1
v_cndmask_b32 v236, v122, v121, vcc
v_cmp_gt_u32 vcc, s44, v123
s_nop 1
v_cndmask_b32 v237, v122, v123, vcc
s_mul_i32 s66, s42, 98304
v_mov_b32_e64 v128, v119
v_add_u32 v129, 512, v119
v_min_u32 v129, 863, v129
v_lshlrev_b32 v130, 1, v128
v_lshlrev_b32 v131, 1, v129
v_lshrrev_b32_e64 v115, 2, v118
v_mul_u32_u24 v115, 768, v115
v_and_b32_e64 v125, 3, v118
v_lshl_add_u32 v115, v125, 4, v115
s_waitcnt lgkmcnt(0)
s_mov_b32 s4, s80
s_and_b32 s5, s81, 65535
s_mov_b32 s6, 50331648
s_mov_b32 s7, 131072
s_mov_b32 s20, s82
s_and_b32 s21, s83, 65535
s_mov_b32 s22, 1728
s_mov_b32 s23, 131072
s_mov_b32 s12, s84
s_and_b32 s13, s85, 65535
s_mov_b32 s14, 73728
s_mov_b32 s15, 131072
buffer_load_ushort v126, v130, s[20:23], 0 offen
buffer_load_ushort v127, v131, s[20:23], 0 offen
s_cmp_ge_u32 s40, 4
s_cbranch_scc1 Lrowb
s_add_u32 m0, s67, 0
s_sub_u32 s45, s66, 98304
s_cmp_eq_u32 s42, 0
s_cselect_b32 s45, 1073741824, s45
buffer_load_dwordx4 v236, s[4:7], s45 offen lds
s_add_u32 m0, s67, 6592
s_nop 0
buffer_load_dwordx4 v236, s[4:7], s66 offen lds
s_add_u32 m0, s67, 13200
s_add_u32 s66, s66, 98304
buffer_load_dwordx4 v236, s[4:7], s66 offen lds
s_add_u32 m0, s67, 19792
s_add_u32 s66, s66, 98304
buffer_load_dwordx4 v236, s[4:7], s66 offen lds
s_add_u32 m0, s67, 26400
s_add_u32 s66, s66, 98304
buffer_load_dwordx4 v236, s[4:7], s66 offen lds
s_add_u32 m0, s67, 32992
s_add_u32 s66, s66, 98304
buffer_load_dwordx4 v236, s[4:7], s66 offen lds
s_add_u32 m0, s67, 39600
s_add_u32 s66, s66, 98304
buffer_load_dwordx4 v236, s[4:7], s66 offen lds
s_add_u32 m0, s67, 46192
s_add_u32 s66, s66, 98304
buffer_load_dwordx4 v236, s[4:7], s66 offen lds
s_add_u32 m0, s67, 52736
s_add_u32 s66, s66, 98304
buffer_load_dwordx4 v236, s[4:7], s66 offen lds
s_add_u32 m0, s67, 59328
s_add_u32 s66, s66, 98304
buffer_load_dwordx4 v236, s[4:7], s66 offen lds
Lrowb:
s_mov_b32 s16, s86
s_and_b32 s17, s87, 65535
s_mov_b32 s18, 73728
s_mov_b32 s19, 131072
s_mov_b32 s24, s88
s_and_b32 s25, s89, 65535
s_mov_b32 s26, 768
s_mov_b32 s27, 131072
s_mov_b32 s28, s90
s_and_b32 s29, s91, 65535
s_mov_b32 s30, 768
s_mov_b32 s31, 131072
s_mov_b32 s8, s92
s_and_b32 s9, s93, 65535
s_mov_b32 s10, 50331648
s_mov_b32 s11, 131072
s_mov_b32 s36, s94
s_and_b32 s37, s95, 65535
s_mov_b32 s38, 256
s_mov_b32 s39, 131072
s_mov_b32 s32, s96
s_and_b32 s33, s97, 65535
s_mov_b32 s34, 83886080
s_mov_b32 s35, 131072
v_lshlrev_b32_e64 v250, 4, v118
v_add_u32 v250, 16384, v250
v_lshlrev_b32_e64 v251, 4, v118
v_add_u32 v251, 81920, v251
v_lshlrev_b32_e64 v252, 4, v118
v_add_u32 v252, 147456, v252
s_lshl_b32 s73, s2, 3
s_add_u32 s73, s73, s40
s_lshl_b32 s80, s73, 10
s_add_u32 s80, s80, 4177920
s_mul_i32 s73, s73, 16
s_add_u32 s73, s73, 1048576
s_mov_b32 s48, 1156203754
s_mov_b32 s49, 4294508536
v_and_b32 v131, 15, v118
v_lshrrev_b32 v132, 4, v118
v_and_b32_e64 v133, 3, v131
v_mul_u32_u24 v134, 13200, v133
v_lshrrev_b32_e64 v133, 2, v131
v_lshl_add_u32 v133, v133, 1, v132
v_mul_u32_u24 v133, 192, v133
s_sub_u32 s43, s67, 90112
v_add3_u32 v246, v133, v134, s43
v_bfe_u32 v133, v131, 2, 1
v_sub_u32 v133, v132, v133
v_lshrrev_b32 v134, 3, v131
v_and_b32_e64 v135, 3, v131
v_lshl_add_u32 v135, v134, 2, v135
v_lshlrev_b32_e64 v136, 6, v133
v_lshl_add_u32 v136, v135, 3, v136
v_add_u32 v136, 156040, v136
v_mov_b32 v137, 156032
v_cmp_gt_u32 vcc, 3, v133
s_nop 1
v_cndmask_b32 v136, v137, v136, vcc
v_cmp_eq_u32 vcc, 0, v134
s_nop 1
v_cndmask_b32 v238, v137, v136, vcc
v_cndmask_b32 v239, v136, v137, vcc
v_lshrrev_b32 v133, 2, v131
v_bfe_u32 v135, v131, 1, 1
v_cmp_eq_u32 vcc, v133, v132
s_nop 1
v_cndmask_b32 v135, 8, v135, vcc
v_cmp_eq_u32 s[88:89], 0, v135
v_cmp_eq_u32 s[90:91], 1, v135
v_lshlrev_b32 v254, 5, v132
v_add_u32 v254, 7936, v254
v_lshlrev_b32 v253, 4, v132
v_and_b32 v131, 31, v118
v_lshrrev_b32_e64 v132, 5, v118
v_bfe_u32 v133, v131, 2, 1
v_bfe_u32 v134, v131, 3, 1
v_bfe_u32 v135, v131, 1, 1
v_lshrrev_b32 v136, 4, v131
v_lshl_add_u32 v135, v136, 1, v135
v_lshl_add_u32 v135, v134, 2, v135
v_cmp_eq_u32 vcc, v133, v132
s_nop 1
v_cndmask_b32 v135, 8, v135, vcc
v_cmp_eq_u32 s[50:51], 0, v135
v_cmp_eq_u32 s[52:53], 1, v135
v_cmp_eq_u32 s[54:55], 2, v135
v_cmp_eq_u32 s[56:57], 3, v135
v_cmp_eq_u32 s[58:59], 4, v135
v_cmp_eq_u32 s[60:61], 5, v135
v_cmp_eq_u32 s[62:63], 6, v135
v_cmp_eq_u32 s[64:65], 7, v135
v_and_b32 v136, 1, v131
v_lshlrev_b32 v136, 4, v136
v_mov_b32 v255, 16256
v_lshlrev_b32 v255, v136, v255
v_and_b32 v137, 19, v131
v_lshl_add_u32 v137, v133, 3, v137
v_lshl_add_u32 v137, v134, 2, v137
v_lshlrev_b32_e64 v137, 2, v137
v_lshl_add_u32 v137, v132, 7, v137
s_mul_i32 s82, s40, 9216
s_add_u32 s72, s82, 90112
v_add_u32 v248, s72, v137
v_and_b32 v133, 3, v118
v_mul_u32_u24 v134, 196608, v133
v_bfe_u32 v133, v118, 2, 2
v_mul_u32_u24 v133, 384, v133
v_add3_u32 v253, v253, v133, v134
s_mul_i32 s46, s41, 192
s_add_u32 s46, s46, s67
s_sub_u32 s46, s46, 90112
s_and_b32 s83, s40, 4
s_lshl_b32 s44, s83, 1
s_add_u32 s44, s44, s42
s_add_u32 s43, s44, 0
s_mul_i32 s43, s43, 98304
s_add_u32 s68, s43, s46
s_add_u32 s43, s44, 1
s_mul_i32 s43, s43, 98304
s_add_u32 s69, s43, s46
s_add_u32 s43, s44, 16
s_mul_i32 s43, s43, 98304
s_add_u32 s70, s43, s46
s_add_u32 s43, s44, 17
s_mul_i32 s43, s43, 98304
s_add_u32 s71, s43, s46
s_mov_b32 s81, 59328
s_mov_b32 s76, 200000
v_mov_b32 v247, 8128
v_lshrrev_b32 v148, 5, v118
v_lshlrev_b32 v116, 8, v148
v_bfe_u32 v148, v118, 2, 2
v_lshl_add_u32 v116, v148, 6, v116
v_bfe_u32 v148, v118, 4, 1
v_lshl_add_u32 v116, v148, 5, v116
v_and_b32_e64 v148, 1, v118
v_lshl_add_u32 v116, v148, 4, v116
v_bfe_u32 v148, v118, 1, 1
v_lshl_add_u32 v116, v148, 3, v116
s_and_b32 s43, s40, 3
s_lshl_b32 s43, s43, 10
v_add_u32_e64 v117, s43, v250
s_add_u32 s43, s43, 16384
v_add_u32 v116, s43, v116
v_mov_b32 v224, 0
v_mov_b32 v225, 0
v_mov_b32 v226, 0
v_mov_b32 v227, 0
v_mov_b32 v228, 0
v_mov_b32 v229, 0
v_mov_b32 v230, 0
v_mov_b32 v231, 0
v_mov_b32 v232, 0
v_mov_b32 v233, 0
v_mov_b32 v234, 0
v_mov_b32 v235, 0
v_mov_b32 v32, 0
v_mov_b32 v33, 0
v_min_u32 v140, 35, v119
v_mul_u32_u24 v140, 200, v140
v_add_u32 v140, 156032, v140
v_and_b32_e64 v141, 3, v119
v_lshl_add_u32 v141, v141, 3, v247
v_cmp_gt_u32 vcc, 64, v119
s_nop 1
v_cndmask_b32 v140, v141, v140, vcc
ds_write_b64 v140, v[32:33]
s_cmp_lt_u32 s40, 4
s_cbranch_scc1 Lrowa
s_add_u32 m0, s67, 896
s_sub_u32 s45, s66, 98304
s_cmp_eq_u32 s42, 0
s_cselect_b32 s45, 1073741824, s45
buffer_load_dwordx4 v237, s[4:7], s45 offen lds
s_add_u32 m0, s67, 7488
s_nop 0
buffer_load_dwordx4 v237, s[4:7], s66 offen lds
s_add_u32 m0, s67, 14096
s_add_u32 s66, s66, 98304
buffer_load_dwordx4 v237, s[4:7], s66 offen lds
s_add_u32 m0, s67, 20688
s_add_u32 s66, s66, 98304
buffer_load_dwordx4 v237, s[4:7], s66 offen lds
s_add_u32 m0, s67, 27296
s_add_u32 s66, s66, 98304
buffer_load_dwordx4 v237, s[4:7], s66 offen lds
s_add_u32 m0, s67, 33888
s_add_u32 s66, s66, 98304
buffer_load_dwordx4 v237, s[4:7], s66 offen lds
s_add_u32 m0, s67, 40496
s_add_u32 s66, s66, 98304
buffer_load_dwordx4 v237, s[4:7], s66 offen lds
s_add_u32 m0, s67, 47088
s_add_u32 s66, s66, 98304
buffer_load_dwordx4 v237, s[4:7], s66 offen lds
s_add_u32 m0, s67, 53632
s_add_u32 s66, s66, 98304
buffer_load_dwordx4 v237, s[4:7], s66 offen lds
s_add_u32 m0, s67, 60224
s_add_u32 s66, s66, 98304
buffer_load_dwordx4 v237, s[4:7], s66 offen lds
Lrowa:
s_waitcnt vmcnt(10)
v_and_b32 v130, 1, v128
v_lshlrev_b32 v130, 4, v130
v_lshlrev_b32 v126, v130, v126
v_bfe_u32 v130, v128, 1, 1
v_cmp_eq_u32 vcc, 0, v130
s_nop 1
v_cndmask_b32 v34, 0, v126, vcc
v_cmp_eq_u32 vcc, 1, v130
s_nop 1
v_cndmask_b32 v35, 0, v126, vcc
v_lshrrev_b32 v140, 3, v128
v_mul_u32_u24 v141, 57, v140
v_lshrrev_b32_e64 v141, 11, v141
v_mul_u32_u24 v142, 171, v140
v_lshrrev_b32_e64 v142, 11, v142
v_mul_u32_u24 v140, 200, v140
v_mul_u32_u24 v142, 2336, v142
v_mul_u32_u24 v141, 2208, v141
v_sub_u32 v140, v140, v142
v_add_u32 v140, v140, v141
v_and_b32_e64 v141, 7, v128
v_lshl_add_u32 v140, v141, 3, v140
v_add_u32 v140, 156040, v140
ds_write_b64 v140, v[34:35]
v_and_b32 v130, 1, v129
v_lshlrev_b32 v130, 4, v130
v_lshlrev_b32_e64 v127, v130, v127
v_bfe_u32 v130, v129, 1, 1
v_cmp_eq_u32 vcc, 0, v130
s_nop 1
v_cndmask_b32 v36, 0, v127, vcc
v_cmp_eq_u32 vcc, 1, v130
s_nop 1
v_cndmask_b32 v37, 0, v127, vcc
v_lshrrev_b32 v140, 3, v129
v_mul_u32_u24 v141, 57, v140
v_lshrrev_b32_e64 v141, 11, v141
v_mul_u32_u24 v142, 171, v140
v_lshrrev_b32_e64 v142, 11, v142
v_mul_u32_u24 v140, 200, v140
v_mul_u32_u24 v142, 2336, v142
v_mul_u32_u24 v141, 2208, v141
v_sub_u32 v140, v140, v142
v_add_u32 v140, v140, v141
v_and_b32_e64 v141, 7, v129
v_lshl_add_u32 v140, v141, 3, v140
v_add_u32 v140, 156040, v140
ds_write_b64 v140, v[36:37]
s_cmp_lt_u32 s40, 4
s_cbranch_scc1 Lnow1a
s_and_b32 s43, s40, 3
s_add_u32 s43, s43, 0
s_mul_i32 s44, s43, 43
s_lshr_b32 s44, s44, 8
s_lshl_b32 s46, s43, 10
s_add_u32 m0, s46, 16384
s_mul_i32 s46, s44, 6
s_sub_u32 s43, s43, s46
s_mul_i32 s43, s43, 12288
s_lshl_b32 s44, s44, 6
s_add_u32 s43, s43, s44
buffer_load_dwordx4 v115, s[12:15], s43 offen lds
s_and_b32 s43, s40, 3
s_add_u32 s43, s43, 4
s_mul_i32 s44, s43, 43
s_lshr_b32 s44, s44, 8
s_lshl_b32 s46, s43, 10
s_add_u32 m0, s46, 16384
s_mul_i32 s46, s44, 6
s_sub_u32 s43, s43, s46
s_mul_i32 s43, s43, 12288
s_lshl_b32 s44, s44, 6
s_add_u32 s43, s43, s44
buffer_load_dwordx4 v115, s[12:15], s43 offen lds
s_and_b32 s43, s40, 3
s_add_u32 s43, s43, 8
s_mul_i32 s44, s43, 43
s_lshr_b32 s44, s44, 8
s_lshl_b32 s46, s43, 10
s_add_u32 m0, s46, 16384
s_mul_i32 s46, s44, 6
s_sub_u32 s43, s43, s46
s_mul_i32 s43, s43, 12288
s_lshl_b32 s44, s44, 6
s_add_u32 s43, s43, s44
buffer_load_dwordx4 v115, s[12:15], s43 offen lds
s_and_b32 s43, s40, 3
s_add_u32 s43, s43, 12
s_mul_i32 s44, s43, 43
s_lshr_b32 s44, s44, 8
s_lshl_b32 s46, s43, 10
s_add_u32 m0, s46, 16384
s_mul_i32 s46, s44, 6
s_sub_u32 s43, s43, s46
s_mul_i32 s43, s43, 12288
s_lshl_b32 s44, s44, 6
s_add_u32 s43, s43, s44
buffer_load_dwordx4 v115, s[12:15], s43 offen lds
s_and_b32 s43, s40, 3
s_add_u32 s43, s43, 16
s_mul_i32 s44, s43, 43
s_lshr_b32 s44, s44, 8
s_lshl_b32 s46, s43, 10
s_add_u32 m0, s46, 16384
s_mul_i32 s46, s44, 6
s_sub_u32 s43, s43, s46
s_mul_i32 s43, s43, 12288
s_lshl_b32 s44, s44, 6
s_add_u32 s43, s43, s44
buffer_load_dwordx4 v115, s[12:15], s43 offen lds
s_and_b32 s43, s40, 3
s_add_u32 s43, s43, 20
s_mul_i32 s44, s43, 43
s_lshr_b32 s44, s44, 8
s_lshl_b32 s46, s43, 10
s_add_u32 m0, s46, 16384
s_mul_i32 s46, s44, 6
s_sub_u32 s43, s43, s46
s_mul_i32 s43, s43, 12288
s_lshl_b32 s44, s44, 6
s_add_u32 s43, s43, s44
buffer_load_dwordx4 v115, s[12:15], s43 offen lds
v_bfe_u32 v141, v250, 4, 6
v_and_b32 v140, 15, v141
v_lshlrev_b32 v140, 7, v140
v_lshrrev_b32 v141, 4, v141
v_mul_u32_u24 v141, 98304, v141
s_sub_u32 s43, s67, -8000
s_mul_i32 s44, s41, 192
s_add_u32 s43, s43, s44
v_add3_u32 v140, v140, v141, s43
s_mov_b32 m0, 163840
s_add_u32 s44, s66, 393216
buffer_load_dword v140, s[4:7], s66 offen lds
buffer_load_dword v140, s[4:7], s44 offen lds
s_waitcnt vmcnt(8) lgkmcnt(0)
s_branch Lwa
Lnow1a:
v_and_b32 v120, 255, v119
v_lshlrev_b32_e64 v121, 8, v120
v_add_u32 v0, 4, v121
v_cvt_f32_f16 v0, v0
v_add_u32 v1, 12, v121
v_cvt_f32_f16 v1, v1
v_add_u32 v2, 20, v121
v_cvt_f32_f16 v2, v2
v_add_u32 v3, 28, v121
v_cvt_f32_f16 v3, v3
v_add_u32 v4, 36, v121
v_cvt_f32_f16 v4, v4
v_add_u32 v5, 44, v121
v_cvt_f32_f16 v5, v5
v_add_u32 v6, 52, v121
v_cvt_f32_f16 v6, v6
v_add_u32 v7, 60, v121
v_cvt_f32_f16 v7, v7
v_add_u32 v8, 68, v121
v_cvt_f32_f16 v8, v8
v_add_u32 v9, 76, v121
v_cvt_f32_f16 v9, v9
v_add_u32 v10, 84, v121
v_cvt_f32_f16 v10, v10
v_add_u32 v11, 92, v121
v_cvt_f32_f16 v11, v11
v_add_u32 v12, 100, v121
v_cvt_f32_f16 v12, v12
v_add_u32 v13, 108, v121
v_cvt_f32_f16 v13, v13
v_add_u32 v14, 116, v121
v_cvt_f32_f16 v14, v14
v_add_u32 v15, 124, v121
v_cvt_f32_f16 v15, v15
v_add_u32 v16, 132, v121
v_cvt_f32_f16 v16, v16
v_add_u32 v17, 140, v121
v_cvt_f32_f16 v17, v17
v_add_u32 v18, 148, v121
v_cvt_f32_f16 v18, v18
v_add_u32 v19, 156, v121
v_cvt_f32_f16 v19, v19
v_add_u32 v20, 164, v121
v_cvt_f32_f16 v20, v20
v_add_u32 v21, 172, v121
v_cvt_f32_f16 v21, v21
v_add_u32 v22, 180, v121
v_cvt_f32_f16 v22, v22
v_add_u32 v23, 188, v121
v_cvt_f32_f16 v23, v23
v_add_u32 v24, 196, v121
v_cvt_f32_f16 v24, v24
v_add_u32 v25, 204, v121
v_cvt_f32_f16 v25, v25
v_add_u32 v26, 212, v121
v_cvt_f32_f16 v26, v26
v_add_u32 v27, 220, v121
v_cvt_f32_f16 v27, v27
v_add_u32 v28, 228, v121
v_cvt_f32_f16 v28, v28
v_add_u32 v29, 236, v121
v_cvt_f32_f16 v29, v29
v_add_u32 v30, 244, v121
v_cvt_f32_f16 v30, v30
v_add_u32 v31, 252, v121
v_cvt_f32_f16 v31, v31
v_fmaak_f32 v32, v0, v0, 0x409d30fc
v_mul_f32_e64 v32, v0, v32
v_fmaak_f32 v33, v1, v1, 0x409d30fc
v_mul_f32_e64 v33, v1, v33
v_fmaak_f32 v34, v2, v2, 0x409d30fc
v_mul_f32_e64 v34, v2, v34
v_fmaak_f32 v35, v3, v3, 0x409d30fc
v_mul_f32_e64 v35, v3, v35
v_fmaak_f32 v36, v4, v4, 0x409d30fc
v_mul_f32_e64 v36, v4, v36
v_fmaak_f32 v37, v5, v5, 0x409d30fc
v_mul_f32_e64 v37, v5, v37
v_fmaak_f32 v38, v6, v6, 0x409d30fc
v_mul_f32_e64 v38, v6, v38
v_fmaak_f32 v39, v7, v7, 0x409d30fc
v_mul_f32_e64 v39, v7, v39
v_fmaak_f32 v40, v8, v8, 0x409d30fc
v_mul_f32_e64 v40, v8, v40
v_fmaak_f32 v41, v9, v9, 0x409d30fc
v_mul_f32_e64 v41, v9, v41
v_fmaak_f32 v42, v10, v10, 0x409d30fc
v_mul_f32_e64 v42, v10, v42
v_fmaak_f32 v43, v11, v11, 0x409d30fc
v_mul_f32_e64 v43, v11, v43
v_fmaak_f32 v44, v12, v12, 0x409d30fc
v_mul_f32_e64 v44, v12, v44
v_fmaak_f32 v45, v13, v13, 0x409d30fc
v_mul_f32_e64 v45, v13, v45
v_fmaak_f32 v46, v14, v14, 0x409d30fc
v_mul_f32_e64 v46, v14, v46
v_fmaak_f32 v47, v15, v15, 0x409d30fc
v_mul_f32_e64 v47, v15, v47
v_fmaak_f32 v48, v16, v16, 0x409d30fc
v_mul_f32_e64 v48, v16, v48
v_fmaak_f32 v49, v17, v17, 0x409d30fc
v_mul_f32_e64 v49, v17, v49
v_fmaak_f32 v50, v18, v18, 0x409d30fc
v_mul_f32_e64 v50, v18, v50
v_fmaak_f32 v51, v19, v19, 0x409d30fc
v_mul_f32_e64 v51, v19, v51
v_fmaak_f32 v52, v20, v20, 0x409d30fc
v_mul_f32_e64 v52, v20, v52
v_fmaak_f32 v53, v21, v21, 0x409d30fc
v_mul_f32_e64 v53, v21, v53
v_fmaak_f32 v54, v22, v22, 0x409d30fc
v_mul_f32_e64 v54, v22, v54
v_fmaak_f32 v55, v23, v23, 0x409d30fc
v_mul_f32_e64 v55, v23, v55
v_fmaak_f32 v56, v24, v24, 0x409d30fc
v_mul_f32_e64 v56, v24, v56
v_fmaak_f32 v57, v25, v25, 0x409d30fc
v_mul_f32_e64 v57, v25, v57
v_fmaak_f32 v58, v26, v26, 0x409d30fc
v_mul_f32_e64 v58, v26, v58
v_fmaak_f32 v59, v27, v27, 0x409d30fc
v_mul_f32_e64 v59, v27, v59
v_fmaak_f32 v60, v28, v28, 0x409d30fc
v_mul_f32_e64 v60, v28, v60
v_fmaak_f32 v61, v29, v29, 0x409d30fc
v_mul_f32_e64 v61, v29, v61
v_fmaak_f32 v62, v30, v30, 0x409d30fc
v_mul_f32_e64 v62, v30, v62
v_fmaak_f32 v63, v31, v31, 0x409d30fc
v_mul_f32 v63, v31, v63
v_exp_f32 v32, v32
v_exp_f32 v33, v33
v_exp_f32 v34, v34
v_exp_f32 v35, v35
v_exp_f32 v36, v36
v_exp_f32 v37, v37
v_exp_f32 v38, v38
v_exp_f32 v39, v39
v_exp_f32 v40, v40
v_exp_f32 v41, v41
v_exp_f32 v42, v42
v_exp_f32 v43, v43
v_exp_f32 v44, v44
v_exp_f32 v45, v45
v_exp_f32 v46, v46
v_exp_f32 v47, v47
v_exp_f32 v48, v48
v_exp_f32 v49, v49
v_exp_f32 v50, v50
v_exp_f32 v51, v51
v_exp_f32 v52, v52
v_exp_f32 v53, v53
v_exp_f32 v54, v54
v_exp_f32 v55, v55
v_exp_f32 v56, v56
v_exp_f32 v57, v57
v_exp_f32 v58, v58
v_exp_f32 v59, v59
v_exp_f32 v60, v60
v_exp_f32 v61, v61
v_exp_f32 v62, v62
v_exp_f32 v63, v63
v_add_f32 v32, 1.0, v32
v_add_f32 v33, 1.0, v33
v_add_f32 v34, 1.0, v34
v_add_f32 v35, 1.0, v35
v_add_f32 v36, 1.0, v36
v_add_f32 v37, 1.0, v37
v_add_f32 v38, 1.0, v38
v_add_f32 v39, 1.0, v39
v_add_f32 v40, 1.0, v40
v_add_f32 v41, 1.0, v41
v_add_f32 v42, 1.0, v42
v_add_f32 v43, 1.0, v43
v_add_f32 v44, 1.0, v44
v_add_f32 v45, 1.0, v45
v_add_f32 v46, 1.0, v46
v_add_f32 v47, 1.0, v47
v_add_f32 v48, 1.0, v48
v_add_f32 v49, 1.0, v49
v_add_f32 v50, 1.0, v50
v_add_f32 v51, 1.0, v51
v_add_f32 v52, 1.0, v52
v_add_f32 v53, 1.0, v53
v_add_f32 v54, 1.0, v54
v_add_f32 v55, 1.0, v55
v_add_f32 v56, 1.0, v56
v_add_f32 v57, 1.0, v57
v_add_f32 v58, 1.0, v58
v_add_f32 v59, 1.0, v59
v_add_f32 v60, 1.0, v60
v_add_f32 v61, 1.0, v61
v_add_f32 v62, 1.0, v62
v_add_f32 v63, 1.0, v63
v_rcp_f32 v32, v32
v_rcp_f32 v33, v33
v_rcp_f32 v34, v34
v_rcp_f32 v35, v35
v_rcp_f32 v36, v36
v_rcp_f32 v37, v37
v_rcp_f32 v38, v38
v_rcp_f32 v39, v39
v_rcp_f32 v40, v40
v_rcp_f32 v41, v41
v_rcp_f32 v42, v42
v_rcp_f32 v43, v43
v_rcp_f32 v44, v44
v_rcp_f32 v45, v45
v_rcp_f32 v46, v46
v_rcp_f32 v47, v47
v_rcp_f32 v48, v48
v_rcp_f32 v49, v49
v_rcp_f32 v50, v50
v_rcp_f32 v51, v51
v_rcp_f32 v52, v52
v_rcp_f32 v53, v53
v_rcp_f32 v54, v54
v_rcp_f32 v55, v55
v_rcp_f32 v56, v56
v_rcp_f32 v57, v57
v_rcp_f32 v58, v58
v_rcp_f32 v59, v59
v_rcp_f32 v60, v60
v_rcp_f32 v61, v61
v_rcp_f32 v62, v62
v_rcp_f32 v63, v63
v_mul_f32 v0, v0, v32
v_mul_f32 v1, v1, v33
v_mul_f32 v2, v2, v34
v_mul_f32 v3, v3, v35
v_mul_f32 v4, v4, v36
v_mul_f32 v5, v5, v37
v_mul_f32 v6, v6, v38
v_mul_f32 v7, v7, v39
v_mul_f32 v8, v8, v40
v_mul_f32 v9, v9, v41
v_mul_f32 v10, v10, v42
v_mul_f32 v11, v11, v43
v_mul_f32 v12, v12, v44
v_mul_f32 v13, v13, v45
v_mul_f32 v14, v14, v46
v_mul_f32 v15, v15, v47
v_mul_f32 v16, v16, v48
v_mul_f32 v17, v17, v49
v_mul_f32 v18, v18, v50
v_mul_f32 v19, v19, v51
v_mul_f32 v20, v20, v52
v_mul_f32 v21, v21, v53
v_mul_f32 v22, v22, v54
v_mul_f32 v23, v23, v55
v_mul_f32 v24, v24, v56
v_mul_f32 v25, v25, v57
v_mul_f32 v26, v26, v58
v_mul_f32 v27, v27, v59
v_mul_f32 v28, v28, v60
v_mul_f32 v29, v29, v61
v_mul_f32 v30, v30, v62
v_mul_f32_e64 v31, v31, v63
v_cvt_pk_f16_f32 v32, v0, v1
v_cvt_pk_f16_f32 v33, v2, v3
v_cvt_pk_f16_f32 v34, v4, v5
v_cvt_pk_f16_f32 v35, v6, v7
v_cvt_pk_f16_f32 v36, v8, v9
v_cvt_pk_f16_f32 v37, v10, v11
v_cvt_pk_f16_f32 v38, v12, v13
v_cvt_pk_f16_f32 v39, v14, v15
v_cvt_pk_f16_f32 v40, v16, v17
v_cvt_pk_f16_f32 v41, v18, v19
v_cvt_pk_f16_f32 v42, v20, v21
v_cvt_pk_f16_f32 v43, v22, v23
v_cvt_pk_f16_f32 v44, v24, v25
v_cvt_pk_f16_f32 v45, v26, v27
v_cvt_pk_f16_f32 v46, v28, v29
v_cvt_pk_f16_f32 v47, v30, v31
v_lshlrev_b32_e64 v121, 6, v120
v_bfe_u32 v120, v120, 2, 5
v_cmp_ne_u32 vcc, 31, v120
s_and_saveexec_b64 s[74:75], vcc
ds_write_b128 v121, v[32:35]
ds_write_b128 v121, v[36:39] offset:16
ds_write_b128 v121, v[40:43] offset:32
ds_write_b128 v121, v[44:47] offset:48
s_mov_b64 exec, s[74:75]
s_waitcnt vmcnt(0) lgkmcnt(0)
Lwa:
s_barrier
s_setprio 3
s_cmp_lt_u32 s40, 4
s_cbranch_scc1 Lsu1
s_setprio 2
s_waitcnt vmcnt(2)
v_add_u32 v113, 65536, v116
v_add_u32 v114, 65536, v117
ds_read_b64_tr_b16 v[0:1], v116
ds_read_b64_tr_b16 v[2:3], v116 offset:512
ds_read_b64_tr_b16 v[4:5], v116 offset:4096
ds_read_b64_tr_b16 v[6:7], v116 offset:4608
ds_read_b64_tr_b16 v[8:9], v116 offset:8192
ds_read_b64_tr_b16 v[10:11], v116 offset:8704
ds_read_b64_tr_b16 v[12:13], v116 offset:12288
ds_read_b64_tr_b16 v[14:15], v116 offset:12800
ds_read_b64_tr_b16 v[16:17], v116 offset:16384
ds_read_b64_tr_b16 v[18:19], v116 offset:16896
ds_read_b64_tr_b16 v[20:21], v116 offset:20480
ds_read_b64_tr_b16 v[22:23], v116 offset:20992
s_waitcnt lgkmcnt(10)
ds_write_b128 v117, v[0:3]
s_waitcnt lgkmcnt(9)
ds_write_b128 v117, v[4:7] offset:4096
s_waitcnt lgkmcnt(8)
ds_write_b128 v117, v[8:11] offset:8192
s_waitcnt lgkmcnt(7)
ds_write_b128 v117, v[12:15] offset:12288
s_waitcnt lgkmcnt(6)
ds_write_b128 v117, v[16:19] offset:16384
s_waitcnt lgkmcnt(5)
ds_write_b128 v117, v[20:23] offset:20480
v_mov_b32_e64 v223, 1
s_waitcnt lgkmcnt(0)
s_mov_b64 exec, 1
ds_add_u32 v247, v223 offset:8
s_mov_b64 exec, -1
s_and_b32 s43, s40, 3
s_add_u32 s43, s43, 24
s_mul_i32 s44, s43, 43
s_lshr_b32 s44, s44, 8
s_lshl_b32 s46, s43, 10
s_add_u32 m0, s46, 16384
s_mul_i32 s46, s44, 6
s_sub_u32 s43, s43, s46
s_mul_i32 s43, s43, 12288
s_lshl_b32 s44, s44, 6
s_add_u32 s43, s43, s44
buffer_load_dwordx4 v115, s[12:15], s43 offen lds
s_and_b32 s43, s40, 3
s_add_u32 s43, s43, 28
s_mul_i32 s44, s43, 43
s_lshr_b32 s44, s44, 8
s_lshl_b32 s46, s43, 10
s_add_u32 m0, s46, 16384
s_mul_i32 s46, s44, 6
s_sub_u32 s43, s43, s46
s_mul_i32 s43, s43, 12288
s_lshl_b32 s44, s44, 6
s_add_u32 s43, s43, s44
buffer_load_dwordx4 v115, s[12:15], s43 offen lds
s_and_b32 s43, s40, 3
s_add_u32 s43, s43, 32
s_mul_i32 s44, s43, 43
s_lshr_b32 s44, s44, 8
s_lshl_b32 s46, s43, 10
s_add_u32 m0, s46, 16384
s_mul_i32 s46, s44, 6
s_sub_u32 s43, s43, s46
s_mul_i32 s43, s43, 12288
s_lshl_b32 s44, s44, 6
s_add_u32 s43, s43, s44
buffer_load_dwordx4 v115, s[12:15], s43 offen lds
s_and_b32 s43, s40, 3
s_add_u32 s43, s43, 36
s_mul_i32 s44, s43, 43
s_lshr_b32 s44, s44, 8
s_lshl_b32 s46, s43, 10
s_add_u32 m0, s46, 16384
s_mul_i32 s46, s44, 6
s_sub_u32 s43, s43, s46
s_mul_i32 s43, s43, 12288
s_lshl_b32 s44, s44, 6
s_add_u32 s43, s43, s44
buffer_load_dwordx4 v115, s[12:15], s43 offen lds
s_and_b32 s43, s40, 3
s_add_u32 s43, s43, 40
s_mul_i32 s44, s43, 43
s_lshr_b32 s44, s44, 8
s_lshl_b32 s46, s43, 10
s_add_u32 m0, s46, 16384
s_mul_i32 s46, s44, 6
s_sub_u32 s43, s43, s46
s_mul_i32 s43, s43, 12288
s_lshl_b32 s44, s44, 6
s_add_u32 s43, s43, s44
buffer_load_dwordx4 v115, s[12:15], s43 offen lds
s_and_b32 s43, s40, 3
s_add_u32 s43, s43, 44
s_mul_i32 s44, s43, 43
s_lshr_b32 s44, s44, 8
s_lshl_b32 s46, s43, 10
s_add_u32 m0, s46, 16384
s_mul_i32 s46, s44, 6
s_sub_u32 s43, s43, s46
s_mul_i32 s43, s43, 12288
s_lshl_b32 s44, s44, 6
s_add_u32 s43, s43, s44
buffer_load_dwordx4 v115, s[12:15], s43 offen lds
s_and_b32 s43, s40, 3
s_add_u32 s43, s43, 48
s_mul_i32 s44, s43, 43
s_lshr_b32 s44, s44, 8
s_lshl_b32 s46, s43, 10
s_add_u32 m0, s46, 16384
s_mul_i32 s46, s44, 6
s_sub_u32 s43, s43, s46
s_mul_i32 s43, s43, 12288
s_lshl_b32 s44, s44, 6
s_add_u32 s43, s43, s44
buffer_load_dwordx4 v115, s[12:15], s43 offen lds
s_and_b32 s43, s40, 3
s_add_u32 s43, s43, 52
s_mul_i32 s44, s43, 43
s_lshr_b32 s44, s44, 8
s_lshl_b32 s46, s43, 10
s_add_u32 m0, s46, 16384
s_mul_i32 s46, s44, 6
s_sub_u32 s43, s43, s46
s_mul_i32 s43, s43, 12288
s_lshl_b32 s44, s44, 6
s_add_u32 s43, s43, s44
buffer_load_dwordx4 v115, s[12:15], s43 offen lds
s_and_b32 s43, s40, 3
s_add_u32 s43, s43, 56
s_mul_i32 s44, s43, 43
s_lshr_b32 s44, s44, 8
s_lshl_b32 s46, s43, 10
s_add_u32 m0, s46, 16384
s_mul_i32 s46, s44, 6
s_sub_u32 s43, s43, s46
s_mul_i32 s43, s43, 12288
s_lshl_b32 s44, s44, 6
s_add_u32 s43, s43, s44
buffer_load_dwordx4 v115, s[12:15], s43 offen lds
s_and_b32 s43, s40, 3
s_add_u32 s43, s43, 60
s_mul_i32 s44, s43, 43
s_lshr_b32 s44, s44, 8
s_lshl_b32 s46, s43, 10
s_add_u32 m0, s46, 16384
s_mul_i32 s46, s44, 6
s_sub_u32 s43, s43, s46
s_mul_i32 s43, s43, 12288
s_lshl_b32 s44, s44, 6
s_add_u32 s43, s43, s44
buffer_load_dwordx4 v115, s[12:15], s43 offen lds
s_and_b32 s43, s40, 3
s_add_u32 s43, s43, 64
s_mul_i32 s44, s43, 43
s_lshr_b32 s44, s44, 8
s_lshl_b32 s46, s43, 10
s_add_u32 m0, s46, 16384
s_mul_i32 s46, s44, 6
s_sub_u32 s43, s43, s46
s_mul_i32 s43, s43, 12288
s_lshl_b32 s44, s44, 6
s_add_u32 s43, s43, s44
buffer_load_dwordx4 v115, s[12:15], s43 offen lds
s_and_b32 s43, s40, 3
s_add_u32 s43, s43, 68
s_mul_i32 s44, s43, 43
s_lshr_b32 s44, s44, 8
s_lshl_b32 s46, s43, 10
s_add_u32 m0, s46, 16384
s_mul_i32 s46, s44, 6
s_sub_u32 s43, s43, s46
s_mul_i32 s43, s43, 12288
s_lshl_b32 s44, s44, 6
s_add_u32 s43, s43, s44
buffer_load_dwordx4 v115, s[12:15], s43 offen lds
v_mov_b32_e64 v223, 0
s_branch Law1
Lax1:
s_sleep 2
Law1:
ds_read_b32 v223, v247 offset:16
s_sub_u32 s76, s76, 1
s_cselect_b32 s44, 4, 0
s_cselect_b32 s76, 0, s76
s_waitcnt lgkmcnt(0)
v_readfirstlane_b32 s43, v223
s_nop 1
s_max_u32 s43, s43, s44
s_cmp_lt_u32 s43, 4
s_cbranch_scc1 Lax1
s_add_u32 s81, s81, 6592
s_cmp_eq_u32 s81, 65920
s_cselect_b32 s81, 0, s81
s_add_u32 s43, s81, s67
s_add_u32 m0, s43, 16
s_add_u32 s66, s66, 98304
buffer_load_dwordx4 v236, s[4:7], s66 offen lds
s_add_u32 m0, s43, 912
s_nop 0
buffer_load_dwordx4 v237, s[4:7], s66 offen lds
s_add_u32 s81, s81, 6592
s_cmp_eq_u32 s81, 65920
s_cselect_b32 s81, 0, s81
s_add_u32 s43, s81, s67
s_add_u32 m0, s43, 16
s_add_u32 s66, s66, 98304
buffer_load_dwordx4 v236, s[4:7], s66 offen lds
s_add_u32 m0, s43, 912
s_nop 0
buffer_load_dwordx4 v237, s[4:7], s66 offen lds
s_add_u32 s81, s81, 6592
s_cmp_eq_u32 s81, 65920
s_cselect_b32 s81, 0, s81
s_add_u32 s43, s81, s67
s_add_u32 m0, s43, 32
s_add_u32 s66, s66, 98304
buffer_load_dwordx4 v236, s[4:7], s66 offen lds
s_add_u32 m0, s43, 928
s_nop 0
buffer_load_dwordx4 v237, s[4:7], s66 offen lds
s_add_u32 s81, s81, 6592
s_cmp_eq_u32 s81, 65920
s_cselect_b32 s81, 0, s81
s_add_u32 s43, s81, s67
s_add_u32 m0, s43, 32
s_add_u32 s66, s66, 98304
buffer_load_dwordx4 v236, s[4:7], s66 offen lds
s_add_u32 m0, s43, 928
s_nop 0
buffer_load_dwordx4 v237, s[4:7], s66 offen lds
s_add_u32 s81, s81, 6592
s_cmp_eq_u32 s81, 65920
s_cselect_b32 s81, 0, s81
s_add_u32 s43, s81, s67
s_add_u32 m0, s43, 48
s_add_u32 s66, s66, 98304
buffer_load_dwordx4 v236, s[4:7], s66 offen lds
s_add_u32 m0, s43, 944
s_nop 0
buffer_load_dwordx4 v237, s[4:7], s66 offen lds
s_add_u32 s81, s81, 6592
s_cmp_eq_u32 s81, 65920
s_cselect_b32 s81, 0, s81
s_add_u32 s43, s81, s67
s_add_u32 m0, s43, 48
s_add_u32 s66, s66, 98304
buffer_load_dwordx4 v236, s[4:7], s66 offen lds
s_add_u32 m0, s43, 944
s_nop 0
buffer_load_dwordx4 v237, s[4:7], s66 offen lds
s_add_u32 s81, s81, 6592
s_cmp_eq_u32 s81, 65920
s_cselect_b32 s81, 0, s81
s_add_u32 s43, s81, s67
s_add_u32 m0, s43, 0
s_add_u32 s66, s66, 98304
buffer_load_dwordx4 v236, s[4:7], s66 offen lds
s_add_u32 m0, s43, 896
s_nop 0
buffer_load_dwordx4 v237, s[4:7], s66 offen lds
s_add_u32 s81, s81, 6592
s_cmp_eq_u32 s81, 65920
s_cselect_b32 s81, 0, s81
s_add_u32 s43, s81, s67
s_add_u32 m0, s43, 0
s_add_u32 s66, s66, 98304
buffer_load_dwordx4 v236, s[4:7], s66 offen lds
s_add_u32 m0, s43, 896
s_nop 0
buffer_load_dwordx4 v237, s[4:7], s66 offen lds
s_waitcnt vmcnt(16)
v_add_u32 v113, 65536, v116
v_add_u32 v114, 65536, v117
ds_read_b64_tr_b16 v[0:1], v116 offset:24576
ds_read_b64_tr_b16 v[2:3], v116 offset:25088
ds_read_b64_tr_b16 v[4:5], v116 offset:28672
ds_read_b64_tr_b16 v[6:7], v116 offset:29184
ds_read_b64_tr_b16 v[8:9], v116 offset:32768
ds_read_b64_tr_b16 v[10:11], v116 offset:33280
ds_read_b64_tr_b16 v[12:13], v116 offset:36864
ds_read_b64_tr_b16 v[14:15], v116 offset:37376
ds_read_b64_tr_b16 v[16:17], v116 offset:40960
ds_read_b64_tr_b16 v[18:19], v116 offset:41472
ds_read_b64_tr_b16 v[20:21], v116 offset:45056
ds_read_b64_tr_b16 v[22:23], v116 offset:45568
ds_read_b64_tr_b16 v[24:25], v116 offset:49152
ds_read_b64_tr_b16 v[26:27], v116 offset:49664
ds_read_b64_tr_b16 v[28:29], v116 offset:53248
ds_read_b64_tr_b16 v[30:31], v116 offset:53760
ds_read_b64_tr_b16 v[32:33], v116 offset:57344
ds_read_b64_tr_b16 v[34:35], v116 offset:57856
ds_read_b64_tr_b16 v[36:37], v116 offset:61440
ds_read_b64_tr_b16 v[38:39], v116 offset:61952
ds_read_b64_tr_b16 v[40:41], v113
ds_read_b64_tr_b16 v[42:43], v113 offset:512
ds_read_b64_tr_b16 v[44:45], v113 offset:4096
ds_read_b64_tr_b16 v[46:47], v113 offset:4608
s_waitcnt lgkmcnt(15)
ds_write_b128 v117, v[0:3] offset:24576
ds_write_b128 v117, v[4:7] offset:28672
ds_write_b128 v117, v[8:11] offset:32768
ds_write_b128 v117, v[12:15] offset:36864
s_waitcnt lgkmcnt(15)
ds_write_b128 v117, v[16:19] offset:40960
ds_write_b128 v117, v[20:23] offset:45056
s_waitcnt lgkmcnt(15)
ds_write_b128 v117, v[24:27] offset:49152
s_waitcnt lgkmcnt(15)
ds_write_b128 v117, v[28:31] offset:53248
s_waitcnt lgkmcnt(14)
ds_write_b128 v117, v[32:35] offset:57344
s_waitcnt lgkmcnt(13)
ds_write_b128 v117, v[36:39] offset:61440
s_waitcnt lgkmcnt(12)
ds_write_b128 v114, v[40:43]
s_waitcnt lgkmcnt(11)
ds_write_b128 v114, v[44:47] offset:4096
v_mov_b32 v223, 1
s_waitcnt lgkmcnt(0)
s_mov_b64 exec, 1
ds_add_u32 v247, v223 offset:12
s_mov_b64 exec, -1
s_cmp_lg_u32 s40, 7
s_cbranch_scc1 Lnosent
v_bfe_u32 v104, v250, 4, 6
v_mov_b32 v108, -1
v_mov_b32 v109, -1
v_mov_b32 v110, -1
v_mov_b32 v111, -1
v_lshlrev_b32_e64 v100, 12, v104
v_add_u32 v101, 262144, v100
v_cmp_gt_u32 vcc, 32, v104
v_mov_b32 v105, 2147483648
s_nop 0
v_cndmask_b32 v101, v105, v101, vcc
s_lshl_b32 s43, s2, 4
buffer_store_dwordx4 v[108:111], v100, s[32:35], s43 offen sc1
buffer_store_dwordx4 v[108:111], v101, s[32:35], s43 offen sc1
s_add_u32 s43, s43, 393216
s_cmp_lt_u32 s2, 96
s_cselect_b32 s43, s43, 1073741824
v_lshlrev_b32 v103, 11, v104
s_mov_b64 exec, 0xff
buffer_store_dwordx4 v[108:111], v103, s[32:35], s43 offen sc1
s_mov_b64 exec, -1
s_nop 1
Lnosent:
s_setprio 3
s_waitcnt vmcnt(0)
Lsu1:
s_add_u32 s43, s81, 6592
v_add_u32_e64 v212, s43, v246
v_subrev_u32 v222, 65920, v212
v_min_u32_e64 v212, v212, v222
v_add_u32 v212, 90112, v212
v_add_u32_e64 v213, s43, v246
v_add_u32 v213, 6592, v213
v_subrev_u32 v222, 65920, v213
v_min_u32_e64 v213, v213, v222
v_add_u32 v213, 90112, v213
v_add_u32_e64 v214, s43, v246
v_add_u32 v214, 13184, v214
v_add_u32_e64 v222, 16, v214
v_bfi_b32 v214, 48, v222, v214
v_subrev_u32 v222, 65920, v214
v_min_u32_e64 v214, v214, v222
v_add_u32 v214, 90112, v214
v_add_u32_e64 v215, s43, v246
v_add_u32 v215, 19776, v215
v_add_u32_e64 v222, 16, v215
v_bfi_b32 v215, 48, v222, v215
v_subrev_u32 v222, 65920, v215
v_min_u32_e64 v215, v215, v222
v_add_u32 v215, 90112, v215
ds_read_b128 v[144:147], v212
ds_read_b64 v[192:193], v238
ds_read_b64 v[194:195], v239
ds_read_b128 v[148:151], v213
ds_read_b128 v[152:155], v214
ds_read_b64 v[196:197], v238 offset:2400
ds_read_b64 v[198:199], v239 offset:2400
ds_read_b128 v[156:159], v215
ds_read_b64 v[200:201], v238 offset:4800
ds_read_b64 v[202:203], v239 offset:4800
ds_read_b128 v[160:163], v212 offset:16
ds_read_b64 v[204:205], v238 offset:200
ds_read_b64 v[206:207], v239 offset:200
ds_read_b128 v[164:167], v213 offset:16
ds_read_b128 v[168:171], v214 offset:16
ds_read_b64 v[208:209], v238 offset:2600
s_waitcnt lgkmcnt(13)
v_mfma_f32_16x16x32_bf16 v[0:3], v[192:195], v[144:147], 0
ds_read_b64 v[210:211], v239 offset:2600
s_waitcnt lgkmcnt(13)
v_mfma_f32_16x16x32_bf16 v[48:51], v[192:195], v[148:151], 0
ds_read_b128 v[172:175], v215 offset:16
ds_read_b64 v[192:193], v238 offset:5000
ds_read_b64 v[194:195], v239 offset:5000
s_waitcnt lgkmcnt(13)
v_mfma_f32_16x16x32_bf16 v[0:3], v[196:199], v[148:151], v[0:3]
ds_read_b128 v[144:147], v212 offset:32
v_mfma_f32_16x16x32_bf16 v[48:51], v[196:199], v[152:155], v[48:51]
ds_read_b64 v[196:197], v238 offset:400
ds_read_b64 v[198:199], v239 offset:400
s_waitcnt lgkmcnt(13)
v_mfma_f32_16x16x32_bf16 v[0:3], v[200:203], v[152:155], v[0:3]
ds_read_b128 v[148:151], v213 offset:32
v_mfma_f32_16x16x32_bf16 v[48:51], v[200:203], v[156:159], v[48:51]
ds_read_b128 v[152:155], v214 offset:32
ds_read_b64 v[200:201], v238 offset:2800
s_waitcnt lgkmcnt(13)
v_mfma_f32_16x16x32_bf16 v[4:7], v[204:207], v[160:163], 0
ds_read_b64 v[202:203], v239 offset:2800
s_waitcnt lgkmcnt(13)
v_mfma_f32_16x16x32_bf16 v[52:55], v[204:207], v[164:167], 0
ds_read_b128 v[156:159], v215 offset:32
ds_read_b64 v[204:205], v238 offset:5200
ds_read_b64 v[206:207], v239 offset:5200
s_waitcnt lgkmcnt(13)
v_mfma_f32_16x16x32_bf16 v[4:7], v[208:211], v[164:167], v[4:7]
ds_read_b128 v[160:163], v212 offset:48
v_mfma_f32_16x16x32_bf16 v[52:55], v[208:211], v[168:171], v[52:55]
ds_read_b64 v[208:209], v238 offset:600
ds_read_b64 v[210:211], v239 offset:600
s_waitcnt lgkmcnt(13)
v_mfma_f32_16x16x32_bf16 v[4:7], v[192:195], v[168:171], v[4:7]
ds_read_b128 v[164:167], v213 offset:48
v_mfma_f32_16x16x32_bf16 v[52:55], v[192:195], v[172:175], v[52:55]
ds_read_b128 v[168:171], v214 offset:48
ds_read_b64 v[192:193], v238 offset:3000
s_waitcnt lgkmcnt(13)
v_mfma_f32_16x16x32_bf16 v[8:11], v[196:199], v[144:147], 0
ds_read_b64 v[194:195], v239 offset:3000
s_waitcnt lgkmcnt(13)
v_mfma_f32_16x16x32_bf16 v[56:59], v[196:199], v[148:151], 0
ds_read_b128 v[172:175], v215 offset:48
ds_read_b64 v[196:197], v238 offset:5400
ds_read_b64 v[198:199], v239 offset:5400
s_waitcnt lgkmcnt(13)
v_mfma_f32_16x16x32_bf16 v[8:11], v[200:203], v[148:151], v[8:11]
ds_read_b128 v[144:147], v212 offset:64
v_mfma_f32_16x16x32_bf16 v[56:59], v[200:203], v[152:155], v[56:59]
ds_read_b64 v[200:201], v238 offset:800
ds_read_b64 v[202:203], v239 offset:800
s_waitcnt lgkmcnt(13)
v_mfma_f32_16x16x32_bf16 v[8:11], v[204:207], v[152:155], v[8:11]
ds_read_b128 v[148:151], v213 offset:64
v_mfma_f32_16x16x32_bf16 v[56:59], v[204:207], v[156:159], v[56:59]
ds_read_b128 v[152:155], v214 offset:64
ds_read_b64 v[204:205], v238 offset:3200
s_waitcnt lgkmcnt(13)
v_mfma_f32_16x16x32_bf16 v[12:15], v[208:211], v[160:163], 0
ds_read_b64 v[206:207], v239 offset:3200
s_waitcnt lgkmcnt(13)
v_mfma_f32_16x16x32_bf16 v[60:63], v[208:211], v[164:167], 0
ds_read_b128 v[156:159], v215 offset:64
ds_read_b64 v[208:209], v238 offset:5600
ds_read_b64 v[210:211], v239 offset:5600
s_waitcnt lgkmcnt(13)
v_mfma_f32_16x16x32_bf16 v[12:15], v[192:195], v[164:167], v[12:15]
ds_read_b128 v[160:163], v212 offset:80
v_mfma_f32_16x16x32_bf16 v[60:63], v[192:195], v[168:171], v[60:63]
ds_read_b64 v[192:193], v238 offset:1000
ds_read_b64 v[194:195], v239 offset:1000
s_waitcnt lgkmcnt(13)
v_mfma_f32_16x16x32_bf16 v[12:15], v[196:199], v[168:171], v[12:15]
ds_read_b128 v[164:167], v213 offset:80
v_mfma_f32_16x16x32_bf16 v[60:63], v[196:199], v[172:175], v[60:63]
ds_read_b128 v[168:171], v214 offset:80
ds_read_b64 v[196:197], v238 offset:3400
s_waitcnt lgkmcnt(13)
v_mfma_f32_16x16x32_bf16 v[16:19], v[200:203], v[144:147], 0
ds_read_b64 v[198:199], v239 offset:3400
s_waitcnt lgkmcnt(13)
v_mfma_f32_16x16x32_bf16 v[64:67], v[200:203], v[148:151], 0
ds_read_b128 v[172:175], v215 offset:80
ds_read_b64 v[200:201], v238 offset:5800
ds_read_b64 v[202:203], v239 offset:5800
s_waitcnt lgkmcnt(13)
v_mfma_f32_16x16x32_bf16 v[16:19], v[204:207], v[148:151], v[16:19]
ds_read_b128 v[144:147], v212 offset:96
v_mfma_f32_16x16x32_bf16 v[64:67], v[204:207], v[152:155], v[64:67]
ds_read_b64 v[204:205], v238 offset:1200
ds_read_b64 v[206:207], v239 offset:1200
s_waitcnt lgkmcnt(13)
v_mfma_f32_16x16x32_bf16 v[16:19], v[208:211], v[152:155], v[16:19]
ds_read_b128 v[148:151], v213 offset:96
v_mfma_f32_16x16x32_bf16 v[64:67], v[208:211], v[156:159], v[64:67]
ds_read_b128 v[152:155], v214 offset:96
ds_read_b64 v[208:209], v238 offset:3600
s_waitcnt lgkmcnt(13)
v_mfma_f32_16x16x32_bf16 v[20:23], v[192:195], v[160:163], 0
ds_read_b64 v[210:211], v239 offset:3600
s_waitcnt lgkmcnt(13)
v_mfma_f32_16x16x32_bf16 v[68:71], v[192:195], v[164:167], 0
ds_read_b128 v[156:159], v215 offset:96
ds_read_b64 v[192:193], v238 offset:6000
ds_read_b64 v[194:195], v239 offset:6000
s_waitcnt lgkmcnt(13)
v_mfma_f32_16x16x32_bf16 v[20:23], v[196:199], v[164:167], v[20:23]
ds_read_b128 v[160:163], v212 offset:112
v_mfma_f32_16x16x32_bf16 v[68:71], v[196:199], v[168:171], v[68:71]
ds_read_b64 v[196:197], v238 offset:1400
ds_read_b64 v[198:199], v239 offset:1400
s_waitcnt lgkmcnt(13)
v_mfma_f32_16x16x32_bf16 v[20:23], v[200:203], v[168:171], v[20:23]
ds_read_b128 v[164:167], v213 offset:112
v_mfma_f32_16x16x32_bf16 v[68:71], v[200:203], v[172:175], v[68:71]
ds_read_b128 v[168:171], v214 offset:112
ds_read_b64 v[200:201], v238 offset:3800
s_waitcnt lgkmcnt(13)
v_mfma_f32_16x16x32_bf16 v[24:27], v[204:207], v[144:147], 0
ds_read_b64 v[202:203], v239 offset:3800
s_waitcnt lgkmcnt(13)
v_mfma_f32_16x16x32_bf16 v[72:75], v[204:207], v[148:151], 0
ds_read_b128 v[172:175], v215 offset:112
ds_read_b64 v[204:205], v238 offset:6200
ds_read_b64 v[206:207], v239 offset:6200
s_waitcnt lgkmcnt(13)
v_mfma_f32_16x16x32_bf16 v[24:27], v[208:211], v[148:151], v[24:27]
ds_read_b128 v[144:147], v212 offset:128
v_mfma_f32_16x16x32_bf16 v[72:75], v[208:211], v[152:155], v[72:75]
ds_read_b64 v[208:209], v238 offset:1600
ds_read_b64 v[210:211], v239 offset:1600
s_waitcnt lgkmcnt(13)
v_mfma_f32_16x16x32_bf16 v[24:27], v[192:195], v[152:155], v[24:27]
ds_read_b128 v[148:151], v213 offset:128
v_mfma_f32_16x16x32_bf16 v[72:75], v[192:195], v[156:159], v[72:75]
ds_read_b128 v[152:155], v214 offset:128
ds_read_b64 v[192:193], v238 offset:4000
s_waitcnt lgkmcnt(13)
v_mfma_f32_16x16x32_bf16 v[28:31], v[196:199], v[160:163], 0
ds_read_b64 v[194:195], v239 offset:4000
s_waitcnt lgkmcnt(13)
v_mfma_f32_16x16x32_bf16 v[76:79], v[196:199], v[164:167], 0
ds_read_b128 v[156:159], v215 offset:128
ds_read_b64 v[196:197], v238 offset:6400
ds_read_b64 v[198:199], v239 offset:6400
s_waitcnt lgkmcnt(13)
v_mfma_f32_16x16x32_bf16 v[28:31], v[200:203], v[164:167], v[28:31]
ds_read_b128 v[160:163], v212 offset:144
v_mul_f32 v242, v0, v0
v_mfma_f32_16x16x32_bf16 v[76:79], v[200:203], v[168:171], v[76:79]
ds_read_b64 v[200:201], v238 offset:1800
ds_read_b64 v[202:203], v239 offset:1800
v_add_f32 v240, v0, v2
s_waitcnt lgkmcnt(13)
v_mfma_f32_16x16x32_bf16 v[28:31], v[204:207], v[168:171], v[28:31]
ds_read_b128 v[164:167], v213 offset:144
v_mul_f32_e64 v243, v1, v1
v_mfma_f32_16x16x32_bf16 v[76:79], v[204:207], v[172:175], v[76:79]
ds_read_b128 v[168:171], v214 offset:144
ds_read_b64 v[204:205], v238 offset:4200
v_add_f32 v241, v1, v3
s_waitcnt lgkmcnt(13)
v_mfma_f32_16x16x32_bf16 v[32:35], v[208:211], v[144:147], 0
ds_read_b64 v[206:207], v239 offset:4200
v_fmac_f32 v242, v2, v2
s_waitcnt lgkmcnt(13)
v_mfma_f32_16x16x32_bf16 v[80:83], v[208:211], v[148:151], 0
ds_read_b128 v[172:175], v215 offset:144
v_fmac_f32 v243, v3, v3
v_fmac_f32 v242, v4, v4
v_add_f32 v240, v240, v4
v_fmac_f32 v243, v5, v5
v_add_f32 v241, v241, v5
s_waitcnt lgkmcnt(11)
v_mfma_f32_16x16x32_bf16 v[32:35], v[192:195], v[148:151], v[32:35]
ds_read_b64 v[208:209], v238 offset:6600
ds_read_b64 v[210:211], v239 offset:6600
v_mfma_f32_16x16x32_bf16 v[80:83], v[192:195], v[152:155], v[80:83]
ds_read_b128 v[144:147], v212 offset:160
ds_read_b64 v[192:193], v238 offset:2000
ds_read_b64 v[194:195], v239 offset:2000
v_fmac_f32 v242, v6, v6
s_waitcnt lgkmcnt(13)
v_mfma_f32_16x16x32_bf16 v[32:35], v[196:199], v[152:155], v[32:35]
ds_read_b128 v[148:151], v213 offset:160
v_add_f32_e64 v240, v240, v6
v_mfma_f32_16x16x32_bf16 v[80:83], v[196:199], v[156:159], v[80:83]
ds_read_b128 v[152:155], v214 offset:160
ds_read_b64 v[196:197], v238 offset:4400
s_waitcnt lgkmcnt(13)
v_mfma_f32_16x16x32_bf16 v[36:39], v[200:203], v[160:163], 0
ds_read_b64 v[198:199], v239 offset:4400
v_fmac_f32 v243, v7, v7
v_add_f32 v241, v241, v7
s_waitcnt lgkmcnt(13)
v_mfma_f32_16x16x32_bf16 v[84:87], v[200:203], v[164:167], 0
ds_read_b128 v[156:159], v215 offset:160
v_fmac_f32 v242, v8, v8
v_add_f32 v240, v240, v8
v_fmac_f32 v243, v9, v9
v_add_f32 v241, v241, v9
v_fmac_f32 v242, v10, v10
s_waitcnt lgkmcnt(11)
v_mfma_f32_16x16x32_bf16 v[36:39], v[204:207], v[164:167], v[36:39]
ds_read_b64 v[200:201], v238 offset:6800
ds_read_b64 v[202:203], v239 offset:6800
v_mfma_f32_16x16x32_bf16 v[84:87], v[204:207], v[168:171], v[84:87]
ds_read_b128 v[160:163], v212 offset:176
ds_read_b64 v[204:205], v238 offset:2200
ds_read_b64 v[206:207], v239 offset:2200
s_waitcnt lgkmcnt(13)
v_mfma_f32_16x16x32_bf16 v[36:39], v[208:211], v[168:171], v[36:39]
ds_read_b128 v[164:167], v213 offset:176
v_add_f32 v240, v240, v10
v_mfma_f32_16x16x32_bf16 v[84:87], v[208:211], v[172:175], v[84:87]
ds_read_b128 v[168:171], v214 offset:176
ds_read_b64 v[208:209], v238 offset:4600
v_fmac_f32 v243, v11, v11
s_waitcnt lgkmcnt(13)
v_mfma_f32_16x16x32_bf16 v[40:43], v[192:195], v[144:147], 0
ds_read_b64 v[210:211], v239 offset:4600
v_add_f32 v241, v241, v11
s_waitcnt lgkmcnt(13)
v_mfma_f32_16x16x32_bf16 v[88:91], v[192:195], v[148:151], 0
ds_read_b128 v[172:175], v215 offset:176
v_fmac_f32 v242, v12, v12
v_add_f32 v240, v240, v12
v_fmac_f32 v243, v13, v13
v_add_f32 v241, v241, v13
v_fmac_f32 v242, v14, v14
s_waitcnt lgkmcnt(11)
v_mfma_f32_16x16x32_bf16 v[40:43], v[196:199], v[148:151], v[40:43]
ds_read_b64 v[192:193], v238 offset:7000
ds_read_b64 v[194:195], v239 offset:7000
v_mfma_f32_16x16x32_bf16 v[88:91], v[196:199], v[152:155], v[88:91]
v_add_f32 v240, v240, v14
v_fmac_f32 v243, v15, v15
v_add_f32 v241, v241, v15
s_waitcnt lgkmcnt(10)
v_mfma_f32_16x16x32_bf16 v[40:43], v[200:203], v[152:155], v[40:43]
v_fmac_f32 v242, v16, v16
v_mfma_f32_16x16x32_bf16 v[88:91], v[200:203], v[156:159], v[88:91]
v_add_f32 v240, v240, v16
v_fmac_f32 v243, v17, v17
v_add_f32 v241, v241, v17
s_waitcnt lgkmcnt(7)
v_mfma_f32_16x16x32_bf16 v[44:47], v[204:207], v[160:163], 0
v_fmac_f32 v242, v18, v18
v_add_f32 v240, v240, v18
s_waitcnt lgkmcnt(6)
v_mfma_f32_16x16x32_bf16 v[92:95], v[204:207], v[164:167], 0
v_fmac_f32 v243, v19, v19
v_add_f32 v241, v241, v19
v_fmac_f32 v242, v20, v20
v_add_f32 v240, v240, v20
v_fmac_f32 v243, v21, v21
v_add_f32 v241, v241, v21
s_waitcnt lgkmcnt(3)
v_mfma_f32_16x16x32_bf16 v[44:47], v[208:211], v[164:167], v[44:47]
v_fmac_f32 v242, v22, v22
v_mfma_f32_16x16x32_bf16 v[92:95], v[208:211], v[168:171], v[92:95]
v_add_f32 v240, v240, v22
v_fmac_f32 v243, v23, v23
v_add_f32 v241, v241, v23
s_waitcnt lgkmcnt(0)
v_mfma_f32_16x16x32_bf16 v[44:47], v[192:195], v[168:171], v[44:47]
v_fmac_f32 v242, v24, v24
v_mfma_f32_16x16x32_bf16 v[92:95], v[192:195], v[172:175], v[92:95]
v_mov_b32 v223, 1
v_add_u32 v222, s83, v247
s_mov_b64 exec, 1
ds_add_u32 v222, v223 offset:16
s_mov_b64 exec, -1
v_add_f32 v240, v240, v24
v_fmac_f32 v243, v25, v25
v_add_f32 v241, v241, v25
v_fmac_f32 v242, v26, v26
v_add_f32 v240, v240, v26
v_fmac_f32 v243, v27, v27
v_add_f32 v241, v241, v27
v_fmac_f32 v242, v28, v28
v_add_f32 v240, v240, v28
v_fmac_f32 v243, v29, v29
v_add_f32 v241, v241, v29
v_fmac_f32 v242, v30, v30
v_add_f32 v240, v240, v30
v_fmac_f32 v243, v31, v31
v_add_f32 v241, v241, v31
v_fmac_f32 v242, v32, v32
v_add_f32 v240, v240, v32
v_fmac_f32 v243, v33, v33
v_add_f32 v241, v241, v33
v_fmac_f32 v242, v34, v34
v_add_f32 v240, v240, v34
v_fmac_f32 v243, v35, v35
v_add_f32 v241, v241, v35
v_fmac_f32 v242, v36, v36
v_add_f32 v240, v240, v36
v_fmac_f32 v243, v37, v37
v_add_f32 v241, v241, v37
v_fmac_f32 v242, v38, v38
v_add_f32 v240, v240, v38
v_fmac_f32 v243, v39, v39
v_add_f32 v241, v241, v39
v_fmac_f32 v242, v40, v40
v_add_f32 v240, v240, v40
v_fmac_f32 v243, v41, v41
v_add_f32 v241, v241, v41
v_fmac_f32 v242, v42, v42
v_add_f32 v240, v240, v42
v_fmac_f32 v243, v43, v43
v_add_f32 v241, v241, v43
v_fmac_f32 v242, v44, v44
v_add_f32 v240, v240, v44
v_fmac_f32 v243, v45, v45
v_add_f32 v241, v241, v45
v_fmac_f32 v242, v46, v46
v_add_f32 v240, v240, v46
v_fmac_f32 v243, v47, v47
v_add_f32 v241, v241, v47
v_mul_f32 v218, v48, v48
v_add_f32 v216, v48, v50
v_mul_f32 v219, v49, v49
v_add_f32 v217, v49, v51
v_fmac_f32 v218, v50, v50
v_fmac_f32 v219, v51, v51
v_fmac_f32 v218, v52, v52
v_add_f32 v216, v216, v52
v_fmac_f32 v219, v53, v53
v_add_f32 v217, v217, v53
v_fmac_f32 v218, v54, v54
v_add_f32 v216, v216, v54
v_fmac_f32 v219, v55, v55
v_add_f32 v217, v217, v55
v_fmac_f32 v218, v56, v56
v_add_f32 v216, v216, v56
v_fmac_f32 v219, v57, v57
v_add_f32 v217, v217, v57
v_fmac_f32 v218, v58, v58
v_add_f32 v216, v216, v58
v_fmac_f32 v219, v59, v59
v_add_f32 v217, v217, v59
v_fmac_f32 v218, v60, v60
v_add_f32 v216, v216, v60
v_fmac_f32 v219, v61, v61
v_add_f32 v217, v217, v61
v_fmac_f32 v218, v62, v62
v_add_f32 v216, v216, v62
v_fmac_f32 v219, v63, v63
v_add_f32 v217, v217, v63
v_fmac_f32 v218, v64, v64
v_add_f32 v216, v216, v64
v_fmac_f32 v219, v65, v65
v_add_f32 v217, v217, v65
v_fmac_f32 v218, v66, v66
v_add_f32 v216, v216, v66
v_fmac_f32 v219, v67, v67
v_add_f32 v217, v217, v67
v_fmac_f32 v218, v68, v68
v_add_f32 v216, v216, v68
v_fmac_f32 v219, v69, v69
v_add_f32 v217, v217, v69
v_fmac_f32 v218, v70, v70
v_add_f32 v216, v216, v70
v_fmac_f32 v219, v71, v71
v_add_f32 v217, v217, v71
v_fmac_f32 v218, v72, v72
v_add_f32 v216, v216, v72
v_fmac_f32 v219, v73, v73
v_add_f32 v217, v217, v73
v_fmac_f32 v218, v74, v74
v_add_f32 v216, v216, v74
v_fmac_f32 v219, v75, v75
v_add_f32 v217, v217, v75
v_fmac_f32 v218, v76, v76
v_add_f32 v216, v216, v76
v_fmac_f32 v219, v77, v77
v_add_f32 v217, v217, v77
v_fmac_f32 v218, v78, v78
v_add_f32 v216, v216, v78
v_fmac_f32 v219, v79, v79
v_add_f32 v217, v217, v79
v_fmac_f32 v218, v80, v80
v_add_f32 v216, v216, v80
v_fmac_f32 v219, v81, v81
v_add_f32 v217, v217, v81
v_fmac_f32 v218, v82, v82
v_add_f32 v216, v216, v82
v_fmac_f32 v219, v83, v83
v_add_f32 v217, v217, v83
v_fmac_f32 v218, v84, v84
v_add_f32 v216, v216, v84
v_fmac_f32 v219, v85, v85
v_add_f32 v217, v217, v85
v_fmac_f32 v218, v86, v86
v_add_f32 v216, v216, v86
v_fmac_f32 v219, v87, v87
v_add_f32 v217, v217, v87
v_fmac_f32 v218, v88, v88
v_add_f32 v216, v216, v88
v_fmac_f32 v219, v89, v89
v_add_f32 v217, v217, v89
v_fmac_f32 v218, v90, v90
v_add_f32 v216, v216, v90
v_fmac_f32 v219, v91, v91
v_add_f32 v217, v217, v91
v_fmac_f32 v218, v92, v92
v_add_f32 v216, v216, v92
v_fmac_f32 v219, v93, v93
v_add_f32 v217, v217, v93
v_fmac_f32 v218, v94, v94
v_add_f32 v216, v216, v94
v_fmac_f32 v219, v95, v95
v_add_f32 v217, v217, v95
v_add_f32 v216, v216, v217
v_add_f32 v218, v218, v219
s_nop 1
v_permlane32_swap_b32 v216, v218
v_add_f32_e64 v216, v216, v218
v_mul_f32 v216, 1009429163, v216
v_mov_b32_e64 v218, v216
s_nop 1
v_permlane32_swap_b32 v216, v218
v_fma_f32 v218, -v216, v216, v218
v_max_f32_e64 v218, 0, v218
v_add_f32 v218, 925353388, v218
v_rsq_f32 v218, v218
v_add_f32 v240, v240, v241
v_mul_f32 v220, 3203396952, v218
v_mul_f32 v221, v216, v220
v_add_f32 v242, v242, v243
s_nop 1
v_permlane32_swap_b32 v240, v242
v_add_f32_e64 v240, v240, v242
v_mul_f32 v240, 1009429163, v240
v_mov_b32_e64 v242, v240
s_nop 1
v_permlane32_swap_b32 v240, v242
v_fma_f32 v242, -v240, v240, v242
v_max_f32_e64 v242, 0, v242
v_add_f32 v242, 925353388, v242
v_rsq_f32_e64 v242, v242
v_fma_f32 v48, v48, v220, -v221
v_mul_f32 v244, 3203396952, v242
v_mul_f32_e64 v245, v240, v244
v_fma_f32 v0, v0, v244, -v245
v_fma_f32 v1, v1, v244, -v245
v_cvt_pk_bf16_f32 v0, v0, v1
v_fma_f32 v2, v2, v244, -v245
v_fma_f32 v3, v3, v244, -v245
v_cvt_pk_bf16_f32 v1, v2, v3
v_fma_f32 v4, v4, v244, -v245
v_fma_f32 v5, v5, v244, -v245
v_cvt_pk_bf16_f32 v2, v4, v5
v_fma_f32 v6, v6, v244, -v245
v_fma_f32 v7, v7, v244, -v245
v_cvt_pk_bf16_f32 v3, v6, v7
v_fma_f32 v8, v8, v244, -v245
v_fma_f32 v9, v9, v244, -v245
v_cvt_pk_bf16_f32 v4, v8, v9
v_fma_f32 v10, v10, v244, -v245
v_fma_f32 v11, v11, v244, -v245
v_cvt_pk_bf16_f32 v5, v10, v11
v_fma_f32 v12, v12, v244, -v245
v_fma_f32 v13, v13, v244, -v245
v_cvt_pk_bf16_f32 v6, v12, v13
v_fma_f32 v14, v14, v244, -v245
v_fma_f32 v15, v15, v244, -v245
v_cvt_pk_bf16_f32 v7, v14, v15
v_fma_f32 v16, v16, v244, -v245
v_fma_f32 v17, v17, v244, -v245
v_cvt_pk_bf16_f32 v8, v16, v17
v_fma_f32 v18, v18, v244, -v245
v_fma_f32 v19, v19, v244, -v245
v_cvt_pk_bf16_f32 v9, v18, v19
v_fma_f32 v20, v20, v244, -v245
v_fma_f32 v21, v21, v244, -v245
v_cvt_pk_bf16_f32 v10, v20, v21
v_fma_f32 v22, v22, v244, -v245
v_fma_f32 v23, v23, v244, -v245
v_cvt_pk_bf16_f32 v11, v22, v23
v_fma_f32 v24, v24, v244, -v245
v_fma_f32 v25, v25, v244, -v245
v_cvt_pk_bf16_f32 v12, v24, v25
v_fma_f32 v26, v26, v244, -v245
v_fma_f32 v27, v27, v244, -v245
v_cvt_pk_bf16_f32 v13, v26, v27
v_mov_b32 v223, 0
s_branch Law2
Lax2:
s_sleep 2
Law2:
ds_read_b32 v223, v247 offset:8
s_sub_u32 s76, s76, 1
s_cselect_b32 s44, 4, 0
s_cselect_b32 s76, 0, s76
s_waitcnt lgkmcnt(0)
v_readfirstlane_b32 s43, v223
s_nop 1
s_max_u32 s43, s43, s44
s_cmp_lt_u32 s43, 4
s_cbranch_scc1 Lax2
v_fma_f32 v28, v28, v244, -v245
v_fma_f32 v29, v29, v244, -v245
v_cvt_pk_bf16_f32 v14, v28, v29
v_fma_f32 v30, v30, v244, -v245
v_fma_f32 v31, v31, v244, -v245
v_cvt_pk_bf16_f32 v15, v30, v31
v_fma_f32 v32, v32, v244, -v245
v_fma_f32 v33, v33, v244, -v245
v_cvt_pk_bf16_f32 v16, v32, v33
v_fma_f32 v34, v34, v244, -v245
v_fma_f32 v35, v35, v244, -v245
v_cvt_pk_bf16_f32 v17, v34, v35
v_fma_f32 v36, v36, v244, -v245
v_fma_f32 v37, v37, v244, -v245
v_cvt_pk_bf16_f32 v18, v36, v37
v_fma_f32 v38, v38, v244, -v245
v_fma_f32 v39, v39, v244, -v245
v_cvt_pk_bf16_f32 v19, v38, v39
v_fma_f32 v40, v40, v244, -v245
v_fma_f32 v41, v41, v244, -v245
v_cvt_pk_bf16_f32 v20, v40, v41
ds_read_b128 v[176:179], v250
v_fma_f32 v42, v42, v244, -v245
v_fma_f32 v43, v43, v244, -v245
v_cvt_pk_bf16_f32 v21, v42, v43
v_fma_f32 v44, v44, v244, -v245
v_fma_f32 v45, v45, v244, -v245
v_cvt_pk_bf16_f32 v22, v44, v45
v_fma_f32 v46, v46, v244, -v245
v_fma_f32 v47, v47, v244, -v245
v_cvt_pk_bf16_f32 v23, v46, v47
v_fma_f32 v49, v49, v220, -v221
v_cvt_pk_bf16_f32 v24, v48, v49
v_fma_f32 v50, v50, v220, -v221
v_fma_f32 v51, v51, v220, -v221
v_cvt_pk_bf16_f32 v25, v50, v51
v_fma_f32 v52, v52, v220, -v221
v_fma_f32 v53, v53, v220, -v221
v_cvt_pk_bf16_f32 v26, v52, v53
v_fma_f32 v54, v54, v220, -v221
v_fma_f32 v55, v55, v220, -v221
v_cvt_pk_bf16_f32 v27, v54, v55
v_fma_f32 v56, v56, v220, -v221
v_fma_f32 v57, v57, v220, -v221
v_cvt_pk_bf16_f32 v28, v56, v57
v_fma_f32 v58, v58, v220, -v221
v_fma_f32 v59, v59, v220, -v221
v_cvt_pk_bf16_f32 v29, v58, v59
v_fma_f32 v60, v60, v220, -v221
v_fma_f32 v61, v61, v220, -v221
v_cvt_pk_bf16_f32 v30, v60, v61
v_fma_f32 v62, v62, v220, -v221
v_fma_f32 v63, v63, v220, -v221
v_cvt_pk_bf16_f32 v31, v62, v63
v_fma_f32 v64, v64, v220, -v221
v_fma_f32 v65, v65, v220, -v221
v_cvt_pk_bf16_f32 v32, v64, v65
ds_read_b128 v[180:183], v250 offset:1024
v_fma_f32 v66, v66, v220, -v221
v_fma_f32 v67, v67, v220, -v221
v_cvt_pk_bf16_f32 v33, v66, v67
v_fma_f32 v68, v68, v220, -v221
v_fma_f32 v69, v69, v220, -v221
v_cvt_pk_bf16_f32 v34, v68, v69
v_fma_f32 v70, v70, v220, -v221
v_fma_f32 v71, v71, v220, -v221
v_cvt_pk_bf16_f32 v35, v70, v71
v_fma_f32 v72, v72, v220, -v221
v_fma_f32 v73, v73, v220, -v221
v_cvt_pk_bf16_f32 v36, v72, v73
v_fma_f32 v74, v74, v220, -v221
v_fma_f32 v75, v75, v220, -v221
v_cvt_pk_bf16_f32 v37, v74, v75
v_fma_f32 v76, v76, v220, -v221
v_fma_f32 v77, v77, v220, -v221
v_cvt_pk_bf16_f32 v38, v76, v77
v_fma_f32 v78, v78, v220, -v221
v_fma_f32 v79, v79, v220, -v221
v_cvt_pk_bf16_f32 v39, v78, v79
v_fma_f32 v80, v80, v220, -v221
v_fma_f32 v81, v81, v220, -v221
v_cvt_pk_bf16_f32 v40, v80, v81
v_fma_f32 v82, v82, v220, -v221
v_fma_f32 v83, v83, v220, -v221
v_cvt_pk_bf16_f32 v41, v82, v83
v_fma_f32 v84, v84, v220, -v221
v_fma_f32 v85, v85, v220, -v221
v_cvt_pk_bf16_f32 v42, v84, v85
v_fma_f32 v86, v86, v220, -v221
v_fma_f32 v87, v87, v220, -v221
v_cvt_pk_bf16_f32 v43, v86, v87
ds_read_b128 v[184:187], v250 offset:2048
v_fma_f32 v88, v88, v220, -v221
v_fma_f32 v89, v89, v220, -v221
v_cvt_pk_bf16_f32 v44, v88, v89
v_fma_f32 v90, v90, v220, -v221
v_fma_f32 v91, v91, v220, -v221
v_cvt_pk_bf16_f32 v45, v90, v91
v_fma_f32 v92, v92, v220, -v221
v_fma_f32 v93, v93, v220, -v221
v_cvt_pk_bf16_f32 v46, v92, v93
v_fma_f32 v94, v94, v220, -v221
v_fma_f32 v95, v95, v220, -v221
v_cvt_pk_bf16_f32 v47, v94, v95
s_waitcnt lgkmcnt(1)
v_mfma_f32_32x32x16_bf16 v[160:175], v[0:3], v[176:179], 0
ds_read_b128 v[188:191], v250 offset:3072
v_mfma_f32_32x32x16_bf16 v[96:111], v[24:27], v[176:179], 0
ds_read_b128 v[176:179], v250 offset:4096
v_mfma_f32_32x32x16_bf16 v[160:175], v[4:7], v[180:183], v[160:175]
v_mfma_f32_32x32x16_bf16 v[96:111], v[28:31], v[180:183], v[96:111]
ds_read_b128 v[180:183], v250 offset:5120
s_waitcnt lgkmcnt(3)
v_mfma_f32_32x32x16_bf16 v[160:175], v[8:11], v[184:187], v[160:175]
v_mfma_f32_32x32x16_bf16 v[96:111], v[32:35], v[184:187], v[96:111]
ds_read_b128 v[184:187], v250 offset:6144
s_waitcnt lgkmcnt(2)
v_mfma_f32_32x32x16_bf16 v[160:175], v[12:15], v[188:191], v[160:175]
v_mfma_f32_32x32x16_bf16 v[96:111], v[36:39], v[188:191], v[96:111]
ds_read_b128 v[188:191], v250 offset:7168
v_mfma_f32_32x32x16_bf16 v[160:175], v[16:19], v[176:179], v[160:175]
v_mfma_f32_32x32x16_bf16 v[96:111], v[40:43], v[176:179], v[96:111]
ds_read_b128 v[176:179], v250 offset:8192
s_waitcnt lgkmcnt(2)
v_mfma_f32_32x32x16_bf16 v[160:175], v[20:23], v[180:183], v[160:175]
v_mfma_f32_32x32x16_bf16 v[96:111], v[44:47], v[180:183], v[96:111]
s_getpc_b64 s[74:75]
Lcq1:
s_lshl_b32 s43, s40, 10
s_add_u32 s43, s43, 6144
s_min_u32 s43, s43, Lend-Lcq1-1024
s_add_u32 s74, s74, s43
s_addc_u32 s75, s75, 0
s_sub_u32 s74, s74, 16384
s_subb_u32 s75, s75, 0
s_mov_b32 m0, 163840
s_nop 0
global_load_lds_dword v250, s[74:75]
ds_read_b128 v[180:183], v250 offset:9216
v_mfma_f32_32x32x16_bf16 v[112:127], v[0:3], v[184:187], 0
v_cvt_pkrtz_f16_f32 v161, v160, v161
v_and_b32_e64 v161, s49, v161
v_bfe_u32 v160, v161, 2, 14
v_lshrrev_b32_e64 v161, 18, v161
ds_read_u16 v160, v160
ds_read_u16 v161, v161
v_cvt_pk_f16_f32 v172, v172, v173
v_cvt_pk_f16_f32 v174, v174, v175
v_pk_fma_f16 v173, v172, v172, s48
v_mfma_f32_32x32x16_bf16 v[128:143], v[24:27], v[184:187], 0
v_cvt_pkrtz_f16_f32 v163, v162, v163
v_and_b32_e64 v163, s49, v163
v_bfe_u32 v162, v163, 2, 14
v_lshrrev_b32_e64 v163, 18, v163
ds_read_u16 v162, v162
ds_read_u16 v163, v163
v_pk_fma_f16 v175, v174, v174, s48
v_pk_mul_f16 v173, v172, v173
v_pk_mul_f16 v175, v174, v175
v_cvt_pkrtz_f16_f32 v165, v164, v165
v_and_b32_e64 v165, s49, v165
v_bfe_u32 v164, v165, 2, 14
v_lshrrev_b32 v165, 18, v165
ds_read_u16 v164, v164
ds_read_u16 v165, v165
v_exp_f16_sdwa v173, v173 dst_sel:WORD_0 dst_unused:UNUSED_PRESERVE src0_sel:WORD_0
s_waitcnt lgkmcnt(6)
v_mfma_f32_32x32x16_bf16 v[112:127], v[4:7], v[188:191], v[112:127]
v_exp_f16_sdwa v175, v175 dst_sel:WORD_0 dst_unused:UNUSED_PRESERVE src0_sel:WORD_0
v_cvt_pkrtz_f16_f32 v167, v166, v167
v_and_b32_e64 v167, s49, v167
v_bfe_u32 v166, v167, 2, 14
v_lshrrev_b32_e64 v167, 18, v167
ds_read_u16 v166, v166
ds_read_u16 v167, v167
v_exp_f16_sdwa v173, v173 dst_sel:WORD_1 dst_unused:UNUSED_PRESERVE src0_sel:WORD_1
v_cvt_pkrtz_f16_f32 v169, v168, v169
v_and_b32_e64 v169, s49, v169
v_bfe_u32 v168, v169, 2, 14
v_lshrrev_b32_e64 v169, 18, v169
ds_read_u16 v168, v168
ds_read_u16 v169, v169
v_exp_f16_sdwa v175, v175 dst_sel:WORD_1 dst_unused:UNUSED_PRESERVE src0_sel:WORD_1
v_mfma_f32_32x32x16_bf16 v[128:143], v[28:31], v[188:191], v[128:143]
ds_read_b128 v[184:187], v250 offset:10240
v_cvt_pkrtz_f16_f32 v171, v170, v171
v_and_b32_e64 v171, s49, v171
v_bfe_u32 v170, v171, 2, 14
v_lshrrev_b32_e64 v171, 18, v171
ds_read_u16 v170, v170
ds_read_u16 v171, v171
v_pk_add_f16 v173, v173, 1.0 op_sel_hi:[1,0]
v_pk_add_f16 v175, v175, 1.0 op_sel_hi:[1,0]
v_rcp_f16_sdwa v173, v173 dst_sel:WORD_0 dst_unused:UNUSED_PRESERVE src0_sel:WORD_0
v_mfma_f32_32x32x16_bf16 v[112:127], v[8:11], v[176:179], v[112:127]
v_rcp_f16_sdwa v175, v175 dst_sel:WORD_0 dst_unused:UNUSED_PRESERVE src0_sel:WORD_0
v_rcp_f16_sdwa v173, v173 dst_sel:WORD_1 dst_unused:UNUSED_PRESERVE src0_sel:WORD_1
v_rcp_f16_sdwa v175, v175 dst_sel:WORD_1 dst_unused:UNUSED_PRESERVE src0_sel:WORD_1
v_mfma_f32_32x32x16_bf16 v[128:143], v[32:35], v[176:179], v[128:143]
ds_read_b128 v[188:191], v250 offset:11264
v_pk_mul_f16 v172, v172, v173
v_pk_mul_f16 v174, v174, v175
v_fma_mix_f32 v224, v172, v172, v224 op_sel_hi:[1,1,0]
v_fma_mix_f32 v224, v174, v174, v224 op_sel_hi:[1,1,0]
v_mfma_f32_32x32x16_bf16 v[112:127], v[12:15], v[180:183], v[112:127]
v_fma_mix_f32 v224, v172, v172, v224 op_sel:[1,1,0] op_sel_hi:[1,1,0]
v_fma_mix_f32 v224, v174, v174, v224 op_sel:[1,1,0] op_sel_hi:[1,1,0]
s_waitcnt lgkmcnt(7)
v_fma_mix_f32 v224, v160, v160, v224 op_sel_hi:[1,1,0]
v_fma_mix_f32 v224, v161, v161, v224 op_sel_hi:[1,1,0]
v_fma_mix_f32 v224, v162, v162, v224 op_sel_hi:[1,1,0]
v_fma_mix_f32 v224, v163, v163, v224 op_sel_hi:[1,1,0]
v_cvt_pkrtz_f16_f32 v97, v96, v97
v_and_b32 v97, s49, v97
v_bfe_u32 v96, v97, 2, 14
v_lshrrev_b32_e64 v97, 18, v97
ds_read_u16 v96, v96
ds_read_u16 v97, v97
v_cvt_pk_f16_f32 v106, v106, v107
v_cvt_pk_f16_f32 v108, v108, v109
v_cvt_pk_f16_f32 v110, v110, v111
v_pk_fma_f16 v107, v106, v106, s48
v_mfma_f32_32x32x16_bf16 v[128:143], v[36:39], v[180:183], v[128:143]
v_fma_mix_f32 v224, v164, v164, v224 op_sel_hi:[1,1,0]
v_fma_mix_f32 v224, v165, v165, v224 op_sel_hi:[1,1,0]
v_pk_fma_f16 v109, v108, v108, s48
ds_read_b128 v[176:179], v250 offset:12288
v_cvt_pkrtz_f16_f32 v99, v98, v99
v_and_b32_e64 v99, s49, v99
v_bfe_u32 v98, v99, 2, 14
v_lshrrev_b32_e64 v99, 18, v99
ds_read_u16 v98, v98
ds_read_u16 v99, v99
v_pk_fma_f16 v111, v110, v110, s48
v_pk_mul_f16 v107, v106, v107
v_pk_mul_f16 v109, v108, v109
v_fma_mix_f32 v224, v166, v166, v224 op_sel_hi:[1,1,0]
s_waitcnt lgkmcnt(8)
v_fma_mix_f32 v224, v167, v167, v224 op_sel_hi:[1,1,0]
v_pk_mul_f16 v111, v110, v111
v_exp_f16_sdwa v107, v107 dst_sel:WORD_0 dst_unused:UNUSED_PRESERVE src0_sel:WORD_0
v_cvt_pkrtz_f16_f32 v101, v100, v101
v_and_b32 v101, s49, v101
v_bfe_u32 v100, v101, 2, 14
v_lshrrev_b32_e64 v101, 18, v101
ds_read_u16 v100, v100
ds_read_u16 v101, v101
v_mfma_f32_32x32x16_bf16 v[112:127], v[16:19], v[184:187], v[112:127]
v_exp_f16_sdwa v109, v109 dst_sel:WORD_0 dst_unused:UNUSED_PRESERVE src0_sel:WORD_0
v_fma_mix_f32 v224, v168, v168, v224 op_sel_hi:[1,1,0]
v_fma_mix_f32 v224, v169, v169, v224 op_sel_hi:[1,1,0]
v_exp_f16_sdwa v111, v111 dst_sel:WORD_0 dst_unused:UNUSED_PRESERVE src0_sel:WORD_0
v_cvt_pkrtz_f16_f32 v103, v102, v103
v_and_b32_e64 v103, s49, v103
v_bfe_u32 v102, v103, 2, 14
v_lshrrev_b32 v103, 18, v103
ds_read_u16 v102, v102
ds_read_u16 v103, v103
v_exp_f16_sdwa v107, v107 dst_sel:WORD_1 dst_unused:UNUSED_PRESERVE src0_sel:WORD_1
s_waitcnt lgkmcnt(7)
v_fma_mix_f32 v224, v170, v170, v224 op_sel_hi:[1,1,0]
v_fma_mix_f32 v224, v171, v171, v224 op_sel_hi:[1,1,0]
v_exp_f16_sdwa v109, v109 dst_sel:WORD_1 dst_unused:UNUSED_PRESERVE src0_sel:WORD_1
v_mfma_f32_32x32x16_bf16 v[128:143], v[40:43], v[184:187], v[128:143]
v_exp_f16_sdwa v111, v111 dst_sel:WORD_1 dst_unused:UNUSED_PRESERVE src0_sel:WORD_1
ds_read_b128 v[180:183], v250 offset:13312
v_cvt_pkrtz_f16_f32 v105, v104, v105
v_and_b32_e64 v105, s49, v105
v_bfe_u32 v104, v105, 2, 14
v_lshrrev_b32_e64 v105, 18, v105
ds_read_u16 v104, v104
ds_read_u16 v105, v105
v_pk_add_f16 v107, v107, 1.0 op_sel_hi:[1,0]
v_pk_add_f16 v109, v109, 1.0 op_sel_hi:[1,0]
v_pk_add_f16 v111, v111, 1.0 op_sel_hi:[1,0]
v_rcp_f16_sdwa v107, v107 dst_sel:WORD_0 dst_unused:UNUSED_PRESERVE src0_sel:WORD_0
v_mfma_f32_32x32x16_bf16 v[112:127], v[20:23], v[188:191], v[112:127]
v_rcp_f16_sdwa v109, v109 dst_sel:WORD_0 dst_unused:UNUSED_PRESERVE src0_sel:WORD_0
v_rcp_f16_sdwa v111, v111 dst_sel:WORD_0 dst_unused:UNUSED_PRESERVE src0_sel:WORD_0
v_rcp_f16_sdwa v107, v107 dst_sel:WORD_1 dst_unused:UNUSED_PRESERVE src0_sel:WORD_1
v_rcp_f16_sdwa v109, v109 dst_sel:WORD_1 dst_unused:UNUSED_PRESERVE src0_sel:WORD_1
v_mfma_f32_32x32x16_bf16 v[128:143], v[44:47], v[188:191], v[128:143]
v_rcp_f16_sdwa v111, v111 dst_sel:WORD_1 dst_unused:UNUSED_PRESERVE src0_sel:WORD_1
ds_read_b128 v[184:187], v250 offset:14336
v_pk_mul_f16 v106, v106, v107
v_pk_mul_f16 v108, v108, v109
v_pk_mul_f16 v110, v110, v111
v_fma_mix_f32 v224, v106, v106, v224 op_sel_hi:[1,1,0]
v_fma_mix_f32 v224, v108, v108, v224 op_sel_hi:[1,1,0]
s_waitcnt lgkmcnt(5)
v_mfma_f32_32x32x16_bf16 v[144:159], v[0:3], v[176:179], 0
buffer_store_dwordx4 v[0:3], v250, s[32:35], s80 offen
v_fma_mix_f32 v224, v110, v110, v224 op_sel_hi:[1,1,0]
v_fma_mix_f32 v224, v106, v106, v224 op_sel:[1,1,0] op_sel_hi:[1,1,0]
v_fma_mix_f32 v224, v108, v108, v224 op_sel:[1,1,0] op_sel_hi:[1,1,0]
v_fma_mix_f32 v224, v110, v110, v224 op_sel:[1,1,0] op_sel_hi:[1,1,0]
v_fma_mix_f32 v224, v96, v96, v224 op_sel_hi:[1,1,0]
v_fma_mix_f32 v224, v97, v97, v224 op_sel_hi:[1,1,0]
v_cvt_pkrtz_f16_f32 v113, v112, v113
v_and_b32 v113, s49, v113
v_bfe_u32 v112, v113, 2, 14
v_lshrrev_b32_e64 v113, 18, v113
ds_read_u16 v112, v112
ds_read_u16 v113, v113
v_cvt_pk_f16_f32 v124, v124, v125
v_fma_mix_f32 v224, v98, v98, v224 op_sel_hi:[1,1,0]
v_fma_mix_f32 v224, v99, v99, v224 op_sel_hi:[1,1,0]
v_cvt_pk_f16_f32 v126, v126, v127
v_pk_fma_f16 v125, v124, v124, s48
v_mfma_f32_32x32x16_bf16 v[160:175], v[24:27], v[176:179], 0
v_cvt_pkrtz_f16_f32 v115, v114, v115
v_and_b32_e64 v115, s49, v115
v_bfe_u32 v114, v115, 2, 14
v_lshrrev_b32_e64 v115, 18, v115
ds_read_u16 v114, v114
ds_read_u16 v115, v115
v_pk_fma_f16 v127, v126, v126, s48
ds_read_b128 v[188:191], v250 offset:15360
v_fma_mix_f32 v224, v100, v100, v224 op_sel_hi:[1,1,0]
v_fma_mix_f32 v224, v101, v101, v224 op_sel_hi:[1,1,0]
v_pk_mul_f16 v125, v124, v125
v_pk_mul_f16 v127, v126, v127
v_cvt_pkrtz_f16_f32 v117, v116, v117
v_and_b32_e64 v117, s49, v117
v_bfe_u32 v116, v117, 2, 14
v_lshrrev_b32 v117, 18, v117
ds_read_u16 v116, v116
ds_read_u16 v117, v117
v_exp_f16_sdwa v125, v125 dst_sel:WORD_0 dst_unused:UNUSED_PRESERVE src0_sel:WORD_0
v_fma_mix_f32 v224, v102, v102, v224 op_sel_hi:[1,1,0]
s_waitcnt lgkmcnt(7)
v_fma_mix_f32 v224, v103, v103, v224 op_sel_hi:[1,1,0]
v_mfma_f32_32x32x16_bf16 v[144:159], v[4:7], v[180:183], v[144:159]
v_exp_f16_sdwa v127, v127 dst_sel:WORD_0 dst_unused:UNUSED_PRESERVE src0_sel:WORD_0
v_cvt_pkrtz_f16_f32 v119, v118, v119
v_and_b32_e64 v119, s49, v119
v_bfe_u32 v118, v119, 2, 14
v_lshrrev_b32_e64 v119, 18, v119
ds_read_u16 v118, v118
ds_read_u16 v119, v119
v_exp_f16_sdwa v125, v125 dst_sel:WORD_1 dst_unused:UNUSED_PRESERVE src0_sel:WORD_1
v_fma_mix_f32 v224, v104, v104, v224 op_sel_hi:[1,1,0]
v_fma_mix_f32 v224, v105, v105, v224 op_sel_hi:[1,1,0]
v_cvt_pkrtz_f16_f32 v121, v120, v121
v_and_b32_e64 v121, s49, v121
v_bfe_u32 v120, v121, 2, 14
v_lshrrev_b32_e64 v121, 18, v121
ds_read_u16 v120, v120
ds_read_u16 v121, v121
v_exp_f16_sdwa v127, v127 dst_sel:WORD_1 dst_unused:UNUSED_PRESERVE src0_sel:WORD_1
v_mfma_f32_32x32x16_bf16 v[160:175], v[28:31], v[180:183], v[160:175]
ds_read_b128 v[176:179], v250 offset:16384
v_cvt_pkrtz_f16_f32 v123, v122, v123
v_and_b32_e64 v123, s49, v123
v_bfe_u32 v122, v123, 2, 14
v_lshrrev_b32_e64 v123, 18, v123
ds_read_u16 v122, v122
ds_read_u16 v123, v123
v_pk_add_f16 v125, v125, 1.0 op_sel_hi:[1,0]
v_pk_add_f16 v127, v127, 1.0 op_sel_hi:[1,0]
v_rcp_f16_sdwa v125, v125 dst_sel:WORD_0 dst_unused:UNUSED_PRESERVE src0_sel:WORD_0
v_mfma_f32_32x32x16_bf16 v[144:159], v[8:11], v[184:187], v[144:159]
v_rcp_f16_sdwa v127, v127 dst_sel:WORD_0 dst_unused:UNUSED_PRESERVE src0_sel:WORD_0
s_add_u32 s46, s80, 2097152
buffer_store_dwordx4 v[4:7], v250, s[32:35], s46 offen
v_rcp_f16_sdwa v125, v125 dst_sel:WORD_1 dst_unused:UNUSED_PRESERVE src0_sel:WORD_1
v_rcp_f16_sdwa v127, v127 dst_sel:WORD_1 dst_unused:UNUSED_PRESERVE src0_sel:WORD_1
v_mfma_f32_32x32x16_bf16 v[160:175], v[32:35], v[184:187], v[160:175]
ds_read_b128 v[180:183], v250 offset:17408
v_pk_mul_f16 v124, v124, v125
v_pk_mul_f16 v126, v126, v127
v_fma_mix_f32 v225, v124, v124, v225 op_sel_hi:[1,1,0]
v_fma_mix_f32 v225, v126, v126, v225 op_sel_hi:[1,1,0]
s_waitcnt lgkmcnt(7)
v_mfma_f32_32x32x16_bf16 v[144:159], v[12:15], v[188:191], v[144:159]
v_fma_mix_f32 v225, v124, v124, v225 op_sel:[1,1,0] op_sel_hi:[1,1,0]
v_fma_mix_f32 v225, v126, v126, v225 op_sel:[1,1,0] op_sel_hi:[1,1,0]
v_fma_mix_f32 v225, v112, v112, v225 op_sel_hi:[1,1,0]
v_fma_mix_f32 v225, v113, v113, v225 op_sel_hi:[1,1,0]
v_fma_mix_f32 v225, v114, v114, v225 op_sel_hi:[1,1,0]
v_fma_mix_f32 v225, v115, v115, v225 op_sel_hi:[1,1,0]
v_cvt_pkrtz_f16_f32 v129, v128, v129
v_and_b32 v129, s49, v129
v_bfe_u32 v128, v129, 2, 14
v_lshrrev_b32_e64 v129, 18, v129
ds_read_u16 v128, v128
ds_read_u16 v129, v129
v_cvt_pk_f16_f32 v138, v138, v139
v_cvt_pk_f16_f32 v140, v140, v141
v_cvt_pk_f16_f32 v142, v142, v143
v_pk_fma_f16 v139, v138, v138, s48
v_mfma_f32_32x32x16_bf16 v[160:175], v[36:39], v[188:191], v[160:175]
v_fma_mix_f32 v225, v116, v116, v225 op_sel_hi:[1,1,0]
v_fma_mix_f32 v225, v117, v117, v225 op_sel_hi:[1,1,0]
v_pk_fma_f16 v141, v140, v140, s48
ds_read_b128 v[184:187], v250 offset:18432
v_cvt_pkrtz_f16_f32 v131, v130, v131
v_and_b32_e64 v131, s49, v131
v_bfe_u32 v130, v131, 2, 14
v_lshrrev_b32_e64 v131, 18, v131
ds_read_u16 v130, v130
ds_read_u16 v131, v131
v_pk_fma_f16 v143, v142, v142, s48
v_pk_mul_f16 v139, v138, v139
v_pk_mul_f16 v141, v140, v141
v_fma_mix_f32 v225, v118, v118, v225 op_sel_hi:[1,1,0]
s_waitcnt lgkmcnt(7)
v_fma_mix_f32 v225, v119, v119, v225 op_sel_hi:[1,1,0]
v_pk_mul_f16 v143, v142, v143
v_exp_f16_sdwa v139, v139 dst_sel:WORD_0 dst_unused:UNUSED_PRESERVE src0_sel:WORD_0
v_cvt_pkrtz_f16_f32 v133, v132, v133
v_and_b32 v133, s49, v133
v_bfe_u32 v132, v133, 2, 14
v_lshrrev_b32_e64 v133, 18, v133
ds_read_u16 v132, v132
ds_read_u16 v133, v133
v_mfma_f32_32x32x16_bf16 v[144:159], v[16:19], v[176:179], v[144:159]
v_exp_f16_sdwa v141, v141 dst_sel:WORD_0 dst_unused:UNUSED_PRESERVE src0_sel:WORD_0
v_fma_mix_f32 v225, v120, v120, v225 op_sel_hi:[1,1,0]
v_fma_mix_f32 v225, v121, v121, v225 op_sel_hi:[1,1,0]
v_exp_f16_sdwa v143, v143 dst_sel:WORD_0 dst_unused:UNUSED_PRESERVE src0_sel:WORD_0
s_add_u32 s46, s80, 4194304
buffer_store_dwordx4 v[8:11], v250, s[32:35], s46 offen
v_cvt_pkrtz_f16_f32 v135, v134, v135
v_and_b32_e64 v135, s49, v135
v_bfe_u32 v134, v135, 2, 14
v_lshrrev_b32 v135, 18, v135
ds_read_u16 v134, v134
ds_read_u16 v135, v135
v_exp_f16_sdwa v139, v139 dst_sel:WORD_1 dst_unused:UNUSED_PRESERVE src0_sel:WORD_1
v_fma_mix_f32 v225, v122, v122, v225 op_sel_hi:[1,1,0]
s_waitcnt lgkmcnt(6)
v_fma_mix_f32 v225, v123, v123, v225 op_sel_hi:[1,1,0]
v_exp_f16_sdwa v141, v141 dst_sel:WORD_1 dst_unused:UNUSED_PRESERVE src0_sel:WORD_1
v_mfma_f32_32x32x16_bf16 v[160:175], v[40:43], v[176:179], v[160:175]
v_exp_f16_sdwa v143, v143 dst_sel:WORD_1 dst_unused:UNUSED_PRESERVE src0_sel:WORD_1
ds_read_b128 v[188:191], v250 offset:19456
v_cvt_pkrtz_f16_f32 v137, v136, v137
v_and_b32_e64 v137, s49, v137
v_bfe_u32 v136, v137, 2, 14
v_lshrrev_b32_e64 v137, 18, v137
ds_read_u16 v136, v136
ds_read_u16 v137, v137
v_pk_add_f16 v139, v139, 1.0 op_sel_hi:[1,0]
v_pk_add_f16 v141, v141, 1.0 op_sel_hi:[1,0]
v_pk_add_f16 v143, v143, 1.0 op_sel_hi:[1,0]
v_rcp_f16_sdwa v139, v139 dst_sel:WORD_0 dst_unused:UNUSED_PRESERVE src0_sel:WORD_0
v_mfma_f32_32x32x16_bf16 v[144:159], v[20:23], v[180:183], v[144:159]
v_rcp_f16_sdwa v141, v141 dst_sel:WORD_0 dst_unused:UNUSED_PRESERVE src0_sel:WORD_0
v_rcp_f16_sdwa v143, v143 dst_sel:WORD_0 dst_unused:UNUSED_PRESERVE src0_sel:WORD_0
v_rcp_f16_sdwa v139, v139 dst_sel:WORD_1 dst_unused:UNUSED_PRESERVE src0_sel:WORD_1
v_rcp_f16_sdwa v141, v141 dst_sel:WORD_1 dst_unused:UNUSED_PRESERVE src0_sel:WORD_1
v_mfma_f32_32x32x16_bf16 v[160:175], v[44:47], v[180:183], v[160:175]
v_rcp_f16_sdwa v143, v143 dst_sel:WORD_1 dst_unused:UNUSED_PRESERVE src0_sel:WORD_1
ds_read_b128 v[176:179], v250 offset:20480
v_pk_mul_f16 v138, v138, v139
v_pk_mul_f16 v140, v140, v141
v_pk_mul_f16 v142, v142, v143
v_fma_mix_f32 v225, v138, v138, v225 op_sel_hi:[1,1,0]
v_fma_mix_f32 v225, v140, v140, v225 op_sel_hi:[1,1,0]
v_mfma_f32_32x32x16_bf16 v[96:111], v[0:3], v[184:187], 0
v_fma_mix_f32 v225, v142, v142, v225 op_sel_hi:[1,1,0]
v_fma_mix_f32 v225, v138, v138, v225 op_sel:[1,1,0] op_sel_hi:[1,1,0]
v_fma_mix_f32 v225, v140, v140, v225 op_sel:[1,1,0] op_sel_hi:[1,1,0]
v_fma_mix_f32 v225, v142, v142, v225 op_sel:[1,1,0] op_sel_hi:[1,1,0]
v_fma_mix_f32 v225, v128, v128, v225 op_sel_hi:[1,1,0]
v_fma_mix_f32 v225, v129, v129, v225 op_sel_hi:[1,1,0]
v_cvt_pkrtz_f16_f32 v145, v144, v145
v_and_b32_e64 v145, s49, v145
v_bfe_u32 v144, v145, 2, 14
v_lshrrev_b32 v145, 18, v145
ds_read_u16 v144, v144
ds_read_u16 v145, v145
v_cvt_pk_f16_f32 v156, v156, v157
s_add_u32 s46, s80, 6291456
buffer_store_dwordx4 v[12:15], v250, s[32:35], s46 offen
s_waitcnt lgkmcnt(4)
v_fma_mix_f32 v225, v130, v130, v225 op_sel_hi:[1,1,0]
v_fma_mix_f32 v225, v131, v131, v225 op_sel_hi:[1,1,0]
v_cvt_pk_f16_f32 v158, v158, v159
v_pk_fma_f16 v157, v156, v156, s48
v_mfma_f32_32x32x16_bf16 v[112:127], v[24:27], v[184:187], 0
v_cvt_pkrtz_f16_f32 v147, v146, v147
v_and_b32_e64 v147, s49, v147
v_bfe_u32 v146, v147, 2, 14
v_lshrrev_b32_e64 v147, 18, v147
ds_read_u16 v146, v146
ds_read_u16 v147, v147
v_pk_fma_f16 v159, v158, v158, s48
ds_read_b128 v[180:183], v250 offset:21504
v_fma_mix_f32 v225, v132, v132, v225 op_sel_hi:[1,1,0]
v_fma_mix_f32 v225, v133, v133, v225 op_sel_hi:[1,1,0]
v_pk_mul_f16 v157, v156, v157
v_pk_mul_f16 v159, v158, v159
v_cvt_pkrtz_f16_f32 v149, v148, v149
v_and_b32_e64 v149, s49, v149
v_bfe_u32 v148, v149, 2, 14
v_lshrrev_b32_e64 v149, 18, v149
ds_read_u16 v148, v148
ds_read_u16 v149, v149
v_exp_f16_sdwa v157, v157 dst_sel:WORD_0 dst_unused:UNUSED_PRESERVE src0_sel:WORD_0
v_fma_mix_f32 v225, v134, v134, v225 op_sel_hi:[1,1,0]
v_fma_mix_f32 v225, v135, v135, v225 op_sel_hi:[1,1,0]
v_mfma_f32_32x32x16_bf16 v[96:111], v[4:7], v[188:191], v[96:111]
v_exp_f16_sdwa v159, v159 dst_sel:WORD_0 dst_unused:UNUSED_PRESERVE src0_sel:WORD_0
v_cvt_pkrtz_f16_f32 v151, v150, v151
v_and_b32_e64 v151, s49, v151
v_bfe_u32 v150, v151, 2, 14
v_lshrrev_b32_e64 v151, 18, v151
ds_read_u16 v150, v150
ds_read_u16 v151, v151
v_exp_f16_sdwa v157, v157 dst_sel:WORD_1 dst_unused:UNUSED_PRESERVE src0_sel:WORD_1
v_fma_mix_f32 v225, v136, v136, v225 op_sel_hi:[1,1,0]
s_waitcnt lgkmcnt(7)
v_fma_mix_f32 v225, v137, v137, v225 op_sel_hi:[1,1,0]
v_cvt_pkrtz_f16_f32 v153, v152, v153
v_and_b32 v153, s49, v153
v_bfe_u32 v152, v153, 2, 14
v_lshrrev_b32_e64 v153, 18, v153
ds_read_u16 v152, v152
ds_read_u16 v153, v153
v_exp_f16_sdwa v159, v159 dst_sel:WORD_1 dst_unused:UNUSED_PRESERVE src0_sel:WORD_1
v_mfma_f32_32x32x16_bf16 v[112:127], v[28:31], v[188:191], v[112:127]
ds_read_b128 v[184:187], v250 offset:22528
v_cvt_pkrtz_f16_f32 v155, v154, v155
v_and_b32_e64 v155, s49, v155
v_bfe_u32 v154, v155, 2, 14
v_lshrrev_b32_e64 v155, 18, v155
ds_read_u16 v154, v154
ds_read_u16 v155, v155
v_pk_add_f16 v157, v157, 1.0 op_sel_hi:[1,0]
v_pk_add_f16 v159, v159, 1.0 op_sel_hi:[1,0]
v_rcp_f16_sdwa v157, v157 dst_sel:WORD_0 dst_unused:UNUSED_PRESERVE src0_sel:WORD_0
v_mfma_f32_32x32x16_bf16 v[96:111], v[8:11], v[176:179], v[96:111]
v_rcp_f16_sdwa v159, v159 dst_sel:WORD_0 dst_unused:UNUSED_PRESERVE src0_sel:WORD_0
v_rcp_f16_sdwa v157, v157 dst_sel:WORD_1 dst_unused:UNUSED_PRESERVE src0_sel:WORD_1
s_add_u32 s46, s80, 8388608
buffer_store_dwordx4 v[16:19], v250, s[32:35], s46 offen
v_rcp_f16_sdwa v159, v159 dst_sel:WORD_1 dst_unused:UNUSED_PRESERVE src0_sel:WORD_1
v_mfma_f32_32x32x16_bf16 v[112:127], v[32:35], v[176:179], v[112:127]
ds_read_b128 v[188:191], v250 offset:23552
v_mov_b32 v223, 0
s_branch Law3
Lax3:
s_sleep 2
Law3:
ds_read_b32 v223, v247 offset:12
s_sub_u32 s76, s76, 1
s_cselect_b32 s44, 4, 0
s_cselect_b32 s76, 0, s76
s_waitcnt lgkmcnt(0)
v_readfirstlane_b32 s43, v223
s_nop 1
s_max_u32 s43, s43, s44
s_cmp_lt_u32 s43, 4
s_cbranch_scc1 Lax3
v_pk_mul_f16 v156, v156, v157
v_pk_mul_f16 v158, v158, v159
v_fma_mix_f32 v226, v156, v156, v226 op_sel_hi:[1,1,0]
v_fma_mix_f32 v226, v158, v158, v226 op_sel_hi:[1,1,0]
v_mfma_f32_32x32x16_bf16 v[96:111], v[12:15], v[180:183], v[96:111]
v_fma_mix_f32 v226, v156, v156, v226 op_sel:[1,1,0] op_sel_hi:[1,1,0]
v_fma_mix_f32 v226, v158, v158, v226 op_sel:[1,1,0] op_sel_hi:[1,1,0]
v_fma_mix_f32 v226, v144, v144, v226 op_sel_hi:[1,1,0]
v_fma_mix_f32 v226, v145, v145, v226 op_sel_hi:[1,1,0]
v_fma_mix_f32 v226, v146, v146, v226 op_sel_hi:[1,1,0]
v_fma_mix_f32 v226, v147, v147, v226 op_sel_hi:[1,1,0]
v_cvt_pkrtz_f16_f32 v161, v160, v161
v_and_b32_e64 v161, s49, v161
v_bfe_u32 v160, v161, 2, 14
v_lshrrev_b32_e64 v161, 18, v161
ds_read_u16 v160, v160
ds_read_u16 v161, v161
v_cvt_pk_f16_f32 v170, v170, v171
v_cvt_pk_f16_f32 v172, v172, v173
v_cvt_pk_f16_f32 v174, v174, v175
v_pk_fma_f16 v171, v170, v170, s48
v_mfma_f32_32x32x16_bf16 v[112:127], v[36:39], v[180:183], v[112:127]
v_fma_mix_f32 v226, v148, v148, v226 op_sel_hi:[1,1,0]
v_fma_mix_f32 v226, v149, v149, v226 op_sel_hi:[1,1,0]
v_pk_fma_f16 v173, v172, v172, s48
ds_read_b128 v[176:179], v250 offset:24576
v_cvt_pkrtz_f16_f32 v163, v162, v163
v_and_b32_e64 v163, s49, v163
v_bfe_u32 v162, v163, 2, 14
v_lshrrev_b32_e64 v163, 18, v163
ds_read_u16 v162, v162
ds_read_u16 v163, v163
v_pk_fma_f16 v175, v174, v174, s48
v_pk_mul_f16 v171, v170, v171
v_pk_mul_f16 v173, v172, v173
v_fma_mix_f32 v226, v150, v150, v226 op_sel_hi:[1,1,0]
v_fma_mix_f32 v226, v151, v151, v226 op_sel_hi:[1,1,0]
v_pk_mul_f16 v175, v174, v175
v_exp_f16_sdwa v171, v171 dst_sel:WORD_0 dst_unused:UNUSED_PRESERVE src0_sel:WORD_0
v_cvt_pkrtz_f16_f32 v165, v164, v165
v_and_b32_e64 v165, s49, v165
v_bfe_u32 v164, v165, 2, 14
v_lshrrev_b32_e64 v165, 18, v165
ds_read_u16 v164, v164
ds_read_u16 v165, v165
v_mfma_f32_32x32x16_bf16 v[96:111], v[16:19], v[184:187], v[96:111]
v_exp_f16_sdwa v173, v173 dst_sel:WORD_0 dst_unused:UNUSED_PRESERVE src0_sel:WORD_0
v_fma_mix_f32 v226, v152, v152, v226 op_sel_hi:[1,1,0]
v_fma_mix_f32 v226, v153, v153, v226 op_sel_hi:[1,1,0]
v_exp_f16_sdwa v175, v175 dst_sel:WORD_0 dst_unused:UNUSED_PRESERVE src0_sel:WORD_0
v_cvt_pkrtz_f16_f32 v167, v166, v167
v_and_b32_e64 v167, s49, v167
v_bfe_u32 v166, v167, 2, 14
v_lshrrev_b32_e64 v167, 18, v167
ds_read_u16 v166, v166
ds_read_u16 v167, v167
v_exp_f16_sdwa v171, v171 dst_sel:WORD_1 dst_unused:UNUSED_PRESERVE src0_sel:WORD_1
v_fma_mix_f32 v226, v154, v154, v226 op_sel_hi:[1,1,0]
v_fma_mix_f32 v226, v155, v155, v226 op_sel_hi:[1,1,0]
v_exp_f16_sdwa v173, v173 dst_sel:WORD_1 dst_unused:UNUSED_PRESERVE src0_sel:WORD_1
s_add_u32 s46, s80, 10485760
buffer_store_dwordx4 v[20:23], v250, s[32:35], s46 offen
v_mfma_f32_32x32x16_bf16 v[112:127], v[40:43], v[184:187], v[112:127]
v_exp_f16_sdwa v175, v175 dst_sel:WORD_1 dst_unused:UNUSED_PRESERVE src0_sel:WORD_1
ds_read_b128 v[180:183], v250 offset:25600
v_cvt_pkrtz_f16_f32 v169, v168, v169
v_and_b32_e64 v169, s49, v169
v_bfe_u32 v168, v169, 2, 14
v_lshrrev_b32_e64 v169, 18, v169
ds_read_u16 v168, v168
ds_read_u16 v169, v169
v_pk_add_f16 v171, v171, 1.0 op_sel_hi:[1,0]
v_pk_add_f16 v173, v173, 1.0 op_sel_hi:[1,0]
v_pk_add_f16 v175, v175, 1.0 op_sel_hi:[1,0]
v_rcp_f16_sdwa v171, v171 dst_sel:WORD_0 dst_unused:UNUSED_PRESERVE src0_sel:WORD_0
v_mfma_f32_32x32x16_bf16 v[96:111], v[20:23], v[188:191], v[96:111]
v_rcp_f16_sdwa v173, v173 dst_sel:WORD_0 dst_unused:UNUSED_PRESERVE src0_sel:WORD_0
v_rcp_f16_sdwa v175, v175 dst_sel:WORD_0 dst_unused:UNUSED_PRESERVE src0_sel:WORD_0
v_rcp_f16_sdwa v171, v171 dst_sel:WORD_1 dst_unused:UNUSED_PRESERVE src0_sel:WORD_1
v_rcp_f16_sdwa v173, v173 dst_sel:WORD_1 dst_unused:UNUSED_PRESERVE src0_sel:WORD_1
v_mfma_f32_32x32x16_bf16 v[112:127], v[44:47], v[188:191], v[112:127]
v_rcp_f16_sdwa v175, v175 dst_sel:WORD_1 dst_unused:UNUSED_PRESERVE src0_sel:WORD_1
ds_read_b128 v[184:187], v250 offset:26624
v_pk_mul_f16 v170, v170, v171
v_pk_mul_f16 v172, v172, v173
v_pk_mul_f16 v174, v174, v175
v_fma_mix_f32 v226, v170, v170, v226 op_sel_hi:[1,1,0]
v_fma_mix_f32 v226, v172, v172, v226 op_sel_hi:[1,1,0]
s_waitcnt lgkmcnt(4)
v_mfma_f32_32x32x16_bf16 v[128:143], v[0:3], v[176:179], 0
v_fma_mix_f32 v226, v174, v174, v226 op_sel_hi:[1,1,0]
v_fma_mix_f32 v226, v170, v170, v226 op_sel:[1,1,0] op_sel_hi:[1,1,0]
v_fma_mix_f32 v226, v172, v172, v226 op_sel:[1,1,0] op_sel_hi:[1,1,0]
v_fma_mix_f32 v226, v174, v174, v226 op_sel:[1,1,0] op_sel_hi:[1,1,0]
v_fma_mix_f32 v226, v160, v160, v226 op_sel_hi:[1,1,0]
v_fma_mix_f32 v226, v161, v161, v226 op_sel_hi:[1,1,0]
v_cvt_pkrtz_f16_f32 v97, v96, v97
v_and_b32 v97, s49, v97
v_bfe_u32 v96, v97, 2, 14
v_lshrrev_b32_e64 v97, 18, v97
ds_read_u16 v96, v96
ds_read_u16 v97, v97
v_cvt_pk_f16_f32 v108, v108, v109
v_fma_mix_f32 v226, v162, v162, v226 op_sel_hi:[1,1,0]
v_fma_mix_f32 v226, v163, v163, v226 op_sel_hi:[1,1,0]
v_cvt_pk_f16_f32 v110, v110, v111
v_pk_fma_f16 v109, v108, v108, s48
v_mfma_f32_32x32x16_bf16 v[144:159], v[24:27], v[176:179], 0
v_cvt_pkrtz_f16_f32 v99, v98, v99
v_and_b32_e64 v99, s49, v99
v_bfe_u32 v98, v99, 2, 14
v_lshrrev_b32_e64 v99, 18, v99
ds_read_u16 v98, v98
ds_read_u16 v99, v99
v_pk_fma_f16 v111, v110, v110, s48
ds_read_b128 v[188:191], v250 offset:27648
v_fma_mix_f32 v226, v164, v164, v226 op_sel_hi:[1,1,0]
v_fma_mix_f32 v226, v165, v165, v226 op_sel_hi:[1,1,0]
v_pk_mul_f16 v109, v108, v109
v_pk_mul_f16 v111, v110, v111
v_cvt_pkrtz_f16_f32 v101, v100, v101
v_and_b32_e64 v101, s49, v101
v_bfe_u32 v100, v101, 2, 14
v_lshrrev_b32_e64 v101, 18, v101
ds_read_u16 v100, v100
ds_read_u16 v101, v101
v_exp_f16_sdwa v109, v109 dst_sel:WORD_0 dst_unused:UNUSED_PRESERVE src0_sel:WORD_0
v_fma_mix_f32 v226, v166, v166, v226 op_sel_hi:[1,1,0]
v_fma_mix_f32 v226, v167, v167, v226 op_sel_hi:[1,1,0]
s_waitcnt lgkmcnt(7)
v_mfma_f32_32x32x16_bf16 v[128:143], v[4:7], v[180:183], v[128:143]
v_exp_f16_sdwa v111, v111 dst_sel:WORD_0 dst_unused:UNUSED_PRESERVE src0_sel:WORD_0
v_cvt_pkrtz_f16_f32 v103, v102, v103
v_and_b32 v103, s49, v103
v_bfe_u32 v102, v103, 2, 14
v_lshrrev_b32_e64 v103, 18, v103
ds_read_u16 v102, v102
ds_read_u16 v103, v103
v_exp_f16_sdwa v109, v109 dst_sel:WORD_1 dst_unused:UNUSED_PRESERVE src0_sel:WORD_1
v_fma_mix_f32 v226, v168, v168, v226 op_sel_hi:[1,1,0]
v_fma_mix_f32 v226, v169, v169, v226 op_sel_hi:[1,1,0]
v_cvt_pkrtz_f16_f32 v105, v104, v105
v_and_b32_e64 v105, s49, v105
v_bfe_u32 v104, v105, 2, 14
v_lshrrev_b32_e64 v105, 18, v105
ds_read_u16 v104, v104
ds_read_u16 v105, v105
v_exp_f16_sdwa v111, v111 dst_sel:WORD_1 dst_unused:UNUSED_PRESERVE src0_sel:WORD_1
v_mfma_f32_32x32x16_bf16 v[144:159], v[28:31], v[180:183], v[144:159]
ds_read_b128 v[176:179], v250 offset:28672
v_cvt_pkrtz_f16_f32 v107, v106, v107
v_and_b32_e64 v107, s49, v107
v_bfe_u32 v106, v107, 2, 14
v_lshrrev_b32_e64 v107, 18, v107
ds_read_u16 v106, v106
ds_read_u16 v107, v107
v_pk_add_f16 v109, v109, 1.0 op_sel_hi:[1,0]
v_pk_add_f16 v111, v111, 1.0 op_sel_hi:[1,0]
v_rcp_f16_sdwa v109, v109 dst_sel:WORD_0 dst_unused:UNUSED_PRESERVE src0_sel:WORD_0
v_mfma_f32_32x32x16_bf16 v[128:143], v[8:11], v[184:187], v[128:143]
v_rcp_f16_sdwa v111, v111 dst_sel:WORD_0 dst_unused:UNUSED_PRESERVE src0_sel:WORD_0
v_rcp_f16_sdwa v109, v109 dst_sel:WORD_1 dst_unused:UNUSED_PRESERVE src0_sel:WORD_1
v_rcp_f16_sdwa v111, v111 dst_sel:WORD_1 dst_unused:UNUSED_PRESERVE src0_sel:WORD_1
v_mfma_f32_32x32x16_bf16 v[144:159], v[32:35], v[184:187], v[144:159]
ds_read_b128 v[180:183], v250 offset:29696
v_pk_mul_f16 v108, v108, v109
v_pk_mul_f16 v110, v110, v111
v_fma_mix_f32 v227, v108, v108, v227 op_sel_hi:[1,1,0]
v_fma_mix_f32 v227, v110, v110, v227 op_sel_hi:[1,1,0]
s_waitcnt lgkmcnt(7)
v_mfma_f32_32x32x16_bf16 v[128:143], v[12:15], v[188:191], v[128:143]
v_fma_mix_f32 v227, v108, v108, v227 op_sel:[1,1,0] op_sel_hi:[1,1,0]
v_fma_mix_f32 v227, v110, v110, v227 op_sel:[1,1,0] op_sel_hi:[1,1,0]
v_fma_mix_f32 v227, v96, v96, v227 op_sel_hi:[1,1,0]
v_fma_mix_f32 v227, v97, v97, v227 op_sel_hi:[1,1,0]
v_fma_mix_f32 v227, v98, v98, v227 op_sel_hi:[1,1,0]
v_fma_mix_f32 v227, v99, v99, v227 op_sel_hi:[1,1,0]
v_cvt_pkrtz_f16_f32 v113, v112, v113
v_and_b32 v113, s49, v113
v_bfe_u32 v112, v113, 2, 14
v_lshrrev_b32_e64 v113, 18, v113
ds_read_u16 v112, v112
ds_read_u16 v113, v113
v_cvt_pk_f16_f32 v122, v122, v123
v_cvt_pk_f16_f32 v124, v124, v125
v_cvt_pk_f16_f32 v126, v126, v127
v_pk_fma_f16 v123, v122, v122, s48
v_mfma_f32_32x32x16_bf16 v[144:159], v[36:39], v[188:191], v[144:159]
v_fma_mix_f32 v227, v100, v100, v227 op_sel_hi:[1,1,0]
v_fma_mix_f32 v227, v101, v101, v227 op_sel_hi:[1,1,0]
v_pk_fma_f16 v125, v124, v124, s48
ds_read_b128 v[184:187], v250 offset:30720
v_cvt_pkrtz_f16_f32 v115, v114, v115
v_and_b32_e64 v115, s49, v115
v_bfe_u32 v114, v115, 2, 14
v_lshrrev_b32_e64 v115, 18, v115
ds_read_u16 v114, v114
ds_read_u16 v115, v115
v_pk_fma_f16 v127, v126, v126, s48
v_pk_mul_f16 v123, v122, v123
v_pk_mul_f16 v125, v124, v125
v_fma_mix_f32 v227, v102, v102, v227 op_sel_hi:[1,1,0]
s_waitcnt lgkmcnt(7)
v_fma_mix_f32 v227, v103, v103, v227 op_sel_hi:[1,1,0]
v_pk_mul_f16 v127, v126, v127
v_exp_f16_sdwa v123, v123 dst_sel:WORD_0 dst_unused:UNUSED_PRESERVE src0_sel:WORD_0
v_cvt_pkrtz_f16_f32 v117, v116, v117
v_and_b32 v117, s49, v117
v_bfe_u32 v116, v117, 2, 14
v_lshrrev_b32_e64 v117, 18, v117
ds_read_u16 v116, v116
ds_read_u16 v117, v117
v_mfma_f32_32x32x16_bf16 v[128:143], v[16:19], v[176:179], v[128:143]
v_exp_f16_sdwa v125, v125 dst_sel:WORD_0 dst_unused:UNUSED_PRESERVE src0_sel:WORD_0
v_fma_mix_f32 v227, v104, v104, v227 op_sel_hi:[1,1,0]
v_fma_mix_f32 v227, v105, v105, v227 op_sel_hi:[1,1,0]
v_exp_f16_sdwa v127, v127 dst_sel:WORD_0 dst_unused:UNUSED_PRESERVE src0_sel:WORD_0
v_cvt_pkrtz_f16_f32 v119, v118, v119
v_and_b32_e64 v119, s49, v119
v_bfe_u32 v118, v119, 2, 14
v_lshrrev_b32 v119, 18, v119
ds_read_u16 v118, v118
ds_read_u16 v119, v119
v_exp_f16_sdwa v123, v123 dst_sel:WORD_1 dst_unused:UNUSED_PRESERVE src0_sel:WORD_1
v_fma_mix_f32 v227, v106, v106, v227 op_sel_hi:[1,1,0]
s_waitcnt lgkmcnt(6)
v_fma_mix_f32 v227, v107, v107, v227 op_sel_hi:[1,1,0]
v_exp_f16_sdwa v125, v125 dst_sel:WORD_1 dst_unused:UNUSED_PRESERVE src0_sel:WORD_1
v_mfma_f32_32x32x16_bf16 v[144:159], v[40:43], v[176:179], v[144:159]
v_exp_f16_sdwa v127, v127 dst_sel:WORD_1 dst_unused:UNUSED_PRESERVE src0_sel:WORD_1
ds_read_b128 v[188:191], v250 offset:31744
v_cvt_pkrtz_f16_f32 v121, v120, v121
v_and_b32_e64 v121, s49, v121
v_bfe_u32 v120, v121, 2, 14
v_lshrrev_b32_e64 v121, 18, v121
ds_read_u16 v120, v120
ds_read_u16 v121, v121
v_pk_add_f16 v123, v123, 1.0 op_sel_hi:[1,0]
v_pk_add_f16 v125, v125, 1.0 op_sel_hi:[1,0]
v_pk_add_f16 v127, v127, 1.0 op_sel_hi:[1,0]
v_rcp_f16_sdwa v123, v123 dst_sel:WORD_0 dst_unused:UNUSED_PRESERVE src0_sel:WORD_0
v_mfma_f32_32x32x16_bf16 v[128:143], v[20:23], v[180:183], v[128:143]
v_rcp_f16_sdwa v125, v125 dst_sel:WORD_0 dst_unused:UNUSED_PRESERVE src0_sel:WORD_0
v_rcp_f16_sdwa v127, v127 dst_sel:WORD_0 dst_unused:UNUSED_PRESERVE src0_sel:WORD_0
v_rcp_f16_sdwa v123, v123 dst_sel:WORD_1 dst_unused:UNUSED_PRESERVE src0_sel:WORD_1
v_rcp_f16_sdwa v125, v125 dst_sel:WORD_1 dst_unused:UNUSED_PRESERVE src0_sel:WORD_1
v_mfma_f32_32x32x16_bf16 v[144:159], v[44:47], v[180:183], v[144:159]
v_rcp_f16_sdwa v127, v127 dst_sel:WORD_1 dst_unused:UNUSED_PRESERVE src0_sel:WORD_1
ds_read_b128 v[176:179], v250 offset:32768
v_pk_mul_f16 v122, v122, v123
v_pk_mul_f16 v124, v124, v125
v_pk_mul_f16 v126, v126, v127
v_fma_mix_f32 v227, v122, v122, v227 op_sel_hi:[1,1,0]
v_fma_mix_f32 v227, v124, v124, v227 op_sel_hi:[1,1,0]
v_mfma_f32_32x32x16_bf16 v[160:175], v[0:3], v[184:187], 0
s_cmp_lg_u32 s40, 7
s_cbranch_scc1 Lnoinit
s_waitcnt vmcnt(0)
v_mov_b32 v222, 1
v_mov_b32 v223, 0
s_mov_b64 exec, 1
buffer_atomic_add v222, v223, s[36:39], 0 offen
s_mov_b64 exec, -1
s_nop 1
Lnoinit:
v_fma_mix_f32 v227, v126, v126, v227 op_sel_hi:[1,1,0]
v_fma_mix_f32 v227, v122, v122, v227 op_sel:[1,1,0] op_sel_hi:[1,1,0]
v_fma_mix_f32 v227, v124, v124, v227 op_sel:[1,1,0] op_sel_hi:[1,1,0]
v_fma_mix_f32 v227, v126, v126, v227 op_sel:[1,1,0] op_sel_hi:[1,1,0]
v_fma_mix_f32 v227, v112, v112, v227 op_sel_hi:[1,1,0]
v_fma_mix_f32 v227, v113, v113, v227 op_sel_hi:[1,1,0]
v_cvt_pkrtz_f16_f32 v129, v128, v129
v_and_b32_e64 v129, s49, v129
v_bfe_u32 v128, v129, 2, 14
v_lshrrev_b32 v129, 18, v129
ds_read_u16 v128, v128
ds_read_u16 v129, v129
v_cvt_pk_f16_f32 v140, v140, v141
s_waitcnt lgkmcnt(4)
v_fma_mix_f32 v227, v114, v114, v227 op_sel_hi:[1,1,0]
v_fma_mix_f32 v227, v115, v115, v227 op_sel_hi:[1,1,0]
v_cvt_pk_f16_f32 v142, v142, v143
v_pk_fma_f16 v141, v140, v140, s48
v_mfma_f32_32x32x16_bf16 v[96:111], v[24:27], v[184:187], 0
v_cvt_pkrtz_f16_f32 v131, v130, v131
v_and_b32_e64 v131, s49, v131
v_bfe_u32 v130, v131, 2, 14
v_lshrrev_b32_e64 v131, 18, v131
ds_read_u16 v130, v130
ds_read_u16 v131, v131
v_pk_fma_f16 v143, v142, v142, s48
ds_read_b128 v[180:183], v250 offset:33792
v_fma_mix_f32 v227, v116, v116, v227 op_sel_hi:[1,1,0]
v_fma_mix_f32 v227, v117, v117, v227 op_sel_hi:[1,1,0]
v_pk_mul_f16 v141, v140, v141
v_pk_mul_f16 v143, v142, v143
v_cvt_pkrtz_f16_f32 v133, v132, v133
v_and_b32_e64 v133, s49, v133
v_bfe_u32 v132, v133, 2, 14
v_lshrrev_b32_e64 v133, 18, v133
ds_read_u16 v132, v132
ds_read_u16 v133, v133
v_exp_f16_sdwa v141, v141 dst_sel:WORD_0 dst_unused:UNUSED_PRESERVE src0_sel:WORD_0
v_fma_mix_f32 v227, v118, v118, v227 op_sel_hi:[1,1,0]
v_fma_mix_f32 v227, v119, v119, v227 op_sel_hi:[1,1,0]
v_mfma_f32_32x32x16_bf16 v[160:175], v[4:7], v[188:191], v[160:175]
v_exp_f16_sdwa v143, v143 dst_sel:WORD_0 dst_unused:UNUSED_PRESERVE src0_sel:WORD_0
v_cvt_pkrtz_f16_f32 v135, v134, v135
v_and_b32_e64 v135, s49, v135
v_bfe_u32 v134, v135, 2, 14
v_lshrrev_b32_e64 v135, 18, v135
ds_read_u16 v134, v134
ds_read_u16 v135, v135
v_exp_f16_sdwa v141, v141 dst_sel:WORD_1 dst_unused:UNUSED_PRESERVE src0_sel:WORD_1
v_fma_mix_f32 v227, v120, v120, v227 op_sel_hi:[1,1,0]
s_waitcnt lgkmcnt(7)
v_fma_mix_f32 v227, v121, v121, v227 op_sel_hi:[1,1,0]
v_cvt_pkrtz_f16_f32 v137, v136, v137
v_and_b32 v137, s49, v137
v_bfe_u32 v136, v137, 2, 14
v_lshrrev_b32_e64 v137, 18, v137
ds_read_u16 v136, v136
ds_read_u16 v137, v137
v_exp_f16_sdwa v143, v143 dst_sel:WORD_1 dst_unused:UNUSED_PRESERVE src0_sel:WORD_1
v_mfma_f32_32x32x16_bf16 v[96:111], v[28:31], v[188:191], v[96:111]
ds_read_b128 v[184:187], v250 offset:34816
v_cvt_pkrtz_f16_f32 v139, v138, v139
v_and_b32_e64 v139, s49, v139
v_bfe_u32 v138, v139, 2, 14
v_lshrrev_b32_e64 v139, 18, v139
ds_read_u16 v138, v138
ds_read_u16 v139, v139
v_pk_add_f16 v141, v141, 1.0 op_sel_hi:[1,0]
v_pk_add_f16 v143, v143, 1.0 op_sel_hi:[1,0]
v_rcp_f16_sdwa v141, v141 dst_sel:WORD_0 dst_unused:UNUSED_PRESERVE src0_sel:WORD_0
v_mfma_f32_32x32x16_bf16 v[160:175], v[8:11], v[176:179], v[160:175]
v_rcp_f16_sdwa v143, v143 dst_sel:WORD_0 dst_unused:UNUSED_PRESERVE src0_sel:WORD_0
v_rcp_f16_sdwa v141, v141 dst_sel:WORD_1 dst_unused:UNUSED_PRESERVE src0_sel:WORD_1
v_rcp_f16_sdwa v143, v143 dst_sel:WORD_1 dst_unused:UNUSED_PRESERVE src0_sel:WORD_1
v_mfma_f32_32x32x16_bf16 v[96:111], v[32:35], v[176:179], v[96:111]
ds_read_b128 v[188:191], v250 offset:35840
v_pk_mul_f16 v140, v140, v141
v_pk_mul_f16 v142, v142, v143
v_fma_mix_f32 v228, v140, v140, v228 op_sel_hi:[1,1,0]
v_fma_mix_f32 v228, v142, v142, v228 op_sel_hi:[1,1,0]
s_waitcnt lgkmcnt(7)
v_mfma_f32_32x32x16_bf16 v[160:175], v[12:15], v[180:183], v[160:175]
s_add_u32 s66, s66, 786432
s_sub_u32 s81, s81, 13184
v_bfe_u32 v223, v250, 4, 6
v_and_b32 v222, 15, v223
v_lshlrev_b32_e64 v222, 7, v222
v_lshrrev_b32 v223, 4, v223
v_mul_u32_u24 v223, 98304, v223
s_sub_u32 s43, s67, -8000
s_mul_i32 s44, s41, 192
s_add_u32 s43, s43, s44
v_add3_u32 v222, v222, v223, s43
s_mov_b32 m0, 163840
s_add_u32 s44, s66, 393216
buffer_load_dword v222, s[4:7], s66 offen lds
buffer_load_dword v222, s[4:7], s44 offen lds
v_fma_mix_f32 v228, v140, v140, v228 op_sel:[1,1,0] op_sel_hi:[1,1,0]
v_fma_mix_f32 v228, v142, v142, v228 op_sel:[1,1,0] op_sel_hi:[1,1,0]
v_fma_mix_f32 v228, v128, v128, v228 op_sel_hi:[1,1,0]
v_fma_mix_f32 v228, v129, v129, v228 op_sel_hi:[1,1,0]
v_fma_mix_f32 v228, v130, v130, v228 op_sel_hi:[1,1,0]
v_fma_mix_f32 v228, v131, v131, v228 op_sel_hi:[1,1,0]
v_cvt_pkrtz_f16_f32 v145, v144, v145
v_and_b32_e64 v145, s49, v145
v_bfe_u32 v144, v145, 2, 14
v_lshrrev_b32_e64 v145, 18, v145
ds_read_u16 v144, v144
ds_read_u16 v145, v145
v_cvt_pk_f16_f32 v154, v154, v155
v_cvt_pk_f16_f32 v156, v156, v157
v_cvt_pk_f16_f32 v158, v158, v159
v_pk_fma_f16 v155, v154, v154, s48
v_mfma_f32_32x32x16_bf16 v[96:111], v[36:39], v[180:183], v[96:111]
v_fma_mix_f32 v228, v132, v132, v228 op_sel_hi:[1,1,0]
v_fma_mix_f32 v228, v133, v133, v228 op_sel_hi:[1,1,0]
v_pk_fma_f16 v157, v156, v156, s48
ds_read_b128 v[176:179], v250 offset:36864
v_cvt_pkrtz_f16_f32 v147, v146, v147
v_and_b32_e64 v147, s49, v147
v_bfe_u32 v146, v147, 2, 14
v_lshrrev_b32_e64 v147, 18, v147
ds_read_u16 v146, v146
ds_read_u16 v147, v147
v_pk_fma_f16 v159, v158, v158, s48
v_pk_mul_f16 v155, v154, v155
v_pk_mul_f16 v157, v156, v157
v_fma_mix_f32 v228, v134, v134, v228 op_sel_hi:[1,1,0]
s_waitcnt lgkmcnt(6)
v_fma_mix_f32 v228, v135, v135, v228 op_sel_hi:[1,1,0]
v_pk_mul_f16 v159, v158, v159
v_exp_f16_sdwa v155, v155 dst_sel:WORD_0 dst_unused:UNUSED_PRESERVE src0_sel:WORD_0
v_cvt_pkrtz_f16_f32 v149, v148, v149
v_and_b32 v149, s49, v149
v_bfe_u32 v148, v149, 2, 14
v_lshrrev_b32_e64 v149, 18, v149
ds_read_u16 v148, v148
ds_read_u16 v149, v149
v_mfma_f32_32x32x16_bf16 v[160:175], v[16:19], v[184:187], v[160:175]
v_exp_f16_sdwa v157, v157 dst_sel:WORD_0 dst_unused:UNUSED_PRESERVE src0_sel:WORD_0
v_fma_mix_f32 v228, v136, v136, v228 op_sel_hi:[1,1,0]
v_fma_mix_f32 v228, v137, v137, v228 op_sel_hi:[1,1,0]
v_exp_f16_sdwa v159, v159 dst_sel:WORD_0 dst_unused:UNUSED_PRESERVE src0_sel:WORD_0
v_cvt_pkrtz_f16_f32 v151, v150, v151
v_and_b32_e64 v151, s49, v151
v_bfe_u32 v150, v151, 2, 14
v_lshrrev_b32_e64 v151, 18, v151
ds_read_u16 v150, v150
ds_read_u16 v151, v151
v_exp_f16_sdwa v155, v155 dst_sel:WORD_1 dst_unused:UNUSED_PRESERVE src0_sel:WORD_1
v_fma_mix_f32 v228, v138, v138, v228 op_sel_hi:[1,1,0]
v_fma_mix_f32 v228, v139, v139, v228 op_sel_hi:[1,1,0]
v_exp_f16_sdwa v157, v157 dst_sel:WORD_1 dst_unused:UNUSED_PRESERVE src0_sel:WORD_1
v_mfma_f32_32x32x16_bf16 v[96:111], v[40:43], v[184:187], v[96:111]
v_exp_f16_sdwa v159, v159 dst_sel:WORD_1 dst_unused:UNUSED_PRESERVE src0_sel:WORD_1
ds_read_b128 v[180:183], v250 offset:37888
v_cvt_pkrtz_f16_f32 v153, v152, v153
v_and_b32_e64 v153, s49, v153
v_bfe_u32 v152, v153, 2, 14
v_lshrrev_b32 v153, 18, v153
ds_read_u16 v152, v152
ds_read_u16 v153, v153
v_pk_add_f16 v155, v155, 1.0 op_sel_hi:[1,0]
v_pk_add_f16 v157, v157, 1.0 op_sel_hi:[1,0]
v_pk_add_f16 v159, v159, 1.0 op_sel_hi:[1,0]
v_rcp_f16_sdwa v155, v155 dst_sel:WORD_0 dst_unused:UNUSED_PRESERVE src0_sel:WORD_0
s_waitcnt lgkmcnt(6)
v_mfma_f32_32x32x16_bf16 v[160:175], v[20:23], v[188:191], v[160:175]
v_rcp_f16_sdwa v157, v157 dst_sel:WORD_0 dst_unused:UNUSED_PRESERVE src0_sel:WORD_0
v_rcp_f16_sdwa v159, v159 dst_sel:WORD_0 dst_unused:UNUSED_PRESERVE src0_sel:WORD_0
v_rcp_f16_sdwa v155, v155 dst_sel:WORD_1 dst_unused:UNUSED_PRESERVE src0_sel:WORD_1
v_rcp_f16_sdwa v157, v157 dst_sel:WORD_1 dst_unused:UNUSED_PRESERVE src0_sel:WORD_1
v_mfma_f32_32x32x16_bf16 v[96:111], v[44:47], v[188:191], v[96:111]
v_rcp_f16_sdwa v159, v159 dst_sel:WORD_1 dst_unused:UNUSED_PRESERVE src0_sel:WORD_1
ds_read_b128 v[184:187], v250 offset:38912
v_pk_mul_f16 v154, v154, v155
v_pk_mul_f16 v156, v156, v157
v_pk_mul_f16 v158, v158, v159
v_fma_mix_f32 v228, v154, v154, v228 op_sel_hi:[1,1,0]
v_fma_mix_f32 v228, v156, v156, v228 op_sel_hi:[1,1,0]
v_mfma_f32_32x32x16_bf16 v[112:127], v[0:3], v[176:179], 0
s_getpc_b64 s[74:75]
Lcq2:
s_lshl_b32 s43, s40, 10
s_add_u32 s43, s43, 6144
s_min_u32 s43, s43, Lend-Lcq2-1024
s_add_u32 s74, s74, s43
s_addc_u32 s75, s75, 0
s_sub_u32 s74, s74, 16384
s_subb_u32 s75, s75, 0
s_mov_b32 m0, 163840
s_nop 0
global_load_lds_dword v250, s[74:75]
v_fma_mix_f32 v228, v158, v158, v228 op_sel_hi:[1,1,0]
v_fma_mix_f32 v228, v154, v154, v228 op_sel:[1,1,0] op_sel_hi:[1,1,0]
v_fma_mix_f32 v228, v156, v156, v228 op_sel:[1,1,0] op_sel_hi:[1,1,0]
v_fma_mix_f32 v228, v158, v158, v228 op_sel:[1,1,0] op_sel_hi:[1,1,0]
v_fma_mix_f32 v228, v144, v144, v228 op_sel_hi:[1,1,0]
v_fma_mix_f32 v228, v145, v145, v228 op_sel_hi:[1,1,0]
v_cvt_pkrtz_f16_f32 v161, v160, v161
v_and_b32_e64 v161, s49, v161
v_bfe_u32 v160, v161, 2, 14
v_lshrrev_b32_e64 v161, 18, v161
ds_read_u16 v160, v160
ds_read_u16 v161, v161
v_cvt_pk_f16_f32 v172, v172, v173
v_fma_mix_f32 v228, v146, v146, v228 op_sel_hi:[1,1,0]
v_fma_mix_f32 v228, v147, v147, v228 op_sel_hi:[1,1,0]
v_cvt_pk_f16_f32 v174, v174, v175
v_pk_fma_f16 v173, v172, v172, s48
v_mfma_f32_32x32x16_bf16 v[128:143], v[24:27], v[176:179], 0
v_cvt_pkrtz_f16_f32 v163, v162, v163
v_and_b32_e64 v163, s49, v163
v_bfe_u32 v162, v163, 2, 14
v_lshrrev_b32_e64 v163, 18, v163
ds_read_u16 v162, v162
ds_read_u16 v163, v163
ds_read_b128 v[188:191], v250 offset:39936
v_pk_fma_f16 v175, v174, v174, s48
v_fma_mix_f32 v228, v148, v148, v228 op_sel_hi:[1,1,0]
s_waitcnt lgkmcnt(5)
v_fma_mix_f32 v228, v149, v149, v228 op_sel_hi:[1,1,0]
v_pk_mul_f16 v173, v172, v173
v_pk_mul_f16 v175, v174, v175
v_cvt_pkrtz_f16_f32 v165, v164, v165
v_and_b32 v165, s49, v165
v_bfe_u32 v164, v165, 2, 14
v_lshrrev_b32_e64 v165, 18, v165
ds_read_u16 v164, v164
ds_read_u16 v165, v165
v_exp_f16_sdwa v173, v173 dst_sel:WORD_0 dst_unused:UNUSED_PRESERVE src0_sel:WORD_0
v_fma_mix_f32 v228, v150, v150, v228 op_sel_hi:[1,1,0]
v_fma_mix_f32 v228, v151, v151, v228 op_sel_hi:[1,1,0]
v_mfma_f32_32x32x16_bf16 v[112:127], v[4:7], v[180:183], v[112:127]
v_exp_f16_sdwa v175, v175 dst_sel:WORD_0 dst_unused:UNUSED_PRESERVE src0_sel:WORD_0
v_cvt_pkrtz_f16_f32 v167, v166, v167
v_and_b32_e64 v167, s49, v167
v_bfe_u32 v166, v167, 2, 14
v_lshrrev_b32_e64 v167, 18, v167
ds_read_u16 v166, v166
ds_read_u16 v167, v167
v_exp_f16_sdwa v173, v173 dst_sel:WORD_1 dst_unused:UNUSED_PRESERVE src0_sel:WORD_1
v_fma_mix_f32 v228, v152, v152, v228 op_sel_hi:[1,1,0]
v_fma_mix_f32 v228, v153, v153, v228 op_sel_hi:[1,1,0]
v_cvt_pkrtz_f16_f32 v169, v168, v169
v_and_b32_e64 v169, s49, v169
v_bfe_u32 v168, v169, 2, 14
v_lshrrev_b32_e64 v169, 18, v169
ds_read_u16 v168, v168
ds_read_u16 v169, v169
v_exp_f16_sdwa v175, v175 dst_sel:WORD_1 dst_unused:UNUSED_PRESERVE src0_sel:WORD_1
v_mfma_f32_32x32x16_bf16 v[128:143], v[28:31], v[180:183], v[128:143]
ds_read_b128 v[176:179], v250 offset:40960
v_cvt_pkrtz_f16_f32 v171, v170, v171
v_and_b32_e64 v171, s49, v171
v_bfe_u32 v170, v171, 2, 14
v_lshrrev_b32_e64 v171, 18, v171
ds_read_u16 v170, v170
ds_read_u16 v171, v171
v_pk_add_f16 v173, v173, 1.0 op_sel_hi:[1,0]
v_pk_add_f16 v175, v175, 1.0 op_sel_hi:[1,0]
v_rcp_f16_sdwa v173, v173 dst_sel:WORD_0 dst_unused:UNUSED_PRESERVE src0_sel:WORD_0
v_mfma_f32_32x32x16_bf16 v[112:127], v[8:11], v[184:187], v[112:127]
v_rcp_f16_sdwa v175, v175 dst_sel:WORD_0 dst_unused:UNUSED_PRESERVE src0_sel:WORD_0
v_rcp_f16_sdwa v173, v173 dst_sel:WORD_1 dst_unused:UNUSED_PRESERVE src0_sel:WORD_1
v_rcp_f16_sdwa v175, v175 dst_sel:WORD_1 dst_unused:UNUSED_PRESERVE src0_sel:WORD_1
v_mfma_f32_32x32x16_bf16 v[128:143], v[32:35], v[184:187], v[128:143]
ds_read_b128 v[180:183], v250 offset:41984
v_pk_mul_f16 v172, v172, v173
v_pk_mul_f16 v174, v174, v175
v_fma_mix_f32 v229, v172, v172, v229 op_sel_hi:[1,1,0]
v_fma_mix_f32 v229, v174, v174, v229 op_sel_hi:[1,1,0]
s_waitcnt lgkmcnt(7)
v_mfma_f32_32x32x16_bf16 v[112:127], v[12:15], v[188:191], v[112:127]
v_fma_mix_f32 v229, v172, v172, v229 op_sel:[1,1,0] op_sel_hi:[1,1,0]
v_fma_mix_f32 v229, v174, v174, v229 op_sel:[1,1,0] op_sel_hi:[1,1,0]
v_fma_mix_f32 v229, v160, v160, v229 op_sel_hi:[1,1,0]
v_fma_mix_f32 v229, v161, v161, v229 op_sel_hi:[1,1,0]
v_fma_mix_f32 v229, v162, v162, v229 op_sel_hi:[1,1,0]
v_fma_mix_f32 v229, v163, v163, v229 op_sel_hi:[1,1,0]
v_cvt_pkrtz_f16_f32 v97, v96, v97
v_and_b32 v97, s49, v97
v_bfe_u32 v96, v97, 2, 14
v_lshrrev_b32_e64 v97, 18, v97
ds_read_u16 v96, v96
ds_read_u16 v97, v97
v_cvt_pk_f16_f32 v106, v106, v107
v_cvt_pk_f16_f32 v108, v108, v109
v_cvt_pk_f16_f32 v110, v110, v111
v_pk_fma_f16 v107, v106, v106, s48
v_mfma_f32_32x32x16_bf16 v[128:143], v[36:39], v[188:191], v[128:143]
v_fma_mix_f32 v229, v164, v164, v229 op_sel_hi:[1,1,0]
v_fma_mix_f32 v229, v165, v165, v229 op_sel_hi:[1,1,0]
v_pk_fma_f16 v109, v108, v108, s48
ds_read_b128 v[184:187], v250 offset:43008
v_cvt_pkrtz_f16_f32 v99, v98, v99
v_and_b32_e64 v99, s49, v99
v_bfe_u32 v98, v99, 2, 14
v_lshrrev_b32_e64 v99, 18, v99
ds_read_u16 v98, v98
ds_read_u16 v99, v99
v_pk_fma_f16 v111, v110, v110, s48
v_pk_mul_f16 v107, v106, v107
v_pk_mul_f16 v109, v108, v109
v_fma_mix_f32 v229, v166, v166, v229 op_sel_hi:[1,1,0]
s_waitcnt lgkmcnt(7)
v_fma_mix_f32 v229, v167, v167, v229 op_sel_hi:[1,1,0]
v_pk_mul_f16 v111, v110, v111
v_exp_f16_sdwa v107, v107 dst_sel:WORD_0 dst_unused:UNUSED_PRESERVE src0_sel:WORD_0
v_cvt_pkrtz_f16_f32 v101, v100, v101
v_and_b32 v101, s49, v101
v_bfe_u32 v100, v101, 2, 14
v_lshrrev_b32_e64 v101, 18, v101
ds_read_u16 v100, v100
ds_read_u16 v101, v101
v_mfma_f32_32x32x16_bf16 v[112:127], v[16:19], v[176:179], v[112:127]
v_exp_f16_sdwa v109, v109 dst_sel:WORD_0 dst_unused:UNUSED_PRESERVE src0_sel:WORD_0
v_fma_mix_f32 v229, v168, v168, v229 op_sel_hi:[1,1,0]
v_fma_mix_f32 v229, v169, v169, v229 op_sel_hi:[1,1,0]
v_exp_f16_sdwa v111, v111 dst_sel:WORD_0 dst_unused:UNUSED_PRESERVE src0_sel:WORD_0
v_cvt_pkrtz_f16_f32 v103, v102, v103
v_and_b32_e64 v103, s49, v103
v_bfe_u32 v102, v103, 2, 14
v_lshrrev_b32 v103, 18, v103
ds_read_u16 v102, v102
ds_read_u16 v103, v103
v_exp_f16_sdwa v107, v107 dst_sel:WORD_1 dst_unused:UNUSED_PRESERVE src0_sel:WORD_1
v_fma_mix_f32 v229, v170, v170, v229 op_sel_hi:[1,1,0]
s_waitcnt lgkmcnt(6)
v_fma_mix_f32 v229, v171, v171, v229 op_sel_hi:[1,1,0]
v_exp_f16_sdwa v109, v109 dst_sel:WORD_1 dst_unused:UNUSED_PRESERVE src0_sel:WORD_1
v_mfma_f32_32x32x16_bf16 v[128:143], v[40:43], v[176:179], v[128:143]
v_exp_f16_sdwa v111, v111 dst_sel:WORD_1 dst_unused:UNUSED_PRESERVE src0_sel:WORD_1
ds_read_b128 v[188:191], v250 offset:44032
v_cvt_pkrtz_f16_f32 v105, v104, v105
v_and_b32_e64 v105, s49, v105
v_bfe_u32 v104, v105, 2, 14
v_lshrrev_b32_e64 v105, 18, v105
ds_read_u16 v104, v104
ds_read_u16 v105, v105
v_pk_add_f16 v107, v107, 1.0 op_sel_hi:[1,0]
v_pk_add_f16 v109, v109, 1.0 op_sel_hi:[1,0]
v_pk_add_f16 v111, v111, 1.0 op_sel_hi:[1,0]
v_rcp_f16_sdwa v107, v107 dst_sel:WORD_0 dst_unused:UNUSED_PRESERVE src0_sel:WORD_0
v_mfma_f32_32x32x16_bf16 v[112:127], v[20:23], v[180:183], v[112:127]
v_rcp_f16_sdwa v109, v109 dst_sel:WORD_0 dst_unused:UNUSED_PRESERVE src0_sel:WORD_0
v_rcp_f16_sdwa v111, v111 dst_sel:WORD_0 dst_unused:UNUSED_PRESERVE src0_sel:WORD_0
v_rcp_f16_sdwa v107, v107 dst_sel:WORD_1 dst_unused:UNUSED_PRESERVE src0_sel:WORD_1
v_rcp_f16_sdwa v109, v109 dst_sel:WORD_1 dst_unused:UNUSED_PRESERVE src0_sel:WORD_1
v_mfma_f32_32x32x16_bf16 v[128:143], v[44:47], v[180:183], v[128:143]
v_rcp_f16_sdwa v111, v111 dst_sel:WORD_1 dst_unused:UNUSED_PRESERVE src0_sel:WORD_1
ds_read_b128 v[176:179], v250 offset:45056
v_pk_mul_f16 v106, v106, v107
v_pk_mul_f16 v108, v108, v109
v_pk_mul_f16 v110, v110, v111
v_fma_mix_f32 v229, v106, v106, v229 op_sel_hi:[1,1,0]
v_fma_mix_f32 v229, v108, v108, v229 op_sel_hi:[1,1,0]
v_mfma_f32_32x32x16_bf16 v[144:159], v[0:3], v[184:187], 0
v_fma_mix_f32 v229, v110, v110, v229 op_sel_hi:[1,1,0]
v_fma_mix_f32 v229, v106, v106, v229 op_sel:[1,1,0] op_sel_hi:[1,1,0]
v_fma_mix_f32 v229, v108, v108, v229 op_sel:[1,1,0] op_sel_hi:[1,1,0]
v_fma_mix_f32 v229, v110, v110, v229 op_sel:[1,1,0] op_sel_hi:[1,1,0]
v_fma_mix_f32 v229, v96, v96, v229 op_sel_hi:[1,1,0]
v_fma_mix_f32 v229, v97, v97, v229 op_sel_hi:[1,1,0]
v_cvt_pkrtz_f16_f32 v113, v112, v113
v_and_b32_e64 v113, s49, v113
v_bfe_u32 v112, v113, 2, 14
v_lshrrev_b32 v113, 18, v113
ds_read_u16 v112, v112
ds_read_u16 v113, v113
v_cvt_pk_f16_f32 v124, v124, v125
s_waitcnt lgkmcnt(4)
v_fma_mix_f32 v229, v98, v98, v229 op_sel_hi:[1,1,0]
v_fma_mix_f32 v229, v99, v99, v229 op_sel_hi:[1,1,0]
v_cvt_pk_f16_f32 v126, v126, v127
v_pk_fma_f16 v125, v124, v124, s48
v_mfma_f32_32x32x16_bf16 v[160:175], v[24:27], v[184:187], 0
v_cvt_pkrtz_f16_f32 v115, v114, v115
v_and_b32_e64 v115, s49, v115
v_bfe_u32 v114, v115, 2, 14
v_lshrrev_b32_e64 v115, 18, v115
ds_read_u16 v114, v114
ds_read_u16 v115, v115
ds_read_b128 v[180:183], v250 offset:46080
v_pk_fma_f16 v127, v126, v126, s48
v_fma_mix_f32 v229, v100, v100, v229 op_sel_hi:[1,1,0]
v_fma_mix_f32 v229, v101, v101, v229 op_sel_hi:[1,1,0]
v_pk_mul_f16 v125, v124, v125
v_pk_mul_f16 v127, v126, v127
v_cvt_pkrtz_f16_f32 v117, v116, v117
v_and_b32_e64 v117, s49, v117
v_bfe_u32 v116, v117, 2, 14
v_lshrrev_b32_e64 v117, 18, v117
ds_read_u16 v116, v116
ds_read_u16 v117, v117
v_exp_f16_sdwa v125, v125 dst_sel:WORD_0 dst_unused:UNUSED_PRESERVE src0_sel:WORD_0
v_fma_mix_f32 v229, v102, v102, v229 op_sel_hi:[1,1,0]
v_fma_mix_f32 v229, v103, v103, v229 op_sel_hi:[1,1,0]
v_mfma_f32_32x32x16_bf16 v[144:159], v[4:7], v[188:191], v[144:159]
v_exp_f16_sdwa v127, v127 dst_sel:WORD_0 dst_unused:UNUSED_PRESERVE src0_sel:WORD_0
v_cvt_pkrtz_f16_f32 v119, v118, v119
v_and_b32_e64 v119, s49, v119
v_bfe_u32 v118, v119, 2, 14
v_lshrrev_b32_e64 v119, 18, v119
ds_read_u16 v118, v118
ds_read_u16 v119, v119
v_exp_f16_sdwa v125, v125 dst_sel:WORD_1 dst_unused:UNUSED_PRESERVE src0_sel:WORD_1
v_fma_mix_f32 v229, v104, v104, v229 op_sel_hi:[1,1,0]
s_waitcnt lgkmcnt(7)
v_fma_mix_f32 v229, v105, v105, v229 op_sel_hi:[1,1,0]
v_cvt_pkrtz_f16_f32 v121, v120, v121
v_and_b32 v121, s49, v121
v_bfe_u32 v120, v121, 2, 14
v_lshrrev_b32_e64 v121, 18, v121
ds_read_u16 v120, v120
ds_read_u16 v121, v121
v_exp_f16_sdwa v127, v127 dst_sel:WORD_1 dst_unused:UNUSED_PRESERVE src0_sel:WORD_1
v_mfma_f32_32x32x16_bf16 v[160:175], v[28:31], v[188:191], v[160:175]
ds_read_b128 v[184:187], v250 offset:47104
v_cvt_pkrtz_f16_f32 v123, v122, v123
v_and_b32_e64 v123, s49, v123
v_bfe_u32 v122, v123, 2, 14
v_lshrrev_b32_e64 v123, 18, v123
ds_read_u16 v122, v122
ds_read_u16 v123, v123
v_pk_add_f16 v125, v125, 1.0 op_sel_hi:[1,0]
v_pk_add_f16 v127, v127, 1.0 op_sel_hi:[1,0]
v_rcp_f16_sdwa v125, v125 dst_sel:WORD_0 dst_unused:UNUSED_PRESERVE src0_sel:WORD_0
v_mfma_f32_32x32x16_bf16 v[144:159], v[8:11], v[176:179], v[144:159]
v_rcp_f16_sdwa v127, v127 dst_sel:WORD_0 dst_unused:UNUSED_PRESERVE src0_sel:WORD_0
v_rcp_f16_sdwa v125, v125 dst_sel:WORD_1 dst_unused:UNUSED_PRESERVE src0_sel:WORD_1
v_rcp_f16_sdwa v127, v127 dst_sel:WORD_1 dst_unused:UNUSED_PRESERVE src0_sel:WORD_1
v_mfma_f32_32x32x16_bf16 v[160:175], v[32:35], v[176:179], v[160:175]
ds_read_b128 v[188:191], v250 offset:48128
v_pk_mul_f16 v124, v124, v125
v_pk_mul_f16 v126, v126, v127
v_fma_mix_f32 v230, v124, v124, v230 op_sel_hi:[1,1,0]
v_fma_mix_f32 v230, v126, v126, v230 op_sel_hi:[1,1,0]
s_waitcnt lgkmcnt(7)
v_mfma_f32_32x32x16_bf16 v[144:159], v[12:15], v[180:183], v[144:159]
v_fma_mix_f32 v230, v124, v124, v230 op_sel:[1,1,0] op_sel_hi:[1,1,0]
v_fma_mix_f32 v230, v126, v126, v230 op_sel:[1,1,0] op_sel_hi:[1,1,0]
v_fma_mix_f32 v230, v112, v112, v230 op_sel_hi:[1,1,0]
v_fma_mix_f32 v230, v113, v113, v230 op_sel_hi:[1,1,0]
v_fma_mix_f32 v230, v114, v114, v230 op_sel_hi:[1,1,0]
v_fma_mix_f32 v230, v115, v115, v230 op_sel_hi:[1,1,0]
v_cvt_pkrtz_f16_f32 v129, v128, v129
v_and_b32 v129, s49, v129
v_bfe_u32 v128, v129, 2, 14
v_lshrrev_b32_e64 v129, 18, v129
ds_read_u16 v128, v128
ds_read_u16 v129, v129
v_cvt_pk_f16_f32 v138, v138, v139
v_cvt_pk_f16_f32 v140, v140, v141
v_cvt_pk_f16_f32 v142, v142, v143
v_pk_fma_f16 v139, v138, v138, s48
v_mfma_f32_32x32x16_bf16 v[160:175], v[36:39], v[180:183], v[160:175]
v_fma_mix_f32 v230, v116, v116, v230 op_sel_hi:[1,1,0]
v_fma_mix_f32 v230, v117, v117, v230 op_sel_hi:[1,1,0]
v_pk_fma_f16 v141, v140, v140, s48
ds_read_b128 v[176:179], v250 offset:49152
v_cvt_pkrtz_f16_f32 v131, v130, v131
v_and_b32_e64 v131, s49, v131
v_bfe_u32 v130, v131, 2, 14
v_lshrrev_b32_e64 v131, 18, v131
ds_read_u16 v130, v130
ds_read_u16 v131, v131
v_pk_fma_f16 v143, v142, v142, s48
v_pk_mul_f16 v139, v138, v139
v_pk_mul_f16 v141, v140, v141
v_fma_mix_f32 v230, v118, v118, v230 op_sel_hi:[1,1,0]
s_waitcnt lgkmcnt(7)
v_fma_mix_f32 v230, v119, v119, v230 op_sel_hi:[1,1,0]
v_pk_mul_f16 v143, v142, v143
v_exp_f16_sdwa v139, v139 dst_sel:WORD_0 dst_unused:UNUSED_PRESERVE src0_sel:WORD_0
v_cvt_pkrtz_f16_f32 v133, v132, v133
v_and_b32 v133, s49, v133
v_bfe_u32 v132, v133, 2, 14
v_lshrrev_b32_e64 v133, 18, v133
ds_read_u16 v132, v132
ds_read_u16 v133, v133
v_mfma_f32_32x32x16_bf16 v[144:159], v[16:19], v[184:187], v[144:159]
v_exp_f16_sdwa v141, v141 dst_sel:WORD_0 dst_unused:UNUSED_PRESERVE src0_sel:WORD_0
v_fma_mix_f32 v230, v120, v120, v230 op_sel_hi:[1,1,0]
v_fma_mix_f32 v230, v121, v121, v230 op_sel_hi:[1,1,0]
v_exp_f16_sdwa v143, v143 dst_sel:WORD_0 dst_unused:UNUSED_PRESERVE src0_sel:WORD_0
v_cvt_pkrtz_f16_f32 v135, v134, v135
v_and_b32_e64 v135, s49, v135
v_bfe_u32 v134, v135, 2, 14
v_lshrrev_b32 v135, 18, v135
ds_read_u16 v134, v134
ds_read_u16 v135, v135
v_exp_f16_sdwa v139, v139 dst_sel:WORD_1 dst_unused:UNUSED_PRESERVE src0_sel:WORD_1
v_fma_mix_f32 v230, v122, v122, v230 op_sel_hi:[1,1,0]
s_waitcnt lgkmcnt(6)
v_fma_mix_f32 v230, v123, v123, v230 op_sel_hi:[1,1,0]
v_exp_f16_sdwa v141, v141 dst_sel:WORD_1 dst_unused:UNUSED_PRESERVE src0_sel:WORD_1
v_mfma_f32_32x32x16_bf16 v[160:175], v[40:43], v[184:187], v[160:175]
v_exp_f16_sdwa v143, v143 dst_sel:WORD_1 dst_unused:UNUSED_PRESERVE src0_sel:WORD_1
ds_read_b128 v[180:183], v250 offset:50176
v_cvt_pkrtz_f16_f32 v137, v136, v137
v_and_b32_e64 v137, s49, v137
v_bfe_u32 v136, v137, 2, 14
v_lshrrev_b32_e64 v137, 18, v137
ds_read_u16 v136, v136
ds_read_u16 v137, v137
v_pk_add_f16 v139, v139, 1.0 op_sel_hi:[1,0]
v_pk_add_f16 v141, v141, 1.0 op_sel_hi:[1,0]
v_pk_add_f16 v143, v143, 1.0 op_sel_hi:[1,0]
v_rcp_f16_sdwa v139, v139 dst_sel:WORD_0 dst_unused:UNUSED_PRESERVE src0_sel:WORD_0
v_mfma_f32_32x32x16_bf16 v[144:159], v[20:23], v[188:191], v[144:159]
v_rcp_f16_sdwa v141, v141 dst_sel:WORD_0 dst_unused:UNUSED_PRESERVE src0_sel:WORD_0
v_rcp_f16_sdwa v143, v143 dst_sel:WORD_0 dst_unused:UNUSED_PRESERVE src0_sel:WORD_0
v_rcp_f16_sdwa v139, v139 dst_sel:WORD_1 dst_unused:UNUSED_PRESERVE src0_sel:WORD_1
v_rcp_f16_sdwa v141, v141 dst_sel:WORD_1 dst_unused:UNUSED_PRESERVE src0_sel:WORD_1
v_mfma_f32_32x32x16_bf16 v[160:175], v[44:47], v[188:191], v[160:175]
v_rcp_f16_sdwa v143, v143 dst_sel:WORD_1 dst_unused:UNUSED_PRESERVE src0_sel:WORD_1
ds_read_b128 v[184:187], v250 offset:51200
v_pk_mul_f16 v138, v138, v139
v_pk_mul_f16 v140, v140, v141
v_pk_mul_f16 v142, v142, v143
v_fma_mix_f32 v230, v138, v138, v230 op_sel_hi:[1,1,0]
v_fma_mix_f32 v230, v140, v140, v230 op_sel_hi:[1,1,0]
v_mfma_f32_32x32x16_bf16 v[96:111], v[0:3], v[176:179], 0
v_fma_mix_f32 v230, v142, v142, v230 op_sel_hi:[1,1,0]
v_fma_mix_f32 v230, v138, v138, v230 op_sel:[1,1,0] op_sel_hi:[1,1,0]
v_fma_mix_f32 v230, v140, v140, v230 op_sel:[1,1,0] op_sel_hi:[1,1,0]
v_fma_mix_f32 v230, v142, v142, v230 op_sel:[1,1,0] op_sel_hi:[1,1,0]
v_fma_mix_f32 v230, v128, v128, v230 op_sel_hi:[1,1,0]
v_fma_mix_f32 v230, v129, v129, v230 op_sel_hi:[1,1,0]
v_cvt_pkrtz_f16_f32 v145, v144, v145
v_and_b32_e64 v145, s49, v145
v_bfe_u32 v144, v145, 2, 14
v_lshrrev_b32 v145, 18, v145
ds_read_u16 v144, v144
ds_read_u16 v145, v145
v_cvt_pk_f16_f32 v156, v156, v157
s_waitcnt lgkmcnt(4)
v_fma_mix_f32 v230, v130, v130, v230 op_sel_hi:[1,1,0]
v_fma_mix_f32 v230, v131, v131, v230 op_sel_hi:[1,1,0]
v_cvt_pk_f16_f32 v158, v158, v159
v_pk_fma_f16 v157, v156, v156, s48
v_mfma_f32_32x32x16_bf16 v[112:127], v[24:27], v[176:179], 0
v_cvt_pkrtz_f16_f32 v147, v146, v147
v_and_b32_e64 v147, s49, v147
v_bfe_u32 v146, v147, 2, 14
v_lshrrev_b32_e64 v147, 18, v147
ds_read_u16 v146, v146
ds_read_u16 v147, v147
ds_read_b128 v[188:191], v250 offset:52224
v_pk_fma_f16 v159, v158, v158, s48
v_fma_mix_f32 v230, v132, v132, v230 op_sel_hi:[1,1,0]
v_fma_mix_f32 v230, v133, v133, v230 op_sel_hi:[1,1,0]
v_pk_mul_f16 v157, v156, v157
v_pk_mul_f16 v159, v158, v159
v_cvt_pkrtz_f16_f32 v149, v148, v149
v_and_b32_e64 v149, s49, v149
v_bfe_u32 v148, v149, 2, 14
v_lshrrev_b32_e64 v149, 18, v149
ds_read_u16 v148, v148
ds_read_u16 v149, v149
v_exp_f16_sdwa v157, v157 dst_sel:WORD_0 dst_unused:UNUSED_PRESERVE src0_sel:WORD_0
v_fma_mix_f32 v230, v134, v134, v230 op_sel_hi:[1,1,0]
v_fma_mix_f32 v230, v135, v135, v230 op_sel_hi:[1,1,0]
v_mfma_f32_32x32x16_bf16 v[96:111], v[4:7], v[180:183], v[96:111]
v_exp_f16_sdwa v159, v159 dst_sel:WORD_0 dst_unused:UNUSED_PRESERVE src0_sel:WORD_0
v_cvt_pkrtz_f16_f32 v151, v150, v151
v_and_b32_e64 v151, s49, v151
v_bfe_u32 v150, v151, 2, 14
v_lshrrev_b32_e64 v151, 18, v151
ds_read_u16 v150, v150
ds_read_u16 v151, v151
v_exp_f16_sdwa v157, v157 dst_sel:WORD_1 dst_unused:UNUSED_PRESERVE src0_sel:WORD_1
v_fma_mix_f32 v230, v136, v136, v230 op_sel_hi:[1,1,0]
s_waitcnt lgkmcnt(7)
v_fma_mix_f32 v230, v137, v137, v230 op_sel_hi:[1,1,0]
v_cvt_pkrtz_f16_f32 v153, v152, v153
v_and_b32 v153, s49, v153
v_bfe_u32 v152, v153, 2, 14
v_lshrrev_b32_e64 v153, 18, v153
ds_read_u16 v152, v152
ds_read_u16 v153, v153
v_exp_f16_sdwa v159, v159 dst_sel:WORD_1 dst_unused:UNUSED_PRESERVE src0_sel:WORD_1
v_mfma_f32_32x32x16_bf16 v[112:127], v[28:31], v[180:183], v[112:127]
ds_read_b128 v[176:179], v250 offset:53248
v_cvt_pkrtz_f16_f32 v155, v154, v155
v_and_b32_e64 v155, s49, v155
v_bfe_u32 v154, v155, 2, 14
v_lshrrev_b32_e64 v155, 18, v155
ds_read_u16 v154, v154
ds_read_u16 v155, v155
v_pk_add_f16 v157, v157, 1.0 op_sel_hi:[1,0]
v_pk_add_f16 v159, v159, 1.0 op_sel_hi:[1,0]
v_rcp_f16_sdwa v157, v157 dst_sel:WORD_0 dst_unused:UNUSED_PRESERVE src0_sel:WORD_0
v_mfma_f32_32x32x16_bf16 v[96:111], v[8:11], v[184:187], v[96:111]
v_rcp_f16_sdwa v159, v159 dst_sel:WORD_0 dst_unused:UNUSED_PRESERVE src0_sel:WORD_0
v_rcp_f16_sdwa v157, v157 dst_sel:WORD_1 dst_unused:UNUSED_PRESERVE src0_sel:WORD_1
v_rcp_f16_sdwa v159, v159 dst_sel:WORD_1 dst_unused:UNUSED_PRESERVE src0_sel:WORD_1
v_mfma_f32_32x32x16_bf16 v[112:127], v[32:35], v[184:187], v[112:127]
ds_read_b128 v[180:183], v250 offset:54272
v_pk_mul_f16 v156, v156, v157
v_pk_mul_f16 v158, v158, v159
v_fma_mix_f32 v231, v156, v156, v231 op_sel_hi:[1,1,0]
v_fma_mix_f32 v231, v158, v158, v231 op_sel_hi:[1,1,0]
s_waitcnt lgkmcnt(7)
v_mfma_f32_32x32x16_bf16 v[96:111], v[12:15], v[188:191], v[96:111]
v_fma_mix_f32 v231, v156, v156, v231 op_sel:[1,1,0] op_sel_hi:[1,1,0]
v_fma_mix_f32 v231, v158, v158, v231 op_sel:[1,1,0] op_sel_hi:[1,1,0]
v_fma_mix_f32 v231, v144, v144, v231 op_sel_hi:[1,1,0]
v_fma_mix_f32 v231, v145, v145, v231 op_sel_hi:[1,1,0]
v_fma_mix_f32 v231, v146, v146, v231 op_sel_hi:[1,1,0]
v_fma_mix_f32 v231, v147, v147, v231 op_sel_hi:[1,1,0]
v_cvt_pkrtz_f16_f32 v161, v160, v161
v_and_b32 v161, s49, v161
v_bfe_u32 v160, v161, 2, 14
v_lshrrev_b32_e64 v161, 18, v161
ds_read_u16 v160, v160
ds_read_u16 v161, v161
v_cvt_pk_f16_f32 v170, v170, v171
v_cvt_pk_f16_f32 v172, v172, v173
v_cvt_pk_f16_f32 v174, v174, v175
v_pk_fma_f16 v171, v170, v170, s48
v_mfma_f32_32x32x16_bf16 v[112:127], v[36:39], v[188:191], v[112:127]
v_fma_mix_f32 v231, v148, v148, v231 op_sel_hi:[1,1,0]
v_fma_mix_f32 v231, v149, v149, v231 op_sel_hi:[1,1,0]
v_pk_fma_f16 v173, v172, v172, s48
ds_read_b128 v[184:187], v250 offset:55296
v_cvt_pkrtz_f16_f32 v163, v162, v163
v_and_b32_e64 v163, s49, v163
v_bfe_u32 v162, v163, 2, 14
v_lshrrev_b32_e64 v163, 18, v163
ds_read_u16 v162, v162
ds_read_u16 v163, v163
v_pk_fma_f16 v175, v174, v174, s48
v_pk_mul_f16 v171, v170, v171
v_pk_mul_f16 v173, v172, v173
v_fma_mix_f32 v231, v150, v150, v231 op_sel_hi:[1,1,0]
s_waitcnt lgkmcnt(7)
v_fma_mix_f32 v231, v151, v151, v231 op_sel_hi:[1,1,0]
v_pk_mul_f16 v175, v174, v175
v_exp_f16_sdwa v171, v171 dst_sel:WORD_0 dst_unused:UNUSED_PRESERVE src0_sel:WORD_0
v_cvt_pkrtz_f16_f32 v165, v164, v165
v_and_b32 v165, s49, v165
v_bfe_u32 v164, v165, 2, 14
v_lshrrev_b32_e64 v165, 18, v165
ds_read_u16 v164, v164
ds_read_u16 v165, v165
v_mfma_f32_32x32x16_bf16 v[96:111], v[16:19], v[176:179], v[96:111]
v_exp_f16_sdwa v173, v173 dst_sel:WORD_0 dst_unused:UNUSED_PRESERVE src0_sel:WORD_0
v_fma_mix_f32 v231, v152, v152, v231 op_sel_hi:[1,1,0]
v_fma_mix_f32 v231, v153, v153, v231 op_sel_hi:[1,1,0]
v_exp_f16_sdwa v175, v175 dst_sel:WORD_0 dst_unused:UNUSED_PRESERVE src0_sel:WORD_0
v_cvt_pkrtz_f16_f32 v167, v166, v167
v_and_b32_e64 v167, s49, v167
v_bfe_u32 v166, v167, 2, 14
v_lshrrev_b32 v167, 18, v167
ds_read_u16 v166, v166
ds_read_u16 v167, v167
v_exp_f16_sdwa v171, v171 dst_sel:WORD_1 dst_unused:UNUSED_PRESERVE src0_sel:WORD_1
v_fma_mix_f32 v231, v154, v154, v231 op_sel_hi:[1,1,0]
s_waitcnt lgkmcnt(6)
v_fma_mix_f32 v231, v155, v155, v231 op_sel_hi:[1,1,0]
v_exp_f16_sdwa v173, v173 dst_sel:WORD_1 dst_unused:UNUSED_PRESERVE src0_sel:WORD_1
v_mfma_f32_32x32x16_bf16 v[112:127], v[40:43], v[176:179], v[112:127]
v_exp_f16_sdwa v175, v175 dst_sel:WORD_1 dst_unused:UNUSED_PRESERVE src0_sel:WORD_1
ds_read_b128 v[188:191], v250 offset:56320
v_cvt_pkrtz_f16_f32 v169, v168, v169
v_and_b32_e64 v169, s49, v169
v_bfe_u32 v168, v169, 2, 14
v_lshrrev_b32_e64 v169, 18, v169
ds_read_u16 v168, v168
ds_read_u16 v169, v169
v_pk_add_f16 v171, v171, 1.0 op_sel_hi:[1,0]
v_pk_add_f16 v173, v173, 1.0 op_sel_hi:[1,0]
v_pk_add_f16 v175, v175, 1.0 op_sel_hi:[1,0]
v_rcp_f16_sdwa v171, v171 dst_sel:WORD_0 dst_unused:UNUSED_PRESERVE src0_sel:WORD_0
v_mfma_f32_32x32x16_bf16 v[96:111], v[20:23], v[180:183], v[96:111]
v_rcp_f16_sdwa v173, v173 dst_sel:WORD_0 dst_unused:UNUSED_PRESERVE src0_sel:WORD_0
v_rcp_f16_sdwa v175, v175 dst_sel:WORD_0 dst_unused:UNUSED_PRESERVE src0_sel:WORD_0
v_rcp_f16_sdwa v171, v171 dst_sel:WORD_1 dst_unused:UNUSED_PRESERVE src0_sel:WORD_1
v_rcp_f16_sdwa v173, v173 dst_sel:WORD_1 dst_unused:UNUSED_PRESERVE src0_sel:WORD_1
v_mfma_f32_32x32x16_bf16 v[112:127], v[44:47], v[180:183], v[112:127]
v_rcp_f16_sdwa v175, v175 dst_sel:WORD_1 dst_unused:UNUSED_PRESERVE src0_sel:WORD_1
ds_read_b128 v[176:179], v250 offset:57344
v_pk_mul_f16 v170, v170, v171
v_pk_mul_f16 v172, v172, v173
v_pk_mul_f16 v174, v174, v175
v_fma_mix_f32 v231, v170, v170, v231 op_sel_hi:[1,1,0]
v_fma_mix_f32 v231, v172, v172, v231 op_sel_hi:[1,1,0]
v_mfma_f32_32x32x16_bf16 v[128:143], v[0:3], v[184:187], 0
v_fma_mix_f32 v231, v174, v174, v231 op_sel_hi:[1,1,0]
v_fma_mix_f32 v231, v170, v170, v231 op_sel:[1,1,0] op_sel_hi:[1,1,0]
v_fma_mix_f32 v231, v172, v172, v231 op_sel:[1,1,0] op_sel_hi:[1,1,0]
v_fma_mix_f32 v231, v174, v174, v231 op_sel:[1,1,0] op_sel_hi:[1,1,0]
v_fma_mix_f32 v231, v160, v160, v231 op_sel_hi:[1,1,0]
v_fma_mix_f32 v231, v161, v161, v231 op_sel_hi:[1,1,0]
v_cvt_pkrtz_f16_f32 v97, v96, v97
v_and_b32_e64 v97, s49, v97
v_bfe_u32 v96, v97, 2, 14
v_lshrrev_b32 v97, 18, v97
ds_read_u16 v96, v96
ds_read_u16 v97, v97
v_cvt_pk_f16_f32 v108, v108, v109
s_waitcnt lgkmcnt(4)
v_fma_mix_f32 v231, v162, v162, v231 op_sel_hi:[1,1,0]
v_fma_mix_f32 v231, v163, v163, v231 op_sel_hi:[1,1,0]
v_cvt_pk_f16_f32 v110, v110, v111
v_pk_fma_f16 v109, v108, v108, s48
v_mfma_f32_32x32x16_bf16 v[144:159], v[24:27], v[184:187], 0
v_cvt_pkrtz_f16_f32 v99, v98, v99
v_and_b32_e64 v99, s49, v99
v_bfe_u32 v98, v99, 2, 14
v_lshrrev_b32_e64 v99, 18, v99
ds_read_u16 v98, v98
ds_read_u16 v99, v99
ds_read_b128 v[180:183], v250 offset:58368
v_pk_fma_f16 v111, v110, v110, s48
v_fma_mix_f32 v231, v164, v164, v231 op_sel_hi:[1,1,0]
v_fma_mix_f32 v231, v165, v165, v231 op_sel_hi:[1,1,0]
v_pk_mul_f16 v109, v108, v109
v_pk_mul_f16 v111, v110, v111
v_cvt_pkrtz_f16_f32 v101, v100, v101
v_and_b32_e64 v101, s49, v101
v_bfe_u32 v100, v101, 2, 14
v_lshrrev_b32_e64 v101, 18, v101
ds_read_u16 v100, v100
ds_read_u16 v101, v101
v_exp_f16_sdwa v109, v109 dst_sel:WORD_0 dst_unused:UNUSED_PRESERVE src0_sel:WORD_0
v_fma_mix_f32 v231, v166, v166, v231 op_sel_hi:[1,1,0]
v_fma_mix_f32 v231, v167, v167, v231 op_sel_hi:[1,1,0]
v_mfma_f32_32x32x16_bf16 v[128:143], v[4:7], v[188:191], v[128:143]
v_exp_f16_sdwa v111, v111 dst_sel:WORD_0 dst_unused:UNUSED_PRESERVE src0_sel:WORD_0
v_cvt_pkrtz_f16_f32 v103, v102, v103
v_and_b32_e64 v103, s49, v103
v_bfe_u32 v102, v103, 2, 14
v_lshrrev_b32_e64 v103, 18, v103
ds_read_u16 v102, v102
ds_read_u16 v103, v103
v_exp_f16_sdwa v109, v109 dst_sel:WORD_1 dst_unused:UNUSED_PRESERVE src0_sel:WORD_1
v_fma_mix_f32 v231, v168, v168, v231 op_sel_hi:[1,1,0]
s_waitcnt lgkmcnt(7)
v_fma_mix_f32 v231, v169, v169, v231 op_sel_hi:[1,1,0]
v_cvt_pkrtz_f16_f32 v105, v104, v105
v_and_b32 v105, s49, v105
v_bfe_u32 v104, v105, 2, 14
v_lshrrev_b32_e64 v105, 18, v105
ds_read_u16 v104, v104
ds_read_u16 v105, v105
v_exp_f16_sdwa v111, v111 dst_sel:WORD_1 dst_unused:UNUSED_PRESERVE src0_sel:WORD_1
v_mfma_f32_32x32x16_bf16 v[144:159], v[28:31], v[188:191], v[144:159]
ds_read_b128 v[184:187], v250 offset:59392
v_cvt_pkrtz_f16_f32 v107, v106, v107
v_and_b32_e64 v107, s49, v107
v_bfe_u32 v106, v107, 2, 14
v_lshrrev_b32_e64 v107, 18, v107
ds_read_u16 v106, v106
ds_read_u16 v107, v107
v_pk_add_f16 v109, v109, 1.0 op_sel_hi:[1,0]
v_pk_add_f16 v111, v111, 1.0 op_sel_hi:[1,0]
v_rcp_f16_sdwa v109, v109 dst_sel:WORD_0 dst_unused:UNUSED_PRESERVE src0_sel:WORD_0
v_mfma_f32_32x32x16_bf16 v[128:143], v[8:11], v[176:179], v[128:143]
v_rcp_f16_sdwa v111, v111 dst_sel:WORD_0 dst_unused:UNUSED_PRESERVE src0_sel:WORD_0
v_rcp_f16_sdwa v109, v109 dst_sel:WORD_1 dst_unused:UNUSED_PRESERVE src0_sel:WORD_1
v_rcp_f16_sdwa v111, v111 dst_sel:WORD_1 dst_unused:UNUSED_PRESERVE src0_sel:WORD_1
v_mfma_f32_32x32x16_bf16 v[144:159], v[32:35], v[176:179], v[144:159]
ds_read_b128 v[188:191], v250 offset:60416
v_pk_mul_f16 v108, v108, v109
v_pk_mul_f16 v110, v110, v111
v_fma_mix_f32 v232, v108, v108, v232 op_sel_hi:[1,1,0]
v_add_u32_e64 v222, s83, v247
v_mov_b32 v223, 0
s_branch Law4
Lax4:
s_sleep 2
Law4:
ds_read_b32 v223, v222 offset:20
s_sub_u32 s76, s76, 1
s_cselect_b32 s44, 4, 0
s_cselect_b32 s76, 0, s76
s_waitcnt lgkmcnt(0)
v_readfirstlane_b32 s43, v223
s_nop 1
s_max_u32 s43, s43, s44
s_cmp_lt_u32 s43, 4
s_cbranch_scc1 Lax4
v_mfma_f32_32x32x16_bf16 v[128:143], v[12:15], v[180:183], v[128:143]
s_add_u32 s81, s81, 6592
s_cmp_eq_u32 s81, 65920
s_cselect_b32 s81, 0, s81
s_add_u32 s43, s81, s67
s_add_u32 m0, s43, 16
s_add_u32 s66, s66, 98304
buffer_load_dwordx4 v236, s[4:7], s66 offen lds
s_add_u32 m0, s43, 912
s_nop 0
buffer_load_dwordx4 v237, s[4:7], s66 offen lds
v_fma_mix_f32 v232, v110, v110, v232 op_sel_hi:[1,1,0]
v_fma_mix_f32 v232, v108, v108, v232 op_sel:[1,1,0] op_sel_hi:[1,1,0]
v_fma_mix_f32 v232, v110, v110, v232 op_sel:[1,1,0] op_sel_hi:[1,1,0]
v_fma_mix_f32 v232, v96, v96, v232 op_sel_hi:[1,1,0]
v_fma_mix_f32 v232, v97, v97, v232 op_sel_hi:[1,1,0]
v_fma_mix_f32 v232, v98, v98, v232 op_sel_hi:[1,1,0]
v_fma_mix_f32 v232, v99, v99, v232 op_sel_hi:[1,1,0]
v_cvt_pkrtz_f16_f32 v113, v112, v113
v_and_b32_e64 v113, s49, v113
v_bfe_u32 v112, v113, 2, 14
v_lshrrev_b32_e64 v113, 18, v113
ds_read_u16 v112, v112
ds_read_u16 v113, v113
v_cvt_pk_f16_f32 v122, v122, v123
v_cvt_pk_f16_f32 v124, v124, v125
v_cvt_pk_f16_f32 v126, v126, v127
v_pk_fma_f16 v123, v122, v122, s48
v_mfma_f32_32x32x16_bf16 v[144:159], v[36:39], v[180:183], v[144:159]
v_fma_mix_f32 v232, v100, v100, v232 op_sel_hi:[1,1,0]
v_fma_mix_f32 v232, v101, v101, v232 op_sel_hi:[1,1,0]
v_pk_fma_f16 v125, v124, v124, s48
ds_read_b128 v[176:179], v250 offset:61440
v_cvt_pkrtz_f16_f32 v115, v114, v115
v_and_b32_e64 v115, s49, v115
v_bfe_u32 v114, v115, 2, 14
v_lshrrev_b32_e64 v115, 18, v115
ds_read_u16 v114, v114
ds_read_u16 v115, v115
v_pk_fma_f16 v127, v126, v126, s48
v_pk_mul_f16 v123, v122, v123
v_pk_mul_f16 v125, v124, v125
v_fma_mix_f32 v232, v102, v102, v232 op_sel_hi:[1,1,0]
v_fma_mix_f32 v232, v103, v103, v232 op_sel_hi:[1,1,0]
v_pk_mul_f16 v127, v126, v127
v_exp_f16_sdwa v123, v123 dst_sel:WORD_0 dst_unused:UNUSED_PRESERVE src0_sel:WORD_0
s_add_u32 s81, s81, 6592
s_cmp_eq_u32 s81, 65920
s_cselect_b32 s81, 0, s81
s_add_u32 s43, s81, s67
s_add_u32 m0, s43, 16
s_add_u32 s66, s66, 98304
buffer_load_dwordx4 v236, s[4:7], s66 offen lds
s_add_u32 m0, s43, 912
s_nop 0
buffer_load_dwordx4 v237, s[4:7], s66 offen lds
v_cvt_pkrtz_f16_f32 v117, v116, v117
v_and_b32_e64 v117, s49, v117
v_bfe_u32 v116, v117, 2, 14
v_lshrrev_b32_e64 v117, 18, v117
ds_read_u16 v116, v116
ds_read_u16 v117, v117
v_mfma_f32_32x32x16_bf16 v[128:143], v[16:19], v[184:187], v[128:143]
v_exp_f16_sdwa v125, v125 dst_sel:WORD_0 dst_unused:UNUSED_PRESERVE src0_sel:WORD_0
v_fma_mix_f32 v232, v104, v104, v232 op_sel_hi:[1,1,0]
v_fma_mix_f32 v232, v105, v105, v232 op_sel_hi:[1,1,0]
v_exp_f16_sdwa v127, v127 dst_sel:WORD_0 dst_unused:UNUSED_PRESERVE src0_sel:WORD_0
v_cvt_pkrtz_f16_f32 v119, v118, v119
v_and_b32_e64 v119, s49, v119
v_bfe_u32 v118, v119, 2, 14
v_lshrrev_b32_e64 v119, 18, v119
ds_read_u16 v118, v118
ds_read_u16 v119, v119
v_exp_f16_sdwa v123, v123 dst_sel:WORD_1 dst_unused:UNUSED_PRESERVE src0_sel:WORD_1
v_fma_mix_f32 v232, v106, v106, v232 op_sel_hi:[1,1,0]
v_fma_mix_f32 v232, v107, v107, v232 op_sel_hi:[1,1,0]
v_exp_f16_sdwa v125, v125 dst_sel:WORD_1 dst_unused:UNUSED_PRESERVE src0_sel:WORD_1
v_mfma_f32_32x32x16_bf16 v[144:159], v[40:43], v[184:187], v[144:159]
v_exp_f16_sdwa v127, v127 dst_sel:WORD_1 dst_unused:UNUSED_PRESERVE src0_sel:WORD_1
ds_read_b128 v[180:183], v250 offset:62464
v_cvt_pkrtz_f16_f32 v121, v120, v121
v_and_b32_e64 v121, s49, v121
v_bfe_u32 v120, v121, 2, 14
v_lshrrev_b32_e64 v121, 18, v121
ds_read_u16 v120, v120
ds_read_u16 v121, v121
v_pk_add_f16 v123, v123, 1.0 op_sel_hi:[1,0]
v_pk_add_f16 v125, v125, 1.0 op_sel_hi:[1,0]
v_pk_add_f16 v127, v127, 1.0 op_sel_hi:[1,0]
s_add_u32 s81, s81, 6592
s_cmp_eq_u32 s81, 65920
s_cselect_b32 s81, 0, s81
s_add_u32 s43, s81, s67
s_add_u32 m0, s43, 32
s_add_u32 s66, s66, 98304
buffer_load_dwordx4 v236, s[4:7], s66 offen lds
s_add_u32 m0, s43, 928
s_nop 0
buffer_load_dwordx4 v237, s[4:7], s66 offen lds
v_rcp_f16_sdwa v123, v123 dst_sel:WORD_0 dst_unused:UNUSED_PRESERVE src0_sel:WORD_0
v_mfma_f32_32x32x16_bf16 v[128:143], v[20:23], v[188:191], v[128:143]
v_rcp_f16_sdwa v125, v125 dst_sel:WORD_0 dst_unused:UNUSED_PRESERVE src0_sel:WORD_0
v_rcp_f16_sdwa v127, v127 dst_sel:WORD_0 dst_unused:UNUSED_PRESERVE src0_sel:WORD_0
v_rcp_f16_sdwa v123, v123 dst_sel:WORD_1 dst_unused:UNUSED_PRESERVE src0_sel:WORD_1
v_rcp_f16_sdwa v125, v125 dst_sel:WORD_1 dst_unused:UNUSED_PRESERVE src0_sel:WORD_1
v_mfma_f32_32x32x16_bf16 v[144:159], v[44:47], v[188:191], v[144:159]
v_rcp_f16_sdwa v127, v127 dst_sel:WORD_1 dst_unused:UNUSED_PRESERVE src0_sel:WORD_1
ds_read_b128 v[184:187], v250 offset:63488
v_pk_mul_f16 v122, v122, v123
v_pk_mul_f16 v124, v124, v125
s_add_u32 s81, s81, 6592
s_cmp_eq_u32 s81, 65920
s_cselect_b32 s81, 0, s81
s_add_u32 s43, s81, s67
s_add_u32 m0, s43, 32
s_add_u32 s66, s66, 98304
buffer_load_dwordx4 v236, s[4:7], s66 offen lds
s_add_u32 m0, s43, 928
s_nop 0
buffer_load_dwordx4 v237, s[4:7], s66 offen lds
v_pk_mul_f16 v126, v126, v127
v_fma_mix_f32 v232, v122, v122, v232 op_sel_hi:[1,1,0]
v_fma_mix_f32 v232, v124, v124, v232 op_sel_hi:[1,1,0]
s_waitcnt lgkmcnt(3)
v_mfma_f32_32x32x16_bf16 v[160:175], v[0:3], v[176:179], 0
v_fma_mix_f32 v232, v126, v126, v232 op_sel_hi:[1,1,0]
v_fma_mix_f32 v232, v122, v122, v232 op_sel:[1,1,0] op_sel_hi:[1,1,0]
v_fma_mix_f32 v232, v124, v124, v232 op_sel:[1,1,0] op_sel_hi:[1,1,0]
v_fma_mix_f32 v232, v126, v126, v232 op_sel:[1,1,0] op_sel_hi:[1,1,0]
v_fma_mix_f32 v232, v112, v112, v232 op_sel_hi:[1,1,0]
v_fma_mix_f32 v232, v113, v113, v232 op_sel_hi:[1,1,0]
v_cvt_pkrtz_f16_f32 v129, v128, v129
v_and_b32 v129, s49, v129
v_bfe_u32 v128, v129, 2, 14
v_lshrrev_b32_e64 v129, 18, v129
ds_read_u16 v128, v128
ds_read_u16 v129, v129
v_cvt_pk_f16_f32 v140, v140, v141
v_fma_mix_f32 v232, v114, v114, v232 op_sel_hi:[1,1,0]
v_fma_mix_f32 v232, v115, v115, v232 op_sel_hi:[1,1,0]
v_cvt_pk_f16_f32 v142, v142, v143
v_pk_fma_f16 v141, v140, v140, s48
v_mfma_f32_32x32x16_bf16 v[96:111], v[24:27], v[176:179], 0
v_cvt_pkrtz_f16_f32 v131, v130, v131
v_and_b32_e64 v131, s49, v131
v_bfe_u32 v130, v131, 2, 14
v_lshrrev_b32_e64 v131, 18, v131
ds_read_u16 v130, v130
ds_read_u16 v131, v131
ds_read_b128 v[188:191], v250 offset:64512
v_pk_fma_f16 v143, v142, v142, s48
v_fma_mix_f32 v232, v116, v116, v232 op_sel_hi:[1,1,0]
v_fma_mix_f32 v232, v117, v117, v232 op_sel_hi:[1,1,0]
v_pk_mul_f16 v141, v140, v141
s_add_u32 s81, s81, 6592
s_cmp_eq_u32 s81, 65920
s_cselect_b32 s81, 0, s81
s_add_u32 s43, s81, s67
s_add_u32 m0, s43, 48
s_add_u32 s66, s66, 98304
buffer_load_dwordx4 v236, s[4:7], s66 offen lds
s_add_u32 m0, s43, 944
s_nop 0
buffer_load_dwordx4 v237, s[4:7], s66 offen lds
v_pk_mul_f16 v143, v142, v143
v_cvt_pkrtz_f16_f32 v133, v132, v133
v_and_b32_e64 v133, s49, v133
v_bfe_u32 v132, v133, 2, 14
v_lshrrev_b32_e64 v133, 18, v133
ds_read_u16 v132, v132
ds_read_u16 v133, v133
v_exp_f16_sdwa v141, v141 dst_sel:WORD_0 dst_unused:UNUSED_PRESERVE src0_sel:WORD_0
v_fma_mix_f32 v232, v118, v118, v232 op_sel_hi:[1,1,0]
v_fma_mix_f32 v232, v119, v119, v232 op_sel_hi:[1,1,0]
v_mfma_f32_32x32x16_bf16 v[160:175], v[4:7], v[180:183], v[160:175]
v_exp_f16_sdwa v143, v143 dst_sel:WORD_0 dst_unused:UNUSED_PRESERVE src0_sel:WORD_0
v_cvt_pkrtz_f16_f32 v135, v134, v135
v_and_b32_e64 v135, s49, v135
v_bfe_u32 v134, v135, 2, 14
v_lshrrev_b32 v135, 18, v135
ds_read_u16 v134, v134
ds_read_u16 v135, v135
v_exp_f16_sdwa v141, v141 dst_sel:WORD_1 dst_unused:UNUSED_PRESERVE src0_sel:WORD_1
s_waitcnt lgkmcnt(7)
v_fma_mix_f32 v232, v120, v120, v232 op_sel_hi:[1,1,0]
v_fma_mix_f32 v232, v121, v121, v232 op_sel_hi:[1,1,0]
v_cvt_pkrtz_f16_f32 v137, v136, v137
v_and_b32_e64 v137, s49, v137
v_bfe_u32 v136, v137, 2, 14
v_lshrrev_b32_e64 v137, 18, v137
ds_read_u16 v136, v136
ds_read_u16 v137, v137
v_exp_f16_sdwa v143, v143 dst_sel:WORD_1 dst_unused:UNUSED_PRESERVE src0_sel:WORD_1
v_mfma_f32_32x32x16_bf16 v[96:111], v[28:31], v[180:183], v[96:111]
ds_read_b128 v[176:179], v251
v_cvt_pkrtz_f16_f32 v139, v138, v139
v_and_b32_e64 v139, s49, v139
v_bfe_u32 v138, v139, 2, 14
v_lshrrev_b32_e64 v139, 18, v139
ds_read_u16 v138, v138
ds_read_u16 v139, v139
s_add_u32 s81, s81, 6592
s_cmp_eq_u32 s81, 65920
s_cselect_b32 s81, 0, s81
s_add_u32 s43, s81, s67
s_add_u32 m0, s43, 48
s_add_u32 s66, s66, 98304
buffer_load_dwordx4 v236, s[4:7], s66 offen lds
s_add_u32 m0, s43, 944
s_nop 0
buffer_load_dwordx4 v237, s[4:7], s66 offen lds
v_pk_add_f16 v141, v141, 1.0 op_sel_hi:[1,0]
v_pk_add_f16 v143, v143, 1.0 op_sel_hi:[1,0]
v_rcp_f16_sdwa v141, v141 dst_sel:WORD_0 dst_unused:UNUSED_PRESERVE src0_sel:WORD_0
v_mfma_f32_32x32x16_bf16 v[160:175], v[8:11], v[184:187], v[160:175]
v_rcp_f16_sdwa v143, v143 dst_sel:WORD_0 dst_unused:UNUSED_PRESERVE src0_sel:WORD_0
v_rcp_f16_sdwa v141, v141 dst_sel:WORD_1 dst_unused:UNUSED_PRESERVE src0_sel:WORD_1
v_rcp_f16_sdwa v143, v143 dst_sel:WORD_1 dst_unused:UNUSED_PRESERVE src0_sel:WORD_1
v_mfma_f32_32x32x16_bf16 v[96:111], v[32:35], v[184:187], v[96:111]
ds_read_b128 v[180:183], v251 offset:1024
s_add_u32 s81, s81, 6592
s_cmp_eq_u32 s81, 65920
s_cselect_b32 s81, 0, s81
s_add_u32 s43, s81, s67
s_add_u32 m0, s43, 0
s_add_u32 s66, s66, 98304
buffer_load_dwordx4 v236, s[4:7], s66 offen lds
s_add_u32 m0, s43, 896
s_nop 0
buffer_load_dwordx4 v237, s[4:7], s66 offen lds
v_pk_mul_f16 v140, v140, v141
v_pk_mul_f16 v142, v142, v143
v_fma_mix_f32 v233, v140, v140, v233 op_sel_hi:[1,1,0]
s_waitcnt lgkmcnt(7)
v_mfma_f32_32x32x16_bf16 v[160:175], v[12:15], v[188:191], v[160:175]
v_fma_mix_f32 v233, v142, v142, v233 op_sel_hi:[1,1,0]
v_fma_mix_f32 v233, v140, v140, v233 op_sel:[1,1,0] op_sel_hi:[1,1,0]
v_fma_mix_f32 v233, v142, v142, v233 op_sel:[1,1,0] op_sel_hi:[1,1,0]
v_fma_mix_f32 v233, v128, v128, v233 op_sel_hi:[1,1,0]
v_fma_mix_f32 v233, v129, v129, v233 op_sel_hi:[1,1,0]
v_fma_mix_f32 v233, v130, v130, v233 op_sel_hi:[1,1,0]
v_fma_mix_f32 v233, v131, v131, v233 op_sel_hi:[1,1,0]
v_cvt_pkrtz_f16_f32 v145, v144, v145
v_and_b32 v145, s49, v145
v_bfe_u32 v144, v145, 2, 14
v_lshrrev_b32_e64 v145, 18, v145
ds_read_u16 v144, v144
ds_read_u16 v145, v145
v_cvt_pk_f16_f32 v154, v154, v155
v_cvt_pk_f16_f32 v156, v156, v157
v_cvt_pk_f16_f32 v158, v158, v159
v_pk_fma_f16 v155, v154, v154, s48
v_mfma_f32_32x32x16_bf16 v[96:111], v[36:39], v[188:191], v[96:111]
v_fma_mix_f32 v233, v132, v132, v233 op_sel_hi:[1,1,0]
v_fma_mix_f32 v233, v133, v133, v233 op_sel_hi:[1,1,0]
s_add_u32 s81, s81, 6592
s_cmp_eq_u32 s81, 65920
s_cselect_b32 s81, 0, s81
s_add_u32 s43, s81, s67
s_add_u32 m0, s43, 0
s_add_u32 s66, s66, 98304
buffer_load_dwordx4 v236, s[4:7], s66 offen lds
s_add_u32 m0, s43, 896
s_nop 0
buffer_load_dwordx4 v237, s[4:7], s66 offen lds
v_pk_fma_f16 v157, v156, v156, s48
ds_read_b128 v[184:187], v251 offset:2048
v_cvt_pkrtz_f16_f32 v147, v146, v147
v_and_b32_e64 v147, s49, v147
v_bfe_u32 v146, v147, 2, 14
v_lshrrev_b32_e64 v147, 18, v147
ds_read_u16 v146, v146
ds_read_u16 v147, v147
v_pk_fma_f16 v159, v158, v158, s48
v_pk_mul_f16 v155, v154, v155
v_pk_mul_f16 v157, v156, v157
v_fma_mix_f32 v233, v134, v134, v233 op_sel_hi:[1,1,0]
s_waitcnt lgkmcnt(7)
v_fma_mix_f32 v233, v135, v135, v233 op_sel_hi:[1,1,0]
v_pk_mul_f16 v159, v158, v159
v_exp_f16_sdwa v155, v155 dst_sel:WORD_0 dst_unused:UNUSED_PRESERVE src0_sel:WORD_0
v_cvt_pkrtz_f16_f32 v149, v148, v149
v_and_b32 v149, s49, v149
v_bfe_u32 v148, v149, 2, 14
v_lshrrev_b32_e64 v149, 18, v149
ds_read_u16 v148, v148
ds_read_u16 v149, v149
v_mfma_f32_32x32x16_bf16 v[160:175], v[16:19], v[176:179], v[160:175]
v_exp_f16_sdwa v157, v157 dst_sel:WORD_0 dst_unused:UNUSED_PRESERVE src0_sel:WORD_0
v_fma_mix_f32 v233, v136, v136, v233 op_sel_hi:[1,1,0]
v_fma_mix_f32 v233, v137, v137, v233 op_sel_hi:[1,1,0]
v_exp_f16_sdwa v159, v159 dst_sel:WORD_0 dst_unused:UNUSED_PRESERVE src0_sel:WORD_0
v_cvt_pkrtz_f16_f32 v151, v150, v151
v_and_b32_e64 v151, s49, v151
v_bfe_u32 v150, v151, 2, 14
v_lshrrev_b32 v151, 18, v151
ds_read_u16 v150, v150
ds_read_u16 v151, v151
v_exp_f16_sdwa v155, v155 dst_sel:WORD_1 dst_unused:UNUSED_PRESERVE src0_sel:WORD_1
v_fma_mix_f32 v233, v138, v138, v233 op_sel_hi:[1,1,0]
s_waitcnt lgkmcnt(6)
v_fma_mix_f32 v233, v139, v139, v233 op_sel_hi:[1,1,0]
v_exp_f16_sdwa v157, v157 dst_sel:WORD_1 dst_unused:UNUSED_PRESERVE src0_sel:WORD_1
v_mfma_f32_32x32x16_bf16 v[96:111], v[40:43], v[176:179], v[96:111]
v_exp_f16_sdwa v159, v159 dst_sel:WORD_1 dst_unused:UNUSED_PRESERVE src0_sel:WORD_1
ds_read_b128 v[188:191], v251 offset:3072
v_cvt_pkrtz_f16_f32 v153, v152, v153
v_and_b32_e64 v153, s49, v153
v_bfe_u32 v152, v153, 2, 14
v_lshrrev_b32_e64 v153, 18, v153
ds_read_u16 v152, v152
ds_read_u16 v153, v153
v_pk_add_f16 v155, v155, 1.0 op_sel_hi:[1,0]
v_pk_add_f16 v157, v157, 1.0 op_sel_hi:[1,0]
v_pk_add_f16 v159, v159, 1.0 op_sel_hi:[1,0]
v_rcp_f16_sdwa v155, v155 dst_sel:WORD_0 dst_unused:UNUSED_PRESERVE src0_sel:WORD_0
v_mfma_f32_32x32x16_bf16 v[160:175], v[20:23], v[180:183], v[160:175]
v_rcp_f16_sdwa v157, v157 dst_sel:WORD_0 dst_unused:UNUSED_PRESERVE src0_sel:WORD_0
v_rcp_f16_sdwa v159, v159 dst_sel:WORD_0 dst_unused:UNUSED_PRESERVE src0_sel:WORD_0
v_rcp_f16_sdwa v155, v155 dst_sel:WORD_1 dst_unused:UNUSED_PRESERVE src0_sel:WORD_1
v_rcp_f16_sdwa v157, v157 dst_sel:WORD_1 dst_unused:UNUSED_PRESERVE src0_sel:WORD_1
v_mfma_f32_32x32x16_bf16 v[96:111], v[44:47], v[180:183], v[96:111]
v_rcp_f16_sdwa v159, v159 dst_sel:WORD_1 dst_unused:UNUSED_PRESERVE src0_sel:WORD_1
ds_read_b128 v[176:179], v251 offset:4096
v_pk_mul_f16 v154, v154, v155
v_pk_mul_f16 v156, v156, v157
v_pk_mul_f16 v158, v158, v159
v_fma_mix_f32 v233, v154, v154, v233 op_sel_hi:[1,1,0]
v_fma_mix_f32 v233, v156, v156, v233 op_sel_hi:[1,1,0]
v_mfma_f32_32x32x16_bf16 v[112:127], v[0:3], v[184:187], 0
s_getpc_b64 s[74:75]
Lcq3:
s_lshl_b32 s43, s40, 10
s_add_u32 s43, s43, 6144
s_min_u32 s43, s43, Lend-Lcq3-1024
s_add_u32 s74, s74, s43
s_addc_u32 s75, s75, 0
s_sub_u32 s74, s74, 16384
s_subb_u32 s75, s75, 0
s_mov_b32 m0, 163840
s_nop 0
global_load_lds_dword v250, s[74:75]
v_fma_mix_f32 v233, v158, v158, v233 op_sel_hi:[1,1,0]
v_fma_mix_f32 v233, v154, v154, v233 op_sel:[1,1,0] op_sel_hi:[1,1,0]
v_fma_mix_f32 v233, v156, v156, v233 op_sel:[1,1,0] op_sel_hi:[1,1,0]
v_fma_mix_f32 v233, v158, v158, v233 op_sel:[1,1,0] op_sel_hi:[1,1,0]
v_fma_mix_f32 v233, v144, v144, v233 op_sel_hi:[1,1,0]
v_fma_mix_f32 v233, v145, v145, v233 op_sel_hi:[1,1,0]
v_cvt_pkrtz_f16_f32 v161, v160, v161
v_and_b32_e64 v161, s49, v161
v_bfe_u32 v160, v161, 2, 14
v_lshrrev_b32 v161, 18, v161
ds_read_u16 v160, v160
ds_read_u16 v161, v161
v_cvt_pk_f16_f32 v172, v172, v173
s_waitcnt lgkmcnt(4)
v_fma_mix_f32 v233, v146, v146, v233 op_sel_hi:[1,1,0]
v_fma_mix_f32 v233, v147, v147, v233 op_sel_hi:[1,1,0]
v_cvt_pk_f16_f32 v174, v174, v175
v_pk_fma_f16 v173, v172, v172, s48
v_mfma_f32_32x32x16_bf16 v[128:143], v[24:27], v[184:187], 0
v_cvt_pkrtz_f16_f32 v163, v162, v163
v_and_b32_e64 v163, s49, v163
v_bfe_u32 v162, v163, 2, 14
v_lshrrev_b32_e64 v163, 18, v163
ds_read_u16 v162, v162
ds_read_u16 v163, v163
ds_read_b128 v[180:183], v251 offset:5120
v_pk_fma_f16 v175, v174, v174, s48
v_fma_mix_f32 v233, v148, v148, v233 op_sel_hi:[1,1,0]
v_fma_mix_f32 v233, v149, v149, v233 op_sel_hi:[1,1,0]
v_pk_mul_f16 v173, v172, v173
v_pk_mul_f16 v175, v174, v175
v_cvt_pkrtz_f16_f32 v165, v164, v165
v_and_b32_e64 v165, s49, v165
v_bfe_u32 v164, v165, 2, 14
v_lshrrev_b32_e64 v165, 18, v165
ds_read_u16 v164, v164
ds_read_u16 v165, v165
v_exp_f16_sdwa v173, v173 dst_sel:WORD_0 dst_unused:UNUSED_PRESERVE src0_sel:WORD_0
v_fma_mix_f32 v233, v150, v150, v233 op_sel_hi:[1,1,0]
v_fma_mix_f32 v233, v151, v151, v233 op_sel_hi:[1,1,0]
v_mfma_f32_32x32x16_bf16 v[112:127], v[4:7], v[188:191], v[112:127]
v_exp_f16_sdwa v175, v175 dst_sel:WORD_0 dst_unused:UNUSED_PRESERVE src0_sel:WORD_0
v_cvt_pkrtz_f16_f32 v167, v166, v167
v_and_b32_e64 v167, s49, v167
v_bfe_u32 v166, v167, 2, 14
v_lshrrev_b32_e64 v167, 18, v167
ds_read_u16 v166, v166
ds_read_u16 v167, v167
v_exp_f16_sdwa v173, v173 dst_sel:WORD_1 dst_unused:UNUSED_PRESERVE src0_sel:WORD_1
v_fma_mix_f32 v233, v152, v152, v233 op_sel_hi:[1,1,0]
s_waitcnt lgkmcnt(7)
v_fma_mix_f32 v233, v153, v153, v233 op_sel_hi:[1,1,0]
v_cvt_pkrtz_f16_f32 v169, v168, v169
v_and_b32 v169, s49, v169
v_bfe_u32 v168, v169, 2, 14
v_lshrrev_b32_e64 v169, 18, v169
ds_read_u16 v168, v168
ds_read_u16 v169, v169
v_exp_f16_sdwa v175, v175 dst_sel:WORD_1 dst_unused:UNUSED_PRESERVE src0_sel:WORD_1
v_mfma_f32_32x32x16_bf16 v[128:143], v[28:31], v[188:191], v[128:143]
ds_read_b128 v[184:187], v251 offset:6144
v_cvt_pkrtz_f16_f32 v171, v170, v171
v_and_b32_e64 v171, s49, v171
v_bfe_u32 v170, v171, 2, 14
v_lshrrev_b32_e64 v171, 18, v171
ds_read_u16 v170, v170
ds_read_u16 v171, v171
v_pk_add_f16 v173, v173, 1.0 op_sel_hi:[1,0]
v_pk_add_f16 v175, v175, 1.0 op_sel_hi:[1,0]
v_rcp_f16_sdwa v173, v173 dst_sel:WORD_0 dst_unused:UNUSED_PRESERVE src0_sel:WORD_0
v_mfma_f32_32x32x16_bf16 v[112:127], v[8:11], v[176:179], v[112:127]
v_rcp_f16_sdwa v175, v175 dst_sel:WORD_0 dst_unused:UNUSED_PRESERVE src0_sel:WORD_0
v_rcp_f16_sdwa v173, v173 dst_sel:WORD_1 dst_unused:UNUSED_PRESERVE src0_sel:WORD_1
v_rcp_f16_sdwa v175, v175 dst_sel:WORD_1 dst_unused:UNUSED_PRESERVE src0_sel:WORD_1
v_mfma_f32_32x32x16_bf16 v[128:143], v[32:35], v[176:179], v[128:143]
ds_read_b128 v[188:191], v251 offset:7168
v_pk_mul_f16 v172, v172, v173
v_pk_mul_f16 v174, v174, v175
v_fma_mix_f32 v234, v172, v172, v234 op_sel_hi:[1,1,0]
v_fma_mix_f32 v234, v174, v174, v234 op_sel_hi:[1,1,0]
s_waitcnt lgkmcnt(7)
v_mfma_f32_32x32x16_bf16 v[112:127], v[12:15], v[180:183], v[112:127]
v_fma_mix_f32 v234, v172, v172, v234 op_sel:[1,1,0] op_sel_hi:[1,1,0]
v_fma_mix_f32 v234, v174, v174, v234 op_sel:[1,1,0] op_sel_hi:[1,1,0]
v_fma_mix_f32 v234, v160, v160, v234 op_sel_hi:[1,1,0]
v_fma_mix_f32 v234, v161, v161, v234 op_sel_hi:[1,1,0]
v_fma_mix_f32 v234, v162, v162, v234 op_sel_hi:[1,1,0]
v_fma_mix_f32 v234, v163, v163, v234 op_sel_hi:[1,1,0]
v_cvt_pkrtz_f16_f32 v97, v96, v97
v_and_b32 v97, s49, v97
v_bfe_u32 v96, v97, 2, 14
v_lshrrev_b32_e64 v97, 18, v97
ds_read_u16 v96, v96
ds_read_u16 v97, v97
v_cvt_pk_f16_f32 v106, v106, v107
v_cvt_pk_f16_f32 v108, v108, v109
v_cvt_pk_f16_f32 v110, v110, v111
v_pk_fma_f16 v107, v106, v106, s48
v_mfma_f32_32x32x16_bf16 v[128:143], v[36:39], v[180:183], v[128:143]
v_fma_mix_f32 v234, v164, v164, v234 op_sel_hi:[1,1,0]
v_fma_mix_f32 v234, v165, v165, v234 op_sel_hi:[1,1,0]
v_pk_fma_f16 v109, v108, v108, s48
v_cvt_pkrtz_f16_f32 v99, v98, v99
v_and_b32_e64 v99, s49, v99
v_bfe_u32 v98, v99, 2, 14
v_lshrrev_b32_e64 v99, 18, v99
ds_read_u16 v98, v98
ds_read_u16 v99, v99
v_pk_fma_f16 v111, v110, v110, s48
v_pk_mul_f16 v107, v106, v107
v_pk_mul_f16 v109, v108, v109
v_fma_mix_f32 v234, v166, v166, v234 op_sel_hi:[1,1,0]
s_waitcnt lgkmcnt(6)
v_fma_mix_f32 v234, v167, v167, v234 op_sel_hi:[1,1,0]
v_pk_mul_f16 v111, v110, v111
v_exp_f16_sdwa v107, v107 dst_sel:WORD_0 dst_unused:UNUSED_PRESERVE src0_sel:WORD_0
v_cvt_pkrtz_f16_f32 v101, v100, v101
v_and_b32 v101, s49, v101
v_bfe_u32 v100, v101, 2, 14
v_lshrrev_b32_e64 v101, 18, v101
ds_read_u16 v100, v100
ds_read_u16 v101, v101
v_mfma_f32_32x32x16_bf16 v[112:127], v[16:19], v[184:187], v[112:127]
v_exp_f16_sdwa v109, v109 dst_sel:WORD_0 dst_unused:UNUSED_PRESERVE src0_sel:WORD_0
v_fma_mix_f32 v234, v168, v168, v234 op_sel_hi:[1,1,0]
v_fma_mix_f32 v234, v169, v169, v234 op_sel_hi:[1,1,0]
v_exp_f16_sdwa v111, v111 dst_sel:WORD_0 dst_unused:UNUSED_PRESERVE src0_sel:WORD_0
v_cvt_pkrtz_f16_f32 v103, v102, v103
v_and_b32_e64 v103, s49, v103
v_bfe_u32 v102, v103, 2, 14
v_lshrrev_b32 v103, 18, v103
ds_read_u16 v102, v102
ds_read_u16 v103, v103
v_exp_f16_sdwa v107, v107 dst_sel:WORD_1 dst_unused:UNUSED_PRESERVE src0_sel:WORD_1
v_fma_mix_f32 v234, v170, v170, v234 op_sel_hi:[1,1,0]
s_waitcnt lgkmcnt(6)
v_fma_mix_f32 v234, v171, v171, v234 op_sel_hi:[1,1,0]
v_exp_f16_sdwa v109, v109 dst_sel:WORD_1 dst_unused:UNUSED_PRESERVE src0_sel:WORD_1
v_mfma_f32_32x32x16_bf16 v[128:143], v[40:43], v[184:187], v[128:143]
v_exp_f16_sdwa v111, v111 dst_sel:WORD_1 dst_unused:UNUSED_PRESERVE src0_sel:WORD_1
v_cvt_pkrtz_f16_f32 v105, v104, v105
v_and_b32_e64 v105, s49, v105
v_bfe_u32 v104, v105, 2, 14
v_lshrrev_b32_e64 v105, 18, v105
ds_read_u16 v104, v104
ds_read_u16 v105, v105
v_pk_add_f16 v107, v107, 1.0 op_sel_hi:[1,0]
v_pk_add_f16 v109, v109, 1.0 op_sel_hi:[1,0]
v_pk_add_f16 v111, v111, 1.0 op_sel_hi:[1,0]
v_rcp_f16_sdwa v107, v107 dst_sel:WORD_0 dst_unused:UNUSED_PRESERVE src0_sel:WORD_0
v_mfma_f32_32x32x16_bf16 v[112:127], v[20:23], v[188:191], v[112:127]
v_rcp_f16_sdwa v109, v109 dst_sel:WORD_0 dst_unused:UNUSED_PRESERVE src0_sel:WORD_0
v_rcp_f16_sdwa v111, v111 dst_sel:WORD_0 dst_unused:UNUSED_PRESERVE src0_sel:WORD_0
v_rcp_f16_sdwa v107, v107 dst_sel:WORD_1 dst_unused:UNUSED_PRESERVE src0_sel:WORD_1
v_rcp_f16_sdwa v109, v109 dst_sel:WORD_1 dst_unused:UNUSED_PRESERVE src0_sel:WORD_1
v_mfma_f32_32x32x16_bf16 v[128:143], v[44:47], v[188:191], v[128:143]
v_rcp_f16_sdwa v111, v111 dst_sel:WORD_1 dst_unused:UNUSED_PRESERVE src0_sel:WORD_1
v_pk_mul_f16 v106, v106, v107
v_pk_mul_f16 v108, v108, v109
v_pk_mul_f16 v110, v110, v111
v_fma_mix_f32 v234, v106, v106, v234 op_sel_hi:[1,1,0]
v_fma_mix_f32 v234, v108, v108, v234 op_sel_hi:[1,1,0]
v_fma_mix_f32 v234, v110, v110, v234 op_sel_hi:[1,1,0]
v_fma_mix_f32 v234, v106, v106, v234 op_sel:[1,1,0] op_sel_hi:[1,1,0]
v_fma_mix_f32 v234, v108, v108, v234 op_sel:[1,1,0] op_sel_hi:[1,1,0]
v_fma_mix_f32 v234, v110, v110, v234 op_sel:[1,1,0] op_sel_hi:[1,1,0]
v_fma_mix_f32 v234, v96, v96, v234 op_sel_hi:[1,1,0]
v_fma_mix_f32 v234, v97, v97, v234 op_sel_hi:[1,1,0]
v_cvt_pkrtz_f16_f32 v113, v112, v113
v_and_b32_e64 v113, s49, v113
v_bfe_u32 v112, v113, 2, 14
v_lshrrev_b32 v113, 18, v113
ds_read_u16 v112, v112
ds_read_u16 v113, v113
v_cvt_pk_f16_f32 v124, v124, v125
s_waitcnt lgkmcnt(2)
v_fma_mix_f32 v234, v98, v98, v234 op_sel_hi:[1,1,0]
v_fma_mix_f32 v234, v99, v99, v234 op_sel_hi:[1,1,0]
v_cvt_pk_f16_f32 v126, v126, v127
v_pk_fma_f16 v125, v124, v124, s48
v_cvt_pkrtz_f16_f32 v115, v114, v115
v_and_b32_e64 v115, s49, v115
v_bfe_u32 v114, v115, 2, 14
v_lshrrev_b32_e64 v115, 18, v115
ds_read_u16 v114, v114
ds_read_u16 v115, v115
s_add_u32 s43, s81, 6592
v_add_u32_e64 v212, s43, v246
v_subrev_u32 v222, 65920, v212
v_min_u32_e64 v212, v212, v222
v_add_u32 v212, 90112, v212
v_add_u32_e64 v213, s43, v246
v_add_u32 v213, 6592, v213
v_subrev_u32 v222, 65920, v213
v_min_u32_e64 v213, v213, v222
v_add_u32 v213, 90112, v213
v_add_u32_e64 v214, s43, v246
v_add_u32 v214, 13184, v214
v_add_u32_e64 v222, 16, v214
v_bfi_b32 v214, 48, v222, v214
v_subrev_u32 v222, 65920, v214
v_min_u32_e64 v214, v214, v222
v_add_u32 v214, 90112, v214
v_add_u32_e64 v215, s43, v246
v_add_u32 v215, 19776, v215
v_add_u32_e64 v222, 16, v215
v_bfi_b32 v215, 48, v222, v215
v_subrev_u32 v222, 65920, v215
v_min_u32_e64 v215, v215, v222
v_add_u32 v215, 90112, v215
v_pk_fma_f16 v127, v126, v126, s48
v_fma_mix_f32 v234, v100, v100, v234 op_sel_hi:[1,1,0]
v_fma_mix_f32 v234, v101, v101, v234 op_sel_hi:[1,1,0]
v_pk_mul_f16 v125, v124, v125
v_pk_mul_f16 v127, v126, v127
v_cvt_pkrtz_f16_f32 v117, v116, v117
v_and_b32_e64 v117, s49, v117
v_bfe_u32 v116, v117, 2, 14
v_lshrrev_b32_e64 v117, 18, v117
ds_read_u16 v116, v116
ds_read_u16 v117, v117
v_exp_f16_sdwa v125, v125 dst_sel:WORD_0 dst_unused:UNUSED_PRESERVE src0_sel:WORD_0
v_fma_mix_f32 v234, v102, v102, v234 op_sel_hi:[1,1,0]
v_fma_mix_f32 v234, v103, v103, v234 op_sel_hi:[1,1,0]
v_exp_f16_sdwa v127, v127 dst_sel:WORD_0 dst_unused:UNUSED_PRESERVE src0_sel:WORD_0
v_cvt_pkrtz_f16_f32 v119, v118, v119
v_and_b32_e64 v119, s49, v119
v_bfe_u32 v118, v119, 2, 14
v_lshrrev_b32 v119, 18, v119
ds_read_u16 v118, v118
ds_read_u16 v119, v119
s_waitcnt vmcnt(1)
v_exp_f16_sdwa v125, v125 dst_sel:WORD_1 dst_unused:UNUSED_PRESERVE src0_sel:WORD_1
v_fma_mix_f32 v234, v104, v104, v234 op_sel_hi:[1,1,0]
v_fma_mix_f32 v234, v105, v105, v234 op_sel_hi:[1,1,0]
v_cvt_pkrtz_f16_f32 v121, v120, v121
v_and_b32_e64 v121, s49, v121
v_bfe_u32 v120, v121, 2, 14
v_lshrrev_b32_e64 v121, 18, v121
ds_read_u16 v120, v120
ds_read_b128 v[144:147], v212
ds_read_b64 v[196:197], v238
ds_read_b64 v[198:199], v239
ds_read_u16 v121, v121
ds_read_b128 v[148:151], v213
v_exp_f16_sdwa v127, v127 dst_sel:WORD_1 dst_unused:UNUSED_PRESERVE src0_sel:WORD_1
v_cvt_pkrtz_f16_f32 v123, v122, v123
v_and_b32_e64 v123, s49, v123
v_bfe_u32 v122, v123, 2, 14
v_lshrrev_b32_e64 v123, 18, v123
ds_read_u16 v122, v122
ds_read_b128 v[152:155], v214
ds_read_b64 v[200:201], v238 offset:2400
ds_read_b64 v[202:203], v239 offset:2400
ds_read_b128 v[156:159], v215
ds_read_u16 v123, v123
v_pk_add_f16 v125, v125, 1.0 op_sel_hi:[1,0]
v_pk_add_f16 v127, v127, 1.0 op_sel_hi:[1,0]
v_rcp_f16_sdwa v125, v125 dst_sel:WORD_0 dst_unused:UNUSED_PRESERVE src0_sel:WORD_0
v_rcp_f16_sdwa v127, v127 dst_sel:WORD_0 dst_unused:UNUSED_PRESERVE src0_sel:WORD_0
v_rcp_f16_sdwa v125, v125 dst_sel:WORD_1 dst_unused:UNUSED_PRESERVE src0_sel:WORD_1
v_rcp_f16_sdwa v127, v127 dst_sel:WORD_1 dst_unused:UNUSED_PRESERVE src0_sel:WORD_1
v_pk_mul_f16 v124, v124, v125
ds_read_b64 v[204:205], v238 offset:4800
ds_read_b64 v[206:207], v239 offset:4800
v_pk_mul_f16 v126, v126, v127
v_fma_mix_f32 v235, v124, v124, v235 op_sel_hi:[1,1,0]
v_fma_mix_f32 v235, v126, v126, v235 op_sel_hi:[1,1,0]
v_fma_mix_f32 v235, v124, v124, v235 op_sel:[1,1,0] op_sel_hi:[1,1,0]
v_fma_mix_f32 v235, v126, v126, v235 op_sel:[1,1,0] op_sel_hi:[1,1,0]
s_waitcnt lgkmcnt(14)
v_fma_mix_f32 v235, v112, v112, v235 op_sel_hi:[1,1,0]
v_fma_mix_f32 v235, v113, v113, v235 op_sel_hi:[1,1,0]
ds_read_b128 v[160:163], v212 offset:16
ds_read_b64 v[208:209], v238 offset:200
ds_read_b64 v[210:211], v239 offset:200
ds_read_b128 v[164:167], v213 offset:16
s_waitcnt lgkmcnt(14)
v_mfma_f32_16x16x32_bf16 v[48:51], v[196:199], v[144:147], 0
v_fma_mix_f32 v235, v114, v114, v235 op_sel_hi:[1,1,0]
v_fma_mix_f32 v235, v115, v115, v235 op_sel_hi:[1,1,0]
v_cvt_pkrtz_f16_f32 v129, v128, v129
v_and_b32_e64 v129, s49, v129
v_bfe_u32 v128, v129, 2, 14
v_lshrrev_b32 v129, 18, v129
ds_read_u16 v128, v128
v_cvt_pk_f16_f32 v138, v138, v139
s_waitcnt lgkmcnt(13)
v_mfma_f32_16x16x32_bf16 v[96:99], v[196:199], v[148:151], 0
ds_read_b128 v[168:171], v214 offset:16
v_cvt_pk_f16_f32 v140, v140, v141
v_cvt_pk_f16_f32 v142, v142, v143
v_pk_fma_f16 v139, v138, v138, s48
v_fma_mix_f32 v235, v116, v116, v235 op_sel_hi:[1,1,0]
ds_read_u16 v129, v129
v_fma_mix_f32 v235, v117, v117, v235 op_sel_hi:[1,1,0]
v_pk_fma_f16 v141, v140, v140, s48
v_cvt_pkrtz_f16_f32 v131, v130, v131
v_and_b32_e64 v131, s49, v131
v_bfe_u32 v130, v131, 2, 14
v_lshrrev_b32 v131, 18, v131
ds_read_u16 v130, v130
ds_read_b64 v[192:193], v238 offset:2600
ds_read_b64 v[194:195], v239 offset:2600
s_waitcnt lgkmcnt(14)
v_mfma_f32_16x16x32_bf16 v[48:51], v[200:203], v[148:151], v[48:51]
v_pk_fma_f16 v143, v142, v142, s48
v_mfma_f32_16x16x32_bf16 v[96:99], v[200:203], v[152:155], v[96:99]
ds_read_b128 v[172:175], v215 offset:16
v_pk_mul_f16 v139, v138, v139
v_pk_mul_f16 v141, v140, v141
v_fma_mix_f32 v235, v118, v118, v235 op_sel_hi:[1,1,0]
v_fma_mix_f32 v235, v119, v119, v235 op_sel_hi:[1,1,0]
ds_read_u16 v131, v131
v_pk_mul_f16 v143, v142, v143
v_exp_f16_sdwa v139, v139 dst_sel:WORD_0 dst_unused:UNUSED_PRESERVE src0_sel:WORD_0
v_cvt_pkrtz_f16_f32 v133, v132, v133
s_waitcnt lgkmcnt(12)
v_mfma_f32_16x16x32_bf16 v[48:51], v[204:207], v[152:155], v[48:51]
ds_read_b64 v[196:197], v238 offset:5000
ds_read_b64 v[198:199], v239 offset:5000
v_mfma_f32_16x16x32_bf16 v[96:99], v[204:207], v[156:159], v[96:99]
ds_read_b128 v[144:147], v212 offset:32
ds_read_b64 v[200:201], v238 offset:400
v_and_b32 v133, s49, v133
s_waitcnt lgkmcnt(13)
v_mfma_f32_16x16x32_bf16 v[52:55], v[208:211], v[160:163], 0
ds_read_b64 v[202:203], v239 offset:400
v_bfe_u32 v132, v133, 2, 14
s_waitcnt lgkmcnt(13)
v_mfma_f32_16x16x32_bf16 v[100:103], v[208:211], v[164:167], 0
ds_read_b128 v[148:151], v213 offset:32
v_lshrrev_b32_e64 v133, 18, v133
v_exp_f16_sdwa v141, v141 dst_sel:WORD_0 dst_unused:UNUSED_PRESERVE src0_sel:WORD_0
v_fma_mix_f32 v235, v120, v120, v235 op_sel_hi:[1,1,0]
ds_read_u16 v132, v132
v_fma_mix_f32 v235, v121, v121, v235 op_sel_hi:[1,1,0]
v_exp_f16_sdwa v143, v143 dst_sel:WORD_0 dst_unused:UNUSED_PRESERVE src0_sel:WORD_0
ds_read_u16 v133, v133
v_cvt_pkrtz_f16_f32 v135, v134, v135
v_and_b32_e64 v135, s49, v135
v_bfe_u32 v134, v135, 2, 14
v_lshrrev_b32_e64 v135, 18, v135
v_exp_f16_sdwa v139, v139 dst_sel:WORD_1 dst_unused:UNUSED_PRESERVE src0_sel:WORD_1
ds_read_u16 v134, v134
v_fma_mix_f32 v235, v122, v122, v235 op_sel_hi:[1,1,0]
v_fma_mix_f32 v235, v123, v123, v235 op_sel_hi:[1,1,0]
v_exp_f16_sdwa v141, v141 dst_sel:WORD_1 dst_unused:UNUSED_PRESERVE src0_sel:WORD_1
v_exp_f16_sdwa v143, v143 dst_sel:WORD_1 dst_unused:UNUSED_PRESERVE src0_sel:WORD_1
ds_read_u16 v135, v135
v_cvt_pkrtz_f16_f32 v137, v136, v137
v_and_b32 v137, s49, v137
v_bfe_u32 v136, v137, 2, 14
s_waitcnt lgkmcnt(12)
v_mfma_f32_16x16x32_bf16 v[52:55], v[192:195], v[164:167], v[52:55]
ds_read_b128 v[152:155], v214 offset:32
ds_read_b64 v[204:205], v238 offset:2800
v_mfma_f32_16x16x32_bf16 v[100:103], v[192:195], v[168:171], v[100:103]
ds_read_b64 v[206:207], v239 offset:2800
v_lshrrev_b32 v137, 18, v137
v_pk_add_f16 v139, v139, 1.0 op_sel_hi:[1,0]
v_pk_add_f16 v141, v141, 1.0 op_sel_hi:[1,0]
v_pk_add_f16 v143, v143, 1.0 op_sel_hi:[1,0]
v_rcp_f16_sdwa v139, v139 dst_sel:WORD_0 dst_unused:UNUSED_PRESERVE src0_sel:WORD_0
ds_read_u16 v136, v136
ds_read_b128 v[156:159], v215 offset:32
v_rcp_f16_sdwa v141, v141 dst_sel:WORD_0 dst_unused:UNUSED_PRESERVE src0_sel:WORD_0
s_waitcnt lgkmcnt(13)
v_mfma_f32_16x16x32_bf16 v[52:55], v[196:199], v[168:171], v[52:55]
ds_read_b64 v[208:209], v238 offset:5200
v_rcp_f16_sdwa v143, v143 dst_sel:WORD_0 dst_unused:UNUSED_PRESERVE src0_sel:WORD_0
v_mfma_f32_16x16x32_bf16 v[100:103], v[196:199], v[172:175], v[100:103]
ds_read_b64 v[210:211], v239 offset:5200
ds_read_b128 v[160:163], v212 offset:48
ds_read_b64 v[192:193], v238 offset:600
s_waitcnt lgkmcnt(14)
v_mfma_f32_16x16x32_bf16 v[56:59], v[200:203], v[144:147], 0
ds_read_b64 v[194:195], v239 offset:600
v_rcp_f16_sdwa v139, v139 dst_sel:WORD_1 dst_unused:UNUSED_PRESERVE src0_sel:WORD_1
s_waitcnt lgkmcnt(14)
v_mfma_f32_16x16x32_bf16 v[104:107], v[200:203], v[148:151], 0
v_rcp_f16_sdwa v141, v141 dst_sel:WORD_1 dst_unused:UNUSED_PRESERVE src0_sel:WORD_1
ds_read_u16 v137, v137
v_rcp_f16_sdwa v143, v143 dst_sel:WORD_1 dst_unused:UNUSED_PRESERVE src0_sel:WORD_1
v_pk_mul_f16 v138, v138, v139
v_pk_mul_f16 v140, v140, v141
v_pk_mul_f16 v142, v142, v143
v_fma_mix_f32 v235, v138, v138, v235 op_sel_hi:[1,1,0]
v_fma_mix_f32 v235, v140, v140, v235 op_sel_hi:[1,1,0]
v_fma_mix_f32 v235, v142, v142, v235 op_sel_hi:[1,1,0]
v_fma_mix_f32 v235, v138, v138, v235 op_sel:[1,1,0] op_sel_hi:[1,1,0]
v_fma_mix_f32 v235, v140, v140, v235 op_sel:[1,1,0] op_sel_hi:[1,1,0]
v_fma_mix_f32 v235, v142, v142, v235 op_sel:[1,1,0] op_sel_hi:[1,1,0]
v_fma_mix_f32 v235, v128, v128, v235 op_sel_hi:[1,1,0]
ds_read_b128 v[164:167], v213 offset:48
ds_read_b128 v[168:171], v214 offset:48
v_fma_mix_f32 v235, v129, v129, v235 op_sel_hi:[1,1,0]
v_fma_mix_f32 v235, v130, v130, v235 op_sel_hi:[1,1,0]
v_fma_mix_f32 v235, v131, v131, v235 op_sel_hi:[1,1,0]
ds_read_b64 v[196:197], v238 offset:3000
ds_read_b64 v[198:199], v239 offset:3000
ds_read_b128 v[172:175], v215 offset:48
s_waitcnt lgkmcnt(13)
v_mfma_f32_16x16x32_bf16 v[56:59], v[204:207], v[148:151], v[56:59]
ds_read_b64 v[200:201], v238 offset:5400
v_fma_mix_f32 v235, v132, v132, v235 op_sel_hi:[1,1,0]
v_mfma_f32_16x16x32_bf16 v[104:107], v[204:207], v[152:155], v[104:107]
v_fma_mix_f32 v235, v133, v133, v235 op_sel_hi:[1,1,0]
ds_read_b64 v[202:203], v239 offset:5400
ds_read_b128 v[144:147], v212 offset:64
ds_read_b64 v[204:205], v238 offset:800
s_waitcnt lgkmcnt(13)
v_mfma_f32_16x16x32_bf16 v[56:59], v[208:211], v[152:155], v[56:59]
ds_read_b64 v[206:207], v239 offset:800
v_mfma_f32_16x16x32_bf16 v[104:107], v[208:211], v[156:159], v[104:107]
ds_read_b128 v[148:151], v213 offset:64
v_fma_mix_f32 v235, v134, v134, v235 op_sel_hi:[1,1,0]
v_fma_mix_f32 v235, v135, v135, v235 op_sel_hi:[1,1,0]
ds_read_b128 v[152:155], v214 offset:64
s_waitcnt lgkmcnt(13)
v_mfma_f32_16x16x32_bf16 v[60:63], v[192:195], v[160:163], 0
ds_read_b64 v[208:209], v238 offset:3200
ds_read_b64 v[210:211], v239 offset:3200
s_waitcnt lgkmcnt(13)
v_mfma_f32_16x16x32_bf16 v[108:111], v[192:195], v[164:167], 0
ds_read_b128 v[156:159], v215 offset:64
ds_read_b64 v[192:193], v238 offset:5600
ds_read_b64 v[194:195], v239 offset:5600
s_waitcnt lgkmcnt(13)
v_mfma_f32_16x16x32_bf16 v[60:63], v[196:199], v[164:167], v[60:63]
ds_read_b128 v[160:163], v212 offset:80
v_fma_mix_f32 v235, v136, v136, v235 op_sel_hi:[1,1,0]
v_mfma_f32_16x16x32_bf16 v[108:111], v[196:199], v[168:171], v[108:111]
ds_read_b64 v[196:197], v238 offset:1000
ds_read_b64 v[198:199], v239 offset:1000
v_fma_mix_f32 v235, v137, v137, v235 op_sel_hi:[1,1,0]
s_waitcnt lgkmcnt(13)
v_mfma_f32_16x16x32_bf16 v[60:63], v[200:203], v[168:171], v[60:63]
ds_read_b128 v[164:167], v213 offset:80
v_mfma_f32_16x16x32_bf16 v[108:111], v[200:203], v[172:175], v[108:111]
ds_read_b128 v[168:171], v214 offset:80
ds_read_b64 v[200:201], v238 offset:3400
s_waitcnt lgkmcnt(13)
v_mfma_f32_16x16x32_bf16 v[64:67], v[204:207], v[144:147], 0
ds_read_b64 v[202:203], v239 offset:3400
s_waitcnt lgkmcnt(13)
v_mfma_f32_16x16x32_bf16 v[112:115], v[204:207], v[148:151], 0
ds_read_b128 v[172:175], v215 offset:80
ds_read_b64 v[204:205], v238 offset:5800
ds_read_b64 v[206:207], v239 offset:5800
s_waitcnt lgkmcnt(13)
v_mfma_f32_16x16x32_bf16 v[64:67], v[208:211], v[148:151], v[64:67]
ds_read_b128 v[144:147], v212 offset:96
v_mfma_f32_16x16x32_bf16 v[112:115], v[208:211], v[152:155], v[112:115]
ds_read_b64 v[208:209], v238 offset:1200
ds_read_b64 v[210:211], v239 offset:1200
s_waitcnt lgkmcnt(13)
v_mfma_f32_16x16x32_bf16 v[64:67], v[192:195], v[152:155], v[64:67]
ds_read_b128 v[148:151], v213 offset:96
v_mfma_f32_16x16x32_bf16 v[112:115], v[192:195], v[156:159], v[112:115]
ds_read_b128 v[152:155], v214 offset:96
ds_read_b64 v[192:193], v238 offset:3600
s_waitcnt lgkmcnt(13)
v_mfma_f32_16x16x32_bf16 v[68:71], v[196:199], v[160:163], 0
ds_read_b64 v[194:195], v239 offset:3600
s_waitcnt lgkmcnt(13)
v_mfma_f32_16x16x32_bf16 v[116:119], v[196:199], v[164:167], 0
ds_read_b128 v[156:159], v215 offset:96
ds_read_b64 v[196:197], v238 offset:6000
ds_read_b64 v[198:199], v239 offset:6000
s_waitcnt lgkmcnt(13)
v_mfma_f32_16x16x32_bf16 v[68:71], v[200:203], v[164:167], v[68:71]
ds_read_b128 v[160:163], v212 offset:112
v_mfma_f32_16x16x32_bf16 v[116:119], v[200:203], v[168:171], v[116:119]
ds_read_b64 v[200:201], v238 offset:1400
ds_read_b64 v[202:203], v239 offset:1400
s_waitcnt lgkmcnt(13)
v_mfma_f32_16x16x32_bf16 v[68:71], v[204:207], v[168:171], v[68:71]
ds_read_b128 v[164:167], v213 offset:112
v_mfma_f32_16x16x32_bf16 v[116:119], v[204:207], v[172:175], v[116:119]
s_getpc_b64 s[74:75]
Lcq4:
s_lshl_b32 s43, s40, 10
s_add_u32 s43, s43, 6144
s_min_u32 s43, s43, Lend-Lcq4-1024
s_add_u32 s74, s74, s43
s_addc_u32 s75, s75, 0
s_sub_u32 s74, s74, 16384
s_subb_u32 s75, s75, 0
s_mov_b32 m0, 163840
s_nop 0
global_load_lds_dword v250, s[74:75]
ds_read_b128 v[168:171], v214 offset:112
ds_read_b64 v[204:205], v238 offset:3800
s_waitcnt lgkmcnt(13)
v_mfma_f32_16x16x32_bf16 v[72:75], v[208:211], v[144:147], 0
ds_read_b64 v[206:207], v239 offset:3800
s_waitcnt lgkmcnt(13)
v_mfma_f32_16x16x32_bf16 v[120:123], v[208:211], v[148:151], 0
ds_read_b128 v[172:175], v215 offset:112
ds_read_b64 v[208:209], v238 offset:6200
ds_read_b64 v[210:211], v239 offset:6200
s_waitcnt lgkmcnt(13)
v_mfma_f32_16x16x32_bf16 v[72:75], v[192:195], v[148:151], v[72:75]
ds_read_b128 v[144:147], v212 offset:128
v_mfma_f32_16x16x32_bf16 v[120:123], v[192:195], v[152:155], v[120:123]
ds_read_b64 v[192:193], v238 offset:1600
ds_read_b64 v[194:195], v239 offset:1600
s_waitcnt lgkmcnt(13)
v_mfma_f32_16x16x32_bf16 v[72:75], v[196:199], v[152:155], v[72:75]
ds_read_b128 v[148:151], v213 offset:128
v_mfma_f32_16x16x32_bf16 v[120:123], v[196:199], v[156:159], v[120:123]
ds_read_b128 v[152:155], v214 offset:128
ds_read_b64 v[196:197], v238 offset:4000
s_waitcnt lgkmcnt(13)
v_mfma_f32_16x16x32_bf16 v[76:79], v[200:203], v[160:163], 0
ds_read_b64 v[198:199], v239 offset:4000
s_waitcnt lgkmcnt(13)
v_mfma_f32_16x16x32_bf16 v[124:127], v[200:203], v[164:167], 0
ds_read_b128 v[156:159], v215 offset:128
ds_read_b64 v[200:201], v238 offset:6400
ds_read_b64 v[202:203], v239 offset:6400
s_waitcnt lgkmcnt(13)
v_mfma_f32_16x16x32_bf16 v[76:79], v[204:207], v[164:167], v[76:79]
ds_read_b128 v[160:163], v212 offset:144
v_mul_f32 v242, v48, v48
v_mfma_f32_16x16x32_bf16 v[124:127], v[204:207], v[168:171], v[124:127]
ds_read_b64 v[204:205], v238 offset:1800
ds_read_b64 v[206:207], v239 offset:1800
v_add_f32 v240, v48, v50
s_waitcnt lgkmcnt(13)
v_mfma_f32_16x16x32_bf16 v[76:79], v[208:211], v[168:171], v[76:79]
ds_read_b128 v[164:167], v213 offset:144
v_mul_f32_e64 v243, v49, v49
v_mfma_f32_16x16x32_bf16 v[124:127], v[208:211], v[172:175], v[124:127]
ds_read_b128 v[168:171], v214 offset:144
ds_read_b64 v[208:209], v238 offset:4200
v_add_f32 v241, v49, v51
s_waitcnt lgkmcnt(13)
v_mfma_f32_16x16x32_bf16 v[80:83], v[192:195], v[144:147], 0
ds_read_b64 v[210:211], v239 offset:4200
v_fmac_f32 v242, v50, v50
s_waitcnt lgkmcnt(13)
v_mfma_f32_16x16x32_bf16 v[128:131], v[192:195], v[148:151], 0
ds_read_b128 v[172:175], v215 offset:144
v_fmac_f32 v243, v51, v51
v_fmac_f32 v242, v52, v52
v_add_f32 v240, v240, v52
v_fmac_f32 v243, v53, v53
v_add_f32 v241, v241, v53
s_waitcnt lgkmcnt(11)
v_mfma_f32_16x16x32_bf16 v[80:83], v[196:199], v[148:151], v[80:83]
ds_read_b64 v[192:193], v238 offset:6600
ds_read_b64 v[194:195], v239 offset:6600
v_mfma_f32_16x16x32_bf16 v[128:131], v[196:199], v[152:155], v[128:131]
ds_read_b128 v[144:147], v212 offset:160
ds_read_b64 v[196:197], v238 offset:2000
ds_read_b64 v[198:199], v239 offset:2000
v_fmac_f32 v242, v54, v54
s_waitcnt lgkmcnt(13)
v_mfma_f32_16x16x32_bf16 v[80:83], v[200:203], v[152:155], v[80:83]
ds_read_b128 v[148:151], v213 offset:160
v_add_f32_e64 v240, v240, v54
v_mfma_f32_16x16x32_bf16 v[128:131], v[200:203], v[156:159], v[128:131]
ds_read_b128 v[152:155], v214 offset:160
ds_read_b64 v[200:201], v238 offset:4400
s_waitcnt lgkmcnt(13)
v_mfma_f32_16x16x32_bf16 v[84:87], v[204:207], v[160:163], 0
ds_read_b64 v[202:203], v239 offset:4400
v_fmac_f32 v243, v55, v55
v_add_f32 v241, v241, v55
s_waitcnt lgkmcnt(13)
v_mfma_f32_16x16x32_bf16 v[132:135], v[204:207], v[164:167], 0
ds_read_b128 v[156:159], v215 offset:160
v_fmac_f32 v242, v56, v56
v_add_f32 v240, v240, v56
v_fmac_f32 v243, v57, v57
v_add_f32 v241, v241, v57
v_fmac_f32 v242, v58, v58
s_waitcnt lgkmcnt(11)
v_mfma_f32_16x16x32_bf16 v[84:87], v[208:211], v[164:167], v[84:87]
ds_read_b64 v[204:205], v238 offset:6800
ds_read_b64 v[206:207], v239 offset:6800
v_mfma_f32_16x16x32_bf16 v[132:135], v[208:211], v[168:171], v[132:135]
ds_read_b128 v[160:163], v212 offset:176
ds_read_b64 v[208:209], v238 offset:2200
ds_read_b64 v[210:211], v239 offset:2200
s_waitcnt lgkmcnt(13)
v_mfma_f32_16x16x32_bf16 v[84:87], v[192:195], v[168:171], v[84:87]
ds_read_b128 v[164:167], v213 offset:176
v_add_f32 v240, v240, v58
v_mfma_f32_16x16x32_bf16 v[132:135], v[192:195], v[172:175], v[132:135]
ds_read_b128 v[168:171], v214 offset:176
ds_read_b64 v[192:193], v238 offset:4600
v_fmac_f32 v243, v59, v59
s_waitcnt lgkmcnt(13)
v_mfma_f32_16x16x32_bf16 v[88:91], v[196:199], v[144:147], 0
ds_read_b64 v[194:195], v239 offset:4600
v_add_f32 v241, v241, v59
s_waitcnt lgkmcnt(13)
v_mfma_f32_16x16x32_bf16 v[136:139], v[196:199], v[148:151], 0
ds_read_b128 v[172:175], v215 offset:176
v_fmac_f32 v242, v60, v60
v_add_f32 v240, v240, v60
v_fmac_f32 v243, v61, v61
v_add_f32 v241, v241, v61
v_fmac_f32 v242, v62, v62
s_waitcnt lgkmcnt(11)
v_mfma_f32_16x16x32_bf16 v[88:91], v[200:203], v[148:151], v[88:91]
ds_read_b64 v[196:197], v238 offset:7000
ds_read_b64 v[198:199], v239 offset:7000
v_mfma_f32_16x16x32_bf16 v[136:139], v[200:203], v[152:155], v[136:139]
v_add_f32 v240, v240, v62
v_fmac_f32 v243, v63, v63
v_add_f32 v241, v241, v63
s_waitcnt lgkmcnt(10)
v_mfma_f32_16x16x32_bf16 v[88:91], v[204:207], v[152:155], v[88:91]
v_fmac_f32 v242, v64, v64
v_mfma_f32_16x16x32_bf16 v[136:139], v[204:207], v[156:159], v[136:139]
v_add_f32 v240, v240, v64
v_fmac_f32 v243, v65, v65
v_add_f32 v241, v241, v65
s_waitcnt lgkmcnt(7)
v_mfma_f32_16x16x32_bf16 v[92:95], v[208:211], v[160:163], 0
v_fmac_f32 v242, v66, v66
v_add_f32 v240, v240, v66
s_waitcnt lgkmcnt(6)
v_mfma_f32_16x16x32_bf16 v[140:143], v[208:211], v[164:167], 0
v_fmac_f32 v243, v67, v67
v_add_f32 v241, v241, v67
v_fmac_f32 v242, v68, v68
v_add_f32 v240, v240, v68
v_fmac_f32 v243, v69, v69
v_add_f32 v241, v241, v69
s_waitcnt lgkmcnt(3)
v_mfma_f32_16x16x32_bf16 v[92:95], v[192:195], v[164:167], v[92:95]
v_fmac_f32 v242, v70, v70
v_mfma_f32_16x16x32_bf16 v[140:143], v[192:195], v[168:171], v[140:143]
v_add_f32 v240, v240, v70
v_fmac_f32 v243, v71, v71
v_add_f32 v241, v241, v71
s_waitcnt lgkmcnt(0)
v_mfma_f32_16x16x32_bf16 v[92:95], v[196:199], v[168:171], v[92:95]
v_fmac_f32 v242, v72, v72
v_mfma_f32_16x16x32_bf16 v[140:143], v[196:199], v[172:175], v[140:143]
v_mov_b32 v223, 1
v_add_u32 v222, s83, v247
s_mov_b64 exec, 1
ds_add_u32 v222, v223 offset:24
s_mov_b64 exec, -1
v_add_f32 v240, v240, v72
v_fmac_f32 v243, v73, v73
v_add_f32 v241, v241, v73
v_fmac_f32 v242, v74, v74
v_add_f32 v240, v240, v74
v_fmac_f32 v243, v75, v75
v_add_f32 v241, v241, v75
v_fmac_f32 v242, v76, v76
v_add_f32 v240, v240, v76
v_fmac_f32 v243, v77, v77
v_add_f32 v241, v241, v77
v_fmac_f32 v242, v78, v78
v_add_f32 v240, v240, v78
v_fmac_f32 v243, v79, v79
v_add_f32 v241, v241, v79
v_fmac_f32 v242, v80, v80
v_add_f32 v240, v240, v80
v_fmac_f32 v243, v81, v81
v_add_f32 v241, v241, v81
v_fmac_f32 v242, v82, v82
v_add_f32 v240, v240, v82
v_fmac_f32 v243, v83, v83
v_add_f32 v241, v241, v83
v_fmac_f32 v242, v84, v84
v_add_f32 v240, v240, v84
v_fmac_f32 v243, v85, v85
v_add_f32 v241, v241, v85
v_fmac_f32 v242, v86, v86
v_add_f32 v240, v240, v86
v_fmac_f32 v243, v87, v87
v_add_f32 v241, v241, v87
v_fmac_f32 v242, v88, v88
v_add_f32 v240, v240, v88
v_fmac_f32 v243, v89, v89
v_add_f32 v241, v241, v89
v_fmac_f32 v242, v90, v90
v_add_f32 v240, v240, v90
v_fmac_f32 v243, v91, v91
v_add_f32 v241, v241, v91
v_fmac_f32 v242, v92, v92
v_add_f32 v240, v240, v92
v_fmac_f32 v243, v93, v93
v_add_f32 v241, v241, v93
v_fmac_f32 v242, v94, v94
v_add_f32 v240, v240, v94
v_fmac_f32 v243, v95, v95
v_add_f32 v241, v241, v95
v_mul_f32 v218, v96, v96
v_add_f32 v216, v96, v98
v_mul_f32 v219, v97, v97
v_add_f32 v217, v97, v99
v_fmac_f32 v218, v98, v98
v_fmac_f32 v219, v99, v99
v_fmac_f32 v218, v100, v100
v_add_f32 v216, v216, v100
v_fmac_f32 v219, v101, v101
v_add_f32 v217, v217, v101
v_fmac_f32 v218, v102, v102
v_add_f32 v216, v216, v102
v_fmac_f32 v219, v103, v103
v_add_f32 v217, v217, v103
v_fmac_f32 v218, v104, v104
v_add_f32 v216, v216, v104
v_fmac_f32 v219, v105, v105
v_add_f32 v217, v217, v105
v_fmac_f32 v218, v106, v106
v_add_f32 v216, v216, v106
v_fmac_f32 v219, v107, v107
v_add_f32 v217, v217, v107
v_fmac_f32 v218, v108, v108
v_add_f32 v216, v216, v108
v_fmac_f32 v219, v109, v109
v_add_f32 v217, v217, v109
v_fmac_f32 v218, v110, v110
v_add_f32 v216, v216, v110
v_fmac_f32 v219, v111, v111
v_add_f32 v217, v217, v111
v_fmac_f32 v218, v112, v112
v_add_f32 v216, v216, v112
v_fmac_f32 v219, v113, v113
v_add_f32 v217, v217, v113
v_fmac_f32 v218, v114, v114
v_add_f32 v216, v216, v114
v_fmac_f32 v219, v115, v115
v_add_f32 v217, v217, v115
v_fmac_f32 v218, v116, v116
v_add_f32 v216, v216, v116
v_fmac_f32 v219, v117, v117
v_add_f32 v217, v217, v117
v_fmac_f32 v218, v118, v118
v_add_f32 v216, v216, v118
v_fmac_f32 v219, v119, v119
v_add_f32 v217, v217, v119
v_fmac_f32 v218, v120, v120
v_add_f32 v216, v216, v120
v_fmac_f32 v219, v121, v121
v_add_f32 v217, v217, v121
v_fmac_f32 v218, v122, v122
v_add_f32 v216, v216, v122
v_fmac_f32 v219, v123, v123
v_add_f32 v217, v217, v123
v_fmac_f32 v218, v124, v124
v_add_f32 v216, v216, v124
v_fmac_f32 v219, v125, v125
v_add_f32 v217, v217, v125
v_fmac_f32 v218, v126, v126
v_add_f32 v216, v216, v126
v_fmac_f32 v219, v127, v127
v_add_f32 v217, v217, v127
v_fmac_f32 v218, v128, v128
v_add_f32 v216, v216, v128
v_fmac_f32 v219, v129, v129
v_add_f32 v217, v217, v129
v_fmac_f32 v218, v130, v130
v_add_f32 v216, v216, v130
v_fmac_f32 v219, v131, v131
v_add_f32 v217, v217, v131
v_fmac_f32 v218, v132, v132
v_add_f32 v216, v216, v132
v_fmac_f32 v219, v133, v133
v_add_f32 v217, v217, v133
v_fmac_f32 v218, v134, v134
v_add_f32 v216, v216, v134
v_fmac_f32 v219, v135, v135
v_add_f32 v217, v217, v135
v_fmac_f32 v218, v136, v136
v_add_f32 v216, v216, v136
v_fmac_f32 v219, v137, v137
v_add_f32 v217, v217, v137
v_fmac_f32 v218, v138, v138
v_add_f32 v216, v216, v138
v_fmac_f32 v219, v139, v139
v_add_f32 v217, v217, v139
v_fmac_f32 v218, v140, v140
v_add_f32 v216, v216, v140
v_fmac_f32 v219, v141, v141
v_add_f32 v217, v217, v141
v_fmac_f32 v218, v142, v142
v_add_f32 v216, v216, v142
v_fmac_f32 v219, v143, v143
v_add_f32 v217, v217, v143
v_add_f32 v216, v216, v217
v_add_f32 v218, v218, v219
s_nop 1
v_permlane32_swap_b32 v216, v218
v_add_f32_e64 v216, v216, v218
v_mul_f32 v216, 1009429163, v216
v_mov_b32_e64 v218, v216
s_nop 1
v_permlane32_swap_b32 v216, v218
v_fma_f32 v218, -v216, v216, v218
v_max_f32_e64 v218, 0, v218
v_add_f32 v218, 925353388, v218
v_rsq_f32 v218, v218
v_add_f32 v240, v240, v241
v_mul_f32 v220, 3203396952, v218
v_mul_f32 v221, v216, v220
v_add_f32 v242, v242, v243
s_nop 1
v_permlane32_swap_b32 v240, v242
v_add_f32_e64 v240, v240, v242
v_mul_f32 v240, 1009429163, v240
v_mov_b32_e64 v242, v240
s_nop 1
v_permlane32_swap_b32 v240, v242
v_fma_f32 v242, -v240, v240, v242
v_max_f32_e64 v242, 0, v242
v_add_f32 v242, 925353388, v242
v_rsq_f32_e64 v242, v242
ds_read_b128 v[176:179], v250
v_mul_f32 v244, 3203396952, v242
v_mul_f32 v245, v240, v244
v_fma_f32 v48, v48, v244, -v245
v_fma_f32 v49, v49, v244, -v245
v_cvt_pk_bf16_f32 v48, v48, v49
v_fma_f32 v50, v50, v244, -v245
v_fma_f32 v51, v51, v244, -v245
v_cvt_pk_bf16_f32 v49, v50, v51
v_fma_f32 v52, v52, v244, -v245
v_fma_f32 v53, v53, v244, -v245
v_cvt_pk_bf16_f32 v50, v52, v53
v_fma_f32 v54, v54, v244, -v245
v_fma_f32 v55, v55, v244, -v245
v_cvt_pk_bf16_f32 v51, v54, v55
v_fma_f32 v56, v56, v244, -v245
v_fma_f32 v57, v57, v244, -v245
v_cvt_pk_bf16_f32 v52, v56, v57
v_fma_f32 v58, v58, v244, -v245
v_fma_f32 v59, v59, v244, -v245
v_cvt_pk_bf16_f32 v53, v58, v59
v_fma_f32 v60, v60, v244, -v245
v_fma_f32 v61, v61, v244, -v245
v_cvt_pk_bf16_f32 v54, v60, v61
v_fma_f32 v62, v62, v244, -v245
v_fma_f32 v63, v63, v244, -v245
v_cvt_pk_bf16_f32 v55, v62, v63
v_fma_f32 v64, v64, v244, -v245
v_fma_f32 v65, v65, v244, -v245
v_cvt_pk_bf16_f32 v56, v64, v65
v_fma_f32 v66, v66, v244, -v245
v_fma_f32 v67, v67, v244, -v245
v_cvt_pk_bf16_f32 v57, v66, v67
v_fma_f32 v68, v68, v244, -v245
v_fma_f32 v69, v69, v244, -v245
v_cvt_pk_bf16_f32 v58, v68, v69
v_fma_f32 v70, v70, v244, -v245
v_fma_f32 v71, v71, v244, -v245
v_cvt_pk_bf16_f32 v59, v70, v71
v_fma_f32 v72, v72, v244, -v245
v_fma_f32 v73, v73, v244, -v245
v_cvt_pk_bf16_f32 v60, v72, v73
v_fma_f32 v74, v74, v244, -v245
v_fma_f32 v75, v75, v244, -v245
v_cvt_pk_bf16_f32 v61, v74, v75
v_fma_f32 v76, v76, v244, -v245
v_fma_f32 v77, v77, v244, -v245
v_cvt_pk_bf16_f32 v62, v76, v77
v_fma_f32 v78, v78, v244, -v245
v_fma_f32 v79, v79, v244, -v245
v_cvt_pk_bf16_f32 v63, v78, v79
v_fma_f32 v80, v80, v244, -v245
v_fma_f32 v81, v81, v244, -v245
v_cvt_pk_bf16_f32 v64, v80, v81
v_fma_f32 v82, v82, v244, -v245
v_fma_f32 v83, v83, v244, -v245
v_cvt_pk_bf16_f32 v65, v82, v83
v_fma_f32 v84, v84, v244, -v245
v_fma_f32 v85, v85, v244, -v245
v_cvt_pk_bf16_f32 v66, v84, v85
v_fma_f32 v86, v86, v244, -v245
v_fma_f32 v87, v87, v244, -v245
v_cvt_pk_bf16_f32 v67, v86, v87
v_fma_f32 v88, v88, v244, -v245
v_fma_f32 v89, v89, v244, -v245
v_cvt_pk_bf16_f32 v68, v88, v89
v_fma_f32 v90, v90, v244, -v245
v_fma_f32 v91, v91, v244, -v245
v_cvt_pk_bf16_f32 v69, v90, v91
v_fma_f32 v92, v92, v244, -v245
v_fma_f32 v93, v93, v244, -v245
v_cvt_pk_bf16_f32 v70, v92, v93
v_fma_f32 v94, v94, v244, -v245
v_fma_f32 v95, v95, v244, -v245
v_cvt_pk_bf16_f32 v71, v94, v95
v_fma_f32 v96, v96, v220, -v221
v_fma_f32 v97, v97, v220, -v221
v_cvt_pk_bf16_f32 v72, v96, v97
s_setprio 2
v_fma_f32 v98, v98, v220, -v221
v_fma_f32 v99, v99, v220, -v221
v_cvt_pk_bf16_f32 v73, v98, v99
v_fma_f32 v100, v100, v220, -v221
v_fma_f32 v101, v101, v220, -v221
v_cvt_pk_bf16_f32 v74, v100, v101
v_fma_f32 v102, v102, v220, -v221
v_fma_f32 v103, v103, v220, -v221
v_cvt_pk_bf16_f32 v75, v102, v103
v_fma_f32 v104, v104, v220, -v221
v_fma_f32 v105, v105, v220, -v221
v_cvt_pk_bf16_f32 v76, v104, v105
v_fma_f32 v106, v106, v220, -v221
v_fma_f32 v107, v107, v220, -v221
v_cvt_pk_bf16_f32 v77, v106, v107
v_fma_f32 v108, v108, v220, -v221
v_fma_f32 v109, v109, v220, -v221
v_cvt_pk_bf16_f32 v78, v108, v109
v_fma_f32 v110, v110, v220, -v221
v_fma_f32 v111, v111, v220, -v221
v_cvt_pk_bf16_f32 v79, v110, v111
v_fma_f32 v112, v112, v220, -v221
v_fma_f32 v113, v113, v220, -v221
v_cvt_pk_bf16_f32 v80, v112, v113
ds_read_b128 v[180:183], v250 offset:1024
v_fma_f32 v114, v114, v220, -v221
v_fma_f32 v115, v115, v220, -v221
v_cvt_pk_bf16_f32 v81, v114, v115
v_fma_f32 v116, v116, v220, -v221
v_fma_f32 v117, v117, v220, -v221
v_cvt_pk_bf16_f32 v82, v116, v117
v_fma_f32 v118, v118, v220, -v221
v_fma_f32 v119, v119, v220, -v221
v_cvt_pk_bf16_f32 v83, v118, v119
v_fma_f32 v120, v120, v220, -v221
v_fma_f32 v121, v121, v220, -v221
v_cvt_pk_bf16_f32 v84, v120, v121
v_fma_f32 v122, v122, v220, -v221
v_fma_f32 v123, v123, v220, -v221
v_cvt_pk_bf16_f32 v85, v122, v123
v_fma_f32 v124, v124, v220, -v221
v_fma_f32 v125, v125, v220, -v221
v_cvt_pk_bf16_f32 v86, v124, v125
v_fma_f32 v126, v126, v220, -v221
v_fma_f32 v127, v127, v220, -v221
v_cvt_pk_bf16_f32 v87, v126, v127
v_fma_f32 v128, v128, v220, -v221
v_fma_f32 v129, v129, v220, -v221
v_cvt_pk_bf16_f32 v88, v128, v129
v_fma_f32 v130, v130, v220, -v221
v_fma_f32 v131, v131, v220, -v221
v_cvt_pk_bf16_f32 v89, v130, v131
v_fma_f32 v132, v132, v220, -v221
v_fma_f32 v133, v133, v220, -v221
v_cvt_pk_bf16_f32 v90, v132, v133
v_fma_f32 v134, v134, v220, -v221
v_fma_f32 v135, v135, v220, -v221
v_cvt_pk_bf16_f32 v91, v134, v135
ds_read_b128 v[184:187], v250 offset:2048
v_fma_f32 v136, v136, v220, -v221
v_fma_f32 v137, v137, v220, -v221
v_cvt_pk_bf16_f32 v92, v136, v137
v_fma_f32 v138, v138, v220, -v221
v_fma_f32 v139, v139, v220, -v221
v_cvt_pk_bf16_f32 v93, v138, v139
v_fma_f32 v140, v140, v220, -v221
v_fma_f32 v141, v141, v220, -v221
v_cvt_pk_bf16_f32 v94, v140, v141
v_fma_f32 v142, v142, v220, -v221
v_fma_f32 v143, v143, v220, -v221
v_cvt_pk_bf16_f32 v95, v142, v143
v_cndmask_b32 v216, 0, v255, s[50:51]
v_and_b32 v216, 1006648320, v216
v_cndmask_b32 v217, 0, v255, s[52:53]
v_and_b32 v217, 1006648320, v217
v_cndmask_b32 v218, 0, v255, s[54:55]
v_and_b32 v218, 1006648320, v218
v_cndmask_b32 v219, 0, v255, s[56:57]
v_and_b32 v219, 1006648320, v219
v_cndmask_b32 v220, 0, v255, s[58:59]
v_and_b32 v220, 1006648320, v220
v_cndmask_b32 v221, 0, v255, s[60:61]
v_and_b32 v221, 1006648320, v221
v_cndmask_b32 v222, 0, v255, s[62:63]
v_and_b32 v222, 1006648320, v222
v_cndmask_b32 v223, 0, v255, s[64:65]
v_and_b32 v223, 1006648320, v223
s_waitcnt lgkmcnt(0)
v_mfma_f32_32x32x16_bf16 v[144:159], v[48:51], v[176:179], 0
ds_read_b128 v[188:191], v250 offset:3072
v_mfma_f32_32x32x16_bf16 v[160:175], v[72:75], v[176:179], 0
ds_read_b128 v[176:179], v250 offset:4096
v_mfma_f32_32x32x16_bf16 v[144:159], v[52:55], v[180:183], v[144:159]
v_mfma_f32_32x32x16_bf16 v[160:175], v[76:79], v[180:183], v[160:175]
ds_read_b128 v[180:183], v250 offset:5120
v_mfma_f32_32x32x16_bf16 v[144:159], v[56:59], v[184:187], v[144:159]
v_mfma_f32_32x32x16_bf16 v[160:175], v[80:83], v[184:187], v[160:175]
ds_read_b128 v[184:187], v250 offset:6144
s_waitcnt lgkmcnt(2)
v_mfma_f32_32x32x16_bf16 v[144:159], v[60:63], v[188:191], v[144:159]
v_mfma_f32_32x32x16_bf16 v[160:175], v[84:87], v[188:191], v[160:175]
ds_read_b128 v[188:191], v250 offset:7168
v_mfma_f32_32x32x16_bf16 v[144:159], v[64:67], v[176:179], v[144:159]
v_mfma_f32_32x32x16_bf16 v[160:175], v[88:91], v[176:179], v[160:175]
ds_read_b128 v[176:179], v250 offset:8192
s_waitcnt lgkmcnt(2)
v_mfma_f32_32x32x16_bf16 v[144:159], v[68:71], v[180:183], v[144:159]
v_mfma_f32_32x32x16_bf16 v[160:175], v[92:95], v[180:183], v[160:175]
ds_read_b128 v[180:183], v250 offset:9216
v_mfma_f32_32x32x16_bf16 v[96:111], v[48:51], v[184:187], 0
s_nop 8
v_cvt_pkrtz_f16_f32 v145, v144, v145
v_and_b32_e64 v145, s49, v145
v_bfe_u32 v144, v145, 2, 14
v_lshrrev_b32_e64 v145, 18, v145
ds_read_u16 v144, v144
ds_read_u16 v145, v145
v_cvt_pk_f16_f32 v156, v156, v157
v_cvt_pk_f16_f32 v158, v158, v159
v_mfma_f32_32x32x16_bf16 v[112:127], v[72:75], v[184:187], 0
v_pk_fma_f16 v157, v156, v156, s48
v_cvt_pkrtz_f16_f32 v147, v146, v147
v_and_b32_e64 v147, s49, v147
v_bfe_u32 v146, v147, 2, 14
v_lshrrev_b32_e64 v147, 18, v147
ds_read_u16 v146, v146
ds_read_u16 v147, v147
v_pk_fma_f16 v159, v158, v158, s48
v_pk_mul_f16 v157, v156, v157
v_pk_mul_f16 v159, v158, v159
v_cvt_pkrtz_f16_f32 v149, v148, v149
v_and_b32_e64 v149, s49, v149
v_bfe_u32 v148, v149, 2, 14
v_lshrrev_b32 v149, 18, v149
ds_read_u16 v148, v148
ds_read_u16 v149, v149
v_exp_f16_sdwa v157, v157 dst_sel:WORD_0 dst_unused:UNUSED_PRESERVE src0_sel:WORD_0
s_waitcnt lgkmcnt(6)
v_mfma_f32_32x32x16_bf16 v[96:111], v[52:55], v[188:191], v[96:111]
v_exp_f16_sdwa v159, v159 dst_sel:WORD_0 dst_unused:UNUSED_PRESERVE src0_sel:WORD_0
v_cvt_pkrtz_f16_f32 v151, v150, v151
v_and_b32_e64 v151, s49, v151
v_bfe_u32 v150, v151, 2, 14
v_lshrrev_b32_e64 v151, 18, v151
ds_read_u16 v150, v150
ds_read_u16 v151, v151
v_exp_f16_sdwa v157, v157 dst_sel:WORD_1 dst_unused:UNUSED_PRESERVE src0_sel:WORD_1
v_cvt_pkrtz_f16_f32 v153, v152, v153
v_and_b32_e64 v153, s49, v153
v_bfe_u32 v152, v153, 2, 14
v_lshrrev_b32_e64 v153, 18, v153
ds_read_u16 v152, v152
ds_read_u16 v153, v153
v_mfma_f32_32x32x16_bf16 v[112:127], v[76:79], v[188:191], v[112:127]
v_exp_f16_sdwa v159, v159 dst_sel:WORD_1 dst_unused:UNUSED_PRESERVE src0_sel:WORD_1
ds_read_b128 v[184:187], v250 offset:10240
v_cvt_pkrtz_f16_f32 v155, v154, v155
v_and_b32_e64 v155, s49, v155
v_bfe_u32 v154, v155, 2, 14
v_lshrrev_b32_e64 v155, 18, v155
ds_read_u16 v154, v154
ds_read_u16 v155, v155
v_pk_add_f16 v157, v157, 1.0 op_sel_hi:[1,0]
v_pk_add_f16 v159, v159, 1.0 op_sel_hi:[1,0]
v_rcp_f16_sdwa v157, v157 dst_sel:WORD_0 dst_unused:UNUSED_PRESERVE src0_sel:WORD_0
v_mfma_f32_32x32x16_bf16 v[96:111], v[56:59], v[176:179], v[96:111]
v_rcp_f16_sdwa v159, v159 dst_sel:WORD_0 dst_unused:UNUSED_PRESERVE src0_sel:WORD_0
v_rcp_f16_sdwa v157, v157 dst_sel:WORD_1 dst_unused:UNUSED_PRESERVE src0_sel:WORD_1
v_mfma_f32_32x32x16_bf16 v[112:127], v[80:83], v[176:179], v[112:127]
v_rcp_f16_sdwa v159, v159 dst_sel:WORD_1 dst_unused:UNUSED_PRESERVE src0_sel:WORD_1
ds_read_b128 v[188:191], v250 offset:11264
v_pk_mul_f16 v156, v156, v157
v_pk_mul_f16 v158, v158, v159
v_fma_mix_f32 v224, v156, v156, v224 op_sel_hi:[1,1,0]
v_fma_mix_f32 v224, v158, v158, v224 op_sel_hi:[1,1,0]
v_mfma_f32_32x32x16_bf16 v[96:111], v[60:63], v[180:183], v[96:111]
v_fma_mix_f32 v224, v156, v156, v224 op_sel:[1,1,0] op_sel_hi:[1,1,0]
v_fma_mix_f32 v224, v158, v158, v224 op_sel:[1,1,0] op_sel_hi:[1,1,0]
s_waitcnt lgkmcnt(7)
v_fma_mix_f32 v224, v144, v144, v224 op_sel_hi:[1,1,0]
v_fma_mix_f32 v224, v145, v145, v224 op_sel_hi:[1,1,0]
v_fma_mix_f32 v224, v146, v146, v224 op_sel_hi:[1,1,0]
v_fma_mix_f32 v224, v147, v147, v224 op_sel_hi:[1,1,0]
v_cvt_pkrtz_f16_f32 v161, v160, v161
v_and_b32 v161, s49, v161
v_bfe_u32 v160, v161, 2, 14
v_lshrrev_b32_e64 v161, 18, v161
ds_read_u16 v160, v160
ds_read_u16 v161, v161
v_cvt_pk_f16_f32 v170, v170, v171
v_cvt_pk_f16_f32 v172, v172, v173
v_cvt_pk_f16_f32 v174, v174, v175
v_mfma_f32_32x32x16_bf16 v[112:127], v[84:87], v[180:183], v[112:127]
v_pk_fma_f16 v171, v170, v170, s48
v_fma_mix_f32 v224, v148, v148, v224 op_sel_hi:[1,1,0]
v_fma_mix_f32 v224, v149, v149, v224 op_sel_hi:[1,1,0]
v_pk_fma_f16 v173, v172, v172, s48
ds_read_b128 v[176:179], v250 offset:12288
v_cvt_pkrtz_f16_f32 v163, v162, v163
v_and_b32_e64 v163, s49, v163
v_bfe_u32 v162, v163, 2, 14
v_lshrrev_b32_e64 v163, 18, v163
ds_read_u16 v162, v162
ds_read_u16 v163, v163
v_pk_fma_f16 v175, v174, v174, s48
v_pk_mul_f16 v171, v170, v171
v_pk_mul_f16 v173, v172, v173
v_fma_mix_f32 v224, v150, v150, v224 op_sel_hi:[1,1,0]
s_waitcnt lgkmcnt(8)
v_fma_mix_f32 v224, v151, v151, v224 op_sel_hi:[1,1,0]
v_pk_mul_f16 v175, v174, v175
v_exp_f16_sdwa v171, v171 dst_sel:WORD_0 dst_unused:UNUSED_PRESERVE src0_sel:WORD_0
v_cvt_pkrtz_f16_f32 v165, v164, v165
v_and_b32 v165, s49, v165
v_bfe_u32 v164, v165, 2, 14
v_lshrrev_b32_e64 v165, 18, v165
ds_read_u16 v164, v164
ds_read_u16 v165, v165
v_mfma_f32_32x32x16_bf16 v[96:111], v[64:67], v[184:187], v[96:111]
v_exp_f16_sdwa v173, v173 dst_sel:WORD_0 dst_unused:UNUSED_PRESERVE src0_sel:WORD_0
v_fma_mix_f32 v224, v152, v152, v224 op_sel_hi:[1,1,0]
v_fma_mix_f32 v224, v153, v153, v224 op_sel_hi:[1,1,0]
v_exp_f16_sdwa v175, v175 dst_sel:WORD_0 dst_unused:UNUSED_PRESERVE src0_sel:WORD_0
v_cvt_pkrtz_f16_f32 v167, v166, v167
v_and_b32_e64 v167, s49, v167
v_bfe_u32 v166, v167, 2, 14
v_lshrrev_b32 v167, 18, v167
ds_read_u16 v166, v166
ds_read_u16 v167, v167
v_exp_f16_sdwa v171, v171 dst_sel:WORD_1 dst_unused:UNUSED_PRESERVE src0_sel:WORD_1
s_waitcnt lgkmcnt(7)
v_fma_mix_f32 v224, v154, v154, v224 op_sel_hi:[1,1,0]
v_fma_mix_f32 v224, v155, v155, v224 op_sel_hi:[1,1,0]
v_exp_f16_sdwa v173, v173 dst_sel:WORD_1 dst_unused:UNUSED_PRESERVE src0_sel:WORD_1
v_mfma_f32_32x32x16_bf16 v[112:127], v[88:91], v[184:187], v[112:127]
v_exp_f16_sdwa v175, v175 dst_sel:WORD_1 dst_unused:UNUSED_PRESERVE src0_sel:WORD_1
ds_read_b128 v[180:183], v250 offset:13312
v_cvt_pkrtz_f16_f32 v169, v168, v169
v_and_b32_e64 v169, s49, v169
v_bfe_u32 v168, v169, 2, 14
v_lshrrev_b32_e64 v169, 18, v169
ds_read_u16 v168, v168
ds_read_u16 v169, v169
v_pk_add_f16 v171, v171, 1.0 op_sel_hi:[1,0]
v_pk_add_f16 v173, v173, 1.0 op_sel_hi:[1,0]
v_pk_add_f16 v175, v175, 1.0 op_sel_hi:[1,0]
v_rcp_f16_sdwa v171, v171 dst_sel:WORD_0 dst_unused:UNUSED_PRESERVE src0_sel:WORD_0
v_mfma_f32_32x32x16_bf16 v[96:111], v[68:71], v[188:191], v[96:111]
v_rcp_f16_sdwa v173, v173 dst_sel:WORD_0 dst_unused:UNUSED_PRESERVE src0_sel:WORD_0
v_rcp_f16_sdwa v175, v175 dst_sel:WORD_0 dst_unused:UNUSED_PRESERVE src0_sel:WORD_0
v_rcp_f16_sdwa v171, v171 dst_sel:WORD_1 dst_unused:UNUSED_PRESERVE src0_sel:WORD_1
v_rcp_f16_sdwa v173, v173 dst_sel:WORD_1 dst_unused:UNUSED_PRESERVE src0_sel:WORD_1
v_mfma_f32_32x32x16_bf16 v[112:127], v[92:95], v[188:191], v[112:127]
v_rcp_f16_sdwa v175, v175 dst_sel:WORD_1 dst_unused:UNUSED_PRESERVE src0_sel:WORD_1
ds_read_b128 v[184:187], v250 offset:14336
v_pk_mul_f16 v170, v170, v171
v_pk_mul_f16 v172, v172, v173
v_pk_mul_f16 v174, v174, v175
v_fma_mix_f32 v224, v170, v170, v224 op_sel_hi:[1,1,0]
v_fma_mix_f32 v224, v172, v172, v224 op_sel_hi:[1,1,0]
s_waitcnt lgkmcnt(5)
v_mfma_f32_32x32x16_bf16 v[128:143], v[48:51], v[176:179], 0
v_fma_mix_f32 v224, v174, v174, v224 op_sel_hi:[1,1,0]
v_fma_mix_f32 v224, v170, v170, v224 op_sel:[1,1,0] op_sel_hi:[1,1,0]
v_fma_mix_f32 v224, v172, v172, v224 op_sel:[1,1,0] op_sel_hi:[1,1,0]
v_fma_mix_f32 v224, v174, v174, v224 op_sel:[1,1,0] op_sel_hi:[1,1,0]
v_fma_mix_f32 v224, v160, v160, v224 op_sel_hi:[1,1,0]
v_fma_mix_f32 v224, v161, v161, v224 op_sel_hi:[1,1,0]
v_cvt_pkrtz_f16_f32 v97, v96, v97
v_and_b32 v97, s49, v97
v_bfe_u32 v96, v97, 2, 14
v_lshrrev_b32_e64 v97, 18, v97
ds_read_u16 v96, v96
ds_read_u16 v97, v97
v_cvt_pk_f16_f32 v108, v108, v109
v_fma_mix_f32 v224, v162, v162, v224 op_sel_hi:[1,1,0]
v_fma_mix_f32 v224, v163, v163, v224 op_sel_hi:[1,1,0]
v_cvt_pk_f16_f32 v110, v110, v111
v_mfma_f32_32x32x16_bf16 v[144:159], v[72:75], v[176:179], 0
v_pk_fma_f16 v109, v108, v108, s48
v_cvt_pkrtz_f16_f32 v99, v98, v99
v_and_b32_e64 v99, s49, v99
v_bfe_u32 v98, v99, 2, 14
v_lshrrev_b32_e64 v99, 18, v99
ds_read_u16 v98, v98
ds_read_u16 v99, v99
v_pk_fma_f16 v111, v110, v110, s48
ds_read_b128 v[188:191], v250 offset:15360
v_fma_mix_f32 v224, v164, v164, v224 op_sel_hi:[1,1,0]
v_fma_mix_f32 v224, v165, v165, v224 op_sel_hi:[1,1,0]
v_pk_mul_f16 v109, v108, v109
v_pk_mul_f16 v111, v110, v111
v_cvt_pkrtz_f16_f32 v101, v100, v101
v_and_b32_e64 v101, s49, v101
v_bfe_u32 v100, v101, 2, 14
v_lshrrev_b32 v101, 18, v101
ds_read_u16 v100, v100
ds_read_u16 v101, v101
v_exp_f16_sdwa v109, v109 dst_sel:WORD_0 dst_unused:UNUSED_PRESERVE src0_sel:WORD_0
v_fma_mix_f32 v224, v166, v166, v224 op_sel_hi:[1,1,0]
s_waitcnt lgkmcnt(7)
v_fma_mix_f32 v224, v167, v167, v224 op_sel_hi:[1,1,0]
v_mfma_f32_32x32x16_bf16 v[128:143], v[52:55], v[180:183], v[128:143]
v_exp_f16_sdwa v111, v111 dst_sel:WORD_0 dst_unused:UNUSED_PRESERVE src0_sel:WORD_0
v_cvt_pkrtz_f16_f32 v103, v102, v103
v_and_b32_e64 v103, s49, v103
v_bfe_u32 v102, v103, 2, 14
v_lshrrev_b32_e64 v103, 18, v103
ds_read_u16 v102, v102
ds_read_u16 v103, v103
v_exp_f16_sdwa v109, v109 dst_sel:WORD_1 dst_unused:UNUSED_PRESERVE src0_sel:WORD_1
v_fma_mix_f32 v224, v168, v168, v224 op_sel_hi:[1,1,0]
v_fma_mix_f32 v224, v169, v169, v224 op_sel_hi:[1,1,0]
v_cvt_pkrtz_f16_f32 v105, v104, v105
v_and_b32_e64 v105, s49, v105
v_bfe_u32 v104, v105, 2, 14
v_lshrrev_b32_e64 v105, 18, v105
ds_read_u16 v104, v104
ds_read_u16 v105, v105
v_mfma_f32_32x32x16_bf16 v[144:159], v[76:79], v[180:183], v[144:159]
v_exp_f16_sdwa v111, v111 dst_sel:WORD_1 dst_unused:UNUSED_PRESERVE src0_sel:WORD_1
ds_read_b128 v[176:179], v250 offset:16384
v_cvt_pkrtz_f16_f32 v107, v106, v107
v_and_b32_e64 v107, s49, v107
v_bfe_u32 v106, v107, 2, 14
v_lshrrev_b32_e64 v107, 18, v107
ds_read_u16 v106, v106
ds_read_u16 v107, v107
v_pk_add_f16 v109, v109, 1.0 op_sel_hi:[1,0]
v_pk_add_f16 v111, v111, 1.0 op_sel_hi:[1,0]
v_rcp_f16_sdwa v109, v109 dst_sel:WORD_0 dst_unused:UNUSED_PRESERVE src0_sel:WORD_0
v_mfma_f32_32x32x16_bf16 v[128:143], v[56:59], v[184:187], v[128:143]
v_rcp_f16_sdwa v111, v111 dst_sel:WORD_0 dst_unused:UNUSED_PRESERVE src0_sel:WORD_0
v_rcp_f16_sdwa v109, v109 dst_sel:WORD_1 dst_unused:UNUSED_PRESERVE src0_sel:WORD_1
v_mfma_f32_32x32x16_bf16 v[144:159], v[80:83], v[184:187], v[144:159]
v_rcp_f16_sdwa v111, v111 dst_sel:WORD_1 dst_unused:UNUSED_PRESERVE src0_sel:WORD_1
ds_read_b128 v[180:183], v250 offset:17408
v_pk_mul_f16 v108, v108, v109
v_pk_mul_f16 v110, v110, v111
v_fma_mix_f32 v225, v108, v108, v225 op_sel_hi:[1,1,0]
v_fma_mix_f32 v225, v110, v110, v225 op_sel_hi:[1,1,0]
s_waitcnt lgkmcnt(7)
v_mfma_f32_32x32x16_bf16 v[128:143], v[60:63], v[188:191], v[128:143]
v_fma_mix_f32 v225, v108, v108, v225 op_sel:[1,1,0] op_sel_hi:[1,1,0]
v_fma_mix_f32 v225, v110, v110, v225 op_sel:[1,1,0] op_sel_hi:[1,1,0]
v_fma_mix_f32 v225, v96, v96, v225 op_sel_hi:[1,1,0]
v_fma_mix_f32 v225, v97, v97, v225 op_sel_hi:[1,1,0]
v_fma_mix_f32 v225, v98, v98, v225 op_sel_hi:[1,1,0]
v_fma_mix_f32 v225, v99, v99, v225 op_sel_hi:[1,1,0]
v_cvt_pkrtz_f16_f32 v113, v112, v113
v_and_b32 v113, s49, v113
v_bfe_u32 v112, v113, 2, 14
v_lshrrev_b32_e64 v113, 18, v113
ds_read_u16 v112, v112
ds_read_u16 v113, v113
v_cvt_pk_f16_f32 v122, v122, v123
v_cvt_pk_f16_f32 v124, v124, v125
v_cvt_pk_f16_f32 v126, v126, v127
v_mfma_f32_32x32x16_bf16 v[144:159], v[84:87], v[188:191], v[144:159]
v_pk_fma_f16 v123, v122, v122, s48
v_fma_mix_f32 v225, v100, v100, v225 op_sel_hi:[1,1,0]
v_fma_mix_f32 v225, v101, v101, v225 op_sel_hi:[1,1,0]
v_pk_fma_f16 v125, v124, v124, s48
ds_read_b128 v[184:187], v250 offset:18432
v_cvt_pkrtz_f16_f32 v115, v114, v115
v_and_b32_e64 v115, s49, v115
v_bfe_u32 v114, v115, 2, 14
v_lshrrev_b32 v115, 18, v115
ds_read_u16 v114, v114
ds_read_u16 v115, v115
v_pk_fma_f16 v127, v126, v126, s48
v_pk_mul_f16 v123, v122, v123
v_pk_mul_f16 v125, v124, v125
v_fma_mix_f32 v225, v102, v102, v225 op_sel_hi:[1,1,0]
s_waitcnt lgkmcnt(7)
v_fma_mix_f32 v225, v103, v103, v225 op_sel_hi:[1,1,0]
v_pk_mul_f16 v127, v126, v127
s_getpc_b64 s[74:75]
Lcq5:
s_lshl_b32 s43, s40, 10
s_add_u32 s43, s43, 6144
s_min_u32 s43, s43, Lend-Lcq5-1024
s_add_u32 s74, s74, s43
s_addc_u32 s75, s75, 0
s_sub_u32 s74, s74, 16384
s_subb_u32 s75, s75, 0
s_mov_b32 m0, 163840
s_nop 0
global_load_lds_dword v250, s[74:75]
v_exp_f16_sdwa v123, v123 dst_sel:WORD_0 dst_unused:UNUSED_PRESERVE src0_sel:WORD_0
v_cvt_pkrtz_f16_f32 v117, v116, v117
v_and_b32_e64 v117, s49, v117
v_bfe_u32 v116, v117, 2, 14
v_lshrrev_b32_e64 v117, 18, v117
ds_read_u16 v116, v116
ds_read_u16 v117, v117
v_mfma_f32_32x32x16_bf16 v[128:143], v[64:67], v[176:179], v[128:143]
v_exp_f16_sdwa v125, v125 dst_sel:WORD_0 dst_unused:UNUSED_PRESERVE src0_sel:WORD_0
v_fma_mix_f32 v225, v104, v104, v225 op_sel_hi:[1,1,0]
v_fma_mix_f32 v225, v105, v105, v225 op_sel_hi:[1,1,0]
v_exp_f16_sdwa v127, v127 dst_sel:WORD_0 dst_unused:UNUSED_PRESERVE src0_sel:WORD_0
v_cvt_pkrtz_f16_f32 v119, v118, v119
v_and_b32_e64 v119, s49, v119
v_bfe_u32 v118, v119, 2, 14
v_lshrrev_b32 v119, 18, v119
ds_read_u16 v118, v118
ds_read_u16 v119, v119
v_exp_f16_sdwa v123, v123 dst_sel:WORD_1 dst_unused:UNUSED_PRESERVE src0_sel:WORD_1
v_fma_mix_f32 v225, v106, v106, v225 op_sel_hi:[1,1,0]
s_waitcnt lgkmcnt(6)
v_fma_mix_f32 v225, v107, v107, v225 op_sel_hi:[1,1,0]
v_exp_f16_sdwa v125, v125 dst_sel:WORD_1 dst_unused:UNUSED_PRESERVE src0_sel:WORD_1
v_mfma_f32_32x32x16_bf16 v[144:159], v[88:91], v[176:179], v[144:159]
v_exp_f16_sdwa v127, v127 dst_sel:WORD_1 dst_unused:UNUSED_PRESERVE src0_sel:WORD_1
ds_read_b128 v[188:191], v250 offset:19456
v_cvt_pkrtz_f16_f32 v121, v120, v121
v_and_b32_e64 v121, s49, v121
v_bfe_u32 v120, v121, 2, 14
v_lshrrev_b32_e64 v121, 18, v121
ds_read_u16 v120, v120
ds_read_u16 v121, v121
v_pk_add_f16 v123, v123, 1.0 op_sel_hi:[1,0]
v_pk_add_f16 v125, v125, 1.0 op_sel_hi:[1,0]
v_pk_add_f16 v127, v127, 1.0 op_sel_hi:[1,0]
v_rcp_f16_sdwa v123, v123 dst_sel:WORD_0 dst_unused:UNUSED_PRESERVE src0_sel:WORD_0
v_mfma_f32_32x32x16_bf16 v[128:143], v[68:71], v[180:183], v[128:143]
v_rcp_f16_sdwa v125, v125 dst_sel:WORD_0 dst_unused:UNUSED_PRESERVE src0_sel:WORD_0
v_rcp_f16_sdwa v127, v127 dst_sel:WORD_0 dst_unused:UNUSED_PRESERVE src0_sel:WORD_0
v_rcp_f16_sdwa v123, v123 dst_sel:WORD_1 dst_unused:UNUSED_PRESERVE src0_sel:WORD_1
v_rcp_f16_sdwa v125, v125 dst_sel:WORD_1 dst_unused:UNUSED_PRESERVE src0_sel:WORD_1
v_mfma_f32_32x32x16_bf16 v[144:159], v[92:95], v[180:183], v[144:159]
v_rcp_f16_sdwa v127, v127 dst_sel:WORD_1 dst_unused:UNUSED_PRESERVE src0_sel:WORD_1
ds_read_b128 v[176:179], v250 offset:20480
v_pk_mul_f16 v122, v122, v123
v_pk_mul_f16 v124, v124, v125
v_pk_mul_f16 v126, v126, v127
v_fma_mix_f32 v225, v122, v122, v225 op_sel_hi:[1,1,0]
v_fma_mix_f32 v225, v124, v124, v225 op_sel_hi:[1,1,0]
v_mfma_f32_32x32x16_bf16 v[160:175], v[48:51], v[184:187], 0
v_fma_mix_f32 v225, v126, v126, v225 op_sel_hi:[1,1,0]
v_fma_mix_f32 v225, v122, v122, v225 op_sel:[1,1,0] op_sel_hi:[1,1,0]
v_fma_mix_f32 v225, v124, v124, v225 op_sel:[1,1,0] op_sel_hi:[1,1,0]
v_fma_mix_f32 v225, v126, v126, v225 op_sel:[1,1,0] op_sel_hi:[1,1,0]
v_fma_mix_f32 v225, v112, v112, v225 op_sel_hi:[1,1,0]
v_fma_mix_f32 v225, v113, v113, v225 op_sel_hi:[1,1,0]
v_cvt_pkrtz_f16_f32 v129, v128, v129
v_and_b32_e64 v129, s49, v129
v_bfe_u32 v128, v129, 2, 14
v_lshrrev_b32 v129, 18, v129
ds_read_u16 v128, v128
ds_read_u16 v129, v129
v_cvt_pk_f16_f32 v140, v140, v141
s_waitcnt lgkmcnt(4)
v_fma_mix_f32 v225, v114, v114, v225 op_sel_hi:[1,1,0]
v_fma_mix_f32 v225, v115, v115, v225 op_sel_hi:[1,1,0]
v_cvt_pk_f16_f32 v142, v142, v143
v_mfma_f32_32x32x16_bf16 v[96:111], v[72:75], v[184:187], 0
v_pk_fma_f16 v141, v140, v140, s48
v_cvt_pkrtz_f16_f32 v131, v130, v131
v_and_b32_e64 v131, s49, v131
v_bfe_u32 v130, v131, 2, 14
v_lshrrev_b32_e64 v131, 18, v131
ds_read_u16 v130, v130
ds_read_u16 v131, v131
v_pk_fma_f16 v143, v142, v142, s48
ds_read_b128 v[180:183], v250 offset:21504
v_fma_mix_f32 v225, v116, v116, v225 op_sel_hi:[1,1,0]
v_fma_mix_f32 v225, v117, v117, v225 op_sel_hi:[1,1,0]
v_pk_mul_f16 v141, v140, v141
v_pk_mul_f16 v143, v142, v143
v_cvt_pkrtz_f16_f32 v133, v132, v133
v_and_b32_e64 v133, s49, v133
v_bfe_u32 v132, v133, 2, 14
v_lshrrev_b32_e64 v133, 18, v133
ds_read_u16 v132, v132
ds_read_u16 v133, v133
v_exp_f16_sdwa v141, v141 dst_sel:WORD_0 dst_unused:UNUSED_PRESERVE src0_sel:WORD_0
v_fma_mix_f32 v225, v118, v118, v225 op_sel_hi:[1,1,0]
v_fma_mix_f32 v225, v119, v119, v225 op_sel_hi:[1,1,0]
v_mfma_f32_32x32x16_bf16 v[160:175], v[52:55], v[188:191], v[160:175]
v_exp_f16_sdwa v143, v143 dst_sel:WORD_0 dst_unused:UNUSED_PRESERVE src0_sel:WORD_0
v_cvt_pkrtz_f16_f32 v135, v134, v135
v_and_b32_e64 v135, s49, v135
v_bfe_u32 v134, v135, 2, 14
v_lshrrev_b32_e64 v135, 18, v135
ds_read_u16 v134, v134
ds_read_u16 v135, v135
v_exp_f16_sdwa v141, v141 dst_sel:WORD_1 dst_unused:UNUSED_PRESERVE src0_sel:WORD_1
v_fma_mix_f32 v225, v120, v120, v225 op_sel_hi:[1,1,0]
s_waitcnt lgkmcnt(7)
v_fma_mix_f32 v225, v121, v121, v225 op_sel_hi:[1,1,0]
v_cvt_pkrtz_f16_f32 v137, v136, v137
v_and_b32 v137, s49, v137
v_bfe_u32 v136, v137, 2, 14
v_lshrrev_b32_e64 v137, 18, v137
ds_read_u16 v136, v136
ds_read_u16 v137, v137
v_mfma_f32_32x32x16_bf16 v[96:111], v[76:79], v[188:191], v[96:111]
v_exp_f16_sdwa v143, v143 dst_sel:WORD_1 dst_unused:UNUSED_PRESERVE src0_sel:WORD_1
ds_read_b128 v[184:187], v250 offset:22528
v_cvt_pkrtz_f16_f32 v139, v138, v139
v_and_b32_e64 v139, s49, v139
v_bfe_u32 v138, v139, 2, 14
v_lshrrev_b32_e64 v139, 18, v139
ds_read_u16 v138, v138
ds_read_u16 v139, v139
v_pk_add_f16 v141, v141, 1.0 op_sel_hi:[1,0]
v_pk_add_f16 v143, v143, 1.0 op_sel_hi:[1,0]
v_rcp_f16_sdwa v141, v141 dst_sel:WORD_0 dst_unused:UNUSED_PRESERVE src0_sel:WORD_0
v_mfma_f32_32x32x16_bf16 v[160:175], v[56:59], v[176:179], v[160:175]
v_rcp_f16_sdwa v143, v143 dst_sel:WORD_0 dst_unused:UNUSED_PRESERVE src0_sel:WORD_0
v_rcp_f16_sdwa v141, v141 dst_sel:WORD_1 dst_unused:UNUSED_PRESERVE src0_sel:WORD_1
v_mfma_f32_32x32x16_bf16 v[96:111], v[80:83], v[176:179], v[96:111]
v_rcp_f16_sdwa v143, v143 dst_sel:WORD_1 dst_unused:UNUSED_PRESERVE src0_sel:WORD_1
ds_read_b128 v[188:191], v250 offset:23552
v_pk_mul_f16 v140, v140, v141
v_pk_mul_f16 v142, v142, v143
v_fma_mix_f32 v226, v140, v140, v226 op_sel_hi:[1,1,0]
v_fma_mix_f32 v226, v142, v142, v226 op_sel_hi:[1,1,0]
s_waitcnt lgkmcnt(7)
v_mfma_f32_32x32x16_bf16 v[160:175], v[60:63], v[180:183], v[160:175]
v_fma_mix_f32 v226, v140, v140, v226 op_sel:[1,1,0] op_sel_hi:[1,1,0]
v_fma_mix_f32 v226, v142, v142, v226 op_sel:[1,1,0] op_sel_hi:[1,1,0]
v_fma_mix_f32 v226, v128, v128, v226 op_sel_hi:[1,1,0]
v_fma_mix_f32 v226, v129, v129, v226 op_sel_hi:[1,1,0]
v_fma_mix_f32 v226, v130, v130, v226 op_sel_hi:[1,1,0]
v_fma_mix_f32 v226, v131, v131, v226 op_sel_hi:[1,1,0]
v_cvt_pkrtz_f16_f32 v145, v144, v145
v_and_b32 v145, s49, v145
v_bfe_u32 v144, v145, 2, 14
v_lshrrev_b32_e64 v145, 18, v145
ds_read_u16 v144, v144
ds_read_u16 v145, v145
v_cvt_pk_f16_f32 v154, v154, v155
v_cvt_pk_f16_f32 v156, v156, v157
v_cvt_pk_f16_f32 v158, v158, v159
v_mfma_f32_32x32x16_bf16 v[96:111], v[84:87], v[180:183], v[96:111]
v_pk_fma_f16 v155, v154, v154, s48
v_fma_mix_f32 v226, v132, v132, v226 op_sel_hi:[1,1,0]
v_fma_mix_f32 v226, v133, v133, v226 op_sel_hi:[1,1,0]
v_pk_fma_f16 v157, v156, v156, s48
ds_read_b128 v[176:179], v250 offset:24576
v_cvt_pkrtz_f16_f32 v147, v146, v147
v_and_b32_e64 v147, s49, v147
v_bfe_u32 v146, v147, 2, 14
v_lshrrev_b32_e64 v147, 18, v147
ds_read_u16 v146, v146
ds_read_u16 v147, v147
v_pk_fma_f16 v159, v158, v158, s48
v_pk_mul_f16 v155, v154, v155
v_pk_mul_f16 v157, v156, v157
v_fma_mix_f32 v226, v134, v134, v226 op_sel_hi:[1,1,0]
s_waitcnt lgkmcnt(7)
v_fma_mix_f32 v226, v135, v135, v226 op_sel_hi:[1,1,0]
v_pk_mul_f16 v159, v158, v159
v_exp_f16_sdwa v155, v155 dst_sel:WORD_0 dst_unused:UNUSED_PRESERVE src0_sel:WORD_0
v_cvt_pkrtz_f16_f32 v149, v148, v149
v_and_b32 v149, s49, v149
v_bfe_u32 v148, v149, 2, 14
v_lshrrev_b32_e64 v149, 18, v149
ds_read_u16 v148, v148
ds_read_u16 v149, v149
v_mfma_f32_32x32x16_bf16 v[160:175], v[64:67], v[184:187], v[160:175]
v_exp_f16_sdwa v157, v157 dst_sel:WORD_0 dst_unused:UNUSED_PRESERVE src0_sel:WORD_0
v_fma_mix_f32 v226, v136, v136, v226 op_sel_hi:[1,1,0]
v_fma_mix_f32 v226, v137, v137, v226 op_sel_hi:[1,1,0]
v_exp_f16_sdwa v159, v159 dst_sel:WORD_0 dst_unused:UNUSED_PRESERVE src0_sel:WORD_0
v_cvt_pkrtz_f16_f32 v151, v150, v151
v_and_b32_e64 v151, s49, v151
v_bfe_u32 v150, v151, 2, 14
v_lshrrev_b32 v151, 18, v151
ds_read_u16 v150, v150
ds_read_u16 v151, v151
v_exp_f16_sdwa v155, v155 dst_sel:WORD_1 dst_unused:UNUSED_PRESERVE src0_sel:WORD_1
v_fma_mix_f32 v226, v138, v138, v226 op_sel_hi:[1,1,0]
s_waitcnt lgkmcnt(6)
v_fma_mix_f32 v226, v139, v139, v226 op_sel_hi:[1,1,0]
v_exp_f16_sdwa v157, v157 dst_sel:WORD_1 dst_unused:UNUSED_PRESERVE src0_sel:WORD_1
v_mfma_f32_32x32x16_bf16 v[96:111], v[88:91], v[184:187], v[96:111]
v_exp_f16_sdwa v159, v159 dst_sel:WORD_1 dst_unused:UNUSED_PRESERVE src0_sel:WORD_1
ds_read_b128 v[180:183], v250 offset:25600
v_cvt_pkrtz_f16_f32 v153, v152, v153
v_and_b32_e64 v153, s49, v153
v_bfe_u32 v152, v153, 2, 14
v_lshrrev_b32_e64 v153, 18, v153
ds_read_u16 v152, v152
ds_read_u16 v153, v153
v_pk_add_f16 v155, v155, 1.0 op_sel_hi:[1,0]
v_pk_add_f16 v157, v157, 1.0 op_sel_hi:[1,0]
v_pk_add_f16 v159, v159, 1.0 op_sel_hi:[1,0]
v_rcp_f16_sdwa v155, v155 dst_sel:WORD_0 dst_unused:UNUSED_PRESERVE src0_sel:WORD_0
v_mfma_f32_32x32x16_bf16 v[160:175], v[68:71], v[188:191], v[160:175]
v_rcp_f16_sdwa v157, v157 dst_sel:WORD_0 dst_unused:UNUSED_PRESERVE src0_sel:WORD_0
v_rcp_f16_sdwa v159, v159 dst_sel:WORD_0 dst_unused:UNUSED_PRESERVE src0_sel:WORD_0
v_rcp_f16_sdwa v155, v155 dst_sel:WORD_1 dst_unused:UNUSED_PRESERVE src0_sel:WORD_1
v_rcp_f16_sdwa v157, v157 dst_sel:WORD_1 dst_unused:UNUSED_PRESERVE src0_sel:WORD_1
v_mfma_f32_32x32x16_bf16 v[96:111], v[92:95], v[188:191], v[96:111]
v_rcp_f16_sdwa v159, v159 dst_sel:WORD_1 dst_unused:UNUSED_PRESERVE src0_sel:WORD_1
ds_read_b128 v[184:187], v250 offset:26624
v_pk_mul_f16 v154, v154, v155
v_pk_mul_f16 v156, v156, v157
v_pk_mul_f16 v158, v158, v159
v_fma_mix_f32 v226, v154, v154, v226 op_sel_hi:[1,1,0]
v_fma_mix_f32 v226, v156, v156, v226 op_sel_hi:[1,1,0]
v_mfma_f32_32x32x16_bf16 v[112:127], v[48:51], v[176:179], 0
v_fma_mix_f32 v226, v158, v158, v226 op_sel_hi:[1,1,0]
v_fma_mix_f32 v226, v154, v154, v226 op_sel:[1,1,0] op_sel_hi:[1,1,0]
v_fma_mix_f32 v226, v156, v156, v226 op_sel:[1,1,0] op_sel_hi:[1,1,0]
v_fma_mix_f32 v226, v158, v158, v226 op_sel:[1,1,0] op_sel_hi:[1,1,0]
v_fma_mix_f32 v226, v144, v144, v226 op_sel_hi:[1,1,0]
v_fma_mix_f32 v226, v145, v145, v226 op_sel_hi:[1,1,0]
v_cvt_pkrtz_f16_f32 v161, v160, v161
v_and_b32_e64 v161, s49, v161
v_bfe_u32 v160, v161, 2, 14
v_lshrrev_b32 v161, 18, v161
ds_read_u16 v160, v160
ds_read_u16 v161, v161
v_cvt_pk_f16_f32 v172, v172, v173
s_waitcnt lgkmcnt(4)
v_fma_mix_f32 v226, v146, v146, v226 op_sel_hi:[1,1,0]
v_fma_mix_f32 v226, v147, v147, v226 op_sel_hi:[1,1,0]
v_cvt_pk_f16_f32 v174, v174, v175
v_mfma_f32_32x32x16_bf16 v[128:143], v[72:75], v[176:179], 0
v_pk_fma_f16 v173, v172, v172, s48
v_cvt_pkrtz_f16_f32 v163, v162, v163
v_and_b32_e64 v163, s49, v163
v_bfe_u32 v162, v163, 2, 14
v_lshrrev_b32_e64 v163, 18, v163
ds_read_u16 v162, v162
ds_read_u16 v163, v163
v_pk_fma_f16 v175, v174, v174, s48
ds_read_b128 v[188:191], v250 offset:27648
v_fma_mix_f32 v226, v148, v148, v226 op_sel_hi:[1,1,0]
v_fma_mix_f32 v226, v149, v149, v226 op_sel_hi:[1,1,0]
v_pk_mul_f16 v173, v172, v173
v_pk_mul_f16 v175, v174, v175
v_cvt_pkrtz_f16_f32 v165, v164, v165
v_and_b32_e64 v165, s49, v165
v_bfe_u32 v164, v165, 2, 14
v_lshrrev_b32_e64 v165, 18, v165
ds_read_u16 v164, v164
ds_read_u16 v165, v165
v_exp_f16_sdwa v173, v173 dst_sel:WORD_0 dst_unused:UNUSED_PRESERVE src0_sel:WORD_0
v_fma_mix_f32 v226, v150, v150, v226 op_sel_hi:[1,1,0]
v_fma_mix_f32 v226, v151, v151, v226 op_sel_hi:[1,1,0]
v_mfma_f32_32x32x16_bf16 v[112:127], v[52:55], v[180:183], v[112:127]
v_exp_f16_sdwa v175, v175 dst_sel:WORD_0 dst_unused:UNUSED_PRESERVE src0_sel:WORD_0
v_cvt_pkrtz_f16_f32 v167, v166, v167
v_and_b32_e64 v167, s49, v167
v_bfe_u32 v166, v167, 2, 14
v_lshrrev_b32_e64 v167, 18, v167
ds_read_u16 v166, v166
ds_read_u16 v167, v167
v_exp_f16_sdwa v173, v173 dst_sel:WORD_1 dst_unused:UNUSED_PRESERVE src0_sel:WORD_1
v_fma_mix_f32 v226, v152, v152, v226 op_sel_hi:[1,1,0]
s_waitcnt lgkmcnt(7)
v_fma_mix_f32 v226, v153, v153, v226 op_sel_hi:[1,1,0]
v_cvt_pkrtz_f16_f32 v169, v168, v169
v_and_b32 v169, s49, v169
v_bfe_u32 v168, v169, 2, 14
v_lshrrev_b32_e64 v169, 18, v169
ds_read_u16 v168, v168
ds_read_u16 v169, v169
v_mfma_f32_32x32x16_bf16 v[128:143], v[76:79], v[180:183], v[128:143]
v_exp_f16_sdwa v175, v175 dst_sel:WORD_1 dst_unused:UNUSED_PRESERVE src0_sel:WORD_1
ds_read_b128 v[176:179], v250 offset:28672
v_cvt_pkrtz_f16_f32 v171, v170, v171
v_and_b32_e64 v171, s49, v171
v_bfe_u32 v170, v171, 2, 14
v_lshrrev_b32_e64 v171, 18, v171
ds_read_u16 v170, v170
ds_read_u16 v171, v171
v_pk_add_f16 v173, v173, 1.0 op_sel_hi:[1,0]
v_pk_add_f16 v175, v175, 1.0 op_sel_hi:[1,0]
v_rcp_f16_sdwa v173, v173 dst_sel:WORD_0 dst_unused:UNUSED_PRESERVE src0_sel:WORD_0
v_mfma_f32_32x32x16_bf16 v[112:127], v[56:59], v[184:187], v[112:127]
v_rcp_f16_sdwa v175, v175 dst_sel:WORD_0 dst_unused:UNUSED_PRESERVE src0_sel:WORD_0
v_rcp_f16_sdwa v173, v173 dst_sel:WORD_1 dst_unused:UNUSED_PRESERVE src0_sel:WORD_1
v_mfma_f32_32x32x16_bf16 v[128:143], v[80:83], v[184:187], v[128:143]
v_rcp_f16_sdwa v175, v175 dst_sel:WORD_1 dst_unused:UNUSED_PRESERVE src0_sel:WORD_1
ds_read_b128 v[180:183], v250 offset:29696
v_pk_mul_f16 v172, v172, v173
v_pk_mul_f16 v174, v174, v175
v_fma_mix_f32 v227, v172, v172, v227 op_sel_hi:[1,1,0]
v_fma_mix_f32 v227, v174, v174, v227 op_sel_hi:[1,1,0]
s_waitcnt lgkmcnt(7)
v_mfma_f32_32x32x16_bf16 v[112:127], v[60:63], v[188:191], v[112:127]
v_fma_mix_f32 v227, v172, v172, v227 op_sel:[1,1,0] op_sel_hi:[1,1,0]
v_fma_mix_f32 v227, v174, v174, v227 op_sel:[1,1,0] op_sel_hi:[1,1,0]
v_fma_mix_f32 v227, v160, v160, v227 op_sel_hi:[1,1,0]
v_fma_mix_f32 v227, v161, v161, v227 op_sel_hi:[1,1,0]
v_fma_mix_f32 v227, v162, v162, v227 op_sel_hi:[1,1,0]
v_fma_mix_f32 v227, v163, v163, v227 op_sel_hi:[1,1,0]
v_cvt_pkrtz_f16_f32 v97, v96, v97
v_and_b32 v97, s49, v97
v_bfe_u32 v96, v97, 2, 14
v_lshrrev_b32_e64 v97, 18, v97
ds_read_u16 v96, v96
ds_read_u16 v97, v97
v_cvt_pk_f16_f32 v106, v106, v107
v_cvt_pk_f16_f32 v108, v108, v109
v_cvt_pk_f16_f32 v110, v110, v111
v_mfma_f32_32x32x16_bf16 v[128:143], v[84:87], v[188:191], v[128:143]
v_pk_fma_f16 v107, v106, v106, s48
v_fma_mix_f32 v227, v164, v164, v227 op_sel_hi:[1,1,0]
v_fma_mix_f32 v227, v165, v165, v227 op_sel_hi:[1,1,0]
v_pk_fma_f16 v109, v108, v108, s48
ds_read_b128 v[184:187], v250 offset:30720
v_cvt_pkrtz_f16_f32 v99, v98, v99
v_and_b32_e64 v99, s49, v99
v_bfe_u32 v98, v99, 2, 14
v_lshrrev_b32_e64 v99, 18, v99
ds_read_u16 v98, v98
ds_read_u16 v99, v99
v_pk_fma_f16 v111, v110, v110, s48
v_pk_mul_f16 v107, v106, v107
v_pk_mul_f16 v109, v108, v109
v_fma_mix_f32 v227, v166, v166, v227 op_sel_hi:[1,1,0]
s_waitcnt lgkmcnt(7)
v_fma_mix_f32 v227, v167, v167, v227 op_sel_hi:[1,1,0]
v_pk_mul_f16 v111, v110, v111
v_exp_f16_sdwa v107, v107 dst_sel:WORD_0 dst_unused:UNUSED_PRESERVE src0_sel:WORD_0
v_cvt_pkrtz_f16_f32 v101, v100, v101
v_and_b32 v101, s49, v101
v_bfe_u32 v100, v101, 2, 14
v_lshrrev_b32_e64 v101, 18, v101
ds_read_u16 v100, v100
ds_read_u16 v101, v101
v_mfma_f32_32x32x16_bf16 v[112:127], v[64:67], v[176:179], v[112:127]
v_exp_f16_sdwa v109, v109 dst_sel:WORD_0 dst_unused:UNUSED_PRESERVE src0_sel:WORD_0
v_fma_mix_f32 v227, v168, v168, v227 op_sel_hi:[1,1,0]
v_fma_mix_f32 v227, v169, v169, v227 op_sel_hi:[1,1,0]
v_exp_f16_sdwa v111, v111 dst_sel:WORD_0 dst_unused:UNUSED_PRESERVE src0_sel:WORD_0
v_cvt_pkrtz_f16_f32 v103, v102, v103
v_and_b32_e64 v103, s49, v103
v_bfe_u32 v102, v103, 2, 14
v_lshrrev_b32 v103, 18, v103
ds_read_u16 v102, v102
ds_read_u16 v103, v103
v_exp_f16_sdwa v107, v107 dst_sel:WORD_1 dst_unused:UNUSED_PRESERVE src0_sel:WORD_1
v_fma_mix_f32 v227, v170, v170, v227 op_sel_hi:[1,1,0]
s_waitcnt lgkmcnt(6)
v_fma_mix_f32 v227, v171, v171, v227 op_sel_hi:[1,1,0]
v_exp_f16_sdwa v109, v109 dst_sel:WORD_1 dst_unused:UNUSED_PRESERVE src0_sel:WORD_1
v_mfma_f32_32x32x16_bf16 v[128:143], v[88:91], v[176:179], v[128:143]
v_exp_f16_sdwa v111, v111 dst_sel:WORD_1 dst_unused:UNUSED_PRESERVE src0_sel:WORD_1
ds_read_b128 v[188:191], v250 offset:31744
v_cvt_pkrtz_f16_f32 v105, v104, v105
v_and_b32_e64 v105, s49, v105
v_bfe_u32 v104, v105, 2, 14
v_lshrrev_b32_e64 v105, 18, v105
ds_read_u16 v104, v104
ds_read_u16 v105, v105
v_pk_add_f16 v107, v107, 1.0 op_sel_hi:[1,0]
v_pk_add_f16 v109, v109, 1.0 op_sel_hi:[1,0]
v_pk_add_f16 v111, v111, 1.0 op_sel_hi:[1,0]
v_rcp_f16_sdwa v107, v107 dst_sel:WORD_0 dst_unused:UNUSED_PRESERVE src0_sel:WORD_0
v_mfma_f32_32x32x16_bf16 v[112:127], v[68:71], v[180:183], v[112:127]
v_rcp_f16_sdwa v109, v109 dst_sel:WORD_0 dst_unused:UNUSED_PRESERVE src0_sel:WORD_0
v_rcp_f16_sdwa v111, v111 dst_sel:WORD_0 dst_unused:UNUSED_PRESERVE src0_sel:WORD_0
v_rcp_f16_sdwa v107, v107 dst_sel:WORD_1 dst_unused:UNUSED_PRESERVE src0_sel:WORD_1
v_rcp_f16_sdwa v109, v109 dst_sel:WORD_1 dst_unused:UNUSED_PRESERVE src0_sel:WORD_1
v_mfma_f32_32x32x16_bf16 v[128:143], v[92:95], v[180:183], v[128:143]
v_rcp_f16_sdwa v111, v111 dst_sel:WORD_1 dst_unused:UNUSED_PRESERVE src0_sel:WORD_1
ds_read_b128 v[176:179], v250 offset:32768
v_pk_mul_f16 v106, v106, v107
v_pk_mul_f16 v108, v108, v109
v_pk_mul_f16 v110, v110, v111
v_fma_mix_f32 v227, v106, v106, v227 op_sel_hi:[1,1,0]
v_fma_mix_f32 v227, v108, v108, v227 op_sel_hi:[1,1,0]
v_mfma_f32_32x32x16_bf16 v[144:159], v[48:51], v[184:187], 0
v_fma_mix_f32 v227, v110, v110, v227 op_sel_hi:[1,1,0]
v_fma_mix_f32 v227, v106, v106, v227 op_sel:[1,1,0] op_sel_hi:[1,1,0]
v_fma_mix_f32 v227, v108, v108, v227 op_sel:[1,1,0] op_sel_hi:[1,1,0]
v_fma_mix_f32 v227, v110, v110, v227 op_sel:[1,1,0] op_sel_hi:[1,1,0]
v_fma_mix_f32 v227, v96, v96, v227 op_sel_hi:[1,1,0]
v_fma_mix_f32 v227, v97, v97, v227 op_sel_hi:[1,1,0]
v_cvt_pkrtz_f16_f32 v113, v112, v113
v_and_b32_e64 v113, s49, v113
v_bfe_u32 v112, v113, 2, 14
v_lshrrev_b32 v113, 18, v113
ds_read_u16 v112, v112
ds_read_u16 v113, v113
v_cvt_pk_f16_f32 v124, v124, v125
s_waitcnt lgkmcnt(4)
v_fma_mix_f32 v227, v98, v98, v227 op_sel_hi:[1,1,0]
v_fma_mix_f32 v227, v99, v99, v227 op_sel_hi:[1,1,0]
v_cvt_pk_f16_f32 v126, v126, v127
v_mfma_f32_32x32x16_bf16 v[160:175], v[72:75], v[184:187], 0
v_pk_fma_f16 v125, v124, v124, s48
v_cvt_pkrtz_f16_f32 v115, v114, v115
v_and_b32_e64 v115, s49, v115
v_bfe_u32 v114, v115, 2, 14
v_lshrrev_b32_e64 v115, 18, v115
ds_read_u16 v114, v114
ds_read_u16 v115, v115
v_pk_fma_f16 v127, v126, v126, s48
ds_read_b128 v[180:183], v250 offset:33792
v_fma_mix_f32 v227, v100, v100, v227 op_sel_hi:[1,1,0]
v_fma_mix_f32 v227, v101, v101, v227 op_sel_hi:[1,1,0]
v_pk_mul_f16 v125, v124, v125
v_pk_mul_f16 v127, v126, v127
v_cvt_pkrtz_f16_f32 v117, v116, v117
v_and_b32_e64 v117, s49, v117
v_bfe_u32 v116, v117, 2, 14
v_lshrrev_b32_e64 v117, 18, v117
ds_read_u16 v116, v116
ds_read_u16 v117, v117
v_exp_f16_sdwa v125, v125 dst_sel:WORD_0 dst_unused:UNUSED_PRESERVE src0_sel:WORD_0
v_fma_mix_f32 v227, v102, v102, v227 op_sel_hi:[1,1,0]
v_fma_mix_f32 v227, v103, v103, v227 op_sel_hi:[1,1,0]
v_mfma_f32_32x32x16_bf16 v[144:159], v[52:55], v[188:191], v[144:159]
v_exp_f16_sdwa v127, v127 dst_sel:WORD_0 dst_unused:UNUSED_PRESERVE src0_sel:WORD_0
v_cvt_pkrtz_f16_f32 v119, v118, v119
v_and_b32_e64 v119, s49, v119
v_bfe_u32 v118, v119, 2, 14
v_lshrrev_b32_e64 v119, 18, v119
ds_read_u16 v118, v118
ds_read_u16 v119, v119
v_exp_f16_sdwa v125, v125 dst_sel:WORD_1 dst_unused:UNUSED_PRESERVE src0_sel:WORD_1
v_fma_mix_f32 v227, v104, v104, v227 op_sel_hi:[1,1,0]
s_waitcnt lgkmcnt(7)
v_fma_mix_f32 v227, v105, v105, v227 op_sel_hi:[1,1,0]
v_cvt_pkrtz_f16_f32 v121, v120, v121
v_and_b32 v121, s49, v121
v_bfe_u32 v120, v121, 2, 14
v_lshrrev_b32_e64 v121, 18, v121
ds_read_u16 v120, v120
ds_read_u16 v121, v121
v_mfma_f32_32x32x16_bf16 v[160:175], v[76:79], v[188:191], v[160:175]
v_exp_f16_sdwa v127, v127 dst_sel:WORD_1 dst_unused:UNUSED_PRESERVE src0_sel:WORD_1
ds_read_b128 v[184:187], v250 offset:34816
v_cvt_pkrtz_f16_f32 v123, v122, v123
v_and_b32_e64 v123, s49, v123
v_bfe_u32 v122, v123, 2, 14
v_lshrrev_b32_e64 v123, 18, v123
ds_read_u16 v122, v122
ds_read_u16 v123, v123
v_pk_add_f16 v125, v125, 1.0 op_sel_hi:[1,0]
v_pk_add_f16 v127, v127, 1.0 op_sel_hi:[1,0]
v_rcp_f16_sdwa v125, v125 dst_sel:WORD_0 dst_unused:UNUSED_PRESERVE src0_sel:WORD_0
v_mfma_f32_32x32x16_bf16 v[144:159], v[56:59], v[176:179], v[144:159]
v_rcp_f16_sdwa v127, v127 dst_sel:WORD_0 dst_unused:UNUSED_PRESERVE src0_sel:WORD_0
v_rcp_f16_sdwa v125, v125 dst_sel:WORD_1 dst_unused:UNUSED_PRESERVE src0_sel:WORD_1
v_mfma_f32_32x32x16_bf16 v[160:175], v[80:83], v[176:179], v[160:175]
v_rcp_f16_sdwa v127, v127 dst_sel:WORD_1 dst_unused:UNUSED_PRESERVE src0_sel:WORD_1
ds_read_b128 v[188:191], v250 offset:35840
v_pk_mul_f16 v124, v124, v125
v_pk_mul_f16 v126, v126, v127
v_fma_mix_f32 v228, v124, v124, v228 op_sel_hi:[1,1,0]
v_fma_mix_f32 v228, v126, v126, v228 op_sel_hi:[1,1,0]
s_waitcnt lgkmcnt(7)
v_mfma_f32_32x32x16_bf16 v[144:159], v[60:63], v[180:183], v[144:159]
v_fma_mix_f32 v228, v124, v124, v228 op_sel:[1,1,0] op_sel_hi:[1,1,0]
v_fma_mix_f32 v228, v126, v126, v228 op_sel:[1,1,0] op_sel_hi:[1,1,0]
v_fma_mix_f32 v228, v112, v112, v228 op_sel_hi:[1,1,0]
v_fma_mix_f32 v228, v113, v113, v228 op_sel_hi:[1,1,0]
v_fma_mix_f32 v228, v114, v114, v228 op_sel_hi:[1,1,0]
v_fma_mix_f32 v228, v115, v115, v228 op_sel_hi:[1,1,0]
v_cvt_pkrtz_f16_f32 v129, v128, v129
v_and_b32 v129, s49, v129
v_bfe_u32 v128, v129, 2, 14
v_lshrrev_b32_e64 v129, 18, v129
ds_read_u16 v128, v128
ds_read_u16 v129, v129
v_cvt_pk_f16_f32 v138, v138, v139
v_cvt_pk_f16_f32 v140, v140, v141
v_cvt_pk_f16_f32 v142, v142, v143
v_mfma_f32_32x32x16_bf16 v[160:175], v[84:87], v[180:183], v[160:175]
v_pk_fma_f16 v139, v138, v138, s48
v_fma_mix_f32 v228, v116, v116, v228 op_sel_hi:[1,1,0]
v_fma_mix_f32 v228, v117, v117, v228 op_sel_hi:[1,1,0]
v_pk_fma_f16 v141, v140, v140, s48
ds_read_b128 v[176:179], v250 offset:36864
v_cvt_pkrtz_f16_f32 v131, v130, v131
v_and_b32_e64 v131, s49, v131
v_bfe_u32 v130, v131, 2, 14
v_lshrrev_b32_e64 v131, 18, v131
ds_read_u16 v130, v130
ds_read_u16 v131, v131
v_pk_fma_f16 v143, v142, v142, s48
v_pk_mul_f16 v139, v138, v139
v_pk_mul_f16 v141, v140, v141
v_fma_mix_f32 v228, v118, v118, v228 op_sel_hi:[1,1,0]
s_waitcnt lgkmcnt(7)
v_fma_mix_f32 v228, v119, v119, v228 op_sel_hi:[1,1,0]
v_pk_mul_f16 v143, v142, v143
v_exp_f16_sdwa v139, v139 dst_sel:WORD_0 dst_unused:UNUSED_PRESERVE src0_sel:WORD_0
v_cvt_pkrtz_f16_f32 v133, v132, v133
v_and_b32 v133, s49, v133
v_bfe_u32 v132, v133, 2, 14
v_lshrrev_b32_e64 v133, 18, v133
ds_read_u16 v132, v132
ds_read_u16 v133, v133
v_mfma_f32_32x32x16_bf16 v[144:159], v[64:67], v[184:187], v[144:159]
v_exp_f16_sdwa v141, v141 dst_sel:WORD_0 dst_unused:UNUSED_PRESERVE src0_sel:WORD_0
v_fma_mix_f32 v228, v120, v120, v228 op_sel_hi:[1,1,0]
v_fma_mix_f32 v228, v121, v121, v228 op_sel_hi:[1,1,0]
v_exp_f16_sdwa v143, v143 dst_sel:WORD_0 dst_unused:UNUSED_PRESERVE src0_sel:WORD_0
v_cvt_pkrtz_f16_f32 v135, v134, v135
v_and_b32_e64 v135, s49, v135
v_bfe_u32 v134, v135, 2, 14
v_lshrrev_b32 v135, 18, v135
ds_read_u16 v134, v134
ds_read_u16 v135, v135
v_exp_f16_sdwa v139, v139 dst_sel:WORD_1 dst_unused:UNUSED_PRESERVE src0_sel:WORD_1
v_fma_mix_f32 v228, v122, v122, v228 op_sel_hi:[1,1,0]
s_waitcnt lgkmcnt(6)
v_fma_mix_f32 v228, v123, v123, v228 op_sel_hi:[1,1,0]
v_exp_f16_sdwa v141, v141 dst_sel:WORD_1 dst_unused:UNUSED_PRESERVE src0_sel:WORD_1
v_mfma_f32_32x32x16_bf16 v[160:175], v[88:91], v[184:187], v[160:175]
v_exp_f16_sdwa v143, v143 dst_sel:WORD_1 dst_unused:UNUSED_PRESERVE src0_sel:WORD_1
ds_read_b128 v[180:183], v250 offset:37888
v_cvt_pkrtz_f16_f32 v137, v136, v137
v_and_b32_e64 v137, s49, v137
v_bfe_u32 v136, v137, 2, 14
v_lshrrev_b32_e64 v137, 18, v137
ds_read_u16 v136, v136
ds_read_u16 v137, v137
v_pk_add_f16 v139, v139, 1.0 op_sel_hi:[1,0]
v_pk_add_f16 v141, v141, 1.0 op_sel_hi:[1,0]
v_pk_add_f16 v143, v143, 1.0 op_sel_hi:[1,0]
v_rcp_f16_sdwa v139, v139 dst_sel:WORD_0 dst_unused:UNUSED_PRESERVE src0_sel:WORD_0
v_mfma_f32_32x32x16_bf16 v[144:159], v[68:71], v[188:191], v[144:159]
v_rcp_f16_sdwa v141, v141 dst_sel:WORD_0 dst_unused:UNUSED_PRESERVE src0_sel:WORD_0
v_rcp_f16_sdwa v143, v143 dst_sel:WORD_0 dst_unused:UNUSED_PRESERVE src0_sel:WORD_0
v_rcp_f16_sdwa v139, v139 dst_sel:WORD_1 dst_unused:UNUSED_PRESERVE src0_sel:WORD_1
v_rcp_f16_sdwa v141, v141 dst_sel:WORD_1 dst_unused:UNUSED_PRESERVE src0_sel:WORD_1
v_mfma_f32_32x32x16_bf16 v[160:175], v[92:95], v[188:191], v[160:175]
v_rcp_f16_sdwa v143, v143 dst_sel:WORD_1 dst_unused:UNUSED_PRESERVE src0_sel:WORD_1
ds_read_b128 v[184:187], v250 offset:38912
v_pk_mul_f16 v138, v138, v139
v_pk_mul_f16 v140, v140, v141
v_pk_mul_f16 v142, v142, v143
v_fma_mix_f32 v228, v138, v138, v228 op_sel_hi:[1,1,0]
v_fma_mix_f32 v228, v140, v140, v228 op_sel_hi:[1,1,0]
v_mfma_f32_32x32x16_bf16 v[96:111], v[48:51], v[176:179], 0
v_fma_mix_f32 v228, v142, v142, v228 op_sel_hi:[1,1,0]
v_fma_mix_f32 v228, v138, v138, v228 op_sel:[1,1,0] op_sel_hi:[1,1,0]
v_fma_mix_f32 v228, v140, v140, v228 op_sel:[1,1,0] op_sel_hi:[1,1,0]
v_fma_mix_f32 v228, v142, v142, v228 op_sel:[1,1,0] op_sel_hi:[1,1,0]
v_fma_mix_f32 v228, v128, v128, v228 op_sel_hi:[1,1,0]
v_fma_mix_f32 v228, v129, v129, v228 op_sel_hi:[1,1,0]
v_cvt_pkrtz_f16_f32 v145, v144, v145
v_and_b32_e64 v145, s49, v145
v_bfe_u32 v144, v145, 2, 14
v_lshrrev_b32 v145, 18, v145
ds_read_u16 v144, v144
ds_read_u16 v145, v145
v_cvt_pk_f16_f32 v156, v156, v157
s_waitcnt lgkmcnt(4)
v_fma_mix_f32 v228, v130, v130, v228 op_sel_hi:[1,1,0]
v_fma_mix_f32 v228, v131, v131, v228 op_sel_hi:[1,1,0]
v_cvt_pk_f16_f32 v158, v158, v159
v_mfma_f32_32x32x16_bf16 v[112:127], v[176:179], v[72:75], 0
v_pk_fma_f16 v157, v156, v156, s48
v_cvt_pkrtz_f16_f32 v147, v146, v147
v_and_b32_e64 v147, s49, v147
v_bfe_u32 v146, v147, 2, 14
v_lshrrev_b32_e64 v147, 18, v147
ds_read_u16 v146, v146
ds_read_u16 v147, v147
v_pk_fma_f16 v159, v158, v158, s48
ds_read_b128 v[188:191], v250 offset:39936
v_fma_mix_f32 v228, v132, v132, v228 op_sel_hi:[1,1,0]
v_fma_mix_f32 v228, v133, v133, v228 op_sel_hi:[1,1,0]
v_pk_mul_f16 v157, v156, v157
v_pk_mul_f16 v159, v158, v159
v_cvt_pkrtz_f16_f32 v149, v148, v149
v_and_b32_e64 v149, s49, v149
v_bfe_u32 v148, v149, 2, 14
v_lshrrev_b32_e64 v149, 18, v149
ds_read_u16 v148, v148
ds_read_u16 v149, v149
v_exp_f16_sdwa v157, v157 dst_sel:WORD_0 dst_unused:UNUSED_PRESERVE src0_sel:WORD_0
v_fma_mix_f32 v228, v134, v134, v228 op_sel_hi:[1,1,0]
v_fma_mix_f32 v228, v135, v135, v228 op_sel_hi:[1,1,0]
v_mfma_f32_32x32x16_bf16 v[96:111], v[52:55], v[180:183], v[96:111]
v_exp_f16_sdwa v159, v159 dst_sel:WORD_0 dst_unused:UNUSED_PRESERVE src0_sel:WORD_0
v_cvt_pkrtz_f16_f32 v151, v150, v151
v_and_b32_e64 v151, s49, v151
v_bfe_u32 v150, v151, 2, 14
v_lshrrev_b32_e64 v151, 18, v151
ds_read_u16 v150, v150
ds_read_u16 v151, v151
v_exp_f16_sdwa v157, v157 dst_sel:WORD_1 dst_unused:UNUSED_PRESERVE src0_sel:WORD_1
v_fma_mix_f32 v228, v136, v136, v228 op_sel_hi:[1,1,0]
s_waitcnt lgkmcnt(7)
v_fma_mix_f32 v228, v137, v137, v228 op_sel_hi:[1,1,0]
v_cvt_pkrtz_f16_f32 v153, v152, v153
v_and_b32 v153, s49, v153
v_bfe_u32 v152, v153, 2, 14
v_lshrrev_b32_e64 v153, 18, v153
ds_read_u16 v152, v152
ds_read_u16 v153, v153
v_mfma_f32_32x32x16_bf16 v[112:127], v[180:183], v[76:79], v[112:127]
v_exp_f16_sdwa v159, v159 dst_sel:WORD_1 dst_unused:UNUSED_PRESERVE src0_sel:WORD_1
ds_read_b128 v[176:179], v250 offset:40960
v_cvt_pkrtz_f16_f32 v155, v154, v155
v_and_b32_e64 v155, s49, v155
v_bfe_u32 v154, v155, 2, 14
v_lshrrev_b32_e64 v155, 18, v155
ds_read_u16 v154, v154
ds_read_u16 v155, v155
v_pk_add_f16 v157, v157, 1.0 op_sel_hi:[1,0]
v_pk_add_f16 v159, v159, 1.0 op_sel_hi:[1,0]
v_rcp_f16_sdwa v157, v157 dst_sel:WORD_0 dst_unused:UNUSED_PRESERVE src0_sel:WORD_0
v_mfma_f32_32x32x16_bf16 v[96:111], v[56:59], v[184:187], v[96:111]
v_rcp_f16_sdwa v159, v159 dst_sel:WORD_0 dst_unused:UNUSED_PRESERVE src0_sel:WORD_0
v_rcp_f16_sdwa v157, v157 dst_sel:WORD_1 dst_unused:UNUSED_PRESERVE src0_sel:WORD_1
v_mfma_f32_32x32x16_bf16 v[112:127], v[184:187], v[80:83], v[112:127]
v_rcp_f16_sdwa v159, v159 dst_sel:WORD_1 dst_unused:UNUSED_PRESERVE src0_sel:WORD_1
ds_read_b128 v[180:183], v250 offset:41984
v_pk_mul_f16 v156, v156, v157
v_pk_mul_f16 v158, v158, v159
v_fma_mix_f32 v229, v156, v156, v229 op_sel_hi:[1,1,0]
v_fma_mix_f32 v229, v158, v158, v229 op_sel_hi:[1,1,0]
s_waitcnt lgkmcnt(7)
v_mfma_f32_32x32x16_bf16 v[96:111], v[60:63], v[188:191], v[96:111]
v_fma_mix_f32 v229, v156, v156, v229 op_sel:[1,1,0] op_sel_hi:[1,1,0]
v_fma_mix_f32 v229, v158, v158, v229 op_sel:[1,1,0] op_sel_hi:[1,1,0]
v_fma_mix_f32 v229, v144, v144, v229 op_sel_hi:[1,1,0]
v_fma_mix_f32 v229, v145, v145, v229 op_sel_hi:[1,1,0]
v_fma_mix_f32 v229, v146, v146, v229 op_sel_hi:[1,1,0]
v_fma_mix_f32 v229, v147, v147, v229 op_sel_hi:[1,1,0]
v_cvt_pkrtz_f16_f32 v161, v160, v161
v_and_b32 v161, s49, v161
v_bfe_u32 v160, v161, 2, 14
v_lshrrev_b32_e64 v161, 18, v161
ds_read_u16 v160, v160
ds_read_u16 v161, v161
v_cvt_pk_f16_f32 v170, v170, v171
v_cvt_pk_f16_f32 v172, v172, v173
v_cvt_pk_f16_f32 v174, v174, v175
v_mfma_f32_32x32x16_bf16 v[112:127], v[188:191], v[84:87], v[112:127]
v_pk_fma_f16 v171, v170, v170, s48
v_fma_mix_f32 v229, v148, v148, v229 op_sel_hi:[1,1,0]
v_fma_mix_f32 v229, v149, v149, v229 op_sel_hi:[1,1,0]
v_pk_fma_f16 v173, v172, v172, s48
ds_read_b128 v[184:187], v250 offset:43008
v_cvt_pkrtz_f16_f32 v163, v162, v163
v_and_b32_e64 v163, s49, v163
v_bfe_u32 v162, v163, 2, 14
v_lshrrev_b32_e64 v163, 18, v163
ds_read_u16 v162, v162
ds_read_u16 v163, v163
v_pk_fma_f16 v175, v174, v174, s48
v_pk_mul_f16 v171, v170, v171
v_pk_mul_f16 v173, v172, v173
v_fma_mix_f32 v229, v150, v150, v229 op_sel_hi:[1,1,0]
s_waitcnt lgkmcnt(7)
v_fma_mix_f32 v229, v151, v151, v229 op_sel_hi:[1,1,0]
v_pk_mul_f16 v175, v174, v175
v_exp_f16_sdwa v171, v171 dst_sel:WORD_0 dst_unused:UNUSED_PRESERVE src0_sel:WORD_0
v_cvt_pkrtz_f16_f32 v165, v164, v165
v_and_b32 v165, s49, v165
v_bfe_u32 v164, v165, 2, 14
v_lshrrev_b32_e64 v165, 18, v165
ds_read_u16 v164, v164
ds_read_u16 v165, v165
v_mfma_f32_32x32x16_bf16 v[96:111], v[64:67], v[176:179], v[96:111]
v_exp_f16_sdwa v173, v173 dst_sel:WORD_0 dst_unused:UNUSED_PRESERVE src0_sel:WORD_0
v_fma_mix_f32 v229, v152, v152, v229 op_sel_hi:[1,1,0]
v_fma_mix_f32 v229, v153, v153, v229 op_sel_hi:[1,1,0]
v_exp_f16_sdwa v175, v175 dst_sel:WORD_0 dst_unused:UNUSED_PRESERVE src0_sel:WORD_0
v_cvt_pkrtz_f16_f32 v167, v166, v167
v_and_b32_e64 v167, s49, v167
v_bfe_u32 v166, v167, 2, 14
v_lshrrev_b32 v167, 18, v167
ds_read_u16 v166, v166
ds_read_u16 v167, v167
v_exp_f16_sdwa v171, v171 dst_sel:WORD_1 dst_unused:UNUSED_PRESERVE src0_sel:WORD_1
v_fma_mix_f32 v229, v154, v154, v229 op_sel_hi:[1,1,0]
s_waitcnt lgkmcnt(6)
v_fma_mix_f32 v229, v155, v155, v229 op_sel_hi:[1,1,0]
v_exp_f16_sdwa v173, v173 dst_sel:WORD_1 dst_unused:UNUSED_PRESERVE src0_sel:WORD_1
v_mfma_f32_32x32x16_bf16 v[112:127], v[176:179], v[88:91], v[112:127]
v_exp_f16_sdwa v175, v175 dst_sel:WORD_1 dst_unused:UNUSED_PRESERVE src0_sel:WORD_1
ds_read_b128 v[188:191], v250 offset:44032
v_cvt_pkrtz_f16_f32 v169, v168, v169
v_and_b32_e64 v169, s49, v169
v_bfe_u32 v168, v169, 2, 14
v_lshrrev_b32_e64 v169, 18, v169
ds_read_u16 v168, v168
ds_read_u16 v169, v169
v_pk_add_f16 v171, v171, 1.0 op_sel_hi:[1,0]
v_pk_add_f16 v173, v173, 1.0 op_sel_hi:[1,0]
v_pk_add_f16 v175, v175, 1.0 op_sel_hi:[1,0]
v_rcp_f16_sdwa v171, v171 dst_sel:WORD_0 dst_unused:UNUSED_PRESERVE src0_sel:WORD_0
v_mfma_f32_32x32x16_bf16 v[96:111], v[68:71], v[180:183], v[96:111]
v_rcp_f16_sdwa v173, v173 dst_sel:WORD_0 dst_unused:UNUSED_PRESERVE src0_sel:WORD_0
v_rcp_f16_sdwa v175, v175 dst_sel:WORD_0 dst_unused:UNUSED_PRESERVE src0_sel:WORD_0
v_rcp_f16_sdwa v171, v171 dst_sel:WORD_1 dst_unused:UNUSED_PRESERVE src0_sel:WORD_1
v_rcp_f16_sdwa v173, v173 dst_sel:WORD_1 dst_unused:UNUSED_PRESERVE src0_sel:WORD_1
v_mfma_f32_32x32x16_bf16 v[112:127], v[180:183], v[92:95], v[112:127]
v_rcp_f16_sdwa v175, v175 dst_sel:WORD_1 dst_unused:UNUSED_PRESERVE src0_sel:WORD_1
ds_read_b128 v[176:179], v250 offset:45056
v_pk_mul_f16 v170, v170, v171
v_pk_mul_f16 v172, v172, v173
v_pk_mul_f16 v174, v174, v175
v_fma_mix_f32 v229, v170, v170, v229 op_sel_hi:[1,1,0]
v_fma_mix_f32 v229, v172, v172, v229 op_sel_hi:[1,1,0]
v_mfma_f32_32x32x16_bf16 v[128:143], v[48:51], v[184:187], 0
v_fma_mix_f32 v229, v174, v174, v229 op_sel_hi:[1,1,0]
v_fma_mix_f32 v229, v170, v170, v229 op_sel:[1,1,0] op_sel_hi:[1,1,0]
v_fma_mix_f32 v229, v172, v172, v229 op_sel:[1,1,0] op_sel_hi:[1,1,0]
v_fma_mix_f32 v229, v174, v174, v229 op_sel:[1,1,0] op_sel_hi:[1,1,0]
v_fma_mix_f32 v229, v160, v160, v229 op_sel_hi:[1,1,0]
v_fma_mix_f32 v229, v161, v161, v229 op_sel_hi:[1,1,0]
v_cvt_pkrtz_f16_f32 v97, v96, v97
v_and_b32_e64 v97, s49, v97
v_bfe_u32 v96, v97, 2, 14
v_lshrrev_b32 v97, 18, v97
ds_read_u16 v96, v96
ds_read_u16 v97, v97
v_cvt_pk_f16_f32 v108, v108, v109
s_waitcnt lgkmcnt(4)
v_fma_mix_f32 v229, v162, v162, v229 op_sel_hi:[1,1,0]
v_fma_mix_f32 v229, v163, v163, v229 op_sel_hi:[1,1,0]
v_cvt_pk_f16_f32 v110, v110, v111
v_mfma_f32_32x32x16_bf16 v[144:159], v[184:187], v[72:75], 0
v_pk_fma_f16 v109, v108, v108, s48
v_cvt_pkrtz_f16_f32 v99, v98, v99
v_and_b32_e64 v99, s49, v99
v_bfe_u32 v98, v99, 2, 14
v_lshrrev_b32_e64 v99, 18, v99
ds_read_u16 v98, v98
ds_read_u16 v99, v99
v_pk_fma_f16 v111, v110, v110, s48
ds_read_b128 v[180:183], v250 offset:46080
v_fma_mix_f32 v229, v164, v164, v229 op_sel_hi:[1,1,0]
v_fma_mix_f32 v229, v165, v165, v229 op_sel_hi:[1,1,0]
v_pk_mul_f16 v109, v108, v109
v_pk_mul_f16 v111, v110, v111
v_cvt_pkrtz_f16_f32 v101, v100, v101
v_and_b32_e64 v101, s49, v101
v_bfe_u32 v100, v101, 2, 14
v_lshrrev_b32_e64 v101, 18, v101
ds_read_u16 v100, v100
ds_read_u16 v101, v101
v_exp_f16_sdwa v109, v109 dst_sel:WORD_0 dst_unused:UNUSED_PRESERVE src0_sel:WORD_0
v_fma_mix_f32 v229, v166, v166, v229 op_sel_hi:[1,1,0]
v_fma_mix_f32 v229, v167, v167, v229 op_sel_hi:[1,1,0]
v_mfma_f32_32x32x16_bf16 v[128:143], v[52:55], v[188:191], v[128:143]
v_exp_f16_sdwa v111, v111 dst_sel:WORD_0 dst_unused:UNUSED_PRESERVE src0_sel:WORD_0
v_cvt_pkrtz_f16_f32 v103, v102, v103
v_and_b32_e64 v103, s49, v103
v_bfe_u32 v102, v103, 2, 14
v_lshrrev_b32_e64 v103, 18, v103
ds_read_u16 v102, v102
ds_read_u16 v103, v103
v_exp_f16_sdwa v109, v109 dst_sel:WORD_1 dst_unused:UNUSED_PRESERVE src0_sel:WORD_1
v_fma_mix_f32 v229, v168, v168, v229 op_sel_hi:[1,1,0]
s_waitcnt lgkmcnt(7)
v_fma_mix_f32 v229, v169, v169, v229 op_sel_hi:[1,1,0]
v_cvt_pkrtz_f16_f32 v105, v104, v105
v_and_b32 v105, s49, v105
v_bfe_u32 v104, v105, 2, 14
v_lshrrev_b32_e64 v105, 18, v105
ds_read_u16 v104, v104
ds_read_u16 v105, v105
v_mfma_f32_32x32x16_bf16 v[144:159], v[188:191], v[76:79], v[144:159]
v_exp_f16_sdwa v111, v111 dst_sel:WORD_1 dst_unused:UNUSED_PRESERVE src0_sel:WORD_1
ds_read_b128 v[184:187], v250 offset:47104
v_cvt_pkrtz_f16_f32 v107, v106, v107
v_and_b32_e64 v107, s49, v107
v_bfe_u32 v106, v107, 2, 14
v_lshrrev_b32_e64 v107, 18, v107
ds_read_u16 v106, v106
ds_read_u16 v107, v107
v_pk_add_f16 v109, v109, 1.0 op_sel_hi:[1,0]
v_pk_add_f16 v111, v111, 1.0 op_sel_hi:[1,0]
v_rcp_f16_sdwa v109, v109 dst_sel:WORD_0 dst_unused:UNUSED_PRESERVE src0_sel:WORD_0
v_mfma_f32_32x32x16_bf16 v[128:143], v[56:59], v[176:179], v[128:143]
v_rcp_f16_sdwa v111, v111 dst_sel:WORD_0 dst_unused:UNUSED_PRESERVE src0_sel:WORD_0
v_rcp_f16_sdwa v109, v109 dst_sel:WORD_1 dst_unused:UNUSED_PRESERVE src0_sel:WORD_1
v_mfma_f32_32x32x16_bf16 v[144:159], v[176:179], v[80:83], v[144:159]
v_rcp_f16_sdwa v111, v111 dst_sel:WORD_1 dst_unused:UNUSED_PRESERVE src0_sel:WORD_1
ds_read_b128 v[188:191], v250 offset:48128
v_pk_mul_f16 v108, v108, v109
v_pk_mul_f16 v110, v110, v111
v_fma_mix_f32 v230, v108, v108, v230 op_sel_hi:[1,1,0]
v_fma_mix_f32 v230, v110, v110, v230 op_sel_hi:[1,1,0]
s_waitcnt lgkmcnt(7)
v_mfma_f32_32x32x16_bf16 v[128:143], v[60:63], v[180:183], v[128:143]
v_fma_mix_f32 v230, v108, v108, v230 op_sel:[1,1,0] op_sel_hi:[1,1,0]
v_fma_mix_f32 v230, v110, v110, v230 op_sel:[1,1,0] op_sel_hi:[1,1,0]
v_fma_mix_f32 v230, v96, v96, v230 op_sel_hi:[1,1,0]
v_fma_mix_f32 v230, v97, v97, v230 op_sel_hi:[1,1,0]
v_fma_mix_f32 v230, v98, v98, v230 op_sel_hi:[1,1,0]
v_fma_mix_f32 v230, v99, v99, v230 op_sel_hi:[1,1,0]
v_cvt_pkrtz_f16_f32 v113, v112, v113
v_and_b32 v113, s49, v113
v_bfe_u32 v112, v113, 2, 14
v_lshrrev_b32_e64 v113, 18, v113
ds_read_u16 v112, v112
ds_read_u16_d16_hi v113, v113
v_cvt_pk_f16_f32 v122, v122, v123
v_cvt_pk_f16_f32 v124, v124, v125
v_cvt_pk_f16_f32 v126, v126, v127
v_mfma_f32_32x32x16_bf16 v[144:159], v[180:183], v[84:87], v[144:159]
v_pk_fma_f16 v123, v122, v122, s48
v_fma_mix_f32 v230, v100, v100, v230 op_sel_hi:[1,1,0]
v_fma_mix_f32 v230, v101, v101, v230 op_sel_hi:[1,1,0]
ds_read_b128 v[176:179], v250 offset:49152
v_pk_fma_f16 v125, v124, v124, s48
v_cvt_pkrtz_f16_f32 v115, v114, v115
v_and_b32_e64 v115, s49, v115
v_bfe_u32 v114, v115, 2, 14
v_lshrrev_b32 v115, 18, v115
ds_read_u16 v114, v114
ds_read_u16_d16_hi v115, v115
v_pk_fma_f16 v127, v126, v126, s48
v_pk_mul_f16 v123, v122, v123
v_fma_mix_f32 v230, v102, v102, v230 op_sel_hi:[1,1,0]
s_waitcnt lgkmcnt(7)
v_fma_mix_f32 v230, v103, v103, v230 op_sel_hi:[1,1,0]
v_pk_mul_f16 v125, v124, v125
s_getpc_b64 s[74:75]
Lcq6:
s_lshl_b32 s43, s40, 10
s_add_u32 s43, s43, 6144
s_min_u32 s43, s43, Lend-Lcq6-1024
s_add_u32 s74, s74, s43
s_addc_u32 s75, s75, 0
s_sub_u32 s74, s74, 16384
s_subb_u32 s75, s75, 0
s_mov_b32 m0, 163840
s_nop 0
global_load_lds_dword v250, s[74:75]
v_pk_mul_f16 v127, v126, v127
v_cvt_pkrtz_f16_f32 v117, v116, v117
v_and_b32_e64 v117, s49, v117
v_bfe_u32 v116, v117, 2, 14
v_lshrrev_b32_e64 v117, 18, v117
ds_read_u16 v116, v116
ds_read_u16_d16_hi v117, v117
v_exp_f16_sdwa v123, v123 dst_sel:WORD_0 dst_unused:UNUSED_PRESERVE src0_sel:WORD_0
v_mfma_f32_32x32x16_bf16 v[128:143], v[64:67], v[184:187], v[128:143]
v_fma_mix_f32 v230, v104, v104, v230 op_sel_hi:[1,1,0]
v_fma_mix_f32 v230, v105, v105, v230 op_sel_hi:[1,1,0]
v_exp_f16_sdwa v125, v125 dst_sel:WORD_0 dst_unused:UNUSED_PRESERVE src0_sel:WORD_0
v_cvt_pkrtz_f16_f32 v119, v118, v119
v_and_b32_e64 v119, s49, v119
v_bfe_u32 v118, v119, 2, 14
v_lshrrev_b32 v119, 18, v119
ds_read_u16 v118, v118
ds_read_u16_d16_hi v119, v119
v_exp_f16_sdwa v127, v127 dst_sel:WORD_0 dst_unused:UNUSED_PRESERVE src0_sel:WORD_0
v_fma_mix_f32 v230, v106, v106, v230 op_sel_hi:[1,1,0]
s_waitcnt lgkmcnt(6)
v_fma_mix_f32 v230, v107, v107, v230 op_sel_hi:[1,1,0]
v_exp_f16_sdwa v123, v123 dst_sel:WORD_1 dst_unused:UNUSED_PRESERVE src0_sel:WORD_1
v_mfma_f32_32x32x16_bf16 v[144:159], v[184:187], v[88:91], v[144:159]
ds_read_b128 v[180:183], v250 offset:50176
v_exp_f16_sdwa v125, v125 dst_sel:WORD_1 dst_unused:UNUSED_PRESERVE src0_sel:WORD_1
v_cvt_pkrtz_f16_f32 v121, v120, v121
v_and_b32_e64 v121, s49, v121
v_bfe_u32 v120, v121, 2, 14
v_lshrrev_b32_e64 v121, 18, v121
ds_read_u16 v120, v120
ds_read_u16_d16_hi v121, v121
v_exp_f16_sdwa v127, v127 dst_sel:WORD_1 dst_unused:UNUSED_PRESERVE src0_sel:WORD_1
v_pk_add_f16 v123, v123, 1.0 op_sel_hi:[1,0]
v_pk_add_f16 v125, v125, 1.0 op_sel_hi:[1,0]
v_mfma_f32_32x32x16_bf16 v[128:143], v[68:71], v[188:191], v[128:143]
v_pk_add_f16 v127, v127, 1.0 op_sel_hi:[1,0]
v_rcp_f16_sdwa v123, v123 dst_sel:WORD_0 dst_unused:UNUSED_PRESERVE src0_sel:WORD_0
v_rcp_f16_sdwa v125, v125 dst_sel:WORD_0 dst_unused:UNUSED_PRESERVE src0_sel:WORD_0
v_rcp_f16_sdwa v127, v127 dst_sel:WORD_0 dst_unused:UNUSED_PRESERVE src0_sel:WORD_0
v_mfma_f32_32x32x16_bf16 v[144:159], v[188:191], v[92:95], v[144:159]
ds_read_b128 v[184:187], v250 offset:51200
v_rcp_f16_sdwa v123, v123 dst_sel:WORD_1 dst_unused:UNUSED_PRESERVE src0_sel:WORD_1
v_rcp_f16_sdwa v125, v125 dst_sel:WORD_1 dst_unused:UNUSED_PRESERVE src0_sel:WORD_1
v_rcp_f16_sdwa v127, v127 dst_sel:WORD_1 dst_unused:UNUSED_PRESERVE src0_sel:WORD_1
v_or_b32 v0, v112, v113
v_mfma_f32_32x32x16_bf16 v[160:175], v[48:51], v[176:179], 0
v_mov_b32 v239, 0
s_branch Law5
Lax5:
s_sleep 2
Law5:
ds_read_b32 v239, v247 offset:28
s_sub_u32 s76, s76, 1
s_cselect_b32 s44, 4, 0
s_cselect_b32 s76, 0, s76
s_waitcnt lgkmcnt(0)
v_readfirstlane_b32 s43, v239
s_nop 1
s_max_u32 s43, s43, s44
s_cmp_lt_u32 s43, 4
s_cbranch_scc1 Lax5
v_bfe_u32 v241, v250, 4, 6
v_lshrrev_b32 v236, 2, v241
v_mul_u32_u24 v236, 192, v236
v_and_b32 v241, 3, v241
v_lshl_add_u32 v236, v241, 4, v236
s_setprio 1
v_pk_mul_f16 v3, v122, v123
v_pk_mul_f16 v6, v124, v125
v_pk_mul_f16 v7, v126, v127
v_cvt_pkrtz_f16_f32 v129, v128, v129
v_and_b32_e64 v129, s49, v129
v_bfe_u32 v128, v129, 2, 14
v_lshrrev_b32 v129, 18, v129
ds_read_u16 v128, v128
ds_read_u16 v129, v129
v_cvt_pk_f16_f32 v140, v140, v141
v_or_b32 v1, v114, v115
v_cvt_pk_f16_f32 v142, v142, v143
v_mfma_f32_32x32x16_bf16 v[96:111], v[176:179], v[72:75], 0
v_pk_fma_f16 v141, v140, v140, s48
v_cvt_pkrtz_f16_f32 v131, v130, v131
v_and_b32_e64 v131, s49, v131
v_bfe_u32 v130, v131, 2, 14
v_lshrrev_b32_e64 v131, 18, v131
ds_read_u16 v130, v130
ds_read_u16 v131, v131
v_pk_fma_f16 v143, v142, v142, s48
ds_read_b128 v[188:191], v250 offset:52224
v_or_b32 v4, v116, v117
v_pk_mul_f16 v141, v140, v141
v_pk_mul_f16 v143, v142, v143
v_cvt_pkrtz_f16_f32 v133, v132, v133
v_and_b32 v133, s49, v133
v_bfe_u32 v132, v133, 2, 14
v_lshrrev_b32_e64 v133, 18, v133
ds_read_u16 v132, v132
ds_read_u16 v133, v133
s_add_u32 m0, s72, 0
s_add_u32 s43, s82, 0
buffer_load_dwordx4 v236, s[16:19], s43 offen lds
v_exp_f16_sdwa v141, v141 dst_sel:WORD_0 dst_unused:UNUSED_PRESERVE src0_sel:WORD_0
v_or_b32 v5, v118, v119
v_mfma_f32_32x32x16_bf16 v[160:175], v[52:55], v[180:183], v[160:175]
v_exp_f16_sdwa v143, v143 dst_sel:WORD_0 dst_unused:UNUSED_PRESERVE src0_sel:WORD_0
v_cvt_pkrtz_f16_f32 v135, v134, v135
v_and_b32 v135, s49, v135
v_bfe_u32 v134, v135, 2, 14
v_lshrrev_b32_e64 v135, 18, v135
ds_read_u16 v134, v134
ds_read_u16 v135, v135
v_exp_f16_sdwa v141, v141 dst_sel:WORD_1 dst_unused:UNUSED_PRESERVE src0_sel:WORD_1
v_or_b32 v2, v120, v121
v_cvt_pkrtz_f16_f32 v137, v136, v137
v_and_b32 v137, s49, v137
v_bfe_u32 v136, v137, 2, 14
v_lshrrev_b32_e64 v137, 18, v137
ds_read_u16 v136, v136
ds_read_u16 v137, v137
v_mfma_f32_32x32x16_bf16 v[96:111], v[180:183], v[76:79], v[96:111]
v_exp_f16_sdwa v143, v143 dst_sel:WORD_1 dst_unused:UNUSED_PRESERVE src0_sel:WORD_1
ds_read_b128 v[176:179], v250 offset:53248
v_cvt_pkrtz_f16_f32 v139, v138, v139
v_and_b32_e64 v139, s49, v139
v_mfma_f32_32x32x16_f16 v[112:127], v[0:3], v[216:219], 0
v_bfe_u32 v138, v139, 2, 14
v_lshrrev_b32_e64 v139, 18, v139
ds_read_u16 v138, v138
ds_read_u16 v139, v139
v_pk_add_f16 v141, v141, 1.0 op_sel_hi:[1,0]
v_pk_add_f16 v143, v143, 1.0 op_sel_hi:[1,0]
v_rcp_f16_sdwa v141, v141 dst_sel:WORD_0 dst_unused:UNUSED_PRESERVE src0_sel:WORD_0
v_mfma_f32_32x32x16_f16 v[112:127], v[4:7], v[220:223], v[112:127]
v_permlane16_swap_b32 v0, v4
v_permlane16_swap_b32 v1, v5
v_permlane16_swap_b32 v2, v6
v_permlane16_swap_b32 v3, v7
v_mfma_f32_32x32x16_bf16 v[160:175], v[56:59], v[184:187], v[160:175]
v_rcp_f16_sdwa v143, v143 dst_sel:WORD_0 dst_unused:UNUSED_PRESERVE src0_sel:WORD_0
v_rcp_f16_sdwa v141, v141 dst_sel:WORD_1 dst_unused:UNUSED_PRESERVE src0_sel:WORD_1
s_add_u32 m0, s72, 1024
s_add_u32 s43, s82, 64
buffer_load_dwordx4 v236, s[16:19], s43 offen lds
v_mfma_f32_32x32x16_bf16 v[96:111], v[184:187], v[80:83], v[96:111]
v_rcp_f16_sdwa v143, v143 dst_sel:WORD_1 dst_unused:UNUSED_PRESERVE src0_sel:WORD_1
ds_read_b128 v[180:183], v250 offset:54272
v_fmac_f32 v230, v112, v112
v_pk_mul_f16 v140, v140, v141
v_fmac_f32 v230, v113, v113
v_pk_mul_f16 v142, v142, v143
v_fmac_f32 v230, v114, v114
v_fmac_f32 v230, v115, v115
v_fma_mix_f32 v231, v140, v140, v231 op_sel_hi:[1,1,0]
v_fmac_f32 v230, v116, v116
v_fmac_f32 v230, v117, v117
v_fma_mix_f32 v231, v142, v142, v231 op_sel_hi:[1,1,0]
s_waitcnt lgkmcnt(5)
v_mfma_f32_32x32x16_bf16 v[160:175], v[60:63], v[188:191], v[160:175]
v_fmac_f32 v230, v118, v118
v_fma_mix_f32 v231, v140, v140, v231 op_sel:[1,1,0] op_sel_hi:[1,1,0]
v_fmac_f32 v230, v119, v119
v_fmac_f32 v230, v120, v120
v_fma_mix_f32 v231, v142, v142, v231 op_sel:[1,1,0] op_sel_hi:[1,1,0]
v_fma_mix_f32 v231, v128, v128, v231 op_sel_hi:[1,1,0]
v_fma_mix_f32 v231, v129, v129, v231 op_sel_hi:[1,1,0]
v_fmac_f32 v230, v121, v121
v_fma_mix_f32 v231, v130, v130, v231 op_sel_hi:[1,1,0]
v_fma_mix_f32 v231, v131, v131, v231 op_sel_hi:[1,1,0]
v_fmac_f32 v230, v122, v122
v_cvt_pkrtz_f16_f32 v145, v144, v145
v_and_b32 v145, s49, v145
v_bfe_u32 v144, v145, 2, 14
v_lshrrev_b32 v145, 18, v145
ds_read_u16 v144, v144
ds_read_u16_d16_hi v145, v145
v_cvt_pk_f16_f32 v154, v154, v155
v_fmac_f32 v230, v123, v123
v_cvt_pk_f16_f32 v156, v156, v157
v_fmac_f32 v230, v124, v124
v_cvt_pk_f16_f32 v158, v158, v159
v_fmac_f32 v230, v125, v125
v_mfma_f32_32x32x16_bf16 v[96:111], v[188:191], v[84:87], v[96:111]
v_pk_fma_f16 v155, v154, v154, s48
v_fmac_f32 v230, v126, v126
v_fma_mix_f32 v231, v132, v132, v231 op_sel_hi:[1,1,0]
v_fma_mix_f32 v231, v133, v133, v231 op_sel_hi:[1,1,0]
v_fmac_f32 v230, v127, v127
ds_read_b128 v[184:187], v250 offset:55296
v_pk_fma_f16 v157, v156, v156, s48
v_cvt_pkrtz_f16_f32 v147, v146, v147
v_and_b32_e64 v147, s49, v147
v_bfe_u32 v146, v147, 2, 14
v_lshrrev_b32_e64 v147, 18, v147
ds_read_u16 v146, v146
ds_read_u16_d16_hi v147, v147
v_pk_fma_f16 v159, v158, v158, s48
v_pk_mul_f16 v155, v154, v155
v_fma_mix_f32 v231, v134, v134, v231 op_sel_hi:[1,1,0]
v_fma_mix_f32 v231, v135, v135, v231 op_sel_hi:[1,1,0]
v_pk_mul_f16 v157, v156, v157
s_add_u32 m0, s72, 2048
s_add_u32 s43, s82, 128
buffer_load_dwordx4 v236, s[16:19], s43 offen lds
v_pk_mul_f16 v159, v158, v159
v_cvt_pkrtz_f16_f32 v149, v148, v149
v_and_b32_e64 v149, s49, v149
v_bfe_u32 v148, v149, 2, 14
v_lshrrev_b32 v149, 18, v149
ds_read_u16 v148, v148
ds_read_u16_d16_hi v149, v149
v_exp_f16_sdwa v155, v155 dst_sel:WORD_0 dst_unused:UNUSED_PRESERVE src0_sel:WORD_0
s_waitcnt lgkmcnt(6)
v_mfma_f32_32x32x16_bf16 v[160:175], v[64:67], v[176:179], v[160:175]
v_fma_mix_f32 v231, v136, v136, v231 op_sel_hi:[1,1,0]
v_fma_mix_f32 v231, v137, v137, v231 op_sel_hi:[1,1,0]
v_exp_f16_sdwa v157, v157 dst_sel:WORD_0 dst_unused:UNUSED_PRESERVE src0_sel:WORD_0
v_cvt_pkrtz_f16_f32 v151, v150, v151
v_and_b32_e64 v151, s49, v151
v_bfe_u32 v150, v151, 2, 14
v_lshrrev_b32_e64 v151, 18, v151
ds_read_u16 v150, v150
ds_read_u16_d16_hi v151, v151
v_exp_f16_sdwa v159, v159 dst_sel:WORD_0 dst_unused:UNUSED_PRESERVE src0_sel:WORD_0
v_fma_mix_f32 v231, v138, v138, v231 op_sel_hi:[1,1,0]
v_fma_mix_f32 v231, v139, v139, v231 op_sel_hi:[1,1,0]
v_exp_f16_sdwa v155, v155 dst_sel:WORD_1 dst_unused:UNUSED_PRESERVE src0_sel:WORD_1
v_mfma_f32_32x32x16_bf16 v[96:111], v[176:179], v[88:91], v[96:111]
ds_read_b128 v[188:191], v250 offset:56320
v_exp_f16_sdwa v157, v157 dst_sel:WORD_1 dst_unused:UNUSED_PRESERVE src0_sel:WORD_1
v_cvt_pkrtz_f16_f32 v153, v152, v153
v_and_b32_e64 v153, s49, v153
v_bfe_u32 v152, v153, 2, 14
v_lshrrev_b32_e64 v153, 18, v153
ds_read_u16 v152, v152
ds_read_u16_d16_hi v153, v153
v_exp_f16_sdwa v159, v159 dst_sel:WORD_1 dst_unused:UNUSED_PRESERVE src0_sel:WORD_1
v_pk_add_f16 v155, v155, 1.0 op_sel_hi:[1,0]
v_pk_add_f16 v157, v157, 1.0 op_sel_hi:[1,0]
v_mfma_f32_32x32x16_bf16 v[160:175], v[68:71], v[180:183], v[160:175]
v_pk_add_f16 v159, v159, 1.0 op_sel_hi:[1,0]
v_rcp_f16_sdwa v155, v155 dst_sel:WORD_0 dst_unused:UNUSED_PRESERVE src0_sel:WORD_0
v_rcp_f16_sdwa v157, v157 dst_sel:WORD_0 dst_unused:UNUSED_PRESERVE src0_sel:WORD_0
s_add_u32 m0, s72, 3072
s_add_u32 s43, s82, 3072
buffer_load_dwordx4 v236, s[16:19], s43 offen lds
v_rcp_f16_sdwa v159, v159 dst_sel:WORD_0 dst_unused:UNUSED_PRESERVE src0_sel:WORD_0
v_mfma_f32_32x32x16_bf16 v[96:111], v[180:183], v[92:95], v[96:111]
ds_read_b128 v[176:179], v250 offset:57344
v_rcp_f16_sdwa v155, v155 dst_sel:WORD_1 dst_unused:UNUSED_PRESERVE src0_sel:WORD_1
v_rcp_f16_sdwa v157, v157 dst_sel:WORD_1 dst_unused:UNUSED_PRESERVE src0_sel:WORD_1
v_rcp_f16_sdwa v159, v159 dst_sel:WORD_1 dst_unused:UNUSED_PRESERVE src0_sel:WORD_1
s_waitcnt lgkmcnt(4)
v_or_b32 v8, v144, v145
v_mfma_f32_32x32x16_bf16 v[112:127], v[48:51], v[184:187], 0
v_pk_mul_f16 v11, v154, v155
v_pk_mul_f16 v14, v156, v157
v_pk_mul_f16 v15, v158, v159
v_cvt_pkrtz_f16_f32 v161, v160, v161
v_and_b32_e64 v161, s49, v161
v_bfe_u32 v160, v161, 2, 14
v_lshrrev_b32 v161, 18, v161
ds_read_u16 v160, v160
ds_read_u16 v161, v161
v_cvt_pk_f16_f32 v172, v172, v173
v_or_b32 v9, v146, v147
v_cvt_pk_f16_f32 v174, v174, v175
v_mfma_f32_32x32x16_bf16 v[128:143], v[184:187], v[72:75], 0
v_pk_fma_f16 v173, v172, v172, s48
v_cvt_pkrtz_f16_f32 v163, v162, v163
v_and_b32_e64 v163, s49, v163
v_bfe_u32 v162, v163, 2, 14
v_lshrrev_b32_e64 v163, 18, v163
ds_read_u16 v162, v162
ds_read_u16 v163, v163
v_pk_fma_f16 v175, v174, v174, s48
ds_read_b128 v[180:183], v250 offset:58368
v_or_b32 v12, v148, v149
v_pk_mul_f16 v173, v172, v173
v_pk_mul_f16 v175, v174, v175
v_cvt_pkrtz_f16_f32 v165, v164, v165
v_and_b32 v165, s49, v165
v_bfe_u32 v164, v165, 2, 14
v_lshrrev_b32_e64 v165, 18, v165
ds_read_u16 v164, v164
ds_read_u16 v165, v165
s_add_u32 m0, s72, 4096
s_add_u32 s43, s82, 3136
buffer_load_dwordx4 v236, s[16:19], s43 offen lds
v_exp_f16_sdwa v173, v173 dst_sel:WORD_0 dst_unused:UNUSED_PRESERVE src0_sel:WORD_0
v_or_b32 v13, v150, v151
s_waitcnt lgkmcnt(7)
v_mfma_f32_32x32x16_bf16 v[112:127], v[52:55], v[188:191], v[112:127]
v_exp_f16_sdwa v175, v175 dst_sel:WORD_0 dst_unused:UNUSED_PRESERVE src0_sel:WORD_0
v_cvt_pkrtz_f16_f32 v167, v166, v167
v_and_b32_e64 v167, s49, v167
v_bfe_u32 v166, v167, 2, 14
v_lshrrev_b32_e64 v167, 18, v167
ds_read_u16 v166, v166
ds_read_u16 v167, v167
v_exp_f16_sdwa v173, v173 dst_sel:WORD_1 dst_unused:UNUSED_PRESERVE src0_sel:WORD_1
v_or_b32 v10, v152, v153
v_cvt_pkrtz_f16_f32 v169, v168, v169
v_and_b32 v169, s49, v169
v_bfe_u32 v168, v169, 2, 14
v_lshrrev_b32_e64 v169, 18, v169
ds_read_u16 v168, v168
ds_read_u16 v169, v169
v_mfma_f32_32x32x16_bf16 v[128:143], v[188:191], v[76:79], v[128:143]
v_exp_f16_sdwa v175, v175 dst_sel:WORD_1 dst_unused:UNUSED_PRESERVE src0_sel:WORD_1
ds_read_b128 v[184:187], v250 offset:59392
v_cvt_pkrtz_f16_f32 v171, v170, v171
v_and_b32_e64 v171, s49, v171
v_mfma_f32_32x32x16_f16 v[144:159], v[8:11], v[216:219], 0
v_bfe_u32 v170, v171, 2, 14
v_lshrrev_b32_e64 v171, 18, v171
ds_read_u16 v170, v170
ds_read_u16 v171, v171
v_pk_add_f16 v173, v173, 1.0 op_sel_hi:[1,0]
v_pk_add_f16 v175, v175, 1.0 op_sel_hi:[1,0]
v_rcp_f16_sdwa v173, v173 dst_sel:WORD_0 dst_unused:UNUSED_PRESERVE src0_sel:WORD_0
v_mfma_f32_32x32x16_f16 v[144:159], v[12:15], v[220:223], v[144:159]
v_permlane16_swap_b32 v8, v12
v_permlane16_swap_b32 v9, v13
v_permlane16_swap_b32 v10, v14
v_permlane16_swap_b32 v11, v15
v_mfma_f32_32x32x16_bf16 v[112:127], v[56:59], v[176:179], v[112:127]
v_rcp_f16_sdwa v175, v175 dst_sel:WORD_0 dst_unused:UNUSED_PRESERVE src0_sel:WORD_0
v_rcp_f16_sdwa v173, v173 dst_sel:WORD_1 dst_unused:UNUSED_PRESERVE src0_sel:WORD_1
s_add_u32 m0, s72, 5120
s_add_u32 s43, s82, 3200
buffer_load_dwordx4 v236, s[16:19], s43 offen lds
v_mfma_f32_32x32x16_bf16 v[128:143], v[176:179], v[80:83], v[128:143]
v_rcp_f16_sdwa v175, v175 dst_sel:WORD_1 dst_unused:UNUSED_PRESERVE src0_sel:WORD_1
ds_read_b128 v[188:191], v250 offset:60416
v_fmac_f32 v231, v144, v144
v_pk_mul_f16 v172, v172, v173
v_fmac_f32 v231, v145, v145
v_pk_mul_f16 v174, v174, v175
v_fmac_f32 v231, v146, v146
v_fmac_f32 v231, v147, v147
v_fma_mix_f32 v232, v172, v172, v232 op_sel_hi:[1,1,0]
v_fmac_f32 v231, v148, v148
v_fmac_f32 v231, v149, v149
v_fma_mix_f32 v232, v174, v174, v232 op_sel_hi:[1,1,0]
s_waitcnt lgkmcnt(5)
v_mfma_f32_32x32x16_bf16 v[112:127], v[60:63], v[180:183], v[112:127]
v_fmac_f32 v231, v150, v150
v_fma_mix_f32 v232, v172, v172, v232 op_sel:[1,1,0] op_sel_hi:[1,1,0]
v_fmac_f32 v231, v151, v151
v_fmac_f32 v231, v152, v152
v_fma_mix_f32 v232, v174, v174, v232 op_sel:[1,1,0] op_sel_hi:[1,1,0]
v_fma_mix_f32 v232, v160, v160, v232 op_sel_hi:[1,1,0]
v_fma_mix_f32 v232, v161, v161, v232 op_sel_hi:[1,1,0]
v_fmac_f32 v231, v153, v153
v_fma_mix_f32 v232, v162, v162, v232 op_sel_hi:[1,1,0]
v_fma_mix_f32 v232, v163, v163, v232 op_sel_hi:[1,1,0]
v_fmac_f32 v231, v154, v154
v_cvt_pkrtz_f16_f32 v97, v96, v97
v_and_b32_e64 v97, s49, v97
v_bfe_u32 v96, v97, 2, 14
v_lshrrev_b32 v97, 18, v97
ds_read_u16 v96, v96
ds_read_u16_d16_hi v97, v97
v_cvt_pk_f16_f32 v106, v106, v107
v_fmac_f32 v231, v155, v155
v_cvt_pk_f16_f32 v108, v108, v109
v_fmac_f32 v231, v156, v156
v_cvt_pk_f16_f32 v110, v110, v111
v_fmac_f32 v231, v157, v157
v_mfma_f32_32x32x16_bf16 v[128:143], v[180:183], v[84:87], v[128:143]
v_pk_fma_f16 v107, v106, v106, s48
v_fmac_f32 v231, v158, v158
v_fma_mix_f32 v232, v164, v164, v232 op_sel_hi:[1,1,0]
v_fma_mix_f32 v232, v165, v165, v232 op_sel_hi:[1,1,0]
v_fmac_f32 v231, v159, v159
ds_read_b128 v[176:179], v250 offset:61440
v_pk_fma_f16 v109, v108, v108, s48
v_cvt_pkrtz_f16_f32 v99, v98, v99
v_and_b32_e64 v99, s49, v99
v_bfe_u32 v98, v99, 2, 14
v_lshrrev_b32_e64 v99, 18, v99
ds_read_u16 v98, v98
ds_read_u16_d16_hi v99, v99
v_pk_fma_f16 v111, v110, v110, s48
v_pk_mul_f16 v107, v106, v107
v_fma_mix_f32 v232, v166, v166, v232 op_sel_hi:[1,1,0]
v_fma_mix_f32 v232, v167, v167, v232 op_sel_hi:[1,1,0]
v_pk_mul_f16 v109, v108, v109
s_add_u32 m0, s72, 6144
s_add_u32 s43, s82, 6144
buffer_load_dwordx4 v236, s[16:19], s43 offen lds
v_pk_mul_f16 v111, v110, v111
v_cvt_pkrtz_f16_f32 v101, v100, v101
v_and_b32_e64 v101, s49, v101
v_bfe_u32 v100, v101, 2, 14
v_lshrrev_b32 v101, 18, v101
ds_read_u16 v100, v100
ds_read_u16_d16_hi v101, v101
v_exp_f16_sdwa v107, v107 dst_sel:WORD_0 dst_unused:UNUSED_PRESERVE src0_sel:WORD_0
s_waitcnt lgkmcnt(6)
v_mfma_f32_32x32x16_bf16 v[112:127], v[64:67], v[184:187], v[112:127]
v_fma_mix_f32 v232, v168, v168, v232 op_sel_hi:[1,1,0]
v_fma_mix_f32 v232, v169, v169, v232 op_sel_hi:[1,1,0]
v_exp_f16_sdwa v109, v109 dst_sel:WORD_0 dst_unused:UNUSED_PRESERVE src0_sel:WORD_0
v_cvt_pkrtz_f16_f32 v103, v102, v103
v_and_b32_e64 v103, s49, v103
v_bfe_u32 v102, v103, 2, 14
v_lshrrev_b32_e64 v103, 18, v103
ds_read_u16 v102, v102
ds_read_u16_d16_hi v103, v103
v_exp_f16_sdwa v111, v111 dst_sel:WORD_0 dst_unused:UNUSED_PRESERVE src0_sel:WORD_0
v_fma_mix_f32 v232, v170, v170, v232 op_sel_hi:[1,1,0]
v_fma_mix_f32 v232, v171, v171, v232 op_sel_hi:[1,1,0]
v_exp_f16_sdwa v107, v107 dst_sel:WORD_1 dst_unused:UNUSED_PRESERVE src0_sel:WORD_1
v_mfma_f32_32x32x16_bf16 v[128:143], v[184:187], v[88:91], v[128:143]
ds_read_b128 v[180:183], v250 offset:62464
v_exp_f16_sdwa v109, v109 dst_sel:WORD_1 dst_unused:UNUSED_PRESERVE src0_sel:WORD_1
v_cvt_pkrtz_f16_f32 v105, v104, v105
v_and_b32_e64 v105, s49, v105
v_bfe_u32 v104, v105, 2, 14
v_lshrrev_b32_e64 v105, 18, v105
ds_read_u16 v104, v104
ds_read_u16_d16_hi v105, v105
v_exp_f16_sdwa v111, v111 dst_sel:WORD_1 dst_unused:UNUSED_PRESERVE src0_sel:WORD_1
v_pk_add_f16 v107, v107, 1.0 op_sel_hi:[1,0]
v_pk_add_f16 v109, v109, 1.0 op_sel_hi:[1,0]
v_mfma_f32_32x32x16_bf16 v[112:127], v[68:71], v[188:191], v[112:127]
v_pk_add_f16 v111, v111, 1.0 op_sel_hi:[1,0]
v_rcp_f16_sdwa v107, v107 dst_sel:WORD_0 dst_unused:UNUSED_PRESERVE src0_sel:WORD_0
v_rcp_f16_sdwa v109, v109 dst_sel:WORD_0 dst_unused:UNUSED_PRESERVE src0_sel:WORD_0
v_rcp_f16_sdwa v111, v111 dst_sel:WORD_0 dst_unused:UNUSED_PRESERVE src0_sel:WORD_0
v_mfma_f32_32x32x16_bf16 v[128:143], v[188:191], v[92:95], v[128:143]
ds_read_b128 v[184:187], v250 offset:63488
v_rcp_f16_sdwa v107, v107 dst_sel:WORD_1 dst_unused:UNUSED_PRESERVE src0_sel:WORD_1
v_rcp_f16_sdwa v109, v109 dst_sel:WORD_1 dst_unused:UNUSED_PRESERVE src0_sel:WORD_1
v_rcp_f16_sdwa v111, v111 dst_sel:WORD_1 dst_unused:UNUSED_PRESERVE src0_sel:WORD_1
s_waitcnt lgkmcnt(4)
v_or_b32 v16, v96, v97
v_mfma_f32_32x32x16_bf16 v[144:159], v[48:51], v[176:179], 0
v_pk_mul_f16 v19, v106, v107
v_pk_mul_f16 v22, v108, v109
v_pk_mul_f16 v23, v110, v111
v_cvt_pkrtz_f16_f32 v113, v112, v113
v_and_b32_e64 v113, s49, v113
v_bfe_u32 v112, v113, 2, 14
v_lshrrev_b32 v113, 18, v113
ds_read_u16 v112, v112
ds_read_u16 v113, v113
v_cvt_pk_f16_f32 v124, v124, v125
v_or_b32 v17, v98, v99
v_cvt_pk_f16_f32 v126, v126, v127
v_mfma_f32_32x32x16_bf16 v[160:175], v[176:179], v[72:75], 0
v_pk_fma_f16 v125, v124, v124, s48
v_cvt_pkrtz_f16_f32 v115, v114, v115
v_and_b32_e64 v115, s49, v115
v_bfe_u32 v114, v115, 2, 14
v_lshrrev_b32_e64 v115, 18, v115
ds_read_u16 v114, v114
ds_read_u16 v115, v115
v_pk_fma_f16 v127, v126, v126, s48
ds_read_b128 v[188:191], v250 offset:64512
v_or_b32 v20, v100, v101
v_pk_mul_f16 v125, v124, v125
v_pk_mul_f16 v127, v126, v127
v_cvt_pkrtz_f16_f32 v117, v116, v117
v_and_b32 v117, s49, v117
v_bfe_u32 v116, v117, 2, 14
v_lshrrev_b32_e64 v117, 18, v117
ds_read_u16 v116, v116
ds_read_u16 v117, v117
v_exp_f16_sdwa v125, v125 dst_sel:WORD_0 dst_unused:UNUSED_PRESERVE src0_sel:WORD_0
v_or_b32 v21, v102, v103
s_waitcnt lgkmcnt(7)
v_mfma_f32_32x32x16_bf16 v[144:159], v[52:55], v[180:183], v[144:159]
v_exp_f16_sdwa v127, v127 dst_sel:WORD_0 dst_unused:UNUSED_PRESERVE src0_sel:WORD_0
v_cvt_pkrtz_f16_f32 v119, v118, v119
v_and_b32_e64 v119, s49, v119
v_bfe_u32 v118, v119, 2, 14
v_lshrrev_b32_e64 v119, 18, v119
ds_read_u16 v118, v118
ds_read_u16 v119, v119
v_exp_f16_sdwa v125, v125 dst_sel:WORD_1 dst_unused:UNUSED_PRESERVE src0_sel:WORD_1
v_or_b32 v18, v104, v105
v_cvt_pkrtz_f16_f32 v121, v120, v121
v_and_b32 v121, s49, v121
v_bfe_u32 v120, v121, 2, 14
v_lshrrev_b32_e64 v121, 18, v121
ds_read_u16 v120, v120
ds_read_u16 v121, v121
v_mfma_f32_32x32x16_bf16 v[160:175], v[180:183], v[76:79], v[160:175]
v_exp_f16_sdwa v127, v127 dst_sel:WORD_1 dst_unused:UNUSED_PRESERVE src0_sel:WORD_1
ds_read_b128 v[176:179], v251
v_cvt_pkrtz_f16_f32 v123, v122, v123
v_and_b32_e64 v123, s49, v123
v_mfma_f32_32x32x16_f16 v[96:111], v[16:19], v[216:219], 0
v_bfe_u32 v122, v123, 2, 14
v_lshrrev_b32_e64 v123, 18, v123
ds_read_u16 v122, v122
ds_read_u16 v123, v123
v_pk_add_f16 v125, v125, 1.0 op_sel_hi:[1,0]
v_pk_add_f16 v127, v127, 1.0 op_sel_hi:[1,0]
v_rcp_f16_sdwa v125, v125 dst_sel:WORD_0 dst_unused:UNUSED_PRESERVE src0_sel:WORD_0
v_mfma_f32_32x32x16_f16 v[96:111], v[20:23], v[220:223], v[96:111]
v_permlane16_swap_b32 v16, v20
v_permlane16_swap_b32 v17, v21
v_permlane16_swap_b32 v18, v22
v_permlane16_swap_b32 v19, v23
v_mfma_f32_32x32x16_bf16 v[144:159], v[56:59], v[184:187], v[144:159]
v_rcp_f16_sdwa v127, v127 dst_sel:WORD_0 dst_unused:UNUSED_PRESERVE src0_sel:WORD_0
v_rcp_f16_sdwa v125, v125 dst_sel:WORD_1 dst_unused:UNUSED_PRESERVE src0_sel:WORD_1
v_mfma_f32_32x32x16_bf16 v[160:175], v[184:187], v[80:83], v[160:175]
v_rcp_f16_sdwa v127, v127 dst_sel:WORD_1 dst_unused:UNUSED_PRESERVE src0_sel:WORD_1
ds_read_b128 v[180:183], v251 offset:1024
s_nop 1
v_fmac_f32 v232, v96, v96
v_pk_mul_f16 v124, v124, v125
v_fmac_f32 v232, v97, v97
v_pk_mul_f16 v126, v126, v127
v_fmac_f32 v232, v98, v98
v_fmac_f32 v232, v99, v99
v_fma_mix_f32 v233, v124, v124, v233 op_sel_hi:[1,1,0]
v_fmac_f32 v232, v100, v100
v_fmac_f32 v232, v101, v101
v_fma_mix_f32 v233, v126, v126, v233 op_sel_hi:[1,1,0]
s_waitcnt lgkmcnt(6)
v_mfma_f32_32x32x16_bf16 v[144:159], v[60:63], v[188:191], v[144:159]
v_fmac_f32 v232, v102, v102
v_fma_mix_f32 v233, v124, v124, v233 op_sel:[1,1,0] op_sel_hi:[1,1,0]
v_fmac_f32 v232, v103, v103
v_fmac_f32 v232, v104, v104
v_fma_mix_f32 v233, v126, v126, v233 op_sel:[1,1,0] op_sel_hi:[1,1,0]
v_fma_mix_f32 v233, v112, v112, v233 op_sel_hi:[1,1,0]
v_fma_mix_f32 v233, v113, v113, v233 op_sel_hi:[1,1,0]
v_fmac_f32 v232, v105, v105
v_fma_mix_f32 v233, v114, v114, v233 op_sel_hi:[1,1,0]
v_fma_mix_f32 v233, v115, v115, v233 op_sel_hi:[1,1,0]
v_fmac_f32 v232, v106, v106
v_cvt_pkrtz_f16_f32 v129, v128, v129
v_and_b32 v129, s49, v129
v_bfe_u32 v128, v129, 2, 14
v_lshrrev_b32 v129, 18, v129
ds_read_u16 v128, v128
ds_read_u16_d16_hi v129, v129
v_cvt_pk_f16_f32 v138, v138, v139
v_fmac_f32 v232, v107, v107
v_cvt_pk_f16_f32 v140, v140, v141
v_fmac_f32 v232, v108, v108
v_cvt_pk_f16_f32 v142, v142, v143
v_fmac_f32 v232, v109, v109
v_mfma_f32_32x32x16_bf16 v[160:175], v[188:191], v[84:87], v[160:175]
v_pk_fma_f16 v139, v138, v138, s48
v_fmac_f32 v232, v110, v110
v_fma_mix_f32 v233, v116, v116, v233 op_sel_hi:[1,1,0]
v_fma_mix_f32 v233, v117, v117, v233 op_sel_hi:[1,1,0]
v_fmac_f32 v232, v111, v111
ds_read_b128 v[184:187], v251 offset:2048
v_pk_fma_f16 v141, v140, v140, s48
v_cvt_pkrtz_f16_f32 v131, v130, v131
v_and_b32_e64 v131, s49, v131
v_bfe_u32 v130, v131, 2, 14
v_lshrrev_b32_e64 v131, 18, v131
ds_read_u16 v130, v130
ds_read_u16_d16_hi v131, v131
v_pk_fma_f16 v143, v142, v142, s48
v_pk_mul_f16 v139, v138, v139
v_fma_mix_f32 v233, v118, v118, v233 op_sel_hi:[1,1,0]
v_fma_mix_f32 v233, v119, v119, v233 op_sel_hi:[1,1,0]
v_pk_mul_f16 v141, v140, v141
v_pk_mul_f16 v143, v142, v143
v_cvt_pkrtz_f16_f32 v133, v132, v133
v_and_b32_e64 v133, s49, v133
v_bfe_u32 v132, v133, 2, 14
v_lshrrev_b32 v133, 18, v133
ds_read_u16 v132, v132
ds_read_u16_d16_hi v133, v133
v_exp_f16_sdwa v139, v139 dst_sel:WORD_0 dst_unused:UNUSED_PRESERVE src0_sel:WORD_0
s_waitcnt lgkmcnt(6)
v_mfma_f32_32x32x16_bf16 v[144:159], v[64:67], v[176:179], v[144:159]
v_fma_mix_f32 v233, v120, v120, v233 op_sel_hi:[1,1,0]
v_fma_mix_f32 v233, v121, v121, v233 op_sel_hi:[1,1,0]
v_exp_f16_sdwa v141, v141 dst_sel:WORD_0 dst_unused:UNUSED_PRESERVE src0_sel:WORD_0
v_cvt_pkrtz_f16_f32 v135, v134, v135
v_and_b32_e64 v135, s49, v135
v_bfe_u32 v134, v135, 2, 14
v_lshrrev_b32_e64 v135, 18, v135
ds_read_u16 v134, v134
ds_read_u16_d16_hi v135, v135
v_exp_f16_sdwa v143, v143 dst_sel:WORD_0 dst_unused:UNUSED_PRESERVE src0_sel:WORD_0
v_fma_mix_f32 v233, v122, v122, v233 op_sel_hi:[1,1,0]
v_fma_mix_f32 v233, v123, v123, v233 op_sel_hi:[1,1,0]
v_exp_f16_sdwa v139, v139 dst_sel:WORD_1 dst_unused:UNUSED_PRESERVE src0_sel:WORD_1
v_mfma_f32_32x32x16_bf16 v[160:175], v[176:179], v[88:91], v[160:175]
ds_read_b128 v[188:191], v251 offset:3072
v_exp_f16_sdwa v141, v141 dst_sel:WORD_1 dst_unused:UNUSED_PRESERVE src0_sel:WORD_1
v_cvt_pkrtz_f16_f32 v137, v136, v137
v_and_b32_e64 v137, s49, v137
v_bfe_u32 v136, v137, 2, 14
v_lshrrev_b32_e64 v137, 18, v137
ds_read_u16 v136, v136
ds_read_u16_d16_hi v137, v137
v_exp_f16_sdwa v143, v143 dst_sel:WORD_1 dst_unused:UNUSED_PRESERVE src0_sel:WORD_1
v_pk_add_f16 v139, v139, 1.0 op_sel_hi:[1,0]
v_pk_add_f16 v141, v141, 1.0 op_sel_hi:[1,0]
v_mfma_f32_32x32x16_bf16 v[144:159], v[68:71], v[180:183], v[144:159]
v_pk_add_f16 v143, v143, 1.0 op_sel_hi:[1,0]
v_rcp_f16_sdwa v139, v139 dst_sel:WORD_0 dst_unused:UNUSED_PRESERVE src0_sel:WORD_0
v_rcp_f16_sdwa v141, v141 dst_sel:WORD_0 dst_unused:UNUSED_PRESERVE src0_sel:WORD_0
v_rcp_f16_sdwa v143, v143 dst_sel:WORD_0 dst_unused:UNUSED_PRESERVE src0_sel:WORD_0
v_mfma_f32_32x32x16_bf16 v[160:175], v[180:183], v[92:95], v[160:175]
ds_read_b128 v[176:179], v251 offset:4096
v_rcp_f16_sdwa v139, v139 dst_sel:WORD_1 dst_unused:UNUSED_PRESERVE src0_sel:WORD_1
v_rcp_f16_sdwa v141, v141 dst_sel:WORD_1 dst_unused:UNUSED_PRESERVE src0_sel:WORD_1
v_rcp_f16_sdwa v143, v143 dst_sel:WORD_1 dst_unused:UNUSED_PRESERVE src0_sel:WORD_1
s_waitcnt lgkmcnt(4)
v_or_b32 v192, v128, v129
v_mfma_f32_32x32x16_bf16 v[96:111], v[48:51], v[184:187], 0
v_pk_mul_f16 v195, v138, v139
v_pk_mul_f16 v198, v140, v141
v_pk_mul_f16 v199, v142, v143
v_cvt_pkrtz_f16_f32 v145, v144, v145
v_and_b32_e64 v145, s49, v145
v_bfe_u32 v144, v145, 2, 14
v_lshrrev_b32 v145, 18, v145
ds_read_u16 v144, v144
ds_read_u16 v145, v145
v_cvt_pk_f16_f32 v156, v156, v157
v_or_b32 v193, v130, v131
v_cvt_pk_f16_f32 v158, v158, v159
v_mfma_f32_32x32x16_bf16 v[112:127], v[184:187], v[72:75], 0
v_pk_fma_f16 v157, v156, v156, s48
v_cvt_pkrtz_f16_f32 v147, v146, v147
v_and_b32_e64 v147, s49, v147
v_bfe_u32 v146, v147, 2, 14
v_lshrrev_b32_e64 v147, 18, v147
ds_read_u16 v146, v146
ds_read_u16 v147, v147
v_pk_fma_f16 v159, v158, v158, s48
ds_read_b128 v[180:183], v251 offset:5120
v_or_b32 v196, v132, v133
v_pk_mul_f16 v157, v156, v157
v_pk_mul_f16 v159, v158, v159
v_cvt_pkrtz_f16_f32 v149, v148, v149
v_and_b32 v149, s49, v149
v_bfe_u32 v148, v149, 2, 14
v_lshrrev_b32_e64 v149, 18, v149
ds_read_u16 v148, v148
ds_read_u16 v149, v149
v_exp_f16_sdwa v157, v157 dst_sel:WORD_0 dst_unused:UNUSED_PRESERVE src0_sel:WORD_0
v_or_b32 v197, v134, v135
s_waitcnt lgkmcnt(7)
v_mfma_f32_32x32x16_bf16 v[96:111], v[52:55], v[188:191], v[96:111]
v_exp_f16_sdwa v159, v159 dst_sel:WORD_0 dst_unused:UNUSED_PRESERVE src0_sel:WORD_0
v_cvt_pkrtz_f16_f32 v151, v150, v151
v_and_b32_e64 v151, s49, v151
v_bfe_u32 v150, v151, 2, 14
v_lshrrev_b32_e64 v151, 18, v151
ds_read_u16 v150, v150
ds_read_u16 v151, v151
v_exp_f16_sdwa v157, v157 dst_sel:WORD_1 dst_unused:UNUSED_PRESERVE src0_sel:WORD_1
v_or_b32 v194, v136, v137
v_cvt_pkrtz_f16_f32 v153, v152, v153
v_and_b32 v153, s49, v153
v_bfe_u32 v152, v153, 2, 14
v_lshrrev_b32 v153, 18, v153
ds_read_u16 v152, v152
ds_read_u16 v153, v153
v_mfma_f32_32x32x16_bf16 v[112:127], v[188:191], v[76:79], v[112:127]
s_setprio 0
v_exp_f16_sdwa v159, v159 dst_sel:WORD_1 dst_unused:UNUSED_PRESERVE src0_sel:WORD_1
ds_read_b128 v[184:187], v251 offset:6144
v_cvt_pkrtz_f16_f32 v155, v154, v155
v_mfma_f32_32x32x16_f16 v[128:143], v[192:195], v[216:219], 0
v_and_b32_e64 v155, s49, v155
v_bfe_u32 v154, v155, 2, 14
v_lshrrev_b32_e64 v155, 18, v155
ds_read_u16 v154, v154
ds_read_u16 v155, v155
v_pk_add_f16 v157, v157, 1.0 op_sel_hi:[1,0]
v_pk_add_f16 v159, v159, 1.0 op_sel_hi:[1,0]
v_rcp_f16_sdwa v157, v157 dst_sel:WORD_0 dst_unused:UNUSED_PRESERVE src0_sel:WORD_0
v_mfma_f32_32x32x16_f16 v[128:143], v[196:199], v[220:223], v[128:143]
v_permlane16_swap_b32 v192, v196
v_permlane16_swap_b32 v193, v197
v_permlane16_swap_b32 v194, v198
v_permlane16_swap_b32 v195, v199
v_mfma_f32_32x32x16_bf16 v[96:111], v[56:59], v[176:179], v[96:111]
v_rcp_f16_sdwa v159, v159 dst_sel:WORD_0 dst_unused:UNUSED_PRESERVE src0_sel:WORD_0
v_rcp_f16_sdwa v157, v157 dst_sel:WORD_1 dst_unused:UNUSED_PRESERVE src0_sel:WORD_1
v_mfma_f32_32x32x16_bf16 v[112:127], v[176:179], v[80:83], v[112:127]
v_rcp_f16_sdwa v159, v159 dst_sel:WORD_1 dst_unused:UNUSED_PRESERVE src0_sel:WORD_1
ds_read_b128 v[188:191], v251 offset:7168
s_nop 1
v_fmac_f32 v233, v128, v128
v_pk_mul_f16 v156, v156, v157
v_fmac_f32 v233, v129, v129
v_pk_mul_f16 v158, v158, v159
v_fmac_f32 v233, v130, v130
v_fmac_f32 v233, v131, v131
v_fma_mix_f32 v234, v156, v156, v234 op_sel_hi:[1,1,0]
v_fmac_f32 v233, v132, v132
v_fmac_f32 v233, v133, v133
v_fma_mix_f32 v234, v158, v158, v234 op_sel_hi:[1,1,0]
s_waitcnt lgkmcnt(6)
v_mfma_f32_32x32x16_bf16 v[96:111], v[60:63], v[180:183], v[96:111]
v_fmac_f32 v233, v134, v134
v_fma_mix_f32 v234, v156, v156, v234 op_sel:[1,1,0] op_sel_hi:[1,1,0]
v_fmac_f32 v233, v135, v135
v_fmac_f32 v233, v136, v136
v_fma_mix_f32 v234, v158, v158, v234 op_sel:[1,1,0] op_sel_hi:[1,1,0]
v_fma_mix_f32 v234, v144, v144, v234 op_sel_hi:[1,1,0]
v_fma_mix_f32 v234, v145, v145, v234 op_sel_hi:[1,1,0]
v_fmac_f32 v233, v137, v137
v_fma_mix_f32 v234, v146, v146, v234 op_sel_hi:[1,1,0]
v_fma_mix_f32 v234, v147, v147, v234 op_sel_hi:[1,1,0]
v_fmac_f32 v233, v138, v138
v_cvt_pkrtz_f16_f32 v161, v160, v161
v_and_b32 v161, s49, v161
v_bfe_u32 v160, v161, 2, 14
v_lshrrev_b32_e64 v161, 18, v161
ds_read_u16 v160, v160
ds_read_u16_d16_hi v161, v161
v_cvt_pk_f16_f32 v170, v170, v171
v_fmac_f32 v233, v139, v139
v_cvt_pk_f16_f32 v172, v172, v173
v_fmac_f32 v233, v140, v140
v_cvt_pk_f16_f32 v174, v174, v175
v_fmac_f32 v233, v141, v141
v_mfma_f32_32x32x16_bf16 v[112:127], v[180:183], v[84:87], v[112:127]
v_pk_fma_f16 v171, v170, v170, s48
v_fmac_f32 v233, v142, v142
v_fma_mix_f32 v234, v148, v148, v234 op_sel_hi:[1,1,0]
v_fma_mix_f32 v234, v149, v149, v234 op_sel_hi:[1,1,0]
v_fmac_f32 v233, v143, v143
v_pk_fma_f16 v173, v172, v172, s48
v_cvt_pkrtz_f16_f32 v163, v162, v163
v_and_b32 v163, s49, v163
v_bfe_u32 v162, v163, 2, 14
v_lshrrev_b32_e64 v163, 18, v163
ds_read_u16 v162, v162
ds_read_u16_d16_hi v163, v163
v_pk_fma_f16 v175, v174, v174, s48
v_pk_mul_f16 v171, v170, v171
v_fma_mix_f32 v234, v150, v150, v234 op_sel_hi:[1,1,0]
v_fma_mix_f32 v234, v151, v151, v234 op_sel_hi:[1,1,0]
v_pk_mul_f16 v173, v172, v173
s_getpc_b64 s[74:75]
Lcq7:
s_lshl_b32 s43, s40, 10
s_add_u32 s43, s43, 6144
s_min_u32 s43, s43, Lend-Lcq7-1024
s_add_u32 s74, s74, s43
s_addc_u32 s75, s75, 0
s_sub_u32 s74, s74, 16384
s_subb_u32 s75, s75, 0
s_mov_b32 m0, 163840
s_nop 0
global_load_lds_dword v250, s[74:75]
v_pk_mul_f16 v175, v174, v175
v_cvt_pkrtz_f16_f32 v165, v164, v165
v_and_b32_e64 v165, s49, v165
v_bfe_u32 v164, v165, 2, 14
v_lshrrev_b32 v165, 18, v165
ds_read_u16 v164, v164
ds_read_u16_d16_hi v165, v165
v_exp_f16_sdwa v171, v171 dst_sel:WORD_0 dst_unused:UNUSED_PRESERVE src0_sel:WORD_0
s_waitcnt lgkmcnt(5)
v_mfma_f32_32x32x16_bf16 v[96:111], v[64:67], v[184:187], v[96:111]
v_fma_mix_f32 v234, v152, v152, v234 op_sel_hi:[1,1,0]
v_fma_mix_f32 v234, v153, v153, v234 op_sel_hi:[1,1,0]
v_exp_f16_sdwa v173, v173 dst_sel:WORD_0 dst_unused:UNUSED_PRESERVE src0_sel:WORD_0
v_cvt_pkrtz_f16_f32 v167, v166, v167
v_and_b32_e64 v167, s49, v167
v_bfe_u32 v166, v167, 2, 14
v_lshrrev_b32_e64 v167, 18, v167
ds_read_u16 v166, v166
ds_read_u16_d16_hi v167, v167
v_exp_f16_sdwa v175, v175 dst_sel:WORD_0 dst_unused:UNUSED_PRESERVE src0_sel:WORD_0
v_fma_mix_f32 v234, v154, v154, v234 op_sel_hi:[1,1,0]
v_fma_mix_f32 v234, v155, v155, v234 op_sel_hi:[1,1,0]
v_exp_f16_sdwa v171, v171 dst_sel:WORD_1 dst_unused:UNUSED_PRESERVE src0_sel:WORD_1
v_mfma_f32_32x32x16_bf16 v[112:127], v[184:187], v[88:91], v[112:127]
v_exp_f16_sdwa v173, v173 dst_sel:WORD_1 dst_unused:UNUSED_PRESERVE src0_sel:WORD_1
v_cvt_pkrtz_f16_f32 v169, v168, v169
v_and_b32_e64 v169, s49, v169
v_bfe_u32 v168, v169, 2, 14
v_lshrrev_b32_e64 v169, 18, v169
ds_read_u16 v168, v168
ds_read_u16_d16_hi v169, v169
v_exp_f16_sdwa v175, v175 dst_sel:WORD_1 dst_unused:UNUSED_PRESERVE src0_sel:WORD_1
v_pk_add_f16 v171, v171, 1.0 op_sel_hi:[1,0]
v_pk_add_f16 v173, v173, 1.0 op_sel_hi:[1,0]
v_mfma_f32_32x32x16_bf16 v[96:111], v[68:71], v[188:191], v[96:111]
v_pk_add_f16 v175, v175, 1.0 op_sel_hi:[1,0]
v_rcp_f16_sdwa v171, v171 dst_sel:WORD_0 dst_unused:UNUSED_PRESERVE src0_sel:WORD_0
v_rcp_f16_sdwa v173, v173 dst_sel:WORD_0 dst_unused:UNUSED_PRESERVE src0_sel:WORD_0
v_rcp_f16_sdwa v175, v175 dst_sel:WORD_0 dst_unused:UNUSED_PRESERVE src0_sel:WORD_0
v_mfma_f32_32x32x16_bf16 v[112:127], v[188:191], v[92:95], v[112:127]
v_rcp_f16_sdwa v171, v171 dst_sel:WORD_1 dst_unused:UNUSED_PRESERVE src0_sel:WORD_1
v_rcp_f16_sdwa v173, v173 dst_sel:WORD_1 dst_unused:UNUSED_PRESERVE src0_sel:WORD_1
v_rcp_f16_sdwa v175, v175 dst_sel:WORD_1 dst_unused:UNUSED_PRESERVE src0_sel:WORD_1
s_waitcnt lgkmcnt(3)
v_or_b32 v200, v160, v161
v_pk_mul_f16 v203, v170, v171
v_pk_mul_f16 v206, v172, v173
v_pk_mul_f16 v207, v174, v175
v_cvt_pkrtz_f16_f32 v97, v96, v97
v_and_b32_e64 v97, s49, v97
v_bfe_u32 v96, v97, 2, 14
v_lshrrev_b32 v97, 18, v97
ds_read_u16 v96, v96
ds_read_u16 v97, v97
v_cvt_pk_f16_f32 v108, v108, v109
v_or_b32 v201, v162, v163
v_cvt_pk_f16_f32 v110, v110, v111
v_pk_fma_f16 v109, v108, v108, s48
v_cvt_pkrtz_f16_f32 v99, v98, v99
v_and_b32_e64 v99, s49, v99
v_bfe_u32 v98, v99, 2, 14
v_lshrrev_b32 v99, 18, v99
ds_read_u16 v98, v98
ds_read_u16 v99, v99
v_pk_fma_f16 v111, v110, v110, s48
v_or_b32 v204, v164, v165
v_pk_mul_f16 v109, v108, v109
v_pk_mul_f16 v111, v110, v111
v_cvt_pkrtz_f16_f32 v101, v100, v101
v_and_b32_e64 v101, s49, v101
v_bfe_u32 v100, v101, 2, 14
v_lshrrev_b32_e64 v101, 18, v101
ds_read_u16 v100, v100
ds_read_u16 v101, v101
v_exp_f16_sdwa v109, v109 dst_sel:WORD_0 dst_unused:UNUSED_PRESERVE src0_sel:WORD_0
s_waitcnt lgkmcnt(6)
v_or_b32 v205, v166, v167
v_exp_f16_sdwa v111, v111 dst_sel:WORD_0 dst_unused:UNUSED_PRESERVE src0_sel:WORD_0
v_cvt_pkrtz_f16_f32 v103, v102, v103
v_and_b32_e64 v103, s49, v103
v_bfe_u32 v102, v103, 2, 14
v_lshrrev_b32_e64 v103, 18, v103
ds_read_u16 v102, v102
ds_read_u16 v103, v103
v_exp_f16_sdwa v109, v109 dst_sel:WORD_1 dst_unused:UNUSED_PRESERVE src0_sel:WORD_1
v_or_b32 v202, v168, v169
v_cvt_pkrtz_f16_f32 v105, v104, v105
v_and_b32 v105, s49, v105
v_bfe_u32 v104, v105, 2, 14
v_lshrrev_b32_e64 v105, 18, v105
ds_read_u16 v104, v104
ds_read_u16 v105, v105
v_exp_f16_sdwa v111, v111 dst_sel:WORD_1 dst_unused:UNUSED_PRESERVE src0_sel:WORD_1
v_mfma_f32_32x32x16_f16 v[160:175], v[200:203], v[216:219], 0
v_cvt_pkrtz_f16_f32 v107, v106, v107
v_and_b32_e64 v107, s49, v107
v_bfe_u32 v106, v107, 2, 14
v_lshrrev_b32_e64 v107, 18, v107
ds_read_u16 v106, v106
ds_read_u16 v107, v107
v_pk_add_f16 v109, v109, 1.0 op_sel_hi:[1,0]
v_pk_add_f16 v111, v111, 1.0 op_sel_hi:[1,0]
v_rcp_f16_sdwa v109, v109 dst_sel:WORD_0 dst_unused:UNUSED_PRESERVE src0_sel:WORD_0
v_mfma_f32_32x32x16_f16 v[160:175], v[204:207], v[220:223], v[160:175]
v_permlane16_swap_b32 v200, v204
v_permlane16_swap_b32 v201, v205
v_permlane16_swap_b32 v202, v206
v_permlane16_swap_b32 v203, v207
v_rcp_f16_sdwa v111, v111 dst_sel:WORD_0 dst_unused:UNUSED_PRESERVE src0_sel:WORD_0
v_rcp_f16_sdwa v109, v109 dst_sel:WORD_1 dst_unused:UNUSED_PRESERVE src0_sel:WORD_1
v_rcp_f16_sdwa v111, v111 dst_sel:WORD_1 dst_unused:UNUSED_PRESERVE src0_sel:WORD_1
v_pk_mul_f16 v108, v108, v109
v_pk_mul_f16 v110, v110, v111
s_nop 2
v_fmac_f32 v234, v160, v160
v_fmac_f32 v234, v161, v161
v_fmac_f32 v234, v162, v162
v_fmac_f32 v234, v163, v163
v_fma_mix_f32 v235, v108, v108, v235 op_sel_hi:[1,1,0]
v_fmac_f32 v234, v164, v164
v_fmac_f32 v234, v165, v165
v_fma_mix_f32 v235, v110, v110, v235 op_sel_hi:[1,1,0]
v_fmac_f32 v234, v166, v166
v_fma_mix_f32 v235, v108, v108, v235 op_sel:[1,1,0] op_sel_hi:[1,1,0]
v_fmac_f32 v234, v167, v167
v_fmac_f32 v234, v168, v168
v_fma_mix_f32 v235, v110, v110, v235 op_sel:[1,1,0] op_sel_hi:[1,1,0]
s_waitcnt lgkmcnt(4)
v_fma_mix_f32 v235, v96, v96, v235 op_sel_hi:[1,1,0]
v_fma_mix_f32 v235, v97, v97, v235 op_sel_hi:[1,1,0]
v_fmac_f32 v234, v169, v169
v_fma_mix_f32 v235, v98, v98, v235 op_sel_hi:[1,1,0]
v_fma_mix_f32 v235, v99, v99, v235 op_sel_hi:[1,1,0]
v_fmac_f32 v234, v170, v170
v_cvt_pkrtz_f16_f32 v113, v112, v113
v_and_b32 v113, s49, v113
v_bfe_u32 v112, v113, 2, 14
v_lshrrev_b32_e64 v113, 18, v113
ds_read_u16 v112, v112
ds_read_u16_d16_hi v113, v113
v_cvt_pk_f16_f32 v122, v122, v123
v_fmac_f32 v234, v171, v171
v_cvt_pk_f16_f32 v124, v124, v125
v_fmac_f32 v234, v172, v172
v_cvt_pk_f16_f32 v126, v126, v127
v_fmac_f32 v234, v173, v173
v_pk_fma_f16 v123, v122, v122, s48
v_fmac_f32 v234, v174, v174
v_fma_mix_f32 v235, v100, v100, v235 op_sel_hi:[1,1,0]
v_fma_mix_f32 v235, v101, v101, v235 op_sel_hi:[1,1,0]
v_fmac_f32 v234, v175, v175
v_pk_fma_f16 v125, v124, v124, s48
v_cvt_pkrtz_f16_f32 v115, v114, v115
v_and_b32 v115, s49, v115
v_bfe_u32 v114, v115, 2, 14
v_lshrrev_b32_e64 v115, 18, v115
ds_read_u16 v114, v114
ds_read_u16_d16_hi v115, v115
v_pk_fma_f16 v127, v126, v126, s48
v_pk_mul_f16 v123, v122, v123
v_fma_mix_f32 v235, v102, v102, v235 op_sel_hi:[1,1,0]
v_fma_mix_f32 v235, v103, v103, v235 op_sel_hi:[1,1,0]
v_pk_mul_f16 v125, v124, v125
v_pk_mul_f16 v127, v126, v127
v_cvt_pkrtz_f16_f32 v117, v116, v117
v_and_b32_e64 v117, s49, v117
v_bfe_u32 v116, v117, 2, 14
v_lshrrev_b32 v117, 18, v117
ds_read_u16 v116, v116
ds_read_u16_d16_hi v117, v117
v_exp_f16_sdwa v123, v123 dst_sel:WORD_0 dst_unused:UNUSED_PRESERVE src0_sel:WORD_0
s_waitcnt lgkmcnt(5)
v_fma_mix_f32 v235, v104, v104, v235 op_sel_hi:[1,1,0]
v_fma_mix_f32 v235, v105, v105, v235 op_sel_hi:[1,1,0]
v_exp_f16_sdwa v125, v125 dst_sel:WORD_0 dst_unused:UNUSED_PRESERVE src0_sel:WORD_0
v_cvt_pkrtz_f16_f32 v119, v118, v119
v_and_b32_e64 v119, s49, v119
v_bfe_u32 v118, v119, 2, 14
v_lshrrev_b32_e64 v119, 18, v119
ds_read_u16 v118, v118
ds_read_u16_d16_hi v119, v119
v_exp_f16_sdwa v127, v127 dst_sel:WORD_0 dst_unused:UNUSED_PRESERVE src0_sel:WORD_0
v_fma_mix_f32 v235, v106, v106, v235 op_sel_hi:[1,1,0]
v_fma_mix_f32 v235, v107, v107, v235 op_sel_hi:[1,1,0]
v_exp_f16_sdwa v123, v123 dst_sel:WORD_1 dst_unused:UNUSED_PRESERVE src0_sel:WORD_1
v_exp_f16_sdwa v125, v125 dst_sel:WORD_1 dst_unused:UNUSED_PRESERVE src0_sel:WORD_1
v_cvt_pkrtz_f16_f32 v121, v120, v121
v_and_b32_e64 v121, s49, v121
v_bfe_u32 v120, v121, 2, 14
v_lshrrev_b32_e64 v121, 18, v121
ds_read_u16 v120, v120
ds_read_u16_d16_hi v121, v121
v_exp_f16_sdwa v127, v127 dst_sel:WORD_1 dst_unused:UNUSED_PRESERVE src0_sel:WORD_1
v_pk_add_f16 v123, v123, 1.0 op_sel_hi:[1,0]
v_pk_add_f16 v125, v125, 1.0 op_sel_hi:[1,0]
v_pk_add_f16 v127, v127, 1.0 op_sel_hi:[1,0]
v_rcp_f16_sdwa v123, v123 dst_sel:WORD_0 dst_unused:UNUSED_PRESERVE src0_sel:WORD_0
v_rcp_f16_sdwa v125, v125 dst_sel:WORD_0 dst_unused:UNUSED_PRESERVE src0_sel:WORD_0
v_rcp_f16_sdwa v127, v127 dst_sel:WORD_0 dst_unused:UNUSED_PRESERVE src0_sel:WORD_0
v_rcp_f16_sdwa v123, v123 dst_sel:WORD_1 dst_unused:UNUSED_PRESERVE src0_sel:WORD_1
v_rcp_f16_sdwa v125, v125 dst_sel:WORD_1 dst_unused:UNUSED_PRESERVE src0_sel:WORD_1
v_rcp_f16_sdwa v127, v127 dst_sel:WORD_1 dst_unused:UNUSED_PRESERVE src0_sel:WORD_1
s_waitcnt lgkmcnt(4)
v_or_b32 v208, v112, v113
v_pk_mul_f16 v211, v122, v123
v_pk_mul_f16 v214, v124, v125
v_pk_mul_f16 v215, v126, v127
v_or_b32 v209, v114, v115
v_or_b32 v212, v116, v117
s_waitcnt lgkmcnt(2)
v_or_b32 v213, v118, v119
s_waitcnt lgkmcnt(0)
v_or_b32 v210, v120, v121
s_nop 1
v_mfma_f32_32x32x16_f16 v[112:127], v[208:211], v[216:219], 0
v_mfma_f32_32x32x16_f16 v[112:127], v[212:215], v[220:223], v[112:127]
v_permlane16_swap_b32 v208, v212
v_permlane16_swap_b32 v209, v213
v_permlane16_swap_b32 v210, v214
v_permlane16_swap_b32 v211, v215
s_nop 7
v_fmac_f32 v235, v112, v112
v_fmac_f32 v235, v113, v113
v_fmac_f32 v235, v114, v114
v_fmac_f32 v235, v115, v115
v_fmac_f32 v235, v116, v116
v_fmac_f32 v235, v117, v117
v_fmac_f32 v235, v118, v118
v_fmac_f32 v235, v119, v119
v_fmac_f32 v235, v120, v120
v_fmac_f32 v235, v121, v121
v_fmac_f32 v235, v122, v122
v_fmac_f32 v235, v123, v123
v_fmac_f32 v235, v124, v124
v_fmac_f32 v235, v125, v125
v_fmac_f32 v235, v126, v126
v_fmac_f32 v235, v127, v127
s_setprio 3
v_permlane32_swap_b32 v224, v225
v_add_f32_e64 v224, v224, v225
ds_write_b32 v248, v224 offset:7168
v_permlane32_swap_b32 v226, v227
v_add_f32 v226, v226, v227
ds_write_b32 v248, v226 offset:7424
v_permlane32_swap_b32 v228, v229
v_add_f32 v228, v228, v229
ds_write_b32 v248, v228 offset:7680
v_permlane32_swap_b32 v230, v231
v_add_f32 v230, v230, v231
ds_write_b32 v248, v230 offset:7936
v_permlane32_swap_b32 v232, v233
v_add_f32 v232, v232, v233
ds_write_b32 v248, v232 offset:8192
v_permlane32_swap_b32 v234, v235
v_add_f32 v234, v234, v235
ds_write_b32 v248, v234 offset:8448
v_mov_b32_e64 v97, 1
s_waitcnt lgkmcnt(0)
s_mov_b64 exec, 1
ds_add_rtn_u32 v98, v247, v97
s_mov_b64 exec, -1
s_waitcnt lgkmcnt(0)
v_readfirstlane_b32 s43, v98
s_nop 1
s_cmp_lg_u32 s43, 7
s_cbranch_scc1 Lnopub
v_bfe_u32 v99, v250, 4, 6
v_min_u32 v99, 47, v99
v_lshlrev_b32 v100, 5, v99
v_add_u32 v100, 97280, v100
ds_read_b128 v[120:123], v100
ds_read_b128 v[124:127], v100 offset:16
ds_read_b128 v[128:131], v100 offset:9216
ds_read_b128 v[132:135], v100 offset:9232
ds_read_b128 v[136:139], v100 offset:18432
ds_read_b128 v[140:143], v100 offset:18448
ds_read_b128 v[144:147], v100 offset:27648
ds_read_b128 v[148:151], v100 offset:27664
ds_read_b128 v[152:155], v100 offset:36864
ds_read_b128 v[156:159], v100 offset:36880
ds_read_b128 v[160:163], v100 offset:46080
ds_read_b128 v[164:167], v100 offset:46096
ds_read_b128 v[168:171], v100 offset:55296
ds_read_b128 v[172:175], v100 offset:55312
ds_read_b128 v[176:179], v100 offset:64512
ds_read_b128 v[180:183], v100 offset:64528
v_lshlrev_b32_e64 v102, 13, v99
v_add_u32 v103, 4096, v102
s_waitcnt lgkmcnt(13)
v_add_f32 v120, v120, v128
v_add_f32 v121, v121, v129
v_add_f32 v122, v122, v130
v_add_f32 v123, v123, v131
s_waitcnt lgkmcnt(12)
v_add_f32 v124, v124, v132
v_add_f32 v125, v125, v133
v_add_f32 v126, v126, v134
v_add_f32 v127, v127, v135
s_waitcnt lgkmcnt(9)
v_add_f32 v136, v136, v144
v_add_f32 v137, v137, v145
v_add_f32 v138, v138, v146
v_add_f32 v139, v139, v147
s_waitcnt lgkmcnt(8)
v_add_f32 v140, v140, v148
v_add_f32 v141, v141, v149
v_add_f32 v142, v142, v150
v_add_f32 v143, v143, v151
s_waitcnt lgkmcnt(5)
v_add_f32 v152, v152, v160
v_add_f32 v153, v153, v161
v_add_f32 v154, v154, v162
v_add_f32 v155, v155, v163
s_waitcnt lgkmcnt(4)
v_add_f32 v156, v156, v164
v_add_f32 v157, v157, v165
v_add_f32 v158, v158, v166
v_add_f32 v159, v159, v167
s_waitcnt lgkmcnt(1)
v_add_f32 v168, v168, v176
v_add_f32 v169, v169, v177
v_add_f32 v170, v170, v178
v_add_f32 v171, v171, v179
s_waitcnt lgkmcnt(0)
v_add_f32 v172, v172, v180
v_add_f32 v173, v173, v181
v_add_f32 v174, v174, v182
v_add_f32 v175, v175, v183
v_add_f32 v120, v120, v136
v_add_f32 v121, v121, v137
v_add_f32 v122, v122, v138
v_add_f32 v123, v123, v139
v_add_f32 v124, v124, v140
v_add_f32 v125, v125, v141
v_add_f32 v126, v126, v142
v_add_f32 v127, v127, v143
v_add_f32 v152, v152, v168
v_add_f32 v153, v153, v169
v_add_f32 v154, v154, v170
v_add_f32 v155, v155, v171
v_add_f32 v156, v156, v172
v_add_f32 v157, v157, v173
v_add_f32 v158, v158, v174
v_add_f32 v159, v159, v175
v_add_f32 v120, v120, v152
v_add_f32 v121, v121, v153
v_add_f32 v122, v122, v154
v_add_f32 v123, v123, v155
v_add_f32 v124, v124, v156
v_add_f32 v125, v125, v157
v_add_f32 v126, v126, v158
v_add_f32 v127, v127, v159
v_min_u32 v128, -2, v120
v_min_u32 v129, -2, v121
v_min_u32 v130, -2, v122
v_min_u32 v131, -2, v123
v_min_u32 v132, -2, v124
v_min_u32 v133, -2, v125
v_min_u32_e64 v134, -2, v126
v_min_u32 v135, -2, v127
s_lshl_b32 s43, s2, 4
buffer_store_dwordx4 v[128:131], v102, s[32:35], s43 offen sc1
buffer_store_dwordx4 v[132:135], v103, s[32:35], s43 offen sc1
ds_write_b32 v247, v97 offset:4
s_waitcnt lgkmcnt(0)
s_nop 1
Lnopub:
s_mov_b32 s76, 200000
s_mov_b32 s77, 0
v_mov_b32 v246, v236
s_cmp_lg_u32 s40, 0
s_cbranch_scc1 Lnorole
v_subrev_u32 v245, 16384, v250
v_lshrrev_b32 v240, 2, v245
v_mov_b32 v242, 0
s_waitcnt vmcnt(0) lgkmcnt(0)
s_nop 4
Lpi:
buffer_load_dword v243, v242, s[36:39], 0 offen sc1
s_waitcnt vmcnt(0)
v_readfirstlane_b32 s43, v243
s_cmp_eq_u32 s76, 0
s_cbranch_scc1 Lpix
s_sub_u32 s76, s76, 1
s_cmp_lt_u32 s43, 256
s_waitcnt vmcnt(0) lgkmcnt(0)
s_nop 4
s_cbranch_scc1 Lpi
s_waitcnt vmcnt(0) lgkmcnt(0)
s_nop 4
Lpix:
v_mov_b32 v152, -1
v_mov_b32 v153, -1
v_mov_b32 v154, -1
v_mov_b32 v155, -1
v_mov_b32 v156, -1
v_mov_b32 v157, -1
v_mov_b32 v158, -1
v_mov_b32 v159, -1
v_mov_b32 v160, -1
v_mov_b32 v161, -1
v_mov_b32 v162, -1
v_mov_b32 v163, -1
v_mov_b32 v164, -1
v_mov_b32 v165, -1
v_mov_b32 v166, -1
v_mov_b32 v167, -1
s_cmp_lt_u32 s2, 96
s_cselect_b32 s77, 1, 2
s_cbranch_scc1 Lnorole
v_lshrrev_b32_e64 v241, 1, v240
buffer_load_ushort v158, v241, s[24:27], 0 offen
buffer_load_ushort v159, v241, s[24:27], 0 offen offset:128
buffer_load_ushort v160, v241, s[24:27], 0 offen offset:256
buffer_load_ushort v161, v241, s[24:27], 0 offen offset:384
buffer_load_ushort v162, v241, s[24:27], 0 offen offset:512
buffer_load_ushort v163, v241, s[24:27], 0 offen offset:640
Lnorole:
v_bfe_u32 v244, v250, 8, 2
v_lshlrev_b32_e64 v244, 3, v244
s_setprio 0
s_waitcnt lgkmcnt(0)
ds_read_b128 v[168:171], v250
ds_read_b128 v[172:175], v250 offset:1024
ds_read_b128 v[176:179], v250 offset:2048
ds_read_b128 v[180:183], v250 offset:3072
ds_read_b128 v[184:187], v250 offset:4096
ds_read_b128 v[188:191], v250 offset:5120
v_permlane16_swap_b32 v48, v52
v_permlane16_swap_b32 v49, v53
v_permlane16_swap_b32 v50, v54
v_permlane16_swap_b32 v51, v55
v_permlane16_swap_b32 v56, v60
v_permlane16_swap_b32 v57, v61
v_permlane16_swap_b32 v58, v62
v_permlane16_swap_b32 v59, v63
v_permlane16_swap_b32 v64, v68
v_permlane16_swap_b32 v65, v69
v_permlane16_swap_b32 v66, v70
v_permlane16_swap_b32 v67, v71
v_permlane16_swap_b32 v24, v28
v_permlane16_swap_b32 v25, v29
v_permlane16_swap_b32 v26, v30
v_permlane16_swap_b32 v27, v31
s_waitcnt lgkmcnt(5)
v_mfma_f32_32x32x16_bf16 v[120:135], v[168:171], v[72:75], 0
v_permlane16_swap_b32 v32, v36
v_permlane16_swap_b32 v33, v37
v_permlane16_swap_b32 v34, v38
v_permlane16_swap_b32 v35, v39
v_permlane16_swap_b32 v40, v44
v_permlane16_swap_b32 v41, v45
v_permlane16_swap_b32 v42, v46
v_permlane16_swap_b32 v43, v47
s_waitcnt lgkmcnt(4)
v_mfma_f32_32x32x16_bf16 v[120:135], v[172:175], v[76:79], v[120:135]
ds_read_b128 v[168:171], v250 offset:6144
ds_read_b128 v[172:175], v250 offset:7168
s_waitcnt lgkmcnt(5)
v_mfma_f32_32x32x16_bf16 v[120:135], v[176:179], v[80:83], v[120:135]
ds_read_b128 v[176:179], v250 offset:8192
s_waitcnt lgkmcnt(5)
v_mfma_f32_32x32x16_bf16 v[120:135], v[180:183], v[84:87], v[120:135]
ds_read_b128 v[180:183], v250 offset:9216
s_waitcnt lgkmcnt(4)
v_mfma_f32_32x32x16_bf16 v[120:135], v[184:187], v[88:91], v[120:135]
ds_read_b128 v[184:187], v250 offset:10240
v_mfma_f32_32x32x16_bf16 v[120:135], v[188:191], v[92:95], v[120:135]
s_cmp_eq_u32 s77, 0
s_cbranch_scc1 Lpp0
s_call_b64 s[78:79], Lpoll
Lpp0:
ds_read_b128 v[188:191], v250 offset:11264
s_waitcnt lgkmcnt(5)
v_mfma_f32_32x32x16_bf16 v[136:151], v[168:171], v[72:75], 0
s_getpc_b64 s[74:75]
Lcq8:
s_lshl_b32 s43, s40, 10
s_add_u32 s43, s43, 6144
s_min_u32 s43, s43, Lend-Lcq8-1024
s_add_u32 s74, s74, s43
s_addc_u32 s75, s75, 0
s_sub_u32 s74, s74, 16384
s_subb_u32 s75, s75, 0
s_mov_b32 m0, 163840
s_nop 0
global_load_lds_dword v250, s[74:75]
ds_read_b128 v[168:171], v250 offset:12288
s_waitcnt lgkmcnt(5)
v_mfma_f32_32x32x16_bf16 v[136:151], v[172:175], v[76:79], v[136:151]
v_cvt_pkrtz_f16_f32 v121, v120, v121
v_and_b32_e64 v121, s49, v121
v_bfe_u32 v120, v121, 2, 14
v_lshrrev_b32_e64 v121, 18, v121
ds_read_u16 v120, v120
ds_read_u16_d16_hi v121, v121
v_cvt_pk_f16_f32 v130, v130, v131
v_cvt_pk_f16_f32 v132, v132, v133
v_cvt_pk_f16_f32 v134, v134, v135
v_pk_fma_f16 v131, v130, v130, s48
v_pk_fma_f16 v133, v132, v132, s48
v_cvt_pkrtz_f16_f32 v123, v122, v123
v_and_b32_e64 v123, s49, v123
v_bfe_u32 v122, v123, 2, 14
v_lshrrev_b32_e64 v123, 18, v123
ds_read_u16 v122, v122
ds_read_u16_d16_hi v123, v123
v_pk_fma_f16 v135, v134, v134, s48
v_pk_mul_f16 v131, v130, v131
v_pk_mul_f16 v133, v132, v133
v_pk_mul_f16 v135, v134, v135
v_cvt_pkrtz_f16_f32 v125, v124, v125
v_and_b32_e64 v125, s49, v125
v_bfe_u32 v124, v125, 2, 14
v_lshrrev_b32_e64 v125, 18, v125
ds_read_u16 v124, v124
ds_read_u16_d16_hi v125, v125
v_exp_f16_sdwa v131, v131 dst_sel:WORD_0 dst_unused:UNUSED_PRESERVE src0_sel:WORD_0
v_exp_f16_sdwa v133, v133 dst_sel:WORD_0 dst_unused:UNUSED_PRESERVE src0_sel:WORD_0
v_cvt_pkrtz_f16_f32 v127, v126, v127
v_and_b32_e64 v127, s49, v127
v_bfe_u32 v126, v127, 2, 14
v_lshrrev_b32_e64 v127, 18, v127
ds_read_u16 v126, v126
ds_read_u16_d16_hi v127, v127
v_exp_f16_sdwa v135, v135 dst_sel:WORD_0 dst_unused:UNUSED_PRESERVE src0_sel:WORD_0
v_exp_f16_sdwa v131, v131 dst_sel:WORD_1 dst_unused:UNUSED_PRESERVE src0_sel:WORD_1
v_exp_f16_sdwa v133, v133 dst_sel:WORD_1 dst_unused:UNUSED_PRESERVE src0_sel:WORD_1
v_cvt_pkrtz_f16_f32 v129, v128, v129
v_and_b32_e64 v129, s49, v129
v_bfe_u32 v128, v129, 2, 14
v_lshrrev_b32 v129, 18, v129
ds_read_u16 v128, v128
ds_read_u16_d16_hi v129, v129
v_exp_f16_sdwa v135, v135 dst_sel:WORD_1 dst_unused:UNUSED_PRESERVE src0_sel:WORD_1
v_pk_add_f16 v131, v131, 1.0 op_sel_hi:[1,0]
s_waitcnt lgkmcnt(7)
v_mfma_f32_32x32x16_bf16 v[136:151], v[176:179], v[80:83], v[136:151]
v_pk_add_f16 v133, v133, 1.0 op_sel_hi:[1,0]
v_pk_add_f16 v135, v135, 1.0 op_sel_hi:[1,0]
v_rcp_f16_sdwa v131, v131 dst_sel:WORD_0 dst_unused:UNUSED_PRESERVE src0_sel:WORD_0
v_mfma_f32_32x32x16_bf16 v[136:151], v[180:183], v[84:87], v[136:151]
v_rcp_f16_sdwa v133, v133 dst_sel:WORD_0 dst_unused:UNUSED_PRESERVE src0_sel:WORD_0
ds_read_b128 v[172:175], v250 offset:13312
v_rcp_f16_sdwa v135, v135 dst_sel:WORD_0 dst_unused:UNUSED_PRESERVE src0_sel:WORD_0
v_mfma_f32_32x32x16_bf16 v[136:151], v[184:187], v[88:91], v[136:151]
ds_read_b128 v[176:179], v250 offset:14336
v_rcp_f16_sdwa v131, v131 dst_sel:WORD_1 dst_unused:UNUSED_PRESERVE src0_sel:WORD_1
v_rcp_f16_sdwa v133, v133 dst_sel:WORD_1 dst_unused:UNUSED_PRESERVE src0_sel:WORD_1
v_mfma_f32_32x32x16_bf16 v[136:151], v[188:191], v[92:95], v[136:151]
ds_read_b128 v[180:183], v250 offset:15360
v_rcp_f16_sdwa v135, v135 dst_sel:WORD_1 dst_unused:UNUSED_PRESERVE src0_sel:WORD_1
ds_read_b128 v[184:187], v250 offset:16384
v_or_b32 v96, v120, v121
s_cmp_eq_u32 s77, 0
s_cbranch_scc1 Lpp1
s_call_b64 s[78:79], Lpoll
Lpp1:
v_pk_mul_f16 v99, v130, v131
v_pk_mul_f16 v102, v132, v133
v_pk_mul_f16 v103, v134, v135
ds_read_b128 v[188:191], v250 offset:17408
s_waitcnt lgkmcnt(8)
v_or_b32 v97, v122, v123
v_or_b32 v100, v124, v125
s_waitcnt lgkmcnt(7)
v_or_b32 v101, v126, v127
v_permlane16_swap_b32 v96, v100
v_cvt_pkrtz_f16_f32 v137, v136, v137
v_and_b32_e64 v137, s49, v137
v_bfe_u32 v136, v137, 2, 14
v_lshrrev_b32_e64 v137, 18, v137
ds_read_u16 v136, v136
ds_read_u16_d16_hi v137, v137
v_cvt_pk_f16_f32 v146, v146, v147
v_cvt_pk_f16_f32 v148, v148, v149
v_cvt_pk_f16_f32 v150, v150, v151
v_pk_fma_f16 v147, v146, v146, s48
v_pk_fma_f16 v149, v148, v148, s48
v_cvt_pkrtz_f16_f32 v139, v138, v139
v_and_b32_e64 v139, s49, v139
v_bfe_u32 v138, v139, 2, 14
v_lshrrev_b32_e64 v139, 18, v139
ds_read_u16 v138, v138
ds_read_u16_d16_hi v139, v139
v_pk_fma_f16 v151, v150, v150, s48
v_pk_mul_f16 v147, v146, v147
v_pk_mul_f16 v149, v148, v149
v_pk_mul_f16 v151, v150, v151
v_cvt_pkrtz_f16_f32 v141, v140, v141
v_and_b32_e64 v141, s49, v141
v_bfe_u32 v140, v141, 2, 14
v_lshrrev_b32_e64 v141, 18, v141
ds_read_u16 v140, v140
ds_read_u16_d16_hi v141, v141
v_exp_f16_sdwa v147, v147 dst_sel:WORD_0 dst_unused:UNUSED_PRESERVE src0_sel:WORD_0
v_exp_f16_sdwa v149, v149 dst_sel:WORD_0 dst_unused:UNUSED_PRESERVE src0_sel:WORD_0
v_cvt_pkrtz_f16_f32 v143, v142, v143
v_and_b32_e64 v143, s49, v143
v_bfe_u32 v142, v143, 2, 14
v_lshrrev_b32_e64 v143, 18, v143
ds_read_u16 v142, v142
ds_read_u16_d16_hi v143, v143
v_exp_f16_sdwa v151, v151 dst_sel:WORD_0 dst_unused:UNUSED_PRESERVE src0_sel:WORD_0
s_waitcnt lgkmcnt(8)
v_or_b32 v98, v128, v129
v_exp_f16_sdwa v147, v147 dst_sel:WORD_1 dst_unused:UNUSED_PRESERVE src0_sel:WORD_1
v_mfma_f32_32x32x16_bf16 v[120:135], v[168:171], v[72:75], 0
s_setprio 3
v_exp_f16_sdwa v149, v149 dst_sel:WORD_1 dst_unused:UNUSED_PRESERVE src0_sel:WORD_1
v_cvt_pkrtz_f16_f32 v145, v144, v145
v_and_b32 v145, s49, v145
v_bfe_u32 v144, v145, 2, 14
v_lshrrev_b32 v145, 18, v145
ds_read_u16 v144, v144
ds_read_u16_d16_hi v145, v145
v_permlane16_swap_b32 v97, v101
v_permlane16_swap_b32 v98, v102
v_permlane16_swap_b32 v99, v103
v_mfma_f32_32x32x16_bf16 v[120:135], v[172:175], v[76:79], v[120:135]
v_exp_f16_sdwa v151, v151 dst_sel:WORD_1 dst_unused:UNUSED_PRESERVE src0_sel:WORD_1
v_pk_add_f16 v147, v147, 1.0 op_sel_hi:[1,0]
v_pk_add_f16 v149, v149, 1.0 op_sel_hi:[1,0]
v_mfma_f32_32x32x16_bf16 v[120:135], v[176:179], v[80:83], v[120:135]
v_pk_add_f16 v151, v151, 1.0 op_sel_hi:[1,0]
ds_read_b128 v[168:171], v250 offset:18432
v_rcp_f16_sdwa v147, v147 dst_sel:WORD_0 dst_unused:UNUSED_PRESERVE src0_sel:WORD_0
v_rcp_f16_sdwa v149, v149 dst_sel:WORD_0 dst_unused:UNUSED_PRESERVE src0_sel:WORD_0
v_mfma_f32_32x32x16_bf16 v[120:135], v[180:183], v[84:87], v[120:135]
ds_read_b128 v[172:175], v250 offset:19456
v_rcp_f16_sdwa v151, v151 dst_sel:WORD_0 dst_unused:UNUSED_PRESERVE src0_sel:WORD_0
ds_read_b128 v[176:179], v250 offset:20480
v_rcp_f16_sdwa v147, v147 dst_sel:WORD_1 dst_unused:UNUSED_PRESERVE src0_sel:WORD_1
v_mfma_f32_32x32x16_bf16 v[120:135], v[184:187], v[88:91], v[120:135]
v_rcp_f16_sdwa v149, v149 dst_sel:WORD_1 dst_unused:UNUSED_PRESERVE src0_sel:WORD_1
ds_read_b128 v[180:183], v250 offset:21504
v_rcp_f16_sdwa v151, v151 dst_sel:WORD_1 dst_unused:UNUSED_PRESERVE src0_sel:WORD_1
v_mfma_f32_32x32x16_bf16 v[120:135], v[188:191], v[92:95], v[120:135]
s_setprio 2
s_waitcnt lgkmcnt(7)
v_or_b32 v104, v136, v137
s_cmp_eq_u32 s77, 0
s_cbranch_scc1 Lpp2
s_call_b64 s[78:79], Lpoll
Lpp2:
ds_read_b128 v[184:187], v250 offset:22528
v_pk_mul_f16 v107, v146, v147
v_pk_mul_f16 v110, v148, v149
v_pk_mul_f16 v111, v150, v151
ds_read_b128 v[188:191], v250 offset:23552
v_or_b32 v105, v138, v139
v_or_b32 v108, v140, v141
s_waitcnt lgkmcnt(8)
v_or_b32 v109, v142, v143
s_waitcnt lgkmcnt(6)
v_or_b32 v106, v144, v145
v_permlane16_swap_b32 v104, v108
v_permlane16_swap_b32 v105, v109
v_cvt_pkrtz_f16_f32 v121, v120, v121
v_and_b32_e64 v121, s49, v121
v_bfe_u32 v120, v121, 2, 14
v_lshrrev_b32_e64 v121, 18, v121
ds_read_u16 v120, v120
ds_read_u16_d16_hi v121, v121
v_cvt_pk_f16_f32 v130, v130, v131
v_cvt_pk_f16_f32 v132, v132, v133
v_cvt_pk_f16_f32 v134, v134, v135
v_pk_fma_f16 v131, v130, v130, s48
v_pk_fma_f16 v133, v132, v132, s48
v_cvt_pkrtz_f16_f32 v123, v122, v123
v_and_b32_e64 v123, s49, v123
v_bfe_u32 v122, v123, 2, 14
v_lshrrev_b32_e64 v123, 18, v123
ds_read_u16 v122, v122
ds_read_u16_d16_hi v123, v123
v_pk_fma_f16 v135, v134, v134, s48
v_pk_mul_f16 v131, v130, v131
v_pk_mul_f16 v133, v132, v133
v_pk_mul_f16 v135, v134, v135
v_cvt_pkrtz_f16_f32 v125, v124, v125
v_and_b32_e64 v125, s49, v125
v_bfe_u32 v124, v125, 2, 14
v_lshrrev_b32_e64 v125, 18, v125
ds_read_u16 v124, v124
ds_read_u16_d16_hi v125, v125
v_exp_f16_sdwa v131, v131 dst_sel:WORD_0 dst_unused:UNUSED_PRESERVE src0_sel:WORD_0
v_exp_f16_sdwa v133, v133 dst_sel:WORD_0 dst_unused:UNUSED_PRESERVE src0_sel:WORD_0
s_setprio 1
v_cvt_pkrtz_f16_f32 v127, v126, v127
v_and_b32 v127, s49, v127
v_bfe_u32 v126, v127, 2, 14
v_lshrrev_b32_e64 v127, 18, v127
ds_read_u16 v126, v126
ds_read_u16_d16_hi v127, v127
v_exp_f16_sdwa v135, v135 dst_sel:WORD_0 dst_unused:UNUSED_PRESERVE src0_sel:WORD_0
v_exp_f16_sdwa v131, v131 dst_sel:WORD_1 dst_unused:UNUSED_PRESERVE src0_sel:WORD_1
s_waitcnt lgkmcnt(7)
v_mfma_f32_32x32x16_bf16 v[136:151], v[168:171], v[72:75], 0
v_mov_b32_e64 v249, 0
s_branch Law6
Lax6:
s_sleep 2
Law6:
ds_read_b32 v249, v247 offset:4
s_sub_u32 s76, s76, 1
s_cselect_b32 s44, 1, 0
s_cselect_b32 s76, 0, s76
s_waitcnt lgkmcnt(0)
v_readfirstlane_b32 s43, v249
s_nop 1
s_max_u32 s43, s43, s44
s_cmp_lt_u32 s43, 1
s_cbranch_scc1 Lax6
s_add_u32 m0, s72, 7168
s_add_u32 s43, s82, 6208
buffer_load_dwordx4 v246, s[16:19], s43 offen lds
s_add_u32 m0, s72, 8192
s_add_u32 s43, s82, 6272
buffer_load_dwordx4 v246, s[16:19], s43 offen lds
v_exp_f16_sdwa v133, v133 dst_sel:WORD_1 dst_unused:UNUSED_PRESERVE src0_sel:WORD_1
v_cvt_pkrtz_f16_f32 v129, v128, v129
v_and_b32_e64 v129, s49, v129
v_bfe_u32 v128, v129, 2, 14
v_lshrrev_b32_e64 v129, 18, v129
ds_read_u16 v128, v128
ds_read_u16_d16_hi v129, v129
v_permlane16_swap_b32 v106, v110
v_permlane16_swap_b32 v107, v111
v_mfma_f32_32x32x16_bf16 v[136:151], v[172:175], v[76:79], v[136:151]
v_exp_f16_sdwa v135, v135 dst_sel:WORD_1 dst_unused:UNUSED_PRESERVE src0_sel:WORD_1
v_pk_add_f16 v131, v131, 1.0 op_sel_hi:[1,0]
v_pk_add_f16 v133, v133, 1.0 op_sel_hi:[1,0]
v_mfma_f32_32x32x16_bf16 v[136:151], v[176:179], v[80:83], v[136:151]
v_pk_add_f16 v135, v135, 1.0 op_sel_hi:[1,0]
ds_read_b128 v[168:171], v250 offset:24576
v_rcp_f16_sdwa v131, v131 dst_sel:WORD_0 dst_unused:UNUSED_PRESERVE src0_sel:WORD_0
v_rcp_f16_sdwa v133, v133 dst_sel:WORD_0 dst_unused:UNUSED_PRESERVE src0_sel:WORD_0
v_mfma_f32_32x32x16_bf16 v[136:151], v[180:183], v[84:87], v[136:151]
ds_read_b128 v[172:175], v250 offset:25600
v_rcp_f16_sdwa v135, v135 dst_sel:WORD_0 dst_unused:UNUSED_PRESERVE src0_sel:WORD_0
ds_read_b128 v[176:179], v250 offset:26624
v_rcp_f16_sdwa v131, v131 dst_sel:WORD_1 dst_unused:UNUSED_PRESERVE src0_sel:WORD_1
v_mfma_f32_32x32x16_bf16 v[136:151], v[184:187], v[88:91], v[136:151]
s_setprio 0
v_rcp_f16_sdwa v133, v133 dst_sel:WORD_1 dst_unused:UNUSED_PRESERVE src0_sel:WORD_1
ds_read_b128 v[180:183], v250 offset:27648
v_rcp_f16_sdwa v135, v135 dst_sel:WORD_1 dst_unused:UNUSED_PRESERVE src0_sel:WORD_1
v_mfma_f32_32x32x16_bf16 v[136:151], v[188:191], v[92:95], v[136:151]
v_or_b32 v112, v120, v121
s_cmp_eq_u32 s77, 0
s_cbranch_scc1 Lpp3
s_call_b64 s[78:79], Lpoll
Lpp3:
ds_read_b128 v[184:187], v250 offset:28672
v_pk_mul_f16 v115, v130, v131
v_pk_mul_f16 v118, v132, v133
v_pk_mul_f16 v119, v134, v135
ds_read_b128 v[188:191], v250 offset:29696
v_or_b32 v113, v122, v123
v_or_b32 v116, v124, v125
v_or_b32 v117, v126, v127
s_waitcnt lgkmcnt(5)
v_or_b32 v114, v128, v129
v_mfma_f32_32x32x16_bf16 v[120:135], v[168:171], v[72:75], 0
v_cvt_pkrtz_f16_f32 v137, v136, v137
v_and_b32_e64 v137, s49, v137
v_bfe_u32 v136, v137, 2, 14
v_lshrrev_b32_e64 v137, 18, v137
ds_read_u16 v136, v136
ds_read_u16_d16_hi v137, v137
v_cvt_pk_f16_f32 v146, v146, v147
v_cvt_pk_f16_f32 v148, v148, v149
v_cvt_pk_f16_f32 v150, v150, v151
v_pk_fma_f16 v147, v146, v146, s48
v_pk_fma_f16 v149, v148, v148, s48
v_cvt_pkrtz_f16_f32 v139, v138, v139
v_and_b32_e64 v139, s49, v139
v_bfe_u32 v138, v139, 2, 14
v_lshrrev_b32_e64 v139, 18, v139
ds_read_u16 v138, v138
ds_read_u16_d16_hi v139, v139
v_pk_fma_f16 v151, v150, v150, s48
v_pk_mul_f16 v147, v146, v147
s_setprio 3
v_pk_mul_f16 v149, v148, v149
v_pk_mul_f16 v151, v150, v151
v_cvt_pkrtz_f16_f32 v141, v140, v141
v_and_b32 v141, s49, v141
v_bfe_u32 v140, v141, 2, 14
v_lshrrev_b32_e64 v141, 18, v141
ds_read_u16 v140, v140
ds_read_u16_d16_hi v141, v141
v_exp_f16_sdwa v147, v147 dst_sel:WORD_0 dst_unused:UNUSED_PRESERVE src0_sel:WORD_0
v_exp_f16_sdwa v149, v149 dst_sel:WORD_0 dst_unused:UNUSED_PRESERVE src0_sel:WORD_0
v_cvt_pkrtz_f16_f32 v143, v142, v143
v_and_b32_e64 v143, s49, v143
v_bfe_u32 v142, v143, 2, 14
v_lshrrev_b32_e64 v143, 18, v143
ds_read_u16 v142, v142
ds_read_u16_d16_hi v143, v143
v_exp_f16_sdwa v151, v151 dst_sel:WORD_0 dst_unused:UNUSED_PRESERVE src0_sel:WORD_0
v_exp_f16_sdwa v147, v147 dst_sel:WORD_1 dst_unused:UNUSED_PRESERVE src0_sel:WORD_1
v_exp_f16_sdwa v149, v149 dst_sel:WORD_1 dst_unused:UNUSED_PRESERVE src0_sel:WORD_1
v_cvt_pkrtz_f16_f32 v145, v144, v145
v_and_b32_e64 v145, s49, v145
v_bfe_u32 v144, v145, 2, 14
v_lshrrev_b32_e64 v145, 18, v145
ds_read_u16 v144, v144
ds_read_u16_d16_hi v145, v145
v_permlane16_swap_b32 v112, v116
v_permlane16_swap_b32 v113, v117
v_permlane16_swap_b32 v114, v118
v_permlane16_swap_b32 v115, v119
s_waitcnt lgkmcnt(7)
v_mfma_f32_32x32x16_bf16 v[120:135], v[172:175], v[76:79], v[120:135]
v_exp_f16_sdwa v151, v151 dst_sel:WORD_1 dst_unused:UNUSED_PRESERVE src0_sel:WORD_1
v_pk_add_f16 v147, v147, 1.0 op_sel_hi:[1,0]
v_pk_add_f16 v149, v149, 1.0 op_sel_hi:[1,0]
v_mfma_f32_32x32x16_bf16 v[120:135], v[176:179], v[80:83], v[120:135]
v_pk_add_f16 v151, v151, 1.0 op_sel_hi:[1,0]
ds_read_b128 v[168:171], v250 offset:30720
s_setprio 2
v_rcp_f16_sdwa v147, v147 dst_sel:WORD_0 dst_unused:UNUSED_PRESERVE src0_sel:WORD_0
v_mfma_f32_32x32x16_bf16 v[120:135], v[180:183], v[84:87], v[120:135]
v_rcp_f16_sdwa v149, v149 dst_sel:WORD_0 dst_unused:UNUSED_PRESERVE src0_sel:WORD_0
ds_read_b128 v[172:175], v250 offset:31744
v_rcp_f16_sdwa v151, v151 dst_sel:WORD_0 dst_unused:UNUSED_PRESERVE src0_sel:WORD_0
v_mfma_f32_32x32x16_bf16 v[120:135], v[184:187], v[88:91], v[120:135]
ds_read_b128 v[176:179], v250 offset:32768
v_rcp_f16_sdwa v147, v147 dst_sel:WORD_1 dst_unused:UNUSED_PRESERVE src0_sel:WORD_1
v_rcp_f16_sdwa v149, v149 dst_sel:WORD_1 dst_unused:UNUSED_PRESERVE src0_sel:WORD_1
v_mfma_f32_32x32x16_bf16 v[120:135], v[188:191], v[92:95], v[120:135]
ds_read_b128 v[180:183], v250 offset:33792
v_rcp_f16_sdwa v151, v151 dst_sel:WORD_1 dst_unused:UNUSED_PRESERVE src0_sel:WORD_1
v_or_b32 v216, v136, v137
s_cmp_eq_u32 s77, 0
s_cbranch_scc1 Lpp4
s_call_b64 s[78:79], Lpoll
Lpp4:
ds_read_b128 v[184:187], v250 offset:34816
v_pk_mul_f16 v219, v146, v147
v_pk_mul_f16 v222, v148, v149
v_pk_mul_f16 v223, v150, v151
ds_read_b128 v[188:191], v250 offset:35840
s_waitcnt lgkmcnt(8)
v_or_b32 v217, v138, v139
v_or_b32 v220, v140, v141
v_or_b32 v221, v142, v143
s_waitcnt lgkmcnt(6)
v_or_b32 v218, v144, v145
v_cvt_pkrtz_f16_f32 v121, v120, v121
v_and_b32_e64 v121, s49, v121
v_bfe_u32 v120, v121, 2, 14
v_lshrrev_b32 v121, 18, v121
ds_read_u16 v120, v120
ds_read_u16_d16_hi v121, v121
v_cvt_pk_f16_f32 v130, v130, v131
v_cvt_pk_f16_f32 v132, v132, v133
s_setprio 1
v_cvt_pk_f16_f32 v134, v134, v135
v_pk_fma_f16 v131, v130, v130, s48
v_pk_fma_f16 v133, v132, v132, s48
v_cvt_pkrtz_f16_f32 v123, v122, v123
v_and_b32_e64 v123, s49, v123
v_bfe_u32 v122, v123, 2, 14
v_lshrrev_b32_e64 v123, 18, v123
ds_read_u16 v122, v122
ds_read_u16_d16_hi v123, v123
v_pk_fma_f16 v135, v134, v134, s48
v_pk_mul_f16 v131, v130, v131
v_pk_mul_f16 v133, v132, v133
v_pk_mul_f16 v135, v134, v135
v_cvt_pkrtz_f16_f32 v125, v124, v125
v_and_b32_e64 v125, s49, v125
v_bfe_u32 v124, v125, 2, 14
v_lshrrev_b32_e64 v125, 18, v125
ds_read_u16 v124, v124
ds_read_u16_d16_hi v125, v125
v_exp_f16_sdwa v131, v131 dst_sel:WORD_0 dst_unused:UNUSED_PRESERVE src0_sel:WORD_0
v_exp_f16_sdwa v133, v133 dst_sel:WORD_0 dst_unused:UNUSED_PRESERVE src0_sel:WORD_0
v_cvt_pkrtz_f16_f32 v127, v126, v127
v_and_b32_e64 v127, s49, v127
v_bfe_u32 v126, v127, 2, 14
v_lshrrev_b32 v127, 18, v127
ds_read_u16 v126, v126
ds_read_u16_d16_hi v127, v127
v_exp_f16_sdwa v135, v135 dst_sel:WORD_0 dst_unused:UNUSED_PRESERVE src0_sel:WORD_0
v_exp_f16_sdwa v131, v131 dst_sel:WORD_1 dst_unused:UNUSED_PRESERVE src0_sel:WORD_1
s_waitcnt lgkmcnt(7)
v_mfma_f32_32x32x16_bf16 v[136:151], v[168:171], v[72:75], 0
s_getpc_b64 s[74:75]
Lcq9:
s_lshl_b32 s43, s40, 10
s_add_u32 s43, s43, 6144
s_min_u32 s43, s43, Lend-Lcq9-1024
s_add_u32 s74, s74, s43
s_addc_u32 s75, s75, 0
s_sub_u32 s74, s74, 16384
s_subb_u32 s75, s75, 0
s_mov_b32 m0, 163840
s_nop 0
global_load_lds_dword v250, s[74:75]
v_exp_f16_sdwa v133, v133 dst_sel:WORD_1 dst_unused:UNUSED_PRESERVE src0_sel:WORD_1
v_cvt_pkrtz_f16_f32 v129, v128, v129
v_and_b32_e64 v129, s49, v129
v_bfe_u32 v128, v129, 2, 14
v_lshrrev_b32 v129, 18, v129
ds_read_u16 v128, v128
ds_read_u16_d16_hi v129, v129
v_permlane16_swap_b32 v216, v220
v_permlane16_swap_b32 v217, v221
v_permlane16_swap_b32 v218, v222
v_permlane16_swap_b32 v219, v223
v_mfma_f32_32x32x16_bf16 v[136:151], v[172:175], v[76:79], v[136:151]
v_exp_f16_sdwa v135, v135 dst_sel:WORD_1 dst_unused:UNUSED_PRESERVE src0_sel:WORD_1
s_setprio 0
v_pk_add_f16 v131, v131, 1.0 op_sel_hi:[1,0]
v_pk_add_f16 v133, v133, 1.0 op_sel_hi:[1,0]
v_mfma_f32_32x32x16_bf16 v[136:151], v[176:179], v[80:83], v[136:151]
v_pk_add_f16 v135, v135, 1.0 op_sel_hi:[1,0]
v_rcp_f16_sdwa v131, v131 dst_sel:WORD_0 dst_unused:UNUSED_PRESERVE src0_sel:WORD_0
v_rcp_f16_sdwa v133, v133 dst_sel:WORD_0 dst_unused:UNUSED_PRESERVE src0_sel:WORD_0
v_mfma_f32_32x32x16_bf16 v[136:151], v[180:183], v[84:87], v[136:151]
v_rcp_f16_sdwa v135, v135 dst_sel:WORD_0 dst_unused:UNUSED_PRESERVE src0_sel:WORD_0
v_rcp_f16_sdwa v131, v131 dst_sel:WORD_1 dst_unused:UNUSED_PRESERVE src0_sel:WORD_1
v_mfma_f32_32x32x16_bf16 v[136:151], v[184:187], v[88:91], v[136:151]
v_rcp_f16_sdwa v133, v133 dst_sel:WORD_1 dst_unused:UNUSED_PRESERVE src0_sel:WORD_1
v_rcp_f16_sdwa v135, v135 dst_sel:WORD_1 dst_unused:UNUSED_PRESERVE src0_sel:WORD_1
v_mfma_f32_32x32x16_bf16 v[136:151], v[188:191], v[92:95], v[136:151]
s_cmp_eq_u32 s77, 0
s_cbranch_scc1 Lpp5
s_call_b64 s[78:79], Lpoll
Lpp5:
s_waitcnt lgkmcnt(3)
v_or_b32 v224, v120, v121
v_pk_mul_f16 v227, v130, v131
s_setprio 3
v_pk_mul_f16 v230, v132, v133
v_pk_mul_f16 v231, v134, v135
v_or_b32 v225, v122, v123
v_or_b32 v228, v124, v125
s_waitcnt lgkmcnt(2)
v_or_b32 v229, v126, v127
v_permlane16_swap_b32 v224, v228
s_waitcnt lgkmcnt(0)
v_or_b32 v226, v128, v129
v_permlane16_swap_b32 v225, v229
s_nop 0
v_permlane16_swap_b32 v226, v230
v_permlane16_swap_b32 v227, v231
v_cvt_pkrtz_f16_f32 v137, v136, v137
v_and_b32 v137, s49, v137
v_bfe_u32 v136, v137, 2, 14
v_lshrrev_b32_e64 v137, 18, v137
ds_read_u16 v136, v136
ds_read_u16_d16_hi v137, v137
v_cvt_pk_f16_f32 v146, v146, v147
v_cvt_pk_f16_f32 v148, v148, v149
v_cvt_pk_f16_f32 v150, v150, v151
v_pk_fma_f16 v147, v146, v146, s48
v_pk_fma_f16 v149, v148, v148, s48
v_cvt_pkrtz_f16_f32 v139, v138, v139
v_and_b32_e64 v139, s49, v139
v_bfe_u32 v138, v139, 2, 14
v_lshrrev_b32_e64 v139, 18, v139
ds_read_u16 v138, v138
ds_read_u16_d16_hi v139, v139
v_pk_fma_f16 v151, v150, v150, s48
v_pk_mul_f16 v147, v146, v147
v_pk_mul_f16 v149, v148, v149
v_pk_mul_f16 v151, v150, v151
v_cvt_pkrtz_f16_f32 v141, v140, v141
v_and_b32_e64 v141, s49, v141
v_bfe_u32 v140, v141, 2, 14
v_lshrrev_b32_e64 v141, 18, v141
ds_read_u16 v140, v140
ds_read_u16_d16_hi v141, v141
v_exp_f16_sdwa v147, v147 dst_sel:WORD_0 dst_unused:UNUSED_PRESERVE src0_sel:WORD_0
v_exp_f16_sdwa v149, v149 dst_sel:WORD_0 dst_unused:UNUSED_PRESERVE src0_sel:WORD_0
v_cvt_pkrtz_f16_f32 v143, v142, v143
v_and_b32_e64 v143, s49, v143
v_bfe_u32 v142, v143, 2, 14
v_lshrrev_b32 v143, 18, v143
ds_read_u16 v142, v142
ds_read_u16_d16_hi v143, v143
v_exp_f16_sdwa v151, v151 dst_sel:WORD_0 dst_unused:UNUSED_PRESERVE src0_sel:WORD_0
s_setprio 2
v_exp_f16_sdwa v147, v147 dst_sel:WORD_1 dst_unused:UNUSED_PRESERVE src0_sel:WORD_1
s_mul_i32 s43, s40, 96
buffer_load_dwordx2 v[72:73], v244, s[28:31], s43 offen
buffer_load_dwordx2 v[74:75], v244, s[28:31], s43 offen offset:32
buffer_load_dwordx2 v[76:77], v244, s[28:31], s43 offen offset:64
v_exp_f16_sdwa v149, v149 dst_sel:WORD_1 dst_unused:UNUSED_PRESERVE src0_sel:WORD_1
v_cvt_pkrtz_f16_f32 v145, v144, v145
v_and_b32_e64 v145, s49, v145
v_bfe_u32 v144, v145, 2, 14
v_lshrrev_b32_e64 v145, 18, v145
ds_read_u16 v144, v144
ds_read_u16_d16_hi v145, v145
v_exp_f16_sdwa v151, v151 dst_sel:WORD_1 dst_unused:UNUSED_PRESERVE src0_sel:WORD_1
v_pk_add_f16 v147, v147, 1.0 op_sel_hi:[1,0]
v_pk_add_f16 v149, v149, 1.0 op_sel_hi:[1,0]
v_pk_add_f16 v151, v151, 1.0 op_sel_hi:[1,0]
v_rcp_f16_sdwa v147, v147 dst_sel:WORD_0 dst_unused:UNUSED_PRESERVE src0_sel:WORD_0
v_rcp_f16_sdwa v149, v149 dst_sel:WORD_0 dst_unused:UNUSED_PRESERVE src0_sel:WORD_0
v_rcp_f16_sdwa v151, v151 dst_sel:WORD_0 dst_unused:UNUSED_PRESERVE src0_sel:WORD_0
v_rcp_f16_sdwa v147, v147 dst_sel:WORD_1 dst_unused:UNUSED_PRESERVE src0_sel:WORD_1
s_setprio 1
v_rcp_f16_sdwa v149, v149 dst_sel:WORD_1 dst_unused:UNUSED_PRESERVE src0_sel:WORD_1
v_rcp_f16_sdwa v151, v151 dst_sel:WORD_1 dst_unused:UNUSED_PRESERVE src0_sel:WORD_1
s_waitcnt lgkmcnt(5)
v_or_b32 v232, v136, v137
v_pk_mul_f16 v235, v146, v147
v_pk_mul_f16 v238, v148, v149
v_pk_mul_f16 v239, v150, v151
v_or_b32 v233, v138, v139
s_waitcnt lgkmcnt(4)
v_or_b32 v236, v140, v141
s_nop 1
v_permlane16_swap_b32 v232, v236
v_permlane16_swap_b32 v235, v239
s_waitcnt lgkmcnt(2)
v_or_b32 v237, v142, v143
s_setprio 0
s_nop 0
v_permlane16_swap_b32 v233, v237
s_waitcnt lgkmcnt(0)
v_or_b32 v234, v144, v145
s_nop 1
v_permlane16_swap_b32 v234, v238
s_setprio 2
v_bfe_u32 v92, v250, 4, 6
v_lshl_add_u32 v88, v92, 4, s72
s_waitcnt vmcnt(4)
ds_read_b64_tr_b16 v[120:121], v88
ds_read_b64_tr_b16 v[122:123], v88 offset:8
ds_read_b64_tr_b16 v[124:125], v88 offset:1024
ds_read_b64_tr_b16 v[126:127], v88 offset:1032
ds_read_b64_tr_b16 v[128:129], v88 offset:2048
ds_read_b64_tr_b16 v[130:131], v88 offset:2056
ds_read_b64_tr_b16 v[132:133], v88 offset:3072
ds_read_b64_tr_b16 v[134:135], v88 offset:3080
ds_read_b64_tr_b16 v[136:137], v88 offset:4096
ds_read_b64_tr_b16 v[138:139], v88 offset:4104
ds_read_b64_tr_b16 v[140:141], v88 offset:5120
ds_read_b64_tr_b16 v[142:143], v88 offset:5128
ds_read_b64_tr_b16 v[144:145], v88 offset:6144
ds_read_b64_tr_b16 v[146:147], v88 offset:6152
ds_read_b64_tr_b16 v[148:149], v88 offset:7168
ds_read_b64_tr_b16 v[150:151], v88 offset:7176
ds_read_b64_tr_b16 v[84:85], v88 offset:8192
ds_read_b64_tr_b16 v[86:87], v88 offset:8200
s_mul_i32 s43, s40, 3
s_add_u32 s43, s43, 0
s_and_b32 s44, s43, 1
s_mul_i32 s44, s44, 3064
s_mul_i32 s43, s43, 3072
s_sub_u32 s43, s43, s44
s_add_u32 s43, s43, 90112
v_lshl_add_u32 v89, v92, 4, s43
s_mul_i32 s43, s40, 3
s_add_u32 s43, s43, 1
s_and_b32 s44, s43, 1
s_mul_i32 s44, s44, 3064
s_mul_i32 s43, s43, 3072
s_sub_u32 s43, s43, s44
s_add_u32 s43, s43, 90112
v_lshl_add_u32 v94, v92, 4, s43
s_mul_i32 s43, s40, 3
s_add_u32 s43, s43, 2
s_and_b32 s44, s43, 1
s_mul_i32 s44, s44, 3064
s_mul_i32 s43, s43, 3072
s_sub_u32 s43, s43, s44
s_add_u32 s43, s43, 90112
v_lshl_add_u32 v95, v92, 4, s43
v_lshl_add_u32 v91, v244, 2, s72
s_waitcnt lgkmcnt(0)
s_waitcnt vmcnt(2)
v_mfma_f32_16x16x16_bf16 v[168:171], v[120:121], v[72:73], 0
v_mfma_f32_16x16x16_bf16 v[172:175], v[122:123], v[72:73], 0
v_mfma_f32_16x16x16_bf16 v[176:179], v[124:125], v[72:73], 0
v_mfma_f32_16x16x16_bf16 v[180:183], v[126:127], v[72:73], 0
v_mfma_f32_16x16x16_bf16 v[184:187], v[128:129], v[72:73], 0
v_mfma_f32_16x16x16_bf16 v[188:191], v[130:131], v[72:73], 0
s_waitcnt vmcnt(1)
v_mfma_f32_16x16x16_bf16 v[168:171], v[132:133], v[74:75], v[168:171]
v_mfma_f32_16x16x16_bf16 v[172:175], v[134:135], v[74:75], v[172:175]
v_mfma_f32_16x16x16_bf16 v[176:179], v[136:137], v[74:75], v[176:179]
v_mfma_f32_16x16x16_bf16 v[180:183], v[138:139], v[74:75], v[180:183]
v_mfma_f32_16x16x16_bf16 v[184:187], v[140:141], v[74:75], v[184:187]
v_mfma_f32_16x16x16_bf16 v[188:191], v[142:143], v[74:75], v[188:191]
s_waitcnt vmcnt(0)
v_mfma_f32_16x16x16_bf16 v[168:171], v[144:145], v[76:77], v[168:171]
v_mfma_f32_16x16x16_bf16 v[172:175], v[146:147], v[76:77], v[172:175]
v_mfma_f32_16x16x16_bf16 v[176:179], v[148:149], v[76:77], v[176:179]
v_mfma_f32_16x16x16_bf16 v[180:183], v[150:151], v[76:77], v[180:183]
v_mfma_f32_16x16x16_bf16 v[184:187], v[84:85], v[76:77], v[184:187]
v_mfma_f32_16x16x16_bf16 v[188:191], v[86:87], v[76:77], v[188:191]
v_lshlrev_b32_e64 v78, 16, v120
v_and_b32 v79, 4294901760, v120
v_cvt_pk_f16_f32 v120, v78, v79
v_lshlrev_b32_e64 v80, 16, v121
v_and_b32 v81, 4294901760, v121
v_cvt_pk_f16_f32 v121, v80, v81
v_lshlrev_b32_e64 v78, 16, v122
v_and_b32 v79, 4294901760, v122
v_cvt_pk_f16_f32 v122, v78, v79
v_lshlrev_b32_e64 v80, 16, v123
v_and_b32 v81, 4294901760, v123
v_cvt_pk_f16_f32 v123, v80, v81
v_lshlrev_b32_e64 v78, 16, v124
v_and_b32 v79, 4294901760, v124
v_cvt_pk_f16_f32 v124, v78, v79
v_lshlrev_b32_e64 v80, 16, v125
v_and_b32 v81, 4294901760, v125
v_cvt_pk_f16_f32 v125, v80, v81
v_lshlrev_b32_e64 v78, 16, v126
v_and_b32 v79, 4294901760, v126
v_cvt_pk_f16_f32 v126, v78, v79
v_lshlrev_b32_e64 v80, 16, v127
v_and_b32 v81, 4294901760, v127
v_cvt_pk_f16_f32 v127, v80, v81
v_lshlrev_b32_e64 v78, 16, v128
v_and_b32 v79, 4294901760, v128
v_cvt_pk_f16_f32 v128, v78, v79
v_lshlrev_b32_e64 v80, 16, v129
v_and_b32 v81, 4294901760, v129
v_cvt_pk_f16_f32 v129, v80, v81
v_lshlrev_b32_e64 v78, 16, v130
v_and_b32 v79, 4294901760, v130
v_cvt_pk_f16_f32 v130, v78, v79
v_lshlrev_b32_e64 v80, 16, v131
v_and_b32 v81, 4294901760, v131
v_cvt_pk_f16_f32 v131, v80, v81
v_lshlrev_b32_e64 v78, 16, v132
v_and_b32 v79, 4294901760, v132
v_cvt_pk_f16_f32 v132, v78, v79
v_lshlrev_b32_e64 v80, 16, v133
v_and_b32 v81, 4294901760, v133
v_cvt_pk_f16_f32 v133, v80, v81
v_lshlrev_b32_e64 v78, 16, v134
v_and_b32 v79, 4294901760, v134
v_cvt_pk_f16_f32 v134, v78, v79
v_lshlrev_b32_e64 v80, 16, v135
v_and_b32 v81, 4294901760, v135
v_cvt_pk_f16_f32 v135, v80, v81
v_lshlrev_b32_e64 v78, 16, v136
v_and_b32 v79, 4294901760, v136
v_cvt_pk_f16_f32 v136, v78, v79
v_lshlrev_b32_e64 v80, 16, v137
v_and_b32 v81, 4294901760, v137
v_cvt_pk_f16_f32 v137, v80, v81
v_lshlrev_b32_e64 v78, 16, v138
v_and_b32 v79, 4294901760, v138
v_cvt_pk_f16_f32 v138, v78, v79
v_lshlrev_b32_e64 v80, 16, v139
v_and_b32 v81, 4294901760, v139
v_cvt_pk_f16_f32 v139, v80, v81
v_lshlrev_b32_e64 v78, 16, v140
v_and_b32 v79, 4294901760, v140
v_cvt_pk_f16_f32 v140, v78, v79
v_lshlrev_b32_e64 v80, 16, v141
v_and_b32 v81, 4294901760, v141
v_cvt_pk_f16_f32 v141, v80, v81
v_lshlrev_b32_e64 v78, 16, v142
v_and_b32 v79, 4294901760, v142
v_cvt_pk_f16_f32 v142, v78, v79
v_lshlrev_b32_e64 v80, 16, v143
v_and_b32 v81, 4294901760, v143
v_cvt_pk_f16_f32 v143, v80, v81
v_lshlrev_b32_e64 v78, 16, v144
v_and_b32 v79, 4294901760, v144
v_cvt_pk_f16_f32 v144, v78, v79
v_lshlrev_b32_e64 v80, 16, v145
v_and_b32 v81, 4294901760, v145
v_cvt_pk_f16_f32 v145, v80, v81
v_lshlrev_b32_e64 v78, 16, v146
v_and_b32 v79, 4294901760, v146
v_cvt_pk_f16_f32 v146, v78, v79
v_lshlrev_b32_e64 v80, 16, v147
v_and_b32 v81, 4294901760, v147
v_cvt_pk_f16_f32 v147, v80, v81
v_lshlrev_b32_e64 v78, 16, v148
v_and_b32 v79, 4294901760, v148
v_cvt_pk_f16_f32 v148, v78, v79
v_lshlrev_b32_e64 v80, 16, v149
v_and_b32 v81, 4294901760, v149
v_cvt_pk_f16_f32 v149, v80, v81
v_lshlrev_b32_e64 v78, 16, v150
v_and_b32 v79, 4294901760, v150
v_cvt_pk_f16_f32 v150, v78, v79
v_lshlrev_b32_e64 v80, 16, v151
v_and_b32 v81, 4294901760, v151
v_cvt_pk_f16_f32 v151, v80, v81
v_lshlrev_b32_e64 v78, 16, v84
v_and_b32 v79, 4294901760, v84
v_cvt_pk_f16_f32 v84, v78, v79
v_lshlrev_b32_e64 v80, 16, v85
v_and_b32 v81, 4294901760, v85
v_cvt_pk_f16_f32 v85, v80, v81
v_lshlrev_b32_e64 v78, 16, v86
v_and_b32 v79, 4294901760, v86
v_cvt_pk_f16_f32 v86, v78, v79
v_lshlrev_b32_e64 v80, 16, v87
v_and_b32 v81, 4294901760, v87
v_cvt_pk_f16_f32 v87, v80, v81
s_mov_b32 exec_lo, 65537
s_mov_b32 exec_hi, 65537
ds_write_b128 v91, v[168:171] offset:3200
ds_write_b128 v91, v[172:175] offset:3216
ds_write_b128 v91, v[176:179] offset:3328
ds_write_b128 v91, v[180:183] offset:3344
ds_write_b128 v91, v[184:187] offset:3456
ds_write_b128 v91, v[188:191] offset:3472
s_mov_b64 exec, -1
v_min_u32 v91, 11, v92
s_mul_i32 s43, s40, 12
v_add_u32 v91, s43, v91
v_cmp_gt_u32 vcc, 64, v91
v_lshlrev_b32 v91, 2, v91
v_add_u32 v88, 93312, v91
v_add_u32 v93, 16128, v91
v_add_u32 v91, 7680, v91
v_cndmask_b32 v91, v91, v93, vcc
v_add_u32 v90, s72, v244
s_waitcnt lgkmcnt(0)
s_barrier
ds_read_b32 v168, v88
ds_read_b32 v169, v88 offset:9216
ds_read_b32 v170, v88 offset:18432
ds_read_b32 v171, v88 offset:27648
ds_read_b32 v172, v88 offset:36864
ds_read_b32 v173, v88 offset:46080
ds_read_b32 v174, v88 offset:55296
ds_read_b32 v175, v88 offset:64512
s_waitcnt lgkmcnt(6)
v_add_f32 v168, v168, v169
s_waitcnt lgkmcnt(5)
v_add_f32 v168, v168, v170
s_waitcnt lgkmcnt(4)
v_add_f32 v168, v168, v171
s_waitcnt lgkmcnt(3)
v_add_f32 v168, v168, v172
s_waitcnt lgkmcnt(2)
v_add_f32 v168, v168, v173
s_waitcnt lgkmcnt(1)
v_add_f32 v168, v168, v174
s_waitcnt lgkmcnt(0)
v_add_f32 v168, v168, v175
ds_write_b32 v91, v168
s_cmp_lg_u32 s40, 0
s_cbranch_scc1 Lspinx
v_add_u32_e64 v176, 0, v92
v_mul_u32_u24 v93, 1366, v176
v_lshrrev_b32_e64 v93, 16, v93
v_mul_u32_u24 v93, 9120, v93
v_lshl_add_u32 v176, v176, 1, v93
v_add_u32 v176, 93184, v176
v_add_u32_e64 v177, 64, v92
v_mul_u32_u24 v93, 1366, v177
v_lshrrev_b32_e64 v93, 16, v93
v_mul_u32_u24 v93, 9120, v93
v_lshl_add_u32 v177, v177, 1, v93
v_add_u32 v177, 93184, v177
v_add_u32 v178, 128, v92
v_mul_u32_u24 v93, 1366, v178
v_lshrrev_b32_e64 v93, 16, v93
v_mul_u32_u24 v93, 9120, v93
v_lshl_add_u32 v178, v178, 1, v93
v_add_u32 v178, 93184, v178
v_add_u32 v179, 192, v92
v_mul_u32_u24 v93, 1366, v179
v_lshrrev_b32_e64 v93, 16, v93
v_mul_u32_u24 v93, 9120, v93
v_lshl_add_u32 v179, v179, 1, v93
v_add_u32 v179, 93184, v179
v_add_u32 v180, 256, v92
v_mul_u32_u24 v93, 1366, v180
v_lshrrev_b32_e64 v93, 16, v93
v_mul_u32_u24 v93, 9120, v93
v_lshl_add_u32 v180, v180, 1, v93
v_add_u32 v180, 93184, v180
v_add_u32 v181, 320, v92
v_mul_u32_u24 v93, 1366, v181
v_lshrrev_b32 v93, 16, v93
v_mul_u32_u24 v93, 9120, v93
v_lshl_add_u32 v181, v181, 1, v93
v_add_u32 v181, 93184, v181
Lspin:
s_cmp_eq_u32 s77, 0
s_cbranch_scc1 Lspiny
s_cmp_eq_u32 s76, 0
s_cbranch_scc1 Lspiny
s_sub_u32 s76, s76, 1
s_call_b64 s[78:79], Lpoll
s_branch Lspin
Lspiny:
v_cvt_f16_f32 v152, v152
ds_write_b16 v176, v152
v_cvt_f16_f32 v153, v153
ds_write_b16 v177, v153
v_cvt_f16_f32 v154, v154
ds_write_b16 v178, v154
v_cvt_f16_f32 v155, v155
ds_write_b16 v179, v155
v_cvt_f16_f32 v156, v156
ds_write_b16 v180, v156
v_cvt_f16_f32 v157, v157
ds_write_b16 v181, v157
s_waitcnt lgkmcnt(0)
Lspinx:
s_waitcnt lgkmcnt(0)
s_barrier
ds_read_b64 v[168:169], v90 offset:3072
ds_read_b64 v[170:171], v90 offset:3104
ds_read_b64 v[172:173], v90 offset:3136
s_waitcnt lgkmcnt(0)
v_pk_mul_f16 v120, v120, v168
v_pk_mul_f16 v121, v121, v169
v_pk_mul_f16 v122, v122, v168
v_pk_mul_f16 v123, v123, v169
ds_write_b64 v89, v[120:121]
ds_write_b64 v89, v[122:123] offset:3072
v_pk_mul_f16 v124, v124, v168
v_pk_mul_f16 v125, v125, v169
v_pk_mul_f16 v126, v126, v168
v_pk_mul_f16 v127, v127, v169
ds_write_b64 v89, v[124:125] offset:1024
ds_write_b64 v89, v[126:127] offset:4096
v_pk_mul_f16 v128, v128, v168
v_pk_mul_f16 v129, v129, v169
v_pk_mul_f16 v130, v130, v168
v_pk_mul_f16 v131, v131, v169
ds_write_b64 v89, v[128:129] offset:2048
ds_write_b64 v89, v[130:131] offset:5120
v_pk_mul_f16 v132, v132, v170
v_pk_mul_f16 v133, v133, v171
v_pk_mul_f16 v134, v134, v170
v_pk_mul_f16 v135, v135, v171
ds_write_b64 v94, v[132:133]
ds_write_b64 v94, v[134:135] offset:3072
v_pk_mul_f16 v136, v136, v170
v_pk_mul_f16 v137, v137, v171
v_pk_mul_f16 v138, v138, v170
v_pk_mul_f16 v139, v139, v171
ds_write_b64 v94, v[136:137] offset:1024
ds_write_b64 v94, v[138:139] offset:4096
v_pk_mul_f16 v140, v140, v170
v_pk_mul_f16 v141, v141, v171
v_pk_mul_f16 v142, v142, v170
v_pk_mul_f16 v143, v143, v171
ds_write_b64 v94, v[140:141] offset:2048
ds_write_b64 v94, v[142:143] offset:5120
v_pk_mul_f16 v144, v144, v172
v_pk_mul_f16 v145, v145, v173
v_pk_mul_f16 v146, v146, v172
v_pk_mul_f16 v147, v147, v173
ds_write_b64 v95, v[144:145]
ds_write_b64 v95, v[146:147] offset:3072
v_pk_mul_f16 v148, v148, v172
v_pk_mul_f16 v149, v149, v173
v_pk_mul_f16 v150, v150, v172
v_pk_mul_f16 v151, v151, v173
ds_write_b64 v95, v[148:149] offset:1024
ds_write_b64 v95, v[150:151] offset:4096
v_pk_mul_f16 v84, v84, v172
v_pk_mul_f16 v85, v85, v173
v_pk_mul_f16 v86, v86, v172
v_pk_mul_f16 v87, v87, v173
ds_write_b64 v95, v[84:85] offset:2048
ds_write_b64 v95, v[86:87] offset:5120
v_and_b32_e64 v88, 3, v92
v_bfe_u32 v93, v92, 2, 1
v_lshl_add_u32 v88, v93, 3, v88
v_bfe_u32 v93, v92, 3, 1
v_lshl_add_u32 v88, v93, 2, v88
v_bfe_u32 v93, v92, 4, 1
v_lshl_add_u32 v88, v93, 6, v88
v_lshrrev_b32_e64 v93, 5, v92
v_lshl_add_u32 v88, v93, 5, v88
v_lshlrev_b32_e64 v88, 4, v88
v_add_u32 v248, 16384, v88
v_add_u32 v249, 53248, v88
s_waitcnt lgkmcnt(0)
s_barrier
ds_read_b128 v[72:75], v254 offset:8192
ds_read_b128 v[76:79], v254 offset:8208
ds_read_b128 v[80:83], v254 offset:8192
ds_read_b128 v[84:87], v254 offset:8208
ds_read_b128 v[152:155], v254 offset:8320
ds_read_b128 v[156:159], v254 offset:8336
ds_read_b128 v[160:163], v254 offset:8320
ds_read_b128 v[164:167], v254 offset:8336
ds_read_b128 v[136:139], v254
ds_read_b128 v[140:143], v254 offset:16
ds_read_b128 v[144:147], v254
ds_read_b128 v[148:151], v254 offset:16
ds_read_b128 v[168:171], v248
ds_read_b128 v[172:175], v251 offset:45056
ds_read_b128 v[176:179], v251 offset:48128
ds_read_b128 v[180:183], v251 offset:46080
ds_read_b128 v[184:187], v251 offset:49152
ds_read_b128 v[188:191], v248 offset:2048
buffer_load_dwordx4 v[88:91], v253, s[4:7], s71 offen
buffer_load_dwordx4 v[240:243], v253, s[4:7], s71 offen offset:64
s_setprio 3
s_waitcnt lgkmcnt(5)
v_mfma_f32_16x16x32_bf16 v[120:123], v[168:171], v[48:51], 0
v_mfma_f32_16x16x32_bf16 v[128:131], v[168:171], v[52:55], 0
ds_read_b128 v[168:171], v251 offset:47104
s_waitcnt lgkmcnt(5)
v_mfma_f32_16x16x32_f16 v[72:75], v[172:175], v[0:3], v[72:75]
v_mfma_f32_16x16x32_f16 v[80:83], v[172:175], v[4:7], v[80:83]
ds_read_b128 v[172:175], v251 offset:50176
s_waitcnt lgkmcnt(5)
v_mfma_f32_16x16x32_f16 v[76:79], v[176:179], v[0:3], v[76:79]
v_mfma_f32_16x16x32_f16 v[84:87], v[176:179], v[4:7], v[84:87]
ds_read_b128 v[176:179], v251 offset:51200
s_waitcnt lgkmcnt(5)
v_mfma_f32_16x16x32_f16 v[152:155], v[180:183], v[0:3], v[152:155]
v_mfma_f32_16x16x32_f16 v[160:163], v[180:183], v[4:7], v[160:163]
ds_read_b128 v[180:183], v248 offset:4096
s_waitcnt lgkmcnt(5)
v_mfma_f32_16x16x32_f16 v[156:159], v[184:187], v[0:3], v[156:159]
s_waitcnt lgkmcnt(4)
v_mfma_f32_16x16x32_bf16 v[120:123], v[188:191], v[56:59], v[120:123]
v_mfma_f32_16x16x32_f16 v[164:167], v[184:187], v[4:7], v[164:167]
ds_read_b128 v[184:187], v251 offset:54272
s_waitcnt lgkmcnt(4)
v_mfma_f32_16x16x32_f16 v[136:139], v[168:171], v[0:3], v[136:139]
v_mfma_f32_16x16x32_f16 v[144:147], v[168:171], v[4:7], v[144:147]
ds_read_b128 v[168:171], v251 offset:55296
v_mfma_f32_16x16x32_bf16 v[128:131], v[188:191], v[60:63], v[128:131]
ds_read_b128 v[188:191], v251 offset:52224
s_waitcnt lgkmcnt(5)
v_mfma_f32_16x16x32_f16 v[140:143], v[172:175], v[0:3], v[140:143]
v_mfma_f32_16x16x32_f16 v[148:151], v[172:175], v[4:7], v[148:151]
ds_read_b128 v[172:175], v248 offset:256
s_waitcnt lgkmcnt(5)
v_mfma_f32_16x16x32_f16 v[72:75], v[176:179], v[8:11], v[72:75]
s_waitcnt lgkmcnt(4)
v_mfma_f32_16x16x32_bf16 v[120:123], v[180:183], v[64:67], v[120:123]
v_mfma_f32_16x16x32_f16 v[80:83], v[176:179], v[12:15], v[80:83]
ds_read_b128 v[176:179], v251 offset:53248
s_waitcnt lgkmcnt(4)
v_mfma_f32_16x16x32_f16 v[76:79], v[184:187], v[8:11], v[76:79]
v_mfma_f32_16x16x32_f16 v[84:87], v[184:187], v[12:15], v[84:87]
ds_read_b128 v[184:187], v251 offset:57344
s_nop 1
v_cvt_pkrtz_f16_f32 v121, v120, v121
v_mfma_f32_16x16x32_bf16 v[128:131], v[180:183], v[68:71], v[128:131]
ds_read_b128 v[180:183], v251 offset:56320
v_and_b32_e64 v121, s49, v121
s_waitcnt lgkmcnt(4)
v_mfma_f32_16x16x32_f16 v[152:155], v[188:191], v[8:11], v[152:155]
buffer_load_dwordx4 v[92:95], v253, s[4:7], s71 offen offset:192
buffer_load_dwordx4 v[244:247], v253, s[4:7], s71 offen offset:256
v_mfma_f32_16x16x32_f16 v[160:163], v[188:191], v[12:15], v[160:163]
ds_read_b128 v[188:191], v248 offset:2304
v_bfe_u32 v120, v121, 2, 14
v_mfma_f32_16x16x32_f16 v[156:159], v[168:171], v[8:11], v[156:159]
v_lshrrev_b32 v121, 18, v121
s_waitcnt lgkmcnt(4)
v_mfma_f32_16x16x32_bf16 v[124:127], v[172:175], v[48:51], 0
s_setprio 2
ds_read_u16 v120, v120
v_mfma_f32_16x16x32_f16 v[164:167], v[168:171], v[12:15], v[164:167]
ds_read_b128 v[168:171], v251 offset:60416
ds_read_u16_d16_hi v121, v121
s_waitcnt lgkmcnt(6)
v_mfma_f32_16x16x32_f16 v[136:139], v[176:179], v[8:11], v[136:139]
v_cvt_pk_f16_f32 v130, v130, v131
v_mfma_f32_16x16x32_f16 v[144:147], v[176:179], v[12:15], v[144:147]
ds_read_b128 v[176:179], v251 offset:61440
v_pk_fma_f16 v131, v130, v130, s48
v_mfma_f32_16x16x32_bf16 v[132:135], v[172:175], v[52:55], 0
ds_read_b128 v[172:175], v251 offset:58368
v_cvt_pkrtz_f16_f32 v123, v122, v123
s_waitcnt lgkmcnt(6)
v_mfma_f32_16x16x32_f16 v[140:143], v[180:183], v[8:11], v[140:143]
v_and_b32 v123, s49, v123
v_mfma_f32_16x16x32_f16 v[148:151], v[180:183], v[12:15], v[148:151]
ds_read_b128 v[180:183], v248 offset:4352
v_bfe_u32 v122, v123, 2, 14
v_mfma_f32_16x16x32_f16 v[72:75], v[184:187], v[16:19], v[72:75]
v_lshrrev_b32_e64 v123, 18, v123
s_waitcnt lgkmcnt(6)
v_mfma_f32_16x16x32_bf16 v[124:127], v[188:191], v[56:59], v[124:127]
ds_read_u16 v122, v122
ds_read_u16_d16_hi v123, v123
v_mfma_f32_16x16x32_f16 v[80:83], v[184:187], v[20:23], v[80:83]
ds_read_b128 v[184:187], v251 offset:59392
v_pk_mul_f16 v131, v130, v131
s_waitcnt lgkmcnt(7)
v_mfma_f32_16x16x32_f16 v[76:79], v[168:171], v[16:19], v[76:79]
v_exp_f16_sdwa v131, v131 dst_sel:WORD_0 dst_unused:UNUSED_PRESERVE src0_sel:WORD_0
v_mfma_f32_16x16x32_f16 v[84:87], v[168:171], v[20:23], v[84:87]
ds_read_b128 v[168:171], v251 offset:8192
v_exp_f16_sdwa v131, v131 dst_sel:WORD_1 dst_unused:UNUSED_PRESERVE src0_sel:WORD_1
v_mfma_f32_16x16x32_bf16 v[132:135], v[188:191], v[60:63], v[132:135]
ds_read_b128 v[188:191], v251 offset:62464
v_cvt_pkrtz_f16_f32 v129, v128, v129
s_waitcnt lgkmcnt(6)
v_mfma_f32_16x16x32_f16 v[152:155], v[172:175], v[16:19], v[152:155]
v_and_b32 v129, s49, v129
v_mfma_f32_16x16x32_f16 v[160:163], v[172:175], v[20:23], v[160:163]
ds_read_b128 v[172:175], v248 offset:6144
v_bfe_u32 v128, v129, 2, 14
v_mfma_f32_16x16x32_f16 v[156:159], v[176:179], v[16:19], v[156:159]
v_lshrrev_b32 v129, 18, v129
s_waitcnt lgkmcnt(6)
v_mfma_f32_16x16x32_bf16 v[124:127], v[180:183], v[64:67], v[124:127]
ds_read_u16 v128, v128
ds_read_u16_d16_hi v129, v129
v_mfma_f32_16x16x32_f16 v[164:167], v[176:179], v[20:23], v[164:167]
ds_read_b128 v[176:179], v251 offset:11264
v_pk_add_f16 v131, v131, 1.0 op_sel_hi:[1,0]
v_mfma_f32_16x16x32_bf16 v[132:135], v[180:183], v[68:71], v[132:135]
ds_read_b128 v[180:183], v251 offset:9216
s_nop 0
v_cvt_pkrtz_f16_f32 v125, v124, v125
s_waitcnt lgkmcnt(7)
v_mfma_f32_16x16x32_f16 v[136:139], v[184:187], v[16:19], v[136:139]
v_and_b32 v125, s49, v125
v_mfma_f32_16x16x32_f16 v[144:147], v[184:187], v[20:23], v[144:147]
ds_read_b128 v[184:187], v251 offset:12288
v_bfe_u32 v124, v125, 2, 14
s_waitcnt lgkmcnt(6)
v_mfma_f32_16x16x32_f16 v[140:143], v[188:191], v[16:19], v[140:143]
v_cvt_pk_f16_f32 v132, v132, v133
v_mfma_f32_16x16x32_f16 v[148:151], v[188:191], v[20:23], v[148:151]
ds_read_b128 v[188:191], v248 offset:8192
v_cvt_pk_f16_f32 v134, v134, v135
v_mfma_f32_16x16x32_f16 v[72:75], v[168:171], v[96:99], v[72:75]
s_getpc_b64 s[74:75]
Lcq10:
s_lshl_b32 s43, s40, 10
s_add_u32 s43, s43, 6144
s_min_u32 s43, s43, Lend-Lcq10-1024
s_add_u32 s74, s74, s43
s_addc_u32 s75, s75, 0
s_sub_u32 s74, s74, 16384
s_subb_u32 s75, s75, 0
s_mov_b32 m0, 163840
s_nop 0
global_load_lds_dword v250, s[74:75]
v_pk_fma_f16 v133, v132, v132, s48
s_waitcnt lgkmcnt(6)
v_mfma_f32_16x16x32_bf16 v[0:3], v[172:175], v[48:51], 0
v_pk_fma_f16 v135, v134, v134, s48
v_mfma_f32_16x16x32_f16 v[80:83], v[168:171], v[100:103], v[80:83]
ds_read_b128 v[168:171], v251 offset:10240
s_setprio 1
v_mfma_f32_16x16x32_bf16 v[8:11], v[172:175], v[52:55], 0
ds_read_b128 v[172:175], v251 offset:13312
v_pk_mul_f16 v133, v132, v133
v_pk_mul_f16 v135, v134, v135
s_waitcnt lgkmcnt(5)
v_mfma_f32_16x16x32_f16 v[76:79], v[176:179], v[96:99], v[76:79]
v_lshrrev_b32_e64 v125, 18, v125
v_mfma_f32_16x16x32_f16 v[84:87], v[176:179], v[100:103], v[84:87]
ds_read_b128 v[176:179], v251 offset:14336
ds_read_u16 v124, v124
s_waitcnt lgkmcnt(6)
v_mfma_f32_16x16x32_f16 v[152:155], v[180:183], v[96:99], v[152:155]
ds_read_u16_d16_hi v125, v125
v_exp_f16_sdwa v133, v133 dst_sel:WORD_0 dst_unused:UNUSED_PRESERVE src0_sel:WORD_0
v_mfma_f32_16x16x32_f16 v[160:163], v[180:183], v[100:103], v[160:163]
ds_read_b128 v[180:183], v248 offset:10240
v_cvt_pkrtz_f16_f32 v127, v126, v127
s_waitcnt lgkmcnt(7)
v_mfma_f32_16x16x32_f16 v[156:159], v[184:187], v[96:99], v[156:159]
v_and_b32 v127, s49, v127
v_mfma_f32_16x16x32_f16 v[164:167], v[184:187], v[100:103], v[164:167]
ds_read_b128 v[184:187], v251 offset:17408
v_bfe_u32 v126, v127, 2, 14
s_waitcnt lgkmcnt(7)
v_mfma_f32_16x16x32_bf16 v[0:3], v[188:191], v[56:59], v[0:3]
v_lshrrev_b32 v127, 18, v127
s_waitcnt lgkmcnt(6)
v_mfma_f32_16x16x32_f16 v[136:139], v[168:171], v[96:99], v[136:139]
ds_read_u16 v126, v126
ds_read_u16_d16_hi v127, v127
v_mfma_f32_16x16x32_f16 v[144:147], v[168:171], v[100:103], v[144:147]
ds_read_b128 v[168:171], v251 offset:18432
v_exp_f16_sdwa v135, v135 dst_sel:WORD_0 dst_unused:UNUSED_PRESERVE src0_sel:WORD_0
s_waitcnt lgkmcnt(7)
v_mfma_f32_16x16x32_f16 v[140:143], v[172:175], v[96:99], v[140:143]
v_exp_f16_sdwa v133, v133 dst_sel:WORD_1 dst_unused:UNUSED_PRESERVE src0_sel:WORD_1
v_mfma_f32_16x16x32_bf16 v[8:11], v[188:191], v[60:63], v[8:11]
ds_read_b128 v[188:191], v251 offset:15360
v_exp_f16_sdwa v135, v135 dst_sel:WORD_1 dst_unused:UNUSED_PRESERVE src0_sel:WORD_1
v_mfma_f32_16x16x32_f16 v[148:151], v[172:175], v[100:103], v[148:151]
ds_read_b128 v[172:175], v248 offset:6400
v_pk_add_f16 v133, v133, 1.0 op_sel_hi:[1,0]
v_mfma_f32_16x16x32_f16 v[72:75], v[176:179], v[104:107], v[72:75]
v_pk_add_f16 v135, v135, 1.0 op_sel_hi:[1,0]
v_mfma_f32_16x16x32_f16 v[80:83], v[176:179], v[108:111], v[80:83]
ds_read_b128 v[176:179], v251 offset:16384
v_rcp_f16_sdwa v131, v131 dst_sel:WORD_0 dst_unused:UNUSED_PRESERVE src0_sel:WORD_0
s_waitcnt lgkmcnt(7)
v_mfma_f32_16x16x32_bf16 v[0:3], v[180:183], v[64:67], v[0:3]
v_rcp_f16_sdwa v133, v133 dst_sel:WORD_0 dst_unused:UNUSED_PRESERVE src0_sel:WORD_0
s_waitcnt lgkmcnt(6)
v_mfma_f32_16x16x32_f16 v[76:79], v[184:187], v[104:107], v[76:79]
v_rcp_f16_sdwa v135, v135 dst_sel:WORD_0 dst_unused:UNUSED_PRESERVE src0_sel:WORD_0
v_mfma_f32_16x16x32_f16 v[84:87], v[184:187], v[108:111], v[84:87]
ds_read_b128 v[184:187], v251 offset:20480
v_rcp_f16_sdwa v131, v131 dst_sel:WORD_1 dst_unused:UNUSED_PRESERVE src0_sel:WORD_1
v_mfma_f32_16x16x32_bf16 v[8:11], v[180:183], v[68:71], v[8:11]
ds_read_b128 v[180:183], v251 offset:19456
v_rcp_f16_sdwa v133, v133 dst_sel:WORD_1 dst_unused:UNUSED_PRESERVE src0_sel:WORD_1
s_waitcnt lgkmcnt(4)
v_mfma_f32_16x16x32_f16 v[152:155], v[188:191], v[104:107], v[152:155]
v_rcp_f16_sdwa v135, v135 dst_sel:WORD_1 dst_unused:UNUSED_PRESERVE src0_sel:WORD_1
v_mfma_f32_16x16x32_f16 v[160:163], v[188:191], v[108:111], v[160:163]
ds_read_b128 v[188:191], v248 offset:8448
v_cvt_pkrtz_f16_f32 v1, v0, v1
v_mfma_f32_16x16x32_f16 v[156:159], v[168:171], v[104:107], v[156:159]
v_and_b32 v1, s49, v1
v_mfma_f32_16x16x32_f16 v[164:167], v[168:171], v[108:111], v[164:167]
ds_read_b128 v[168:171], v251 offset:23552
v_bfe_u32 v0, v1, 2, 14
s_waitcnt lgkmcnt(4)
v_mfma_f32_16x16x32_bf16 v[4:7], v[172:175], v[48:51], 0
v_lshrrev_b32 v1, 18, v1
v_mfma_f32_16x16x32_f16 v[136:139], v[176:179], v[104:107], v[136:139]
s_setprio 0
ds_read_u16 v0, v0
v_mfma_f32_16x16x32_f16 v[144:147], v[176:179], v[108:111], v[144:147]
ds_read_b128 v[176:179], v251 offset:24576
ds_read_u16_d16_hi v1, v1
s_waitcnt lgkmcnt(5)
v_mfma_f32_16x16x32_f16 v[140:143], v[180:183], v[104:107], v[140:143]
v_cvt_pk_f16_f32 v10, v10, v11
v_mfma_f32_16x16x32_bf16 v[12:15], v[172:175], v[52:55], 0
ds_read_b128 v[172:175], v251 offset:21504
v_pk_fma_f16 v11, v10, v10, s48
v_mfma_f32_16x16x32_f16 v[148:151], v[180:183], v[108:111], v[148:151]
ds_read_b128 v[180:183], v248 offset:10496
v_cvt_pkrtz_f16_f32 v3, v2, v3
v_mfma_f32_16x16x32_f16 v[72:75], v[184:187], v[112:115], v[72:75]
v_and_b32_e64 v3, s49, v3
v_mfma_f32_16x16x32_f16 v[80:83], v[184:187], v[116:119], v[80:83]
ds_read_b128 v[184:187], v251 offset:22528
v_bfe_u32 v2, v3, 2, 14
s_waitcnt lgkmcnt(6)
v_mfma_f32_16x16x32_bf16 v[4:7], v[188:191], v[56:59], v[4:7]
v_lshrrev_b32 v3, 18, v3
v_mfma_f32_16x16x32_f16 v[76:79], v[168:171], v[112:115], v[76:79]
ds_read_u16 v2, v2
ds_read_u16_d16_hi v3, v3
v_mfma_f32_16x16x32_f16 v[84:87], v[168:171], v[116:119], v[84:87]
ds_read_b128 v[168:171], v251 offset:63488
v_pk_mul_f16 v11, v10, v11
v_mfma_f32_16x16x32_bf16 v[12:15], v[188:191], v[60:63], v[12:15]
ds_read_b128 v[188:191], v251 offset:25600
v_exp_f16_sdwa v11, v11 dst_sel:WORD_0 dst_unused:UNUSED_PRESERVE src0_sel:WORD_0
s_waitcnt lgkmcnt(8)
v_mfma_f32_16x16x32_f16 v[156:159], v[176:179], v[112:115], v[156:159]
v_exp_f16_sdwa v11, v11 dst_sel:WORD_1 dst_unused:UNUSED_PRESERVE src0_sel:WORD_1
s_waitcnt lgkmcnt(6)
v_mfma_f32_16x16x32_f16 v[152:155], v[172:175], v[112:115], v[152:155]
v_cvt_pkrtz_f16_f32 v9, v8, v9
v_mfma_f32_16x16x32_f16 v[160:163], v[172:175], v[116:119], v[160:163]
ds_read_b128 v[172:175], v248 offset:12288
v_and_b32_e64 v9, s49, v9
v_mfma_f32_16x16x32_f16 v[164:167], v[176:179], v[116:119], v[164:167]
ds_read_b128 v[176:179], v252 offset:1024
v_bfe_u32 v8, v9, 2, 14
s_waitcnt lgkmcnt(7)
v_mfma_f32_16x16x32_bf16 v[4:7], v[180:183], v[64:67], v[4:7]
v_lshrrev_b32_e64 v9, 18, v9
s_waitcnt lgkmcnt(6)
v_mfma_f32_16x16x32_f16 v[136:139], v[184:187], v[112:115], v[136:139]
ds_read_u16 v8, v8
ds_read_u16_d16_hi v9, v9
v_mfma_f32_16x16x32_f16 v[144:147], v[184:187], v[116:119], v[144:147]
ds_read_b128 v[184:187], v252 offset:2048
v_pk_add_f16 v11, v11, 1.0 op_sel_hi:[1,0]
v_mfma_f32_16x16x32_bf16 v[12:15], v[180:183], v[68:71], v[12:15]
ds_read_b128 v[180:183], v251 offset:64512
v_cvt_pkrtz_f16_f32 v5, v4, v5
s_waitcnt lgkmcnt(7)
v_mfma_f32_16x16x32_f16 v[72:75], v[168:171], v[192:195], v[72:75]
v_and_b32 v5, s49, v5
s_waitcnt lgkmcnt(6)
v_mfma_f32_16x16x32_f16 v[140:143], v[188:191], v[112:115], v[140:143]
v_or_b32 v112, v120, v121
v_mfma_f32_16x16x32_f16 v[148:151], v[188:191], v[116:119], v[148:151]
ds_read_b128 v[188:191], v248 offset:14336
v_pk_mul_f16 v117, v130, v131
v_mfma_f32_16x16x32_f16 v[80:83], v[168:171], v[196:199], v[80:83]
ds_read_b128 v[168:171], v252
v_pk_mul_f16 v118, v132, v133
s_waitcnt lgkmcnt(7)
v_mfma_f32_16x16x32_bf16 v[96:99], v[172:175], v[48:51], 0
v_pk_mul_f16 v119, v134, v135
s_waitcnt lgkmcnt(6)
v_mfma_f32_16x16x32_f16 v[76:79], v[176:179], v[192:195], v[76:79]
v_or_b32 v113, v122, v123
v_mfma_f32_16x16x32_f16 v[84:87], v[176:179], v[196:199], v[84:87]
ds_read_b128 v[176:179], v252 offset:4096
s_setprio 3
v_mfma_f32_16x16x32_bf16 v[104:107], v[172:175], v[52:55], 0
ds_read_b128 v[172:175], v252 offset:3072
v_cvt_pk_f16_f32 v12, v12, v13
v_cvt_pk_f16_f32 v14, v14, v15
v_pk_fma_f16 v13, v12, v12, s48
s_waitcnt lgkmcnt(5)
v_mfma_f32_16x16x32_f16 v[156:159], v[184:187], v[192:195], v[156:159]
v_or_b32 v114, v124, v125
v_mfma_f32_16x16x32_f16 v[164:167], v[184:187], v[196:199], v[164:167]
ds_read_b128 v[184:187], v248 offset:16384
v_pk_fma_f16 v15, v14, v14, s48
s_waitcnt lgkmcnt(5)
v_mfma_f32_16x16x32_f16 v[152:155], v[180:183], v[192:195], v[152:155]
v_pk_mul_f16 v13, v12, v13
v_mfma_f32_16x16x32_f16 v[160:163], v[180:183], v[196:199], v[160:163]
ds_read_b128 v[180:183], v252 offset:7168
v_pk_mul_f16 v15, v14, v15
s_waitcnt lgkmcnt(5)
v_mfma_f32_16x16x32_bf16 v[96:99], v[188:191], v[56:59], v[96:99]
v_bfe_u32 v4, v5, 2, 14
s_waitcnt lgkmcnt(4)
v_mfma_f32_16x16x32_f16 v[136:139], v[168:171], v[192:195], v[136:139]
v_lshrrev_b32 v5, 18, v5
v_mfma_f32_16x16x32_f16 v[144:147], v[168:171], v[196:199], v[144:147]
ds_read_b128 v[168:171], v252 offset:8192
ds_read_u16 v4, v4
s_waitcnt lgkmcnt(4)
v_mfma_f32_16x16x32_f16 v[140:143], v[172:175], v[192:195], v[140:143]
ds_read_u16_d16_hi v5, v5
v_or_b32 v115, v126, v127
v_mfma_f32_16x16x32_f16 v[148:151], v[172:175], v[196:199], v[148:151]
ds_read_b128 v[172:175], v252 offset:6144
v_exp_f16_sdwa v13, v13 dst_sel:WORD_0 dst_unused:UNUSED_PRESERVE src0_sel:WORD_0
v_mfma_f32_16x16x32_bf16 v[104:107], v[188:191], v[60:63], v[104:107]
ds_read_b128 v[188:191], v252 offset:5120
v_cvt_pkrtz_f16_f32 v7, v6, v7
v_mfma_f32_16x16x32_f16 v[72:75], v[176:179], v[200:203], v[72:75]
v_and_b32_e64 v7, s49, v7
v_mfma_f32_16x16x32_f16 v[80:83], v[176:179], v[204:207], v[80:83]
ds_read_b128 v[176:179], v248 offset:12544
v_bfe_u32 v6, v7, 2, 14
s_waitcnt lgkmcnt(6)
v_mfma_f32_16x16x32_f16 v[76:79], v[180:183], v[200:203], v[76:79]
v_lshrrev_b32 v7, 18, v7
v_mfma_f32_16x16x32_bf16 v[96:99], v[184:187], v[64:67], v[96:99]
ds_read_u16 v6, v6
ds_read_u16_d16_hi v7, v7
v_mfma_f32_16x16x32_f16 v[84:87], v[180:183], v[204:207], v[84:87]
ds_read_b128 v[180:183], v252 offset:9216
v_exp_f16_sdwa v15, v15 dst_sel:WORD_0 dst_unused:UNUSED_PRESERVE src0_sel:WORD_0
v_mfma_f32_16x16x32_bf16 v[104:107], v[184:187], v[68:71], v[104:107]
ds_read_b128 v[184:187], v252 offset:10240
v_or_b32 v116, v128, v129
s_waitcnt lgkmcnt(8)
v_mfma_f32_16x16x32_f16 v[156:159], v[168:171], v[200:203], v[156:159]
v_exp_f16_sdwa v13, v13 dst_sel:WORD_1 dst_unused:UNUSED_PRESERVE src0_sel:WORD_1
v_mfma_f32_16x16x32_f16 v[164:167], v[168:171], v[204:207], v[164:167]
ds_read_b128 v[168:171], v252 offset:13312
v_exp_f16_sdwa v15, v15 dst_sel:WORD_1 dst_unused:UNUSED_PRESERVE src0_sel:WORD_1
s_waitcnt lgkmcnt(6)
v_mfma_f32_16x16x32_f16 v[152:155], v[188:191], v[200:203], v[152:155]
v_pk_add_f16 v13, v13, 1.0 op_sel_hi:[1,0]
v_mfma_f32_16x16x32_f16 v[160:163], v[188:191], v[204:207], v[160:163]
ds_read_b128 v[188:191], v248 offset:14592
v_pk_add_f16 v15, v15, 1.0 op_sel_hi:[1,0]
v_mfma_f32_16x16x32_f16 v[136:139], v[172:175], v[200:203], v[136:139]
v_rcp_f16_sdwa v11, v11 dst_sel:WORD_0 dst_unused:UNUSED_PRESERVE src0_sel:WORD_0
s_waitcnt lgkmcnt(6)
v_mfma_f32_16x16x32_bf16 v[100:103], v[176:179], v[48:51], 0
v_rcp_f16_sdwa v13, v13 dst_sel:WORD_0 dst_unused:UNUSED_PRESERVE src0_sel:WORD_0
v_mfma_f32_16x16x32_f16 v[144:147], v[172:175], v[204:207], v[144:147]
ds_read_b128 v[172:175], v248 offset:16640
s_setprio 2
v_mfma_f32_16x16x32_bf16 v[108:111], v[176:179], v[52:55], 0
ds_read_b128 v[176:179], v252 offset:11264
v_rcp_f16_sdwa v15, v15 dst_sel:WORD_0 dst_unused:UNUSED_PRESERVE src0_sel:WORD_0
s_waitcnt lgkmcnt(5)
v_mfma_f32_16x16x32_f16 v[140:143], v[180:183], v[200:203], v[140:143]
v_rcp_f16_sdwa v11, v11 dst_sel:WORD_1 dst_unused:UNUSED_PRESERVE src0_sel:WORD_1
v_mfma_f32_16x16x32_f16 v[148:151], v[180:183], v[204:207], v[148:151]
ds_read_b128 v[180:183], v248 offset:18432
buffer_load_dwordx4 v[192:195], v253, s[4:7], s71 offen offset:128
s_waitcnt lgkmcnt(5)
v_mfma_f32_16x16x32_f16 v[72:75], v[184:187], v[208:211], v[72:75]
v_rcp_f16_sdwa v13, v13 dst_sel:WORD_1 dst_unused:UNUSED_PRESERVE src0_sel:WORD_1
s_waitcnt lgkmcnt(3)
v_mfma_f32_16x16x32_bf16 v[100:103], v[188:191], v[56:59], v[100:103]
v_mov_b32_e64 v16, 0
v_mfma_f32_16x16x32_f16 v[80:83], v[184:187], v[212:215], v[80:83]
ds_read_b128 v[184:187], v252 offset:14336
v_mov_b32_e64 v17, 0
v_mfma_f32_16x16x32_f16 v[76:79], v[168:171], v[208:211], v[76:79]
v_cndmask_b32 v18, 0, v255, s[88:89]
v_mfma_f32_16x16x32_bf16 v[108:111], v[188:191], v[60:63], v[108:111]
ds_read_b128 v[188:191], v248 offset:20480
v_cndmask_b32 v19, 0, v255, s[90:91]
v_mfma_f32_16x16x32_f16 v[84:87], v[168:171], v[212:215], v[84:87]
ds_read_b128 v[168:171], v252 offset:12288
v_mov_b32 v20, 0
s_waitcnt lgkmcnt(4)
v_mfma_f32_16x16x32_bf16 v[100:103], v[172:175], v[64:67], v[100:103]
v_mov_b32_e64 v21, 0
v_mfma_f32_16x16x32_f16 v[152:155], v[176:179], v[208:211], v[152:155]
v_rcp_f16_sdwa v15, v15 dst_sel:WORD_1 dst_unused:UNUSED_PRESERVE src0_sel:WORD_1
v_mfma_f32_16x16x32_bf16 v[108:111], v[172:175], v[68:71], v[108:111]
ds_read_b128 v[172:175], v248 offset:22528
v_or_b32 v200, v0, v1
v_mfma_f32_16x16x32_f16 v[160:163], v[176:179], v[212:215], v[160:163]
ds_read_b128 v[176:179], v252 offset:15360
v_pk_mul_f16 v205, v10, v11
s_waitcnt lgkmcnt(5)
v_mfma_f32_16x16x32_bf16 v[120:123], v[180:183], v[48:51], 0
s_setprio 1
v_pk_mul_f16 v206, v12, v13
s_waitcnt lgkmcnt(4)
v_mfma_f32_16x16x32_f16 v[156:159], v[184:187], v[208:211], v[156:159]
buffer_load_dwordx4 v[196:199], v253, s[4:7], s71 offen offset:320
v_pk_mul_f16 v207, v14, v15
v_mfma_f32_16x16x32_bf16 v[128:131], v[180:183], v[52:55], 0
ds_read_b128 v[180:183], v251 offset:26624
v_cvt_pkrtz_f16_f32 v97, v96, v97
v_mfma_f32_16x16x32_f16 v[164:167], v[184:187], v[212:215], v[164:167]
ds_read_b128 v[184:187], v248 offset:18688
v_and_b32_e64 v97, s49, v97
v_bfe_u32 v96, v97, 2, 14
v_lshrrev_b32_e64 v97, 18, v97
ds_read_u16 v96, v96
ds_read_u16_d16_hi v97, v97
v_cvt_pk_f16_f32 v106, v106, v107
v_or_b32 v201, v2, v3
s_waitcnt lgkmcnt(6)
v_mfma_f32_16x16x32_bf16 v[120:123], v[188:191], v[56:59], v[120:123]
v_cvt_pk_f16_f32 v108, v108, v109
v_mfma_f32_16x16x32_f16 v[136:139], v[168:171], v[208:211], v[136:139]
v_cvt_pk_f16_f32 v110, v110, v111
v_pk_fma_f16 v107, v106, v106, s48
v_mfma_f32_16x16x32_bf16 v[128:131], v[188:191], v[60:63], v[128:131]
ds_read_b128 v[188:191], v251 offset:29696
v_pk_fma_f16 v109, v108, v108, s48
v_cvt_pkrtz_f16_f32 v99, v98, v99
v_and_b32_e64 v99, s49, v99
v_bfe_u32 v98, v99, 2, 14
v_lshrrev_b32_e64 v99, 18, v99
ds_read_u16 v98, v98
ds_read_u16_d16_hi v99, v99
v_or_b32 v202, v4, v5
v_mfma_f32_16x16x32_f16 v[144:147], v[168:171], v[212:215], v[144:147]
ds_read_b128 v[168:171], v248 offset:20736
v_pk_fma_f16 v111, v110, v110, s48
v_pk_mul_f16 v107, v106, v107
v_pk_mul_f16 v109, v108, v109
s_waitcnt lgkmcnt(6)
v_mfma_f32_16x16x32_bf16 v[120:123], v[172:175], v[64:67], v[120:123]
v_pk_mul_f16 v111, v110, v111
v_mfma_f32_16x16x32_f16 v[140:143], v[176:179], v[208:211], v[140:143]
v_cvt_pkrtz_f16_f32 v101, v100, v101
v_and_b32_e64 v101, s49, v101
v_bfe_u32 v100, v101, 2, 14
v_lshrrev_b32 v101, 18, v101
ds_read_u16 v100, v100
ds_read_u16_d16_hi v101, v101
v_or_b32 v203, v6, v7
v_exp_f16_sdwa v107, v107 dst_sel:WORD_0 dst_unused:UNUSED_PRESERVE src0_sel:WORD_0
v_mfma_f32_16x16x32_bf16 v[128:131], v[172:175], v[68:71], v[128:131]
ds_read_b128 v[172:175], v251 offset:27648
v_exp_f16_sdwa v109, v109 dst_sel:WORD_0 dst_unused:UNUSED_PRESERVE src0_sel:WORD_0
v_mfma_f32_16x16x32_f16 v[148:151], v[176:179], v[212:215], v[148:151]
ds_read_b128 v[176:179], v248 offset:22784
v_cvt_pkrtz_f16_f32 v103, v102, v103
v_and_b32_e64 v103, s49, v103
v_bfe_u32 v102, v103, 2, 14
v_lshrrev_b32 v103, 18, v103
ds_read_u16 v102, v102
ds_read_u16_d16_hi v103, v103
s_waitcnt vmcnt(6)
v_mfma_f32_16x16x32_bf16 v[72:75], v[18:21], v[88:91], v[72:75]
v_exp_f16_sdwa v111, v111 dst_sel:WORD_0 dst_unused:UNUSED_PRESERVE src0_sel:WORD_0
v_mfma_f32_16x16x32_bf16 v[76:79], v[16:19], v[88:91], v[76:79]
v_or_b32 v204, v8, v9
s_waitcnt vmcnt(4)
v_mfma_f32_16x16x32_bf16 v[80:83], v[18:21], v[92:95], v[80:83]
v_exp_f16_sdwa v107, v107 dst_sel:WORD_1 dst_unused:UNUSED_PRESERVE src0_sel:WORD_1
v_mfma_f32_16x16x32_bf16 v[84:87], v[16:19], v[92:95], v[84:87]
v_exp_f16_sdwa v109, v109 dst_sel:WORD_1 dst_unused:UNUSED_PRESERVE src0_sel:WORD_1
v_mfma_f32_16x16x32_f16 v[72:75], v[180:183], v[216:219], v[72:75]
v_cvt_pkrtz_f16_f32 v105, v104, v105
v_mfma_f32_16x16x32_bf16 v[124:127], v[184:187], v[48:51], 0
s_setprio 0
v_and_b32 v105, s49, v105
v_mfma_f32_16x16x32_f16 v[80:83], v[180:183], v[220:223], v[80:83]
ds_read_b128 v[180:183], v251 offset:30720
v_bfe_u32 v104, v105, 2, 14
v_mfma_f32_16x16x32_bf16 v[132:135], v[184:187], v[52:55], 0
ds_read_b128 v[184:187], v248 offset:24576
v_lshrrev_b32 v105, 18, v105
ds_read_u16 v104, v104
ds_read_u16_d16_hi v105, v105
v_exp_f16_sdwa v111, v111 dst_sel:WORD_1 dst_unused:UNUSED_PRESERVE src0_sel:WORD_1
s_waitcnt lgkmcnt(6)
v_mfma_f32_16x16x32_f16 v[76:79], v[188:191], v[216:219], v[76:79]
v_pk_add_f16 v107, v107, 1.0 op_sel_hi:[1,0]
v_mfma_f32_16x16x32_bf16 v[124:127], v[168:171], v[56:59], v[124:127]
v_pk_add_f16 v109, v109, 1.0 op_sel_hi:[1,0]
v_mfma_f32_16x16x32_f16 v[84:87], v[188:191], v[220:223], v[84:87]
ds_read_b128 v[188:191], v251 offset:28672
v_pk_add_f16 v111, v111, 1.0 op_sel_hi:[1,0]
v_mfma_f32_16x16x32_bf16 v[132:135], v[168:171], v[60:63], v[132:135]
ds_read_b128 v[168:171], v248 offset:26624
v_rcp_f16_sdwa v107, v107 dst_sel:WORD_0 dst_unused:UNUSED_PRESERVE src0_sel:WORD_0
v_mfma_f32_16x16x32_f16 v[152:155], v[172:175], v[216:219], v[152:155]
v_rcp_f16_sdwa v109, v109 dst_sel:WORD_0 dst_unused:UNUSED_PRESERVE src0_sel:WORD_0
v_mfma_f32_16x16x32_bf16 v[124:127], v[176:179], v[64:67], v[124:127]
v_rcp_f16_sdwa v111, v111 dst_sel:WORD_0 dst_unused:UNUSED_PRESERVE src0_sel:WORD_0
v_mfma_f32_16x16x32_f16 v[160:163], v[172:175], v[220:223], v[160:163]
ds_read_b128 v[172:175], v251 offset:31744
v_rcp_f16_sdwa v107, v107 dst_sel:WORD_1 dst_unused:UNUSED_PRESERVE src0_sel:WORD_1
v_mfma_f32_16x16x32_bf16 v[132:135], v[176:179], v[68:71], v[132:135]
ds_read_b128 v[176:179], v248 offset:28672
v_rcp_f16_sdwa v109, v109 dst_sel:WORD_1 dst_unused:UNUSED_PRESERVE src0_sel:WORD_1
s_waitcnt lgkmcnt(5)
v_mfma_f32_16x16x32_f16 v[156:159], v[180:183], v[216:219], v[156:159]
v_rcp_f16_sdwa v111, v111 dst_sel:WORD_1 dst_unused:UNUSED_PRESERVE src0_sel:WORD_1
v_mfma_f32_16x16x32_bf16 v[0:3], v[184:187], v[48:51], 0
v_or_b32 v208, v96, v97
v_mfma_f32_16x16x32_f16 v[164:167], v[180:183], v[220:223], v[164:167]
ds_read_b128 v[180:183], v251 offset:32768
s_setprio 3
v_pk_mul_f16 v213, v106, v107
v_mfma_f32_16x16x32_bf16 v[8:11], v[184:187], v[52:55], 0
ds_read_b128 v[184:187], v248 offset:24832
v_pk_mul_f16 v214, v108, v109
s_waitcnt lgkmcnt(4)
v_mfma_f32_16x16x32_f16 v[136:139], v[188:191], v[216:219], v[136:139]
v_pk_mul_f16 v215, v110, v111
v_cvt_pkrtz_f16_f32 v121, v120, v121
v_and_b32_e64 v121, s49, v121
v_bfe_u32 v120, v121, 2, 14
v_lshrrev_b32_e64 v121, 18, v121
ds_read_u16 v120, v120
ds_read_u16_d16_hi v121, v121
v_cvt_pk_f16_f32 v130, v130, v131
v_or_b32 v209, v98, v99
v_mfma_f32_16x16x32_bf16 v[0:3], v[168:171], v[56:59], v[0:3]
v_cvt_pk_f16_f32 v132, v132, v133
v_mfma_f32_16x16x32_f16 v[144:147], v[188:191], v[220:223], v[144:147]
ds_read_b128 v[188:191], v251 offset:35840
v_cvt_pk_f16_f32 v134, v134, v135
v_pk_fma_f16 v131, v130, v130, s48
s_waitcnt lgkmcnt(5)
v_mfma_f32_16x16x32_f16 v[140:143], v[172:175], v[216:219], v[140:143]
v_pk_fma_f16 v133, v132, v132, s48
v_mfma_f32_16x16x32_bf16 v[8:11], v[168:171], v[60:63], v[8:11]
ds_read_b128 v[168:171], v248 offset:26880
v_cvt_pkrtz_f16_f32 v123, v122, v123
v_and_b32_e64 v123, s49, v123
v_bfe_u32 v122, v123, 2, 14
v_lshrrev_b32 v123, 18, v123
ds_read_u16 v122, v122
ds_read_u16_d16_hi v123, v123
v_or_b32 v210, v100, v101
v_pk_fma_f16 v135, v134, v134, s48
v_pk_mul_f16 v131, v130, v131
v_mfma_f32_16x16x32_f16 v[148:151], v[172:175], v[220:223], v[148:151]
ds_read_b128 v[172:175], v251 offset:33792
v_pk_mul_f16 v133, v132, v133
v_mfma_f32_16x16x32_bf16 v[0:3], v[176:179], v[64:67], v[0:3]
v_pk_mul_f16 v135, v134, v135
v_cvt_pkrtz_f16_f32 v125, v124, v125
v_and_b32_e64 v125, s49, v125
v_bfe_u32 v124, v125, 2, 14
v_lshrrev_b32_e64 v125, 18, v125
ds_read_u16 v124, v124
ds_read_u16_d16_hi v125, v125
v_mfma_f32_16x16x32_bf16 v[152:155], v[18:21], v[240:243], v[152:155]
v_or_b32 v211, v102, v103
v_mfma_f32_16x16x32_bf16 v[156:159], v[16:19], v[240:243], v[156:159]
v_exp_f16_sdwa v131, v131 dst_sel:WORD_0 dst_unused:UNUSED_PRESERVE src0_sel:WORD_0
s_waitcnt vmcnt(3)
v_mfma_f32_16x16x32_bf16 v[160:163], v[18:21], v[244:247], v[160:163]
v_exp_f16_sdwa v133, v133 dst_sel:WORD_0 dst_unused:UNUSED_PRESERVE src0_sel:WORD_0
v_mfma_f32_16x16x32_bf16 v[164:167], v[16:19], v[244:247], v[164:167]
v_cvt_pkrtz_f16_f32 v127, v126, v127
s_waitcnt lgkmcnt(4)
v_mfma_f32_16x16x32_f16 v[72:75], v[180:183], v[224:227], v[72:75]
v_and_b32 v127, s49, v127
v_mfma_f32_16x16x32_bf16 v[8:11], v[176:179], v[68:71], v[8:11]
ds_read_b128 v[176:179], v248 offset:28928
v_bfe_u32 v126, v127, 2, 14
v_mfma_f32_16x16x32_f16 v[80:83], v[180:183], v[228:231], v[80:83]
ds_read_b128 v[180:183], v251 offset:36864
v_lshrrev_b32_e64 v127, 18, v127
ds_read_u16 v126, v126
ds_read_u16_d16_hi v127, v127
v_exp_f16_sdwa v135, v135 dst_sel:WORD_0 dst_unused:UNUSED_PRESERVE src0_sel:WORD_0
v_or_b32 v212, v104, v105
v_mfma_f32_16x16x32_bf16 v[4:7], v[184:187], v[48:51], 0
v_exp_f16_sdwa v131, v131 dst_sel:WORD_1 dst_unused:UNUSED_PRESERVE src0_sel:WORD_1
v_mfma_f32_16x16x32_f16 v[76:79], v[188:191], v[224:227], v[76:79]
s_setprio 2
v_exp_f16_sdwa v133, v133 dst_sel:WORD_1 dst_unused:UNUSED_PRESERVE src0_sel:WORD_1
v_mfma_f32_16x16x32_bf16 v[12:15], v[184:187], v[52:55], 0
ds_read_b128 v[184:187], v251 offset:34816
v_cvt_pkrtz_f16_f32 v129, v128, v129
v_and_b32_e64 v129, s49, v129
v_bfe_u32 v128, v129, 2, 14
v_lshrrev_b32 v129, 18, v129
ds_read_u16 v128, v128
ds_read_u16_d16_hi v129, v129
v_mfma_f32_16x16x32_f16 v[84:87], v[188:191], v[228:231], v[84:87]
ds_read_b128 v[188:191], v248 offset:30720
v_exp_f16_sdwa v135, v135 dst_sel:WORD_1 dst_unused:UNUSED_PRESERVE src0_sel:WORD_1
v_mfma_f32_16x16x32_bf16 v[4:7], v[168:171], v[56:59], v[4:7]
v_pk_add_f16 v131, v131, 1.0 op_sel_hi:[1,0]
s_waitcnt lgkmcnt(6)
v_mfma_f32_16x16x32_f16 v[152:155], v[172:175], v[224:227], v[152:155]
v_pk_add_f16 v133, v133, 1.0 op_sel_hi:[1,0]
v_pk_add_f16 v135, v135, 1.0 op_sel_hi:[1,0]
v_mfma_f32_16x16x32_bf16 v[12:15], v[168:171], v[60:63], v[12:15]
ds_read_b128 v[168:171], v251 offset:37888
v_rcp_f16_sdwa v131, v131 dst_sel:WORD_0 dst_unused:UNUSED_PRESERVE src0_sel:WORD_0
v_mfma_f32_16x16x32_f16 v[160:163], v[172:175], v[228:231], v[160:163]
ds_read_b128 v[172:175], v248 offset:32768
v_rcp_f16_sdwa v133, v133 dst_sel:WORD_0 dst_unused:UNUSED_PRESERVE src0_sel:WORD_0
v_mfma_f32_16x16x32_bf16 v[4:7], v[176:179], v[64:67], v[4:7]
v_rcp_f16_sdwa v135, v135 dst_sel:WORD_0 dst_unused:UNUSED_PRESERVE src0_sel:WORD_0
v_mfma_f32_16x16x32_f16 v[156:159], v[180:183], v[224:227], v[156:159]
v_rcp_f16_sdwa v131, v131 dst_sel:WORD_1 dst_unused:UNUSED_PRESERVE src0_sel:WORD_1
v_mfma_f32_16x16x32_bf16 v[12:15], v[176:179], v[68:71], v[12:15]
ds_read_b128 v[176:179], v251 offset:38912
v_rcp_f16_sdwa v133, v133 dst_sel:WORD_1 dst_unused:UNUSED_PRESERVE src0_sel:WORD_1
v_mfma_f32_16x16x32_f16 v[164:167], v[180:183], v[228:231], v[164:167]
ds_read_b128 v[180:183], v248 offset:34816
v_rcp_f16_sdwa v135, v135 dst_sel:WORD_1 dst_unused:UNUSED_PRESERVE src0_sel:WORD_1
s_waitcnt lgkmcnt(5)
v_mfma_f32_16x16x32_f16 v[136:139], v[184:187], v[224:227], v[136:139]
v_or_b32 v88, v120, v121
s_waitcnt lgkmcnt(4)
v_mfma_f32_16x16x32_bf16 v[96:99], v[188:191], v[48:51], 0
v_pk_mul_f16 v93, v130, v131
v_mfma_f32_16x16x32_f16 v[144:147], v[184:187], v[228:231], v[144:147]
ds_read_b128 v[184:187], v251 offset:41984
s_setprio 1
v_mfma_f32_16x16x32_bf16 v[104:107], v[188:191], v[52:55], 0
ds_read_b128 v[188:191], v248 offset:30976
v_pk_mul_f16 v94, v132, v133
v_pk_mul_f16 v95, v134, v135
s_waitcnt lgkmcnt(4)
v_mfma_f32_16x16x32_f16 v[140:143], v[168:171], v[224:227], v[140:143]
v_cvt_pkrtz_f16_f32 v1, v0, v1
v_and_b32 v1, s49, v1
v_bfe_u32 v0, v1, 2, 14
v_lshrrev_b32 v1, 18, v1
ds_read_u16 v0, v0
ds_read_u16_d16_hi v1, v1
v_cvt_pk_f16_f32 v10, v10, v11
v_or_b32 v89, v122, v123
v_mfma_f32_16x16x32_bf16 v[96:99], v[172:175], v[56:59], v[96:99]
v_cvt_pk_f16_f32 v12, v12, v13
v_cvt_pk_f16_f32 v14, v14, v15
v_mfma_f32_16x16x32_f16 v[148:151], v[168:171], v[228:231], v[148:151]
ds_read_b128 v[168:171], v251 offset:39936
v_pk_fma_f16 v11, v10, v10, s48
v_mfma_f32_16x16x32_bf16 v[104:107], v[172:175], v[60:63], v[104:107]
ds_read_b128 v[172:175], v248 offset:33024
v_pk_fma_f16 v13, v12, v12, s48
v_cvt_pkrtz_f16_f32 v3, v2, v3
v_and_b32_e64 v3, s49, v3
v_bfe_u32 v2, v3, 2, 14
v_lshrrev_b32_e64 v3, 18, v3
ds_read_u16 v2, v2
ds_read_u16_d16_hi v3, v3
v_or_b32 v90, v124, v125
s_waitcnt vmcnt(1)
v_mfma_f32_16x16x32_bf16 v[136:139], v[18:21], v[192:195], v[136:139]
v_pk_fma_f16 v15, v14, v14, s48
v_mfma_f32_16x16x32_bf16 v[140:143], v[16:19], v[192:195], v[140:143]
v_pk_mul_f16 v11, v10, v11
s_waitcnt vmcnt(0)
v_mfma_f32_16x16x32_bf16 v[144:147], v[18:21], v[196:199], v[144:147]
v_pk_mul_f16 v13, v12, v13
v_mfma_f32_16x16x32_bf16 v[148:151], v[16:19], v[196:199], v[148:151]
v_pk_mul_f16 v15, v14, v15
s_waitcnt lgkmcnt(5)
v_mfma_f32_16x16x32_f16 v[72:75], v[176:179], v[232:235], v[72:75]
v_cvt_pkrtz_f16_f32 v5, v4, v5
v_mfma_f32_16x16x32_bf16 v[96:99], v[180:183], v[64:67], v[96:99]
v_and_b32_e64 v5, s49, v5
v_mfma_f32_16x16x32_f16 v[80:83], v[176:179], v[236:239], v[80:83]
ds_read_b128 v[176:179], v251 offset:43008
v_bfe_u32 v4, v5, 2, 14
v_lshrrev_b32 v5, 18, v5
ds_read_u16 v4, v4
ds_read_u16_d16_hi v5, v5
v_or_b32 v91, v126, v127
v_exp_f16_sdwa v11, v11 dst_sel:WORD_0 dst_unused:UNUSED_PRESERVE src0_sel:WORD_0
v_mfma_f32_16x16x32_bf16 v[104:107], v[180:183], v[68:71], v[104:107]
ds_read_b128 v[180:183], v248 offset:35072
v_exp_f16_sdwa v13, v13 dst_sel:WORD_0 dst_unused:UNUSED_PRESERVE src0_sel:WORD_0
v_mfma_f32_16x16x32_f16 v[76:79], v[184:187], v[232:235], v[76:79]
v_cvt_pkrtz_f16_f32 v7, v6, v7
v_and_b32_e64 v7, s49, v7
v_bfe_u32 v6, v7, 2, 14
v_lshrrev_b32 v7, 18, v7
ds_read_u16 v6, v6
ds_read_u16_d16_hi v7, v7
v_exp_f16_sdwa v15, v15 dst_sel:WORD_0 dst_unused:UNUSED_PRESERVE src0_sel:WORD_0
v_or_b32 v92, v128, v129
v_mfma_f32_16x16x32_bf16 v[100:103], v[188:191], v[48:51], 0
v_exp_f16_sdwa v11, v11 dst_sel:WORD_1 dst_unused:UNUSED_PRESERVE src0_sel:WORD_1
v_mfma_f32_16x16x32_f16 v[84:87], v[184:187], v[236:239], v[84:87]
ds_read_b128 v[184:187], v251 offset:40960
v_exp_f16_sdwa v13, v13 dst_sel:WORD_1 dst_unused:UNUSED_PRESERVE src0_sel:WORD_1
v_mfma_f32_16x16x32_bf16 v[108:111], v[188:191], v[52:55], 0
ds_read_b128 v[188:191], v249
s_setprio 0
v_cvt_pkrtz_f16_f32 v9, v8, v9
v_and_b32 v9, s49, v9
v_bfe_u32 v8, v9, 2, 14
v_lshrrev_b32_e64 v9, 18, v9
ds_read_u16 v8, v8
ds_read_u16_d16_hi v9, v9
s_waitcnt lgkmcnt(8)
v_mfma_f32_16x16x32_f16 v[152:155], v[168:171], v[232:235], v[152:155]
v_exp_f16_sdwa v15, v15 dst_sel:WORD_1 dst_unused:UNUSED_PRESERVE src0_sel:WORD_1
v_mfma_f32_16x16x32_f16 v[160:163], v[168:171], v[236:239], v[160:163]
ds_read_b128 v[168:171], v251 offset:44032
v_pk_add_f16 v11, v11, 1.0 op_sel_hi:[1,0]
v_mfma_f32_16x16x32_bf16 v[100:103], v[172:175], v[56:59], v[100:103]
v_pk_add_f16 v13, v13, 1.0 op_sel_hi:[1,0]
v_pk_add_f16 v15, v15, 1.0 op_sel_hi:[1,0]
v_mfma_f32_16x16x32_f16 v[156:159], v[176:179], v[232:235], v[156:159]
v_rcp_f16_sdwa v11, v11 dst_sel:WORD_0 dst_unused:UNUSED_PRESERVE src0_sel:WORD_0
v_mfma_f32_16x16x32_bf16 v[108:111], v[172:175], v[60:63], v[108:111]
ds_read_b128 v[172:175], v249 offset:2048
v_rcp_f16_sdwa v13, v13 dst_sel:WORD_0 dst_unused:UNUSED_PRESERVE src0_sel:WORD_0
v_mfma_f32_16x16x32_f16 v[164:167], v[176:179], v[236:239], v[164:167]
ds_read_b128 v[176:179], v251 offset:8192
v_rcp_f16_sdwa v15, v15 dst_sel:WORD_0 dst_unused:UNUSED_PRESERVE src0_sel:WORD_0
s_waitcnt lgkmcnt(6)
v_mfma_f32_16x16x32_bf16 v[100:103], v[180:183], v[64:67], v[100:103]
v_cvt_pk_bf16_f32 v240, v72, v73
v_cvt_pk_bf16_f32 v241, v74, v75
v_cvt_pk_bf16_f32 v242, v76, v77
v_cvt_pk_bf16_f32 v243, v78, v79
v_cvt_pk_bf16_f32 v244, v80, v81
v_cvt_pk_bf16_f32 v245, v82, v83
v_cvt_pk_bf16_f32 v246, v84, v85
v_cvt_pk_bf16_f32 v247, v86, v87
ds_read_b128 v[72:75], v254 offset:8192
ds_read_b128 v[76:79], v254 offset:8208
ds_read_b128 v[80:83], v254 offset:8192
ds_read_b128 v[84:87], v254 offset:8208
v_mfma_f32_16x16x32_f16 v[136:139], v[184:187], v[232:235], v[136:139]
v_rcp_f16_sdwa v11, v11 dst_sel:WORD_1 dst_unused:UNUSED_PRESERVE src0_sel:WORD_1
v_mfma_f32_16x16x32_bf16 v[108:111], v[180:183], v[68:71], v[108:111]
ds_read_b128 v[180:183], v249 offset:4096
v_cvt_pk_bf16_f32 v224, v152, v153
v_cvt_pk_bf16_f32 v225, v154, v155
v_cvt_pk_bf16_f32 v226, v156, v157
v_cvt_pk_bf16_f32 v227, v158, v159
v_cvt_pk_bf16_f32 v228, v160, v161
v_cvt_pk_bf16_f32 v229, v162, v163
v_cvt_pk_bf16_f32 v230, v164, v165
v_cvt_pk_bf16_f32 v231, v166, v167
ds_read_b128 v[152:155], v254 offset:8320
ds_read_b128 v[156:159], v254 offset:8336
ds_read_b128 v[160:163], v254 offset:8320
ds_read_b128 v[164:167], v254 offset:8336
v_mfma_f32_16x16x32_f16 v[144:147], v[184:187], v[236:239], v[144:147]
ds_read_b128 v[184:187], v251 offset:11264
v_rcp_f16_sdwa v13, v13 dst_sel:WORD_1 dst_unused:UNUSED_PRESERVE src0_sel:WORD_1
v_cvt_pk_bf16_f32 v16, v136, v137
v_cvt_pk_bf16_f32 v17, v138, v139
ds_read_b128 v[136:139], v254
s_waitcnt lgkmcnt(10)
v_mfma_f32_16x16x32_bf16 v[120:123], v[188:191], v[48:51], 0
v_rcp_f16_sdwa v15, v15 dst_sel:WORD_1 dst_unused:UNUSED_PRESERVE src0_sel:WORD_1
v_cvt_pk_bf16_f32 v20, v144, v145
v_cvt_pk_bf16_f32 v21, v146, v147
ds_read_b128 v[144:147], v254
v_mfma_f32_16x16x32_f16 v[140:143], v[168:171], v[232:235], v[140:143]
v_or_b32 v216, v0, v1
v_pk_mul_f16 v221, v10, v11
v_mfma_f32_16x16x32_bf16 v[128:131], v[188:191], v[52:55], 0
ds_read_b128 v[188:191], v251 offset:9216
v_pk_mul_f16 v222, v12, v13
v_mfma_f32_16x16x32_f16 v[148:151], v[168:171], v[236:239], v[148:151]
s_setprio 3
s_nop 0
v_cvt_pk_bf16_f32 v18, v140, v141
v_cvt_pk_bf16_f32 v19, v142, v143
ds_read_b128 v[140:143], v254 offset:16
ds_read_b128 v[168:171], v249 offset:256
v_pk_mul_f16 v223, v14, v15
v_cvt_pkrtz_f16_f32 v97, v96, v97
v_and_b32_e64 v97, s49, v97
v_bfe_u32 v96, v97, 2, 14
v_lshrrev_b32 v97, 18, v97
v_cvt_pk_bf16_f32 v22, v148, v149
v_cvt_pk_bf16_f32 v23, v150, v151
ds_read_b128 v[148:151], v254 offset:16
ds_read_u16 v96, v96
ds_read_u16_d16_hi v97, v97
v_cvt_pk_f16_f32 v106, v106, v107
v_or_b32 v217, v2, v3
v_mfma_f32_16x16x32_bf16 v[120:123], v[172:175], v[56:59], v[120:123]
buffer_store_dwordx4 v[240:243], v253, s[8:11], s71 offen sc1
v_cvt_pk_f16_f32 v108, v108, v109
v_mfma_f32_16x16x32_f16 v[72:75], v[176:179], v[112:115], v[72:75]
v_cvt_pk_f16_f32 v110, v110, v111
v_pk_fma_f16 v107, v106, v106, s48
v_mfma_f32_16x16x32_bf16 v[128:131], v[172:175], v[60:63], v[128:131]
ds_read_b128 v[172:175], v251 offset:12288
v_pk_fma_f16 v109, v108, v108, s48
v_cvt_pkrtz_f16_f32 v99, v98, v99
v_and_b32_e64 v99, s49, v99
v_bfe_u32 v98, v99, 2, 14
v_lshrrev_b32_e64 v99, 18, v99
ds_read_u16 v98, v98
ds_read_u16_d16_hi v99, v99
s_waitcnt lgkmcnt(8)
v_mfma_f32_16x16x32_f16 v[80:83], v[176:179], v[116:119], v[80:83]
ds_read_b128 v[176:179], v249 offset:2304
v_or_b32 v218, v4, v5
v_pk_fma_f16 v111, v110, v110, s48
v_pk_mul_f16 v107, v106, v107
v_pk_mul_f16 v109, v108, v109
v_mfma_f32_16x16x32_bf16 v[120:123], v[180:183], v[64:67], v[120:123]
v_pk_mul_f16 v111, v110, v111
v_mfma_f32_16x16x32_f16 v[76:79], v[184:187], v[112:115], v[76:79]
v_cvt_pkrtz_f16_f32 v101, v100, v101
v_and_b32_e64 v101, s49, v101
v_bfe_u32 v100, v101, 2, 14
v_lshrrev_b32 v101, 18, v101
ds_read_u16 v100, v100
ds_read_u16_d16_hi v101, v101
v_or_b32 v219, v6, v7
v_exp_f16_sdwa v107, v107 dst_sel:WORD_0 dst_unused:UNUSED_PRESERVE src0_sel:WORD_0
v_mfma_f32_16x16x32_f16 v[84:87], v[184:187], v[116:119], v[84:87]
ds_read_b128 v[184:187], v249 offset:4352
v_exp_f16_sdwa v109, v109 dst_sel:WORD_0 dst_unused:UNUSED_PRESERVE src0_sel:WORD_0
v_mfma_f32_16x16x32_bf16 v[128:131], v[180:183], v[68:71], v[128:131]
ds_read_b128 v[180:183], v251 offset:10240
v_cvt_pkrtz_f16_f32 v103, v102, v103
v_and_b32_e64 v103, s49, v103
v_bfe_u32 v102, v103, 2, 14
v_lshrrev_b32_e64 v103, 18, v103
ds_read_u16 v102, v102
ds_read_u16_d16_hi v103, v103
v_exp_f16_sdwa v111, v111 dst_sel:WORD_0 dst_unused:UNUSED_PRESERVE src0_sel:WORD_0
v_mfma_f32_16x16x32_f16 v[152:155], v[188:191], v[112:115], v[152:155]
v_or_b32 v220, v8, v9
s_waitcnt lgkmcnt(8)
v_mfma_f32_16x16x32_bf16 v[124:127], v[168:171], v[48:51], 0
v_exp_f16_sdwa v107, v107 dst_sel:WORD_1 dst_unused:UNUSED_PRESERVE src0_sel:WORD_1
v_mfma_f32_16x16x32_f16 v[160:163], v[188:191], v[116:119], v[160:163]
ds_read_b128 v[188:191], v251 offset:13312
v_exp_f16_sdwa v109, v109 dst_sel:WORD_1 dst_unused:UNUSED_PRESERVE src0_sel:WORD_1
v_mfma_f32_16x16x32_bf16 v[132:135], v[168:171], v[52:55], 0
ds_read_b128 v[168:171], v249 offset:6144
v_cvt_pkrtz_f16_f32 v105, v104, v105
v_and_b32_e64 v105, s49, v105
v_bfe_u32 v104, v105, 2, 14
v_lshrrev_b32 v105, 18, v105
ds_read_u16 v104, v104
ds_read_u16_d16_hi v105, v105
s_setprio 2
v_exp_f16_sdwa v111, v111 dst_sel:WORD_1 dst_unused:UNUSED_PRESERVE src0_sel:WORD_1
v_mfma_f32_16x16x32_f16 v[156:159], v[172:175], v[112:115], v[156:159]
v_pk_add_f16 v107, v107, 1.0 op_sel_hi:[1,0]
s_waitcnt lgkmcnt(8)
v_mfma_f32_16x16x32_bf16 v[124:127], v[176:179], v[56:59], v[124:127]
v_pk_add_f16 v109, v109, 1.0 op_sel_hi:[1,0]
v_mfma_f32_16x16x32_f16 v[164:167], v[172:175], v[116:119], v[164:167]
ds_read_b128 v[172:175], v251 offset:14336
v_pk_add_f16 v111, v111, 1.0 op_sel_hi:[1,0]
v_mfma_f32_16x16x32_bf16 v[132:135], v[176:179], v[60:63], v[132:135]
ds_read_b128 v[176:179], v249 offset:8192
v_rcp_f16_sdwa v107, v107 dst_sel:WORD_0 dst_unused:UNUSED_PRESERVE src0_sel:WORD_0
s_waitcnt lgkmcnt(8)
v_mfma_f32_16x16x32_f16 v[136:139], v[180:183], v[112:115], v[136:139]
v_rcp_f16_sdwa v109, v109 dst_sel:WORD_0 dst_unused:UNUSED_PRESERVE src0_sel:WORD_0
v_mfma_f32_16x16x32_bf16 v[124:127], v[184:187], v[64:67], v[124:127]
v_rcp_f16_sdwa v111, v111 dst_sel:WORD_0 dst_unused:UNUSED_PRESERVE src0_sel:WORD_0
v_mfma_f32_16x16x32_f16 v[144:147], v[180:183], v[116:119], v[144:147]
ds_read_b128 v[180:183], v251 offset:17408
v_rcp_f16_sdwa v107, v107 dst_sel:WORD_1 dst_unused:UNUSED_PRESERVE src0_sel:WORD_1
v_mfma_f32_16x16x32_bf16 v[132:135], v[184:187], v[68:71], v[132:135]
ds_read_b128 v[184:187], v249 offset:10240
v_rcp_f16_sdwa v109, v109 dst_sel:WORD_1 dst_unused:UNUSED_PRESERVE src0_sel:WORD_1
s_waitcnt lgkmcnt(6)
v_mfma_f32_16x16x32_f16 v[140:143], v[188:191], v[112:115], v[140:143]
buffer_store_dwordx4 v[244:247], v253, s[8:11], s71 offen offset:192 sc1
v_rcp_f16_sdwa v111, v111 dst_sel:WORD_1 dst_unused:UNUSED_PRESERVE src0_sel:WORD_1
v_mfma_f32_16x16x32_bf16 v[0:3], v[168:171], v[48:51], 0
v_or_b32 v192, v96, v97
v_mfma_f32_16x16x32_f16 v[148:151], v[188:191], v[116:119], v[148:151]
ds_read_b128 v[188:191], v251 offset:15360
v_pk_mul_f16 v197, v106, v107
v_mfma_f32_16x16x32_bf16 v[8:11], v[168:171], v[52:55], 0
ds_read_b128 v[168:171], v249 offset:6400
v_pk_mul_f16 v198, v108, v109
s_waitcnt lgkmcnt(5)
v_mfma_f32_16x16x32_f16 v[72:75], v[172:175], v[200:203], v[72:75]
s_setprio 1
v_pk_mul_f16 v199, v110, v111
v_cvt_pkrtz_f16_f32 v121, v120, v121
v_and_b32_e64 v121, s49, v121
v_bfe_u32 v120, v121, 2, 14
v_lshrrev_b32_e64 v121, 18, v121
ds_read_u16 v120, v120
ds_read_u16_d16_hi v121, v121
v_cvt_pk_f16_f32 v130, v130, v131
v_or_b32 v193, v98, v99
v_mfma_f32_16x16x32_f16 v[80:83], v[172:175], v[204:207], v[80:83]
ds_read_b128 v[172:175], v251 offset:18432
v_cvt_pk_f16_f32 v132, v132, v133
s_waitcnt lgkmcnt(5)
v_mfma_f32_16x16x32_bf16 v[0:3], v[176:179], v[56:59], v[0:3]
v_cvt_pk_f16_f32 v134, v134, v135
v_pk_fma_f16 v131, v130, v130, s48
v_mfma_f32_16x16x32_f16 v[76:79], v[180:183], v[200:203], v[76:79]
v_pk_fma_f16 v133, v132, v132, s48
v_mfma_f32_16x16x32_bf16 v[8:11], v[176:179], v[60:63], v[8:11]
ds_read_b128 v[176:179], v249 offset:8448
v_cvt_pkrtz_f16_f32 v123, v122, v123
v_and_b32_e64 v123, s49, v123
v_bfe_u32 v122, v123, 2, 14
v_lshrrev_b32 v123, 18, v123
ds_read_u16 v122, v122
ds_read_u16_d16_hi v123, v123
v_or_b32 v194, v100, v101
v_pk_fma_f16 v135, v134, v134, s48
v_pk_mul_f16 v131, v130, v131
v_mfma_f32_16x16x32_f16 v[84:87], v[180:183], v[204:207], v[84:87]
ds_read_b128 v[180:183], v251 offset:16384
v_pk_mul_f16 v133, v132, v133
v_mfma_f32_16x16x32_bf16 v[0:3], v[184:187], v[64:67], v[0:3]
v_pk_mul_f16 v135, v134, v135
v_cvt_pkrtz_f16_f32 v125, v124, v125
v_and_b32_e64 v125, s49, v125
v_bfe_u32 v124, v125, 2, 14
v_lshrrev_b32_e64 v125, 18, v125
ds_read_u16 v124, v124
ds_read_u16_d16_hi v125, v125
v_or_b32 v195, v102, v103
v_exp_f16_sdwa v131, v131 dst_sel:WORD_0 dst_unused:UNUSED_PRESERVE src0_sel:WORD_0
s_waitcnt lgkmcnt(7)
v_mfma_f32_16x16x32_f16 v[152:155], v[188:191], v[200:203], v[152:155]
v_exp_f16_sdwa v133, v133 dst_sel:WORD_0 dst_unused:UNUSED_PRESERVE src0_sel:WORD_0
v_mfma_f32_16x16x32_bf16 v[8:11], v[184:187], v[68:71], v[8:11]
ds_read_b128 v[184:187], v249 offset:10496
v_cvt_pkrtz_f16_f32 v127, v126, v127
v_mfma_f32_16x16x32_f16 v[160:163], v[188:191], v[204:207], v[160:163]
ds_read_b128 v[188:191], v251 offset:19456
v_and_b32_e64 v127, s49, v127
v_bfe_u32 v126, v127, 2, 14
v_lshrrev_b32_e64 v127, 18, v127
ds_read_u16 v126, v126
ds_read_u16_d16_hi v127, v127
v_exp_f16_sdwa v135, v135 dst_sel:WORD_0 dst_unused:UNUSED_PRESERVE src0_sel:WORD_0
v_or_b32 v196, v104, v105
v_mfma_f32_16x16x32_bf16 v[4:7], v[168:171], v[48:51], 0
v_exp_f16_sdwa v131, v131 dst_sel:WORD_1 dst_unused:UNUSED_PRESERVE src0_sel:WORD_1
s_waitcnt lgkmcnt(6)
v_mfma_f32_16x16x32_f16 v[156:159], v[172:175], v[200:203], v[156:159]
v_exp_f16_sdwa v133, v133 dst_sel:WORD_1 dst_unused:UNUSED_PRESERVE src0_sel:WORD_1
v_mfma_f32_16x16x32_bf16 v[12:15], v[168:171], v[52:55], 0
ds_read_b128 v[168:171], v251 offset:20480
v_cvt_pkrtz_f16_f32 v129, v128, v129
v_and_b32_e64 v129, s49, v129
v_bfe_u32 v128, v129, 2, 14
v_lshrrev_b32 v129, 18, v129
ds_read_u16 v128, v128
ds_read_u16_d16_hi v129, v129
v_mfma_f32_16x16x32_f16 v[164:167], v[172:175], v[204:207], v[164:167]
ds_read_b128 v[172:175], v249 offset:12288
s_setprio 0
v_exp_f16_sdwa v135, v135 dst_sel:WORD_1 dst_unused:UNUSED_PRESERVE src0_sel:WORD_1
v_mfma_f32_16x16x32_bf16 v[4:7], v[176:179], v[56:59], v[4:7]
v_pk_add_f16 v131, v131, 1.0 op_sel_hi:[1,0]
v_mfma_f32_16x16x32_f16 v[136:139], v[180:183], v[200:203], v[136:139]
v_pk_add_f16 v133, v133, 1.0 op_sel_hi:[1,0]
v_pk_add_f16 v135, v135, 1.0 op_sel_hi:[1,0]
v_mfma_f32_16x16x32_bf16 v[12:15], v[176:179], v[60:63], v[12:15]
ds_read_b128 v[176:179], v251 offset:23552
v_rcp_f16_sdwa v131, v131 dst_sel:WORD_0 dst_unused:UNUSED_PRESERVE src0_sel:WORD_0
v_mfma_f32_16x16x32_f16 v[144:147], v[180:183], v[204:207], v[144:147]
ds_read_b128 v[180:183], v249 offset:14336
v_rcp_f16_sdwa v133, v133 dst_sel:WORD_0 dst_unused:UNUSED_PRESERVE src0_sel:WORD_0
buffer_store_dwordx4 v[224:227], v253, s[8:11], s71 offen offset:64 sc1
s_waitcnt lgkmcnt(7)
v_mfma_f32_16x16x32_bf16 v[4:7], v[184:187], v[64:67], v[4:7]
v_rcp_f16_sdwa v135, v135 dst_sel:WORD_0 dst_unused:UNUSED_PRESERVE src0_sel:WORD_0
v_mfma_f32_16x16x32_f16 v[140:143], v[188:191], v[200:203], v[140:143]
v_rcp_f16_sdwa v131, v131 dst_sel:WORD_1 dst_unused:UNUSED_PRESERVE src0_sel:WORD_1
v_mfma_f32_16x16x32_f16 v[148:151], v[188:191], v[204:207], v[148:151]
ds_read_b128 v[188:191], v249 offset:16384
v_rcp_f16_sdwa v133, v133 dst_sel:WORD_1 dst_unused:UNUSED_PRESERVE src0_sel:WORD_1
v_mfma_f32_16x16x32_bf16 v[12:15], v[184:187], v[68:71], v[12:15]
ds_read_b128 v[184:187], v251 offset:21504
v_rcp_f16_sdwa v135, v135 dst_sel:WORD_1 dst_unused:UNUSED_PRESERVE src0_sel:WORD_1
s_waitcnt lgkmcnt(6)
v_mfma_f32_16x16x32_f16 v[72:75], v[168:171], v[208:211], v[72:75]
s_getpc_b64 s[74:75]
Lcq11:
s_lshl_b32 s43, s40, 10
s_add_u32 s43, s43, 6144
s_min_u32 s43, s43, Lend-Lcq11-1024
s_add_u32 s74, s74, s43
s_addc_u32 s75, s75, 0
s_sub_u32 s74, s74, 16384
s_subb_u32 s75, s75, 0
s_mov_b32 m0, 163840
s_nop 0
global_load_lds_dword v250, s[74:75]
v_or_b32 v232, v120, v121
s_waitcnt lgkmcnt(4)
v_mfma_f32_16x16x32_bf16 v[96:99], v[172:175], v[48:51], 0
v_pk_mul_f16 v237, v130, v131
v_mfma_f32_16x16x32_f16 v[80:83], v[168:171], v[212:215], v[80:83]
ds_read_b128 v[168:171], v251 offset:24576
v_pk_mul_f16 v238, v132, v133
v_mfma_f32_16x16x32_bf16 v[104:107], v[172:175], v[52:55], 0
ds_read_b128 v[172:175], v249 offset:12544
v_pk_mul_f16 v239, v134, v135
s_setprio 3
s_waitcnt lgkmcnt(4)
v_mfma_f32_16x16x32_f16 v[76:79], v[176:179], v[208:211], v[76:79]
v_cvt_pkrtz_f16_f32 v1, v0, v1
v_and_b32_e64 v1, s49, v1
v_bfe_u32 v0, v1, 2, 14
v_lshrrev_b32 v1, 18, v1
ds_read_u16 v0, v0
ds_read_u16_d16_hi v1, v1
v_cvt_pk_f16_f32 v10, v10, v11
v_or_b32 v233, v122, v123
v_mfma_f32_16x16x32_bf16 v[96:99], v[180:183], v[56:59], v[96:99]
v_cvt_pk_f16_f32 v12, v12, v13
v_cvt_pk_f16_f32 v14, v14, v15
v_mfma_f32_16x16x32_f16 v[84:87], v[176:179], v[212:215], v[84:87]
ds_read_b128 v[176:179], v251 offset:22528
v_pk_fma_f16 v11, v10, v10, s48
v_mfma_f32_16x16x32_bf16 v[104:107], v[180:183], v[60:63], v[104:107]
ds_read_b128 v[180:183], v249 offset:14592
v_pk_fma_f16 v13, v12, v12, s48
v_cvt_pkrtz_f16_f32 v3, v2, v3
v_and_b32_e64 v3, s49, v3
v_bfe_u32 v2, v3, 2, 14
v_lshrrev_b32_e64 v3, 18, v3
ds_read_u16 v2, v2
ds_read_u16_d16_hi v3, v3
v_or_b32 v234, v124, v125
v_pk_fma_f16 v15, v14, v14, s48
s_waitcnt lgkmcnt(6)
v_mfma_f32_16x16x32_f16 v[152:155], v[184:187], v[208:211], v[152:155]
v_pk_mul_f16 v11, v10, v11
v_pk_mul_f16 v13, v12, v13
v_mfma_f32_16x16x32_bf16 v[96:99], v[188:191], v[64:67], v[96:99]
v_pk_mul_f16 v15, v14, v15
v_mfma_f32_16x16x32_f16 v[160:163], v[184:187], v[212:215], v[160:163]
ds_read_b128 v[184:187], v251 offset:25600
v_cvt_pkrtz_f16_f32 v5, v4, v5
v_and_b32_e64 v5, s49, v5
v_bfe_u32 v4, v5, 2, 14
v_lshrrev_b32 v5, 18, v5
ds_read_u16 v4, v4
ds_read_u16_d16_hi v5, v5
v_or_b32 v235, v126, v127
v_exp_f16_sdwa v11, v11 dst_sel:WORD_0 dst_unused:UNUSED_PRESERVE src0_sel:WORD_0
v_mfma_f32_16x16x32_bf16 v[104:107], v[188:191], v[68:71], v[104:107]
ds_read_b128 v[188:191], v249 offset:16640
v_exp_f16_sdwa v13, v13 dst_sel:WORD_0 dst_unused:UNUSED_PRESERVE src0_sel:WORD_0
buffer_load_dwordx4 v[240:243], v253, s[4:7], s70 offen
v_mfma_f32_16x16x32_f16 v[156:159], v[168:171], v[208:211], v[156:159]
v_cvt_pkrtz_f16_f32 v7, v6, v7
v_and_b32_e64 v7, s49, v7
v_bfe_u32 v6, v7, 2, 14
v_lshrrev_b32_e64 v7, 18, v7
ds_read_u16 v6, v6
ds_read_u16_d16_hi v7, v7
v_exp_f16_sdwa v15, v15 dst_sel:WORD_0 dst_unused:UNUSED_PRESERVE src0_sel:WORD_0
v_or_b32 v236, v128, v129
v_mfma_f32_16x16x32_bf16 v[100:103], v[172:175], v[48:51], 0
v_exp_f16_sdwa v11, v11 dst_sel:WORD_1 dst_unused:UNUSED_PRESERVE src0_sel:WORD_1
v_mfma_f32_16x16x32_f16 v[164:167], v[168:171], v[212:215], v[164:167]
ds_read_b128 v[168:171], v251 offset:26624
v_exp_f16_sdwa v13, v13 dst_sel:WORD_1 dst_unused:UNUSED_PRESERVE src0_sel:WORD_1
s_waitcnt lgkmcnt(6)
v_mfma_f32_16x16x32_f16 v[136:139], v[176:179], v[208:211], v[136:139]
v_cvt_pkrtz_f16_f32 v9, v8, v9
v_mfma_f32_16x16x32_bf16 v[108:111], v[172:175], v[52:55], 0
ds_read_b128 v[172:175], v249 offset:18432
v_and_b32_e64 v9, s49, v9
v_bfe_u32 v8, v9, 2, 14
v_lshrrev_b32 v9, 18, v9
ds_read_u16 v8, v8
ds_read_u16_d16_hi v9, v9
buffer_store_dwordx4 v[228:231], v253, s[8:11], s71 offen offset:256 sc1
s_setprio 2
v_exp_f16_sdwa v15, v15 dst_sel:WORD_1 dst_unused:UNUSED_PRESERVE src0_sel:WORD_1
v_mfma_f32_16x16x32_f16 v[144:147], v[176:179], v[212:215], v[144:147]
ds_read_b128 v[176:179], v251 offset:29696
v_pk_add_f16 v11, v11, 1.0 op_sel_hi:[1,0]
v_mfma_f32_16x16x32_bf16 v[100:103], v[180:183], v[56:59], v[100:103]
v_pk_add_f16 v13, v13, 1.0 op_sel_hi:[1,0]
v_mfma_f32_16x16x32_f16 v[140:143], v[184:187], v[208:211], v[140:143]
v_pk_add_f16 v15, v15, 1.0 op_sel_hi:[1,0]
v_mfma_f32_16x16x32_bf16 v[108:111], v[180:183], v[60:63], v[108:111]
ds_read_b128 v[180:183], v249 offset:20480
v_rcp_f16_sdwa v11, v11 dst_sel:WORD_0 dst_unused:UNUSED_PRESERVE src0_sel:WORD_0
v_mfma_f32_16x16x32_f16 v[148:151], v[184:187], v[212:215], v[148:151]
ds_read_b128 v[184:187], v251 offset:27648
v_rcp_f16_sdwa v13, v13 dst_sel:WORD_0 dst_unused:UNUSED_PRESERVE src0_sel:WORD_0
s_waitcnt lgkmcnt(6)
v_mfma_f32_16x16x32_bf16 v[100:103], v[188:191], v[64:67], v[100:103]
v_rcp_f16_sdwa v15, v15 dst_sel:WORD_0 dst_unused:UNUSED_PRESERVE src0_sel:WORD_0
v_mfma_f32_16x16x32_f16 v[72:75], v[168:171], v[88:91], v[72:75]
buffer_load_dwordx4 v[244:247], v253, s[4:7], s70 offen offset:192
v_rcp_f16_sdwa v11, v11 dst_sel:WORD_1 dst_unused:UNUSED_PRESERVE src0_sel:WORD_1
v_mfma_f32_16x16x32_bf16 v[108:111], v[188:191], v[68:71], v[108:111]
ds_read_b128 v[188:191], v251 offset:30720
v_rcp_f16_sdwa v13, v13 dst_sel:WORD_1 dst_unused:UNUSED_PRESERVE src0_sel:WORD_1
v_mfma_f32_16x16x32_f16 v[80:83], v[168:171], v[92:95], v[80:83]
ds_read_b128 v[168:171], v249 offset:22528
v_rcp_f16_sdwa v15, v15 dst_sel:WORD_1 dst_unused:UNUSED_PRESERVE src0_sel:WORD_1
s_waitcnt lgkmcnt(5)
v_mfma_f32_16x16x32_bf16 v[120:123], v[172:175], v[48:51], 0
v_or_b32 v112, v0, v1
s_waitcnt lgkmcnt(4)
v_mfma_f32_16x16x32_f16 v[76:79], v[176:179], v[88:91], v[76:79]
v_pk_mul_f16 v117, v10, v11
v_mfma_f32_16x16x32_bf16 v[128:131], v[172:175], v[52:55], 0
ds_read_b128 v[172:175], v251 offset:28672
v_pk_mul_f16 v118, v12, v13
v_mfma_f32_16x16x32_f16 v[84:87], v[176:179], v[92:95], v[84:87]
ds_read_b128 v[176:179], v249 offset:18688
v_pk_mul_f16 v119, v14, v15
s_setprio 1
v_cvt_pkrtz_f16_f32 v97, v96, v97
v_and_b32 v97, s49, v97
v_bfe_u32 v96, v97, 2, 14
v_lshrrev_b32_e64 v97, 18, v97
ds_read_u16 v96, v96
ds_read_u16_d16_hi v97, v97
v_cvt_pk_f16_f32 v106, v106, v107
v_or_b32 v113, v2, v3
s_waitcnt lgkmcnt(5)
v_mfma_f32_16x16x32_bf16 v[120:123], v[180:183], v[56:59], v[120:123]
v_cvt_pk_f16_f32 v108, v108, v109
v_mfma_f32_16x16x32_f16 v[152:155], v[184:187], v[88:91], v[152:155]
v_cvt_pk_f16_f32 v110, v110, v111
v_pk_fma_f16 v107, v106, v106, s48
v_mfma_f32_16x16x32_bf16 v[128:131], v[180:183], v[60:63], v[128:131]
ds_read_b128 v[180:183], v251 offset:31744
v_pk_fma_f16 v109, v108, v108, s48
v_mfma_f32_16x16x32_f16 v[160:163], v[184:187], v[92:95], v[160:163]
ds_read_b128 v[184:187], v249 offset:20736
v_cvt_pkrtz_f16_f32 v99, v98, v99
v_and_b32_e64 v99, s49, v99
v_bfe_u32 v98, v99, 2, 14
v_lshrrev_b32 v99, 18, v99
ds_read_u16 v98, v98
ds_read_u16_d16_hi v99, v99
v_or_b32 v114, v4, v5
v_pk_fma_f16 v111, v110, v110, s48
v_pk_mul_f16 v107, v106, v107
v_pk_mul_f16 v109, v108, v109
buffer_load_dwordx4 v[200:203], v253, s[4:7], s70 offen offset:64
v_mfma_f32_16x16x32_f16 v[156:159], v[188:191], v[88:91], v[156:159]
v_pk_mul_f16 v111, v110, v111
s_waitcnt lgkmcnt(6)
v_mfma_f32_16x16x32_bf16 v[120:123], v[168:171], v[64:67], v[120:123]
v_cvt_pkrtz_f16_f32 v101, v100, v101
v_and_b32 v101, s49, v101
v_bfe_u32 v100, v101, 2, 14
v_lshrrev_b32 v101, 18, v101
ds_read_u16 v100, v100
ds_read_u16_d16_hi v101, v101
v_or_b32 v115, v6, v7
v_exp_f16_sdwa v107, v107 dst_sel:WORD_0 dst_unused:UNUSED_PRESERVE src0_sel:WORD_0
v_mfma_f32_16x16x32_f16 v[164:167], v[188:191], v[92:95], v[164:167]
ds_read_b128 v[188:191], v251 offset:32768
v_exp_f16_sdwa v109, v109 dst_sel:WORD_0 dst_unused:UNUSED_PRESERVE src0_sel:WORD_0
v_mfma_f32_16x16x32_bf16 v[128:131], v[168:171], v[68:71], v[128:131]
ds_read_b128 v[168:171], v249 offset:22784
buffer_store_dwordx4 v[16:19], v253, s[8:11], s71 offen offset:128 sc1
v_cvt_pkrtz_f16_f32 v103, v102, v103
v_and_b32_e64 v103, s49, v103
v_bfe_u32 v102, v103, 2, 14
v_lshrrev_b32 v103, 18, v103
ds_read_u16 v102, v102
ds_read_u16_d16_hi v103, v103
v_mfma_f32_16x16x32_f16 v[136:139], v[172:175], v[88:91], v[136:139]
v_exp_f16_sdwa v111, v111 dst_sel:WORD_0 dst_unused:UNUSED_PRESERVE src0_sel:WORD_0
v_or_b32 v116, v8, v9
v_mfma_f32_16x16x32_bf16 v[124:127], v[176:179], v[48:51], 0
v_exp_f16_sdwa v107, v107 dst_sel:WORD_1 dst_unused:UNUSED_PRESERVE src0_sel:WORD_1
v_mfma_f32_16x16x32_f16 v[144:147], v[172:175], v[92:95], v[144:147]
ds_read_b128 v[172:175], v251 offset:35840
v_exp_f16_sdwa v109, v109 dst_sel:WORD_1 dst_unused:UNUSED_PRESERVE src0_sel:WORD_1
v_mfma_f32_16x16x32_bf16 v[132:135], v[176:179], v[52:55], 0
ds_read_b128 v[176:179], v249 offset:24576
v_cvt_pkrtz_f16_f32 v105, v104, v105
v_and_b32_e64 v105, s49, v105
v_bfe_u32 v104, v105, 2, 14
v_lshrrev_b32_e64 v105, 18, v105
ds_read_u16 v104, v104
ds_read_u16_d16_hi v105, v105
s_waitcnt lgkmcnt(8)
v_mfma_f32_16x16x32_f16 v[140:143], v[180:183], v[88:91], v[140:143]
v_exp_f16_sdwa v111, v111 dst_sel:WORD_1 dst_unused:UNUSED_PRESERVE src0_sel:WORD_1
s_setprio 0
v_mfma_f32_16x16x32_bf16 v[124:127], v[184:187], v[56:59], v[124:127]
v_pk_add_f16 v107, v107, 1.0 op_sel_hi:[1,0]
v_mfma_f32_16x16x32_f16 v[148:151], v[180:183], v[92:95], v[148:151]
ds_read_b128 v[180:183], v251 offset:33792
v_pk_add_f16 v109, v109, 1.0 op_sel_hi:[1,0]
v_pk_add_f16 v111, v111, 1.0 op_sel_hi:[1,0]
v_mfma_f32_16x16x32_bf16 v[132:135], v[184:187], v[60:63], v[132:135]
ds_read_b128 v[184:187], v249 offset:26624
v_rcp_f16_sdwa v107, v107 dst_sel:WORD_0 dst_unused:UNUSED_PRESERVE src0_sel:WORD_0
s_waitcnt lgkmcnt(7)
v_mfma_f32_16x16x32_f16 v[72:75], v[188:191], v[216:219], v[72:75]
buffer_load_dwordx4 v[204:207], v253, s[4:7], s70 offen offset:256
v_rcp_f16_sdwa v109, v109 dst_sel:WORD_0 dst_unused:UNUSED_PRESERVE src0_sel:WORD_0
v_mfma_f32_16x16x32_bf16 v[124:127], v[168:171], v[64:67], v[124:127]
v_rcp_f16_sdwa v111, v111 dst_sel:WORD_0 dst_unused:UNUSED_PRESERVE src0_sel:WORD_0
v_mfma_f32_16x16x32_f16 v[80:83], v[188:191], v[220:223], v[80:83]
ds_read_b128 v[188:191], v251 offset:36864
v_rcp_f16_sdwa v107, v107 dst_sel:WORD_1 dst_unused:UNUSED_PRESERVE src0_sel:WORD_1
v_mfma_f32_16x16x32_bf16 v[132:135], v[168:171], v[68:71], v[132:135]
ds_read_b128 v[168:171], v249 offset:28672
v_rcp_f16_sdwa v109, v109 dst_sel:WORD_1 dst_unused:UNUSED_PRESERVE src0_sel:WORD_1
s_waitcnt lgkmcnt(5)
v_mfma_f32_16x16x32_f16 v[76:79], v[172:175], v[216:219], v[76:79]
v_rcp_f16_sdwa v111, v111 dst_sel:WORD_1 dst_unused:UNUSED_PRESERVE src0_sel:WORD_1
v_mfma_f32_16x16x32_bf16 v[0:3], v[176:179], v[48:51], 0
v_or_b32 v224, v96, v97
v_mfma_f32_16x16x32_f16 v[84:87], v[172:175], v[220:223], v[84:87]
ds_read_b128 v[172:175], v251 offset:34816
v_pk_mul_f16 v229, v106, v107
s_waitcnt lgkmcnt(4)
v_mfma_f32_16x16x32_f16 v[152:155], v[180:183], v[216:219], v[152:155]
v_pk_mul_f16 v230, v108, v109
v_mfma_f32_16x16x32_bf16 v[8:11], v[176:179], v[52:55], 0
ds_read_b128 v[176:179], v249 offset:24832
v_pk_mul_f16 v231, v110, v111
v_cvt_pkrtz_f16_f32 v121, v120, v121
v_and_b32_e64 v121, s49, v121
v_bfe_u32 v120, v121, 2, 14
v_lshrrev_b32 v121, 18, v121
ds_read_u16 v120, v120
ds_read_u16_d16_hi v121, v121
v_cvt_pk_f16_f32 v130, v130, v131
v_mfma_f32_16x16x32_f16 v[160:163], v[180:183], v[220:223], v[160:163]
ds_read_b128 v[180:183], v251 offset:37888
s_setprio 3
v_or_b32 v225, v98, v99
buffer_load_dwordx4 v[208:211], v253, s[4:7], s70 offen offset:128
s_waitcnt lgkmcnt(5)
v_mfma_f32_16x16x32_bf16 v[0:3], v[184:187], v[56:59], v[0:3]
v_cvt_pk_f16_f32 v132, v132, v133
v_cvt_pk_f16_f32 v134, v134, v135
v_pk_fma_f16 v131, v130, v130, s48
v_mfma_f32_16x16x32_f16 v[156:159], v[188:191], v[216:219], v[156:159]
v_pk_fma_f16 v133, v132, v132, s48
v_mfma_f32_16x16x32_bf16 v[8:11], v[184:187], v[60:63], v[8:11]
ds_read_b128 v[184:187], v249 offset:26880
v_cvt_pkrtz_f16_f32 v123, v122, v123
v_and_b32_e64 v123, s49, v123
v_bfe_u32 v122, v123, 2, 14
v_lshrrev_b32 v123, 18, v123
ds_read_u16 v122, v122
ds_read_u16_d16_hi v123, v123
v_or_b32 v226, v100, v101
buffer_store_dwordx4 v[20:23], v253, s[8:11], s71 offen offset:320 sc1
v_pk_fma_f16 v135, v134, v134, s48
v_mfma_f32_16x16x32_f16 v[164:167], v[188:191], v[220:223], v[164:167]
ds_read_b128 v[188:191], v251 offset:38912
v_pk_mul_f16 v131, v130, v131
v_pk_mul_f16 v133, v132, v133
v_mfma_f32_16x16x32_bf16 v[0:3], v[168:171], v[64:67], v[0:3]
v_pk_mul_f16 v135, v134, v135
v_cvt_pkrtz_f16_f32 v125, v124, v125
v_and_b32_e64 v125, s49, v125
v_bfe_u32 v124, v125, 2, 14
v_lshrrev_b32_e64 v125, 18, v125
ds_read_u16 v124, v124
ds_read_u16_d16_hi v125, v125
s_waitcnt lgkmcnt(7)
v_mfma_f32_16x16x32_f16 v[136:139], v[172:175], v[216:219], v[136:139]
v_or_b32 v227, v102, v103
v_exp_f16_sdwa v131, v131 dst_sel:WORD_0 dst_unused:UNUSED_PRESERVE src0_sel:WORD_0
v_mfma_f32_16x16x32_bf16 v[8:11], v[168:171], v[68:71], v[8:11]
ds_read_b128 v[168:171], v251 offset:41984
v_exp_f16_sdwa v133, v133 dst_sel:WORD_0 dst_unused:UNUSED_PRESERVE src0_sel:WORD_0
v_mfma_f32_16x16x32_f16 v[144:147], v[172:175], v[220:223], v[144:147]
ds_read_b128 v[172:175], v249 offset:28928
v_cvt_pkrtz_f16_f32 v127, v126, v127
v_and_b32_e64 v127, s49, v127
v_bfe_u32 v126, v127, 2, 14
v_lshrrev_b32_e64 v127, 18, v127
ds_read_u16 v126, v126
ds_read_u16_d16_hi v127, v127
v_exp_f16_sdwa v135, v135 dst_sel:WORD_0 dst_unused:UNUSED_PRESERVE src0_sel:WORD_0
v_or_b32 v228, v104, v105
v_mfma_f32_16x16x32_bf16 v[4:7], v[176:179], v[48:51], 0
v_exp_f16_sdwa v131, v131 dst_sel:WORD_1 dst_unused:UNUSED_PRESERVE src0_sel:WORD_1
s_waitcnt lgkmcnt(6)
v_mfma_f32_16x16x32_f16 v[140:143], v[180:183], v[216:219], v[140:143]
v_exp_f16_sdwa v133, v133 dst_sel:WORD_1 dst_unused:UNUSED_PRESERVE src0_sel:WORD_1
v_mfma_f32_16x16x32_bf16 v[12:15], v[176:179], v[52:55], 0
ds_read_b128 v[176:179], v251 offset:39936
v_cvt_pkrtz_f16_f32 v129, v128, v129
v_and_b32_e64 v129, s49, v129
v_bfe_u32 v128, v129, 2, 14
v_lshrrev_b32 v129, 18, v129
ds_read_u16 v128, v128
ds_read_u16_d16_hi v129, v129
v_mfma_f32_16x16x32_f16 v[148:151], v[180:183], v[220:223], v[148:151]
ds_read_b128 v[180:183], v249 offset:30720
buffer_load_dwordx4 v[212:215], v253, s[4:7], s70 offen offset:320
v_exp_f16_sdwa v135, v135 dst_sel:WORD_1 dst_unused:UNUSED_PRESERVE src0_sel:WORD_1
s_setprio 2
v_mfma_f32_16x16x32_bf16 v[4:7], v[184:187], v[56:59], v[4:7]
v_pk_add_f16 v131, v131, 1.0 op_sel_hi:[1,0]
v_mfma_f32_16x16x32_f16 v[72:75], v[188:191], v[192:195], v[72:75]
v_pk_add_f16 v133, v133, 1.0 op_sel_hi:[1,0]
v_pk_add_f16 v135, v135, 1.0 op_sel_hi:[1,0]
v_mfma_f32_16x16x32_bf16 v[12:15], v[184:187], v[60:63], v[12:15]
ds_read_b128 v[184:187], v251 offset:43008
v_rcp_f16_sdwa v131, v131 dst_sel:WORD_0 dst_unused:UNUSED_PRESERVE src0_sel:WORD_0
v_mfma_f32_16x16x32_f16 v[80:83], v[188:191], v[196:199], v[80:83]
ds_read_b128 v[188:191], v249 offset:32768
v_rcp_f16_sdwa v133, v133 dst_sel:WORD_0 dst_unused:UNUSED_PRESERVE src0_sel:WORD_0
s_waitcnt lgkmcnt(6)
v_mfma_f32_16x16x32_f16 v[76:79], v[168:171], v[192:195], v[76:79]
v_rcp_f16_sdwa v135, v135 dst_sel:WORD_0 dst_unused:UNUSED_PRESERVE src0_sel:WORD_0
v_mfma_f32_16x16x32_bf16 v[4:7], v[172:175], v[64:67], v[4:7]
v_rcp_f16_sdwa v131, v131 dst_sel:WORD_1 dst_unused:UNUSED_PRESERVE src0_sel:WORD_1
v_mfma_f32_16x16x32_f16 v[84:87], v[168:171], v[196:199], v[84:87]
ds_read_b128 v[168:171], v251 offset:40960
v_rcp_f16_sdwa v133, v133 dst_sel:WORD_1 dst_unused:UNUSED_PRESERVE src0_sel:WORD_1
v_mfma_f32_16x16x32_bf16 v[12:15], v[172:175], v[68:71], v[12:15]
ds_read_b128 v[172:175], v249 offset:34816
v_rcp_f16_sdwa v135, v135 dst_sel:WORD_1 dst_unused:UNUSED_PRESERVE src0_sel:WORD_1
s_waitcnt lgkmcnt(5)
v_mfma_f32_16x16x32_f16 v[152:155], v[176:179], v[192:195], v[152:155]
v_or_b32 v88, v120, v121
s_waitcnt lgkmcnt(4)
v_mfma_f32_16x16x32_bf16 v[96:99], v[180:183], v[48:51], 0
v_pk_mul_f16 v93, v130, v131
v_mfma_f32_16x16x32_f16 v[160:163], v[176:179], v[196:199], v[160:163]
ds_read_b128 v[176:179], v251 offset:44032
v_pk_mul_f16 v94, v132, v133
v_mfma_f32_16x16x32_bf16 v[104:107], v[180:183], v[52:55], 0
ds_read_b128 v[180:183], v249 offset:30976
v_pk_mul_f16 v95, v134, v135
s_waitcnt lgkmcnt(4)
v_mfma_f32_16x16x32_f16 v[156:159], v[184:187], v[192:195], v[156:159]
v_cvt_pkrtz_f16_f32 v1, v0, v1
v_and_b32 v1, s49, v1
v_bfe_u32 v0, v1, 2, 14
v_lshrrev_b32_e64 v1, 18, v1
ds_read_u16 v0, v0
ds_read_u16_d16_hi v1, v1
v_cvt_pk_f16_f32 v10, v10, v11
v_or_b32 v89, v122, v123
v_mfma_f32_16x16x32_bf16 v[96:99], v[188:191], v[56:59], v[96:99]
s_setprio 1
v_cvt_pk_f16_f32 v12, v12, v13
v_mfma_f32_16x16x32_f16 v[164:167], v[184:187], v[196:199], v[164:167]
ds_read_b128 v[184:187], v251 offset:45056
v_cvt_pk_f16_f32 v14, v14, v15
v_pk_fma_f16 v11, v10, v10, s48
v_mfma_f32_16x16x32_bf16 v[104:107], v[188:191], v[60:63], v[104:107]
ds_read_b128 v[188:191], v249 offset:33024
v_pk_fma_f16 v13, v12, v12, s48
v_cvt_pkrtz_f16_f32 v3, v2, v3
v_and_b32_e64 v3, s49, v3
v_bfe_u32 v2, v3, 2, 14
v_lshrrev_b32_e64 v3, 18, v3
ds_read_u16 v2, v2
ds_read_u16_d16_hi v3, v3
v_or_b32 v90, v124, v125
s_waitcnt lgkmcnt(6)
v_mfma_f32_16x16x32_f16 v[136:139], v[168:171], v[192:195], v[136:139]
v_pk_fma_f16 v15, v14, v14, s48
v_pk_mul_f16 v11, v10, v11
v_pk_mul_f16 v13, v12, v13
v_mfma_f32_16x16x32_bf16 v[96:99], v[172:175], v[64:67], v[96:99]
v_pk_mul_f16 v15, v14, v15
v_mfma_f32_16x16x32_f16 v[144:147], v[168:171], v[196:199], v[144:147]
ds_read_b128 v[168:171], v251 offset:48128
v_cvt_pkrtz_f16_f32 v5, v4, v5
v_and_b32_e64 v5, s49, v5
v_bfe_u32 v4, v5, 2, 14
v_lshrrev_b32 v5, 18, v5
ds_read_u16 v4, v4
ds_read_u16_d16_hi v5, v5
v_or_b32 v91, v126, v127
v_exp_f16_sdwa v11, v11 dst_sel:WORD_0 dst_unused:UNUSED_PRESERVE src0_sel:WORD_0
v_mfma_f32_16x16x32_bf16 v[104:107], v[172:175], v[68:71], v[104:107]
ds_read_b128 v[172:175], v249 offset:35072
v_exp_f16_sdwa v13, v13 dst_sel:WORD_0 dst_unused:UNUSED_PRESERVE src0_sel:WORD_0
v_mfma_f32_16x16x32_f16 v[140:143], v[176:179], v[192:195], v[140:143]
v_cvt_pkrtz_f16_f32 v7, v6, v7
v_and_b32_e64 v7, s49, v7
v_bfe_u32 v6, v7, 2, 14
v_lshrrev_b32_e64 v7, 18, v7
ds_read_u16 v6, v6
ds_read_u16_d16_hi v7, v7
v_exp_f16_sdwa v15, v15 dst_sel:WORD_0 dst_unused:UNUSED_PRESERVE src0_sel:WORD_0
v_or_b32 v92, v128, v129
v_mfma_f32_16x16x32_f16 v[148:151], v[176:179], v[196:199], v[148:151]
ds_read_b128 v[176:179], v251 offset:46080
v_exp_f16_sdwa v11, v11 dst_sel:WORD_1 dst_unused:UNUSED_PRESERVE src0_sel:WORD_1
v_mfma_f32_16x16x32_bf16 v[100:103], v[180:183], v[48:51], 0
v_exp_f16_sdwa v13, v13 dst_sel:WORD_1 dst_unused:UNUSED_PRESERVE src0_sel:WORD_1
s_waitcnt lgkmcnt(6)
v_mfma_f32_16x16x32_f16 v[72:75], v[184:187], v[232:235], v[72:75]
v_cvt_pkrtz_f16_f32 v9, v8, v9
v_mfma_f32_16x16x32_bf16 v[108:111], v[180:183], v[52:55], 0
ds_read_b128 v[180:183], v248
v_and_b32_e64 v9, s49, v9
v_bfe_u32 v8, v9, 2, 14
v_lshrrev_b32_e64 v9, 18, v9
ds_read_u16 v8, v8
ds_read_u16_d16_hi v9, v9
v_exp_f16_sdwa v15, v15 dst_sel:WORD_1 dst_unused:UNUSED_PRESERVE src0_sel:WORD_1
v_mfma_f32_16x16x32_f16 v[80:83], v[184:187], v[236:239], v[80:83]
ds_read_b128 v[184:187], v251 offset:49152
v_pk_add_f16 v11, v11, 1.0 op_sel_hi:[1,0]
v_mfma_f32_16x16x32_bf16 v[100:103], v[188:191], v[56:59], v[100:103]
s_setprio 0
v_pk_add_f16 v13, v13, 1.0 op_sel_hi:[1,0]
v_mfma_f32_16x16x32_f16 v[76:79], v[168:171], v[232:235], v[76:79]
v_pk_add_f16 v15, v15, 1.0 op_sel_hi:[1,0]
v_mfma_f32_16x16x32_bf16 v[108:111], v[188:191], v[60:63], v[108:111]
ds_read_b128 v[188:191], v248 offset:2048
v_rcp_f16_sdwa v11, v11 dst_sel:WORD_0 dst_unused:UNUSED_PRESERVE src0_sel:WORD_0
v_mfma_f32_16x16x32_f16 v[84:87], v[168:171], v[236:239], v[84:87]
ds_read_b128 v[168:171], v251 offset:47104
v_rcp_f16_sdwa v13, v13 dst_sel:WORD_0 dst_unused:UNUSED_PRESERVE src0_sel:WORD_0
s_waitcnt lgkmcnt(7)
v_mfma_f32_16x16x32_bf16 v[100:103], v[172:175], v[64:67], v[100:103]
v_rcp_f16_sdwa v15, v15 dst_sel:WORD_0 dst_unused:UNUSED_PRESERVE src0_sel:WORD_0
s_waitcnt lgkmcnt(6)
v_mfma_f32_16x16x32_f16 v[152:155], v[176:179], v[232:235], v[152:155]
v_rcp_f16_sdwa v11, v11 dst_sel:WORD_1 dst_unused:UNUSED_PRESERVE src0_sel:WORD_1
v_mfma_f32_16x16x32_bf16 v[108:111], v[172:175], v[68:71], v[108:111]
ds_read_b128 v[172:175], v251 offset:50176
v_rcp_f16_sdwa v13, v13 dst_sel:WORD_1 dst_unused:UNUSED_PRESERVE src0_sel:WORD_1
v_mfma_f32_16x16x32_f16 v[160:163], v[176:179], v[236:239], v[160:163]
ds_read_b128 v[176:179], v248 offset:4096
v_rcp_f16_sdwa v15, v15 dst_sel:WORD_1 dst_unused:UNUSED_PRESERVE src0_sel:WORD_1
s_waitcnt lgkmcnt(6)
v_mfma_f32_16x16x32_bf16 v[120:123], v[180:183], v[24:27], 0
v_or_b32 v216, v0, v1
s_waitcnt lgkmcnt(4)
v_mfma_f32_16x16x32_f16 v[156:159], v[184:187], v[232:235], v[156:159]
v_pk_mul_f16 v221, v10, v11
v_mfma_f32_16x16x32_bf16 v[128:131], v[180:183], v[28:31], 0
ds_read_b128 v[180:183], v251 offset:51200
v_pk_mul_f16 v222, v12, v13
v_mfma_f32_16x16x32_f16 v[164:167], v[184:187], v[236:239], v[164:167]
ds_read_b128 v[184:187], v248 offset:256
v_pk_mul_f16 v223, v14, v15
v_cvt_pkrtz_f16_f32 v97, v96, v97
v_and_b32_e64 v97, s49, v97
v_bfe_u32 v96, v97, 2, 14
v_lshrrev_b32 v97, 18, v97
ds_read_u16 v96, v96
ds_read_u16_d16_hi v97, v97
v_cvt_pk_f16_f32 v106, v106, v107
v_or_b32 v217, v2, v3
s_waitcnt lgkmcnt(5)
v_mfma_f32_16x16x32_bf16 v[120:123], v[188:191], v[32:35], v[120:123]
v_cvt_pk_f16_f32 v108, v108, v109
v_mfma_f32_16x16x32_f16 v[136:139], v[168:171], v[232:235], v[136:139]
s_setprio 3
v_cvt_pk_f16_f32 v110, v110, v111
v_pk_fma_f16 v107, v106, v106, s48
v_mfma_f32_16x16x32_f16 v[144:147], v[168:171], v[236:239], v[144:147]
ds_read_b128 v[168:171], v248 offset:2304
v_pk_fma_f16 v109, v108, v108, s48
v_mfma_f32_16x16x32_bf16 v[128:131], v[188:191], v[36:39], v[128:131]
ds_read_b128 v[188:191], v251 offset:54272
v_cvt_pkrtz_f16_f32 v99, v98, v99
v_and_b32_e64 v99, s49, v99
v_bfe_u32 v98, v99, 2, 14
v_lshrrev_b32_e64 v99, 18, v99
ds_read_u16 v98, v98
ds_read_u16_d16_hi v99, v99
v_or_b32 v218, v4, v5
v_pk_fma_f16 v111, v110, v110, s48
v_pk_mul_f16 v107, v106, v107
v_mfma_f32_16x16x32_f16 v[140:143], v[172:175], v[232:235], v[140:143]
v_pk_mul_f16 v109, v108, v109
s_waitcnt lgkmcnt(6)
v_mfma_f32_16x16x32_bf16 v[120:123], v[176:179], v[40:43], v[120:123]
v_pk_mul_f16 v111, v110, v111
v_cvt_pkrtz_f16_f32 v101, v100, v101
v_and_b32_e64 v101, s49, v101
v_bfe_u32 v100, v101, 2, 14
v_lshrrev_b32 v101, 18, v101
ds_read_u16 v100, v100
ds_read_u16_d16_hi v101, v101
v_or_b32 v219, v6, v7
v_exp_f16_sdwa v107, v107 dst_sel:WORD_0 dst_unused:UNUSED_PRESERVE src0_sel:WORD_0
v_mfma_f32_16x16x32_f16 v[148:151], v[172:175], v[236:239], v[148:151]
ds_read_b128 v[172:175], v251 offset:52224
v_exp_f16_sdwa v109, v109 dst_sel:WORD_0 dst_unused:UNUSED_PRESERVE src0_sel:WORD_0
v_mfma_f32_16x16x32_bf16 v[128:131], v[176:179], v[44:47], v[128:131]
ds_read_b128 v[176:179], v248 offset:4352
v_cvt_pkrtz_f16_f32 v103, v102, v103
v_mfma_f32_16x16x32_f16 v[72:75], v[180:183], v[112:115], v[72:75]
v_and_b32_e64 v103, s49, v103
v_bfe_u32 v102, v103, 2, 14
v_lshrrev_b32 v103, 18, v103
ds_read_u16 v102, v102
ds_read_u16_d16_hi v103, v103
v_exp_f16_sdwa v111, v111 dst_sel:WORD_0 dst_unused:UNUSED_PRESERVE src0_sel:WORD_0
v_or_b32 v220, v8, v9
v_mfma_f32_16x16x32_bf16 v[124:127], v[184:187], v[24:27], 0
buffer_load_dwordx4 v[48:51], v250, s[32:35], s80 offen
v_exp_f16_sdwa v107, v107 dst_sel:WORD_1 dst_unused:UNUSED_PRESERVE src0_sel:WORD_1
v_mfma_f32_16x16x32_f16 v[80:83], v[180:183], v[116:119], v[80:83]
ds_read_b128 v[180:183], v251 offset:55296
v_exp_f16_sdwa v109, v109 dst_sel:WORD_1 dst_unused:UNUSED_PRESERVE src0_sel:WORD_1
v_mfma_f32_16x16x32_bf16 v[132:135], v[184:187], v[28:31], 0
ds_read_b128 v[184:187], v248 offset:6144
v_cvt_pkrtz_f16_f32 v105, v104, v105
v_and_b32_e64 v105, s49, v105
v_bfe_u32 v104, v105, 2, 14
v_lshrrev_b32_e64 v105, 18, v105
ds_read_u16 v104, v104
ds_read_u16_d16_hi v105, v105
s_waitcnt lgkmcnt(8)
v_mfma_f32_16x16x32_f16 v[76:79], v[188:191], v[112:115], v[76:79]
v_exp_f16_sdwa v111, v111 dst_sel:WORD_1 dst_unused:UNUSED_PRESERVE src0_sel:WORD_1
v_mfma_f32_16x16x32_bf16 v[124:127], v[168:171], v[32:35], v[124:127]
v_pk_add_f16 v107, v107, 1.0 op_sel_hi:[1,0]
v_mfma_f32_16x16x32_f16 v[84:87], v[188:191], v[116:119], v[84:87]
ds_read_b128 v[188:191], v251 offset:53248
s_setprio 2
v_pk_add_f16 v109, v109, 1.0 op_sel_hi:[1,0]
v_pk_add_f16 v111, v111, 1.0 op_sel_hi:[1,0]
v_mfma_f32_16x16x32_bf16 v[132:135], v[168:171], v[36:39], v[132:135]
ds_read_b128 v[168:171], v248 offset:8192
v_rcp_f16_sdwa v107, v107 dst_sel:WORD_0 dst_unused:UNUSED_PRESERVE src0_sel:WORD_0
s_waitcnt lgkmcnt(7)
v_mfma_f32_16x16x32_f16 v[152:155], v[172:175], v[112:115], v[152:155]
v_rcp_f16_sdwa v109, v109 dst_sel:WORD_0 dst_unused:UNUSED_PRESERVE src0_sel:WORD_0
v_mfma_f32_16x16x32_bf16 v[124:127], v[176:179], v[40:43], v[124:127]
v_rcp_f16_sdwa v111, v111 dst_sel:WORD_0 dst_unused:UNUSED_PRESERVE src0_sel:WORD_0
v_mfma_f32_16x16x32_f16 v[160:163], v[172:175], v[116:119], v[160:163]
ds_read_b128 v[172:175], v251 offset:56320
v_rcp_f16_sdwa v107, v107 dst_sel:WORD_1 dst_unused:UNUSED_PRESERVE src0_sel:WORD_1
v_mfma_f32_16x16x32_bf16 v[132:135], v[176:179], v[44:47], v[132:135]
ds_read_b128 v[176:179], v248 offset:10240
v_rcp_f16_sdwa v109, v109 dst_sel:WORD_1 dst_unused:UNUSED_PRESERVE src0_sel:WORD_1
s_waitcnt lgkmcnt(5)
v_mfma_f32_16x16x32_f16 v[156:159], v[180:183], v[112:115], v[156:159]
v_rcp_f16_sdwa v111, v111 dst_sel:WORD_1 dst_unused:UNUSED_PRESERVE src0_sel:WORD_1
v_mfma_f32_16x16x32_f16 v[164:167], v[180:183], v[116:119], v[164:167]
ds_read_b128 v[180:183], v251 offset:57344
v_or_b32 v192, v96, v97
v_mfma_f32_16x16x32_bf16 v[0:3], v[184:187], v[24:27], 0
v_pk_mul_f16 v197, v106, v107
s_waitcnt lgkmcnt(4)
v_mfma_f32_16x16x32_f16 v[136:139], v[188:191], v[112:115], v[136:139]
v_pk_mul_f16 v198, v108, v109
v_mfma_f32_16x16x32_bf16 v[8:11], v[184:187], v[28:31], 0
ds_read_b128 v[184:187], v248 offset:6400
v_pk_mul_f16 v199, v110, v111
v_mfma_f32_16x16x32_f16 v[144:147], v[188:191], v[116:119], v[144:147]
ds_read_b128 v[188:191], v251 offset:60416
v_cvt_pkrtz_f16_f32 v121, v120, v121
v_and_b32_e64 v121, s49, v121
v_bfe_u32 v120, v121, 2, 14
v_lshrrev_b32_e64 v121, 18, v121
ds_read_u16 v120, v120
ds_read_u16_d16_hi v121, v121
v_cvt_pk_f16_f32 v130, v130, v131
v_or_b32 v193, v98, v99
s_waitcnt lgkmcnt(5)
v_mfma_f32_16x16x32_bf16 v[0:3], v[168:171], v[32:35], v[0:3]
v_cvt_pk_f16_f32 v132, v132, v133
s_add_u32 s46, s80, 2097152
buffer_load_dwordx4 v[52:55], v250, s[32:35], s46 offen
v_cvt_pk_f16_f32 v134, v134, v135
s_setprio 1
v_mfma_f32_16x16x32_f16 v[140:143], v[172:175], v[112:115], v[140:143]
v_pk_fma_f16 v131, v130, v130, s48
v_mfma_f32_16x16x32_bf16 v[8:11], v[168:171], v[36:39], v[8:11]
ds_read_b128 v[168:171], v248 offset:8448
v_pk_fma_f16 v133, v132, v132, s48
v_cvt_pkrtz_f16_f32 v123, v122, v123
v_and_b32 v123, s49, v123
v_bfe_u32 v122, v123, 2, 14
v_lshrrev_b32 v123, 18, v123
ds_read_u16 v122, v122
ds_read_u16_d16_hi v123, v123
v_or_b32 v194, v100, v101
v_pk_fma_f16 v135, v134, v134, s48
v_mfma_f32_16x16x32_f16 v[148:151], v[172:175], v[116:119], v[148:151]
ds_read_b128 v[172:175], v251 offset:58368
v_pk_mul_f16 v131, v130, v131
v_pk_mul_f16 v133, v132, v133
v_mfma_f32_16x16x32_bf16 v[0:3], v[176:179], v[40:43], v[0:3]
v_pk_mul_f16 v135, v134, v135
s_waitcnt lgkmcnt(5)
v_mfma_f32_16x16x32_f16 v[72:75], v[180:183], v[224:227], v[72:75]
v_cvt_pkrtz_f16_f32 v125, v124, v125
v_and_b32 v125, s49, v125
v_bfe_u32 v124, v125, 2, 14
v_lshrrev_b32 v125, 18, v125
ds_read_u16 v124, v124
ds_read_u16_d16_hi v125, v125
v_or_b32 v195, v102, v103
v_exp_f16_sdwa v131, v131 dst_sel:WORD_0 dst_unused:UNUSED_PRESERVE src0_sel:WORD_0
v_mfma_f32_16x16x32_bf16 v[8:11], v[176:179], v[44:47], v[8:11]
ds_read_b128 v[176:179], v251 offset:61440
v_exp_f16_sdwa v133, v133 dst_sel:WORD_0 dst_unused:UNUSED_PRESERVE src0_sel:WORD_0
v_mfma_f32_16x16x32_f16 v[80:83], v[180:183], v[228:231], v[80:83]
ds_read_b128 v[180:183], v248 offset:10496
v_cvt_pkrtz_f16_f32 v127, v126, v127
v_and_b32_e64 v127, s49, v127
v_bfe_u32 v126, v127, 2, 14
v_lshrrev_b32 v127, 18, v127
ds_read_u16 v126, v126
ds_read_u16_d16_hi v127, v127
v_exp_f16_sdwa v135, v135 dst_sel:WORD_0 dst_unused:UNUSED_PRESERVE src0_sel:WORD_0
v_or_b32 v196, v104, v105
v_mfma_f32_16x16x32_bf16 v[4:7], v[184:187], v[24:27], 0
v_exp_f16_sdwa v131, v131 dst_sel:WORD_1 dst_unused:UNUSED_PRESERVE src0_sel:WORD_1
v_mfma_f32_16x16x32_f16 v[76:79], v[188:191], v[224:227], v[76:79]
v_exp_f16_sdwa v133, v133 dst_sel:WORD_1 dst_unused:UNUSED_PRESERVE src0_sel:WORD_1
v_mfma_f32_16x16x32_bf16 v[12:15], v[184:187], v[28:31], 0
ds_read_b128 v[184:187], v251 offset:59392
v_cvt_pkrtz_f16_f32 v129, v128, v129
v_and_b32_e64 v129, s49, v129
v_bfe_u32 v128, v129, 2, 14
v_lshrrev_b32_e64 v129, 18, v129
ds_read_u16 v128, v128
ds_read_u16_d16_hi v129, v129
v_mfma_f32_16x16x32_f16 v[84:87], v[188:191], v[228:231], v[84:87]
ds_read_b128 v[188:191], v248 offset:12288
v_exp_f16_sdwa v135, v135 dst_sel:WORD_1 dst_unused:UNUSED_PRESERVE src0_sel:WORD_1
s_waitcnt lgkmcnt(7)
v_mfma_f32_16x16x32_bf16 v[4:7], v[168:171], v[32:35], v[4:7]
v_pk_add_f16 v131, v131, 1.0 op_sel_hi:[1,0]
v_mfma_f32_16x16x32_f16 v[152:155], v[172:175], v[224:227], v[152:155]
s_setprio 0
v_pk_add_f16 v133, v133, 1.0 op_sel_hi:[1,0]
v_pk_add_f16 v135, v135, 1.0 op_sel_hi:[1,0]
v_mfma_f32_16x16x32_f16 v[160:163], v[172:175], v[228:231], v[160:163]
ds_read_b128 v[172:175], v248 offset:14336
v_mov_b32_e64 v16, 0
v_mfma_f32_16x16x32_bf16 v[12:15], v[168:171], v[36:39], v[12:15]
ds_read_b128 v[168:171], v251 offset:62464
v_mov_b32_e64 v17, 0
v_cndmask_b32 v18, 0, v255, s[88:89]
v_cndmask_b32 v19, 0, v255, s[90:91]
v_mov_b32_e64 v20, 0
v_mov_b32 v21, 0
v_rcp_f16_sdwa v131, v131 dst_sel:WORD_0 dst_unused:UNUSED_PRESERVE src0_sel:WORD_0
v_rcp_f16_sdwa v133, v133 dst_sel:WORD_0 dst_unused:UNUSED_PRESERVE src0_sel:WORD_0
v_mfma_f32_16x16x32_f16 v[156:159], v[176:179], v[224:227], v[156:159]
v_rcp_f16_sdwa v135, v135 dst_sel:WORD_0 dst_unused:UNUSED_PRESERVE src0_sel:WORD_0
s_waitcnt lgkmcnt(5)
v_mfma_f32_16x16x32_bf16 v[4:7], v[180:183], v[40:43], v[4:7]
v_rcp_f16_sdwa v131, v131 dst_sel:WORD_1 dst_unused:UNUSED_PRESERVE src0_sel:WORD_1
v_mfma_f32_16x16x32_f16 v[164:167], v[176:179], v[228:231], v[164:167]
ds_read_b128 v[176:179], v251 offset:63488
s_add_u32 s46, s80, 4194304
buffer_load_dwordx4 v[56:59], v250, s[32:35], s46 offen
v_mfma_f32_16x16x32_bf16 v[12:15], v[180:183], v[44:47], v[12:15]
ds_read_b128 v[180:183], v248 offset:16384
v_rcp_f16_sdwa v133, v133 dst_sel:WORD_1 dst_unused:UNUSED_PRESERVE src0_sel:WORD_1
v_mfma_f32_16x16x32_f16 v[136:139], v[184:187], v[224:227], v[136:139]
v_rcp_f16_sdwa v135, v135 dst_sel:WORD_1 dst_unused:UNUSED_PRESERVE src0_sel:WORD_1
s_waitcnt lgkmcnt(3)
v_mfma_f32_16x16x32_bf16 v[96:99], v[188:191], v[24:27], 0
v_or_b32 v232, v120, v121
v_mfma_f32_16x16x32_f16 v[144:147], v[184:187], v[228:231], v[144:147]
ds_read_b128 v[184:187], v252 offset:1024
v_pk_mul_f16 v237, v130, v131
v_mfma_f32_16x16x32_bf16 v[104:107], v[188:191], v[28:31], 0
ds_read_b128 v[188:191], v248 offset:12544
v_pk_mul_f16 v238, v132, v133
s_waitcnt lgkmcnt(4)
v_mfma_f32_16x16x32_f16 v[140:143], v[168:171], v[224:227], v[140:143]
v_pk_mul_f16 v239, v134, v135
v_cvt_pkrtz_f16_f32 v1, v0, v1
v_and_b32 v1, s49, v1
v_bfe_u32 v0, v1, 2, 14
v_lshrrev_b32 v1, 18, v1
ds_read_u16 v0, v0
ds_read_u16_d16_hi v1, v1
v_cvt_pk_f16_f32 v10, v10, v11
v_or_b32 v233, v122, v123
v_mfma_f32_16x16x32_bf16 v[96:99], v[172:175], v[32:35], v[96:99]
v_cvt_pk_f16_f32 v12, v12, v13
v_mfma_f32_16x16x32_f16 v[148:151], v[168:171], v[228:231], v[148:151]
ds_read_b128 v[168:171], v251 offset:64512
v_cvt_pk_f16_f32 v14, v14, v15
s_setprio 3
v_pk_fma_f16 v11, v10, v10, s48
v_mfma_f32_16x16x32_bf16 v[104:107], v[172:175], v[36:39], v[104:107]
ds_read_b128 v[172:175], v248 offset:14592
v_pk_fma_f16 v13, v12, v12, s48
s_waitcnt vmcnt(11)
v_mfma_f32_16x16x32_bf16 v[72:75], v[18:21], v[240:243], v[72:75]
v_cvt_pkrtz_f16_f32 v3, v2, v3
v_mfma_f32_16x16x32_bf16 v[76:79], v[16:19], v[240:243], v[76:79]
v_and_b32 v3, s49, v3
s_waitcnt vmcnt(9)
v_mfma_f32_16x16x32_bf16 v[80:83], v[18:21], v[244:247], v[80:83]
v_bfe_u32 v2, v3, 2, 14
v_mfma_f32_16x16x32_bf16 v[84:87], v[16:19], v[244:247], v[84:87]
v_lshrrev_b32_e64 v3, 18, v3
ds_read_u16 v2, v2
ds_read_u16_d16_hi v3, v3
s_waitcnt lgkmcnt(6)
v_mfma_f32_16x16x32_f16 v[72:75], v[176:179], v[88:91], v[72:75]
v_or_b32 v234, v124, v125
v_pk_fma_f16 v15, v14, v14, s48
v_pk_mul_f16 v11, v10, v11
v_pk_mul_f16 v13, v12, v13
v_mfma_f32_16x16x32_bf16 v[96:99], v[180:183], v[40:43], v[96:99]
v_pk_mul_f16 v15, v14, v15
v_mfma_f32_16x16x32_f16 v[80:83], v[176:179], v[92:95], v[80:83]
ds_read_b128 v[176:179], v252 offset:2048
v_cvt_pkrtz_f16_f32 v5, v4, v5
v_and_b32_e64 v5, s49, v5
v_bfe_u32 v4, v5, 2, 14
v_lshrrev_b32 v5, 18, v5
ds_read_u16 v4, v4
ds_read_u16_d16_hi v5, v5
v_or_b32 v235, v126, v127
v_exp_f16_sdwa v11, v11 dst_sel:WORD_0 dst_unused:UNUSED_PRESERVE src0_sel:WORD_0
v_mfma_f32_16x16x32_f16 v[76:79], v[184:187], v[88:91], v[76:79]
v_exp_f16_sdwa v13, v13 dst_sel:WORD_0 dst_unused:UNUSED_PRESERVE src0_sel:WORD_0
v_mfma_f32_16x16x32_bf16 v[104:107], v[180:183], v[44:47], v[104:107]
ds_read_b128 v[180:183], v248 offset:16640
v_cvt_pkrtz_f16_f32 v7, v6, v7
v_and_b32_e64 v7, s49, v7
v_bfe_u32 v6, v7, 2, 14
v_lshrrev_b32_e64 v7, 18, v7
ds_read_u16 v6, v6
ds_read_u16_d16_hi v7, v7
v_exp_f16_sdwa v15, v15 dst_sel:WORD_0 dst_unused:UNUSED_PRESERVE src0_sel:WORD_0
v_or_b32 v236, v128, v129
v_mfma_f32_16x16x32_f16 v[84:87], v[184:187], v[92:95], v[84:87]
ds_read_b128 v[184:187], v252
v_exp_f16_sdwa v11, v11 dst_sel:WORD_1 dst_unused:UNUSED_PRESERVE src0_sel:WORD_1
v_mfma_f32_16x16x32_bf16 v[100:103], v[188:191], v[24:27], 0
v_exp_f16_sdwa v13, v13 dst_sel:WORD_1 dst_unused:UNUSED_PRESERVE src0_sel:WORD_1
s_waitcnt lgkmcnt(6)
v_mfma_f32_16x16x32_f16 v[152:155], v[168:171], v[88:91], v[152:155]
v_cvt_pkrtz_f16_f32 v9, v8, v9
v_mfma_f32_16x16x32_bf16 v[108:111], v[188:191], v[28:31], 0
ds_read_b128 v[188:191], v248 offset:18432
v_and_b32_e64 v9, s49, v9
v_bfe_u32 v8, v9, 2, 14
v_lshrrev_b32_e64 v9, 18, v9
ds_read_u16 v8, v8
ds_read_u16_d16_hi v9, v9
s_add_u32 s46, s80, 6291456
buffer_load_dwordx4 v[60:63], v250, s[32:35], s46 offen
v_exp_f16_sdwa v15, v15 dst_sel:WORD_1 dst_unused:UNUSED_PRESERVE src0_sel:WORD_1
v_mfma_f32_16x16x32_f16 v[160:163], v[168:171], v[92:95], v[160:163]
ds_read_b128 v[168:171], v252 offset:3072
v_pk_add_f16 v11, v11, 1.0 op_sel_hi:[1,0]
v_mfma_f32_16x16x32_bf16 v[100:103], v[172:175], v[32:35], v[100:103]
v_pk_add_f16 v13, v13, 1.0 op_sel_hi:[1,0]
v_mfma_f32_16x16x32_f16 v[156:159], v[176:179], v[88:91], v[156:159]
s_setprio 2
v_pk_add_f16 v15, v15, 1.0 op_sel_hi:[1,0]
v_mfma_f32_16x16x32_bf16 v[108:111], v[172:175], v[36:39], v[108:111]
ds_read_b128 v[172:175], v252 offset:4096
v_rcp_f16_sdwa v11, v11 dst_sel:WORD_0 dst_unused:UNUSED_PRESERVE src0_sel:WORD_0
v_mfma_f32_16x16x32_f16 v[164:167], v[176:179], v[92:95], v[164:167]
ds_read_b128 v[176:179], v248 offset:20480
v_rcp_f16_sdwa v13, v13 dst_sel:WORD_0 dst_unused:UNUSED_PRESERVE src0_sel:WORD_0
s_waitcnt lgkmcnt(6)
v_mfma_f32_16x16x32_bf16 v[100:103], v[180:183], v[40:43], v[100:103]
v_rcp_f16_sdwa v15, v15 dst_sel:WORD_0 dst_unused:UNUSED_PRESERVE src0_sel:WORD_0
v_mfma_f32_16x16x32_f16 v[136:139], v[184:187], v[88:91], v[136:139]
v_rcp_f16_sdwa v11, v11 dst_sel:WORD_1 dst_unused:UNUSED_PRESERVE src0_sel:WORD_1
v_mfma_f32_16x16x32_bf16 v[108:111], v[180:183], v[44:47], v[108:111]
ds_read_b128 v[180:183], v252 offset:7168
v_rcp_f16_sdwa v13, v13 dst_sel:WORD_1 dst_unused:UNUSED_PRESERVE src0_sel:WORD_1
v_mfma_f32_16x16x32_f16 v[144:147], v[184:187], v[92:95], v[144:147]
ds_read_b128 v[184:187], v248 offset:22528
s_getpc_b64 s[74:75]
Lcq12:
s_lshl_b32 s43, s40, 10
s_add_u32 s43, s43, 6144
s_min_u32 s43, s43, Lend-Lcq12-1024
s_add_u32 s74, s74, s43
s_addc_u32 s75, s75, 0
s_sub_u32 s74, s74, 16384
s_subb_u32 s75, s75, 0
s_mov_b32 m0, 163840
s_nop 0
global_load_lds_dword v250, s[74:75]
s_waitcnt lgkmcnt(5)
v_mfma_f32_16x16x32_bf16 v[120:123], v[188:191], v[24:27], 0
v_rcp_f16_sdwa v15, v15 dst_sel:WORD_1 dst_unused:UNUSED_PRESERVE src0_sel:WORD_1
s_waitcnt lgkmcnt(4)
v_mfma_f32_16x16x32_f16 v[140:143], v[168:171], v[88:91], v[140:143]
v_or_b32 v112, v0, v1
v_pk_mul_f16 v117, v10, v11
v_mfma_f32_16x16x32_bf16 v[128:131], v[188:191], v[28:31], 0
ds_read_b128 v[188:191], v252 offset:5120
v_pk_mul_f16 v118, v12, v13
v_mfma_f32_16x16x32_f16 v[148:151], v[168:171], v[92:95], v[148:151]
ds_read_b128 v[168:171], v248 offset:18688
v_pk_mul_f16 v119, v14, v15
s_waitcnt vmcnt(10)
v_mfma_f32_16x16x32_bf16 v[152:155], v[18:21], v[200:203], v[152:155]
v_cvt_pkrtz_f16_f32 v97, v96, v97
v_mfma_f32_16x16x32_bf16 v[156:159], v[16:19], v[200:203], v[156:159]
v_and_b32 v97, s49, v97
s_waitcnt vmcnt(8)
v_mfma_f32_16x16x32_bf16 v[160:163], v[18:21], v[204:207], v[160:163]
v_bfe_u32 v96, v97, 2, 14
v_mfma_f32_16x16x32_bf16 v[164:167], v[16:19], v[204:207], v[164:167]
v_lshrrev_b32_e64 v97, 18, v97
ds_read_u16 v96, v96
ds_read_u16_d16_hi v97, v97
v_cvt_pk_f16_f32 v106, v106, v107
v_or_b32 v113, v2, v3
s_waitcnt lgkmcnt(4)
v_mfma_f32_16x16x32_f16 v[72:75], v[172:175], v[216:219], v[72:75]
v_cvt_pk_f16_f32 v108, v108, v109
v_mfma_f32_16x16x32_bf16 v[120:123], v[176:179], v[32:35], v[120:123]
v_cvt_pk_f16_f32 v110, v110, v111
v_pk_fma_f16 v107, v106, v106, s48
s_setprio 1
v_mfma_f32_16x16x32_f16 v[80:83], v[172:175], v[220:223], v[80:83]
ds_read_b128 v[172:175], v252 offset:8192
v_pk_fma_f16 v109, v108, v108, s48
v_mfma_f32_16x16x32_bf16 v[128:131], v[176:179], v[36:39], v[128:131]
ds_read_b128 v[176:179], v248 offset:20736
v_cvt_pkrtz_f16_f32 v99, v98, v99
v_and_b32 v99, s49, v99
v_bfe_u32 v98, v99, 2, 14
v_lshrrev_b32 v99, 18, v99
ds_read_u16 v98, v98
ds_read_u16_d16_hi v99, v99
v_or_b32 v114, v4, v5
v_pk_fma_f16 v111, v110, v110, s48
s_add_u32 s46, s80, 8388608
buffer_load_dwordx4 v[64:67], v250, s[32:35], s46 offen
v_pk_mul_f16 v107, v106, v107
v_mfma_f32_16x16x32_f16 v[76:79], v[180:183], v[216:219], v[76:79]
v_pk_mul_f16 v109, v108, v109
v_mfma_f32_16x16x32_bf16 v[120:123], v[184:187], v[40:43], v[120:123]
v_pk_mul_f16 v111, v110, v111
v_cvt_pkrtz_f16_f32 v101, v100, v101
v_and_b32_e64 v101, s49, v101
v_bfe_u32 v100, v101, 2, 14
v_lshrrev_b32 v101, 18, v101
ds_read_u16 v100, v100
ds_read_u16_d16_hi v101, v101
v_or_b32 v115, v6, v7
v_exp_f16_sdwa v107, v107 dst_sel:WORD_0 dst_unused:UNUSED_PRESERVE src0_sel:WORD_0
v_mfma_f32_16x16x32_f16 v[84:87], v[180:183], v[220:223], v[84:87]
ds_read_b128 v[180:183], v252 offset:6144
v_exp_f16_sdwa v109, v109 dst_sel:WORD_0 dst_unused:UNUSED_PRESERVE src0_sel:WORD_0
v_mfma_f32_16x16x32_bf16 v[128:131], v[184:187], v[44:47], v[128:131]
ds_read_b128 v[184:187], v248 offset:22784
v_cvt_pkrtz_f16_f32 v103, v102, v103
s_waitcnt lgkmcnt(6)
v_mfma_f32_16x16x32_f16 v[152:155], v[188:191], v[216:219], v[152:155]
v_and_b32 v103, s49, v103
v_bfe_u32 v102, v103, 2, 14
v_lshrrev_b32 v103, 18, v103
ds_read_u16 v102, v102
ds_read_u16_d16_hi v103, v103
v_exp_f16_sdwa v111, v111 dst_sel:WORD_0 dst_unused:UNUSED_PRESERVE src0_sel:WORD_0
v_or_b32 v116, v8, v9
v_mfma_f32_16x16x32_bf16 v[124:127], v[168:171], v[24:27], 0
v_exp_f16_sdwa v107, v107 dst_sel:WORD_1 dst_unused:UNUSED_PRESERVE src0_sel:WORD_1
v_mfma_f32_16x16x32_f16 v[160:163], v[188:191], v[220:223], v[160:163]
ds_read_b128 v[188:191], v252 offset:9216
v_exp_f16_sdwa v109, v109 dst_sel:WORD_1 dst_unused:UNUSED_PRESERVE src0_sel:WORD_1
v_mfma_f32_16x16x32_bf16 v[132:135], v[168:171], v[28:31], 0
ds_read_b128 v[168:171], v248 offset:24576
v_cvt_pkrtz_f16_f32 v105, v104, v105
v_and_b32_e64 v105, s49, v105
v_bfe_u32 v104, v105, 2, 14
v_lshrrev_b32_e64 v105, 18, v105
ds_read_u16 v104, v104
ds_read_u16_d16_hi v105, v105
v_mfma_f32_16x16x32_f16 v[156:159], v[172:175], v[216:219], v[156:159]
v_exp_f16_sdwa v111, v111 dst_sel:WORD_1 dst_unused:UNUSED_PRESERVE src0_sel:WORD_1
v_mfma_f32_16x16x32_bf16 v[124:127], v[176:179], v[32:35], v[124:127]
v_pk_add_f16 v107, v107, 1.0 op_sel_hi:[1,0]
v_mfma_f32_16x16x32_f16 v[164:167], v[172:175], v[220:223], v[164:167]
ds_read_b128 v[172:175], v252 offset:10240
v_pk_add_f16 v109, v109, 1.0 op_sel_hi:[1,0]
v_pk_add_f16 v111, v111, 1.0 op_sel_hi:[1,0]
s_setprio 0
v_mfma_f32_16x16x32_bf16 v[132:135], v[176:179], v[36:39], v[132:135]
ds_read_b128 v[176:179], v248 offset:26624
v_rcp_f16_sdwa v107, v107 dst_sel:WORD_0 dst_unused:UNUSED_PRESERVE src0_sel:WORD_0
s_waitcnt lgkmcnt(7)
v_mfma_f32_16x16x32_f16 v[136:139], v[180:183], v[216:219], v[136:139]
v_rcp_f16_sdwa v109, v109 dst_sel:WORD_0 dst_unused:UNUSED_PRESERVE src0_sel:WORD_0
v_mfma_f32_16x16x32_bf16 v[124:127], v[184:187], v[40:43], v[124:127]
v_rcp_f16_sdwa v111, v111 dst_sel:WORD_0 dst_unused:UNUSED_PRESERVE src0_sel:WORD_0
v_mfma_f32_16x16x32_f16 v[144:147], v[180:183], v[220:223], v[144:147]
ds_read_b128 v[180:183], v252 offset:13312
v_rcp_f16_sdwa v107, v107 dst_sel:WORD_1 dst_unused:UNUSED_PRESERVE src0_sel:WORD_1
s_waitcnt lgkmcnt(5)
v_mfma_f32_16x16x32_f16 v[140:143], v[188:191], v[216:219], v[140:143]
v_rcp_f16_sdwa v109, v109 dst_sel:WORD_1 dst_unused:UNUSED_PRESERVE src0_sel:WORD_1
v_mfma_f32_16x16x32_bf16 v[132:135], v[184:187], v[44:47], v[132:135]
ds_read_b128 v[184:187], v248 offset:28672
v_rcp_f16_sdwa v111, v111 dst_sel:WORD_1 dst_unused:UNUSED_PRESERVE src0_sel:WORD_1
v_mfma_f32_16x16x32_f16 v[148:151], v[188:191], v[220:223], v[148:151]
ds_read_b128 v[188:191], v252 offset:11264
s_add_u32 s46, s80, 10485760
buffer_load_dwordx4 v[68:71], v250, s[32:35], s46 offen
v_mfma_f32_16x16x32_bf16 v[0:3], v[168:171], v[24:27], 0
v_or_b32 v224, v96, v97
s_waitcnt vmcnt(9)
v_mfma_f32_16x16x32_bf16 v[136:139], v[18:21], v[208:211], v[136:139]
v_pk_mul_f16 v229, v106, v107
v_mfma_f32_16x16x32_bf16 v[140:143], v[16:19], v[208:211], v[140:143]
v_pk_mul_f16 v230, v108, v109
s_waitcnt vmcnt(7)
v_mfma_f32_16x16x32_bf16 v[144:147], v[18:21], v[212:215], v[144:147]
v_pk_mul_f16 v231, v110, v111
v_mfma_f32_16x16x32_bf16 v[148:151], v[16:19], v[212:215], v[148:151]
v_cvt_pkrtz_f16_f32 v121, v120, v121
s_waitcnt lgkmcnt(2)
v_mfma_f32_16x16x32_f16 v[72:75], v[172:175], v[192:195], v[72:75]
v_and_b32 v121, s49, v121
v_mfma_f32_16x16x32_bf16 v[8:11], v[168:171], v[28:31], 0
ds_read_b128 v[168:171], v248 offset:24832
v_bfe_u32 v120, v121, 2, 14
v_mfma_f32_16x16x32_f16 v[80:83], v[172:175], v[196:199], v[80:83]
ds_read_b128 v[172:175], v252 offset:14336
v_lshrrev_b32 v121, 18, v121
ds_read_u16 v120, v120
ds_read_u16_d16_hi v121, v121
v_cvt_pk_f16_f32 v130, v130, v131
v_or_b32 v225, v98, v99
v_mfma_f32_16x16x32_bf16 v[0:3], v[176:179], v[32:35], v[0:3]
v_cvt_pk_f16_f32 v132, v132, v133
v_cvt_pk_f16_f32 v134, v134, v135
v_mfma_f32_16x16x32_f16 v[76:79], v[180:183], v[192:195], v[76:79]
v_pk_fma_f16 v131, v130, v130, s48
v_mfma_f32_16x16x32_bf16 v[8:11], v[176:179], v[36:39], v[8:11]
ds_read_b128 v[176:179], v252 offset:12288
v_pk_fma_f16 v133, v132, v132, s48
s_setprio 3
v_cvt_pkrtz_f16_f32 v123, v122, v123
v_and_b32 v123, s49, v123
v_bfe_u32 v122, v123, 2, 14
v_lshrrev_b32_e64 v123, 18, v123
ds_read_u16 v122, v122
ds_read_u16_d16_hi v123, v123
v_or_b32 v226, v100, v101
v_pk_fma_f16 v135, v134, v134, s48
v_mfma_f32_16x16x32_f16 v[84:87], v[180:183], v[196:199], v[84:87]
ds_read_b128 v[180:183], v248 offset:26880
v_pk_mul_f16 v131, v130, v131
v_pk_mul_f16 v133, v132, v133
s_waitcnt lgkmcnt(6)
v_mfma_f32_16x16x32_bf16 v[0:3], v[184:187], v[40:43], v[0:3]
v_pk_mul_f16 v135, v134, v135
v_mfma_f32_16x16x32_f16 v[152:155], v[188:191], v[192:195], v[152:155]
v_cvt_pkrtz_f16_f32 v125, v124, v125
v_and_b32_e64 v125, s49, v125
v_bfe_u32 v124, v125, 2, 14
v_lshrrev_b32 v125, 18, v125
ds_read_u16 v124, v124
ds_read_u16_d16_hi v125, v125
v_or_b32 v227, v102, v103
v_exp_f16_sdwa v131, v131 dst_sel:WORD_0 dst_unused:UNUSED_PRESERVE src0_sel:WORD_0
v_mfma_f32_16x16x32_bf16 v[8:11], v[184:187], v[44:47], v[8:11]
ds_read_b128 v[184:187], v252 offset:15360
v_exp_f16_sdwa v133, v133 dst_sel:WORD_0 dst_unused:UNUSED_PRESERVE src0_sel:WORD_0
v_mfma_f32_16x16x32_f16 v[160:163], v[188:191], v[196:199], v[160:163]
ds_read_b128 v[188:191], v248 offset:28928
v_cvt_pkrtz_f16_f32 v127, v126, v127
v_and_b32_e64 v127, s49, v127
v_bfe_u32 v126, v127, 2, 14
v_lshrrev_b32 v127, 18, v127
ds_read_u16 v126, v126
ds_read_u16_d16_hi v127, v127
v_exp_f16_sdwa v135, v135 dst_sel:WORD_0 dst_unused:UNUSED_PRESERVE src0_sel:WORD_0
v_or_b32 v228, v104, v105
v_mfma_f32_16x16x32_bf16 v[4:7], v[168:171], v[24:27], 0
v_exp_f16_sdwa v131, v131 dst_sel:WORD_1 dst_unused:UNUSED_PRESERVE src0_sel:WORD_1
v_mfma_f32_16x16x32_f16 v[156:159], v[172:175], v[192:195], v[156:159]
v_exp_f16_sdwa v133, v133 dst_sel:WORD_1 dst_unused:UNUSED_PRESERVE src0_sel:WORD_1
v_mfma_f32_16x16x32_bf16 v[12:15], v[168:171], v[28:31], 0
ds_read_b128 v[168:171], v251 offset:8192
v_cvt_pkrtz_f16_f32 v129, v128, v129
v_mfma_f32_16x16x32_f16 v[164:167], v[172:175], v[196:199], v[164:167]
ds_read_b128 v[172:175], v248 offset:30720
v_and_b32_e64 v129, s49, v129
v_bfe_u32 v128, v129, 2, 14
v_lshrrev_b32 v129, 18, v129
ds_read_u16 v128, v128
ds_read_u16_d16_hi v129, v129
v_exp_f16_sdwa v135, v135 dst_sel:WORD_1 dst_unused:UNUSED_PRESERVE src0_sel:WORD_1
v_cvt_pk_bf16_f32 v240, v72, v73
v_cvt_pk_bf16_f32 v241, v74, v75
v_cvt_pk_bf16_f32 v242, v76, v77
v_cvt_pk_bf16_f32 v243, v78, v79
v_cvt_pk_bf16_f32 v244, v80, v81
v_cvt_pk_bf16_f32 v245, v82, v83
v_cvt_pk_bf16_f32 v246, v84, v85
v_cvt_pk_bf16_f32 v247, v86, v87
ds_read_b128 v[72:75], v254 offset:8192
ds_read_b128 v[76:79], v254 offset:8208
ds_read_b128 v[80:83], v254 offset:8192
ds_read_b128 v[84:87], v254 offset:8208
s_waitcnt lgkmcnt(10)
v_mfma_f32_16x16x32_f16 v[136:139], v[176:179], v[192:195], v[136:139]
v_pk_add_f16 v131, v131, 1.0 op_sel_hi:[1,0]
v_mfma_f32_16x16x32_bf16 v[4:7], v[180:183], v[32:35], v[4:7]
v_cvt_pk_bf16_f32 v88, v152, v153
v_cvt_pk_bf16_f32 v89, v154, v155
v_cvt_pk_bf16_f32 v90, v156, v157
v_cvt_pk_bf16_f32 v91, v158, v159
v_cvt_pk_bf16_f32 v92, v160, v161
v_cvt_pk_bf16_f32 v93, v162, v163
v_cvt_pk_bf16_f32 v94, v164, v165
v_cvt_pk_bf16_f32 v95, v166, v167
ds_read_b128 v[152:155], v254 offset:8320
ds_read_b128 v[156:159], v254 offset:8336
ds_read_b128 v[160:163], v254 offset:8320
ds_read_b128 v[164:167], v254 offset:8336
v_pk_add_f16 v133, v133, 1.0 op_sel_hi:[1,0]
v_mfma_f32_16x16x32_f16 v[144:147], v[176:179], v[196:199], v[144:147]
ds_read_b128 v[176:179], v251 offset:11264
v_pk_add_f16 v135, v135, 1.0 op_sel_hi:[1,0]
v_cvt_pk_bf16_f32 v16, v136, v137
v_cvt_pk_bf16_f32 v17, v138, v139
ds_read_b128 v[136:139], v254
v_mfma_f32_16x16x32_bf16 v[12:15], v[180:183], v[36:39], v[12:15]
ds_read_b128 v[180:183], v248 offset:32768
v_rcp_f16_sdwa v131, v131 dst_sel:WORD_0 dst_unused:UNUSED_PRESERVE src0_sel:WORD_0
v_cvt_pk_bf16_f32 v20, v144, v145
v_cvt_pk_bf16_f32 v21, v146, v147
ds_read_b128 v[144:147], v254
s_setprio 2
v_mfma_f32_16x16x32_f16 v[140:143], v[184:187], v[192:195], v[140:143]
v_rcp_f16_sdwa v133, v133 dst_sel:WORD_0 dst_unused:UNUSED_PRESERVE src0_sel:WORD_0
v_mfma_f32_16x16x32_bf16 v[4:7], v[188:191], v[40:43], v[4:7]
v_rcp_f16_sdwa v135, v135 dst_sel:WORD_0 dst_unused:UNUSED_PRESERVE src0_sel:WORD_0
v_mfma_f32_16x16x32_f16 v[148:151], v[184:187], v[196:199], v[148:151]
s_nop 3
v_cvt_pk_bf16_f32 v18, v140, v141
v_cvt_pk_bf16_f32 v19, v142, v143
ds_read_b128 v[140:143], v254 offset:16
ds_read_b128 v[184:187], v251 offset:9216
v_mfma_f32_16x16x32_bf16 v[12:15], v[188:191], v[44:47], v[12:15]
ds_read_b128 v[188:191], v248 offset:34816
v_rcp_f16_sdwa v131, v131 dst_sel:WORD_1 dst_unused:UNUSED_PRESERVE src0_sel:WORD_1
v_cvt_pk_bf16_f32 v22, v148, v149
v_cvt_pk_bf16_f32 v23, v150, v151
ds_read_b128 v[148:151], v254 offset:16
buffer_store_dwordx4 v[240:243], v253, s[8:11], s70 offen sc1
s_waitcnt lgkmcnt(11)
v_mfma_f32_16x16x32_f16 v[72:75], v[168:171], v[232:235], v[72:75]
v_rcp_f16_sdwa v133, v133 dst_sel:WORD_1 dst_unused:UNUSED_PRESERVE src0_sel:WORD_1
v_mfma_f32_16x16x32_bf16 v[96:99], v[172:175], v[24:27], 0
v_rcp_f16_sdwa v135, v135 dst_sel:WORD_1 dst_unused:UNUSED_PRESERVE src0_sel:WORD_1
v_mfma_f32_16x16x32_f16 v[80:83], v[168:171], v[236:239], v[80:83]
ds_read_b128 v[168:171], v251 offset:12288
v_or_b32 v200, v120, v121
v_pk_mul_f16 v205, v130, v131
v_mfma_f32_16x16x32_bf16 v[104:107], v[172:175], v[28:31], 0
ds_read_b128 v[172:175], v248 offset:30976
v_pk_mul_f16 v206, v132, v133
s_waitcnt lgkmcnt(8)
v_mfma_f32_16x16x32_f16 v[76:79], v[176:179], v[232:235], v[76:79]
v_pk_mul_f16 v207, v134, v135
v_cvt_pkrtz_f16_f32 v1, v0, v1
v_and_b32 v1, s49, v1
v_bfe_u32 v0, v1, 2, 14
v_lshrrev_b32_e64 v1, 18, v1
ds_read_u16 v0, v0
ds_read_u16_d16_hi v1, v1
v_cvt_pk_f16_f32 v10, v10, v11
v_or_b32 v201, v122, v123
s_waitcnt lgkmcnt(8)
v_mfma_f32_16x16x32_bf16 v[96:99], v[180:183], v[32:35], v[96:99]
v_cvt_pk_f16_f32 v12, v12, v13
v_mfma_f32_16x16x32_f16 v[84:87], v[176:179], v[236:239], v[84:87]
ds_read_b128 v[176:179], v251 offset:10240
v_cvt_pk_f16_f32 v14, v14, v15
v_pk_fma_f16 v11, v10, v10, s48
v_mfma_f32_16x16x32_bf16 v[104:107], v[180:183], v[36:39], v[104:107]
ds_read_b128 v[180:183], v248 offset:33024
v_pk_fma_f16 v13, v12, v12, s48
s_waitcnt lgkmcnt(7)
v_mfma_f32_16x16x32_f16 v[152:155], v[184:187], v[232:235], v[152:155]
v_cvt_pkrtz_f16_f32 v3, v2, v3
v_and_b32 v3, s49, v3
v_bfe_u32 v2, v3, 2, 14
v_lshrrev_b32_e64 v3, 18, v3
ds_read_u16 v2, v2
ds_read_u16_d16_hi v3, v3
s_setprio 1
v_or_b32 v202, v124, v125
v_pk_fma_f16 v15, v14, v14, s48
v_pk_mul_f16 v11, v10, v11
v_pk_mul_f16 v13, v12, v13
v_mfma_f32_16x16x32_f16 v[160:163], v[184:187], v[236:239], v[160:163]
ds_read_b128 v[184:187], v251 offset:13312
v_pk_mul_f16 v15, v14, v15
v_mfma_f32_16x16x32_bf16 v[96:99], v[188:191], v[40:43], v[96:99]
v_cvt_pkrtz_f16_f32 v5, v4, v5
v_and_b32_e64 v5, s49, v5
v_bfe_u32 v4, v5, 2, 14
v_lshrrev_b32_e64 v5, 18, v5
ds_read_u16 v4, v4
ds_read_u16_d16_hi v5, v5
v_or_b32 v203, v126, v127
v_exp_f16_sdwa v11, v11 dst_sel:WORD_0 dst_unused:UNUSED_PRESERVE src0_sel:WORD_0
s_waitcnt lgkmcnt(7)
v_mfma_f32_16x16x32_f16 v[156:159], v[168:171], v[232:235], v[156:159]
v_exp_f16_sdwa v13, v13 dst_sel:WORD_0 dst_unused:UNUSED_PRESERVE src0_sel:WORD_0
v_mfma_f32_16x16x32_bf16 v[104:107], v[188:191], v[44:47], v[104:107]
ds_read_b128 v[188:191], v248 offset:35072
v_cvt_pkrtz_f16_f32 v7, v6, v7
v_and_b32_e64 v7, s49, v7
v_bfe_u32 v6, v7, 2, 14
v_lshrrev_b32_e64 v7, 18, v7
ds_read_u16 v6, v6
ds_read_u16_d16_hi v7, v7
v_mfma_f32_16x16x32_f16 v[164:167], v[168:171], v[236:239], v[164:167]
ds_read_b128 v[168:171], v251 offset:14336
v_exp_f16_sdwa v15, v15 dst_sel:WORD_0 dst_unused:UNUSED_PRESERVE src0_sel:WORD_0
v_or_b32 v204, v128, v129
v_mfma_f32_16x16x32_bf16 v[100:103], v[172:175], v[24:27], 0
v_exp_f16_sdwa v11, v11 dst_sel:WORD_1 dst_unused:UNUSED_PRESERVE src0_sel:WORD_1
s_waitcnt lgkmcnt(7)
v_mfma_f32_16x16x32_f16 v[136:139], v[176:179], v[232:235], v[136:139]
v_exp_f16_sdwa v13, v13 dst_sel:WORD_1 dst_unused:UNUSED_PRESERVE src0_sel:WORD_1
v_mfma_f32_16x16x32_bf16 v[108:111], v[172:175], v[28:31], 0
ds_read_b128 v[172:175], v249
v_cvt_pkrtz_f16_f32 v9, v8, v9
v_and_b32_e64 v9, s49, v9
v_bfe_u32 v8, v9, 2, 14
v_lshrrev_b32_e64 v9, 18, v9
ds_read_u16 v8, v8
ds_read_u16_d16_hi v9, v9
v_mfma_f32_16x16x32_f16 v[144:147], v[176:179], v[236:239], v[144:147]
ds_read_b128 v[176:179], v251 offset:17408
v_exp_f16_sdwa v15, v15 dst_sel:WORD_1 dst_unused:UNUSED_PRESERVE src0_sel:WORD_1
v_mfma_f32_16x16x32_bf16 v[100:103], v[180:183], v[32:35], v[100:103]
v_pk_add_f16 v11, v11, 1.0 op_sel_hi:[1,0]
s_waitcnt lgkmcnt(7)
v_mfma_f32_16x16x32_f16 v[140:143], v[184:187], v[232:235], v[140:143]
v_pk_add_f16 v13, v13, 1.0 op_sel_hi:[1,0]
v_pk_add_f16 v15, v15, 1.0 op_sel_hi:[1,0]
buffer_store_dwordx4 v[244:247], v253, s[8:11], s70 offen offset:192 sc1
v_mfma_f32_16x16x32_bf16 v[108:111], v[180:183], v[36:39], v[108:111]
ds_read_b128 v[180:183], v251 offset:15360
v_rcp_f16_sdwa v11, v11 dst_sel:WORD_0 dst_unused:UNUSED_PRESERVE src0_sel:WORD_0
s_setprio 0
v_mfma_f32_16x16x32_f16 v[148:151], v[184:187], v[236:239], v[148:151]
ds_read_b128 v[184:187], v249 offset:2048
v_rcp_f16_sdwa v13, v13 dst_sel:WORD_0 dst_unused:UNUSED_PRESERVE src0_sel:WORD_0
v_mfma_f32_16x16x32_bf16 v[100:103], v[188:191], v[40:43], v[100:103]
v_rcp_f16_sdwa v15, v15 dst_sel:WORD_0 dst_unused:UNUSED_PRESERVE src0_sel:WORD_0
s_waitcnt lgkmcnt(6)
v_mfma_f32_16x16x32_f16 v[72:75], v[168:171], v[112:115], v[72:75]
v_rcp_f16_sdwa v11, v11 dst_sel:WORD_1 dst_unused:UNUSED_PRESERVE src0_sel:WORD_1
v_mfma_f32_16x16x32_bf16 v[108:111], v[188:191], v[44:47], v[108:111]
ds_read_b128 v[188:191], v251 offset:18432
v_rcp_f16_sdwa v13, v13 dst_sel:WORD_1 dst_unused:UNUSED_PRESERVE src0_sel:WORD_1
v_mfma_f32_16x16x32_f16 v[80:83], v[168:171], v[116:119], v[80:83]
ds_read_b128 v[168:171], v249 offset:4096
v_rcp_f16_sdwa v15, v15 dst_sel:WORD_1 dst_unused:UNUSED_PRESERVE src0_sel:WORD_1
s_waitcnt lgkmcnt(6)
v_mfma_f32_16x16x32_bf16 v[120:123], v[172:175], v[24:27], 0
v_or_b32 v216, v0, v1
s_waitcnt lgkmcnt(4)
v_mfma_f32_16x16x32_f16 v[76:79], v[176:179], v[112:115], v[76:79]
v_pk_mul_f16 v221, v10, v11
v_mfma_f32_16x16x32_f16 v[84:87], v[176:179], v[116:119], v[84:87]
ds_read_b128 v[176:179], v249 offset:256
v_pk_mul_f16 v222, v12, v13
v_mfma_f32_16x16x32_bf16 v[128:131], v[172:175], v[28:31], 0
ds_read_b128 v[172:175], v251 offset:16384
v_pk_mul_f16 v223, v14, v15
v_cvt_pkrtz_f16_f32 v97, v96, v97
v_and_b32_e64 v97, s49, v97
v_bfe_u32 v96, v97, 2, 14
v_lshrrev_b32_e64 v97, 18, v97
ds_read_u16 v96, v96
ds_read_u16_d16_hi v97, v97
v_cvt_pk_f16_f32 v106, v106, v107
s_waitcnt lgkmcnt(5)
v_mfma_f32_16x16x32_f16 v[152:155], v[180:183], v[112:115], v[152:155]
v_or_b32 v217, v2, v3
v_mfma_f32_16x16x32_bf16 v[120:123], v[184:187], v[32:35], v[120:123]
v_cvt_pk_f16_f32 v108, v108, v109
v_cvt_pk_f16_f32 v110, v110, v111
v_pk_fma_f16 v107, v106, v106, s48
v_mfma_f32_16x16x32_f16 v[160:163], v[180:183], v[116:119], v[160:163]
ds_read_b128 v[180:183], v251 offset:19456
v_pk_fma_f16 v109, v108, v108, s48
v_mfma_f32_16x16x32_bf16 v[128:131], v[184:187], v[36:39], v[128:131]
ds_read_b128 v[184:187], v249 offset:2304
v_cvt_pkrtz_f16_f32 v99, v98, v99
v_and_b32_e64 v99, s49, v99
v_bfe_u32 v98, v99, 2, 14
v_lshrrev_b32_e64 v99, 18, v99
ds_read_u16 v98, v98
ds_read_u16_d16_hi v99, v99
v_or_b32 v218, v4, v5
v_pk_fma_f16 v111, v110, v110, s48
s_setprio 3
v_pk_mul_f16 v107, v106, v107
v_mfma_f32_16x16x32_f16 v[156:159], v[188:191], v[112:115], v[156:159]
v_pk_mul_f16 v109, v108, v109
s_waitcnt lgkmcnt(6)
v_mfma_f32_16x16x32_bf16 v[120:123], v[168:171], v[40:43], v[120:123]
v_pk_mul_f16 v111, v110, v111
v_cvt_pkrtz_f16_f32 v101, v100, v101
v_and_b32 v101, s49, v101
v_bfe_u32 v100, v101, 2, 14
v_lshrrev_b32 v101, 18, v101
ds_read_u16 v100, v100
ds_read_u16_d16_hi v101, v101
v_mfma_f32_16x16x32_f16 v[164:167], v[188:191], v[116:119], v[164:167]
ds_read_b128 v[188:191], v251 offset:20480
v_or_b32 v219, v6, v7
v_exp_f16_sdwa v107, v107 dst_sel:WORD_0 dst_unused:UNUSED_PRESERVE src0_sel:WORD_0
v_mfma_f32_16x16x32_bf16 v[128:131], v[168:171], v[44:47], v[128:131]
ds_read_b128 v[168:171], v249 offset:4352
v_exp_f16_sdwa v109, v109 dst_sel:WORD_0 dst_unused:UNUSED_PRESERVE src0_sel:WORD_0
v_mfma_f32_16x16x32_f16 v[136:139], v[172:175], v[112:115], v[136:139]
v_cvt_pkrtz_f16_f32 v103, v102, v103
v_and_b32_e64 v103, s49, v103
v_bfe_u32 v102, v103, 2, 14
v_lshrrev_b32 v103, 18, v103
ds_read_u16 v102, v102
ds_read_u16_d16_hi v103, v103
v_exp_f16_sdwa v111, v111 dst_sel:WORD_0 dst_unused:UNUSED_PRESERVE src0_sel:WORD_0
v_or_b32 v220, v8, v9
v_mfma_f32_16x16x32_bf16 v[124:127], v[176:179], v[24:27], 0
v_exp_f16_sdwa v107, v107 dst_sel:WORD_1 dst_unused:UNUSED_PRESERVE src0_sel:WORD_1
v_mfma_f32_16x16x32_f16 v[144:147], v[172:175], v[116:119], v[144:147]
ds_read_b128 v[172:175], v251 offset:23552
v_exp_f16_sdwa v109, v109 dst_sel:WORD_1 dst_unused:UNUSED_PRESERVE src0_sel:WORD_1
v_mfma_f32_16x16x32_bf16 v[132:135], v[176:179], v[28:31], 0
ds_read_b128 v[176:179], v249 offset:6144
v_cvt_pkrtz_f16_f32 v105, v104, v105
v_and_b32_e64 v105, s49, v105
v_bfe_u32 v104, v105, 2, 14
v_lshrrev_b32 v105, 18, v105
ds_read_u16 v104, v104
ds_read_u16_d16_hi v105, v105
buffer_store_dwordx4 v[88:91], v253, s[8:11], s70 offen offset:64 sc1
s_waitcnt lgkmcnt(8)
v_mfma_f32_16x16x32_f16 v[140:143], v[180:183], v[112:115], v[140:143]
v_exp_f16_sdwa v111, v111 dst_sel:WORD_1 dst_unused:UNUSED_PRESERVE src0_sel:WORD_1
v_mfma_f32_16x16x32_bf16 v[124:127], v[184:187], v[32:35], v[124:127]
v_pk_add_f16 v107, v107, 1.0 op_sel_hi:[1,0]
v_mfma_f32_16x16x32_f16 v[148:151], v[180:183], v[116:119], v[148:151]
ds_read_b128 v[180:183], v251 offset:21504
v_pk_add_f16 v109, v109, 1.0 op_sel_hi:[1,0]
v_pk_add_f16 v111, v111, 1.0 op_sel_hi:[1,0]
v_mfma_f32_16x16x32_bf16 v[132:135], v[184:187], v[36:39], v[132:135]
ds_read_b128 v[184:187], v249 offset:8192
v_rcp_f16_sdwa v107, v107 dst_sel:WORD_0 dst_unused:UNUSED_PRESERVE src0_sel:WORD_0
s_waitcnt lgkmcnt(7)
v_mfma_f32_16x16x32_f16 v[72:75], v[188:191], v[224:227], v[72:75]
s_setprio 2
v_rcp_f16_sdwa v109, v109 dst_sel:WORD_0 dst_unused:UNUSED_PRESERVE src0_sel:WORD_0
v_mfma_f32_16x16x32_f16 v[80:83], v[188:191], v[228:231], v[80:83]
ds_read_b128 v[188:191], v251 offset:24576
v_rcp_f16_sdwa v111, v111 dst_sel:WORD_0 dst_unused:UNUSED_PRESERVE src0_sel:WORD_0
v_mfma_f32_16x16x32_bf16 v[124:127], v[168:171], v[40:43], v[124:127]
v_rcp_f16_sdwa v107, v107 dst_sel:WORD_1 dst_unused:UNUSED_PRESERVE src0_sel:WORD_1
s_waitcnt lgkmcnt(5)
v_mfma_f32_16x16x32_f16 v[76:79], v[172:175], v[224:227], v[76:79]
v_rcp_f16_sdwa v109, v109 dst_sel:WORD_1 dst_unused:UNUSED_PRESERVE src0_sel:WORD_1
v_mfma_f32_16x16x32_bf16 v[132:135], v[168:171], v[44:47], v[132:135]
ds_read_b128 v[168:171], v249 offset:10240
v_rcp_f16_sdwa v111, v111 dst_sel:WORD_1 dst_unused:UNUSED_PRESERVE src0_sel:WORD_1
v_mfma_f32_16x16x32_f16 v[84:87], v[172:175], v[228:231], v[84:87]
ds_read_b128 v[172:175], v251 offset:22528
v_or_b32 v208, v96, v97
v_mfma_f32_16x16x32_bf16 v[0:3], v[176:179], v[24:27], 0
v_pk_mul_f16 v213, v106, v107
s_waitcnt lgkmcnt(4)
v_mfma_f32_16x16x32_f16 v[152:155], v[180:183], v[224:227], v[152:155]
v_pk_mul_f16 v214, v108, v109
v_mfma_f32_16x16x32_bf16 v[8:11], v[176:179], v[28:31], 0
ds_read_b128 v[176:179], v249 offset:6400
v_pk_mul_f16 v215, v110, v111
v_mfma_f32_16x16x32_f16 v[160:163], v[180:183], v[228:231], v[160:163]
ds_read_b128 v[180:183], v251 offset:25600
v_cvt_pkrtz_f16_f32 v121, v120, v121
v_and_b32 v121, s49, v121
v_bfe_u32 v120, v121, 2, 14
v_lshrrev_b32_e64 v121, 18, v121
ds_read_u16 v120, v120
ds_read_u16_d16_hi v121, v121
v_cvt_pk_f16_f32 v130, v130, v131
v_or_b32 v209, v98, v99
buffer_load_dwordx4 v[192:195], v253, s[4:7], s69 offen
s_waitcnt lgkmcnt(6)
v_mfma_f32_16x16x32_bf16 v[0:3], v[184:187], v[32:35], v[0:3]
v_cvt_pk_f16_f32 v132, v132, v133
v_cvt_pk_f16_f32 v134, v134, v135
v_mfma_f32_16x16x32_f16 v[156:159], v[188:191], v[224:227], v[156:159]
v_pk_fma_f16 v131, v130, v130, s48
v_mfma_f32_16x16x32_bf16 v[8:11], v[184:187], v[36:39], v[8:11]
ds_read_b128 v[184:187], v251 offset:26624
v_pk_fma_f16 v133, v132, v132, s48
v_cvt_pkrtz_f16_f32 v123, v122, v123
v_and_b32_e64 v123, s49, v123
v_bfe_u32 v122, v123, 2, 14
v_lshrrev_b32 v123, 18, v123
ds_read_u16 v122, v122
ds_read_u16_d16_hi v123, v123
v_or_b32 v210, v100, v101
v_mfma_f32_16x16x32_f16 v[164:167], v[188:191], v[228:231], v[164:167]
ds_read_b128 v[188:191], v249 offset:8448
v_pk_fma_f16 v135, v134, v134, s48
s_setprio 1
v_pk_mul_f16 v131, v130, v131
v_pk_mul_f16 v133, v132, v133
s_waitcnt lgkmcnt(6)
v_mfma_f32_16x16x32_bf16 v[0:3], v[168:171], v[40:43], v[0:3]
v_pk_mul_f16 v135, v134, v135
v_mfma_f32_16x16x32_f16 v[136:139], v[172:175], v[224:227], v[136:139]
v_cvt_pkrtz_f16_f32 v125, v124, v125
v_and_b32_e64 v125, s49, v125
v_bfe_u32 v124, v125, 2, 14
v_lshrrev_b32 v125, 18, v125
ds_read_u16 v124, v124
ds_read_u16_d16_hi v125, v125
v_or_b32 v211, v102, v103
v_exp_f16_sdwa v131, v131 dst_sel:WORD_0 dst_unused:UNUSED_PRESERVE src0_sel:WORD_0
buffer_store_dwordx4 v[92:95], v253, s[8:11], s70 offen offset:256 sc1
v_mfma_f32_16x16x32_bf16 v[8:11], v[168:171], v[44:47], v[8:11]
ds_read_b128 v[168:171], v251 offset:29696
v_exp_f16_sdwa v133, v133 dst_sel:WORD_0 dst_unused:UNUSED_PRESERVE src0_sel:WORD_0
v_mfma_f32_16x16x32_f16 v[144:147], v[172:175], v[228:231], v[144:147]
ds_read_b128 v[172:175], v249 offset:10496
v_cvt_pkrtz_f16_f32 v127, v126, v127
v_and_b32_e64 v127, s49, v127
v_bfe_u32 v126, v127, 2, 14
v_lshrrev_b32 v127, 18, v127
ds_read_u16 v126, v126
ds_read_u16_d16_hi v127, v127
v_exp_f16_sdwa v135, v135 dst_sel:WORD_0 dst_unused:UNUSED_PRESERVE src0_sel:WORD_0
v_or_b32 v212, v104, v105
v_mfma_f32_16x16x32_bf16 v[4:7], v[176:179], v[24:27], 0
v_exp_f16_sdwa v131, v131 dst_sel:WORD_1 dst_unused:UNUSED_PRESERVE src0_sel:WORD_1
v_mfma_f32_16x16x32_f16 v[140:143], v[180:183], v[224:227], v[140:143]
v_exp_f16_sdwa v133, v133 dst_sel:WORD_1 dst_unused:UNUSED_PRESERVE src0_sel:WORD_1
v_mfma_f32_16x16x32_f16 v[148:151], v[180:183], v[228:231], v[148:151]
ds_read_b128 v[180:183], v249 offset:12288
v_cvt_pkrtz_f16_f32 v129, v128, v129
v_mfma_f32_16x16x32_bf16 v[12:15], v[176:179], v[28:31], 0
ds_read_b128 v[176:179], v251 offset:27648
v_and_b32_e64 v129, s49, v129
v_bfe_u32 v128, v129, 2, 14
v_lshrrev_b32 v129, 18, v129
ds_read_u16 v128, v128
ds_read_u16_d16_hi v129, v129
buffer_load_dwordx4 v[196:199], v253, s[4:7], s69 offen offset:192
v_exp_f16_sdwa v135, v135 dst_sel:WORD_1 dst_unused:UNUSED_PRESERVE src0_sel:WORD_1
s_waitcnt lgkmcnt(7)
v_mfma_f32_16x16x32_f16 v[72:75], v[184:187], v[200:203], v[72:75]
v_pk_add_f16 v131, v131, 1.0 op_sel_hi:[1,0]
v_mfma_f32_16x16x32_bf16 v[4:7], v[188:191], v[32:35], v[4:7]
v_pk_add_f16 v133, v133, 1.0 op_sel_hi:[1,0]
v_mfma_f32_16x16x32_f16 v[80:83], v[184:187], v[204:207], v[80:83]
ds_read_b128 v[184:187], v251 offset:30720
v_pk_add_f16 v135, v135, 1.0 op_sel_hi:[1,0]
v_mfma_f32_16x16x32_bf16 v[12:15], v[188:191], v[36:39], v[12:15]
ds_read_b128 v[188:191], v249 offset:14336
v_rcp_f16_sdwa v131, v131 dst_sel:WORD_0 dst_unused:UNUSED_PRESERVE src0_sel:WORD_0
v_mfma_f32_16x16x32_f16 v[76:79], v[168:171], v[200:203], v[76:79]
s_setprio 0
v_rcp_f16_sdwa v133, v133 dst_sel:WORD_0 dst_unused:UNUSED_PRESERVE src0_sel:WORD_0
s_waitcnt lgkmcnt(6)
v_mfma_f32_16x16x32_bf16 v[4:7], v[172:175], v[40:43], v[4:7]
v_rcp_f16_sdwa v135, v135 dst_sel:WORD_0 dst_unused:UNUSED_PRESERVE src0_sel:WORD_0
v_mfma_f32_16x16x32_f16 v[84:87], v[168:171], v[204:207], v[84:87]
ds_read_b128 v[168:171], v251 offset:28672
v_rcp_f16_sdwa v131, v131 dst_sel:WORD_1 dst_unused:UNUSED_PRESERVE src0_sel:WORD_1
v_mfma_f32_16x16x32_bf16 v[12:15], v[172:175], v[44:47], v[12:15]
ds_read_b128 v[172:175], v249 offset:16384
v_rcp_f16_sdwa v133, v133 dst_sel:WORD_1 dst_unused:UNUSED_PRESERVE src0_sel:WORD_1
s_waitcnt lgkmcnt(5)
v_mfma_f32_16x16x32_f16 v[152:155], v[176:179], v[200:203], v[152:155]
v_rcp_f16_sdwa v135, v135 dst_sel:WORD_1 dst_unused:UNUSED_PRESERVE src0_sel:WORD_1
v_mfma_f32_16x16x32_bf16 v[96:99], v[180:183], v[24:27], 0
v_or_b32 v232, v120, v121
v_mfma_f32_16x16x32_f16 v[160:163], v[176:179], v[204:207], v[160:163]
ds_read_b128 v[176:179], v251 offset:31744
buffer_load_dwordx4 v[240:243], v253, s[4:7], s69 offen offset:64
v_pk_mul_f16 v237, v130, v131
v_mfma_f32_16x16x32_bf16 v[104:107], v[180:183], v[28:31], 0
ds_read_b128 v[180:183], v249 offset:12544
v_pk_mul_f16 v238, v132, v133
s_waitcnt lgkmcnt(4)
v_mfma_f32_16x16x32_f16 v[156:159], v[184:187], v[200:203], v[156:159]
v_pk_mul_f16 v239, v134, v135
v_cvt_pkrtz_f16_f32 v1, v0, v1
v_and_b32 v1, s49, v1
v_bfe_u32 v0, v1, 2, 14
v_lshrrev_b32_e64 v1, 18, v1
ds_read_u16 v0, v0
ds_read_u16_d16_hi v1, v1
v_cvt_pk_f16_f32 v10, v10, v11
v_or_b32 v233, v122, v123
v_mfma_f32_16x16x32_bf16 v[96:99], v[188:191], v[32:35], v[96:99]
v_cvt_pk_f16_f32 v12, v12, v13
v_mfma_f32_16x16x32_f16 v[164:167], v[184:187], v[204:207], v[164:167]
ds_read_b128 v[184:187], v251 offset:32768
v_cvt_pk_f16_f32 v14, v14, v15
v_pk_fma_f16 v11, v10, v10, s48
buffer_store_dwordx4 v[16:19], v253, s[8:11], s70 offen offset:128 sc1
s_waitcnt lgkmcnt(5)
v_mfma_f32_16x16x32_f16 v[136:139], v[168:171], v[200:203], v[136:139]
v_pk_fma_f16 v13, v12, v12, s48
v_mfma_f32_16x16x32_bf16 v[104:107], v[188:191], v[36:39], v[104:107]
ds_read_b128 v[188:191], v249 offset:14592
v_cvt_pkrtz_f16_f32 v3, v2, v3
v_and_b32_e64 v3, s49, v3
v_bfe_u32 v2, v3, 2, 14
v_lshrrev_b32_e64 v3, 18, v3
ds_read_u16 v2, v2
ds_read_u16_d16_hi v3, v3
v_or_b32 v234, v124, v125
v_pk_fma_f16 v15, v14, v14, s48
v_pk_mul_f16 v11, v10, v11
s_setprio 3
v_mfma_f32_16x16x32_f16 v[144:147], v[168:171], v[204:207], v[144:147]
ds_read_b128 v[168:171], v251 offset:35840
v_pk_mul_f16 v13, v12, v13
v_mfma_f32_16x16x32_bf16 v[96:99], v[172:175], v[40:43], v[96:99]
v_pk_mul_f16 v15, v14, v15
v_cvt_pkrtz_f16_f32 v5, v4, v5
v_and_b32_e64 v5, s49, v5
v_bfe_u32 v4, v5, 2, 14
v_lshrrev_b32_e64 v5, 18, v5
ds_read_u16 v4, v4
ds_read_u16_d16_hi v5, v5
v_or_b32 v235, v126, v127
v_exp_f16_sdwa v11, v11 dst_sel:WORD_0 dst_unused:UNUSED_PRESERVE src0_sel:WORD_0
s_waitcnt lgkmcnt(6)
v_mfma_f32_16x16x32_f16 v[140:143], v[176:179], v[200:203], v[140:143]
v_exp_f16_sdwa v13, v13 dst_sel:WORD_0 dst_unused:UNUSED_PRESERVE src0_sel:WORD_0
v_mfma_f32_16x16x32_bf16 v[104:107], v[172:175], v[44:47], v[104:107]
ds_read_b128 v[172:175], v249 offset:16640
v_cvt_pkrtz_f16_f32 v7, v6, v7
v_mfma_f32_16x16x32_f16 v[148:151], v[176:179], v[204:207], v[148:151]
ds_read_b128 v[176:179], v251 offset:33792
v_and_b32_e64 v7, s49, v7
v_bfe_u32 v6, v7, 2, 14
v_lshrrev_b32 v7, 18, v7
ds_read_u16 v6, v6
ds_read_u16_d16_hi v7, v7
v_exp_f16_sdwa v15, v15 dst_sel:WORD_0 dst_unused:UNUSED_PRESERVE src0_sel:WORD_0
v_or_b32 v236, v128, v129
buffer_load_dwordx4 v[244:247], v253, s[4:7], s69 offen offset:256
v_mfma_f32_16x16x32_bf16 v[100:103], v[180:183], v[24:27], 0
v_exp_f16_sdwa v11, v11 dst_sel:WORD_1 dst_unused:UNUSED_PRESERVE src0_sel:WORD_1
v_mfma_f32_16x16x32_f16 v[72:75], v[184:187], v[216:219], v[72:75]
v_exp_f16_sdwa v13, v13 dst_sel:WORD_1 dst_unused:UNUSED_PRESERVE src0_sel:WORD_1
v_mfma_f32_16x16x32_bf16 v[108:111], v[180:183], v[28:31], 0
ds_read_b128 v[180:183], v251 offset:36864
v_cvt_pkrtz_f16_f32 v9, v8, v9
v_and_b32_e64 v9, s49, v9
v_bfe_u32 v8, v9, 2, 14
v_lshrrev_b32 v9, 18, v9
ds_read_u16 v8, v8
ds_read_u16_d16_hi v9, v9
v_mfma_f32_16x16x32_f16 v[80:83], v[184:187], v[220:223], v[80:83]
ds_read_b128 v[184:187], v249 offset:18432
v_exp_f16_sdwa v15, v15 dst_sel:WORD_1 dst_unused:UNUSED_PRESERVE src0_sel:WORD_1
s_waitcnt lgkmcnt(7)
v_mfma_f32_16x16x32_bf16 v[100:103], v[188:191], v[32:35], v[100:103]
v_pk_add_f16 v11, v11, 1.0 op_sel_hi:[1,0]
v_mfma_f32_16x16x32_f16 v[76:79], v[168:171], v[216:219], v[76:79]
v_pk_add_f16 v13, v13, 1.0 op_sel_hi:[1,0]
v_pk_add_f16 v15, v15, 1.0 op_sel_hi:[1,0]
v_mfma_f32_16x16x32_bf16 v[108:111], v[188:191], v[36:39], v[108:111]
ds_read_b128 v[188:191], v251 offset:34816
v_rcp_f16_sdwa v11, v11 dst_sel:WORD_0 dst_unused:UNUSED_PRESERVE src0_sel:WORD_0
v_mfma_f32_16x16x32_f16 v[84:87], v[168:171], v[220:223], v[84:87]
ds_read_b128 v[168:171], v249 offset:20480
v_rcp_f16_sdwa v13, v13 dst_sel:WORD_0 dst_unused:UNUSED_PRESERVE src0_sel:WORD_0
s_setprio 2
v_mfma_f32_16x16x32_bf16 v[100:103], v[172:175], v[40:43], v[100:103]
v_rcp_f16_sdwa v15, v15 dst_sel:WORD_0 dst_unused:UNUSED_PRESERVE src0_sel:WORD_0
s_waitcnt lgkmcnt(5)
v_mfma_f32_16x16x32_f16 v[152:155], v[176:179], v[216:219], v[152:155]
v_rcp_f16_sdwa v11, v11 dst_sel:WORD_1 dst_unused:UNUSED_PRESERVE src0_sel:WORD_1
v_mfma_f32_16x16x32_bf16 v[108:111], v[172:175], v[44:47], v[108:111]
ds_read_b128 v[172:175], v251 offset:37888
v_rcp_f16_sdwa v13, v13 dst_sel:WORD_1 dst_unused:UNUSED_PRESERVE src0_sel:WORD_1
v_mfma_f32_16x16x32_f16 v[160:163], v[176:179], v[220:223], v[160:163]
ds_read_b128 v[176:179], v249 offset:22528
buffer_load_dwordx4 v[112:115], v253, s[4:7], s69 offen offset:128
v_mfma_f32_16x16x32_f16 v[156:159], v[180:183], v[216:219], v[156:159]
v_rcp_f16_sdwa v15, v15 dst_sel:WORD_1 dst_unused:UNUSED_PRESERVE src0_sel:WORD_1
s_waitcnt lgkmcnt(4)
v_mfma_f32_16x16x32_bf16 v[120:123], v[184:187], v[24:27], 0
buffer_store_dwordx4 v[20:23], v253, s[8:11], s70 offen offset:320 sc1
v_or_b32 v88, v0, v1
v_mfma_f32_16x16x32_f16 v[164:167], v[180:183], v[220:223], v[164:167]
ds_read_b128 v[180:183], v251 offset:38912
v_pk_mul_f16 v93, v10, v11
v_mfma_f32_16x16x32_bf16 v[128:131], v[184:187], v[28:31], 0
ds_read_b128 v[184:187], v249 offset:18688
v_pk_mul_f16 v94, v12, v13
v_pk_mul_f16 v95, v14, v15
s_waitcnt lgkmcnt(4)
v_mfma_f32_16x16x32_f16 v[136:139], v[188:191], v[216:219], v[136:139]
v_cvt_pkrtz_f16_f32 v97, v96, v97
v_and_b32 v97, s49, v97
v_bfe_u32 v96, v97, 2, 14
v_lshrrev_b32 v97, 18, v97
ds_read_u16 v96, v96
ds_read_u16_d16_hi v97, v97
v_cvt_pk_f16_f32 v106, v106, v107
v_or_b32 v89, v2, v3
v_mfma_f32_16x16x32_bf16 v[120:123], v[168:171], v[32:35], v[120:123]
v_cvt_pk_f16_f32 v108, v108, v109
v_cvt_pk_f16_f32 v110, v110, v111
v_mfma_f32_16x16x32_f16 v[144:147], v[188:191], v[220:223], v[144:147]
ds_read_b128 v[188:191], v251 offset:41984
v_pk_fma_f16 v107, v106, v106, s48
v_mfma_f32_16x16x32_bf16 v[128:131], v[168:171], v[36:39], v[128:131]
ds_read_b128 v[168:171], v249 offset:20736
v_pk_fma_f16 v109, v108, v108, s48
v_cvt_pkrtz_f16_f32 v99, v98, v99
v_and_b32_e64 v99, s49, v99
v_bfe_u32 v98, v99, 2, 14
v_lshrrev_b32_e64 v99, 18, v99
ds_read_u16 v98, v98
ds_read_u16_d16_hi v99, v99
v_or_b32 v90, v4, v5
v_pk_fma_f16 v111, v110, v110, s48
s_waitcnt lgkmcnt(6)
v_mfma_f32_16x16x32_f16 v[140:143], v[172:175], v[216:219], v[140:143]
v_pk_mul_f16 v107, v106, v107
v_pk_mul_f16 v109, v108, v109
s_setprio 1
v_mfma_f32_16x16x32_bf16 v[120:123], v[176:179], v[40:43], v[120:123]
v_pk_mul_f16 v111, v110, v111
v_cvt_pkrtz_f16_f32 v101, v100, v101
v_and_b32 v101, s49, v101
v_bfe_u32 v100, v101, 2, 14
v_lshrrev_b32 v101, 18, v101
ds_read_u16 v100, v100
ds_read_u16_d16_hi v101, v101
v_mfma_f32_16x16x32_f16 v[148:151], v[172:175], v[220:223], v[148:151]
ds_read_b128 v[172:175], v251 offset:39936
v_or_b32 v91, v6, v7
v_exp_f16_sdwa v107, v107 dst_sel:WORD_0 dst_unused:UNUSED_PRESERVE src0_sel:WORD_0
v_mfma_f32_16x16x32_bf16 v[128:131], v[176:179], v[44:47], v[128:131]
ds_read_b128 v[176:179], v249 offset:22784
v_exp_f16_sdwa v109, v109 dst_sel:WORD_0 dst_unused:UNUSED_PRESERVE src0_sel:WORD_0
v_mfma_f32_16x16x32_f16 v[72:75], v[180:183], v[208:211], v[72:75]
buffer_load_dwordx4 v[116:119], v253, s[4:7], s69 offen offset:320
v_cvt_pkrtz_f16_f32 v103, v102, v103
v_and_b32_e64 v103, s49, v103
v_bfe_u32 v102, v103, 2, 14
v_lshrrev_b32 v103, 18, v103
ds_read_u16 v102, v102
ds_read_u16_d16_hi v103, v103
v_exp_f16_sdwa v111, v111 dst_sel:WORD_0 dst_unused:UNUSED_PRESERVE src0_sel:WORD_0
v_or_b32 v92, v8, v9
v_mfma_f32_16x16x32_bf16 v[124:127], v[184:187], v[24:27], 0
v_exp_f16_sdwa v107, v107 dst_sel:WORD_1 dst_unused:UNUSED_PRESERVE src0_sel:WORD_1
v_mfma_f32_16x16x32_f16 v[80:83], v[180:183], v[212:215], v[80:83]
ds_read_b128 v[180:183], v251 offset:43008
v_exp_f16_sdwa v109, v109 dst_sel:WORD_1 dst_unused:UNUSED_PRESERVE src0_sel:WORD_1
v_mfma_f32_16x16x32_bf16 v[132:135], v[184:187], v[28:31], 0
ds_read_b128 v[184:187], v249 offset:24576
v_cvt_pkrtz_f16_f32 v105, v104, v105
v_and_b32_e64 v105, s49, v105
v_bfe_u32 v104, v105, 2, 14
v_lshrrev_b32_e64 v105, 18, v105
ds_read_u16 v104, v104
ds_read_u16_d16_hi v105, v105
s_waitcnt lgkmcnt(8)
v_mfma_f32_16x16x32_f16 v[76:79], v[188:191], v[208:211], v[76:79]
v_exp_f16_sdwa v111, v111 dst_sel:WORD_1 dst_unused:UNUSED_PRESERVE src0_sel:WORD_1
v_mfma_f32_16x16x32_bf16 v[124:127], v[168:171], v[32:35], v[124:127]
v_pk_add_f16 v107, v107, 1.0 op_sel_hi:[1,0]
v_mfma_f32_16x16x32_f16 v[84:87], v[188:191], v[212:215], v[84:87]
ds_read_b128 v[188:191], v251 offset:40960
v_pk_add_f16 v109, v109, 1.0 op_sel_hi:[1,0]
v_pk_add_f16 v111, v111, 1.0 op_sel_hi:[1,0]
s_waitcnt lgkmcnt(7)
v_mfma_f32_16x16x32_f16 v[152:155], v[172:175], v[208:211], v[152:155]
v_rcp_f16_sdwa v107, v107 dst_sel:WORD_0 dst_unused:UNUSED_PRESERVE src0_sel:WORD_0
v_mfma_f32_16x16x32_bf16 v[132:135], v[168:171], v[36:39], v[132:135]
ds_read_b128 v[168:171], v249 offset:26624
v_rcp_f16_sdwa v109, v109 dst_sel:WORD_0 dst_unused:UNUSED_PRESERVE src0_sel:WORD_0
v_mfma_f32_16x16x32_f16 v[160:163], v[172:175], v[212:215], v[160:163]
ds_read_b128 v[172:175], v251 offset:44032
v_rcp_f16_sdwa v111, v111 dst_sel:WORD_0 dst_unused:UNUSED_PRESERVE src0_sel:WORD_0
v_mfma_f32_16x16x32_bf16 v[124:127], v[176:179], v[40:43], v[124:127]
s_setprio 0
v_rcp_f16_sdwa v107, v107 dst_sel:WORD_1 dst_unused:UNUSED_PRESERVE src0_sel:WORD_1
s_waitcnt lgkmcnt(5)
v_mfma_f32_16x16x32_f16 v[156:159], v[180:183], v[208:211], v[156:159]
v_rcp_f16_sdwa v109, v109 dst_sel:WORD_1 dst_unused:UNUSED_PRESERVE src0_sel:WORD_1
v_mfma_f32_16x16x32_bf16 v[132:135], v[176:179], v[44:47], v[132:135]
ds_read_b128 v[176:179], v249 offset:28672
v_rcp_f16_sdwa v111, v111 dst_sel:WORD_1 dst_unused:UNUSED_PRESERVE src0_sel:WORD_1
v_mfma_f32_16x16x32_f16 v[164:167], v[180:183], v[212:215], v[164:167]
ds_read_b128 v[180:183], v251 offset:45056
s_getpc_b64 s[74:75]
Lcq13:
s_lshl_b32 s43, s40, 10
s_add_u32 s43, s43, 6144
s_min_u32 s43, s43, Lend-Lcq13-1024
s_add_u32 s74, s74, s43
s_addc_u32 s75, s75, 0
s_sub_u32 s74, s74, 16384
s_subb_u32 s75, s75, 0
s_mov_b32 m0, 163840
s_nop 0
global_load_lds_dword v250, s[74:75]
v_mfma_f32_16x16x32_bf16 v[0:3], v[184:187], v[24:27], 0
v_or_b32 v224, v96, v97
s_waitcnt lgkmcnt(4)
v_mfma_f32_16x16x32_f16 v[136:139], v[188:191], v[208:211], v[136:139]
v_pk_mul_f16 v229, v106, v107
v_mfma_f32_16x16x32_bf16 v[8:11], v[184:187], v[28:31], 0
ds_read_b128 v[184:187], v251 offset:48128
v_pk_mul_f16 v230, v108, v109
v_mfma_f32_16x16x32_f16 v[144:147], v[188:191], v[212:215], v[144:147]
ds_read_b128 v[188:191], v249 offset:24832
v_pk_mul_f16 v231, v110, v111
v_cvt_pkrtz_f16_f32 v121, v120, v121
v_and_b32_e64 v121, s49, v121
v_bfe_u32 v120, v121, 2, 14
v_lshrrev_b32_e64 v121, 18, v121
ds_read_u16 v120, v120
ds_read_u16_d16_hi v121, v121
v_cvt_pk_f16_f32 v130, v130, v131
v_or_b32 v225, v98, v99
s_waitcnt lgkmcnt(6)
v_mfma_f32_16x16x32_bf16 v[0:3], v[168:171], v[32:35], v[0:3]
v_cvt_pk_f16_f32 v132, v132, v133
v_mfma_f32_16x16x32_f16 v[140:143], v[172:175], v[208:211], v[140:143]
v_cvt_pk_f16_f32 v134, v134, v135
v_pk_fma_f16 v131, v130, v130, s48
v_mfma_f32_16x16x32_bf16 v[8:11], v[168:171], v[36:39], v[8:11]
ds_read_b128 v[168:171], v251 offset:46080
v_pk_fma_f16 v133, v132, v132, s48
v_cvt_pkrtz_f16_f32 v123, v122, v123
v_and_b32_e64 v123, s49, v123
v_bfe_u32 v122, v123, 2, 14
v_lshrrev_b32_e64 v123, 18, v123
ds_read_u16 v122, v122
ds_read_u16_d16_hi v123, v123
v_mfma_f32_16x16x32_f16 v[148:151], v[172:175], v[212:215], v[148:151]
ds_read_b128 v[172:175], v249 offset:26880
v_or_b32 v226, v100, v101
v_pk_fma_f16 v135, v134, v134, s48
v_pk_mul_f16 v131, v130, v131
v_pk_mul_f16 v133, v132, v133
s_waitcnt lgkmcnt(6)
v_mfma_f32_16x16x32_bf16 v[0:3], v[176:179], v[40:43], v[0:3]
v_pk_mul_f16 v135, v134, v135
v_mfma_f32_16x16x32_f16 v[72:75], v[180:183], v[232:235], v[72:75]
s_setprio 3
v_cvt_pkrtz_f16_f32 v125, v124, v125
v_and_b32 v125, s49, v125
v_bfe_u32 v124, v125, 2, 14
v_lshrrev_b32 v125, 18, v125
ds_read_u16 v124, v124
ds_read_u16_d16_hi v125, v125
v_or_b32 v227, v102, v103
v_exp_f16_sdwa v131, v131 dst_sel:WORD_0 dst_unused:UNUSED_PRESERVE src0_sel:WORD_0
v_mfma_f32_16x16x32_bf16 v[8:11], v[176:179], v[44:47], v[8:11]
ds_read_b128 v[176:179], v251 offset:49152
v_exp_f16_sdwa v133, v133 dst_sel:WORD_0 dst_unused:UNUSED_PRESERVE src0_sel:WORD_0
v_mfma_f32_16x16x32_f16 v[80:83], v[180:183], v[236:239], v[80:83]
ds_read_b128 v[180:183], v249 offset:28928
v_cvt_pkrtz_f16_f32 v127, v126, v127
v_and_b32_e64 v127, s49, v127
v_bfe_u32 v126, v127, 2, 14
v_lshrrev_b32 v127, 18, v127
ds_read_u16 v126, v126
ds_read_u16_d16_hi v127, v127
v_exp_f16_sdwa v135, v135 dst_sel:WORD_0 dst_unused:UNUSED_PRESERVE src0_sel:WORD_0
v_or_b32 v228, v104, v105
v_mfma_f32_16x16x32_f16 v[76:79], v[184:187], v[232:235], v[76:79]
v_exp_f16_sdwa v131, v131 dst_sel:WORD_1 dst_unused:UNUSED_PRESERVE src0_sel:WORD_1
v_mfma_f32_16x16x32_bf16 v[4:7], v[188:191], v[24:27], 0
v_exp_f16_sdwa v133, v133 dst_sel:WORD_1 dst_unused:UNUSED_PRESERVE src0_sel:WORD_1
v_mfma_f32_16x16x32_f16 v[84:87], v[184:187], v[236:239], v[84:87]
ds_read_b128 v[184:187], v251 offset:47104
v_cvt_pkrtz_f16_f32 v129, v128, v129
v_mfma_f32_16x16x32_bf16 v[12:15], v[188:191], v[28:31], 0
ds_read_b128 v[188:191], v249 offset:30720
v_and_b32_e64 v129, s49, v129
v_bfe_u32 v128, v129, 2, 14
v_lshrrev_b32 v129, 18, v129
ds_read_u16 v128, v128
ds_read_u16_d16_hi v129, v129
v_exp_f16_sdwa v135, v135 dst_sel:WORD_1 dst_unused:UNUSED_PRESERVE src0_sel:WORD_1
s_waitcnt lgkmcnt(7)
v_mfma_f32_16x16x32_f16 v[152:155], v[168:171], v[232:235], v[152:155]
v_pk_add_f16 v131, v131, 1.0 op_sel_hi:[1,0]
v_mfma_f32_16x16x32_bf16 v[4:7], v[172:175], v[32:35], v[4:7]
v_pk_add_f16 v133, v133, 1.0 op_sel_hi:[1,0]
v_mfma_f32_16x16x32_f16 v[160:163], v[168:171], v[236:239], v[160:163]
ds_read_b128 v[168:171], v251 offset:50176
v_pk_add_f16 v135, v135, 1.0 op_sel_hi:[1,0]
v_mfma_f32_16x16x32_bf16 v[12:15], v[172:175], v[36:39], v[12:15]
ds_read_b128 v[172:175], v249 offset:32768
v_rcp_f16_sdwa v131, v131 dst_sel:WORD_0 dst_unused:UNUSED_PRESERVE src0_sel:WORD_0
v_mfma_f32_16x16x32_f16 v[156:159], v[176:179], v[232:235], v[156:159]
v_rcp_f16_sdwa v133, v133 dst_sel:WORD_0 dst_unused:UNUSED_PRESERVE src0_sel:WORD_0
s_waitcnt lgkmcnt(6)
v_mfma_f32_16x16x32_bf16 v[4:7], v[180:183], v[40:43], v[4:7]
s_setprio 2
v_rcp_f16_sdwa v135, v135 dst_sel:WORD_0 dst_unused:UNUSED_PRESERVE src0_sel:WORD_0
v_mfma_f32_16x16x32_f16 v[164:167], v[176:179], v[236:239], v[164:167]
ds_read_b128 v[176:179], v251 offset:51200
v_rcp_f16_sdwa v131, v131 dst_sel:WORD_1 dst_unused:UNUSED_PRESERVE src0_sel:WORD_1
v_mfma_f32_16x16x32_bf16 v[12:15], v[180:183], v[44:47], v[12:15]
ds_read_b128 v[180:183], v249 offset:34816
v_rcp_f16_sdwa v133, v133 dst_sel:WORD_1 dst_unused:UNUSED_PRESERVE src0_sel:WORD_1
s_waitcnt lgkmcnt(5)
v_mfma_f32_16x16x32_f16 v[136:139], v[184:187], v[232:235], v[136:139]
s_waitcnt vmcnt(18)
v_permlane16_swap_b32 v48, v52
v_mfma_f32_16x16x32_bf16 v[96:99], v[188:191], v[24:27], 0
v_permlane16_swap_b32 v49, v53
v_permlane16_swap_b32 v50, v54
v_permlane16_swap_b32 v51, v55
s_waitcnt vmcnt(16)
v_permlane16_swap_b32 v56, v60
v_permlane16_swap_b32 v57, v61
v_permlane16_swap_b32 v58, v62
v_permlane16_swap_b32 v59, v63
s_waitcnt vmcnt(13)
v_permlane16_swap_b32 v64, v68
v_permlane16_swap_b32 v65, v69
v_permlane16_swap_b32 v66, v70
v_permlane16_swap_b32 v67, v71
v_mfma_f32_16x16x32_f16 v[144:147], v[184:187], v[236:239], v[144:147]
ds_read_b128 v[184:187], v251 offset:54272
v_rcp_f16_sdwa v135, v135 dst_sel:WORD_1 dst_unused:UNUSED_PRESERVE src0_sel:WORD_1
v_or_b32 v200, v120, v121
v_pk_mul_f16 v205, v130, v131
v_mfma_f32_16x16x32_bf16 v[104:107], v[188:191], v[28:31], 0
ds_read_b128 v[188:191], v249 offset:30976
v_pk_mul_f16 v206, v132, v133
s_waitcnt lgkmcnt(2)
v_mfma_f32_16x16x32_f16 v[140:143], v[168:171], v[232:235], v[140:143]
v_pk_mul_f16 v207, v134, v135
v_cvt_pkrtz_f16_f32 v1, v0, v1
v_and_b32_e64 v1, s49, v1
v_bfe_u32 v0, v1, 2, 14
v_lshrrev_b32 v1, 18, v1
ds_read_u16 v0, v0
ds_read_u16_d16_hi v1, v1
v_cvt_pk_f16_f32 v10, v10, v11
v_or_b32 v201, v122, v123
v_mfma_f32_16x16x32_f16 v[148:151], v[168:171], v[236:239], v[148:151]
ds_read_b128 v[168:171], v251 offset:52224
v_cvt_pk_f16_f32 v12, v12, v13
v_mfma_f32_16x16x32_bf16 v[96:99], v[172:175], v[32:35], v[96:99]
v_cvt_pk_f16_f32 v14, v14, v15
v_pk_fma_f16 v11, v10, v10, s48
v_mfma_f32_16x16x32_f16 v[72:75], v[176:179], v[88:91], v[72:75]
v_pk_fma_f16 v13, v12, v12, s48
v_mfma_f32_16x16x32_bf16 v[104:107], v[172:175], v[36:39], v[104:107]
ds_read_b128 v[172:175], v249 offset:33024
v_cvt_pkrtz_f16_f32 v3, v2, v3
v_and_b32_e64 v3, s49, v3
v_bfe_u32 v2, v3, 2, 14
v_lshrrev_b32 v3, 18, v3
ds_read_u16 v2, v2
ds_read_u16_d16_hi v3, v3
v_or_b32 v202, v124, v125
v_pk_fma_f16 v15, v14, v14, s48
v_pk_mul_f16 v11, v10, v11
v_mfma_f32_16x16x32_f16 v[80:83], v[176:179], v[92:95], v[80:83]
ds_read_b128 v[176:179], v251 offset:55296
v_pk_mul_f16 v13, v12, v13
v_mfma_f32_16x16x32_bf16 v[96:99], v[180:183], v[40:43], v[96:99]
v_pk_mul_f16 v15, v14, v15
s_setprio 1
v_cvt_pkrtz_f16_f32 v5, v4, v5
v_and_b32 v5, s49, v5
v_bfe_u32 v4, v5, 2, 14
v_lshrrev_b32_e64 v5, 18, v5
ds_read_u16 v4, v4
ds_read_u16_d16_hi v5, v5
v_or_b32 v203, v126, v127
v_exp_f16_sdwa v11, v11 dst_sel:WORD_0 dst_unused:UNUSED_PRESERVE src0_sel:WORD_0
s_waitcnt lgkmcnt(6)
v_mfma_f32_16x16x32_f16 v[76:79], v[184:187], v[88:91], v[76:79]
v_exp_f16_sdwa v13, v13 dst_sel:WORD_0 dst_unused:UNUSED_PRESERVE src0_sel:WORD_0
v_mfma_f32_16x16x32_bf16 v[104:107], v[180:183], v[44:47], v[104:107]
ds_read_b128 v[180:183], v249 offset:35072
v_cvt_pkrtz_f16_f32 v7, v6, v7
v_mfma_f32_16x16x32_f16 v[84:87], v[184:187], v[92:95], v[84:87]
ds_read_b128 v[184:187], v251 offset:53248
v_and_b32_e64 v7, s49, v7
v_bfe_u32 v6, v7, 2, 14
v_lshrrev_b32 v7, 18, v7
ds_read_u16 v6, v6
ds_read_u16_d16_hi v7, v7
v_exp_f16_sdwa v15, v15 dst_sel:WORD_0 dst_unused:UNUSED_PRESERVE src0_sel:WORD_0
v_or_b32 v204, v128, v129
v_mfma_f32_16x16x32_bf16 v[100:103], v[188:191], v[24:27], 0
v_exp_f16_sdwa v11, v11 dst_sel:WORD_1 dst_unused:UNUSED_PRESERVE src0_sel:WORD_1
v_mfma_f32_16x16x32_f16 v[152:155], v[168:171], v[88:91], v[152:155]
v_exp_f16_sdwa v13, v13 dst_sel:WORD_1 dst_unused:UNUSED_PRESERVE src0_sel:WORD_1
v_mfma_f32_16x16x32_bf16 v[108:111], v[188:191], v[28:31], 0
ds_read_b128 v[188:191], v251 offset:56320
v_cvt_pkrtz_f16_f32 v9, v8, v9
v_and_b32_e64 v9, s49, v9
v_bfe_u32 v8, v9, 2, 14
v_lshrrev_b32 v9, 18, v9
ds_read_u16 v8, v8
ds_read_u16_d16_hi v9, v9
v_mfma_f32_16x16x32_f16 v[160:163], v[168:171], v[92:95], v[160:163]
ds_read_b128 v[168:171], v248
v_exp_f16_sdwa v15, v15 dst_sel:WORD_1 dst_unused:UNUSED_PRESERVE src0_sel:WORD_1
s_waitcnt lgkmcnt(7)
v_mfma_f32_16x16x32_bf16 v[100:103], v[172:175], v[32:35], v[100:103]
v_pk_add_f16 v11, v11, 1.0 op_sel_hi:[1,0]
v_mfma_f32_16x16x32_f16 v[156:159], v[176:179], v[88:91], v[156:159]
v_pk_add_f16 v13, v13, 1.0 op_sel_hi:[1,0]
v_pk_add_f16 v15, v15, 1.0 op_sel_hi:[1,0]
v_mfma_f32_16x16x32_bf16 v[108:111], v[172:175], v[36:39], v[108:111]
ds_read_b128 v[172:175], v251 offset:57344
v_rcp_f16_sdwa v11, v11 dst_sel:WORD_0 dst_unused:UNUSED_PRESERVE src0_sel:WORD_0
v_mfma_f32_16x16x32_f16 v[164:167], v[176:179], v[92:95], v[164:167]
ds_read_b128 v[176:179], v248 offset:2048
v_rcp_f16_sdwa v13, v13 dst_sel:WORD_0 dst_unused:UNUSED_PRESERVE src0_sel:WORD_0
v_mfma_f32_16x16x32_bf16 v[100:103], v[180:183], v[40:43], v[100:103]
v_rcp_f16_sdwa v15, v15 dst_sel:WORD_0 dst_unused:UNUSED_PRESERVE src0_sel:WORD_0
s_waitcnt lgkmcnt(6)
v_mfma_f32_16x16x32_f16 v[136:139], v[184:187], v[88:91], v[136:139]
s_setprio 0
v_rcp_f16_sdwa v11, v11 dst_sel:WORD_1 dst_unused:UNUSED_PRESERVE src0_sel:WORD_1
v_mfma_f32_16x16x32_f16 v[144:147], v[184:187], v[92:95], v[144:147]
ds_read_b128 v[184:187], v248 offset:4096
v_rcp_f16_sdwa v13, v13 dst_sel:WORD_1 dst_unused:UNUSED_PRESERVE src0_sel:WORD_1
v_mfma_f32_16x16x32_bf16 v[108:111], v[180:183], v[44:47], v[108:111]
ds_read_b128 v[180:183], v251 offset:60416
v_rcp_f16_sdwa v15, v15 dst_sel:WORD_1 dst_unused:UNUSED_PRESERVE src0_sel:WORD_1
s_waitcnt lgkmcnt(6)
v_mfma_f32_16x16x32_f16 v[140:143], v[188:191], v[88:91], v[140:143]
v_or_b32 v216, v0, v1
s_waitcnt lgkmcnt(4)
v_mfma_f32_16x16x32_bf16 v[120:123], v[168:171], v[48:51], 0
v_pk_mul_f16 v221, v10, v11
v_mfma_f32_16x16x32_f16 v[148:151], v[188:191], v[92:95], v[148:151]
ds_read_b128 v[188:191], v251 offset:58368
v_pk_mul_f16 v222, v12, v13
v_mfma_f32_16x16x32_bf16 v[128:131], v[168:171], v[52:55], 0
ds_read_b128 v[168:171], v248 offset:256
v_pk_mul_f16 v223, v14, v15
s_waitcnt lgkmcnt(4)
v_mfma_f32_16x16x32_f16 v[72:75], v[172:175], v[224:227], v[72:75]
v_cvt_pkrtz_f16_f32 v97, v96, v97
v_and_b32_e64 v97, s49, v97
v_bfe_u32 v96, v97, 2, 14
v_lshrrev_b32 v97, 18, v97
ds_read_u16 v96, v96
ds_read_u16_d16_hi v97, v97
v_cvt_pk_f16_f32 v106, v106, v107
v_or_b32 v217, v2, v3
v_mfma_f32_16x16x32_bf16 v[120:123], v[176:179], v[56:59], v[120:123]
v_cvt_pk_f16_f32 v108, v108, v109
v_cvt_pk_f16_f32 v110, v110, v111
v_mfma_f32_16x16x32_f16 v[80:83], v[172:175], v[228:231], v[80:83]
ds_read_b128 v[172:175], v251 offset:61440
v_pk_fma_f16 v107, v106, v106, s48
v_mfma_f32_16x16x32_bf16 v[128:131], v[176:179], v[60:63], v[128:131]
ds_read_b128 v[176:179], v248 offset:2304
v_pk_fma_f16 v109, v108, v108, s48
v_cvt_pkrtz_f16_f32 v99, v98, v99
v_and_b32_e64 v99, s49, v99
v_bfe_u32 v98, v99, 2, 14
v_lshrrev_b32_e64 v99, 18, v99
ds_read_u16 v98, v98
ds_read_u16_d16_hi v99, v99
v_or_b32 v218, v4, v5
v_pk_fma_f16 v111, v110, v110, s48
s_waitcnt lgkmcnt(6)
v_mfma_f32_16x16x32_f16 v[76:79], v[180:183], v[224:227], v[76:79]
v_pk_mul_f16 v107, v106, v107
v_pk_mul_f16 v109, v108, v109
v_mfma_f32_16x16x32_bf16 v[120:123], v[184:187], v[64:67], v[120:123]
v_pk_mul_f16 v111, v110, v111
v_mfma_f32_16x16x32_f16 v[84:87], v[180:183], v[228:231], v[84:87]
ds_read_b128 v[180:183], v251 offset:59392
v_cvt_pkrtz_f16_f32 v101, v100, v101
v_and_b32_e64 v101, s49, v101
v_bfe_u32 v100, v101, 2, 14
v_lshrrev_b32_e64 v101, 18, v101
ds_read_u16 v100, v100
ds_read_u16_d16_hi v101, v101
s_setprio 3
v_or_b32 v219, v6, v7
v_exp_f16_sdwa v107, v107 dst_sel:WORD_0 dst_unused:UNUSED_PRESERVE src0_sel:WORD_0
v_mfma_f32_16x16x32_bf16 v[128:131], v[184:187], v[68:71], v[128:131]
ds_read_b128 v[184:187], v248 offset:4352
v_exp_f16_sdwa v109, v109 dst_sel:WORD_0 dst_unused:UNUSED_PRESERVE src0_sel:WORD_0
v_mfma_f32_16x16x32_f16 v[152:155], v[188:191], v[224:227], v[152:155]
v_cvt_pkrtz_f16_f32 v103, v102, v103
v_and_b32_e64 v103, s49, v103
v_bfe_u32 v102, v103, 2, 14
v_lshrrev_b32_e64 v103, 18, v103
ds_read_u16 v102, v102
ds_read_u16_d16_hi v103, v103
v_exp_f16_sdwa v111, v111 dst_sel:WORD_0 dst_unused:UNUSED_PRESERVE src0_sel:WORD_0
v_or_b32 v220, v8, v9
v_mfma_f32_16x16x32_bf16 v[124:127], v[168:171], v[48:51], 0
v_mov_b32 v16, 0
v_mfma_f32_16x16x32_f16 v[160:163], v[188:191], v[228:231], v[160:163]
ds_read_b128 v[188:191], v251 offset:62464
v_mov_b32_e64 v17, 0
v_cndmask_b32 v18, 0, v255, s[88:89]
v_cndmask_b32 v19, 0, v255, s[90:91]
v_mov_b32 v20, 0
v_mov_b32 v21, 0
v_exp_f16_sdwa v107, v107 dst_sel:WORD_1 dst_unused:UNUSED_PRESERVE src0_sel:WORD_1
v_mfma_f32_16x16x32_bf16 v[132:135], v[168:171], v[52:55], 0
ds_read_b128 v[168:171], v248 offset:6144
v_exp_f16_sdwa v109, v109 dst_sel:WORD_1 dst_unused:UNUSED_PRESERVE src0_sel:WORD_1
s_waitcnt lgkmcnt(6)
v_mfma_f32_16x16x32_f16 v[156:159], v[172:175], v[224:227], v[156:159]
v_cvt_pkrtz_f16_f32 v105, v104, v105
v_and_b32 v105, s49, v105
v_bfe_u32 v104, v105, 2, 14
v_lshrrev_b32_e64 v105, 18, v105
ds_read_u16 v104, v104
ds_read_u16_d16_hi v105, v105
v_exp_f16_sdwa v111, v111 dst_sel:WORD_1 dst_unused:UNUSED_PRESERVE src0_sel:WORD_1
v_mfma_f32_16x16x32_f16 v[164:167], v[172:175], v[228:231], v[164:167]
ds_read_b128 v[172:175], v251 offset:63488
v_pk_add_f16 v107, v107, 1.0 op_sel_hi:[1,0]
v_mfma_f32_16x16x32_bf16 v[124:127], v[176:179], v[56:59], v[124:127]
v_pk_add_f16 v109, v109, 1.0 op_sel_hi:[1,0]
v_mfma_f32_16x16x32_f16 v[136:139], v[180:183], v[224:227], v[136:139]
v_pk_add_f16 v111, v111, 1.0 op_sel_hi:[1,0]
v_mfma_f32_16x16x32_bf16 v[132:135], v[176:179], v[60:63], v[132:135]
ds_read_b128 v[176:179], v248 offset:8192
v_rcp_f16_sdwa v107, v107 dst_sel:WORD_0 dst_unused:UNUSED_PRESERVE src0_sel:WORD_0
v_mfma_f32_16x16x32_f16 v[144:147], v[180:183], v[228:231], v[144:147]
ds_read_b128 v[180:183], v252 offset:1024
v_rcp_f16_sdwa v109, v109 dst_sel:WORD_0 dst_unused:UNUSED_PRESERVE src0_sel:WORD_0
s_waitcnt lgkmcnt(5)
v_mfma_f32_16x16x32_bf16 v[124:127], v[184:187], v[64:67], v[124:127]
v_rcp_f16_sdwa v111, v111 dst_sel:WORD_0 dst_unused:UNUSED_PRESERVE src0_sel:WORD_0
v_mfma_f32_16x16x32_f16 v[140:143], v[188:191], v[224:227], v[140:143]
s_setprio 2
v_rcp_f16_sdwa v107, v107 dst_sel:WORD_1 dst_unused:UNUSED_PRESERVE src0_sel:WORD_1
v_mfma_f32_16x16x32_bf16 v[132:135], v[184:187], v[68:71], v[132:135]
ds_read_b128 v[184:187], v248 offset:10240
v_rcp_f16_sdwa v109, v109 dst_sel:WORD_1 dst_unused:UNUSED_PRESERVE src0_sel:WORD_1
v_mfma_f32_16x16x32_f16 v[148:151], v[188:191], v[228:231], v[148:151]
ds_read_b128 v[188:191], v251 offset:64512
v_rcp_f16_sdwa v111, v111 dst_sel:WORD_1 dst_unused:UNUSED_PRESERVE src0_sel:WORD_1
v_mfma_f32_16x16x32_bf16 v[0:3], v[168:171], v[48:51], 0
v_or_b32 v208, v96, v97
s_waitcnt vmcnt(9)
v_mfma_f32_16x16x32_bf16 v[72:75], v[18:21], v[192:195], v[72:75]
v_pk_mul_f16 v213, v106, v107
v_mfma_f32_16x16x32_bf16 v[76:79], v[16:19], v[192:195], v[76:79]
v_pk_mul_f16 v214, v108, v109
s_waitcnt vmcnt(7)
v_mfma_f32_16x16x32_bf16 v[80:83], v[18:21], v[196:199], v[80:83]
v_pk_mul_f16 v215, v110, v111
v_mfma_f32_16x16x32_bf16 v[84:87], v[16:19], v[196:199], v[84:87]
v_cvt_pkrtz_f16_f32 v121, v120, v121
s_waitcnt lgkmcnt(2)
v_mfma_f32_16x16x32_f16 v[72:75], v[172:175], v[200:203], v[72:75]
v_and_b32_e64 v121, s49, v121
v_mfma_f32_16x16x32_bf16 v[8:11], v[168:171], v[52:55], 0
ds_read_b128 v[168:171], v252 offset:2048
v_bfe_u32 v120, v121, 2, 14
v_mfma_f32_16x16x32_f16 v[80:83], v[172:175], v[204:207], v[80:83]
ds_read_b128 v[172:175], v248 offset:6400
v_lshrrev_b32 v121, 18, v121
ds_read_u16 v120, v120
ds_read_u16_d16_hi v121, v121
v_cvt_pk_f16_f32 v130, v130, v131
v_or_b32 v209, v98, v99
v_mfma_f32_16x16x32_bf16 v[0:3], v[176:179], v[56:59], v[0:3]
v_cvt_pk_f16_f32 v132, v132, v133
v_mfma_f32_16x16x32_f16 v[76:79], v[180:183], v[200:203], v[76:79]
v_cvt_pk_f16_f32 v134, v134, v135
v_pk_fma_f16 v131, v130, v130, s48
v_mfma_f32_16x16x32_bf16 v[8:11], v[176:179], v[60:63], v[8:11]
ds_read_b128 v[176:179], v252
v_pk_fma_f16 v133, v132, v132, s48
v_cvt_pkrtz_f16_f32 v123, v122, v123
v_and_b32_e64 v123, s49, v123
v_bfe_u32 v122, v123, 2, 14
v_lshrrev_b32_e64 v123, 18, v123
ds_read_u16 v122, v122
ds_read_u16_d16_hi v123, v123
v_mfma_f32_16x16x32_f16 v[84:87], v[180:183], v[204:207], v[84:87]
ds_read_b128 v[180:183], v248 offset:8448
v_or_b32 v210, v100, v101
v_pk_fma_f16 v135, v134, v134, s48
v_pk_mul_f16 v131, v130, v131
v_pk_mul_f16 v133, v132, v133
s_waitcnt lgkmcnt(6)
v_mfma_f32_16x16x32_bf16 v[0:3], v[184:187], v[64:67], v[0:3]
v_pk_mul_f16 v135, v134, v135
v_mfma_f32_16x16x32_f16 v[152:155], v[188:191], v[200:203], v[152:155]
v_cvt_pkrtz_f16_f32 v125, v124, v125
v_and_b32_e64 v125, s49, v125
v_bfe_u32 v124, v125, 2, 14
v_lshrrev_b32_e64 v125, 18, v125
ds_read_u16 v124, v124
ds_read_u16_d16_hi v125, v125
v_or_b32 v211, v102, v103
v_exp_f16_sdwa v131, v131 dst_sel:WORD_0 dst_unused:UNUSED_PRESERVE src0_sel:WORD_0
s_setprio 1
v_mfma_f32_16x16x32_f16 v[160:163], v[188:191], v[204:207], v[160:163]
ds_read_b128 v[188:191], v248 offset:10496
v_exp_f16_sdwa v133, v133 dst_sel:WORD_0 dst_unused:UNUSED_PRESERVE src0_sel:WORD_0
v_mfma_f32_16x16x32_bf16 v[8:11], v[184:187], v[68:71], v[8:11]
ds_read_b128 v[184:187], v252 offset:3072
v_cvt_pkrtz_f16_f32 v127, v126, v127
v_and_b32_e64 v127, s49, v127
v_bfe_u32 v126, v127, 2, 14
v_lshrrev_b32 v127, 18, v127
ds_read_u16 v126, v126
ds_read_u16_d16_hi v127, v127
v_exp_f16_sdwa v135, v135 dst_sel:WORD_0 dst_unused:UNUSED_PRESERVE src0_sel:WORD_0
v_mfma_f32_16x16x32_f16 v[156:159], v[168:171], v[200:203], v[156:159]
v_or_b32 v212, v104, v105
v_mfma_f32_16x16x32_bf16 v[4:7], v[172:175], v[48:51], 0
v_exp_f16_sdwa v131, v131 dst_sel:WORD_1 dst_unused:UNUSED_PRESERVE src0_sel:WORD_1
v_mfma_f32_16x16x32_f16 v[164:167], v[168:171], v[204:207], v[164:167]
ds_read_b128 v[168:171], v252 offset:4096
v_exp_f16_sdwa v133, v133 dst_sel:WORD_1 dst_unused:UNUSED_PRESERVE src0_sel:WORD_1
v_mfma_f32_16x16x32_bf16 v[12:15], v[172:175], v[52:55], 0
ds_read_b128 v[172:175], v248 offset:12288
v_cvt_pkrtz_f16_f32 v129, v128, v129
v_and_b32_e64 v129, s49, v129
v_bfe_u32 v128, v129, 2, 14
v_lshrrev_b32 v129, 18, v129
ds_read_u16 v128, v128
ds_read_u16_d16_hi v129, v129
s_waitcnt lgkmcnt(8)
v_mfma_f32_16x16x32_f16 v[136:139], v[176:179], v[200:203], v[136:139]
v_exp_f16_sdwa v135, v135 dst_sel:WORD_1 dst_unused:UNUSED_PRESERVE src0_sel:WORD_1
v_mfma_f32_16x16x32_bf16 v[4:7], v[180:183], v[56:59], v[4:7]
v_pk_add_f16 v131, v131, 1.0 op_sel_hi:[1,0]
v_mfma_f32_16x16x32_f16 v[144:147], v[176:179], v[204:207], v[144:147]
ds_read_b128 v[176:179], v252 offset:7168
v_pk_add_f16 v133, v133, 1.0 op_sel_hi:[1,0]
v_pk_add_f16 v135, v135, 1.0 op_sel_hi:[1,0]
v_mfma_f32_16x16x32_bf16 v[12:15], v[180:183], v[60:63], v[12:15]
ds_read_b128 v[180:183], v248 offset:14336
v_rcp_f16_sdwa v131, v131 dst_sel:WORD_0 dst_unused:UNUSED_PRESERVE src0_sel:WORD_0
s_waitcnt lgkmcnt(7)
v_mfma_f32_16x16x32_f16 v[140:143], v[184:187], v[200:203], v[140:143]
v_rcp_f16_sdwa v133, v133 dst_sel:WORD_0 dst_unused:UNUSED_PRESERVE src0_sel:WORD_0
v_mfma_f32_16x16x32_bf16 v[4:7], v[188:191], v[64:67], v[4:7]
v_rcp_f16_sdwa v135, v135 dst_sel:WORD_0 dst_unused:UNUSED_PRESERVE src0_sel:WORD_0
v_mfma_f32_16x16x32_f16 v[148:151], v[184:187], v[204:207], v[148:151]
ds_read_b128 v[184:187], v252 offset:5120
s_setprio 0
v_mfma_f32_16x16x32_bf16 v[12:15], v[188:191], v[68:71], v[12:15]
ds_read_b128 v[188:191], v248 offset:16384
v_rcp_f16_sdwa v131, v131 dst_sel:WORD_1 dst_unused:UNUSED_PRESERVE src0_sel:WORD_1
s_waitcnt vmcnt(6)
v_mfma_f32_16x16x32_bf16 v[152:155], v[18:21], v[240:243], v[152:155]
v_rcp_f16_sdwa v133, v133 dst_sel:WORD_1 dst_unused:UNUSED_PRESERVE src0_sel:WORD_1
v_mfma_f32_16x16x32_bf16 v[156:159], v[16:19], v[240:243], v[156:159]
v_rcp_f16_sdwa v135, v135 dst_sel:WORD_1 dst_unused:UNUSED_PRESERVE src0_sel:WORD_1
s_waitcnt vmcnt(4)
v_mfma_f32_16x16x32_bf16 v[160:163], v[18:21], v[244:247], v[160:163]
v_or_b32 v232, v120, v121
v_mfma_f32_16x16x32_bf16 v[164:167], v[16:19], v[244:247], v[164:167]
v_pk_mul_f16 v237, v130, v131
s_waitcnt lgkmcnt(3)
v_mfma_f32_16x16x32_f16 v[72:75], v[168:171], v[216:219], v[72:75]
v_pk_mul_f16 v238, v132, v133
v_mfma_f32_16x16x32_bf16 v[96:99], v[172:175], v[48:51], 0
v_pk_mul_f16 v239, v134, v135
v_mfma_f32_16x16x32_f16 v[80:83], v[168:171], v[220:223], v[80:83]
ds_read_b128 v[168:171], v252 offset:8192
v_cvt_pkrtz_f16_f32 v1, v0, v1
v_mfma_f32_16x16x32_f16 v[76:79], v[176:179], v[216:219], v[76:79]
v_and_b32_e64 v1, s49, v1
v_mfma_f32_16x16x32_bf16 v[104:107], v[172:175], v[52:55], 0
ds_read_b128 v[172:175], v248 offset:12544
v_bfe_u32 v0, v1, 2, 14
v_lshrrev_b32_e64 v1, 18, v1
ds_read_u16 v0, v0
ds_read_u16_d16_hi v1, v1
v_cvt_pk_f16_f32 v10, v10, v11
v_mfma_f32_16x16x32_f16 v[84:87], v[176:179], v[220:223], v[84:87]
ds_read_b128 v[176:179], v252 offset:6144
v_or_b32 v233, v122, v123
s_waitcnt lgkmcnt(5)
v_mfma_f32_16x16x32_bf16 v[96:99], v[180:183], v[56:59], v[96:99]
v_cvt_pk_f16_f32 v12, v12, v13
v_cvt_pk_f16_f32 v14, v14, v15
v_pk_fma_f16 v11, v10, v10, s48
v_mfma_f32_16x16x32_f16 v[152:155], v[184:187], v[216:219], v[152:155]
v_pk_fma_f16 v13, v12, v12, s48
v_mfma_f32_16x16x32_bf16 v[104:107], v[180:183], v[60:63], v[104:107]
ds_read_b128 v[180:183], v248 offset:14592
v_cvt_pkrtz_f16_f32 v3, v2, v3
v_and_b32_e64 v3, s49, v3
v_bfe_u32 v2, v3, 2, 14
v_lshrrev_b32 v3, 18, v3
ds_read_u16 v2, v2
ds_read_u16_d16_hi v3, v3
v_or_b32 v234, v124, v125
v_pk_fma_f16 v15, v14, v14, s48
v_pk_mul_f16 v11, v10, v11
v_mfma_f32_16x16x32_f16 v[160:163], v[184:187], v[220:223], v[160:163]
ds_read_b128 v[184:187], v252 offset:9216
v_pk_mul_f16 v13, v12, v13
v_mfma_f32_16x16x32_bf16 v[96:99], v[188:191], v[64:67], v[96:99]
v_pk_mul_f16 v15, v14, v15
v_cvt_pkrtz_f16_f32 v5, v4, v5
v_and_b32_e64 v5, s49, v5
v_bfe_u32 v4, v5, 2, 14
v_lshrrev_b32 v5, 18, v5
ds_read_u16 v4, v4
ds_read_u16_d16_hi v5, v5
v_or_b32 v235, v126, v127
v_exp_f16_sdwa v11, v11 dst_sel:WORD_0 dst_unused:UNUSED_PRESERVE src0_sel:WORD_0
s_waitcnt lgkmcnt(7)
v_mfma_f32_16x16x32_f16 v[156:159], v[168:171], v[216:219], v[156:159]
s_setprio 3
v_exp_f16_sdwa v13, v13 dst_sel:WORD_0 dst_unused:UNUSED_PRESERVE src0_sel:WORD_0
v_mfma_f32_16x16x32_bf16 v[104:107], v[188:191], v[68:71], v[104:107]
ds_read_b128 v[188:191], v252 offset:10240
v_cvt_pkrtz_f16_f32 v7, v6, v7
v_mfma_f32_16x16x32_f16 v[164:167], v[168:171], v[220:223], v[164:167]
ds_read_b128 v[168:171], v248 offset:16640
v_and_b32_e64 v7, s49, v7
v_bfe_u32 v6, v7, 2, 14
v_lshrrev_b32_e64 v7, 18, v7
ds_read_u16 v6, v6
ds_read_u16_d16_hi v7, v7
v_exp_f16_sdwa v15, v15 dst_sel:WORD_0 dst_unused:UNUSED_PRESERVE src0_sel:WORD_0
v_or_b32 v236, v128, v129
v_mfma_f32_16x16x32_bf16 v[100:103], v[172:175], v[48:51], 0
v_exp_f16_sdwa v11, v11 dst_sel:WORD_1 dst_unused:UNUSED_PRESERVE src0_sel:WORD_1
s_waitcnt lgkmcnt(7)
v_mfma_f32_16x16x32_f16 v[136:139], v[176:179], v[216:219], v[136:139]
v_exp_f16_sdwa v13, v13 dst_sel:WORD_1 dst_unused:UNUSED_PRESERVE src0_sel:WORD_1
v_mfma_f32_16x16x32_bf16 v[108:111], v[172:175], v[52:55], 0
ds_read_b128 v[172:175], v252 offset:13312
v_cvt_pkrtz_f16_f32 v9, v8, v9
v_and_b32_e64 v9, s49, v9
v_bfe_u32 v8, v9, 2, 14
v_lshrrev_b32 v9, 18, v9
ds_read_u16 v8, v8
ds_read_u16_d16_hi v9, v9
v_mfma_f32_16x16x32_f16 v[144:147], v[176:179], v[220:223], v[144:147]
ds_read_b128 v[176:179], v248 offset:18432
v_exp_f16_sdwa v15, v15 dst_sel:WORD_1 dst_unused:UNUSED_PRESERVE src0_sel:WORD_1
v_mfma_f32_16x16x32_bf16 v[100:103], v[180:183], v[56:59], v[100:103]
v_pk_add_f16 v11, v11, 1.0 op_sel_hi:[1,0]
s_waitcnt lgkmcnt(7)
v_mfma_f32_16x16x32_f16 v[140:143], v[184:187], v[216:219], v[140:143]
v_pk_add_f16 v13, v13, 1.0 op_sel_hi:[1,0]
v_pk_add_f16 v15, v15, 1.0 op_sel_hi:[1,0]
v_mfma_f32_16x16x32_bf16 v[108:111], v[180:183], v[60:63], v[108:111]
ds_read_b128 v[180:183], v252 offset:11264
v_rcp_f16_sdwa v11, v11 dst_sel:WORD_0 dst_unused:UNUSED_PRESERVE src0_sel:WORD_0
v_mfma_f32_16x16x32_f16 v[148:151], v[184:187], v[220:223], v[148:151]
ds_read_b128 v[184:187], v248 offset:20480
v_rcp_f16_sdwa v13, v13 dst_sel:WORD_0 dst_unused:UNUSED_PRESERVE src0_sel:WORD_0
s_waitcnt vmcnt(3)
v_mfma_f32_16x16x32_bf16 v[136:139], v[18:21], v[112:115], v[136:139]
v_rcp_f16_sdwa v15, v15 dst_sel:WORD_0 dst_unused:UNUSED_PRESERVE src0_sel:WORD_0
v_mfma_f32_16x16x32_bf16 v[140:143], v[16:19], v[112:115], v[140:143]
v_rcp_f16_sdwa v11, v11 dst_sel:WORD_1 dst_unused:UNUSED_PRESERVE src0_sel:WORD_1
s_waitcnt vmcnt(1)
v_mfma_f32_16x16x32_bf16 v[144:147], v[18:21], v[116:119], v[144:147]
v_rcp_f16_sdwa v13, v13 dst_sel:WORD_1 dst_unused:UNUSED_PRESERVE src0_sel:WORD_1
v_mfma_f32_16x16x32_bf16 v[148:151], v[16:19], v[116:119], v[148:151]
v_rcp_f16_sdwa v15, v15 dst_sel:WORD_1 dst_unused:UNUSED_PRESERVE src0_sel:WORD_1
v_mfma_f32_16x16x32_f16 v[72:75], v[188:191], v[208:211], v[72:75]
v_or_b32 v24, v0, v1
s_waitcnt lgkmcnt(4)
v_mfma_f32_16x16x32_bf16 v[100:103], v[168:171], v[64:67], v[100:103]
v_pk_mul_f16 v29, v10, v11
v_mfma_f32_16x16x32_f16 v[80:83], v[188:191], v[212:215], v[80:83]
ds_read_b128 v[188:191], v252 offset:14336
v_pk_mul_f16 v30, v12, v13
v_mfma_f32_16x16x32_bf16 v[108:111], v[168:171], v[68:71], v[108:111]
ds_read_b128 v[168:171], v248 offset:22528
s_setprio 2
v_mfma_f32_16x16x32_f16 v[76:79], v[172:175], v[208:211], v[76:79]
v_pk_mul_f16 v31, v14, v15
s_waitcnt lgkmcnt(2)
v_mfma_f32_16x16x32_bf16 v[120:123], v[176:179], v[48:51], 0
v_cvt_pkrtz_f16_f32 v97, v96, v97
v_mfma_f32_16x16x32_f16 v[84:87], v[172:175], v[212:215], v[84:87]
ds_read_b128 v[172:175], v252 offset:12288
v_and_b32_e64 v97, s49, v97
v_mfma_f32_16x16x32_bf16 v[128:131], v[176:179], v[52:55], 0
ds_read_b128 v[176:179], v248 offset:18688
v_bfe_u32 v96, v97, 2, 14
v_mfma_f32_16x16x32_f16 v[152:155], v[180:183], v[208:211], v[152:155]
v_lshrrev_b32 v97, 18, v97
ds_read_u16 v96, v96
ds_read_u16_d16_hi v97, v97
v_cvt_pk_f16_f32 v106, v106, v107
v_or_b32 v25, v2, v3
v_mfma_f32_16x16x32_bf16 v[120:123], v[184:187], v[56:59], v[120:123]
v_cvt_pk_f16_f32 v108, v108, v109
v_cvt_pk_f16_f32 v110, v110, v111
v_mfma_f32_16x16x32_f16 v[160:163], v[180:183], v[212:215], v[160:163]
ds_read_b128 v[180:183], v252 offset:15360
v_pk_fma_f16 v107, v106, v106, s48
v_mfma_f32_16x16x32_bf16 v[128:131], v[184:187], v[60:63], v[128:131]
ds_read_b128 v[184:187], v248 offset:20736
v_pk_fma_f16 v109, v108, v108, s48
v_cvt_pkrtz_f16_f32 v99, v98, v99
v_and_b32_e64 v99, s49, v99
v_bfe_u32 v98, v99, 2, 14
v_lshrrev_b32_e64 v99, 18, v99
ds_read_u16 v98, v98
ds_read_u16_d16_hi v99, v99
v_or_b32 v26, v4, v5
v_pk_fma_f16 v111, v110, v110, s48
s_waitcnt lgkmcnt(7)
v_mfma_f32_16x16x32_f16 v[156:159], v[188:191], v[208:211], v[156:159]
v_pk_mul_f16 v107, v106, v107
v_pk_mul_f16 v109, v108, v109
v_mfma_f32_16x16x32_bf16 v[120:123], v[168:171], v[64:67], v[120:123]
v_pk_mul_f16 v111, v110, v111
v_mfma_f32_16x16x32_f16 v[164:167], v[188:191], v[212:215], v[164:167]
ds_read_b128 v[188:191], v251 offset:8192
v_cvt_pkrtz_f16_f32 v101, v100, v101
v_and_b32_e64 v101, s49, v101
v_bfe_u32 v100, v101, 2, 14
v_lshrrev_b32_e64 v101, 18, v101
ds_read_u16 v100, v100
ds_read_u16_d16_hi v101, v101
v_or_b32 v27, v6, v7
v_exp_f16_sdwa v107, v107 dst_sel:WORD_0 dst_unused:UNUSED_PRESERVE src0_sel:WORD_0
v_cvt_pk_bf16_f32 v32, v72, v73
v_cvt_pk_bf16_f32 v33, v74, v75
v_cvt_pk_bf16_f32 v34, v76, v77
v_cvt_pk_bf16_f32 v35, v78, v79
v_cvt_pk_bf16_f32 v36, v80, v81
v_cvt_pk_bf16_f32 v37, v82, v83
v_cvt_pk_bf16_f32 v38, v84, v85
v_cvt_pk_bf16_f32 v39, v86, v87
ds_read_b128 v[72:75], v254 offset:8192
ds_read_b128 v[76:79], v254 offset:8208
ds_read_b128 v[80:83], v254 offset:8192
ds_read_b128 v[84:87], v254 offset:8208
v_mfma_f32_16x16x32_bf16 v[128:131], v[168:171], v[68:71], v[128:131]
ds_read_b128 v[168:171], v248 offset:22784
s_setprio 1
v_mfma_f32_16x16x32_f16 v[136:139], v[172:175], v[208:211], v[136:139]
v_exp_f16_sdwa v109, v109 dst_sel:WORD_0 dst_unused:UNUSED_PRESERVE src0_sel:WORD_0
v_cvt_pk_bf16_f32 v40, v152, v153
v_cvt_pk_bf16_f32 v41, v154, v155
v_cvt_pk_bf16_f32 v42, v156, v157
v_cvt_pk_bf16_f32 v43, v158, v159
v_cvt_pk_bf16_f32 v44, v160, v161
v_cvt_pk_bf16_f32 v45, v162, v163
v_cvt_pk_bf16_f32 v46, v164, v165
v_cvt_pk_bf16_f32 v47, v166, v167
ds_read_b128 v[152:155], v254 offset:8320
ds_read_b128 v[156:159], v254 offset:8336
ds_read_b128 v[160:163], v254 offset:8320
ds_read_b128 v[164:167], v254 offset:8336
v_cvt_pkrtz_f16_f32 v103, v102, v103
v_and_b32_e64 v103, s49, v103
v_bfe_u32 v102, v103, 2, 14
v_lshrrev_b32_e64 v103, 18, v103
ds_read_u16 v102, v102
ds_read_u16_d16_hi v103, v103
v_exp_f16_sdwa v111, v111 dst_sel:WORD_0 dst_unused:UNUSED_PRESERVE src0_sel:WORD_0
v_or_b32 v28, v8, v9
s_waitcnt lgkmcnt(11)
v_mfma_f32_16x16x32_bf16 v[124:127], v[176:179], v[48:51], 0
v_cvt_pk_bf16_f32 v16, v136, v137
v_mfma_f32_16x16x32_f16 v[144:147], v[172:175], v[212:215], v[144:147]
ds_read_b128 v[172:175], v251 offset:11264
v_cvt_pk_bf16_f32 v17, v138, v139
ds_read_b128 v[136:139], v254
v_exp_f16_sdwa v107, v107 dst_sel:WORD_1 dst_unused:UNUSED_PRESERVE src0_sel:WORD_1
v_mfma_f32_16x16x32_f16 v[140:143], v[180:183], v[208:211], v[140:143]
v_exp_f16_sdwa v109, v109 dst_sel:WORD_1 dst_unused:UNUSED_PRESERVE src0_sel:WORD_1
s_nop 1
v_cvt_pk_bf16_f32 v20, v144, v145
v_cvt_pk_bf16_f32 v21, v146, v147
ds_read_b128 v[144:147], v254
v_mfma_f32_16x16x32_bf16 v[132:135], v[176:179], v[52:55], 0
ds_read_b128 v[176:179], v248 offset:24576
v_cvt_pkrtz_f16_f32 v105, v104, v105
v_cvt_pk_bf16_f32 v18, v140, v141
v_cvt_pk_bf16_f32 v19, v142, v143
ds_read_b128 v[140:143], v254 offset:16
v_and_b32 v105, s49, v105
v_bfe_u32 v104, v105, 2, 14
v_lshrrev_b32 v105, 18, v105
ds_read_u16 v104, v104
ds_read_u16_d16_hi v105, v105
v_exp_f16_sdwa v111, v111 dst_sel:WORD_1 dst_unused:UNUSED_PRESERVE src0_sel:WORD_1
v_mfma_f32_16x16x32_f16 v[148:151], v[180:183], v[212:215], v[148:151]
ds_read_b128 v[180:183], v251 offset:9216
v_pk_add_f16 v107, v107, 1.0 op_sel_hi:[1,0]
v_mfma_f32_16x16x32_bf16 v[124:127], v[184:187], v[56:59], v[124:127]
v_pk_add_f16 v109, v109, 1.0 op_sel_hi:[1,0]
s_waitcnt lgkmcnt(10)
v_mfma_f32_16x16x32_f16 v[72:75], v[188:191], v[232:235], v[72:75]
buffer_store_dwordx4 v[32:35], v253, s[8:11], s69 offen sc1
v_pk_add_f16 v111, v111, 1.0 op_sel_hi:[1,0]
v_cvt_pk_bf16_f32 v22, v148, v149
v_cvt_pk_bf16_f32 v23, v150, v151
ds_read_b128 v[148:151], v254 offset:16
v_mfma_f32_16x16x32_bf16 v[132:135], v[184:187], v[60:63], v[132:135]
ds_read_b128 v[184:187], v248 offset:26624
v_rcp_f16_sdwa v107, v107 dst_sel:WORD_0 dst_unused:UNUSED_PRESERVE src0_sel:WORD_0
v_mfma_f32_16x16x32_f16 v[80:83], v[188:191], v[236:239], v[80:83]
ds_read_b128 v[188:191], v251 offset:12288
v_rcp_f16_sdwa v109, v109 dst_sel:WORD_0 dst_unused:UNUSED_PRESERVE src0_sel:WORD_0
v_mfma_f32_16x16x32_bf16 v[124:127], v[168:171], v[64:67], v[124:127]
v_rcp_f16_sdwa v111, v111 dst_sel:WORD_0 dst_unused:UNUSED_PRESERVE src0_sel:WORD_0
s_waitcnt lgkmcnt(9)
v_mfma_f32_16x16x32_f16 v[76:79], v[172:175], v[232:235], v[76:79]
v_rcp_f16_sdwa v107, v107 dst_sel:WORD_1 dst_unused:UNUSED_PRESERVE src0_sel:WORD_1
v_mfma_f32_16x16x32_bf16 v[132:135], v[168:171], v[68:71], v[132:135]
ds_read_b128 v[168:171], v251 offset:10240
s_setprio 0
v_mfma_f32_16x16x32_f16 v[84:87], v[172:175], v[236:239], v[84:87]
ds_read_b128 v[172:175], v248 offset:28672
v_rcp_f16_sdwa v109, v109 dst_sel:WORD_1 dst_unused:UNUSED_PRESERVE src0_sel:WORD_1
s_waitcnt lgkmcnt(8)
v_mfma_f32_16x16x32_bf16 v[0:3], v[176:179], v[48:51], 0
v_rcp_f16_sdwa v111, v111 dst_sel:WORD_1 dst_unused:UNUSED_PRESERVE src0_sel:WORD_1
v_or_b32 v88, v96, v97
v_pk_mul_f16 v93, v106, v107
v_mfma_f32_16x16x32_bf16 v[8:11], v[176:179], v[52:55], 0
ds_read_b128 v[176:179], v251 offset:13312
v_pk_mul_f16 v94, v108, v109
s_waitcnt lgkmcnt(6)
v_mfma_f32_16x16x32_f16 v[152:155], v[180:183], v[232:235], v[152:155]
v_pk_mul_f16 v95, v110, v111
v_mfma_f32_16x16x32_f16 v[160:163], v[180:183], v[236:239], v[160:163]
ds_read_b128 v[180:183], v248 offset:24832
v_cvt_pkrtz_f16_f32 v121, v120, v121
v_and_b32 v121, s49, v121
v_bfe_u32 v120, v121, 2, 14
v_lshrrev_b32 v121, 18, v121
ds_read_u16 v120, v120
ds_read_u16_d16_hi v121, v121
v_cvt_pk_f16_f32 v130, v130, v131
v_or_b32 v89, v98, v99
s_waitcnt lgkmcnt(7)
v_mfma_f32_16x16x32_bf16 v[0:3], v[184:187], v[56:59], v[0:3]
v_cvt_pk_f16_f32 v132, v132, v133
s_waitcnt lgkmcnt(6)
v_mfma_f32_16x16x32_f16 v[156:159], v[188:191], v[232:235], v[156:159]
v_cvt_pk_f16_f32 v134, v134, v135
v_pk_fma_f16 v131, v130, v130, s48
v_mfma_f32_16x16x32_bf16 v[8:11], v[184:187], v[60:63], v[8:11]
ds_read_b128 v[184:187], v251 offset:14336
v_pk_fma_f16 v133, v132, v132, s48
v_mfma_f32_16x16x32_f16 v[164:167], v[188:191], v[236:239], v[164:167]
ds_read_b128 v[188:191], v248 offset:26880
v_cvt_pkrtz_f16_f32 v123, v122, v123
v_and_b32_e64 v123, s49, v123
v_bfe_u32 v122, v123, 2, 14
v_lshrrev_b32_e64 v123, 18, v123
ds_read_u16 v122, v122
ds_read_u16_d16_hi v123, v123
v_or_b32 v90, v100, v101
v_pk_fma_f16 v135, v134, v134, s48
v_pk_mul_f16 v131, v130, v131
s_waitcnt lgkmcnt(7)
v_mfma_f32_16x16x32_f16 v[136:139], v[168:171], v[232:235], v[136:139]
v_pk_mul_f16 v133, v132, v133
v_mfma_f32_16x16x32_bf16 v[0:3], v[172:175], v[64:67], v[0:3]
v_pk_mul_f16 v135, v134, v135
v_cvt_pkrtz_f16_f32 v125, v124, v125
v_and_b32_e64 v125, s49, v125
v_bfe_u32 v124, v125, 2, 14
v_lshrrev_b32 v125, 18, v125
ds_read_u16 v124, v124
ds_read_u16_d16_hi v125, v125
v_or_b32 v91, v102, v103
v_exp_f16_sdwa v131, v131 dst_sel:WORD_0 dst_unused:UNUSED_PRESERVE src0_sel:WORD_0
v_mfma_f32_16x16x32_f16 v[144:147], v[168:171], v[236:239], v[144:147]
ds_read_b128 v[168:171], v251 offset:17408
v_exp_f16_sdwa v133, v133 dst_sel:WORD_0 dst_unused:UNUSED_PRESERVE src0_sel:WORD_0
v_mfma_f32_16x16x32_bf16 v[8:11], v[172:175], v[68:71], v[8:11]
ds_read_b128 v[172:175], v248 offset:28928
s_setprio 3
v_mfma_f32_16x16x32_f16 v[140:143], v[176:179], v[232:235], v[140:143]
v_cvt_pkrtz_f16_f32 v127, v126, v127
v_and_b32 v127, s49, v127
v_bfe_u32 v126, v127, 2, 14
v_lshrrev_b32_e64 v127, 18, v127
ds_read_u16 v126, v126
ds_read_u16_d16_hi v127, v127
v_exp_f16_sdwa v135, v135 dst_sel:WORD_0 dst_unused:UNUSED_PRESERVE src0_sel:WORD_0
v_or_b32 v92, v104, v105
s_waitcnt lgkmcnt(7)
v_mfma_f32_16x16x32_bf16 v[4:7], v[180:183], v[48:51], 0
buffer_store_dwordx4 v[36:39], v253, s[8:11], s69 offen offset:192 sc1
v_exp_f16_sdwa v131, v131 dst_sel:WORD_1 dst_unused:UNUSED_PRESERVE src0_sel:WORD_1
v_mfma_f32_16x16x32_f16 v[148:151], v[176:179], v[236:239], v[148:151]
ds_read_b128 v[176:179], v251 offset:15360
v_exp_f16_sdwa v133, v133 dst_sel:WORD_1 dst_unused:UNUSED_PRESERVE src0_sel:WORD_1
v_mfma_f32_16x16x32_bf16 v[12:15], v[180:183], v[52:55], 0
ds_read_b128 v[180:183], v248 offset:30720
v_cvt_pkrtz_f16_f32 v129, v128, v129
v_and_b32_e64 v129, s49, v129
v_bfe_u32 v128, v129, 2, 14
v_lshrrev_b32 v129, 18, v129
ds_read_u16 v128, v128
ds_read_u16_d16_hi v129, v129
v_mfma_f32_16x16x32_f16 v[72:75], v[184:187], v[24:27], v[72:75]
v_exp_f16_sdwa v135, v135 dst_sel:WORD_1 dst_unused:UNUSED_PRESERVE src0_sel:WORD_1
v_mfma_f32_16x16x32_bf16 v[4:7], v[188:191], v[56:59], v[4:7]
v_pk_add_f16 v131, v131, 1.0 op_sel_hi:[1,0]
v_mfma_f32_16x16x32_f16 v[80:83], v[184:187], v[28:31], v[80:83]
ds_read_b128 v[184:187], v251 offset:18432
v_pk_add_f16 v133, v133, 1.0 op_sel_hi:[1,0]
v_pk_add_f16 v135, v135, 1.0 op_sel_hi:[1,0]
v_mfma_f32_16x16x32_bf16 v[12:15], v[188:191], v[60:63], v[12:15]
ds_read_b128 v[188:191], v248 offset:32768
v_rcp_f16_sdwa v131, v131 dst_sel:WORD_0 dst_unused:UNUSED_PRESERVE src0_sel:WORD_0
s_waitcnt lgkmcnt(7)
v_mfma_f32_16x16x32_f16 v[76:79], v[168:171], v[24:27], v[76:79]
v_rcp_f16_sdwa v133, v133 dst_sel:WORD_0 dst_unused:UNUSED_PRESERVE src0_sel:WORD_0
v_mfma_f32_16x16x32_bf16 v[4:7], v[172:175], v[64:67], v[4:7]
v_rcp_f16_sdwa v135, v135 dst_sel:WORD_0 dst_unused:UNUSED_PRESERVE src0_sel:WORD_0
v_mfma_f32_16x16x32_f16 v[84:87], v[168:171], v[28:31], v[84:87]
ds_read_b128 v[168:171], v251 offset:16384
v_rcp_f16_sdwa v131, v131 dst_sel:WORD_1 dst_unused:UNUSED_PRESERVE src0_sel:WORD_1
v_mfma_f32_16x16x32_bf16 v[12:15], v[172:175], v[68:71], v[12:15]
ds_read_b128 v[172:175], v248 offset:34816
v_rcp_f16_sdwa v133, v133 dst_sel:WORD_1 dst_unused:UNUSED_PRESERVE src0_sel:WORD_1
s_waitcnt lgkmcnt(6)
v_mfma_f32_16x16x32_f16 v[152:155], v[176:179], v[24:27], v[152:155]
s_setprio 2
v_rcp_f16_sdwa v135, v135 dst_sel:WORD_1 dst_unused:UNUSED_PRESERVE src0_sel:WORD_1
v_mfma_f32_16x16x32_f16 v[160:163], v[176:179], v[28:31], v[160:163]
ds_read_b128 v[176:179], v251 offset:19456
v_or_b32 v224, v120, v121
v_mfma_f32_16x16x32_bf16 v[96:99], v[180:183], v[48:51], 0
v_pk_mul_f16 v229, v130, v131
s_waitcnt lgkmcnt(4)
v_mfma_f32_16x16x32_f16 v[156:159], v[184:187], v[24:27], v[156:159]
v_pk_mul_f16 v230, v132, v133
v_mfma_f32_16x16x32_bf16 v[104:107], v[180:183], v[52:55], 0
ds_read_b128 v[180:183], v248 offset:30976
v_pk_mul_f16 v231, v134, v135
v_mfma_f32_16x16x32_f16 v[164:167], v[184:187], v[28:31], v[164:167]
ds_read_b128 v[184:187], v251 offset:20480
v_cvt_pkrtz_f16_f32 v1, v0, v1
v_and_b32_e64 v1, s49, v1
v_bfe_u32 v0, v1, 2, 14
v_lshrrev_b32_e64 v1, 18, v1
ds_read_u16 v0, v0
ds_read_u16_d16_hi v1, v1
v_cvt_pk_f16_f32 v10, v10, v11
v_or_b32 v225, v122, v123
s_waitcnt lgkmcnt(5)
v_mfma_f32_16x16x32_bf16 v[96:99], v[188:191], v[56:59], v[96:99]
v_cvt_pk_f16_f32 v12, v12, v13
v_cvt_pk_f16_f32 v14, v14, v15
v_mfma_f32_16x16x32_f16 v[136:139], v[168:171], v[24:27], v[136:139]
v_pk_fma_f16 v11, v10, v10, s48
v_mfma_f32_16x16x32_bf16 v[104:107], v[188:191], v[60:63], v[104:107]
ds_read_b128 v[188:191], v248 offset:33024
v_pk_fma_f16 v13, v12, v12, s48
v_cvt_pkrtz_f16_f32 v3, v2, v3
v_and_b32_e64 v3, s49, v3
v_bfe_u32 v2, v3, 2, 14
v_lshrrev_b32 v3, 18, v3
ds_read_u16 v2, v2
ds_read_u16_d16_hi v3, v3
v_or_b32 v226, v124, v125
v_pk_fma_f16 v15, v14, v14, s48
v_mfma_f32_16x16x32_f16 v[144:147], v[168:171], v[28:31], v[144:147]
ds_read_b128 v[168:171], v251 offset:23552
v_pk_mul_f16 v11, v10, v11
v_pk_mul_f16 v13, v12, v13
v_mfma_f32_16x16x32_bf16 v[96:99], v[172:175], v[64:67], v[96:99]
v_pk_mul_f16 v15, v14, v15
buffer_store_dwordx4 v[40:43], v253, s[8:11], s69 offen offset:64 sc1
v_cvt_pkrtz_f16_f32 v5, v4, v5
v_and_b32_e64 v5, s49, v5
v_bfe_u32 v4, v5, 2, 14
v_lshrrev_b32_e64 v5, 18, v5
ds_read_u16 v4, v4
ds_read_u16_d16_hi v5, v5
s_waitcnt lgkmcnt(7)
v_mfma_f32_16x16x32_f16 v[140:143], v[176:179], v[24:27], v[140:143]
v_or_b32 v227, v126, v127
v_exp_f16_sdwa v11, v11 dst_sel:WORD_0 dst_unused:UNUSED_PRESERVE src0_sel:WORD_0
v_mfma_f32_16x16x32_bf16 v[104:107], v[172:175], v[68:71], v[104:107]
ds_read_b128 v[172:175], v251 offset:21504
v_exp_f16_sdwa v13, v13 dst_sel:WORD_0 dst_unused:UNUSED_PRESERVE src0_sel:WORD_0
v_mfma_f32_16x16x32_f16 v[148:151], v[176:179], v[28:31], v[148:151]
ds_read_b128 v[176:179], v248 offset:35072
s_setprio 1
v_cvt_pkrtz_f16_f32 v7, v6, v7
v_and_b32 v7, s49, v7
v_bfe_u32 v6, v7, 2, 14
v_lshrrev_b32 v7, 18, v7
ds_read_u16 v6, v6
ds_read_u16_d16_hi v7, v7
v_exp_f16_sdwa v15, v15 dst_sel:WORD_0 dst_unused:UNUSED_PRESERVE src0_sel:WORD_0
v_or_b32 v228, v128, v129
v_mfma_f32_16x16x32_bf16 v[100:103], v[180:183], v[48:51], 0
v_exp_f16_sdwa v11, v11 dst_sel:WORD_1 dst_unused:UNUSED_PRESERVE src0_sel:WORD_1
v_mfma_f32_16x16x32_f16 v[72:75], v[184:187], v[88:91], v[72:75]
v_exp_f16_sdwa v13, v13 dst_sel:WORD_1 dst_unused:UNUSED_PRESERVE src0_sel:WORD_1
v_mfma_f32_16x16x32_bf16 v[108:111], v[180:183], v[52:55], 0
ds_read_b128 v[180:183], v251 offset:24576
v_cvt_pkrtz_f16_f32 v9, v8, v9
v_and_b32_e64 v9, s49, v9
v_bfe_u32 v8, v9, 2, 14
v_lshrrev_b32 v9, 18, v9
ds_read_u16 v8, v8
ds_read_u16_d16_hi v9, v9
v_mfma_f32_16x16x32_f16 v[80:83], v[184:187], v[92:95], v[80:83]
ds_read_b128 v[184:187], v249
v_exp_f16_sdwa v15, v15 dst_sel:WORD_1 dst_unused:UNUSED_PRESERVE src0_sel:WORD_1
s_waitcnt lgkmcnt(7)
v_mfma_f32_16x16x32_bf16 v[100:103], v[188:191], v[56:59], v[100:103]
v_pk_add_f16 v11, v11, 1.0 op_sel_hi:[1,0]
v_mfma_f32_16x16x32_f16 v[76:79], v[168:171], v[88:91], v[76:79]
v_pk_add_f16 v13, v13, 1.0 op_sel_hi:[1,0]
v_pk_add_f16 v15, v15, 1.0 op_sel_hi:[1,0]
v_mfma_f32_16x16x32_f16 v[84:87], v[168:171], v[92:95], v[84:87]
ds_read_b128 v[168:171], v249 offset:2048
v_rcp_f16_sdwa v11, v11 dst_sel:WORD_0 dst_unused:UNUSED_PRESERVE src0_sel:WORD_0
v_mfma_f32_16x16x32_bf16 v[108:111], v[188:191], v[60:63], v[108:111]
ds_read_b128 v[188:191], v251 offset:22528
v_rcp_f16_sdwa v13, v13 dst_sel:WORD_0 dst_unused:UNUSED_PRESERVE src0_sel:WORD_0
v_mfma_f32_16x16x32_f16 v[152:155], v[172:175], v[88:91], v[152:155]
v_rcp_f16_sdwa v15, v15 dst_sel:WORD_0 dst_unused:UNUSED_PRESERVE src0_sel:WORD_0
s_waitcnt lgkmcnt(5)
v_mfma_f32_16x16x32_bf16 v[100:103], v[176:179], v[64:67], v[100:103]
v_rcp_f16_sdwa v11, v11 dst_sel:WORD_1 dst_unused:UNUSED_PRESERVE src0_sel:WORD_1
v_mfma_f32_16x16x32_f16 v[160:163], v[172:175], v[92:95], v[160:163]
ds_read_b128 v[172:175], v251 offset:25600
v_rcp_f16_sdwa v13, v13 dst_sel:WORD_1 dst_unused:UNUSED_PRESERVE src0_sel:WORD_1
v_mfma_f32_16x16x32_bf16 v[108:111], v[176:179], v[68:71], v[108:111]
ds_read_b128 v[176:179], v249 offset:4096
s_setprio 0
buffer_load_dwordx4 v[192:195], v253, s[4:7], s68 offen
v_mfma_f32_16x16x32_f16 v[156:159], v[180:183], v[88:91], v[156:159]
v_rcp_f16_sdwa v15, v15 dst_sel:WORD_1 dst_unused:UNUSED_PRESERVE src0_sel:WORD_1
s_waitcnt lgkmcnt(4)
v_mfma_f32_16x16x32_bf16 v[120:123], v[184:187], v[48:51], 0
v_or_b32 v200, v0, v1
v_mfma_f32_16x16x32_f16 v[164:167], v[180:183], v[92:95], v[164:167]
ds_read_b128 v[180:183], v251 offset:26624
v_pk_mul_f16 v205, v10, v11
v_mfma_f32_16x16x32_bf16 v[128:131], v[184:187], v[52:55], 0
ds_read_b128 v[184:187], v249 offset:256
v_pk_mul_f16 v206, v12, v13
s_waitcnt lgkmcnt(4)
v_mfma_f32_16x16x32_f16 v[136:139], v[188:191], v[88:91], v[136:139]
v_pk_mul_f16 v207, v14, v15
v_cvt_pkrtz_f16_f32 v97, v96, v97
v_and_b32 v97, s49, v97
v_bfe_u32 v96, v97, 2, 14
v_lshrrev_b32 v97, 18, v97
ds_read_u16 v96, v96
ds_read_u16_d16_hi v97, v97
v_cvt_pk_f16_f32 v106, v106, v107
v_or_b32 v201, v2, v3
buffer_store_dwordx4 v[44:47], v253, s[8:11], s69 offen offset:256 sc1
v_mfma_f32_16x16x32_bf16 v[120:123], v[168:171], v[56:59], v[120:123]
v_cvt_pk_f16_f32 v108, v108, v109
v_mfma_f32_16x16x32_f16 v[144:147], v[188:191], v[92:95], v[144:147]
ds_read_b128 v[188:191], v251 offset:29696
v_cvt_pk_f16_f32 v110, v110, v111
v_pk_fma_f16 v107, v106, v106, s48
v_mfma_f32_16x16x32_bf16 v[128:131], v[168:171], v[60:63], v[128:131]
ds_read_b128 v[168:171], v249 offset:2304
v_pk_fma_f16 v109, v108, v108, s48
v_cvt_pkrtz_f16_f32 v99, v98, v99
v_and_b32_e64 v99, s49, v99
v_bfe_u32 v98, v99, 2, 14
v_lshrrev_b32_e64 v99, 18, v99
ds_read_u16 v98, v98
ds_read_u16_d16_hi v99, v99
v_or_b32 v202, v4, v5
s_waitcnt lgkmcnt(6)
v_mfma_f32_16x16x32_f16 v[140:143], v[172:175], v[88:91], v[140:143]
v_pk_fma_f16 v111, v110, v110, s48
v_pk_mul_f16 v107, v106, v107
v_pk_mul_f16 v109, v108, v109
v_mfma_f32_16x16x32_bf16 v[120:123], v[176:179], v[64:67], v[120:123]
v_pk_mul_f16 v111, v110, v111
v_mfma_f32_16x16x32_f16 v[148:151], v[172:175], v[92:95], v[148:151]
ds_read_b128 v[172:175], v251 offset:27648
v_cvt_pkrtz_f16_f32 v101, v100, v101
v_and_b32_e64 v101, s49, v101
v_bfe_u32 v100, v101, 2, 14
v_lshrrev_b32 v101, 18, v101
ds_read_u16 v100, v100
ds_read_u16_d16_hi v101, v101
v_or_b32 v203, v6, v7
v_exp_f16_sdwa v107, v107 dst_sel:WORD_0 dst_unused:UNUSED_PRESERVE src0_sel:WORD_0
v_mfma_f32_16x16x32_bf16 v[128:131], v[176:179], v[68:71], v[128:131]
ds_read_b128 v[176:179], v249 offset:4352
v_exp_f16_sdwa v109, v109 dst_sel:WORD_0 dst_unused:UNUSED_PRESERVE src0_sel:WORD_0
v_mfma_f32_16x16x32_f16 v[72:75], v[180:183], v[224:227], v[72:75]
buffer_load_dwordx4 v[196:199], v253, s[4:7], s68 offen offset:192
s_setprio 3
v_cvt_pkrtz_f16_f32 v103, v102, v103
v_and_b32 v103, s49, v103
v_bfe_u32 v102, v103, 2, 14
v_lshrrev_b32_e64 v103, 18, v103
ds_read_u16 v102, v102
ds_read_u16_d16_hi v103, v103
v_exp_f16_sdwa v111, v111 dst_sel:WORD_0 dst_unused:UNUSED_PRESERVE src0_sel:WORD_0
v_or_b32 v204, v8, v9
v_mfma_f32_16x16x32_f16 v[80:83], v[180:183], v[228:231], v[80:83]
ds_read_b128 v[180:183], v251 offset:30720
v_exp_f16_sdwa v107, v107 dst_sel:WORD_1 dst_unused:UNUSED_PRESERVE src0_sel:WORD_1
v_mfma_f32_16x16x32_bf16 v[124:127], v[184:187], v[48:51], 0
v_exp_f16_sdwa v109, v109 dst_sel:WORD_1 dst_unused:UNUSED_PRESERVE src0_sel:WORD_1
s_waitcnt lgkmcnt(6)
v_mfma_f32_16x16x32_f16 v[76:79], v[188:191], v[224:227], v[76:79]
v_cvt_pkrtz_f16_f32 v105, v104, v105
v_mfma_f32_16x16x32_bf16 v[132:135], v[184:187], v[52:55], 0
ds_read_b128 v[184:187], v249 offset:6144
v_and_b32_e64 v105, s49, v105
v_bfe_u32 v104, v105, 2, 14
v_lshrrev_b32 v105, 18, v105
ds_read_u16 v104, v104
ds_read_u16_d16_hi v105, v105
v_exp_f16_sdwa v111, v111 dst_sel:WORD_1 dst_unused:UNUSED_PRESERVE src0_sel:WORD_1
v_mfma_f32_16x16x32_f16 v[84:87], v[188:191], v[228:231], v[84:87]
ds_read_b128 v[188:191], v251 offset:28672
v_pk_add_f16 v107, v107, 1.0 op_sel_hi:[1,0]
v_mfma_f32_16x16x32_bf16 v[124:127], v[168:171], v[56:59], v[124:127]
v_pk_add_f16 v109, v109, 1.0 op_sel_hi:[1,0]
v_mfma_f32_16x16x32_f16 v[152:155], v[172:175], v[224:227], v[152:155]
v_pk_add_f16 v111, v111, 1.0 op_sel_hi:[1,0]
v_mfma_f32_16x16x32_bf16 v[132:135], v[168:171], v[60:63], v[132:135]
ds_read_b128 v[168:171], v249 offset:8192
v_rcp_f16_sdwa v107, v107 dst_sel:WORD_0 dst_unused:UNUSED_PRESERVE src0_sel:WORD_0
v_mfma_f32_16x16x32_f16 v[160:163], v[172:175], v[228:231], v[160:163]
ds_read_b128 v[172:175], v251 offset:31744
v_rcp_f16_sdwa v109, v109 dst_sel:WORD_0 dst_unused:UNUSED_PRESERVE src0_sel:WORD_0
buffer_load_dwordx4 v[240:243], v253, s[4:7], s68 offen offset:64
s_waitcnt lgkmcnt(6)
v_mfma_f32_16x16x32_bf16 v[124:127], v[176:179], v[64:67], v[124:127]
v_rcp_f16_sdwa v111, v111 dst_sel:WORD_0 dst_unused:UNUSED_PRESERVE src0_sel:WORD_0
v_mfma_f32_16x16x32_f16 v[156:159], v[180:183], v[224:227], v[156:159]
v_rcp_f16_sdwa v107, v107 dst_sel:WORD_1 dst_unused:UNUSED_PRESERVE src0_sel:WORD_1
v_mfma_f32_16x16x32_bf16 v[132:135], v[176:179], v[68:71], v[132:135]
ds_read_b128 v[176:179], v251 offset:32768
v_rcp_f16_sdwa v109, v109 dst_sel:WORD_1 dst_unused:UNUSED_PRESERVE src0_sel:WORD_1
v_mfma_f32_16x16x32_f16 v[164:167], v[180:183], v[228:231], v[164:167]
ds_read_b128 v[180:183], v249 offset:10240
s_setprio 2
s_waitcnt lgkmcnt(6)
v_mfma_f32_16x16x32_bf16 v[0:3], v[184:187], v[48:51], 0
buffer_store_dwordx4 v[16:19], v253, s[8:11], s69 offen offset:128 sc1
v_rcp_f16_sdwa v111, v111 dst_sel:WORD_1 dst_unused:UNUSED_PRESERVE src0_sel:WORD_1
s_waitcnt lgkmcnt(4)
v_mfma_f32_16x16x32_f16 v[136:139], v[188:191], v[224:227], v[136:139]
v_or_b32 v216, v96, v97
v_pk_mul_f16 v221, v106, v107
v_mfma_f32_16x16x32_bf16 v[8:11], v[184:187], v[52:55], 0
ds_read_b128 v[184:187], v251 offset:35840
v_pk_mul_f16 v222, v108, v109
v_mfma_f32_16x16x32_f16 v[144:147], v[188:191], v[228:231], v[144:147]
ds_read_b128 v[188:191], v249 offset:6400
v_pk_mul_f16 v223, v110, v111
v_cvt_pkrtz_f16_f32 v121, v120, v121
v_and_b32_e64 v121, s49, v121
v_bfe_u32 v120, v121, 2, 14
v_lshrrev_b32_e64 v121, 18, v121
ds_read_u16 v120, v120
ds_read_u16_d16_hi v121, v121
v_cvt_pk_f16_f32 v130, v130, v131
v_or_b32 v217, v98, v99
s_waitcnt lgkmcnt(5)
v_mfma_f32_16x16x32_bf16 v[0:3], v[168:171], v[56:59], v[0:3]
v_cvt_pk_f16_f32 v132, v132, v133
v_mfma_f32_16x16x32_f16 v[140:143], v[172:175], v[224:227], v[140:143]
v_cvt_pk_f16_f32 v134, v134, v135
v_pk_fma_f16 v131, v130, v130, s48
v_mfma_f32_16x16x32_f16 v[148:151], v[172:175], v[228:231], v[148:151]
ds_read_b128 v[172:175], v249 offset:8448
v_pk_fma_f16 v133, v132, v132, s48
v_mfma_f32_16x16x32_bf16 v[8:11], v[168:171], v[60:63], v[8:11]
ds_read_b128 v[168:171], v251 offset:33792
v_cvt_pkrtz_f16_f32 v123, v122, v123
v_and_b32_e64 v123, s49, v123
v_bfe_u32 v122, v123, 2, 14
v_lshrrev_b32 v123, 18, v123
ds_read_u16 v122, v122
ds_read_u16_d16_hi v123, v123
v_or_b32 v218, v100, v101
v_pk_fma_f16 v135, v134, v134, s48
buffer_load_dwordx4 v[244:247], v253, s[4:7], s68 offen offset:256
v_pk_mul_f16 v131, v130, v131
v_mfma_f32_16x16x32_f16 v[72:75], v[176:179], v[200:203], v[72:75]
v_pk_mul_f16 v133, v132, v133
s_waitcnt lgkmcnt(6)
v_mfma_f32_16x16x32_bf16 v[0:3], v[180:183], v[64:67], v[0:3]
v_pk_mul_f16 v135, v134, v135
v_cvt_pkrtz_f16_f32 v125, v124, v125
v_and_b32 v125, s49, v125
v_bfe_u32 v124, v125, 2, 14
v_lshrrev_b32 v125, 18, v125
ds_read_u16 v124, v124
ds_read_u16_d16_hi v125, v125
v_or_b32 v219, v102, v103
v_exp_f16_sdwa v131, v131 dst_sel:WORD_0 dst_unused:UNUSED_PRESERVE src0_sel:WORD_0
v_mfma_f32_16x16x32_f16 v[80:83], v[176:179], v[204:207], v[80:83]
ds_read_b128 v[176:179], v251 offset:36864
v_exp_f16_sdwa v133, v133 dst_sel:WORD_0 dst_unused:UNUSED_PRESERVE src0_sel:WORD_0
v_mfma_f32_16x16x32_bf16 v[8:11], v[180:183], v[68:71], v[8:11]
ds_read_b128 v[180:183], v249 offset:10496
v_cvt_pkrtz_f16_f32 v127, v126, v127
v_mfma_f32_16x16x32_f16 v[76:79], v[184:187], v[200:203], v[76:79]
v_and_b32_e64 v127, s49, v127
v_bfe_u32 v126, v127, 2, 14
v_lshrrev_b32_e64 v127, 18, v127
ds_read_u16 v126, v126
ds_read_u16_d16_hi v127, v127
v_exp_f16_sdwa v135, v135 dst_sel:WORD_0 dst_unused:UNUSED_PRESERVE src0_sel:WORD_0
s_setprio 1
v_or_b32 v220, v104, v105
v_mfma_f32_16x16x32_bf16 v[4:7], v[188:191], v[48:51], 0
v_exp_f16_sdwa v131, v131 dst_sel:WORD_1 dst_unused:UNUSED_PRESERVE src0_sel:WORD_1
v_mfma_f32_16x16x32_f16 v[84:87], v[184:187], v[204:207], v[84:87]
ds_read_b128 v[184:187], v251 offset:34816
v_exp_f16_sdwa v133, v133 dst_sel:WORD_1 dst_unused:UNUSED_PRESERVE src0_sel:WORD_1
v_mfma_f32_16x16x32_bf16 v[12:15], v[188:191], v[52:55], 0
ds_read_b128 v[188:191], v249 offset:12288
v_cvt_pkrtz_f16_f32 v129, v128, v129
v_and_b32_e64 v129, s49, v129
v_bfe_u32 v128, v129, 2, 14
v_lshrrev_b32_e64 v129, 18, v129
ds_read_u16 v128, v128
ds_read_u16_d16_hi v129, v129
s_waitcnt lgkmcnt(8)
v_mfma_f32_16x16x32_f16 v[152:155], v[168:171], v[200:203], v[152:155]
v_exp_f16_sdwa v135, v135 dst_sel:WORD_1 dst_unused:UNUSED_PRESERVE src0_sel:WORD_1
v_mfma_f32_16x16x32_bf16 v[4:7], v[172:175], v[56:59], v[4:7]
v_pk_add_f16 v131, v131, 1.0 op_sel_hi:[1,0]
v_mfma_f32_16x16x32_f16 v[160:163], v[168:171], v[204:207], v[160:163]
ds_read_b128 v[168:171], v251 offset:37888
v_pk_add_f16 v133, v133, 1.0 op_sel_hi:[1,0]
v_pk_add_f16 v135, v135, 1.0 op_sel_hi:[1,0]
v_mfma_f32_16x16x32_bf16 v[12:15], v[172:175], v[60:63], v[12:15]
ds_read_b128 v[172:175], v249 offset:14336
v_rcp_f16_sdwa v131, v131 dst_sel:WORD_0 dst_unused:UNUSED_PRESERVE src0_sel:WORD_0
buffer_load_dwordx4 v[112:115], v253, s[4:7], s68 offen offset:128
s_waitcnt lgkmcnt(7)
v_mfma_f32_16x16x32_f16 v[156:159], v[176:179], v[200:203], v[156:159]
buffer_store_dwordx4 v[20:23], v253, s[8:11], s69 offen offset:320 sc1
v_rcp_f16_sdwa v133, v133 dst_sel:WORD_0 dst_unused:UNUSED_PRESERVE src0_sel:WORD_0
v_mfma_f32_16x16x32_bf16 v[4:7], v[180:183], v[64:67], v[4:7]
v_rcp_f16_sdwa v135, v135 dst_sel:WORD_0 dst_unused:UNUSED_PRESERVE src0_sel:WORD_0
v_mfma_f32_16x16x32_f16 v[164:167], v[176:179], v[204:207], v[164:167]
ds_read_b128 v[176:179], v251 offset:38912
v_rcp_f16_sdwa v131, v131 dst_sel:WORD_1 dst_unused:UNUSED_PRESERVE src0_sel:WORD_1
s_waitcnt lgkmcnt(5)
v_mfma_f32_16x16x32_f16 v[136:139], v[184:187], v[200:203], v[136:139]
v_rcp_f16_sdwa v133, v133 dst_sel:WORD_1 dst_unused:UNUSED_PRESERVE src0_sel:WORD_1
v_mfma_f32_16x16x32_bf16 v[12:15], v[180:183], v[68:71], v[12:15]
ds_read_b128 v[180:183], v249 offset:16384
v_rcp_f16_sdwa v135, v135 dst_sel:WORD_1 dst_unused:UNUSED_PRESERVE src0_sel:WORD_1
v_mfma_f32_16x16x32_f16 v[144:147], v[184:187], v[204:207], v[144:147]
ds_read_b128 v[184:187], v251 offset:41984
s_setprio 0
v_mfma_f32_16x16x32_bf16 v[96:99], v[188:191], v[48:51], 0
v_or_b32 v208, v120, v121
s_waitcnt lgkmcnt(4)
v_mfma_f32_16x16x32_f16 v[140:143], v[168:171], v[200:203], v[140:143]
v_pk_mul_f16 v213, v130, v131
v_mfma_f32_16x16x32_bf16 v[104:107], v[188:191], v[52:55], 0
ds_read_b128 v[188:191], v249 offset:12544
v_pk_mul_f16 v214, v132, v133
v_pk_mul_f16 v215, v134, v135
v_mfma_f32_16x16x32_f16 v[148:151], v[168:171], v[204:207], v[148:151]
ds_read_b128 v[168:171], v251 offset:39936
v_cvt_pkrtz_f16_f32 v1, v0, v1
v_and_b32_e64 v1, s49, v1
v_bfe_u32 v0, v1, 2, 14
v_lshrrev_b32_e64 v1, 18, v1
ds_read_u16 v0, v0
ds_read_u16_d16_hi v1, v1
v_cvt_pk_f16_f32 v10, v10, v11
v_or_b32 v209, v122, v123
s_waitcnt lgkmcnt(6)
v_mfma_f32_16x16x32_bf16 v[96:99], v[172:175], v[56:59], v[96:99]
v_cvt_pk_f16_f32 v12, v12, v13
v_cvt_pk_f16_f32 v14, v14, v15
v_mfma_f32_16x16x32_f16 v[72:75], v[176:179], v[216:219], v[72:75]
buffer_load_dwordx4 v[116:119], v253, s[4:7], s68 offen offset:320
v_pk_fma_f16 v11, v10, v10, s48
v_mfma_f32_16x16x32_bf16 v[104:107], v[172:175], v[60:63], v[104:107]
ds_read_b128 v[172:175], v251 offset:43008
v_pk_fma_f16 v13, v12, v12, s48
v_cvt_pkrtz_f16_f32 v3, v2, v3
v_and_b32_e64 v3, s49, v3
v_bfe_u32 v2, v3, 2, 14
v_lshrrev_b32_e64 v3, 18, v3
ds_read_u16 v2, v2
ds_read_u16_d16_hi v3, v3
v_or_b32 v210, v124, v125
v_pk_fma_f16 v15, v14, v14, s48
v_mfma_f32_16x16x32_f16 v[80:83], v[176:179], v[220:223], v[80:83]
ds_read_b128 v[176:179], v249 offset:14592
v_pk_mul_f16 v11, v10, v11
v_pk_mul_f16 v13, v12, v13
s_waitcnt lgkmcnt(6)
v_mfma_f32_16x16x32_bf16 v[96:99], v[180:183], v[64:67], v[96:99]
v_pk_mul_f16 v15, v14, v15
v_mfma_f32_16x16x32_f16 v[76:79], v[184:187], v[216:219], v[76:79]
v_cvt_pkrtz_f16_f32 v5, v4, v5
v_and_b32_e64 v5, s49, v5
v_bfe_u32 v4, v5, 2, 14
v_lshrrev_b32 v5, 18, v5
ds_read_u16 v4, v4
ds_read_u16_d16_hi v5, v5
v_or_b32 v211, v126, v127
v_exp_f16_sdwa v11, v11 dst_sel:WORD_0 dst_unused:UNUSED_PRESERVE src0_sel:WORD_0
v_mfma_f32_16x16x32_bf16 v[104:107], v[180:183], v[68:71], v[104:107]
ds_read_b128 v[180:183], v251 offset:40960
v_exp_f16_sdwa v13, v13 dst_sel:WORD_0 dst_unused:UNUSED_PRESERVE src0_sel:WORD_0
v_mfma_f32_16x16x32_f16 v[84:87], v[184:187], v[220:223], v[84:87]
ds_read_b128 v[184:187], v249 offset:16640
v_cvt_pkrtz_f16_f32 v7, v6, v7
v_and_b32_e64 v7, s49, v7
v_bfe_u32 v6, v7, 2, 14
v_lshrrev_b32_e64 v7, 18, v7
ds_read_u16 v6, v6
ds_read_u16_d16_hi v7, v7
v_exp_f16_sdwa v15, v15 dst_sel:WORD_0 dst_unused:UNUSED_PRESERVE src0_sel:WORD_0
v_or_b32 v212, v128, v129
v_mfma_f32_16x16x32_bf16 v[100:103], v[188:191], v[48:51], 0
s_setprio 3
v_exp_f16_sdwa v11, v11 dst_sel:WORD_1 dst_unused:UNUSED_PRESERVE src0_sel:WORD_1
v_mfma_f32_16x16x32_f16 v[152:155], v[168:171], v[216:219], v[152:155]
v_exp_f16_sdwa v13, v13 dst_sel:WORD_1 dst_unused:UNUSED_PRESERVE src0_sel:WORD_1
v_mfma_f32_16x16x32_bf16 v[108:111], v[188:191], v[52:55], 0
ds_read_b128 v[188:191], v251 offset:44032
v_cvt_pkrtz_f16_f32 v9, v8, v9
v_mfma_f32_16x16x32_f16 v[160:163], v[168:171], v[220:223], v[160:163]
ds_read_b128 v[168:171], v249 offset:18432
v_and_b32_e64 v9, s49, v9
v_bfe_u32 v8, v9, 2, 14
v_lshrrev_b32 v9, 18, v9
ds_read_u16 v8, v8
ds_read_u16_d16_hi v9, v9
v_exp_f16_sdwa v15, v15 dst_sel:WORD_1 dst_unused:UNUSED_PRESERVE src0_sel:WORD_1
s_waitcnt lgkmcnt(7)
v_mfma_f32_16x16x32_f16 v[156:159], v[172:175], v[216:219], v[156:159]
v_pk_add_f16 v11, v11, 1.0 op_sel_hi:[1,0]
v_mfma_f32_16x16x32_bf16 v[100:103], v[176:179], v[56:59], v[100:103]
v_pk_add_f16 v13, v13, 1.0 op_sel_hi:[1,0]
v_mfma_f32_16x16x32_f16 v[164:167], v[172:175], v[220:223], v[164:167]
ds_read_b128 v[172:175], v251 offset:45056
v_pk_add_f16 v15, v15, 1.0 op_sel_hi:[1,0]
v_mfma_f32_16x16x32_bf16 v[108:111], v[176:179], v[60:63], v[108:111]
ds_read_b128 v[176:179], v249 offset:20480
v_rcp_f16_sdwa v11, v11 dst_sel:WORD_0 dst_unused:UNUSED_PRESERVE src0_sel:WORD_0
v_mfma_f32_16x16x32_f16 v[136:139], v[180:183], v[216:219], v[136:139]
v_rcp_f16_sdwa v13, v13 dst_sel:WORD_0 dst_unused:UNUSED_PRESERVE src0_sel:WORD_0
s_waitcnt lgkmcnt(6)
v_mfma_f32_16x16x32_bf16 v[100:103], v[184:187], v[64:67], v[100:103]
v_rcp_f16_sdwa v15, v15 dst_sel:WORD_0 dst_unused:UNUSED_PRESERVE src0_sel:WORD_0
v_mfma_f32_16x16x32_f16 v[144:147], v[180:183], v[220:223], v[144:147]
ds_read_b128 v[180:183], v251 offset:48128
v_rcp_f16_sdwa v11, v11 dst_sel:WORD_1 dst_unused:UNUSED_PRESERVE src0_sel:WORD_1
v_mfma_f32_16x16x32_bf16 v[108:111], v[184:187], v[68:71], v[108:111]
ds_read_b128 v[184:187], v249 offset:22528
v_rcp_f16_sdwa v13, v13 dst_sel:WORD_1 dst_unused:UNUSED_PRESERVE src0_sel:WORD_1
s_waitcnt lgkmcnt(5)
v_mfma_f32_16x16x32_f16 v[140:143], v[188:191], v[216:219], v[140:143]
v_rcp_f16_sdwa v15, v15 dst_sel:WORD_1 dst_unused:UNUSED_PRESERVE src0_sel:WORD_1
v_mfma_f32_16x16x32_bf16 v[120:123], v[168:171], v[48:51], 0
s_setprio 2
v_or_b32 v32, v0, v1
v_mfma_f32_16x16x32_f16 v[148:151], v[188:191], v[220:223], v[148:151]
ds_read_b128 v[188:191], v251 offset:46080
v_pk_mul_f16 v37, v10, v11
v_mfma_f32_16x16x32_bf16 v[128:131], v[168:171], v[52:55], 0
ds_read_b128 v[168:171], v249 offset:18688
v_pk_mul_f16 v38, v12, v13
s_waitcnt lgkmcnt(4)
v_mfma_f32_16x16x32_f16 v[72:75], v[172:175], v[208:211], v[72:75]
v_pk_mul_f16 v39, v14, v15
v_cvt_pkrtz_f16_f32 v97, v96, v97
v_and_b32 v97, s49, v97
v_bfe_u32 v96, v97, 2, 14
v_lshrrev_b32 v97, 18, v97
ds_read_u16 v96, v96
ds_read_u16_d16_hi v97, v97
v_cvt_pk_f16_f32 v106, v106, v107
v_or_b32 v33, v2, v3
v_mfma_f32_16x16x32_bf16 v[120:123], v[176:179], v[56:59], v[120:123]
v_cvt_pk_f16_f32 v108, v108, v109
v_mfma_f32_16x16x32_f16 v[80:83], v[172:175], v[212:215], v[80:83]
ds_read_b128 v[172:175], v251 offset:49152
v_cvt_pk_f16_f32 v110, v110, v111
v_pk_fma_f16 v107, v106, v106, s48
v_mfma_f32_16x16x32_bf16 v[128:131], v[176:179], v[60:63], v[128:131]
ds_read_b128 v[176:179], v249 offset:20736
v_pk_fma_f16 v109, v108, v108, s48
v_cvt_pkrtz_f16_f32 v99, v98, v99
v_and_b32_e64 v99, s49, v99
v_bfe_u32 v98, v99, 2, 14
v_lshrrev_b32_e64 v99, 18, v99
ds_read_u16 v98, v98
ds_read_u16_d16_hi v99, v99
s_waitcnt lgkmcnt(6)
v_mfma_f32_16x16x32_f16 v[76:79], v[180:183], v[208:211], v[76:79]
v_or_b32 v34, v4, v5
v_pk_fma_f16 v111, v110, v110, s48
v_pk_mul_f16 v107, v106, v107
v_pk_mul_f16 v109, v108, v109
v_mfma_f32_16x16x32_bf16 v[120:123], v[184:187], v[64:67], v[120:123]
v_pk_mul_f16 v111, v110, v111
v_mfma_f32_16x16x32_f16 v[84:87], v[180:183], v[212:215], v[84:87]
ds_read_b128 v[180:183], v251 offset:47104
v_cvt_pkrtz_f16_f32 v101, v100, v101
v_and_b32_e64 v101, s49, v101
v_bfe_u32 v100, v101, 2, 14
v_lshrrev_b32 v101, 18, v101
ds_read_u16 v100, v100
ds_read_u16_d16_hi v101, v101
v_or_b32 v35, v6, v7
v_exp_f16_sdwa v107, v107 dst_sel:WORD_0 dst_unused:UNUSED_PRESERVE src0_sel:WORD_0
v_mfma_f32_16x16x32_f16 v[152:155], v[188:191], v[208:211], v[152:155]
v_exp_f16_sdwa v109, v109 dst_sel:WORD_0 dst_unused:UNUSED_PRESERVE src0_sel:WORD_0
v_mfma_f32_16x16x32_bf16 v[128:131], v[184:187], v[68:71], v[128:131]
ds_read_b128 v[184:187], v249 offset:22784
v_cvt_pkrtz_f16_f32 v103, v102, v103
v_and_b32_e64 v103, s49, v103
v_bfe_u32 v102, v103, 2, 14
v_lshrrev_b32 v103, 18, v103
ds_read_u16 v102, v102
ds_read_u16_d16_hi v103, v103
v_exp_f16_sdwa v111, v111 dst_sel:WORD_0 dst_unused:UNUSED_PRESERVE src0_sel:WORD_0
v_mfma_f32_16x16x32_f16 v[160:163], v[188:191], v[212:215], v[160:163]
ds_read_b128 v[188:191], v251 offset:50176
v_or_b32 v36, v8, v9
v_mfma_f32_16x16x32_bf16 v[124:127], v[168:171], v[48:51], 0
s_setprio 1
v_exp_f16_sdwa v107, v107 dst_sel:WORD_1 dst_unused:UNUSED_PRESERVE src0_sel:WORD_1
s_waitcnt lgkmcnt(6)
v_mfma_f32_16x16x32_f16 v[156:159], v[172:175], v[208:211], v[156:159]
v_exp_f16_sdwa v109, v109 dst_sel:WORD_1 dst_unused:UNUSED_PRESERVE src0_sel:WORD_1
v_mfma_f32_16x16x32_bf16 v[132:135], v[168:171], v[52:55], 0
ds_read_b128 v[168:171], v249 offset:24576
v_cvt_pkrtz_f16_f32 v105, v104, v105
v_and_b32_e64 v105, s49, v105
v_bfe_u32 v104, v105, 2, 14
v_lshrrev_b32_e64 v105, 18, v105
ds_read_u16 v104, v104
ds_read_u16_d16_hi v105, v105
v_mfma_f32_16x16x32_f16 v[164:167], v[172:175], v[212:215], v[164:167]
ds_read_b128 v[172:175], v251 offset:51200
v_exp_f16_sdwa v111, v111 dst_sel:WORD_1 dst_unused:UNUSED_PRESERVE src0_sel:WORD_1
v_mfma_f32_16x16x32_bf16 v[124:127], v[176:179], v[56:59], v[124:127]
v_pk_add_f16 v107, v107, 1.0 op_sel_hi:[1,0]
v_mfma_f32_16x16x32_f16 v[136:139], v[180:183], v[208:211], v[136:139]
v_pk_add_f16 v109, v109, 1.0 op_sel_hi:[1,0]
v_pk_add_f16 v111, v111, 1.0 op_sel_hi:[1,0]
v_mfma_f32_16x16x32_bf16 v[132:135], v[176:179], v[60:63], v[132:135]
ds_read_b128 v[176:179], v251 offset:54272
v_rcp_f16_sdwa v107, v107 dst_sel:WORD_0 dst_unused:UNUSED_PRESERVE src0_sel:WORD_0
v_mfma_f32_16x16x32_f16 v[144:147], v[180:183], v[212:215], v[144:147]
ds_read_b128 v[180:183], v249 offset:26624
v_rcp_f16_sdwa v109, v109 dst_sel:WORD_0 dst_unused:UNUSED_PRESERVE src0_sel:WORD_0
s_waitcnt lgkmcnt(7)
v_mfma_f32_16x16x32_bf16 v[124:127], v[184:187], v[64:67], v[124:127]
v_rcp_f16_sdwa v111, v111 dst_sel:WORD_0 dst_unused:UNUSED_PRESERVE src0_sel:WORD_0
s_waitcnt lgkmcnt(6)
v_mfma_f32_16x16x32_f16 v[140:143], v[188:191], v[208:211], v[140:143]
v_rcp_f16_sdwa v107, v107 dst_sel:WORD_1 dst_unused:UNUSED_PRESERVE src0_sel:WORD_1
v_mfma_f32_16x16x32_bf16 v[132:135], v[184:187], v[68:71], v[132:135]
ds_read_b128 v[184:187], v251 offset:52224
v_rcp_f16_sdwa v109, v109 dst_sel:WORD_1 dst_unused:UNUSED_PRESERVE src0_sel:WORD_1
v_mfma_f32_16x16x32_f16 v[148:151], v[188:191], v[212:215], v[148:151]
ds_read_b128 v[188:191], v249 offset:28672
v_rcp_f16_sdwa v111, v111 dst_sel:WORD_1 dst_unused:UNUSED_PRESERVE src0_sel:WORD_1
s_waitcnt lgkmcnt(6)
v_mfma_f32_16x16x32_bf16 v[0:3], v[168:171], v[48:51], 0
v_or_b32 v232, v96, v97
s_waitcnt lgkmcnt(4)
v_mfma_f32_16x16x32_f16 v[72:75], v[172:175], v[32:35], v[72:75]
s_setprio 0
v_pk_mul_f16 v237, v106, v107
v_mfma_f32_16x16x32_bf16 v[8:11], v[168:171], v[52:55], 0
ds_read_b128 v[168:171], v251 offset:55296
v_pk_mul_f16 v238, v108, v109
v_mfma_f32_16x16x32_f16 v[80:83], v[172:175], v[36:39], v[80:83]
ds_read_b128 v[172:175], v249 offset:24832
v_pk_mul_f16 v239, v110, v111
v_cvt_pkrtz_f16_f32 v121, v120, v121
v_and_b32_e64 v121, s49, v121
v_bfe_u32 v120, v121, 2, 14
v_lshrrev_b32_e64 v121, 18, v121
ds_read_u16 v120, v120
ds_read_u16_d16_hi v121, v121
v_cvt_pk_f16_f32 v130, v130, v131
s_waitcnt lgkmcnt(5)
v_mfma_f32_16x16x32_f16 v[76:79], v[176:179], v[32:35], v[76:79]
v_or_b32 v233, v98, v99
v_mfma_f32_16x16x32_bf16 v[0:3], v[180:183], v[56:59], v[0:3]
v_cvt_pk_f16_f32 v132, v132, v133
v_cvt_pk_f16_f32 v134, v134, v135
v_pk_fma_f16 v131, v130, v130, s48
v_mfma_f32_16x16x32_f16 v[84:87], v[176:179], v[36:39], v[84:87]
ds_read_b128 v[176:179], v251 offset:53248
v_pk_fma_f16 v133, v132, v132, s48
v_mfma_f32_16x16x32_bf16 v[8:11], v[180:183], v[60:63], v[8:11]
ds_read_b128 v[180:183], v249 offset:26880
v_cvt_pkrtz_f16_f32 v123, v122, v123
v_and_b32_e64 v123, s49, v123
v_bfe_u32 v122, v123, 2, 14
v_lshrrev_b32_e64 v123, 18, v123
ds_read_u16 v122, v122
ds_read_u16_d16_hi v123, v123
v_or_b32 v234, v100, v101
v_pk_fma_f16 v135, v134, v134, s48
v_pk_mul_f16 v131, v130, v131
v_mfma_f32_16x16x32_f16 v[152:155], v[184:187], v[32:35], v[152:155]
v_pk_mul_f16 v133, v132, v133
s_waitcnt lgkmcnt(6)
v_mfma_f32_16x16x32_bf16 v[0:3], v[188:191], v[64:67], v[0:3]
v_pk_mul_f16 v135, v134, v135
v_cvt_pkrtz_f16_f32 v125, v124, v125
v_and_b32_e64 v125, s49, v125
v_bfe_u32 v124, v125, 2, 14
v_lshrrev_b32 v125, 18, v125
ds_read_u16 v124, v124
ds_read_u16_d16_hi v125, v125
v_or_b32 v235, v102, v103
v_exp_f16_sdwa v131, v131 dst_sel:WORD_0 dst_unused:UNUSED_PRESERVE src0_sel:WORD_0
v_mfma_f32_16x16x32_f16 v[160:163], v[184:187], v[36:39], v[160:163]
ds_read_b128 v[184:187], v251 offset:56320
v_exp_f16_sdwa v133, v133 dst_sel:WORD_0 dst_unused:UNUSED_PRESERVE src0_sel:WORD_0
v_mfma_f32_16x16x32_bf16 v[8:11], v[188:191], v[68:71], v[8:11]
ds_read_b128 v[188:191], v249 offset:28928
v_cvt_pkrtz_f16_f32 v127, v126, v127
v_mfma_f32_16x16x32_f16 v[156:159], v[168:171], v[32:35], v[156:159]
v_and_b32_e64 v127, s49, v127
v_bfe_u32 v126, v127, 2, 14
v_lshrrev_b32_e64 v127, 18, v127
ds_read_u16 v126, v126
ds_read_u16_d16_hi v127, v127
v_exp_f16_sdwa v135, v135 dst_sel:WORD_0 dst_unused:UNUSED_PRESERVE src0_sel:WORD_0
v_or_b32 v236, v104, v105
v_mfma_f32_16x16x32_bf16 v[4:7], v[172:175], v[48:51], 0
v_exp_f16_sdwa v131, v131 dst_sel:WORD_1 dst_unused:UNUSED_PRESERVE src0_sel:WORD_1
v_mfma_f32_16x16x32_f16 v[164:167], v[168:171], v[36:39], v[164:167]
ds_read_b128 v[168:171], v251 offset:57344
s_setprio 3
v_mfma_f32_16x16x32_bf16 v[12:15], v[172:175], v[52:55], 0
ds_read_b128 v[172:175], v249 offset:30720
v_exp_f16_sdwa v133, v133 dst_sel:WORD_1 dst_unused:UNUSED_PRESERVE src0_sel:WORD_1
v_cvt_pkrtz_f16_f32 v129, v128, v129
v_and_b32_e64 v129, s49, v129
v_bfe_u32 v128, v129, 2, 14
v_lshrrev_b32 v129, 18, v129
ds_read_u16 v128, v128
ds_read_u16_d16_hi v129, v129
s_waitcnt lgkmcnt(8)
v_mfma_f32_16x16x32_f16 v[136:139], v[176:179], v[32:35], v[136:139]
v_exp_f16_sdwa v135, v135 dst_sel:WORD_1 dst_unused:UNUSED_PRESERVE src0_sel:WORD_1
v_mfma_f32_16x16x32_bf16 v[4:7], v[180:183], v[56:59], v[4:7]
v_pk_add_f16 v131, v131, 1.0 op_sel_hi:[1,0]
v_mfma_f32_16x16x32_f16 v[144:147], v[176:179], v[36:39], v[144:147]
ds_read_b128 v[176:179], v251 offset:60416
v_pk_add_f16 v133, v133, 1.0 op_sel_hi:[1,0]
v_pk_add_f16 v135, v135, 1.0 op_sel_hi:[1,0]
v_mfma_f32_16x16x32_bf16 v[12:15], v[180:183], v[60:63], v[12:15]
ds_read_b128 v[180:183], v249 offset:32768
v_rcp_f16_sdwa v131, v131 dst_sel:WORD_0 dst_unused:UNUSED_PRESERVE src0_sel:WORD_0
s_waitcnt lgkmcnt(7)
v_mfma_f32_16x16x32_f16 v[140:143], v[184:187], v[32:35], v[140:143]
v_rcp_f16_sdwa v133, v133 dst_sel:WORD_0 dst_unused:UNUSED_PRESERVE src0_sel:WORD_0
v_mfma_f32_16x16x32_f16 v[148:151], v[184:187], v[36:39], v[148:151]
ds_read_b128 v[184:187], v251 offset:58368
v_rcp_f16_sdwa v135, v135 dst_sel:WORD_0 dst_unused:UNUSED_PRESERVE src0_sel:WORD_0
v_mfma_f32_16x16x32_bf16 v[4:7], v[188:191], v[64:67], v[4:7]
v_rcp_f16_sdwa v131, v131 dst_sel:WORD_1 dst_unused:UNUSED_PRESERVE src0_sel:WORD_1
s_waitcnt lgkmcnt(5)
v_mfma_f32_16x16x32_f16 v[72:75], v[168:171], v[232:235], v[72:75]
v_rcp_f16_sdwa v133, v133 dst_sel:WORD_1 dst_unused:UNUSED_PRESERVE src0_sel:WORD_1
v_mfma_f32_16x16x32_bf16 v[12:15], v[188:191], v[68:71], v[12:15]
ds_read_b128 v[188:191], v249 offset:34816
v_rcp_f16_sdwa v135, v135 dst_sel:WORD_1 dst_unused:UNUSED_PRESERVE src0_sel:WORD_1
v_mfma_f32_16x16x32_f16 v[80:83], v[168:171], v[236:239], v[80:83]
ds_read_b128 v[168:171], v251 offset:61440
v_or_b32 v24, v120, v121
v_mfma_f32_16x16x32_bf16 v[96:99], v[172:175], v[48:51], 0
s_setprio 2
v_pk_mul_f16 v29, v130, v131
s_waitcnt lgkmcnt(4)
v_mfma_f32_16x16x32_f16 v[76:79], v[176:179], v[232:235], v[76:79]
v_pk_mul_f16 v30, v132, v133
v_mfma_f32_16x16x32_bf16 v[104:107], v[172:175], v[52:55], 0
ds_read_b128 v[172:175], v249 offset:30976
v_pk_mul_f16 v31, v134, v135
v_mfma_f32_16x16x32_f16 v[84:87], v[176:179], v[236:239], v[84:87]
ds_read_b128 v[176:179], v251 offset:59392
v_cvt_pkrtz_f16_f32 v1, v0, v1
v_and_b32 v1, s49, v1
v_bfe_u32 v0, v1, 2, 14
v_lshrrev_b32_e64 v1, 18, v1
ds_read_u16 v0, v0
ds_read_u16_d16_hi v1, v1
v_cvt_pk_f16_f32 v10, v10, v11
v_or_b32 v25, v122, v123
s_waitcnt lgkmcnt(6)
v_mfma_f32_16x16x32_bf16 v[96:99], v[180:183], v[56:59], v[96:99]
v_cvt_pk_f16_f32 v12, v12, v13
v_cvt_pk_f16_f32 v14, v14, v15
v_mfma_f32_16x16x32_f16 v[152:155], v[184:187], v[232:235], v[152:155]
v_pk_fma_f16 v11, v10, v10, s48
v_mfma_f32_16x16x32_bf16 v[104:107], v[180:183], v[60:63], v[104:107]
ds_read_b128 v[180:183], v251 offset:62464
v_pk_fma_f16 v13, v12, v12, s48
v_cvt_pkrtz_f16_f32 v3, v2, v3
v_and_b32_e64 v3, s49, v3
v_bfe_u32 v2, v3, 2, 14
v_lshrrev_b32 v3, 18, v3
ds_read_u16 v2, v2
ds_read_u16_d16_hi v3, v3
v_or_b32 v26, v124, v125
v_pk_fma_f16 v15, v14, v14, s48
v_mfma_f32_16x16x32_f16 v[160:163], v[184:187], v[236:239], v[160:163]
ds_read_b128 v[184:187], v249 offset:33024
v_mov_b32 v16, 0
v_mov_b32 v17, 0
v_cndmask_b32 v18, 0, v255, s[88:89]
v_cndmask_b32 v19, 0, v255, s[90:91]
v_mov_b32_e64 v20, 0
v_mov_b32 v21, 0
v_pk_mul_f16 v11, v10, v11
v_pk_mul_f16 v13, v12, v13
s_waitcnt lgkmcnt(5)
v_mfma_f32_16x16x32_bf16 v[96:99], v[188:191], v[64:67], v[96:99]
v_pk_mul_f16 v15, v14, v15
v_mfma_f32_16x16x32_f16 v[156:159], v[168:171], v[232:235], v[156:159]
v_cvt_pkrtz_f16_f32 v5, v4, v5
v_and_b32_e64 v5, s49, v5
v_bfe_u32 v4, v5, 2, 14
v_lshrrev_b32 v5, 18, v5
ds_read_u16 v4, v4
ds_read_u16_d16_hi v5, v5
v_or_b32 v27, v126, v127
v_exp_f16_sdwa v11, v11 dst_sel:WORD_0 dst_unused:UNUSED_PRESERVE src0_sel:WORD_0
v_mfma_f32_16x16x32_bf16 v[104:107], v[188:191], v[68:71], v[104:107]
ds_read_b128 v[188:191], v251 offset:63488
v_exp_f16_sdwa v13, v13 dst_sel:WORD_0 dst_unused:UNUSED_PRESERVE src0_sel:WORD_0
v_mfma_f32_16x16x32_f16 v[164:167], v[168:171], v[236:239], v[164:167]
ds_read_b128 v[168:171], v249 offset:35072
v_cvt_pkrtz_f16_f32 v7, v6, v7
v_and_b32_e64 v7, s49, v7
v_bfe_u32 v6, v7, 2, 14
v_lshrrev_b32_e64 v7, 18, v7
ds_read_u16 v6, v6
ds_read_u16_d16_hi v7, v7
v_exp_f16_sdwa v15, v15 dst_sel:WORD_0 dst_unused:UNUSED_PRESERVE src0_sel:WORD_0
v_or_b32 v28, v128, v129
v_mfma_f32_16x16x32_bf16 v[100:103], v[172:175], v[48:51], 0
v_exp_f16_sdwa v11, v11 dst_sel:WORD_1 dst_unused:UNUSED_PRESERVE src0_sel:WORD_1
v_mfma_f32_16x16x32_f16 v[136:139], v[176:179], v[232:235], v[136:139]
s_setprio 1
v_exp_f16_sdwa v13, v13 dst_sel:WORD_1 dst_unused:UNUSED_PRESERVE src0_sel:WORD_1
v_mfma_f32_16x16x32_f16 v[144:147], v[176:179], v[236:239], v[144:147]
ds_read_b128 v[176:179], v251 offset:64512
v_cvt_pkrtz_f16_f32 v9, v8, v9
v_mfma_f32_16x16x32_bf16 v[108:111], v[172:175], v[52:55], 0
ds_read_b128 v[172:175], v252 offset:1024
v_and_b32_e64 v9, s49, v9
v_bfe_u32 v8, v9, 2, 14
v_lshrrev_b32 v9, 18, v9
ds_read_u16 v8, v8
ds_read_u16_d16_hi v9, v9
v_exp_f16_sdwa v15, v15 dst_sel:WORD_1 dst_unused:UNUSED_PRESERVE src0_sel:WORD_1
s_waitcnt lgkmcnt(7)
v_mfma_f32_16x16x32_f16 v[140:143], v[180:183], v[232:235], v[140:143]
v_pk_add_f16 v11, v11, 1.0 op_sel_hi:[1,0]
v_mfma_f32_16x16x32_bf16 v[100:103], v[184:187], v[56:59], v[100:103]
v_pk_add_f16 v13, v13, 1.0 op_sel_hi:[1,0]
v_mfma_f32_16x16x32_f16 v[148:151], v[180:183], v[236:239], v[148:151]
ds_read_b128 v[180:183], v252 offset:2048
v_pk_add_f16 v15, v15, 1.0 op_sel_hi:[1,0]
v_mfma_f32_16x16x32_bf16 v[108:111], v[184:187], v[60:63], v[108:111]
ds_read_b128 v[184:187], v252
v_rcp_f16_sdwa v11, v11 dst_sel:WORD_0 dst_unused:UNUSED_PRESERVE src0_sel:WORD_0
s_waitcnt vmcnt(8)
v_mfma_f32_16x16x32_bf16 v[72:75], v[18:21], v[192:195], v[72:75]
v_rcp_f16_sdwa v13, v13 dst_sel:WORD_0 dst_unused:UNUSED_PRESERVE src0_sel:WORD_0
v_mfma_f32_16x16x32_bf16 v[76:79], v[16:19], v[192:195], v[76:79]
v_rcp_f16_sdwa v15, v15 dst_sel:WORD_0 dst_unused:UNUSED_PRESERVE src0_sel:WORD_0
s_waitcnt vmcnt(6)
v_mfma_f32_16x16x32_bf16 v[80:83], v[18:21], v[196:199], v[80:83]
v_rcp_f16_sdwa v11, v11 dst_sel:WORD_1 dst_unused:UNUSED_PRESERVE src0_sel:WORD_1
v_mfma_f32_16x16x32_bf16 v[84:87], v[16:19], v[196:199], v[84:87]
v_rcp_f16_sdwa v13, v13 dst_sel:WORD_1 dst_unused:UNUSED_PRESERVE src0_sel:WORD_1
v_mfma_f32_16x16x32_f16 v[72:75], v[188:191], v[24:27], v[72:75]
v_rcp_f16_sdwa v15, v15 dst_sel:WORD_1 dst_unused:UNUSED_PRESERVE src0_sel:WORD_1
s_waitcnt lgkmcnt(3)
v_mfma_f32_16x16x32_bf16 v[100:103], v[168:171], v[64:67], v[100:103]
v_or_b32 v40, v0, v1
v_mfma_f32_16x16x32_f16 v[80:83], v[188:191], v[28:31], v[80:83]
ds_read_b128 v[188:191], v252 offset:3072
v_pk_mul_f16 v45, v10, v11
v_mfma_f32_16x16x32_bf16 v[108:111], v[168:171], v[68:71], v[108:111]
ds_read_b128 v[168:171], v252 offset:4096
v_pk_mul_f16 v46, v12, v13
v_mfma_f32_16x16x32_f16 v[76:79], v[172:175], v[24:27], v[76:79]
v_pk_mul_f16 v47, v14, v15
v_mfma_f32_16x16x32_f16 v[84:87], v[172:175], v[28:31], v[84:87]
ds_read_b128 v[172:175], v252 offset:7168
s_setprio 0
v_mfma_f32_16x16x32_f16 v[152:155], v[176:179], v[24:27], v[152:155]
v_cvt_pkrtz_f16_f32 v97, v96, v97
v_and_b32 v97, s49, v97
v_bfe_u32 v96, v97, 2, 14
v_lshrrev_b32 v97, 18, v97
ds_read_u16 v96, v96
ds_read_u16_d16_hi v97, v97
v_cvt_pk_f16_f32 v106, v106, v107
v_or_b32 v41, v2, v3
v_cvt_pk_f16_f32 v108, v108, v109
v_mfma_f32_16x16x32_f16 v[160:163], v[176:179], v[28:31], v[160:163]
v_cvt_pk_f16_f32 v110, v110, v111
ds_read_b128 v[176:179], v252 offset:5120
v_pk_fma_f16 v107, v106, v106, s48
v_pk_fma_f16 v109, v108, v108, s48
s_waitcnt lgkmcnt(5)
v_mfma_f32_16x16x32_f16 v[156:159], v[180:183], v[24:27], v[156:159]
v_cvt_pkrtz_f16_f32 v99, v98, v99
v_and_b32 v99, s49, v99
v_bfe_u32 v98, v99, 2, 14
v_lshrrev_b32 v99, 18, v99
ds_read_u16 v98, v98
ds_read_u16_d16_hi v99, v99
v_or_b32 v42, v4, v5
v_pk_fma_f16 v111, v110, v110, s48
v_pk_mul_f16 v107, v106, v107
v_mfma_f32_16x16x32_f16 v[164:167], v[180:183], v[28:31], v[164:167]
v_pk_mul_f16 v109, v108, v109
ds_read_b128 v[180:183], v252 offset:8192
v_pk_mul_f16 v111, v110, v111
v_cvt_pkrtz_f16_f32 v101, v100, v101
v_and_b32_e64 v101, s49, v101
v_bfe_u32 v100, v101, 2, 14
v_lshrrev_b32 v101, 18, v101
ds_read_u16 v100, v100
ds_read_u16_d16_hi v101, v101
v_or_b32 v43, v6, v7
v_exp_f16_sdwa v107, v107 dst_sel:WORD_0 dst_unused:UNUSED_PRESERVE src0_sel:WORD_0
v_mfma_f32_16x16x32_f16 v[136:139], v[184:187], v[24:27], v[136:139]
v_exp_f16_sdwa v109, v109 dst_sel:WORD_0 dst_unused:UNUSED_PRESERVE src0_sel:WORD_0
v_mfma_f32_16x16x32_f16 v[144:147], v[184:187], v[28:31], v[144:147]
v_cvt_pkrtz_f16_f32 v103, v102, v103
v_and_b32_e64 v103, s49, v103
v_bfe_u32 v102, v103, 2, 14
v_lshrrev_b32_e64 v103, 18, v103
ds_read_u16 v102, v102
ds_read_u16_d16_hi v103, v103
v_exp_f16_sdwa v111, v111 dst_sel:WORD_0 dst_unused:UNUSED_PRESERVE src0_sel:WORD_0
v_or_b32 v44, v8, v9
ds_read_b128 v[184:187], v252 offset:6144
v_exp_f16_sdwa v107, v107 dst_sel:WORD_1 dst_unused:UNUSED_PRESERVE src0_sel:WORD_1
v_mfma_f32_16x16x32_f16 v[140:143], v[188:191], v[24:27], v[140:143]
s_setprio 3
v_exp_f16_sdwa v109, v109 dst_sel:WORD_1 dst_unused:UNUSED_PRESERVE src0_sel:WORD_1
v_cvt_pkrtz_f16_f32 v105, v104, v105
v_and_b32_e64 v105, s49, v105
v_bfe_u32 v104, v105, 2, 14
v_lshrrev_b32 v105, 18, v105
ds_read_u16 v104, v104
ds_read_u16_d16_hi v105, v105
v_mfma_f32_16x16x32_f16 v[148:151], v[188:191], v[28:31], v[148:151]
v_exp_f16_sdwa v111, v111 dst_sel:WORD_1 dst_unused:UNUSED_PRESERVE src0_sel:WORD_1
ds_read_b128 v[188:191], v252 offset:9216
s_waitcnt vmcnt(5)
v_mfma_f32_16x16x32_bf16 v[152:155], v[18:21], v[240:243], v[152:155]
v_pk_add_f16 v107, v107, 1.0 op_sel_hi:[1,0]
v_mfma_f32_16x16x32_bf16 v[156:159], v[16:19], v[240:243], v[156:159]
v_pk_add_f16 v109, v109, 1.0 op_sel_hi:[1,0]
s_waitcnt vmcnt(3)
v_mfma_f32_16x16x32_bf16 v[160:163], v[18:21], v[244:247], v[160:163]
v_pk_add_f16 v111, v111, 1.0 op_sel_hi:[1,0]
v_mfma_f32_16x16x32_bf16 v[164:167], v[16:19], v[244:247], v[164:167]
v_rcp_f16_sdwa v107, v107 dst_sel:WORD_0 dst_unused:UNUSED_PRESERVE src0_sel:WORD_0
s_waitcnt lgkmcnt(5)
v_mfma_f32_16x16x32_f16 v[72:75], v[168:171], v[40:43], v[72:75]
v_rcp_f16_sdwa v109, v109 dst_sel:WORD_0 dst_unused:UNUSED_PRESERVE src0_sel:WORD_0
v_mfma_f32_16x16x32_f16 v[80:83], v[168:171], v[44:47], v[80:83]
ds_read_b128 v[168:171], v252 offset:10240
v_rcp_f16_sdwa v111, v111 dst_sel:WORD_0 dst_unused:UNUSED_PRESERVE src0_sel:WORD_0
v_mfma_f32_16x16x32_f16 v[76:79], v[172:175], v[40:43], v[76:79]
v_rcp_f16_sdwa v107, v107 dst_sel:WORD_1 dst_unused:UNUSED_PRESERVE src0_sel:WORD_1
v_mfma_f32_16x16x32_f16 v[84:87], v[172:175], v[44:47], v[84:87]
ds_read_b128 v[172:175], v252 offset:13312
v_rcp_f16_sdwa v109, v109 dst_sel:WORD_1 dst_unused:UNUSED_PRESERVE src0_sel:WORD_1
v_mfma_f32_16x16x32_f16 v[152:155], v[176:179], v[40:43], v[152:155]
v_rcp_f16_sdwa v111, v111 dst_sel:WORD_1 dst_unused:UNUSED_PRESERVE src0_sel:WORD_1
v_or_b32 v88, v96, v97
v_pk_mul_f16 v93, v106, v107
s_setprio 2
v_mfma_f32_16x16x32_f16 v[160:163], v[176:179], v[44:47], v[160:163]
ds_read_b128 v[176:179], v252 offset:11264
v_pk_mul_f16 v94, v108, v109
v_pk_mul_f16 v95, v110, v111
v_mfma_f32_16x16x32_f16 v[156:159], v[180:183], v[40:43], v[156:159]
v_or_b32 v89, v98, v99
v_mfma_f32_16x16x32_f16 v[164:167], v[180:183], v[44:47], v[164:167]
ds_read_b128 v[180:183], v252 offset:14336
v_or_b32 v90, v100, v101
s_waitcnt lgkmcnt(3)
v_mfma_f32_16x16x32_f16 v[136:139], v[184:187], v[40:43], v[136:139]
v_or_b32 v91, v102, v103
v_mfma_f32_16x16x32_f16 v[144:147], v[184:187], v[44:47], v[144:147]
ds_read_b128 v[184:187], v252 offset:12288
v_or_b32 v92, v104, v105
v_mfma_f32_16x16x32_f16 v[140:143], v[188:191], v[40:43], v[140:143]
v_mfma_f32_16x16x32_f16 v[148:151], v[188:191], v[44:47], v[148:151]
ds_read_b128 v[188:191], v252 offset:15360
s_setprio 1
s_waitcnt vmcnt(2)
v_mfma_f32_16x16x32_bf16 v[136:139], v[18:21], v[112:115], v[136:139]
v_mfma_f32_16x16x32_bf16 v[140:143], v[16:19], v[112:115], v[140:143]
s_waitcnt vmcnt(0)
v_mfma_f32_16x16x32_bf16 v[144:147], v[18:21], v[116:119], v[144:147]
v_mfma_f32_16x16x32_bf16 v[148:151], v[16:19], v[116:119], v[148:151]
v_mfma_f32_16x16x32_f16 v[72:75], v[168:171], v[88:91], v[72:75]
v_mfma_f32_16x16x32_f16 v[80:83], v[168:171], v[92:95], v[80:83]
s_waitcnt lgkmcnt(2)
v_mfma_f32_16x16x32_f16 v[76:79], v[172:175], v[88:91], v[76:79]
v_mfma_f32_16x16x32_f16 v[84:87], v[172:175], v[92:95], v[84:87]
s_nop 3
v_cvt_pk_bf16_f32 v72, v72, v73
v_mfma_f32_16x16x32_f16 v[152:155], v[176:179], v[88:91], v[152:155]
v_cvt_pk_bf16_f32 v73, v74, v75
v_mfma_f32_16x16x32_f16 v[160:163], v[176:179], v[92:95], v[160:163]
v_cvt_pk_bf16_f32 v74, v76, v77
v_cvt_pk_bf16_f32 v75, v78, v79
v_cvt_pk_bf16_f32 v76, v80, v81
v_cvt_pk_bf16_f32 v77, v82, v83
v_cvt_pk_bf16_f32 v78, v84, v85
v_cvt_pk_bf16_f32 v79, v86, v87
v_mfma_f32_16x16x32_f16 v[156:159], v[180:183], v[88:91], v[156:159]
v_cvt_pk_bf16_f32 v152, v152, v153
v_cvt_pk_bf16_f32 v153, v154, v155
v_mfma_f32_16x16x32_f16 v[164:167], v[180:183], v[92:95], v[164:167]
s_waitcnt lgkmcnt(0)
v_mfma_f32_16x16x32_f16 v[136:139], v[184:187], v[88:91], v[136:139]
s_nop 2
v_cvt_pk_bf16_f32 v154, v156, v157
v_cvt_pk_bf16_f32 v155, v158, v159
v_cvt_pk_bf16_f32 v156, v160, v161
v_cvt_pk_bf16_f32 v157, v162, v163
v_cvt_pk_bf16_f32 v158, v164, v165
v_cvt_pk_bf16_f32 v159, v166, v167
v_mfma_f32_16x16x32_f16 v[144:147], v[184:187], v[92:95], v[144:147]
v_cvt_pk_bf16_f32 v136, v136, v137
v_cvt_pk_bf16_f32 v137, v138, v139
s_setprio 0
v_mfma_f32_16x16x32_f16 v[140:143], v[188:191], v[88:91], v[140:143]
v_mfma_f32_16x16x32_f16 v[148:151], v[188:191], v[92:95], v[148:151]
s_nop 6
v_cvt_pk_bf16_f32 v138, v140, v141
v_cvt_pk_bf16_f32 v139, v142, v143
v_cvt_pk_bf16_f32 v140, v144, v145
v_cvt_pk_bf16_f32 v141, v146, v147
v_cvt_pk_bf16_f32 v142, v148, v149
v_cvt_pk_bf16_f32 v143, v150, v151
buffer_store_dwordx4 v[72:75], v253, s[8:11], s68 offen sc1
buffer_store_dwordx4 v[76:79], v253, s[8:11], s68 offen offset:192 sc1
buffer_store_dwordx4 v[152:155], v253, s[8:11], s68 offen offset:64 sc1
buffer_store_dwordx4 v[156:159], v253, s[8:11], s68 offen offset:256 sc1
buffer_store_dwordx4 v[136:139], v253, s[8:11], s68 offen offset:128 sc1
buffer_store_dwordx4 v[140:143], v253, s[8:11], s68 offen offset:320 sc1
s_endpgm
Lpoll:
s_waitcnt vmcnt(0)
s_cmp_eq_u32 s77, 2
s_cbranch_scc1 LpollC
v_max_u32 v241, v152, v153
v_max3_u32 v241, v241, v154, v155
v_max3_u32 v241, v241, v156, v157
v_max3_u32 v241, v241, v158, v159
v_max3_u32 v241, v241, v160, v161
v_max3_u32 v241, v241, v162, v163
v_max3_u32 v241, v241, v164, v165
v_max3_u32 v241, v241, v166, v167
v_cmp_eq_u32 vcc, -1, v241
s_nop 4
s_cbranch_vccz LpollR
s_lshl_b32 s44, s2, 12
buffer_load_dwordx4 v[152:155], v245, s[32:35], s44 offen sc1
buffer_load_dwordx4 v[156:159], v245, s[32:35], s44 offen offset:1024 sc1
buffer_load_dwordx4 v[160:163], v245, s[32:35], s44 offen offset:2048 sc1
buffer_load_dwordx4 v[164:167], v245, s[32:35], s44 offen offset:3072 sc1
s_setpc_b64 s[78:79]
LpollR:
v_add_f32 v152, v152, v156
v_add_f32 v164, v160, v164
v_add_f32 v164, v152, v164
v_add_f32 v153, v153, v157
v_add_f32 v165, v161, v165
v_add_f32 v165, v153, v165
v_add_f32 v154, v154, v158
v_add_f32 v166, v162, v166
v_add_f32 v166, v154, v166
v_add_f32 v155, v155, v159
v_add_f32 v167, v163, v167
v_add_f32 v167, v155, v167
v_add_f32_dpp v164, v164, v164 row_ror:8 row_mask:0xf bank_mask:0xf
s_nop 1
v_add_f32_dpp v164, v164, v164 row_ror:4 row_mask:0xf bank_mask:0xf
s_nop 1
v_add_f32_dpp v164, v164, v164 row_ror:2 row_mask:0xf bank_mask:0xf
s_nop 1
v_add_f32_dpp v164, v164, v164 row_ror:1 row_mask:0xf bank_mask:0xf
v_mov_b32 v241, v164
s_nop 1
v_permlane16_swap_b32 v164, v241
v_add_f32 v164, v164, v241
v_mov_b32 v241, v164
s_nop 1
v_permlane32_swap_b32 v164, v241
v_add_f32 v164, v164, v241
v_min_u32 v164, -2, v164
v_add_f32_dpp v165, v165, v165 row_ror:8 row_mask:0xf bank_mask:0xf
s_nop 1
v_add_f32_dpp v165, v165, v165 row_ror:4 row_mask:0xf bank_mask:0xf
s_nop 1
v_add_f32_dpp v165, v165, v165 row_ror:2 row_mask:0xf bank_mask:0xf
s_nop 1
v_add_f32_dpp v165, v165, v165 row_ror:1 row_mask:0xf bank_mask:0xf
v_mov_b32 v241, v165
s_nop 1
v_permlane16_swap_b32 v165, v241
v_add_f32 v165, v165, v241
v_mov_b32 v241, v165
s_nop 1
v_permlane32_swap_b32 v165, v241
v_add_f32 v165, v165, v241
v_min_u32 v165, -2, v165
v_add_f32_dpp v166, v166, v166 row_ror:8 row_mask:0xf bank_mask:0xf
s_nop 1
v_add_f32_dpp v166, v166, v166 row_ror:4 row_mask:0xf bank_mask:0xf
s_nop 1
v_add_f32_dpp v166, v166, v166 row_ror:2 row_mask:0xf bank_mask:0xf
s_nop 1
v_add_f32_dpp v166, v166, v166 row_ror:1 row_mask:0xf bank_mask:0xf
v_mov_b32 v241, v166
s_nop 1
v_permlane16_swap_b32 v166, v241
v_add_f32 v166, v166, v241
v_mov_b32 v241, v166
s_nop 1
v_permlane32_swap_b32 v166, v241
v_add_f32 v166, v166, v241
v_min_u32 v166, -2, v166
v_add_f32_dpp v167, v167, v167 row_ror:8 row_mask:0xf bank_mask:0xf
s_nop 1
v_add_f32_dpp v167, v167, v167 row_ror:4 row_mask:0xf bank_mask:0xf
s_nop 1
v_add_f32_dpp v167, v167, v167 row_ror:2 row_mask:0xf bank_mask:0xf
s_nop 1
v_add_f32_dpp v167, v167, v167 row_ror:1 row_mask:0xf bank_mask:0xf
v_mov_b32 v241, v167
s_nop 1
v_permlane16_swap_b32 v167, v241
v_add_f32 v167, v167, v241
v_mov_b32 v241, v167
s_nop 1
v_permlane32_swap_b32 v167, v241
v_add_f32_e64 v167, v167, v241
v_min_u32 v167, -2, v167
s_lshl_b32 s44, s2, 4
s_add_u32 s44, s44, 393216
v_lshlrev_b32_e64 v241, 9, v240
s_mov_b64 exec, 0xff
buffer_store_dwordx4 v[164:167], v241, s[32:35], s44 offen sc1
s_mov_b64 exec, -1
s_mov_b32 s77, 2
s_and_b32 s44, s2, 7
s_lshl_b32 s44, s44, 11
s_add_u32 s44, s44, 393216
buffer_load_dword v152, v240, s[32:35], s44 offen sc1
buffer_load_dword v153, v240, s[32:35], s44 offen offset:256 sc1
buffer_load_dword v154, v240, s[32:35], s44 offen offset:512 sc1
buffer_load_dword v155, v240, s[32:35], s44 offen offset:768 sc1
buffer_load_dword v156, v240, s[32:35], s44 offen offset:1024 sc1
buffer_load_dword v157, v240, s[32:35], s44 offen offset:1280 sc1
v_lshrrev_b32 v241, 1, v240
buffer_load_ushort v158, v241, s[24:27], 0 offen
buffer_load_ushort v159, v241, s[24:27], 0 offen offset:128
buffer_load_ushort v160, v241, s[24:27], 0 offen offset:256
buffer_load_ushort v161, v241, s[24:27], 0 offen offset:384
buffer_load_ushort v162, v241, s[24:27], 0 offen offset:512
buffer_load_ushort v163, v241, s[24:27], 0 offen offset:640
s_setpc_b64 s[78:79]
LpollC:
v_max3_u32 v241, v152, v153, v154
v_max3_u32 v241, v241, v155, v156
v_max_u32 v241, v241, v157
v_cmp_eq_u32 vcc, -1, v241
s_nop 4
s_cbranch_vccz LpollS
s_and_b32 s44, s2, 7
s_lshl_b32 s44, s44, 11
s_add_u32 s44, s44, 393216
buffer_load_dword v152, v240, s[32:35], s44 offen sc1
buffer_load_dword v153, v240, s[32:35], s44 offen offset:256 sc1
buffer_load_dword v154, v240, s[32:35], s44 offen offset:512 sc1
buffer_load_dword v155, v240, s[32:35], s44 offen offset:768 sc1
buffer_load_dword v156, v240, s[32:35], s44 offen offset:1024 sc1
buffer_load_dword v157, v240, s[32:35], s44 offen offset:1280 sc1
s_setpc_b64 s[78:79]
LpollS:
s_mov_b32 s43, 1083289508
v_mov_b32 v242, 897988541
v_fma_f32 v152, v152, s43, v242
v_sqrt_f32 v152, v152
v_lshlrev_b32_e64 v158, 16, v158
v_fma_f32 v153, v153, s43, v242
v_sqrt_f32 v153, v153
v_lshlrev_b32 v159, 16, v159
v_fma_f32 v154, v154, s43, v242
v_sqrt_f32 v154, v154
v_lshlrev_b32 v160, 16, v160
v_fma_f32 v155, v155, s43, v242
v_sqrt_f32 v155, v155
v_lshlrev_b32 v161, 16, v161
v_fma_f32 v156, v156, s43, v242
v_sqrt_f32 v156, v156
v_lshlrev_b32 v162, 16, v162
v_fma_f32 v157, v157, s43, v242
v_sqrt_f32 v157, v157
v_lshlrev_b32 v163, 16, v163
v_add_f32 v243, v152, v153
v_add_f32 v243, v243, v154
v_add_f32 v243, v243, v155
v_add_f32 v243, v243, v156
v_add_f32 v243, v243, v157
s_nop 1
v_add_f32_dpp v243, v243, v243 row_ror:8 row_mask:0xf bank_mask:0xf
s_nop 1
v_add_f32_dpp v243, v243, v243 row_ror:4 row_mask:0xf bank_mask:0xf
s_nop 1
v_add_f32_dpp v243, v243, v243 row_ror:2 row_mask:0xf bank_mask:0xf
s_nop 1
v_add_f32_dpp v243, v243, v243 row_ror:1 row_mask:0xf bank_mask:0xf
v_mov_b32 v241, v243
s_nop 1
v_permlane16_swap_b32 v243, v241
v_add_f32 v243, v243, v241
v_mov_b32 v241, v243
s_nop 1
v_permlane32_swap_b32 v243, v241
v_add_f32_e64 v243, v243, v241
s_mov_b32 s43, 992651947
v_fma_f32 v243, v243, s43, v242
v_rcp_f32 v243, v243
s_nop 0
v_mul_f32_e64 v152, v152, v243
v_fma_f32 v152, v152, v158, 1.0
v_mul_f32 v152, 3221786265, v152
v_mul_f32_e64 v153, v153, v243
v_fma_f32 v153, v153, v159, 1.0
v_mul_f32 v153, 3221786265, v153
v_mul_f32_e64 v154, v154, v243
v_fma_f32 v154, v154, v160, 1.0
v_mul_f32 v154, 3221786265, v154
v_mul_f32_e64 v155, v155, v243
v_fma_f32 v155, v155, v161, 1.0
v_mul_f32 v155, 3221786265, v155
v_mul_f32_e64 v156, v156, v243
v_fma_f32 v156, v156, v162, 1.0
v_mul_f32 v156, 3221786265, v156
v_mul_f32_e64 v157, v157, v243
v_fma_f32 v157, v157, v163, 1.0
v_mul_f32 v157, 3221786265, v157
s_mov_b32 s77, 0
s_nop 1
s_setpc_b64 s[78:79]
Lend:
s_endpgm

.section .rodata,"a"
.p2align 6
.amdhsa_kernel standalone__modern_conv_block_convnext_v2__vision_kernel
  .amdhsa_next_free_vgpr 256
  .amdhsa_next_free_sgpr 102
  .amdhsa_accum_offset 256
  .amdhsa_group_segment_fixed_size 0
  .amdhsa_kernarg_size 72
  .amdhsa_user_sgpr_count 2
  .amdhsa_user_sgpr_kernarg_segment_ptr 1
  .amdhsa_system_sgpr_workgroup_id_x 1
.end_amdhsa_kernel
```

```asm
; @launch grid=(256,1,1) block=(512,1,1) lds=163840
.amdgcn_target "amdgcn-amd-amdhsa--gfx950"
.text
.globl standalone__modern_conv_block_convnext_v2__vision_kernel
.p2align 8
.type standalone__modern_conv_block_convnext_v2__vision_kernel,@function
standalone__modern_conv_block_convnext_v2__vision_kernel:
s_cmp_ge_u32 s2, 256
s_cbranch_scc1 Lend
s_load_dwordx16 s[80:95], s[0:1], 0
s_load_dwordx2 s[96:97], s[0:1], 64
v_mov_b32 v119, v0
v_and_b32 v118, 63, v0
v_lshrrev_b32 v120, 6, v0
s_nop 0
v_readfirstlane_b32 s40, v120
s_getpc_b64 s[74:75]
Lpc:
s_lshr_b32 s43, s2, 3
s_and_b32 s43, s43, 15
s_lshl_b32 s43, s43, 13
v_lshrrev_b32_e64 v122, 3, v0
v_lshl_add_u32 v122, v122, 7, s43
v_min_u32 v122, Lend-Lpc, v122
global_load_dword v112, v122, s[74:75]
s_and_b32 s43, s2, 7
s_lshr_b32 s44, s2, 3
s_and_b32 s41, s43, 3
s_lshl_b32 s41, s41, 2
s_and_b32 s45, s44, 3
s_add_u32 s41, s41, s45
s_lshr_b32 s42, s43, 2
s_lshl_b32 s42, s42, 3
s_lshr_b32 s45, s44, 2
s_add_u32 s42, s42, s45
s_lshl_b32 s41, s41, 5
s_lshl_b32 s42, s42, 5
s_and_b32 s43, s40, 3
s_mul_i32 s43, s43, 1536
s_add_u32 s67, s43, 90112
s_mul_i32 s44, s41, 192
s_add_u32 s43, s43, s44
s_sub_u32 s43, s43, 192
v_lshl_add_u32 v121, v118, 4, s43
v_add_u32 v123, 896, v121
v_mov_b32 v122, 2147483648
s_mov_b32 s44, 98304
v_cmp_gt_u32 vcc, s44, v121
s_nop 1
v_cndmask_b32 v236, v122, v121, vcc
v_cmp_gt_u32 vcc, s44, v123
s_nop 1
v_cndmask_b32 v237, v122, v123, vcc
s_mul_i32 s66, s42, 98304
v_min_u32 v128, 215, v119
v_lshlrev_b32_e64 v130, 3, v128
v_lshlrev_b32 v250, 4, v118
s_waitcnt lgkmcnt(0)
s_mov_b32 s4, s80
s_and_b32 s5, s81, 65535
s_mov_b32 s6, 50331648
s_mov_b32 s7, 131072
s_cmp_ge_u32 s40, 4
s_cbranch_scc1 Lrowb
s_mov_b32 s20, s82
s_and_b32 s21, s83, 65535
s_mov_b32 s22, 1728
s_mov_b32 s23, 131072
buffer_load_dwordx2 v[126:127], v130, s[20:23], 0 offen
s_add_u32 m0, s67, 0
s_sub_u32 s45, s66, 98304
s_cmp_eq_u32 s42, 0
s_cselect_b32 s45, 1073741824, s45
buffer_load_dwordx4 v236, s[4:7], s45 offen lds
s_add_u32 m0, s67, 6592
s_nop 0
buffer_load_dwordx4 v236, s[4:7], s66 offen lds
s_add_u32 m0, s67, 13200
s_add_u32 s66, s66, 98304
buffer_load_dwordx4 v236, s[4:7], s66 offen lds
s_add_u32 m0, s67, 19792
s_add_u32 s66, s66, 98304
buffer_load_dwordx4 v236, s[4:7], s66 offen lds
s_add_u32 m0, s67, 26400
s_add_u32 s66, s66, 98304
buffer_load_dwordx4 v236, s[4:7], s66 offen lds
s_add_u32 m0, s67, 32992
s_add_u32 s66, s66, 98304
buffer_load_dwordx4 v236, s[4:7], s66 offen lds
s_add_u32 m0, s67, 39600
s_add_u32 s66, s66, 98304
buffer_load_dwordx4 v236, s[4:7], s66 offen lds
s_add_u32 m0, s67, 46192
s_add_u32 s66, s66, 98304
buffer_load_dwordx4 v236, s[4:7], s66 offen lds
s_add_u32 m0, s67, 52736
s_add_u32 s66, s66, 98304
buffer_load_dwordx4 v236, s[4:7], s66 offen lds
s_add_u32 m0, s67, 59328
s_add_u32 s66, s66, 98304
buffer_load_dwordx4 v236, s[4:7], s66 offen lds
s_branch Lsetup
Lrowb:
s_add_u32 m0, s67, 896
s_sub_u32 s45, s66, 98304
s_cmp_eq_u32 s42, 0
s_cselect_b32 s45, 1073741824, s45
buffer_load_dwordx4 v237, s[4:7], s45 offen lds
s_add_u32 m0, s67, 7488
s_nop 0
buffer_load_dwordx4 v237, s[4:7], s66 offen lds
s_add_u32 m0, s67, 14096
s_add_u32 s66, s66, 98304
buffer_load_dwordx4 v237, s[4:7], s66 offen lds
s_add_u32 m0, s67, 20688
s_add_u32 s66, s66, 98304
buffer_load_dwordx4 v237, s[4:7], s66 offen lds
s_add_u32 m0, s67, 27296
s_add_u32 s66, s66, 98304
buffer_load_dwordx4 v237, s[4:7], s66 offen lds
s_add_u32 m0, s67, 33888
s_add_u32 s66, s66, 98304
buffer_load_dwordx4 v237, s[4:7], s66 offen lds
s_add_u32 m0, s67, 40496
s_add_u32 s66, s66, 98304
buffer_load_dwordx4 v237, s[4:7], s66 offen lds
s_add_u32 m0, s67, 47088
s_add_u32 s66, s66, 98304
buffer_load_dwordx4 v237, s[4:7], s66 offen lds
s_add_u32 m0, s67, 53632
s_add_u32 s66, s66, 98304
buffer_load_dwordx4 v237, s[4:7], s66 offen lds
s_add_u32 m0, s67, 60224
s_add_u32 s66, s66, 98304
buffer_load_dwordx4 v237, s[4:7], s66 offen lds
s_mov_b32 s12, s84
s_and_b32 s13, s85, 65535
s_mov_b32 s14, 73728
s_mov_b32 s15, 131072
v_lshrrev_b32 v115, 2, v118
v_mul_u32_u24 v115, 768, v115
v_and_b32_e64 v125, 3, v118
v_lshl_add_u32 v115, v125, 4, v115
s_and_b32 s43, s40, 3
s_add_u32 s43, s43, 0
s_mul_i32 s44, s43, 43
s_lshr_b32 s44, s44, 8
s_lshl_b32 s46, s43, 10
s_add_u32 m0, s46, 16384
s_mul_i32 s46, s44, 6
s_sub_u32 s43, s43, s46
s_mul_i32 s43, s43, 12288
s_lshl_b32 s44, s44, 6
s_add_u32 s43, s43, s44
buffer_load_dwordx4 v115, s[12:15], s43 offen lds
s_and_b32 s43, s40, 3
s_add_u32 s43, s43, 4
s_mul_i32 s44, s43, 43
s_lshr_b32 s44, s44, 8
s_lshl_b32 s46, s43, 10
s_add_u32 m0, s46, 16384
s_mul_i32 s46, s44, 6
s_sub_u32 s43, s43, s46
s_mul_i32 s43, s43, 12288
s_lshl_b32 s44, s44, 6
s_add_u32 s43, s43, s44
buffer_load_dwordx4 v115, s[12:15], s43 offen lds
s_and_b32 s43, s40, 3
s_add_u32 s43, s43, 8
s_mul_i32 s44, s43, 43
s_lshr_b32 s44, s44, 8
s_lshl_b32 s46, s43, 10
s_add_u32 m0, s46, 16384
s_mul_i32 s46, s44, 6
s_sub_u32 s43, s43, s46
s_mul_i32 s43, s43, 12288
s_lshl_b32 s44, s44, 6
s_add_u32 s43, s43, s44
buffer_load_dwordx4 v115, s[12:15], s43 offen lds
s_and_b32 s43, s40, 3
s_add_u32 s43, s43, 12
s_mul_i32 s44, s43, 43
s_lshr_b32 s44, s44, 8
s_lshl_b32 s46, s43, 10
s_add_u32 m0, s46, 16384
s_mul_i32 s46, s44, 6
s_sub_u32 s43, s43, s46
s_mul_i32 s43, s43, 12288
s_lshl_b32 s44, s44, 6
s_add_u32 s43, s43, s44
buffer_load_dwordx4 v115, s[12:15], s43 offen lds
s_and_b32 s43, s40, 3
s_add_u32 s43, s43, 16
s_mul_i32 s44, s43, 43
s_lshr_b32 s44, s44, 8
s_lshl_b32 s46, s43, 10
s_add_u32 m0, s46, 16384
s_mul_i32 s46, s44, 6
s_sub_u32 s43, s43, s46
s_mul_i32 s43, s43, 12288
s_lshl_b32 s44, s44, 6
s_add_u32 s43, s43, s44
buffer_load_dwordx4 v115, s[12:15], s43 offen lds
s_and_b32 s43, s40, 3
s_add_u32 s43, s43, 20
s_mul_i32 s44, s43, 43
s_lshr_b32 s44, s44, 8
s_lshl_b32 s46, s43, 10
s_add_u32 m0, s46, 16384
s_mul_i32 s46, s44, 6
s_sub_u32 s43, s43, s46
s_mul_i32 s43, s43, 12288
s_lshl_b32 s44, s44, 6
s_add_u32 s43, s43, s44
buffer_load_dwordx4 v115, s[12:15], s43 offen lds
v_bfe_u32 v141, v250, 4, 6
v_and_b32 v140, 15, v141
v_lshlrev_b32 v140, 7, v140
v_lshrrev_b32 v141, 4, v141
v_mul_u32_u24 v141, 98304, v141
s_sub_u32 s43, s67, -8000
s_mul_i32 s44, s41, 192
s_add_u32 s43, s43, s44
v_add3_u32 v140, v140, v141, s43
s_mov_b32 m0, 163840
s_add_u32 s44, s66, 393216
buffer_load_dword v140, s[4:7], s66 offen lds
buffer_load_dword v140, s[4:7], s44 offen lds
s_waitcnt vmcnt(8)
s_barrier
s_setprio 0
s_and_b32 s43, s40, 3
s_add_u32 s43, s43, 24
s_mul_i32 s44, s43, 43
s_lshr_b32 s44, s44, 8
s_lshl_b32 s46, s43, 10
s_add_u32 m0, s46, 16384
s_mul_i32 s46, s44, 6
s_sub_u32 s43, s43, s46
s_mul_i32 s43, s43, 12288
s_lshl_b32 s44, s44, 6
s_add_u32 s43, s43, s44
buffer_load_dwordx4 v115, s[12:15], s43 offen lds
s_and_b32 s43, s40, 3
s_add_u32 s43, s43, 28
s_mul_i32 s44, s43, 43
s_lshr_b32 s44, s44, 8
s_lshl_b32 s46, s43, 10
s_add_u32 m0, s46, 16384
s_mul_i32 s46, s44, 6
s_sub_u32 s43, s43, s46
s_mul_i32 s43, s43, 12288
s_lshl_b32 s44, s44, 6
s_add_u32 s43, s43, s44
buffer_load_dwordx4 v115, s[12:15], s43 offen lds
s_and_b32 s43, s40, 3
s_add_u32 s43, s43, 32
s_mul_i32 s44, s43, 43
s_lshr_b32 s44, s44, 8
s_lshl_b32 s46, s43, 10
s_add_u32 m0, s46, 16384
s_mul_i32 s46, s44, 6
s_sub_u32 s43, s43, s46
s_mul_i32 s43, s43, 12288
s_lshl_b32 s44, s44, 6
s_add_u32 s43, s43, s44
buffer_load_dwordx4 v115, s[12:15], s43 offen lds
s_and_b32 s43, s40, 3
s_add_u32 s43, s43, 36
s_mul_i32 s44, s43, 43
s_lshr_b32 s44, s44, 8
s_lshl_b32 s46, s43, 10
s_add_u32 m0, s46, 16384
s_mul_i32 s46, s44, 6
s_sub_u32 s43, s43, s46
s_mul_i32 s43, s43, 12288
s_lshl_b32 s44, s44, 6
s_add_u32 s43, s43, s44
buffer_load_dwordx4 v115, s[12:15], s43 offen lds
s_and_b32 s43, s40, 3
s_add_u32 s43, s43, 40
s_mul_i32 s44, s43, 43
s_lshr_b32 s44, s44, 8
s_lshl_b32 s46, s43, 10
s_add_u32 m0, s46, 16384
s_mul_i32 s46, s44, 6
s_sub_u32 s43, s43, s46
s_mul_i32 s43, s43, 12288
s_lshl_b32 s44, s44, 6
s_add_u32 s43, s43, s44
buffer_load_dwordx4 v115, s[12:15], s43 offen lds
s_and_b32 s43, s40, 3
s_add_u32 s43, s43, 44
s_mul_i32 s44, s43, 43
s_lshr_b32 s44, s44, 8
s_lshl_b32 s46, s43, 10
s_add_u32 m0, s46, 16384
s_mul_i32 s46, s44, 6
s_sub_u32 s43, s43, s46
s_mul_i32 s43, s43, 12288
s_lshl_b32 s44, s44, 6
s_add_u32 s43, s43, s44
buffer_load_dwordx4 v115, s[12:15], s43 offen lds
s_and_b32 s43, s40, 3
s_add_u32 s43, s43, 48
s_mul_i32 s44, s43, 43
s_lshr_b32 s44, s44, 8
s_lshl_b32 s46, s43, 10
s_add_u32 m0, s46, 16384
s_mul_i32 s46, s44, 6
s_sub_u32 s43, s43, s46
s_mul_i32 s43, s43, 12288
s_lshl_b32 s44, s44, 6
s_add_u32 s43, s43, s44
buffer_load_dwordx4 v115, s[12:15], s43 offen lds
s_and_b32 s43, s40, 3
s_add_u32 s43, s43, 52
s_mul_i32 s44, s43, 43
s_lshr_b32 s44, s44, 8
s_lshl_b32 s46, s43, 10
s_add_u32 m0, s46, 16384
s_mul_i32 s46, s44, 6
s_sub_u32 s43, s43, s46
s_mul_i32 s43, s43, 12288
s_lshl_b32 s44, s44, 6
s_add_u32 s43, s43, s44
buffer_load_dwordx4 v115, s[12:15], s43 offen lds
s_and_b32 s43, s40, 3
s_add_u32 s43, s43, 56
s_mul_i32 s44, s43, 43
s_lshr_b32 s44, s44, 8
s_lshl_b32 s46, s43, 10
s_add_u32 m0, s46, 16384
s_mul_i32 s46, s44, 6
s_sub_u32 s43, s43, s46
s_mul_i32 s43, s43, 12288
s_lshl_b32 s44, s44, 6
s_add_u32 s43, s43, s44
buffer_load_dwordx4 v115, s[12:15], s43 offen lds
s_and_b32 s43, s40, 3
s_add_u32 s43, s43, 60
s_mul_i32 s44, s43, 43
s_lshr_b32 s44, s44, 8
s_lshl_b32 s46, s43, 10
s_add_u32 m0, s46, 16384
s_mul_i32 s46, s44, 6
s_sub_u32 s43, s43, s46
s_mul_i32 s43, s43, 12288
s_lshl_b32 s44, s44, 6
s_add_u32 s43, s43, s44
buffer_load_dwordx4 v115, s[12:15], s43 offen lds
s_and_b32 s43, s40, 3
s_add_u32 s43, s43, 64
s_mul_i32 s44, s43, 43
s_lshr_b32 s44, s44, 8
s_lshl_b32 s46, s43, 10
s_add_u32 m0, s46, 16384
s_mul_i32 s46, s44, 6
s_sub_u32 s43, s43, s46
s_mul_i32 s43, s43, 12288
s_lshl_b32 s44, s44, 6
s_add_u32 s43, s43, s44
buffer_load_dwordx4 v115, s[12:15], s43 offen lds
s_and_b32 s43, s40, 3
s_add_u32 s43, s43, 68
s_mul_i32 s44, s43, 43
s_lshr_b32 s44, s44, 8
s_lshl_b32 s46, s43, 10
s_add_u32 m0, s46, 16384
s_mul_i32 s46, s44, 6
s_sub_u32 s43, s43, s46
s_mul_i32 s43, s43, 12288
s_lshl_b32 s44, s44, 6
s_add_u32 s43, s43, s44
buffer_load_dwordx4 v115, s[12:15], s43 offen lds
Lsetup:
s_mov_b32 s16, s86
s_and_b32 s17, s87, 65535
s_mov_b32 s18, 73728
s_mov_b32 s19, 131072
s_mov_b32 s24, s88
s_and_b32 s25, s89, 65535
s_mov_b32 s26, 768
s_mov_b32 s27, 131072
s_mov_b32 s28, s90
s_and_b32 s29, s91, 65535
s_mov_b32 s30, 768
s_mov_b32 s31, 131072
s_mov_b32 s8, s92
s_and_b32 s9, s93, 65535
s_mov_b32 s10, 50331648
s_mov_b32 s11, 131072
s_mov_b32 s36, s94
s_and_b32 s37, s95, 65535
s_mov_b32 s38, 256
s_mov_b32 s39, 131072
s_mov_b32 s32, s96
s_and_b32 s33, s97, 65535
s_mov_b32 s34, 83886080
s_mov_b32 s35, 131072
v_lshlrev_b32_e64 v250, 4, v118
v_add_u32 v250, 16384, v250
v_lshlrev_b32_e64 v251, 4, v118
v_add_u32 v251, 81920, v251
v_lshlrev_b32_e64 v252, 4, v118
v_add_u32 v252, 147456, v252
s_lshl_b32 s73, s2, 3
s_add_u32 s73, s73, s40
s_lshl_b32 s80, s73, 10
s_add_u32 s80, s80, 4177920
s_mul_i32 s73, s73, 16
s_add_u32 s73, s73, 1048576
s_mov_b32 s48, 1156203754
s_mov_b32 s49, 4294508536
v_and_b32 v131, 15, v118
v_lshrrev_b32 v132, 4, v118
v_and_b32_e64 v133, 3, v131
v_mul_u32_u24 v134, 13200, v133
v_lshrrev_b32_e64 v133, 2, v131
v_lshl_add_u32 v133, v133, 1, v132
v_mul_u32_u24 v133, 192, v133
s_sub_u32 s43, s67, 90112
v_add3_u32 v246, v133, v134, s43
v_bfe_u32 v133, v131, 2, 1
v_sub_u32 v133, v132, v133
v_lshrrev_b32 v134, 3, v131
v_and_b32_e64 v135, 3, v131
v_lshl_add_u32 v135, v134, 2, v135
v_lshlrev_b32_e64 v136, 6, v133
v_lshl_add_u32 v136, v135, 3, v136
v_add_u32 v136, 156040, v136
v_mov_b32 v137, 156032
v_cmp_gt_u32 vcc, 3, v133
s_nop 1
v_cndmask_b32 v136, v137, v136, vcc
v_cmp_eq_u32 vcc, 0, v134
s_nop 1
v_cndmask_b32 v238, v137, v136, vcc
v_cndmask_b32 v239, v136, v137, vcc
v_lshrrev_b32 v133, 2, v131
v_bfe_u32 v135, v131, 1, 1
v_cmp_eq_u32 vcc, v133, v132
s_nop 1
v_cndmask_b32 v135, 8, v135, vcc
v_cmp_eq_u32 s[88:89], 0, v135
v_cmp_eq_u32 s[90:91], 1, v135
v_lshlrev_b32 v254, 5, v132
v_add_u32 v254, 7936, v254
v_lshlrev_b32 v253, 4, v132
v_and_b32 v131, 31, v118
v_lshrrev_b32_e64 v132, 5, v118
v_bfe_u32 v133, v131, 2, 1
v_bfe_u32 v134, v131, 3, 1
v_bfe_u32 v135, v131, 1, 1
v_lshrrev_b32 v136, 4, v131
v_lshl_add_u32 v135, v136, 1, v135
v_lshl_add_u32 v135, v134, 2, v135
v_cmp_eq_u32 vcc, v133, v132
s_nop 1
v_cndmask_b32 v135, 8, v135, vcc
v_cmp_eq_u32 s[50:51], 0, v135
v_cmp_eq_u32 s[52:53], 1, v135
v_cmp_eq_u32 s[54:55], 2, v135
v_cmp_eq_u32 s[56:57], 3, v135
v_cmp_eq_u32 s[58:59], 4, v135
v_cmp_eq_u32 s[60:61], 5, v135
v_cmp_eq_u32 s[62:63], 6, v135
v_cmp_eq_u32 s[64:65], 7, v135
v_and_b32 v136, 1, v131
v_lshlrev_b32 v136, 4, v136
v_mov_b32 v255, 16256
v_lshlrev_b32 v255, v136, v255
v_and_b32 v137, 19, v131
v_lshl_add_u32 v137, v133, 3, v137
v_lshl_add_u32 v137, v134, 2, v137
v_lshlrev_b32_e64 v137, 2, v137
v_lshl_add_u32 v137, v132, 7, v137
s_mul_i32 s82, s40, 9216
s_add_u32 s72, s82, 90112
v_add_u32 v248, s72, v137
v_and_b32 v133, 3, v118
v_mul_u32_u24 v134, 196608, v133
v_bfe_u32 v133, v118, 2, 2
v_mul_u32_u24 v133, 384, v133
v_add3_u32 v253, v253, v133, v134
s_mul_i32 s46, s41, 192
s_add_u32 s46, s46, s67
s_sub_u32 s46, s46, 90112
s_and_b32 s83, s40, 4
s_lshl_b32 s44, s83, 1
s_add_u32 s44, s44, s42
s_add_u32 s43, s44, 0
s_mul_i32 s43, s43, 98304
s_add_u32 s68, s43, s46
s_add_u32 s43, s44, 1
s_mul_i32 s43, s43, 98304
s_add_u32 s69, s43, s46
s_add_u32 s43, s44, 16
s_mul_i32 s43, s43, 98304
s_add_u32 s70, s43, s46
s_add_u32 s43, s44, 17
s_mul_i32 s43, s43, 98304
s_add_u32 s71, s43, s46
s_mov_b32 s92, 2863311530
s_mov_b32 s94, 3435973836
s_mov_b32 s93, 2863311530
s_mov_b32 s95, 3435973836
s_mov_b32 s81, 59328
s_mov_b32 s76, 200000
v_mov_b32 v247, 8128
v_lshrrev_b32 v148, 5, v118
v_lshlrev_b32 v116, 8, v148
v_bfe_u32 v148, v118, 2, 2
v_lshl_add_u32 v116, v148, 6, v116
v_bfe_u32 v148, v118, 4, 1
v_lshl_add_u32 v116, v148, 5, v116
v_and_b32_e64 v148, 1, v118
v_lshl_add_u32 v116, v148, 4, v116
v_bfe_u32 v148, v118, 1, 1
v_lshl_add_u32 v116, v148, 3, v116
s_and_b32 s43, s40, 3
s_lshl_b32 s43, s43, 10
v_add_u32_e64 v117, s43, v250
s_add_u32 s43, s43, 16384
v_add_u32 v116, s43, v116
v_mov_b32 v224, 0
v_mov_b32 v225, 0
v_mov_b32 v226, 0
v_mov_b32 v227, 0
v_mov_b32 v228, 0
v_mov_b32 v229, 0
v_mov_b32 v230, 0
v_mov_b32 v231, 0
v_mov_b32 v232, 0
v_mov_b32 v233, 0
v_mov_b32 v234, 0
v_mov_b32 v235, 0
s_cmp_ge_u32 s40, 4
s_cbranch_scc1 Lwa
v_mov_b32 v65, 0
v_mov_b32 v67, 0
v_mov_b32 v68, 0
v_mov_b32 v70, 0
v_mov_b32 v72, 0
v_mov_b32 v73, 0
v_min_u32 v140, 35, v119
v_mul_u32_u24 v140, 200, v140
v_add_u32 v140, 156032, v140
v_and_b32 v141, 31, v119
v_lshlrev_b32 v141, 3, v141
v_bfe_u32 v142, v119, 5, 1
v_lshl_add_u32 v141, v142, 13, v141
v_add_u32 v141, 7936, v141
v_cmp_gt_u32 vcc, 64, v119
s_nop 1
v_cndmask_b32 v140, v141, v140, vcc
ds_write_b64 v140, v[72:73]
v_lshrrev_b32 v140, 1, v128
v_mul_u32_u24 v141, 57, v140
v_lshrrev_b32 v141, 11, v141
v_mul_u32_u24 v142, 171, v140
v_lshrrev_b32_e64 v142, 11, v142
v_mul_u32_u24 v140, 200, v140
v_mul_u32_u24 v142, 2336, v142
v_mul_u32_u24 v141, 2208, v141
v_sub_u32 v140, v140, v142
v_add_u32 v140, v140, v141
v_and_b32_e64 v141, 1, v128
v_lshl_add_u32 v140, v141, 5, v140
v_add_u32 v140, 156040, v140
v_and_b32 v120, 255, v119
v_lshlrev_b32 v121, 8, v120
v_add_u32 v0, 4, v121
v_cvt_f32_f16 v0, v0
v_add_u32 v1, 12, v121
v_cvt_f32_f16 v1, v1
v_add_u32 v2, 20, v121
v_cvt_f32_f16 v2, v2
v_add_u32 v3, 28, v121
v_cvt_f32_f16 v3, v3
v_add_u32 v4, 36, v121
v_cvt_f32_f16 v4, v4
v_add_u32 v5, 44, v121
v_cvt_f32_f16 v5, v5
v_add_u32 v6, 52, v121
v_cvt_f32_f16 v6, v6
v_add_u32 v7, 60, v121
v_cvt_f32_f16_e64 v7, v7
v_add_u32 v8, 68, v121
v_cvt_f32_f16_e64 v8, v8
v_add_u32 v9, 76, v121
v_cvt_f32_f16_e64 v9, v9
v_add_u32 v10, 84, v121
v_cvt_f32_f16_e64 v10, v10
v_add_u32 v11, 92, v121
v_cvt_f32_f16_e64 v11, v11
v_add_u32 v12, 100, v121
v_cvt_f32_f16_e64 v12, v12
v_add_u32 v13, 108, v121
v_cvt_f32_f16_e64 v13, v13
v_add_u32 v14, 116, v121
v_cvt_f32_f16_e64 v14, v14
v_add_u32 v15, 124, v121
v_cvt_f32_f16_e64 v15, v15
v_add_u32 v16, 132, v121
v_cvt_f32_f16_e64 v16, v16
v_add_u32 v17, 140, v121
v_cvt_f32_f16_e64 v17, v17
v_add_u32 v18, 148, v121
v_cvt_f32_f16_e64 v18, v18
v_add_u32 v19, 156, v121
v_cvt_f32_f16_e64 v19, v19
v_add_u32 v20, 164, v121
v_cvt_f32_f16_e64 v20, v20
v_add_u32 v21, 172, v121
v_cvt_f32_f16_e64 v21, v21
v_add_u32 v22, 180, v121
v_cvt_f32_f16_e64 v22, v22
v_add_u32 v23, 188, v121
v_cvt_f32_f16_e64 v23, v23
v_add_u32 v24, 196, v121
v_cvt_f32_f16_e64 v24, v24
v_add_u32 v25, 204, v121
v_cvt_f32_f16_e64 v25, v25
v_add_u32 v26, 212, v121
v_cvt_f32_f16_e64 v26, v26
v_add_u32 v27, 220, v121
v_cvt_f32_f16_e64 v27, v27
v_add_u32 v28, 228, v121
v_cvt_f32_f16_e64 v28, v28
v_add_u32 v29, 236, v121
v_cvt_f32_f16_e64 v29, v29
v_add_u32 v30, 244, v121
v_cvt_f32_f16_e64 v30, v30
v_add_u32 v31, 252, v121
v_cvt_f32_f16_e64 v31, v31
v_fmaak_f32 v32, v0, v0, 0x409d30fc
v_mul_f32_e64 v32, v0, v32
v_fmaak_f32 v33, v1, v1, 0x409d30fc
v_mul_f32_e64 v33, v1, v33
v_fmaak_f32 v34, v2, v2, 0x409d30fc
v_mul_f32_e64 v34, v2, v34
v_fmaak_f32 v35, v3, v3, 0x409d30fc
v_mul_f32_e64 v35, v3, v35
v_fmaak_f32 v36, v4, v4, 0x409d30fc
v_mul_f32_e64 v36, v4, v36
v_fmaak_f32 v37, v5, v5, 0x409d30fc
v_mul_f32_e64 v37, v5, v37
v_fmaak_f32 v38, v6, v6, 0x409d30fc
v_mul_f32_e64 v38, v6, v38
v_fmaak_f32 v39, v7, v7, 0x409d30fc
v_mul_f32_e64 v39, v7, v39
v_fmaak_f32 v40, v8, v8, 0x409d30fc
v_mul_f32_e64 v40, v8, v40
v_fmaak_f32 v41, v9, v9, 0x409d30fc
v_mul_f32_e64 v41, v9, v41
v_fmaak_f32 v42, v10, v10, 0x409d30fc
v_mul_f32_e64 v42, v10, v42
v_fmaak_f32 v43, v11, v11, 0x409d30fc
v_mul_f32_e64 v43, v11, v43
v_fmaak_f32 v44, v12, v12, 0x409d30fc
v_mul_f32_e64 v44, v12, v44
v_fmaak_f32 v45, v13, v13, 0x409d30fc
v_mul_f32_e64 v45, v13, v45
v_fmaak_f32 v46, v14, v14, 0x409d30fc
v_mul_f32_e64 v46, v14, v46
v_fmaak_f32 v47, v15, v15, 0x409d30fc
v_mul_f32_e64 v47, v15, v47
v_fmaak_f32 v48, v16, v16, 0x409d30fc
v_mul_f32_e64 v48, v16, v48
v_fmaak_f32 v49, v17, v17, 0x409d30fc
v_mul_f32_e64 v49, v17, v49
v_fmaak_f32 v50, v18, v18, 0x409d30fc
v_mul_f32_e64 v50, v18, v50
v_fmaak_f32 v51, v19, v19, 0x409d30fc
v_mul_f32_e64 v51, v19, v51
v_fmaak_f32 v52, v20, v20, 0x409d30fc
v_mul_f32_e64 v52, v20, v52
v_fmaak_f32 v53, v21, v21, 0x409d30fc
v_mul_f32_e64 v53, v21, v53
v_fmaak_f32 v54, v22, v22, 0x409d30fc
v_mul_f32_e64 v54, v22, v54
v_fmaak_f32 v55, v23, v23, 0x409d30fc
v_mul_f32_e64 v55, v23, v55
v_fmaak_f32 v56, v24, v24, 0x409d30fc
v_mul_f32_e64 v56, v24, v56
v_fmaak_f32 v57, v25, v25, 0x409d30fc
v_mul_f32_e64 v57, v25, v57
v_fmaak_f32 v58, v26, v26, 0x409d30fc
v_mul_f32_e64 v58, v26, v58
v_fmaak_f32 v59, v27, v27, 0x409d30fc
v_mul_f32_e64 v59, v27, v59
v_fmaak_f32 v60, v28, v28, 0x409d30fc
v_mul_f32_e64 v60, v28, v60
v_fmaak_f32 v61, v29, v29, 0x409d30fc
v_mul_f32_e64 v61, v29, v61
v_fmaak_f32 v62, v30, v30, 0x409d30fc
v_mul_f32_e64 v62, v30, v62
v_fmaak_f32 v63, v31, v31, 0x409d30fc
v_mul_f32 v63, v31, v63
v_exp_f32 v32, v32
v_exp_f32 v33, v33
v_exp_f32 v34, v34
v_exp_f32 v35, v35
v_exp_f32 v36, v36
v_exp_f32 v37, v37
v_exp_f32 v38, v38
v_exp_f32 v39, v39
v_exp_f32 v40, v40
v_exp_f32 v41, v41
v_exp_f32 v42, v42
v_exp_f32 v43, v43
v_exp_f32 v44, v44
v_exp_f32 v45, v45
v_exp_f32 v46, v46
v_exp_f32 v47, v47
v_exp_f32 v48, v48
v_exp_f32 v49, v49
v_exp_f32 v50, v50
v_exp_f32 v51, v51
v_exp_f32 v52, v52
v_exp_f32 v53, v53
v_exp_f32 v54, v54
v_exp_f32 v55, v55
v_exp_f32 v56, v56
v_exp_f32 v57, v57
v_exp_f32 v58, v58
v_exp_f32 v59, v59
v_exp_f32 v60, v60
v_exp_f32 v61, v61
v_exp_f32 v62, v62
v_exp_f32 v63, v63
v_add_f32 v32, 1.0, v32
v_add_f32 v33, 1.0, v33
v_add_f32 v34, 1.0, v34
v_add_f32 v35, 1.0, v35
v_add_f32 v36, 1.0, v36
v_add_f32 v37, 1.0, v37
v_add_f32 v38, 1.0, v38
v_add_f32 v39, 1.0, v39
v_add_f32 v40, 1.0, v40
v_add_f32 v41, 1.0, v41
v_add_f32 v42, 1.0, v42
v_add_f32 v43, 1.0, v43
v_add_f32 v44, 1.0, v44
v_add_f32 v45, 1.0, v45
v_add_f32 v46, 1.0, v46
v_add_f32 v47, 1.0, v47
v_add_f32 v48, 1.0, v48
v_add_f32 v49, 1.0, v49
v_add_f32 v50, 1.0, v50
v_add_f32 v51, 1.0, v51
v_add_f32 v52, 1.0, v52
v_add_f32 v53, 1.0, v53
v_add_f32 v54, 1.0, v54
v_add_f32 v55, 1.0, v55
v_add_f32 v56, 1.0, v56
v_add_f32 v57, 1.0, v57
v_add_f32 v58, 1.0, v58
v_add_f32 v59, 1.0, v59
v_add_f32 v60, 1.0, v60
v_add_f32 v61, 1.0, v61
v_add_f32 v62, 1.0, v62
v_add_f32 v63, 1.0, v63
v_rcp_f32 v32, v32
v_rcp_f32 v33, v33
v_rcp_f32 v34, v34
v_rcp_f32 v35, v35
v_rcp_f32 v36, v36
v_rcp_f32 v37, v37
v_rcp_f32 v38, v38
v_rcp_f32 v39, v39
v_rcp_f32 v40, v40
v_rcp_f32 v41, v41
v_rcp_f32 v42, v42
v_rcp_f32 v43, v43
v_rcp_f32 v44, v44
v_rcp_f32 v45, v45
v_rcp_f32 v46, v46
v_rcp_f32 v47, v47
v_rcp_f32 v48, v48
v_rcp_f32 v49, v49
v_rcp_f32 v50, v50
v_rcp_f32 v51, v51
v_rcp_f32 v52, v52
v_rcp_f32 v53, v53
v_rcp_f32 v54, v54
v_rcp_f32 v55, v55
v_rcp_f32 v56, v56
v_rcp_f32 v57, v57
v_rcp_f32 v58, v58
v_rcp_f32 v59, v59
v_rcp_f32 v60, v60
v_rcp_f32 v61, v61
v_rcp_f32 v62, v62
v_rcp_f32 v63, v63
v_mul_f32 v0, v0, v32
v_mul_f32 v1, v1, v33
v_mul_f32 v2, v2, v34
v_mul_f32 v3, v3, v35
v_mul_f32 v4, v4, v36
v_mul_f32 v5, v5, v37
v_mul_f32 v6, v6, v38
v_mul_f32 v7, v7, v39
v_mul_f32 v8, v8, v40
v_mul_f32 v9, v9, v41
v_mul_f32 v10, v10, v42
v_mul_f32 v11, v11, v43
v_mul_f32 v12, v12, v44
v_mul_f32 v13, v13, v45
v_mul_f32 v14, v14, v46
v_mul_f32 v15, v15, v47
v_mul_f32 v16, v16, v48
v_mul_f32 v17, v17, v49
v_mul_f32 v18, v18, v50
v_mul_f32 v19, v19, v51
v_mul_f32 v20, v20, v52
v_mul_f32 v21, v21, v53
v_mul_f32 v22, v22, v54
v_mul_f32 v23, v23, v55
v_mul_f32 v24, v24, v56
v_mul_f32 v25, v25, v57
v_mul_f32 v26, v26, v58
v_mul_f32 v27, v27, v59
v_mul_f32 v28, v28, v60
v_mul_f32 v29, v29, v61
v_mul_f32 v30, v30, v62
v_mul_f32_e64 v31, v31, v63
v_cvt_pk_f16_f32 v32, v0, v1
v_cvt_pk_f16_f32 v33, v2, v3
v_cvt_pk_f16_f32 v34, v4, v5
v_cvt_pk_f16_f32 v35, v6, v7
v_cvt_pk_f16_f32 v36, v8, v9
v_cvt_pk_f16_f32 v37, v10, v11
v_cvt_pk_f16_f32 v38, v12, v13
v_cvt_pk_f16_f32 v39, v14, v15
v_cvt_pk_f16_f32 v40, v16, v17
v_cvt_pk_f16_f32 v41, v18, v19
v_cvt_pk_f16_f32 v42, v20, v21
v_cvt_pk_f16_f32 v43, v22, v23
v_cvt_pk_f16_f32 v44, v24, v25
v_cvt_pk_f16_f32 v45, v26, v27
v_cvt_pk_f16_f32 v46, v28, v29
v_cvt_pk_f16_f32 v47, v30, v31
v_lshlrev_b32 v121, 6, v120
v_bfe_u32 v120, v120, 2, 5
v_cmp_ne_u32 vcc, 31, v120
s_and_saveexec_b64 s[74:75], vcc
ds_write_b128 v121, v[32:35]
ds_write_b128 v121, v[36:39] offset:16
ds_write_b128 v121, v[40:43] offset:32
ds_write_b128 v121, v[44:47] offset:48
s_mov_b64 exec, s[74:75]
s_waitcnt vmcnt(10)
v_and_b32 v64, 65535, v126
ds_write_b64 v140, v[64:65]
v_and_b32 v66, 4294901760, v126
ds_write_b64 v140, v[66:67] offset:8
v_and_b32 v69, 65535, v127
ds_write_b64 v140, v[68:69] offset:16
v_and_b32 v71, 4294901760, v127
ds_write_b64 v140, v[70:71] offset:24
s_waitcnt vmcnt(0) lgkmcnt(0)
s_barrier
Lwa:
s_cmp_lt_u32 s40, 4
s_cbranch_scc1 Lsu1
s_waitcnt vmcnt(14)
v_add_u32 v113, 65536, v116
v_add_u32 v114, 65536, v117
ds_read_b64_tr_b16 v[0:1], v116
ds_read_b64_tr_b16 v[2:3], v116 offset:512
ds_read_b64_tr_b16 v[4:5], v116 offset:4096
ds_read_b64_tr_b16 v[6:7], v116 offset:4608
ds_read_b64_tr_b16 v[8:9], v116 offset:8192
ds_read_b64_tr_b16 v[10:11], v116 offset:8704
ds_read_b64_tr_b16 v[12:13], v116 offset:12288
ds_read_b64_tr_b16 v[14:15], v116 offset:12800
ds_read_b64_tr_b16 v[16:17], v116 offset:16384
ds_read_b64_tr_b16 v[18:19], v116 offset:16896
ds_read_b64_tr_b16 v[20:21], v116 offset:20480
ds_read_b64_tr_b16 v[22:23], v116 offset:20992
s_waitcnt lgkmcnt(10)
ds_write_b128 v117, v[0:3]
s_waitcnt lgkmcnt(9)
ds_write_b128 v117, v[4:7] offset:4096
s_waitcnt lgkmcnt(8)
ds_write_b128 v117, v[8:11] offset:8192
s_waitcnt lgkmcnt(7)
ds_write_b128 v117, v[12:15] offset:12288
s_waitcnt lgkmcnt(6)
ds_write_b128 v117, v[16:19] offset:16384
s_waitcnt lgkmcnt(5)
ds_write_b128 v117, v[20:23] offset:20480
v_mov_b32_e64 v223, 1
s_waitcnt lgkmcnt(0)
s_mov_b64 exec, 1
ds_add_u32 v247, v223 offset:8
s_mov_b64 exec, -1
s_nop 0
v_mov_b32_e64 v223, 0
s_branch Law1
Lax1:
s_sleep 2
Law1:
ds_read_b32 v223, v247 offset:16
s_sub_u32 s76, s76, 1
s_cselect_b32 s44, 4, 0
s_cselect_b32 s76, 0, s76
s_waitcnt lgkmcnt(0)
v_readfirstlane_b32 s43, v223
s_nop 1
s_max_u32 s43, s43, s44
s_cmp_lt_u32 s43, 4
s_cbranch_scc1 Lax1
s_add_u32 s81, s81, 6592
s_cmp_eq_u32 s81, 65920
s_cselect_b32 s81, 0, s81
s_add_u32 s43, s81, s67
s_add_u32 m0, s43, 16
s_add_u32 s66, s66, 98304
buffer_load_dwordx4 v236, s[4:7], s66 offen lds
s_add_u32 m0, s43, 912
s_nop 0
buffer_load_dwordx4 v237, s[4:7], s66 offen lds
s_add_u32 s81, s81, 6592
s_cmp_eq_u32 s81, 65920
s_cselect_b32 s81, 0, s81
s_add_u32 s43, s81, s67
s_add_u32 m0, s43, 16
s_add_u32 s66, s66, 98304
buffer_load_dwordx4 v236, s[4:7], s66 offen lds
s_add_u32 m0, s43, 912
s_nop 0
buffer_load_dwordx4 v237, s[4:7], s66 offen lds
s_add_u32 s81, s81, 6592
s_cmp_eq_u32 s81, 65920
s_cselect_b32 s81, 0, s81
s_add_u32 s43, s81, s67
s_add_u32 m0, s43, 32
s_add_u32 s66, s66, 98304
buffer_load_dwordx4 v236, s[4:7], s66 offen lds
s_add_u32 m0, s43, 928
s_nop 0
buffer_load_dwordx4 v237, s[4:7], s66 offen lds
s_add_u32 s81, s81, 6592
s_cmp_eq_u32 s81, 65920
s_cselect_b32 s81, 0, s81
s_add_u32 s43, s81, s67
s_add_u32 m0, s43, 32
s_add_u32 s66, s66, 98304
buffer_load_dwordx4 v236, s[4:7], s66 offen lds
s_add_u32 m0, s43, 928
s_nop 0
buffer_load_dwordx4 v237, s[4:7], s66 offen lds
s_add_u32 s81, s81, 6592
s_cmp_eq_u32 s81, 65920
s_cselect_b32 s81, 0, s81
s_add_u32 s43, s81, s67
s_add_u32 m0, s43, 48
s_add_u32 s66, s66, 98304
buffer_load_dwordx4 v236, s[4:7], s66 offen lds
s_add_u32 m0, s43, 944
s_nop 0
buffer_load_dwordx4 v237, s[4:7], s66 offen lds
s_add_u32 s81, s81, 6592
s_cmp_eq_u32 s81, 65920
s_cselect_b32 s81, 0, s81
s_add_u32 s43, s81, s67
s_add_u32 m0, s43, 48
s_add_u32 s66, s66, 98304
buffer_load_dwordx4 v236, s[4:7], s66 offen lds
s_add_u32 m0, s43, 944
s_nop 0
buffer_load_dwordx4 v237, s[4:7], s66 offen lds
s_add_u32 s81, s81, 6592
s_cmp_eq_u32 s81, 65920
s_cselect_b32 s81, 0, s81
s_add_u32 s43, s81, s67
s_add_u32 m0, s43, 0
s_add_u32 s66, s66, 98304
buffer_load_dwordx4 v236, s[4:7], s66 offen lds
s_add_u32 m0, s43, 896
s_nop 0
buffer_load_dwordx4 v237, s[4:7], s66 offen lds
s_add_u32 s81, s81, 6592
s_cmp_eq_u32 s81, 65920
s_cselect_b32 s81, 0, s81
s_add_u32 s43, s81, s67
s_add_u32 m0, s43, 0
s_add_u32 s66, s66, 98304
buffer_load_dwordx4 v236, s[4:7], s66 offen lds
s_add_u32 m0, s43, 896
s_nop 0
buffer_load_dwordx4 v237, s[4:7], s66 offen lds
s_waitcnt vmcnt(16)
v_add_u32 v113, 65536, v116
v_add_u32 v114, 65536, v117
ds_read_b64_tr_b16 v[0:1], v116 offset:24576
ds_read_b64_tr_b16 v[2:3], v116 offset:25088
ds_read_b64_tr_b16 v[4:5], v116 offset:28672
ds_read_b64_tr_b16 v[6:7], v116 offset:29184
ds_read_b64_tr_b16 v[8:9], v116 offset:32768
ds_read_b64_tr_b16 v[10:11], v116 offset:33280
ds_read_b64_tr_b16 v[12:13], v116 offset:36864
ds_read_b64_tr_b16 v[14:15], v116 offset:37376
ds_read_b64_tr_b16 v[16:17], v116 offset:40960
ds_read_b64_tr_b16 v[18:19], v116 offset:41472
ds_read_b64_tr_b16 v[20:21], v116 offset:45056
ds_read_b64_tr_b16 v[22:23], v116 offset:45568
ds_read_b64_tr_b16 v[24:25], v116 offset:49152
ds_read_b64_tr_b16 v[26:27], v116 offset:49664
ds_read_b64_tr_b16 v[28:29], v116 offset:53248
s_waitcnt lgkmcnt(14)
ds_read_b64_tr_b16 v[30:31], v116 offset:53760
s_waitcnt lgkmcnt(14)
ds_read_b64_tr_b16 v[32:33], v116 offset:57344
s_waitcnt lgkmcnt(14)
ds_read_b64_tr_b16 v[34:35], v116 offset:57856
s_waitcnt lgkmcnt(14)
ds_read_b64_tr_b16 v[36:37], v116 offset:61440
s_waitcnt lgkmcnt(14)
ds_read_b64_tr_b16 v[38:39], v116 offset:61952
s_waitcnt lgkmcnt(14)
ds_read_b64_tr_b16 v[40:41], v113
s_waitcnt lgkmcnt(14)
ds_read_b64_tr_b16 v[42:43], v113 offset:512
s_waitcnt lgkmcnt(14)
ds_read_b64_tr_b16 v[44:45], v113 offset:4096
s_waitcnt lgkmcnt(14)
ds_read_b64_tr_b16 v[46:47], v113 offset:4608
s_waitcnt lgkmcnt(14)
ds_write_b128 v117, v[0:3] offset:24576
s_waitcnt lgkmcnt(14)
ds_write_b128 v117, v[4:7] offset:28672
s_waitcnt lgkmcnt(14)
ds_write_b128 v117, v[8:11] offset:32768
s_waitcnt lgkmcnt(14)
ds_write_b128 v117, v[12:15] offset:36864
s_waitcnt lgkmcnt(14)
ds_write_b128 v117, v[16:19] offset:40960
s_waitcnt lgkmcnt(14)
ds_write_b128 v117, v[20:23] offset:45056
s_waitcnt lgkmcnt(14)
ds_write_b128 v117, v[24:27] offset:49152
s_waitcnt lgkmcnt(14)
ds_write_b128 v117, v[28:31] offset:53248
s_waitcnt lgkmcnt(14)
ds_write_b128 v117, v[32:35] offset:57344
s_waitcnt lgkmcnt(14)
s_waitcnt lgkmcnt(13)
ds_write_b128 v117, v[36:39] offset:61440
s_waitcnt lgkmcnt(12)
ds_write_b128 v114, v[40:43]
s_waitcnt lgkmcnt(11)
ds_write_b128 v114, v[44:47] offset:4096
v_mov_b32 v223, 1
s_waitcnt lgkmcnt(0)
s_mov_b64 exec, 1
ds_add_u32 v247, v223 offset:12
s_mov_b64 exec, -1
s_cmp_lg_u32 s40, 7
s_cbranch_scc1 Lnosent
v_bfe_u32 v104, v250, 4, 6
v_mov_b32 v108, -1
v_mov_b32 v109, -1
v_mov_b32 v110, -1
v_mov_b32 v111, -1
v_lshlrev_b32_e64 v100, 12, v104
v_add_u32 v101, 262144, v100
v_cmp_gt_u32 vcc, 32, v104
v_mov_b32 v105, 2147483648
s_nop 0
v_cndmask_b32 v101, v105, v101, vcc
s_lshl_b32 s43, s2, 4
buffer_store_dwordx4 v[108:111], v100, s[32:35], s43 offen sc1
buffer_store_dwordx4 v[108:111], v101, s[32:35], s43 offen sc1
s_add_u32 s43, s43, 393216
s_cmp_lt_u32 s2, 96
s_cselect_b32 s43, s43, 1073741824
v_lshlrev_b32 v103, 11, v104
s_mov_b64 exec, 0xff
buffer_store_dwordx4 v[108:111], v103, s[32:35], s43 offen sc1
s_mov_b64 exec, -1
s_nop 1
Lnosent:
s_setprio 3
s_waitcnt vmcnt(0)
Lsu1:
s_add_u32 s43, s81, 6592
v_add_u32_e64 v212, s43, v246
v_subrev_u32 v222, 65920, v212
v_min_u32_e64 v212, v212, v222
v_add_u32 v212, 90112, v212
v_add_u32_e64 v213, s43, v246
v_add_u32 v213, 6592, v213
v_subrev_u32 v222, 65920, v213
v_min_u32_e64 v213, v213, v222
v_add_u32 v213, 90112, v213
v_add_u32_e64 v214, s43, v246
v_add_u32 v214, 13184, v214
v_add_u32_e64 v222, 16, v214
v_bfi_b32 v214, 48, v222, v214
v_subrev_u32 v222, 65920, v214
v_min_u32_e64 v214, v214, v222
v_add_u32 v214, 90112, v214
v_add_u32_e64 v215, s43, v246
v_add_u32 v215, 19776, v215
v_add_u32_e64 v222, 16, v215
v_bfi_b32 v215, 48, v222, v215
v_subrev_u32 v222, 65920, v215
v_min_u32_e64 v215, v215, v222
v_add_u32 v215, 90112, v215
ds_read_b128 v[144:147], v212
ds_read_b64 v[192:193], v238
ds_read_b64 v[194:195], v239
ds_read_b128 v[148:151], v213
ds_read_b128 v[152:155], v214
ds_read_b64 v[196:197], v238 offset:2400
ds_read_b64 v[198:199], v239 offset:2400
ds_read_b128 v[156:159], v215
ds_read_b64 v[200:201], v238 offset:4800
ds_read_b64 v[202:203], v239 offset:4800
ds_read_b128 v[160:163], v212 offset:16
ds_read_b64 v[204:205], v238 offset:200
ds_read_b64 v[206:207], v239 offset:200
ds_read_b128 v[164:167], v213 offset:16
ds_read_b128 v[168:171], v214 offset:16
s_waitcnt lgkmcnt(14)
ds_read_b64 v[208:209], v238 offset:2600
s_waitcnt lgkmcnt(13)
v_mfma_f32_16x16x32_bf16 v[0:3], v[192:195], v[144:147], 0
ds_read_b64 v[210:211], v239 offset:2600
s_waitcnt lgkmcnt(13)
v_mfma_f32_16x16x32_bf16 v[48:51], v[192:195], v[148:151], 0
ds_read_b128 v[172:175], v215 offset:16
ds_read_b64 v[192:193], v238 offset:5000
s_waitcnt lgkmcnt(14)
ds_read_b64 v[194:195], v239 offset:5000
s_waitcnt lgkmcnt(13)
v_mfma_f32_16x16x32_bf16 v[0:3], v[196:199], v[148:151], v[0:3]
ds_read_b128 v[144:147], v212 offset:32
v_mfma_f32_16x16x32_bf16 v[48:51], v[196:199], v[152:155], v[48:51]
ds_read_b64 v[196:197], v238 offset:400
s_waitcnt lgkmcnt(14)
ds_read_b64 v[198:199], v239 offset:400
s_waitcnt lgkmcnt(13)
v_mfma_f32_16x16x32_bf16 v[0:3], v[200:203], v[152:155], v[0:3]
ds_read_b128 v[148:151], v213 offset:32
v_mfma_f32_16x16x32_bf16 v[48:51], v[200:203], v[156:159], v[48:51]
ds_read_b128 v[152:155], v214 offset:32
s_waitcnt lgkmcnt(14)
ds_read_b64 v[200:201], v238 offset:2800
s_waitcnt lgkmcnt(13)
v_mfma_f32_16x16x32_bf16 v[4:7], v[204:207], v[160:163], 0
ds_read_b64 v[202:203], v239 offset:2800
s_waitcnt lgkmcnt(13)
v_mfma_f32_16x16x32_bf16 v[52:55], v[204:207], v[164:167], 0
ds_read_b128 v[156:159], v215 offset:32
ds_read_b64 v[204:205], v238 offset:5200
s_waitcnt lgkmcnt(14)
ds_read_b64 v[206:207], v239 offset:5200
s_waitcnt lgkmcnt(13)
v_mfma_f32_16x16x32_bf16 v[4:7], v[208:211], v[164:167], v[4:7]
ds_read_b128 v[160:163], v212 offset:48
v_mfma_f32_16x16x32_bf16 v[52:55], v[208:211], v[168:171], v[52:55]
ds_read_b64 v[208:209], v238 offset:600
s_waitcnt lgkmcnt(14)
ds_read_b64 v[210:211], v239 offset:600
s_waitcnt lgkmcnt(13)
v_mfma_f32_16x16x32_bf16 v[4:7], v[192:195], v[168:171], v[4:7]
ds_read_b128 v[164:167], v213 offset:48
v_mfma_f32_16x16x32_bf16 v[52:55], v[192:195], v[172:175], v[52:55]
ds_read_b128 v[168:171], v214 offset:48
s_waitcnt lgkmcnt(14)
ds_read_b64 v[192:193], v238 offset:3000
s_waitcnt lgkmcnt(13)
v_mfma_f32_16x16x32_bf16 v[8:11], v[196:199], v[144:147], 0
ds_read_b64 v[194:195], v239 offset:3000
s_waitcnt lgkmcnt(13)
v_mfma_f32_16x16x32_bf16 v[56:59], v[196:199], v[148:151], 0
ds_read_b128 v[172:175], v215 offset:48
ds_read_b64 v[196:197], v238 offset:5400
s_waitcnt lgkmcnt(14)
ds_read_b64 v[198:199], v239 offset:5400
s_waitcnt lgkmcnt(13)
v_mfma_f32_16x16x32_bf16 v[8:11], v[200:203], v[148:151], v[8:11]
ds_read_b128 v[144:147], v212 offset:64
v_mfma_f32_16x16x32_bf16 v[56:59], v[200:203], v[152:155], v[56:59]
ds_read_b64 v[200:201], v238 offset:800
s_waitcnt lgkmcnt(14)
ds_read_b64 v[202:203], v239 offset:800
s_waitcnt lgkmcnt(13)
v_mfma_f32_16x16x32_bf16 v[8:11], v[204:207], v[152:155], v[8:11]
ds_read_b128 v[148:151], v213 offset:64
v_mfma_f32_16x16x32_bf16 v[56:59], v[204:207], v[156:159], v[56:59]
ds_read_b128 v[152:155], v214 offset:64
s_waitcnt lgkmcnt(14)
ds_read_b64 v[204:205], v238 offset:3200
s_waitcnt lgkmcnt(13)
v_mfma_f32_16x16x32_bf16 v[12:15], v[208:211], v[160:163], 0
ds_read_b64 v[206:207], v239 offset:3200
s_waitcnt lgkmcnt(13)
v_mfma_f32_16x16x32_bf16 v[60:63], v[208:211], v[164:167], 0
ds_read_b128 v[156:159], v215 offset:64
ds_read_b64 v[208:209], v238 offset:5600
s_waitcnt lgkmcnt(14)
ds_read_b64 v[210:211], v239 offset:5600
s_waitcnt lgkmcnt(13)
v_mfma_f32_16x16x32_bf16 v[12:15], v[192:195], v[164:167], v[12:15]
ds_read_b128 v[160:163], v212 offset:80
v_mfma_f32_16x16x32_bf16 v[60:63], v[192:195], v[168:171], v[60:63]
ds_read_b64 v[192:193], v238 offset:1000
s_waitcnt lgkmcnt(14)
ds_read_b64 v[194:195], v239 offset:1000
s_waitcnt lgkmcnt(13)
v_mfma_f32_16x16x32_bf16 v[12:15], v[196:199], v[168:171], v[12:15]
ds_read_b128 v[164:167], v213 offset:80
v_mfma_f32_16x16x32_bf16 v[60:63], v[196:199], v[172:175], v[60:63]
ds_read_b128 v[168:171], v214 offset:80
s_waitcnt lgkmcnt(14)
ds_read_b64 v[196:197], v238 offset:3400
s_waitcnt lgkmcnt(13)
v_mfma_f32_16x16x32_bf16 v[16:19], v[200:203], v[144:147], 0
ds_read_b64 v[198:199], v239 offset:3400
s_waitcnt lgkmcnt(13)
v_mfma_f32_16x16x32_bf16 v[64:67], v[200:203], v[148:151], 0
ds_read_b128 v[172:175], v215 offset:80
ds_read_b64 v[200:201], v238 offset:5800
s_waitcnt lgkmcnt(14)
ds_read_b64 v[202:203], v239 offset:5800
s_waitcnt lgkmcnt(13)
v_mfma_f32_16x16x32_bf16 v[16:19], v[204:207], v[148:151], v[16:19]
ds_read_b128 v[144:147], v212 offset:96
v_mfma_f32_16x16x32_bf16 v[64:67], v[204:207], v[152:155], v[64:67]
ds_read_b64 v[204:205], v238 offset:1200
s_waitcnt lgkmcnt(14)
ds_read_b64 v[206:207], v239 offset:1200
s_waitcnt lgkmcnt(13)
v_mfma_f32_16x16x32_bf16 v[16:19], v[208:211], v[152:155], v[16:19]
ds_read_b128 v[148:151], v213 offset:96
v_mfma_f32_16x16x32_bf16 v[64:67], v[208:211], v[156:159], v[64:67]
ds_read_b128 v[152:155], v214 offset:96
s_waitcnt lgkmcnt(14)
ds_read_b64 v[208:209], v238 offset:3600
s_waitcnt lgkmcnt(13)
v_mfma_f32_16x16x32_bf16 v[20:23], v[192:195], v[160:163], 0
ds_read_b64 v[210:211], v239 offset:3600
s_waitcnt lgkmcnt(13)
v_mfma_f32_16x16x32_bf16 v[68:71], v[192:195], v[164:167], 0
ds_read_b128 v[156:159], v215 offset:96
ds_read_b64 v[192:193], v238 offset:6000
s_waitcnt lgkmcnt(14)
ds_read_b64 v[194:195], v239 offset:6000
s_waitcnt lgkmcnt(13)
v_mfma_f32_16x16x32_bf16 v[20:23], v[196:199], v[164:167], v[20:23]
ds_read_b128 v[160:163], v212 offset:112
v_mfma_f32_16x16x32_bf16 v[68:71], v[196:199], v[168:171], v[68:71]
ds_read_b64 v[196:197], v238 offset:1400
s_waitcnt lgkmcnt(14)
ds_read_b64 v[198:199], v239 offset:1400
s_waitcnt lgkmcnt(13)
v_mfma_f32_16x16x32_bf16 v[20:23], v[200:203], v[168:171], v[20:23]
ds_read_b128 v[164:167], v213 offset:112
v_mfma_f32_16x16x32_bf16 v[68:71], v[200:203], v[172:175], v[68:71]
ds_read_b128 v[168:171], v214 offset:112
s_waitcnt lgkmcnt(14)
ds_read_b64 v[200:201], v238 offset:3800
s_waitcnt lgkmcnt(13)
v_mfma_f32_16x16x32_bf16 v[24:27], v[204:207], v[144:147], 0
ds_read_b64 v[202:203], v239 offset:3800
s_waitcnt lgkmcnt(13)
v_mfma_f32_16x16x32_bf16 v[72:75], v[204:207], v[148:151], 0
ds_read_b128 v[172:175], v215 offset:112
ds_read_b64 v[204:205], v238 offset:6200
s_waitcnt lgkmcnt(14)
ds_read_b64 v[206:207], v239 offset:6200
s_waitcnt lgkmcnt(13)
v_mfma_f32_16x16x32_bf16 v[24:27], v[208:211], v[148:151], v[24:27]
ds_read_b128 v[144:147], v212 offset:128
v_mfma_f32_16x16x32_bf16 v[72:75], v[208:211], v[152:155], v[72:75]
ds_read_b64 v[208:209], v238 offset:1600
s_waitcnt lgkmcnt(14)
ds_read_b64 v[210:211], v239 offset:1600
s_waitcnt lgkmcnt(13)
v_mfma_f32_16x16x32_bf16 v[24:27], v[192:195], v[152:155], v[24:27]
ds_read_b128 v[148:151], v213 offset:128
v_mfma_f32_16x16x32_bf16 v[72:75], v[192:195], v[156:159], v[72:75]
ds_read_b128 v[152:155], v214 offset:128
s_waitcnt lgkmcnt(14)
ds_read_b64 v[192:193], v238 offset:4000
s_waitcnt lgkmcnt(13)
v_mfma_f32_16x16x32_bf16 v[28:31], v[196:199], v[160:163], 0
ds_read_b64 v[194:195], v239 offset:4000
s_waitcnt lgkmcnt(13)
v_mfma_f32_16x16x32_bf16 v[76:79], v[196:199], v[164:167], 0
ds_read_b128 v[156:159], v215 offset:128
ds_read_b64 v[196:197], v238 offset:6400
s_waitcnt lgkmcnt(14)
ds_read_b64 v[198:199], v239 offset:6400
s_waitcnt lgkmcnt(13)
v_mfma_f32_16x16x32_bf16 v[28:31], v[200:203], v[164:167], v[28:31]
ds_read_b128 v[160:163], v212 offset:144
v_mfma_f32_16x16x32_bf16 v[76:79], v[200:203], v[168:171], v[76:79]
ds_read_b64 v[200:201], v238 offset:1800
s_waitcnt lgkmcnt(14)
ds_read_b64 v[202:203], v239 offset:1800
s_waitcnt lgkmcnt(13)
v_mfma_f32_16x16x32_bf16 v[28:31], v[204:207], v[168:171], v[28:31]
ds_read_b128 v[164:167], v213 offset:144
v_mfma_f32_16x16x32_bf16 v[76:79], v[204:207], v[172:175], v[76:79]
ds_read_b128 v[168:171], v214 offset:144
s_waitcnt lgkmcnt(14)
ds_read_b64 v[204:205], v238 offset:4200
s_waitcnt lgkmcnt(13)
v_mfma_f32_16x16x32_bf16 v[32:35], v[208:211], v[144:147], 0
ds_read_b64 v[206:207], v239 offset:4200
s_waitcnt lgkmcnt(13)
v_mfma_f32_16x16x32_bf16 v[80:83], v[208:211], v[148:151], 0
ds_read_b128 v[172:175], v215 offset:144
ds_read_b64 v[208:209], v238 offset:6600
s_waitcnt lgkmcnt(14)
ds_read_b64 v[210:211], v239 offset:6600
s_waitcnt lgkmcnt(13)
v_mfma_f32_16x16x32_bf16 v[32:35], v[192:195], v[148:151], v[32:35]
ds_read_b128 v[144:147], v212 offset:160
v_mfma_f32_16x16x32_bf16 v[80:83], v[192:195], v[152:155], v[80:83]
ds_read_b64 v[192:193], v238 offset:2000
s_waitcnt lgkmcnt(14)
ds_read_b64 v[194:195], v239 offset:2000
s_waitcnt lgkmcnt(13)
v_mfma_f32_16x16x32_bf16 v[32:35], v[196:199], v[152:155], v[32:35]
ds_read_b128 v[148:151], v213 offset:160
v_mfma_f32_16x16x32_bf16 v[80:83], v[196:199], v[156:159], v[80:83]
ds_read_b128 v[152:155], v214 offset:160
s_waitcnt lgkmcnt(14)
ds_read_b64 v[196:197], v238 offset:4400
s_waitcnt lgkmcnt(13)
v_mfma_f32_16x16x32_bf16 v[36:39], v[200:203], v[160:163], 0
ds_read_b64 v[198:199], v239 offset:4400
s_waitcnt lgkmcnt(13)
v_mfma_f32_16x16x32_bf16 v[84:87], v[200:203], v[164:167], 0
ds_read_b128 v[156:159], v215 offset:160
ds_read_b64 v[200:201], v238 offset:6800
s_waitcnt lgkmcnt(14)
ds_read_b64 v[202:203], v239 offset:6800
s_waitcnt lgkmcnt(13)
v_mfma_f32_16x16x32_bf16 v[36:39], v[204:207], v[164:167], v[36:39]
ds_read_b128 v[160:163], v212 offset:176
v_mfma_f32_16x16x32_bf16 v[84:87], v[204:207], v[168:171], v[84:87]
ds_read_b64 v[204:205], v238 offset:2200
s_waitcnt lgkmcnt(14)
ds_read_b64 v[206:207], v239 offset:2200
s_waitcnt lgkmcnt(13)
v_mfma_f32_16x16x32_bf16 v[36:39], v[208:211], v[168:171], v[36:39]
ds_read_b128 v[164:167], v213 offset:176
v_mfma_f32_16x16x32_bf16 v[84:87], v[208:211], v[172:175], v[84:87]
ds_read_b128 v[168:171], v214 offset:176
s_waitcnt lgkmcnt(14)
ds_read_b64 v[208:209], v238 offset:4600
s_waitcnt lgkmcnt(13)
v_mfma_f32_16x16x32_bf16 v[40:43], v[192:195], v[144:147], 0
ds_read_b64 v[210:211], v239 offset:4600
s_waitcnt lgkmcnt(13)
v_mfma_f32_16x16x32_bf16 v[88:91], v[192:195], v[148:151], 0
ds_read_b128 v[172:175], v215 offset:176
ds_read_b64 v[192:193], v238 offset:7000
s_waitcnt lgkmcnt(14)
ds_read_b64 v[194:195], v239 offset:7000
s_waitcnt lgkmcnt(13)
v_mfma_f32_16x16x32_bf16 v[40:43], v[196:199], v[148:151], v[40:43]
v_mfma_f32_16x16x32_bf16 v[88:91], v[196:199], v[152:155], v[88:91]
s_waitcnt lgkmcnt(10)
v_mfma_f32_16x16x32_bf16 v[40:43], v[200:203], v[152:155], v[40:43]
v_mfma_f32_16x16x32_bf16 v[88:91], v[200:203], v[156:159], v[88:91]
s_waitcnt lgkmcnt(7)
v_mfma_f32_16x16x32_bf16 v[44:47], v[204:207], v[160:163], 0
s_waitcnt lgkmcnt(6)
v_mfma_f32_16x16x32_bf16 v[92:95], v[204:207], v[164:167], 0
s_waitcnt lgkmcnt(3)
v_mfma_f32_16x16x32_bf16 v[44:47], v[208:211], v[164:167], v[44:47]
v_mfma_f32_16x16x32_bf16 v[92:95], v[208:211], v[168:171], v[92:95]
s_waitcnt lgkmcnt(0)
v_mfma_f32_16x16x32_bf16 v[44:47], v[192:195], v[168:171], v[44:47]
v_mfma_f32_16x16x32_bf16 v[92:95], v[192:195], v[172:175], v[92:95]
v_mov_b32_e64 v223, 1
v_add_u32 v222, s83, v247
s_nop 7
s_mov_b64 exec, 1
ds_add_u32 v222, v223 offset:16
s_mov_b64 exec, -1
v_pk_mul_f32 v[242:243], v[0:1], v[0:1]
v_pk_add_f32 v[240:241], v[0:1], v[2:3]
v_pk_fma_f32 v[242:243], v[2:3], v[2:3], v[242:243]
v_pk_mul_f32 v[218:219], v[48:49], v[48:49]
v_pk_add_f32 v[216:217], v[48:49], v[50:51]
v_pk_fma_f32 v[218:219], v[50:51], v[50:51], v[218:219]
v_pk_fma_f32 v[242:243], v[4:5], v[4:5], v[242:243]
v_pk_add_f32 v[240:241], v[240:241], v[4:5]
v_pk_fma_f32 v[242:243], v[6:7], v[6:7], v[242:243]
v_pk_add_f32 v[240:241], v[240:241], v[6:7]
v_pk_fma_f32 v[218:219], v[52:53], v[52:53], v[218:219]
v_pk_add_f32 v[216:217], v[216:217], v[52:53]
v_pk_fma_f32 v[218:219], v[54:55], v[54:55], v[218:219]
v_pk_add_f32 v[216:217], v[216:217], v[54:55]
v_pk_fma_f32 v[242:243], v[8:9], v[8:9], v[242:243]
v_pk_add_f32 v[240:241], v[240:241], v[8:9]
v_pk_fma_f32 v[242:243], v[10:11], v[10:11], v[242:243]
v_pk_add_f32 v[240:241], v[240:241], v[10:11]
v_pk_fma_f32 v[218:219], v[56:57], v[56:57], v[218:219]
v_pk_add_f32 v[216:217], v[216:217], v[56:57]
v_pk_fma_f32 v[218:219], v[58:59], v[58:59], v[218:219]
v_pk_add_f32 v[216:217], v[216:217], v[58:59]
v_pk_fma_f32 v[242:243], v[12:13], v[12:13], v[242:243]
v_pk_add_f32 v[240:241], v[240:241], v[12:13]
v_pk_fma_f32 v[242:243], v[14:15], v[14:15], v[242:243]
v_pk_add_f32 v[240:241], v[240:241], v[14:15]
v_pk_fma_f32 v[218:219], v[60:61], v[60:61], v[218:219]
v_pk_add_f32 v[216:217], v[216:217], v[60:61]
v_pk_fma_f32 v[218:219], v[62:63], v[62:63], v[218:219]
v_pk_add_f32 v[216:217], v[216:217], v[62:63]
v_pk_fma_f32 v[242:243], v[16:17], v[16:17], v[242:243]
v_pk_add_f32 v[240:241], v[240:241], v[16:17]
v_pk_fma_f32 v[242:243], v[18:19], v[18:19], v[242:243]
v_pk_add_f32 v[240:241], v[240:241], v[18:19]
v_pk_fma_f32 v[218:219], v[64:65], v[64:65], v[218:219]
v_pk_add_f32 v[216:217], v[216:217], v[64:65]
v_pk_fma_f32 v[218:219], v[66:67], v[66:67], v[218:219]
v_pk_add_f32 v[216:217], v[216:217], v[66:67]
v_pk_fma_f32 v[242:243], v[20:21], v[20:21], v[242:243]
v_pk_add_f32 v[240:241], v[240:241], v[20:21]
v_pk_fma_f32 v[242:243], v[22:23], v[22:23], v[242:243]
v_pk_add_f32 v[240:241], v[240:241], v[22:23]
v_pk_fma_f32 v[218:219], v[68:69], v[68:69], v[218:219]
v_pk_add_f32 v[216:217], v[216:217], v[68:69]
v_pk_fma_f32 v[218:219], v[70:71], v[70:71], v[218:219]
v_pk_add_f32 v[216:217], v[216:217], v[70:71]
v_pk_fma_f32 v[242:243], v[24:25], v[24:25], v[242:243]
v_pk_add_f32 v[240:241], v[240:241], v[24:25]
v_pk_fma_f32 v[242:243], v[26:27], v[26:27], v[242:243]
v_pk_add_f32 v[240:241], v[240:241], v[26:27]
v_pk_fma_f32 v[218:219], v[72:73], v[72:73], v[218:219]
v_pk_add_f32 v[216:217], v[216:217], v[72:73]
v_pk_fma_f32 v[218:219], v[74:75], v[74:75], v[218:219]
v_pk_add_f32 v[216:217], v[216:217], v[74:75]
v_pk_fma_f32 v[242:243], v[28:29], v[28:29], v[242:243]
v_pk_add_f32 v[240:241], v[240:241], v[28:29]
v_pk_fma_f32 v[242:243], v[30:31], v[30:31], v[242:243]
v_pk_add_f32 v[240:241], v[240:241], v[30:31]
v_pk_fma_f32 v[218:219], v[76:77], v[76:77], v[218:219]
v_pk_add_f32 v[216:217], v[216:217], v[76:77]
v_pk_fma_f32 v[218:219], v[78:79], v[78:79], v[218:219]
v_pk_add_f32 v[216:217], v[216:217], v[78:79]
v_pk_fma_f32 v[242:243], v[32:33], v[32:33], v[242:243]
v_pk_add_f32 v[240:241], v[240:241], v[32:33]
v_pk_fma_f32 v[242:243], v[34:35], v[34:35], v[242:243]
v_pk_add_f32 v[240:241], v[240:241], v[34:35]
v_pk_fma_f32 v[218:219], v[80:81], v[80:81], v[218:219]
v_pk_add_f32 v[216:217], v[216:217], v[80:81]
v_pk_fma_f32 v[218:219], v[82:83], v[82:83], v[218:219]
v_pk_add_f32 v[216:217], v[216:217], v[82:83]
v_pk_fma_f32 v[242:243], v[36:37], v[36:37], v[242:243]
v_pk_add_f32 v[240:241], v[240:241], v[36:37]
v_pk_fma_f32 v[242:243], v[38:39], v[38:39], v[242:243]
v_pk_add_f32 v[240:241], v[240:241], v[38:39]
v_pk_fma_f32 v[218:219], v[84:85], v[84:85], v[218:219]
v_pk_add_f32 v[216:217], v[216:217], v[84:85]
v_pk_fma_f32 v[218:219], v[86:87], v[86:87], v[218:219]
v_pk_add_f32 v[216:217], v[216:217], v[86:87]
v_pk_fma_f32 v[242:243], v[40:41], v[40:41], v[242:243]
v_pk_add_f32 v[240:241], v[240:241], v[40:41]
v_pk_fma_f32 v[242:243], v[42:43], v[42:43], v[242:243]
v_pk_add_f32 v[240:241], v[240:241], v[42:43]
v_pk_fma_f32 v[218:219], v[88:89], v[88:89], v[218:219]
v_pk_add_f32 v[216:217], v[216:217], v[88:89]
v_pk_fma_f32 v[218:219], v[90:91], v[90:91], v[218:219]
v_pk_add_f32 v[216:217], v[216:217], v[90:91]
v_pk_fma_f32 v[242:243], v[44:45], v[44:45], v[242:243]
v_pk_add_f32 v[240:241], v[240:241], v[44:45]
v_pk_fma_f32 v[242:243], v[46:47], v[46:47], v[242:243]
v_pk_add_f32 v[240:241], v[240:241], v[46:47]
v_pk_fma_f32 v[218:219], v[92:93], v[92:93], v[218:219]
v_pk_add_f32 v[216:217], v[216:217], v[92:93]
v_pk_fma_f32 v[218:219], v[94:95], v[94:95], v[218:219]
v_pk_add_f32 v[216:217], v[216:217], v[94:95]
v_add_f32 v218, v218, v219
v_add_f32 v216, v216, v217
s_nop 1
v_permlane32_swap_b32 v216, v218
v_add_f32_e64 v216, v216, v218
v_mul_f32 v216, 1009429163, v216
v_mov_b32_e64 v218, v216
s_nop 1
v_permlane32_swap_b32 v216, v218
v_fma_f32 v218, -v216, v216, v218
v_max_f32_e64 v218, 0, v218
v_add_f32 v218, 925353388, v218
v_rsq_f32 v218, v218
v_add_f32 v240, v240, v241
v_mul_f32 v220, 3203396952, v218
v_mul_f32 v221, 3203396952, v218
v_mul_f32 v218, v216, v220
v_mul_f32 v219, v216, v220
v_add_f32 v242, v242, v243
s_nop 1
v_permlane32_swap_b32 v240, v242
v_add_f32 v240, v240, v242
v_mul_f32 v240, 1009429163, v240
v_mov_b32_e64 v242, v240
s_nop 1
v_permlane32_swap_b32 v240, v242
v_fma_f32 v242, -v240, v240, v242
v_max_f32_e64 v242, 0, v242
v_add_f32 v242, 925353388, v242
v_rsq_f32_e64 v242, v242
v_pk_fma_f32 v[48:49], v[48:49], v[220:221], v[218:219] neg_lo:[0,0,1] neg_hi:[0,0,1]
v_mul_f32 v244, 3203396952, v242
v_mul_f32 v245, 3203396952, v242
v_mul_f32 v242, v240, v244
v_mul_f32 v243, v240, v244
v_pk_fma_f32 v[0:1], v[0:1], v[244:245], v[242:243] neg_lo:[0,0,1] neg_hi:[0,0,1]
v_pk_fma_f32 v[2:3], v[2:3], v[244:245], v[242:243] neg_lo:[0,0,1] neg_hi:[0,0,1]
v_cvt_pk_bf16_f32 v0, v0, v1
v_cvt_pk_bf16_f32 v1, v2, v3
v_pk_fma_f32 v[4:5], v[4:5], v[244:245], v[242:243] neg_lo:[0,0,1] neg_hi:[0,0,1]
v_pk_fma_f32 v[6:7], v[6:7], v[244:245], v[242:243] neg_lo:[0,0,1] neg_hi:[0,0,1]
v_cvt_pk_bf16_f32 v2, v4, v5
v_cvt_pk_bf16_f32 v3, v6, v7
v_pk_fma_f32 v[8:9], v[8:9], v[244:245], v[242:243] neg_lo:[0,0,1] neg_hi:[0,0,1]
v_pk_fma_f32 v[10:11], v[10:11], v[244:245], v[242:243] neg_lo:[0,0,1] neg_hi:[0,0,1]
v_cvt_pk_bf16_f32 v4, v8, v9
v_cvt_pk_bf16_f32 v5, v10, v11
v_pk_fma_f32 v[12:13], v[12:13], v[244:245], v[242:243] neg_lo:[0,0,1] neg_hi:[0,0,1]
v_pk_fma_f32 v[14:15], v[14:15], v[244:245], v[242:243] neg_lo:[0,0,1] neg_hi:[0,0,1]
v_cvt_pk_bf16_f32 v6, v12, v13
v_cvt_pk_bf16_f32 v7, v14, v15
v_pk_fma_f32 v[16:17], v[16:17], v[244:245], v[242:243] neg_lo:[0,0,1] neg_hi:[0,0,1]
v_pk_fma_f32 v[18:19], v[18:19], v[244:245], v[242:243] neg_lo:[0,0,1] neg_hi:[0,0,1]
v_cvt_pk_bf16_f32 v8, v16, v17
v_cvt_pk_bf16_f32 v9, v18, v19
v_pk_fma_f32 v[20:21], v[20:21], v[244:245], v[242:243] neg_lo:[0,0,1] neg_hi:[0,0,1]
v_pk_fma_f32 v[22:23], v[22:23], v[244:245], v[242:243] neg_lo:[0,0,1] neg_hi:[0,0,1]
v_cvt_pk_bf16_f32 v10, v20, v21
v_cvt_pk_bf16_f32 v11, v22, v23
v_pk_fma_f32 v[24:25], v[24:25], v[244:245], v[242:243] neg_lo:[0,0,1] neg_hi:[0,0,1]
v_pk_fma_f32 v[26:27], v[26:27], v[244:245], v[242:243] neg_lo:[0,0,1] neg_hi:[0,0,1]
v_cvt_pk_bf16_f32 v12, v24, v25
v_cvt_pk_bf16_f32 v13, v26, v27
v_mov_b32 v223, 0
s_branch Law2
Lax2:
s_sleep 2
Law2:
ds_read_b32 v223, v247 offset:8
s_sub_u32 s76, s76, 1
s_cselect_b32 s44, 4, 0
s_cselect_b32 s76, 0, s76
s_waitcnt lgkmcnt(0)
v_readfirstlane_b32 s43, v223
s_nop 1
s_max_u32 s43, s43, s44
s_cmp_lt_u32 s43, 4
s_cbranch_scc1 Lax2
v_pk_fma_f32 v[28:29], v[28:29], v[244:245], v[242:243] neg_lo:[0,0,1] neg_hi:[0,0,1]
v_pk_fma_f32 v[30:31], v[30:31], v[244:245], v[242:243] neg_lo:[0,0,1] neg_hi:[0,0,1]
v_cvt_pk_bf16_f32 v14, v28, v29
v_cvt_pk_bf16_f32 v15, v30, v31
v_pk_fma_f32 v[32:33], v[32:33], v[244:245], v[242:243] neg_lo:[0,0,1] neg_hi:[0,0,1]
v_pk_fma_f32 v[34:35], v[34:35], v[244:245], v[242:243] neg_lo:[0,0,1] neg_hi:[0,0,1]
v_cvt_pk_bf16_f32 v16, v32, v33
v_cvt_pk_bf16_f32 v17, v34, v35
v_pk_fma_f32 v[36:37], v[36:37], v[244:245], v[242:243] neg_lo:[0,0,1] neg_hi:[0,0,1]
v_pk_fma_f32 v[38:39], v[38:39], v[244:245], v[242:243] neg_lo:[0,0,1] neg_hi:[0,0,1]
v_cvt_pk_bf16_f32 v18, v36, v37
v_cvt_pk_bf16_f32 v19, v38, v39
v_pk_fma_f32 v[40:41], v[40:41], v[244:245], v[242:243] neg_lo:[0,0,1] neg_hi:[0,0,1]
ds_read_b128 v[176:179], v250
v_cvt_pk_bf16_f32 v20, v40, v41
v_pk_fma_f32 v[42:43], v[42:43], v[244:245], v[242:243] neg_lo:[0,0,1] neg_hi:[0,0,1]
v_pk_fma_f32 v[44:45], v[44:45], v[244:245], v[242:243] neg_lo:[0,0,1] neg_hi:[0,0,1]
v_cvt_pk_bf16_f32 v21, v42, v43
v_cvt_pk_bf16_f32 v22, v44, v45
v_pk_fma_f32 v[46:47], v[46:47], v[244:245], v[242:243] neg_lo:[0,0,1] neg_hi:[0,0,1]
v_cvt_pk_bf16_f32 v24, v48, v49
v_cvt_pk_bf16_f32 v23, v46, v47
v_pk_fma_f32 v[50:51], v[50:51], v[220:221], v[218:219] neg_lo:[0,0,1] neg_hi:[0,0,1]
v_pk_fma_f32 v[52:53], v[52:53], v[220:221], v[218:219] neg_lo:[0,0,1] neg_hi:[0,0,1]
v_cvt_pk_bf16_f32 v25, v50, v51
v_cvt_pk_bf16_f32 v26, v52, v53
v_pk_fma_f32 v[54:55], v[54:55], v[220:221], v[218:219] neg_lo:[0,0,1] neg_hi:[0,0,1]
v_pk_fma_f32 v[56:57], v[56:57], v[220:221], v[218:219] neg_lo:[0,0,1] neg_hi:[0,0,1]
v_cvt_pk_bf16_f32 v27, v54, v55
v_cvt_pk_bf16_f32 v28, v56, v57
v_pk_fma_f32 v[58:59], v[58:59], v[220:221], v[218:219] neg_lo:[0,0,1] neg_hi:[0,0,1]
v_pk_fma_f32 v[60:61], v[60:61], v[220:221], v[218:219] neg_lo:[0,0,1] neg_hi:[0,0,1]
v_cvt_pk_bf16_f32 v29, v58, v59
v_cvt_pk_bf16_f32 v30, v60, v61
v_pk_fma_f32 v[62:63], v[62:63], v[220:221], v[218:219] neg_lo:[0,0,1] neg_hi:[0,0,1]
v_pk_fma_f32 v[64:65], v[64:65], v[220:221], v[218:219] neg_lo:[0,0,1] neg_hi:[0,0,1]
v_cvt_pk_bf16_f32 v31, v62, v63
v_cvt_pk_bf16_f32 v32, v64, v65
ds_read_b128 v[180:183], v250 offset:1024
v_pk_fma_f32 v[66:67], v[66:67], v[220:221], v[218:219] neg_lo:[0,0,1] neg_hi:[0,0,1]
v_pk_fma_f32 v[68:69], v[68:69], v[220:221], v[218:219] neg_lo:[0,0,1] neg_hi:[0,0,1]
v_cvt_pk_bf16_f32 v33, v66, v67
v_cvt_pk_bf16_f32 v34, v68, v69
v_pk_fma_f32 v[70:71], v[70:71], v[220:221], v[218:219] neg_lo:[0,0,1] neg_hi:[0,0,1]
v_pk_fma_f32 v[72:73], v[72:73], v[220:221], v[218:219] neg_lo:[0,0,1] neg_hi:[0,0,1]
v_cvt_pk_bf16_f32 v35, v70, v71
v_cvt_pk_bf16_f32 v36, v72, v73
v_pk_fma_f32 v[74:75], v[74:75], v[220:221], v[218:219] neg_lo:[0,0,1] neg_hi:[0,0,1]
v_pk_fma_f32 v[76:77], v[76:77], v[220:221], v[218:219] neg_lo:[0,0,1] neg_hi:[0,0,1]
v_cvt_pk_bf16_f32 v37, v74, v75
v_cvt_pk_bf16_f32 v38, v76, v77
v_pk_fma_f32 v[78:79], v[78:79], v[220:221], v[218:219] neg_lo:[0,0,1] neg_hi:[0,0,1]
v_pk_fma_f32 v[80:81], v[80:81], v[220:221], v[218:219] neg_lo:[0,0,1] neg_hi:[0,0,1]
v_cvt_pk_bf16_f32 v39, v78, v79
v_cvt_pk_bf16_f32 v40, v80, v81
v_pk_fma_f32 v[82:83], v[82:83], v[220:221], v[218:219] neg_lo:[0,0,1] neg_hi:[0,0,1]
v_pk_fma_f32 v[84:85], v[84:85], v[220:221], v[218:219] neg_lo:[0,0,1] neg_hi:[0,0,1]
v_cvt_pk_bf16_f32 v41, v82, v83
v_cvt_pk_bf16_f32 v42, v84, v85
v_pk_fma_f32 v[86:87], v[86:87], v[220:221], v[218:219] neg_lo:[0,0,1] neg_hi:[0,0,1]
ds_read_b128 v[184:187], v250 offset:2048
v_cvt_pk_bf16_f32 v43, v86, v87
v_pk_fma_f32 v[88:89], v[88:89], v[220:221], v[218:219] neg_lo:[0,0,1] neg_hi:[0,0,1]
v_pk_fma_f32 v[90:91], v[90:91], v[220:221], v[218:219] neg_lo:[0,0,1] neg_hi:[0,0,1]
v_cvt_pk_bf16_f32 v44, v88, v89
v_cvt_pk_bf16_f32 v45, v90, v91
v_pk_fma_f32 v[92:93], v[92:93], v[220:221], v[218:219] neg_lo:[0,0,1] neg_hi:[0,0,1]
v_pk_fma_f32 v[94:95], v[94:95], v[220:221], v[218:219] neg_lo:[0,0,1] neg_hi:[0,0,1]
v_cvt_pk_bf16_f32 v46, v92, v93
v_cvt_pk_bf16_f32 v47, v94, v95
s_waitcnt lgkmcnt(1)
v_mfma_f32_32x32x16_bf16 v[160:175], v[0:3], v[176:179], 0
ds_read_b128 v[188:191], v250 offset:3072
v_mfma_f32_32x32x16_bf16 v[96:111], v[24:27], v[176:179], 0
ds_read_b128 v[176:179], v250 offset:4096
v_mfma_f32_32x32x16_bf16 v[160:175], v[4:7], v[180:183], v[160:175]
v_mfma_f32_32x32x16_bf16 v[96:111], v[28:31], v[180:183], v[96:111]
ds_read_b128 v[180:183], v250 offset:5120
s_waitcnt lgkmcnt(3)
v_mfma_f32_32x32x16_bf16 v[160:175], v[8:11], v[184:187], v[160:175]
v_mfma_f32_32x32x16_bf16 v[96:111], v[32:35], v[184:187], v[96:111]
ds_read_b128 v[184:187], v250 offset:6144
s_waitcnt lgkmcnt(2)
v_mfma_f32_32x32x16_bf16 v[160:175], v[12:15], v[188:191], v[160:175]
v_mfma_f32_32x32x16_bf16 v[96:111], v[36:39], v[188:191], v[96:111]
ds_read_b128 v[188:191], v250 offset:7168
v_mfma_f32_32x32x16_bf16 v[160:175], v[16:19], v[176:179], v[160:175]
v_mfma_f32_32x32x16_bf16 v[96:111], v[40:43], v[176:179], v[96:111]
ds_read_b128 v[176:179], v250 offset:8192
s_waitcnt lgkmcnt(2)
v_mfma_f32_32x32x16_bf16 v[160:175], v[20:23], v[180:183], v[160:175]
v_mfma_f32_32x32x16_bf16 v[96:111], v[44:47], v[180:183], v[96:111]
s_getpc_b64 s[74:75]
Lcq1:
s_lshl_b32 s43, s40, 10
s_add_u32 s43, s43, 6144
s_min_u32 s43, s43, Lend-Lcq1-1024
s_add_u32 s74, s74, s43
s_addc_u32 s75, s75, 0
s_sub_u32 s74, s74, 16384
s_subb_u32 s75, s75, 0
s_mov_b32 m0, 163840
s_nop 0
global_load_lds_dword v250, s[74:75]
ds_read_b128 v[180:183], v250 offset:9216
v_mfma_f32_32x32x16_bf16 v[112:127], v[0:3], v[184:187], 0
v_cvt_pkrtz_f16_f32 v161, v160, v161
v_and_b32_e64 v161, s49, v161
v_bfe_u32 v160, v161, 2, 14
v_lshrrev_b32_e64 v161, 18, v161
ds_read_u16 v160, v160
ds_read_u16 v161, v161
v_cvt_pk_f16_f32 v172, v172, v173
v_cvt_pk_f16_f32 v174, v174, v175
v_pk_fma_f16 v173, v172, v172, s48
v_mfma_f32_32x32x16_bf16 v[128:143], v[24:27], v[184:187], 0
v_cvt_pkrtz_f16_f32 v163, v162, v163
v_and_b32_e64 v163, s49, v163
v_bfe_u32 v162, v163, 2, 14
v_lshrrev_b32_e64 v163, 18, v163
ds_read_u16 v162, v162
ds_read_u16 v163, v163
v_pk_fma_f16 v175, v174, v174, s48
v_pk_mul_f16 v173, v172, v173
v_pk_mul_f16 v175, v174, v175
v_cvt_pkrtz_f16_f32 v165, v164, v165
v_and_b32_e64 v165, s49, v165
v_bfe_u32 v164, v165, 2, 14
v_lshrrev_b32 v165, 18, v165
ds_read_u16 v164, v164
ds_read_u16 v165, v165
v_exp_f16_sdwa v173, v173 dst_sel:WORD_0 dst_unused:UNUSED_PRESERVE src0_sel:WORD_0
s_waitcnt lgkmcnt(6)
v_mfma_f32_32x32x16_bf16 v[112:127], v[4:7], v[188:191], v[112:127]
v_exp_f16_sdwa v175, v175 dst_sel:WORD_0 dst_unused:UNUSED_PRESERVE src0_sel:WORD_0
v_cvt_pkrtz_f16_f32 v167, v166, v167
v_and_b32_e64 v167, s49, v167
v_bfe_u32 v166, v167, 2, 14
v_lshrrev_b32_e64 v167, 18, v167
ds_read_u16 v166, v166
ds_read_u16 v167, v167
v_exp_f16_sdwa v173, v173 dst_sel:WORD_1 dst_unused:UNUSED_PRESERVE src0_sel:WORD_1
v_cvt_pkrtz_f16_f32 v169, v168, v169
v_and_b32_e64 v169, s49, v169
v_bfe_u32 v168, v169, 2, 14
v_lshrrev_b32_e64 v169, 18, v169
ds_read_u16 v168, v168
ds_read_u16 v169, v169
v_exp_f16_sdwa v175, v175 dst_sel:WORD_1 dst_unused:UNUSED_PRESERVE src0_sel:WORD_1
v_mfma_f32_32x32x16_bf16 v[128:143], v[28:31], v[188:191], v[128:143]
ds_read_b128 v[184:187], v250 offset:10240
v_cvt_pkrtz_f16_f32 v171, v170, v171
v_and_b32_e64 v171, s49, v171
v_bfe_u32 v170, v171, 2, 14
v_lshrrev_b32_e64 v171, 18, v171
ds_read_u16 v170, v170
ds_read_u16 v171, v171
v_pk_add_f16 v173, v173, 1.0 op_sel_hi:[1,0]
v_pk_add_f16 v175, v175, 1.0 op_sel_hi:[1,0]
v_rcp_f16_sdwa v173, v173 dst_sel:WORD_0 dst_unused:UNUSED_PRESERVE src0_sel:WORD_0
v_mfma_f32_32x32x16_bf16 v[112:127], v[8:11], v[176:179], v[112:127]
v_rcp_f16_sdwa v175, v175 dst_sel:WORD_0 dst_unused:UNUSED_PRESERVE src0_sel:WORD_0
v_rcp_f16_sdwa v173, v173 dst_sel:WORD_1 dst_unused:UNUSED_PRESERVE src0_sel:WORD_1
v_rcp_f16_sdwa v175, v175 dst_sel:WORD_1 dst_unused:UNUSED_PRESERVE src0_sel:WORD_1
v_mfma_f32_32x32x16_bf16 v[128:143], v[32:35], v[176:179], v[128:143]
ds_read_b128 v[188:191], v250 offset:11264
v_pk_mul_f16 v172, v172, v173
v_pk_mul_f16 v174, v174, v175
v_fma_mix_f32 v224, v172, v172, v224 op_sel_hi:[1,1,0]
v_cvt_pkrtz_f16_f32 v97, v96, v97
v_fma_mix_f32 v224, v174, v174, v224 op_sel_hi:[1,1,0]
v_mfma_f32_32x32x16_bf16 v[112:127], v[12:15], v[180:183], v[112:127]
v_fma_mix_f32 v224, v172, v172, v224 op_sel:[1,1,0] op_sel_hi:[1,1,0]
v_and_b32_e64 v97, s49, v97
v_fma_mix_f32 v224, v174, v174, v224 op_sel:[1,1,0] op_sel_hi:[1,1,0]
v_bfe_u32 v96, v97, 2, 14
s_waitcnt lgkmcnt(7)
v_fma_mix_f32 v224, v160, v160, v224 op_sel_hi:[1,1,0]
v_lshrrev_b32 v97, 18, v97
v_fma_mix_f32 v224, v161, v161, v224 op_sel_hi:[1,1,0]
ds_read_u16 v96, v96
v_fma_mix_f32 v224, v162, v162, v224 op_sel_hi:[1,1,0]
ds_read_u16 v97, v97
v_fma_mix_f32 v224, v163, v163, v224 op_sel_hi:[1,1,0]
v_cvt_pk_f16_f32 v106, v106, v107
v_cvt_pk_f16_f32 v108, v108, v109
v_cvt_pk_f16_f32 v110, v110, v111
v_pk_fma_f16 v107, v106, v106, s48
v_mfma_f32_32x32x16_bf16 v[128:143], v[36:39], v[180:183], v[128:143]
v_fma_mix_f32 v224, v164, v164, v224 op_sel_hi:[1,1,0]
v_pk_fma_f16 v109, v108, v108, s48
v_fma_mix_f32 v224, v165, v165, v224 op_sel_hi:[1,1,0]
ds_read_b128 v[176:179], v250 offset:12288
v_cvt_pkrtz_f16_f32 v99, v98, v99
v_and_b32_e64 v99, s49, v99
v_bfe_u32 v98, v99, 2, 14
v_lshrrev_b32_e64 v99, 18, v99
ds_read_u16 v98, v98
ds_read_u16 v99, v99
v_pk_fma_f16 v111, v110, v110, s48
v_pk_mul_f16 v107, v106, v107
v_pk_mul_f16 v109, v108, v109
v_fma_mix_f32 v224, v166, v166, v224 op_sel_hi:[1,1,0]
v_pk_mul_f16 v111, v110, v111
s_waitcnt lgkmcnt(7)
v_fma_mix_f32 v224, v167, v167, v224 op_sel_hi:[1,1,0]
v_exp_f16_sdwa v107, v107 dst_sel:WORD_0 dst_unused:UNUSED_PRESERVE src0_sel:WORD_0
v_cvt_pkrtz_f16_f32 v101, v100, v101
v_and_b32 v101, s49, v101
v_bfe_u32 v100, v101, 2, 14
v_lshrrev_b32_e64 v101, 18, v101
ds_read_u16 v100, v100
ds_read_u16 v101, v101
v_mfma_f32_32x32x16_bf16 v[112:127], v[16:19], v[184:187], v[112:127]
v_exp_f16_sdwa v109, v109 dst_sel:WORD_0 dst_unused:UNUSED_PRESERVE src0_sel:WORD_0
v_fma_mix_f32 v224, v168, v168, v224 op_sel_hi:[1,1,0]
v_exp_f16_sdwa v111, v111 dst_sel:WORD_0 dst_unused:UNUSED_PRESERVE src0_sel:WORD_0
v_fma_mix_f32 v224, v169, v169, v224 op_sel_hi:[1,1,0]
v_cvt_pkrtz_f16_f32 v103, v102, v103
v_and_b32_e64 v103, s49, v103
v_bfe_u32 v102, v103, 2, 14
v_lshrrev_b32_e64 v103, 18, v103
ds_read_u16 v102, v102
ds_read_u16 v103, v103
v_exp_f16_sdwa v107, v107 dst_sel:WORD_1 dst_unused:UNUSED_PRESERVE src0_sel:WORD_1
v_fma_mix_f32 v224, v170, v170, v224 op_sel_hi:[1,1,0]
v_exp_f16_sdwa v109, v109 dst_sel:WORD_1 dst_unused:UNUSED_PRESERVE src0_sel:WORD_1
s_waitcnt lgkmcnt(7)
v_fma_mix_f32 v224, v171, v171, v224 op_sel_hi:[1,1,0]
v_mfma_f32_32x32x16_bf16 v[128:143], v[40:43], v[184:187], v[128:143]
v_exp_f16_sdwa v111, v111 dst_sel:WORD_1 dst_unused:UNUSED_PRESERVE src0_sel:WORD_1
ds_read_b128 v[180:183], v250 offset:13312
v_cvt_pkrtz_f16_f32 v105, v104, v105
v_and_b32 v105, s49, v105
v_bfe_u32 v104, v105, 2, 14
v_lshrrev_b32_e64 v105, 18, v105
ds_read_u16 v104, v104
ds_read_u16 v105, v105
v_pk_add_f16 v107, v107, 1.0 op_sel_hi:[1,0]
v_pk_add_f16 v109, v109, 1.0 op_sel_hi:[1,0]
v_pk_add_f16 v111, v111, 1.0 op_sel_hi:[1,0]
v_rcp_f16_sdwa v107, v107 dst_sel:WORD_0 dst_unused:UNUSED_PRESERVE src0_sel:WORD_0
v_mfma_f32_32x32x16_bf16 v[112:127], v[20:23], v[188:191], v[112:127]
v_rcp_f16_sdwa v109, v109 dst_sel:WORD_0 dst_unused:UNUSED_PRESERVE src0_sel:WORD_0
v_rcp_f16_sdwa v111, v111 dst_sel:WORD_0 dst_unused:UNUSED_PRESERVE src0_sel:WORD_0
v_rcp_f16_sdwa v107, v107 dst_sel:WORD_1 dst_unused:UNUSED_PRESERVE src0_sel:WORD_1
v_rcp_f16_sdwa v109, v109 dst_sel:WORD_1 dst_unused:UNUSED_PRESERVE src0_sel:WORD_1
v_mfma_f32_32x32x16_bf16 v[128:143], v[44:47], v[188:191], v[128:143]
v_rcp_f16_sdwa v111, v111 dst_sel:WORD_1 dst_unused:UNUSED_PRESERVE src0_sel:WORD_1
ds_read_b128 v[184:187], v250 offset:14336
v_pk_mul_f16 v106, v106, v107
v_pk_mul_f16 v108, v108, v109
v_pk_mul_f16 v110, v110, v111
v_fma_mix_f32 v224, v106, v106, v224 op_sel_hi:[1,1,0]
s_waitcnt lgkmcnt(5)
v_mfma_f32_32x32x16_bf16 v[144:159], v[0:3], v[176:179], 0
v_fma_mix_f32 v224, v108, v108, v224 op_sel_hi:[1,1,0]
buffer_store_dwordx4 v[0:3], v250, s[32:35], s80 offen
v_fma_mix_f32 v224, v110, v110, v224 op_sel_hi:[1,1,0]
v_cvt_pkrtz_f16_f32 v113, v112, v113
v_fma_mix_f32 v224, v106, v106, v224 op_sel:[1,1,0] op_sel_hi:[1,1,0]
v_and_b32 v113, s49, v113
v_fma_mix_f32 v224, v108, v108, v224 op_sel:[1,1,0] op_sel_hi:[1,1,0]
v_bfe_u32 v112, v113, 2, 14
v_fma_mix_f32 v224, v110, v110, v224 op_sel:[1,1,0] op_sel_hi:[1,1,0]
v_lshrrev_b32_e64 v113, 18, v113
v_fma_mix_f32 v224, v96, v96, v224 op_sel_hi:[1,1,0]
ds_read_u16 v112, v112
v_fma_mix_f32 v224, v97, v97, v224 op_sel_hi:[1,1,0]
ds_read_u16 v113, v113
v_cvt_pk_f16_f32 v124, v124, v125
v_fma_mix_f32 v224, v98, v98, v224 op_sel_hi:[1,1,0]
v_cvt_pk_f16_f32 v126, v126, v127
v_fma_mix_f32 v224, v99, v99, v224 op_sel_hi:[1,1,0]
v_pk_fma_f16 v125, v124, v124, s48
v_mfma_f32_32x32x16_bf16 v[160:175], v[24:27], v[176:179], 0
v_cvt_pkrtz_f16_f32 v115, v114, v115
v_and_b32_e64 v115, s49, v115
v_bfe_u32 v114, v115, 2, 14
v_lshrrev_b32_e64 v115, 18, v115
ds_read_u16 v114, v114
ds_read_u16 v115, v115
v_pk_fma_f16 v127, v126, v126, s48
ds_read_b128 v[188:191], v250 offset:15360
v_fma_mix_f32 v224, v100, v100, v224 op_sel_hi:[1,1,0]
v_pk_mul_f16 v125, v124, v125
v_fma_mix_f32 v224, v101, v101, v224 op_sel_hi:[1,1,0]
v_pk_mul_f16 v127, v126, v127
v_cvt_pkrtz_f16_f32 v117, v116, v117
v_and_b32_e64 v117, s49, v117
v_bfe_u32 v116, v117, 2, 14
v_lshrrev_b32 v117, 18, v117
ds_read_u16 v116, v116
ds_read_u16 v117, v117
v_exp_f16_sdwa v125, v125 dst_sel:WORD_0 dst_unused:UNUSED_PRESERVE src0_sel:WORD_0
v_fma_mix_f32 v224, v102, v102, v224 op_sel_hi:[1,1,0]
s_waitcnt lgkmcnt(7)
v_mfma_f32_32x32x16_bf16 v[144:159], v[4:7], v[180:183], v[144:159]
v_fma_mix_f32 v224, v103, v103, v224 op_sel_hi:[1,1,0]
v_exp_f16_sdwa v127, v127 dst_sel:WORD_0 dst_unused:UNUSED_PRESERVE src0_sel:WORD_0
v_cvt_pkrtz_f16_f32 v119, v118, v119
v_and_b32_e64 v119, s49, v119
v_bfe_u32 v118, v119, 2, 14
v_lshrrev_b32_e64 v119, 18, v119
ds_read_u16 v118, v118
ds_read_u16 v119, v119
v_exp_f16_sdwa v125, v125 dst_sel:WORD_1 dst_unused:UNUSED_PRESERVE src0_sel:WORD_1
v_fma_mix_f32 v224, v104, v104, v224 op_sel_hi:[1,1,0]
v_cvt_pkrtz_f16_f32 v121, v120, v121
v_fma_mix_f32 v224, v105, v105, v224 op_sel_hi:[1,1,0]
v_and_b32_e64 v121, s49, v121
v_bfe_u32 v120, v121, 2, 14
v_lshrrev_b32_e64 v121, 18, v121
ds_read_u16 v120, v120
ds_read_u16 v121, v121
v_exp_f16_sdwa v127, v127 dst_sel:WORD_1 dst_unused:UNUSED_PRESERVE src0_sel:WORD_1
v_mfma_f32_32x32x16_bf16 v[160:175], v[28:31], v[180:183], v[160:175]
ds_read_b128 v[176:179], v250 offset:16384
v_cvt_pkrtz_f16_f32 v123, v122, v123
v_and_b32_e64 v123, s49, v123
v_bfe_u32 v122, v123, 2, 14
v_lshrrev_b32_e64 v123, 18, v123
ds_read_u16 v122, v122
ds_read_u16 v123, v123
v_pk_add_f16 v125, v125, 1.0 op_sel_hi:[1,0]
v_pk_add_f16 v127, v127, 1.0 op_sel_hi:[1,0]
v_rcp_f16_sdwa v125, v125 dst_sel:WORD_0 dst_unused:UNUSED_PRESERVE src0_sel:WORD_0
v_mfma_f32_32x32x16_bf16 v[144:159], v[8:11], v[184:187], v[144:159]
v_rcp_f16_sdwa v127, v127 dst_sel:WORD_0 dst_unused:UNUSED_PRESERVE src0_sel:WORD_0
s_add_u32 s46, s80, 2097152
buffer_store_dwordx4 v[4:7], v250, s[32:35], s46 offen
v_rcp_f16_sdwa v125, v125 dst_sel:WORD_1 dst_unused:UNUSED_PRESERVE src0_sel:WORD_1
v_rcp_f16_sdwa v127, v127 dst_sel:WORD_1 dst_unused:UNUSED_PRESERVE src0_sel:WORD_1
v_mfma_f32_32x32x16_bf16 v[160:175], v[32:35], v[184:187], v[160:175]
ds_read_b128 v[180:183], v250 offset:17408
v_pk_mul_f16 v124, v124, v125
v_pk_mul_f16 v126, v126, v127
v_fma_mix_f32 v225, v124, v124, v225 op_sel_hi:[1,1,0]
v_cvt_pkrtz_f16_f32 v129, v128, v129
v_fma_mix_f32 v225, v126, v126, v225 op_sel_hi:[1,1,0]
s_waitcnt lgkmcnt(7)
v_mfma_f32_32x32x16_bf16 v[144:159], v[12:15], v[188:191], v[144:159]
v_fma_mix_f32 v225, v124, v124, v225 op_sel:[1,1,0] op_sel_hi:[1,1,0]
v_and_b32 v129, s49, v129
v_fma_mix_f32 v225, v126, v126, v225 op_sel:[1,1,0] op_sel_hi:[1,1,0]
v_bfe_u32 v128, v129, 2, 14
v_fma_mix_f32 v225, v112, v112, v225 op_sel_hi:[1,1,0]
v_lshrrev_b32_e64 v129, 18, v129
v_fma_mix_f32 v225, v113, v113, v225 op_sel_hi:[1,1,0]
ds_read_u16 v128, v128
v_fma_mix_f32 v225, v114, v114, v225 op_sel_hi:[1,1,0]
ds_read_u16 v129, v129
v_fma_mix_f32 v225, v115, v115, v225 op_sel_hi:[1,1,0]
v_cvt_pk_f16_f32 v138, v138, v139
v_cvt_pk_f16_f32 v140, v140, v141
v_cvt_pk_f16_f32 v142, v142, v143
v_pk_fma_f16 v139, v138, v138, s48
v_mfma_f32_32x32x16_bf16 v[160:175], v[36:39], v[188:191], v[160:175]
v_fma_mix_f32 v225, v116, v116, v225 op_sel_hi:[1,1,0]
v_pk_fma_f16 v141, v140, v140, s48
v_fma_mix_f32 v225, v117, v117, v225 op_sel_hi:[1,1,0]
ds_read_b128 v[184:187], v250 offset:18432
v_cvt_pkrtz_f16_f32 v131, v130, v131
v_and_b32_e64 v131, s49, v131
v_bfe_u32 v130, v131, 2, 14
v_lshrrev_b32_e64 v131, 18, v131
ds_read_u16 v130, v130
ds_read_u16 v131, v131
v_pk_fma_f16 v143, v142, v142, s48
v_pk_mul_f16 v139, v138, v139
v_pk_mul_f16 v141, v140, v141
v_fma_mix_f32 v225, v118, v118, v225 op_sel_hi:[1,1,0]
v_pk_mul_f16 v143, v142, v143
s_waitcnt lgkmcnt(6)
v_fma_mix_f32 v225, v119, v119, v225 op_sel_hi:[1,1,0]
v_exp_f16_sdwa v139, v139 dst_sel:WORD_0 dst_unused:UNUSED_PRESERVE src0_sel:WORD_0
v_cvt_pkrtz_f16_f32 v133, v132, v133
v_and_b32 v133, s49, v133
v_bfe_u32 v132, v133, 2, 14
v_lshrrev_b32_e64 v133, 18, v133
ds_read_u16 v132, v132
ds_read_u16 v133, v133
v_mfma_f32_32x32x16_bf16 v[144:159], v[16:19], v[176:179], v[144:159]
v_exp_f16_sdwa v141, v141 dst_sel:WORD_0 dst_unused:UNUSED_PRESERVE src0_sel:WORD_0
v_fma_mix_f32 v225, v120, v120, v225 op_sel_hi:[1,1,0]
v_exp_f16_sdwa v143, v143 dst_sel:WORD_0 dst_unused:UNUSED_PRESERVE src0_sel:WORD_0
v_fma_mix_f32 v225, v121, v121, v225 op_sel_hi:[1,1,0]
s_add_u32 s46, s80, 4194304
buffer_store_dwordx4 v[8:11], v250, s[32:35], s46 offen
v_cvt_pkrtz_f16_f32 v135, v134, v135
v_and_b32_e64 v135, s49, v135
v_bfe_u32 v134, v135, 2, 14
v_lshrrev_b32_e64 v135, 18, v135
ds_read_u16 v134, v134
ds_read_u16 v135, v135
v_exp_f16_sdwa v139, v139 dst_sel:WORD_1 dst_unused:UNUSED_PRESERVE src0_sel:WORD_1
v_fma_mix_f32 v225, v122, v122, v225 op_sel_hi:[1,1,0]
v_exp_f16_sdwa v141, v141 dst_sel:WORD_1 dst_unused:UNUSED_PRESERVE src0_sel:WORD_1
v_fma_mix_f32 v225, v123, v123, v225 op_sel_hi:[1,1,0]
v_mfma_f32_32x32x16_bf16 v[160:175], v[40:43], v[176:179], v[160:175]
v_exp_f16_sdwa v143, v143 dst_sel:WORD_1 dst_unused:UNUSED_PRESERVE src0_sel:WORD_1
ds_read_b128 v[188:191], v250 offset:19456
v_cvt_pkrtz_f16_f32 v137, v136, v137
v_and_b32_e64 v137, s49, v137
v_bfe_u32 v136, v137, 2, 14
v_lshrrev_b32 v137, 18, v137
ds_read_u16 v136, v136
ds_read_u16 v137, v137
v_pk_add_f16 v139, v139, 1.0 op_sel_hi:[1,0]
v_pk_add_f16 v141, v141, 1.0 op_sel_hi:[1,0]
v_pk_add_f16 v143, v143, 1.0 op_sel_hi:[1,0]
v_rcp_f16_sdwa v139, v139 dst_sel:WORD_0 dst_unused:UNUSED_PRESERVE src0_sel:WORD_0
s_waitcnt lgkmcnt(6)
v_mfma_f32_32x32x16_bf16 v[144:159], v[20:23], v[180:183], v[144:159]
v_rcp_f16_sdwa v141, v141 dst_sel:WORD_0 dst_unused:UNUSED_PRESERVE src0_sel:WORD_0
v_rcp_f16_sdwa v143, v143 dst_sel:WORD_0 dst_unused:UNUSED_PRESERVE src0_sel:WORD_0
v_rcp_f16_sdwa v139, v139 dst_sel:WORD_1 dst_unused:UNUSED_PRESERVE src0_sel:WORD_1
v_rcp_f16_sdwa v141, v141 dst_sel:WORD_1 dst_unused:UNUSED_PRESERVE src0_sel:WORD_1
v_mfma_f32_32x32x16_bf16 v[160:175], v[44:47], v[180:183], v[160:175]
v_rcp_f16_sdwa v143, v143 dst_sel:WORD_1 dst_unused:UNUSED_PRESERVE src0_sel:WORD_1
ds_read_b128 v[176:179], v250 offset:20480
v_pk_mul_f16 v138, v138, v139
v_pk_mul_f16 v140, v140, v141
v_pk_mul_f16 v142, v142, v143
v_fma_mix_f32 v225, v138, v138, v225 op_sel_hi:[1,1,0]
v_mfma_f32_32x32x16_bf16 v[96:111], v[0:3], v[184:187], 0
v_fma_mix_f32 v225, v140, v140, v225 op_sel_hi:[1,1,0]
v_cvt_pkrtz_f16_f32 v145, v144, v145
v_fma_mix_f32 v225, v142, v142, v225 op_sel_hi:[1,1,0]
v_and_b32_e64 v145, s49, v145
v_fma_mix_f32 v225, v138, v138, v225 op_sel:[1,1,0] op_sel_hi:[1,1,0]
v_bfe_u32 v144, v145, 2, 14
v_fma_mix_f32 v225, v140, v140, v225 op_sel:[1,1,0] op_sel_hi:[1,1,0]
v_lshrrev_b32_e64 v145, 18, v145
v_fma_mix_f32 v225, v142, v142, v225 op_sel:[1,1,0] op_sel_hi:[1,1,0]
ds_read_u16 v144, v144
v_fma_mix_f32 v225, v128, v128, v225 op_sel_hi:[1,1,0]
ds_read_u16 v145, v145
v_fma_mix_f32 v225, v129, v129, v225 op_sel_hi:[1,1,0]
v_cvt_pk_f16_f32 v156, v156, v157
s_add_u32 s46, s80, 6291456
buffer_store_dwordx4 v[12:15], v250, s[32:35], s46 offen
v_fma_mix_f32 v225, v130, v130, v225 op_sel_hi:[1,1,0]
v_cvt_pk_f16_f32 v158, v158, v159
v_fma_mix_f32 v225, v131, v131, v225 op_sel_hi:[1,1,0]
v_pk_fma_f16 v157, v156, v156, s48
v_mfma_f32_32x32x16_bf16 v[112:127], v[24:27], v[184:187], 0
v_cvt_pkrtz_f16_f32 v147, v146, v147
v_and_b32_e64 v147, s49, v147
v_bfe_u32 v146, v147, 2, 14
v_lshrrev_b32_e64 v147, 18, v147
ds_read_u16 v146, v146
ds_read_u16 v147, v147
v_pk_fma_f16 v159, v158, v158, s48
ds_read_b128 v[180:183], v250 offset:21504
v_fma_mix_f32 v225, v132, v132, v225 op_sel_hi:[1,1,0]
v_pk_mul_f16 v157, v156, v157
s_waitcnt lgkmcnt(5)
v_fma_mix_f32 v225, v133, v133, v225 op_sel_hi:[1,1,0]
v_pk_mul_f16 v159, v158, v159
v_cvt_pkrtz_f16_f32 v149, v148, v149
v_and_b32 v149, s49, v149
v_bfe_u32 v148, v149, 2, 14
v_lshrrev_b32_e64 v149, 18, v149
ds_read_u16 v148, v148
ds_read_u16 v149, v149
v_exp_f16_sdwa v157, v157 dst_sel:WORD_0 dst_unused:UNUSED_PRESERVE src0_sel:WORD_0
v_fma_mix_f32 v225, v134, v134, v225 op_sel_hi:[1,1,0]
v_mfma_f32_32x32x16_bf16 v[96:111], v[4:7], v[188:191], v[96:111]
v_fma_mix_f32 v225, v135, v135, v225 op_sel_hi:[1,1,0]
v_exp_f16_sdwa v159, v159 dst_sel:WORD_0 dst_unused:UNUSED_PRESERVE src0_sel:WORD_0
v_cvt_pkrtz_f16_f32 v151, v150, v151
v_and_b32_e64 v151, s49, v151
v_bfe_u32 v150, v151, 2, 14
v_lshrrev_b32_e64 v151, 18, v151
ds_read_u16 v150, v150
ds_read_u16 v151, v151
v_exp_f16_sdwa v157, v157 dst_sel:WORD_1 dst_unused:UNUSED_PRESERVE src0_sel:WORD_1
v_fma_mix_f32 v225, v136, v136, v225 op_sel_hi:[1,1,0]
v_cvt_pkrtz_f16_f32 v153, v152, v153
v_fma_mix_f32 v225, v137, v137, v225 op_sel_hi:[1,1,0]
v_and_b32_e64 v153, s49, v153
v_bfe_u32 v152, v153, 2, 14
v_lshrrev_b32_e64 v153, 18, v153
ds_read_u16 v152, v152
ds_read_u16 v153, v153
v_exp_f16_sdwa v159, v159 dst_sel:WORD_1 dst_unused:UNUSED_PRESERVE src0_sel:WORD_1
v_mfma_f32_32x32x16_bf16 v[112:127], v[28:31], v[188:191], v[112:127]
ds_read_b128 v[184:187], v250 offset:22528
v_cvt_pkrtz_f16_f32 v155, v154, v155
v_and_b32_e64 v155, s49, v155
v_bfe_u32 v154, v155, 2, 14
v_lshrrev_b32_e64 v155, 18, v155
ds_read_u16 v154, v154
ds_read_u16 v155, v155
v_pk_add_f16 v157, v157, 1.0 op_sel_hi:[1,0]
v_pk_add_f16 v159, v159, 1.0 op_sel_hi:[1,0]
v_rcp_f16_sdwa v157, v157 dst_sel:WORD_0 dst_unused:UNUSED_PRESERVE src0_sel:WORD_0
v_mfma_f32_32x32x16_bf16 v[96:111], v[8:11], v[176:179], v[96:111]
v_rcp_f16_sdwa v159, v159 dst_sel:WORD_0 dst_unused:UNUSED_PRESERVE src0_sel:WORD_0
v_rcp_f16_sdwa v157, v157 dst_sel:WORD_1 dst_unused:UNUSED_PRESERVE src0_sel:WORD_1
s_add_u32 s46, s80, 8388608
buffer_store_dwordx4 v[16:19], v250, s[32:35], s46 offen
v_rcp_f16_sdwa v159, v159 dst_sel:WORD_1 dst_unused:UNUSED_PRESERVE src0_sel:WORD_1
v_mfma_f32_32x32x16_bf16 v[112:127], v[32:35], v[176:179], v[112:127]
ds_read_b128 v[188:191], v250 offset:23552
v_mov_b32 v223, 0
s_branch Law3
Lax3:
s_sleep 2
Law3:
ds_read_b32 v223, v247 offset:12
s_sub_u32 s76, s76, 1
s_cselect_b32 s44, 4, 0
s_cselect_b32 s76, 0, s76
s_waitcnt lgkmcnt(0)
v_readfirstlane_b32 s43, v223
s_nop 1
s_max_u32 s43, s43, s44
s_cmp_lt_u32 s43, 4
s_cbranch_scc1 Lax3
v_pk_mul_f16 v156, v156, v157
v_pk_mul_f16 v158, v158, v159
v_fma_mix_f32 v226, v156, v156, v226 op_sel_hi:[1,1,0]
v_mfma_f32_32x32x16_bf16 v[96:111], v[12:15], v[180:183], v[96:111]
v_fma_mix_f32 v226, v158, v158, v226 op_sel_hi:[1,1,0]
s_setprio 3
v_cvt_pkrtz_f16_f32 v161, v160, v161
v_fma_mix_f32 v226, v156, v156, v226 op_sel:[1,1,0] op_sel_hi:[1,1,0]
v_and_b32 v161, s49, v161
v_fma_mix_f32 v226, v158, v158, v226 op_sel:[1,1,0] op_sel_hi:[1,1,0]
v_bfe_u32 v160, v161, 2, 14
v_fma_mix_f32 v226, v144, v144, v226 op_sel_hi:[1,1,0]
v_lshrrev_b32_e64 v161, 18, v161
v_fma_mix_f32 v226, v145, v145, v226 op_sel_hi:[1,1,0]
ds_read_u16 v160, v160
v_fma_mix_f32 v226, v146, v146, v226 op_sel_hi:[1,1,0]
ds_read_u16 v161, v161
v_fma_mix_f32 v226, v147, v147, v226 op_sel_hi:[1,1,0]
v_cvt_pk_f16_f32 v170, v170, v171
v_cvt_pk_f16_f32 v172, v172, v173
v_cvt_pk_f16_f32 v174, v174, v175
v_pk_fma_f16 v171, v170, v170, s48
v_mfma_f32_32x32x16_bf16 v[112:127], v[36:39], v[180:183], v[112:127]
v_fma_mix_f32 v226, v148, v148, v226 op_sel_hi:[1,1,0]
v_pk_fma_f16 v173, v172, v172, s48
v_fma_mix_f32 v226, v149, v149, v226 op_sel_hi:[1,1,0]
ds_read_b128 v[176:179], v250 offset:24576
v_cvt_pkrtz_f16_f32 v163, v162, v163
v_and_b32_e64 v163, s49, v163
v_bfe_u32 v162, v163, 2, 14
v_lshrrev_b32_e64 v163, 18, v163
ds_read_u16 v162, v162
ds_read_u16 v163, v163
v_pk_fma_f16 v175, v174, v174, s48
v_pk_mul_f16 v171, v170, v171
v_pk_mul_f16 v173, v172, v173
v_fma_mix_f32 v226, v150, v150, v226 op_sel_hi:[1,1,0]
v_pk_mul_f16 v175, v174, v175
v_fma_mix_f32 v226, v151, v151, v226 op_sel_hi:[1,1,0]
v_exp_f16_sdwa v171, v171 dst_sel:WORD_0 dst_unused:UNUSED_PRESERVE src0_sel:WORD_0
v_cvt_pkrtz_f16_f32 v165, v164, v165
v_and_b32_e64 v165, s49, v165
v_bfe_u32 v164, v165, 2, 14
v_lshrrev_b32_e64 v165, 18, v165
ds_read_u16 v164, v164
ds_read_u16 v165, v165
v_mfma_f32_32x32x16_bf16 v[96:111], v[16:19], v[184:187], v[96:111]
v_exp_f16_sdwa v173, v173 dst_sel:WORD_0 dst_unused:UNUSED_PRESERVE src0_sel:WORD_0
v_fma_mix_f32 v226, v152, v152, v226 op_sel_hi:[1,1,0]
v_exp_f16_sdwa v175, v175 dst_sel:WORD_0 dst_unused:UNUSED_PRESERVE src0_sel:WORD_0
v_fma_mix_f32 v226, v153, v153, v226 op_sel_hi:[1,1,0]
v_cvt_pkrtz_f16_f32 v167, v166, v167
v_and_b32_e64 v167, s49, v167
v_bfe_u32 v166, v167, 2, 14
v_lshrrev_b32_e64 v167, 18, v167
ds_read_u16 v166, v166
ds_read_u16 v167, v167
v_exp_f16_sdwa v171, v171 dst_sel:WORD_1 dst_unused:UNUSED_PRESERVE src0_sel:WORD_1
v_fma_mix_f32 v226, v154, v154, v226 op_sel_hi:[1,1,0]
v_exp_f16_sdwa v173, v173 dst_sel:WORD_1 dst_unused:UNUSED_PRESERVE src0_sel:WORD_1
v_fma_mix_f32 v226, v155, v155, v226 op_sel_hi:[1,1,0]
s_add_u32 s46, s80, 10485760
buffer_store_dwordx4 v[20:23], v250, s[32:35], s46 offen
v_mfma_f32_32x32x16_bf16 v[112:127], v[40:43], v[184:187], v[112:127]
v_exp_f16_sdwa v175, v175 dst_sel:WORD_1 dst_unused:UNUSED_PRESERVE src0_sel:WORD_1
ds_read_b128 v[180:183], v250 offset:25600
v_cvt_pkrtz_f16_f32 v169, v168, v169
v_and_b32_e64 v169, s49, v169
v_bfe_u32 v168, v169, 2, 14
v_lshrrev_b32_e64 v169, 18, v169
ds_read_u16 v168, v168
ds_read_u16 v169, v169
v_pk_add_f16 v171, v171, 1.0 op_sel_hi:[1,0]
v_pk_add_f16 v173, v173, 1.0 op_sel_hi:[1,0]
v_pk_add_f16 v175, v175, 1.0 op_sel_hi:[1,0]
v_rcp_f16_sdwa v171, v171 dst_sel:WORD_0 dst_unused:UNUSED_PRESERVE src0_sel:WORD_0
v_mfma_f32_32x32x16_bf16 v[96:111], v[20:23], v[188:191], v[96:111]
v_rcp_f16_sdwa v173, v173 dst_sel:WORD_0 dst_unused:UNUSED_PRESERVE src0_sel:WORD_0
v_rcp_f16_sdwa v175, v175 dst_sel:WORD_0 dst_unused:UNUSED_PRESERVE src0_sel:WORD_0
v_rcp_f16_sdwa v171, v171 dst_sel:WORD_1 dst_unused:UNUSED_PRESERVE src0_sel:WORD_1
v_rcp_f16_sdwa v173, v173 dst_sel:WORD_1 dst_unused:UNUSED_PRESERVE src0_sel:WORD_1
v_mfma_f32_32x32x16_bf16 v[112:127], v[44:47], v[188:191], v[112:127]
v_rcp_f16_sdwa v175, v175 dst_sel:WORD_1 dst_unused:UNUSED_PRESERVE src0_sel:WORD_1
ds_read_b128 v[184:187], v250 offset:26624
v_pk_mul_f16 v170, v170, v171
v_pk_mul_f16 v172, v172, v173
v_pk_mul_f16 v174, v174, v175
v_fma_mix_f32 v226, v170, v170, v226 op_sel_hi:[1,1,0]
s_waitcnt lgkmcnt(3)
v_mfma_f32_32x32x16_bf16 v[128:143], v[0:3], v[176:179], 0
v_fma_mix_f32 v226, v172, v172, v226 op_sel_hi:[1,1,0]
v_cvt_pkrtz_f16_f32 v97, v96, v97
v_fma_mix_f32 v226, v174, v174, v226 op_sel_hi:[1,1,0]
v_and_b32 v97, s49, v97
v_fma_mix_f32 v226, v170, v170, v226 op_sel:[1,1,0] op_sel_hi:[1,1,0]
v_bfe_u32 v96, v97, 2, 14
v_fma_mix_f32 v226, v172, v172, v226 op_sel:[1,1,0] op_sel_hi:[1,1,0]
v_lshrrev_b32_e64 v97, 18, v97
v_fma_mix_f32 v226, v174, v174, v226 op_sel:[1,1,0] op_sel_hi:[1,1,0]
ds_read_u16 v96, v96
v_fma_mix_f32 v226, v160, v160, v226 op_sel_hi:[1,1,0]
ds_read_u16 v97, v97
v_fma_mix_f32 v226, v161, v161, v226 op_sel_hi:[1,1,0]
v_cvt_pk_f16_f32 v108, v108, v109
v_fma_mix_f32 v226, v162, v162, v226 op_sel_hi:[1,1,0]
v_cvt_pk_f16_f32 v110, v110, v111
v_fma_mix_f32 v226, v163, v163, v226 op_sel_hi:[1,1,0]
v_pk_fma_f16 v109, v108, v108, s48
v_mfma_f32_32x32x16_bf16 v[144:159], v[24:27], v[176:179], 0
v_cvt_pkrtz_f16_f32 v99, v98, v99
v_and_b32_e64 v99, s49, v99
v_bfe_u32 v98, v99, 2, 14
v_lshrrev_b32_e64 v99, 18, v99
ds_read_u16 v98, v98
ds_read_u16 v99, v99
v_pk_fma_f16 v111, v110, v110, s48
ds_read_b128 v[188:191], v250 offset:27648
v_fma_mix_f32 v226, v164, v164, v226 op_sel_hi:[1,1,0]
v_pk_mul_f16 v109, v108, v109
v_fma_mix_f32 v226, v165, v165, v226 op_sel_hi:[1,1,0]
v_pk_mul_f16 v111, v110, v111
v_cvt_pkrtz_f16_f32 v101, v100, v101
v_and_b32_e64 v101, s49, v101
v_bfe_u32 v100, v101, 2, 14
v_lshrrev_b32_e64 v101, 18, v101
ds_read_u16 v100, v100
ds_read_u16 v101, v101
v_exp_f16_sdwa v109, v109 dst_sel:WORD_0 dst_unused:UNUSED_PRESERVE src0_sel:WORD_0
v_fma_mix_f32 v226, v166, v166, v226 op_sel_hi:[1,1,0]
v_mfma_f32_32x32x16_bf16 v[128:143], v[4:7], v[180:183], v[128:143]
v_fma_mix_f32 v226, v167, v167, v226 op_sel_hi:[1,1,0]
v_exp_f16_sdwa v111, v111 dst_sel:WORD_0 dst_unused:UNUSED_PRESERVE src0_sel:WORD_0
v_cvt_pkrtz_f16_f32 v103, v102, v103
v_and_b32_e64 v103, s49, v103
v_bfe_u32 v102, v103, 2, 14
v_lshrrev_b32 v103, 18, v103
ds_read_u16 v102, v102
ds_read_u16 v103, v103
v_exp_f16_sdwa v109, v109 dst_sel:WORD_1 dst_unused:UNUSED_PRESERVE src0_sel:WORD_1
s_waitcnt lgkmcnt(7)
v_fma_mix_f32 v226, v168, v168, v226 op_sel_hi:[1,1,0]
v_cvt_pkrtz_f16_f32 v105, v104, v105
v_fma_mix_f32 v226, v169, v169, v226 op_sel_hi:[1,1,0]
v_and_b32_e64 v105, s49, v105
v_bfe_u32 v104, v105, 2, 14
v_lshrrev_b32_e64 v105, 18, v105
ds_read_u16 v104, v104
ds_read_u16 v105, v105
v_exp_f16_sdwa v111, v111 dst_sel:WORD_1 dst_unused:UNUSED_PRESERVE src0_sel:WORD_1
v_mfma_f32_32x32x16_bf16 v[144:159], v[28:31], v[180:183], v[144:159]
ds_read_b128 v[176:179], v250 offset:28672
v_cvt_pkrtz_f16_f32 v107, v106, v107
v_and_b32_e64 v107, s49, v107
v_bfe_u32 v106, v107, 2, 14
v_lshrrev_b32_e64 v107, 18, v107
ds_read_u16 v106, v106
ds_read_u16 v107, v107
v_pk_add_f16 v109, v109, 1.0 op_sel_hi:[1,0]
v_pk_add_f16 v111, v111, 1.0 op_sel_hi:[1,0]
v_rcp_f16_sdwa v109, v109 dst_sel:WORD_0 dst_unused:UNUSED_PRESERVE src0_sel:WORD_0
v_mfma_f32_32x32x16_bf16 v[128:143], v[8:11], v[184:187], v[128:143]
v_rcp_f16_sdwa v111, v111 dst_sel:WORD_0 dst_unused:UNUSED_PRESERVE src0_sel:WORD_0
v_rcp_f16_sdwa v109, v109 dst_sel:WORD_1 dst_unused:UNUSED_PRESERVE src0_sel:WORD_1
v_rcp_f16_sdwa v111, v111 dst_sel:WORD_1 dst_unused:UNUSED_PRESERVE src0_sel:WORD_1
v_mfma_f32_32x32x16_bf16 v[144:159], v[32:35], v[184:187], v[144:159]
ds_read_b128 v[180:183], v250 offset:29696
v_pk_mul_f16 v108, v108, v109
v_pk_mul_f16 v110, v110, v111
v_fma_mix_f32 v227, v108, v108, v227 op_sel_hi:[1,1,0]
v_cvt_pkrtz_f16_f32 v113, v112, v113
v_fma_mix_f32 v227, v110, v110, v227 op_sel_hi:[1,1,0]
s_waitcnt lgkmcnt(7)
v_mfma_f32_32x32x16_bf16 v[128:143], v[12:15], v[188:191], v[128:143]
v_fma_mix_f32 v227, v108, v108, v227 op_sel:[1,1,0] op_sel_hi:[1,1,0]
v_and_b32 v113, s49, v113
v_fma_mix_f32 v227, v110, v110, v227 op_sel:[1,1,0] op_sel_hi:[1,1,0]
v_bfe_u32 v112, v113, 2, 14
v_fma_mix_f32 v227, v96, v96, v227 op_sel_hi:[1,1,0]
v_lshrrev_b32_e64 v113, 18, v113
v_fma_mix_f32 v227, v97, v97, v227 op_sel_hi:[1,1,0]
ds_read_u16 v112, v112
v_fma_mix_f32 v227, v98, v98, v227 op_sel_hi:[1,1,0]
ds_read_u16 v113, v113
v_fma_mix_f32 v227, v99, v99, v227 op_sel_hi:[1,1,0]
v_cvt_pk_f16_f32 v122, v122, v123
v_cvt_pk_f16_f32 v124, v124, v125
v_cvt_pk_f16_f32 v126, v126, v127
v_pk_fma_f16 v123, v122, v122, s48
v_mfma_f32_32x32x16_bf16 v[144:159], v[36:39], v[188:191], v[144:159]
v_fma_mix_f32 v227, v100, v100, v227 op_sel_hi:[1,1,0]
v_pk_fma_f16 v125, v124, v124, s48
v_fma_mix_f32 v227, v101, v101, v227 op_sel_hi:[1,1,0]
ds_read_b128 v[184:187], v250 offset:30720
v_cvt_pkrtz_f16_f32 v115, v114, v115
v_and_b32_e64 v115, s49, v115
v_bfe_u32 v114, v115, 2, 14
v_lshrrev_b32_e64 v115, 18, v115
ds_read_u16 v114, v114
ds_read_u16 v115, v115
v_pk_fma_f16 v127, v126, v126, s48
v_pk_mul_f16 v123, v122, v123
v_pk_mul_f16 v125, v124, v125
v_fma_mix_f32 v227, v102, v102, v227 op_sel_hi:[1,1,0]
v_pk_mul_f16 v127, v126, v127
s_waitcnt lgkmcnt(7)
v_fma_mix_f32 v227, v103, v103, v227 op_sel_hi:[1,1,0]
v_exp_f16_sdwa v123, v123 dst_sel:WORD_0 dst_unused:UNUSED_PRESERVE src0_sel:WORD_0
v_cvt_pkrtz_f16_f32 v117, v116, v117
v_and_b32 v117, s49, v117
v_bfe_u32 v116, v117, 2, 14
v_lshrrev_b32_e64 v117, 18, v117
ds_read_u16 v116, v116
ds_read_u16 v117, v117
v_mfma_f32_32x32x16_bf16 v[128:143], v[16:19], v[176:179], v[128:143]
v_exp_f16_sdwa v125, v125 dst_sel:WORD_0 dst_unused:UNUSED_PRESERVE src0_sel:WORD_0
v_fma_mix_f32 v227, v104, v104, v227 op_sel_hi:[1,1,0]
v_exp_f16_sdwa v127, v127 dst_sel:WORD_0 dst_unused:UNUSED_PRESERVE src0_sel:WORD_0
v_fma_mix_f32 v227, v105, v105, v227 op_sel_hi:[1,1,0]
v_cvt_pkrtz_f16_f32 v119, v118, v119
v_and_b32_e64 v119, s49, v119
v_bfe_u32 v118, v119, 2, 14
v_lshrrev_b32 v119, 18, v119
ds_read_u16 v118, v118
ds_read_u16 v119, v119
v_exp_f16_sdwa v123, v123 dst_sel:WORD_1 dst_unused:UNUSED_PRESERVE src0_sel:WORD_1
v_fma_mix_f32 v227, v106, v106, v227 op_sel_hi:[1,1,0]
v_exp_f16_sdwa v125, v125 dst_sel:WORD_1 dst_unused:UNUSED_PRESERVE src0_sel:WORD_1
s_waitcnt lgkmcnt(6)
v_fma_mix_f32 v227, v107, v107, v227 op_sel_hi:[1,1,0]
v_mfma_f32_32x32x16_bf16 v[144:159], v[40:43], v[176:179], v[144:159]
v_exp_f16_sdwa v127, v127 dst_sel:WORD_1 dst_unused:UNUSED_PRESERVE src0_sel:WORD_1
ds_read_b128 v[188:191], v250 offset:31744
v_cvt_pkrtz_f16_f32 v121, v120, v121
v_and_b32_e64 v121, s49, v121
v_bfe_u32 v120, v121, 2, 14
v_lshrrev_b32_e64 v121, 18, v121
ds_read_u16 v120, v120
ds_read_u16 v121, v121
v_pk_add_f16 v123, v123, 1.0 op_sel_hi:[1,0]
v_pk_add_f16 v125, v125, 1.0 op_sel_hi:[1,0]
v_pk_add_f16 v127, v127, 1.0 op_sel_hi:[1,0]
v_rcp_f16_sdwa v123, v123 dst_sel:WORD_0 dst_unused:UNUSED_PRESERVE src0_sel:WORD_0
v_mfma_f32_32x32x16_bf16 v[128:143], v[20:23], v[180:183], v[128:143]
v_rcp_f16_sdwa v125, v125 dst_sel:WORD_0 dst_unused:UNUSED_PRESERVE src0_sel:WORD_0
v_rcp_f16_sdwa v127, v127 dst_sel:WORD_0 dst_unused:UNUSED_PRESERVE src0_sel:WORD_0
v_rcp_f16_sdwa v123, v123 dst_sel:WORD_1 dst_unused:UNUSED_PRESERVE src0_sel:WORD_1
v_rcp_f16_sdwa v125, v125 dst_sel:WORD_1 dst_unused:UNUSED_PRESERVE src0_sel:WORD_1
v_mfma_f32_32x32x16_bf16 v[144:159], v[44:47], v[180:183], v[144:159]
v_rcp_f16_sdwa v127, v127 dst_sel:WORD_1 dst_unused:UNUSED_PRESERVE src0_sel:WORD_1
ds_read_b128 v[176:179], v250 offset:32768
v_pk_mul_f16 v122, v122, v123
v_pk_mul_f16 v124, v124, v125
v_pk_mul_f16 v126, v126, v127
v_fma_mix_f32 v227, v122, v122, v227 op_sel_hi:[1,1,0]
v_mfma_f32_32x32x16_bf16 v[160:175], v[0:3], v[184:187], 0
v_fma_mix_f32 v227, v124, v124, v227 op_sel_hi:[1,1,0]
s_cmp_lg_u32 s40, 7
s_cbranch_scc1 Lnoinit
s_waitcnt vmcnt(0)
v_mov_b32 v222, 1
v_mov_b32_e64 v223, 0
s_nop 7
s_mov_b64 exec, 1
buffer_atomic_add v222, v223, s[36:39], 0 offen
s_mov_b64 exec, -1
s_nop 1
Lnoinit:
v_cvt_pkrtz_f16_f32 v129, v128, v129
v_fma_mix_f32 v227, v126, v126, v227 op_sel_hi:[1,1,0]
v_and_b32_e64 v129, s49, v129
v_fma_mix_f32 v227, v122, v122, v227 op_sel:[1,1,0] op_sel_hi:[1,1,0]
v_bfe_u32 v128, v129, 2, 14
v_fma_mix_f32 v227, v124, v124, v227 op_sel:[1,1,0] op_sel_hi:[1,1,0]
v_lshrrev_b32 v129, 18, v129
v_fma_mix_f32 v227, v126, v126, v227 op_sel:[1,1,0] op_sel_hi:[1,1,0]
ds_read_u16 v128, v128
v_fma_mix_f32 v227, v112, v112, v227 op_sel_hi:[1,1,0]
ds_read_u16 v129, v129
v_fma_mix_f32 v227, v113, v113, v227 op_sel_hi:[1,1,0]
v_cvt_pk_f16_f32 v140, v140, v141
s_waitcnt lgkmcnt(4)
v_fma_mix_f32 v227, v114, v114, v227 op_sel_hi:[1,1,0]
v_cvt_pk_f16_f32 v142, v142, v143
v_fma_mix_f32 v227, v115, v115, v227 op_sel_hi:[1,1,0]
v_pk_fma_f16 v141, v140, v140, s48
v_mfma_f32_32x32x16_bf16 v[96:111], v[24:27], v[184:187], 0
v_cvt_pkrtz_f16_f32 v131, v130, v131
v_and_b32_e64 v131, s49, v131
v_bfe_u32 v130, v131, 2, 14
v_lshrrev_b32_e64 v131, 18, v131
ds_read_u16 v130, v130
ds_read_u16 v131, v131
v_pk_fma_f16 v143, v142, v142, s48
ds_read_b128 v[180:183], v250 offset:33792
v_fma_mix_f32 v227, v116, v116, v227 op_sel_hi:[1,1,0]
v_pk_mul_f16 v141, v140, v141
v_fma_mix_f32 v227, v117, v117, v227 op_sel_hi:[1,1,0]
v_pk_mul_f16 v143, v142, v143
v_cvt_pkrtz_f16_f32 v133, v132, v133
v_and_b32_e64 v133, s49, v133
v_bfe_u32 v132, v133, 2, 14
v_lshrrev_b32_e64 v133, 18, v133
ds_read_u16 v132, v132
ds_read_u16 v133, v133
v_exp_f16_sdwa v141, v141 dst_sel:WORD_0 dst_unused:UNUSED_PRESERVE src0_sel:WORD_0
v_fma_mix_f32 v227, v118, v118, v227 op_sel_hi:[1,1,0]
v_mfma_f32_32x32x16_bf16 v[160:175], v[4:7], v[188:191], v[160:175]
v_fma_mix_f32 v227, v119, v119, v227 op_sel_hi:[1,1,0]
v_exp_f16_sdwa v143, v143 dst_sel:WORD_0 dst_unused:UNUSED_PRESERVE src0_sel:WORD_0
v_cvt_pkrtz_f16_f32 v135, v134, v135
v_and_b32_e64 v135, s49, v135
v_bfe_u32 v134, v135, 2, 14
v_lshrrev_b32_e64 v135, 18, v135
ds_read_u16 v134, v134
ds_read_u16 v135, v135
v_exp_f16_sdwa v141, v141 dst_sel:WORD_1 dst_unused:UNUSED_PRESERVE src0_sel:WORD_1
v_fma_mix_f32 v227, v120, v120, v227 op_sel_hi:[1,1,0]
v_cvt_pkrtz_f16_f32 v137, v136, v137
s_waitcnt lgkmcnt(6)
v_fma_mix_f32 v227, v121, v121, v227 op_sel_hi:[1,1,0]
v_and_b32 v137, s49, v137
v_bfe_u32 v136, v137, 2, 14
v_lshrrev_b32_e64 v137, 18, v137
ds_read_u16 v136, v136
ds_read_u16 v137, v137
v_exp_f16_sdwa v143, v143 dst_sel:WORD_1 dst_unused:UNUSED_PRESERVE src0_sel:WORD_1
v_mfma_f32_32x32x16_bf16 v[96:111], v[28:31], v[188:191], v[96:111]
ds_read_b128 v[184:187], v250 offset:34816
v_cvt_pkrtz_f16_f32 v139, v138, v139
v_and_b32_e64 v139, s49, v139
v_bfe_u32 v138, v139, 2, 14
v_lshrrev_b32_e64 v139, 18, v139
ds_read_u16 v138, v138
ds_read_u16 v139, v139
v_pk_add_f16 v141, v141, 1.0 op_sel_hi:[1,0]
v_pk_add_f16 v143, v143, 1.0 op_sel_hi:[1,0]
v_rcp_f16_sdwa v141, v141 dst_sel:WORD_0 dst_unused:UNUSED_PRESERVE src0_sel:WORD_0
v_mfma_f32_32x32x16_bf16 v[160:175], v[8:11], v[176:179], v[160:175]
v_rcp_f16_sdwa v143, v143 dst_sel:WORD_0 dst_unused:UNUSED_PRESERVE src0_sel:WORD_0
v_rcp_f16_sdwa v141, v141 dst_sel:WORD_1 dst_unused:UNUSED_PRESERVE src0_sel:WORD_1
v_rcp_f16_sdwa v143, v143 dst_sel:WORD_1 dst_unused:UNUSED_PRESERVE src0_sel:WORD_1
v_mfma_f32_32x32x16_bf16 v[96:111], v[32:35], v[176:179], v[96:111]
ds_read_b128 v[188:191], v250 offset:35840
v_pk_mul_f16 v140, v140, v141
v_pk_mul_f16 v142, v142, v143
v_fma_mix_f32 v228, v140, v140, v228 op_sel_hi:[1,1,0]
s_add_u32 s66, s66, 786432
s_sub_u32 s81, s81, 13184
v_bfe_u32 v223, v250, 4, 6
v_and_b32 v222, 15, v223
v_lshlrev_b32 v222, 7, v222
v_lshrrev_b32_e64 v223, 4, v223
v_mul_u32_u24 v223, 98304, v223
s_sub_u32 s43, s67, -8000
s_mul_i32 s44, s41, 192
s_add_u32 s43, s43, s44
v_add3_u32 v222, v222, v223, s43
s_mov_b32 m0, 163840
s_add_u32 s44, s66, 393216
buffer_load_dword v222, s[4:7], s66 offen lds
buffer_load_dword v222, s[4:7], s44 offen lds
v_fma_mix_f32 v228, v142, v142, v228 op_sel_hi:[1,1,0]
s_waitcnt lgkmcnt(6)
v_mfma_f32_32x32x16_bf16 v[160:175], v[12:15], v[180:183], v[160:175]
v_fma_mix_f32 v228, v140, v140, v228 op_sel:[1,1,0] op_sel_hi:[1,1,0]
v_cvt_pkrtz_f16_f32 v145, v144, v145
v_fma_mix_f32 v228, v142, v142, v228 op_sel:[1,1,0] op_sel_hi:[1,1,0]
v_and_b32_e64 v145, s49, v145
v_fma_mix_f32 v228, v128, v128, v228 op_sel_hi:[1,1,0]
v_bfe_u32 v144, v145, 2, 14
v_fma_mix_f32 v228, v129, v129, v228 op_sel_hi:[1,1,0]
v_lshrrev_b32_e64 v145, 18, v145
v_fma_mix_f32 v228, v130, v130, v228 op_sel_hi:[1,1,0]
ds_read_u16 v144, v144
v_fma_mix_f32 v228, v131, v131, v228 op_sel_hi:[1,1,0]
ds_read_u16 v145, v145
v_cvt_pk_f16_f32 v154, v154, v155
v_cvt_pk_f16_f32 v156, v156, v157
v_cvt_pk_f16_f32 v158, v158, v159
v_pk_fma_f16 v155, v154, v154, s48
v_mfma_f32_32x32x16_bf16 v[96:111], v[36:39], v[180:183], v[96:111]
v_fma_mix_f32 v228, v132, v132, v228 op_sel_hi:[1,1,0]
v_pk_fma_f16 v157, v156, v156, s48
v_fma_mix_f32 v228, v133, v133, v228 op_sel_hi:[1,1,0]
ds_read_b128 v[176:179], v250 offset:36864
v_cvt_pkrtz_f16_f32 v147, v146, v147
v_and_b32_e64 v147, s49, v147
v_bfe_u32 v146, v147, 2, 14
v_lshrrev_b32_e64 v147, 18, v147
ds_read_u16 v146, v146
ds_read_u16 v147, v147
v_pk_fma_f16 v159, v158, v158, s48
v_pk_mul_f16 v155, v154, v155
v_pk_mul_f16 v157, v156, v157
v_fma_mix_f32 v228, v134, v134, v228 op_sel_hi:[1,1,0]
v_pk_mul_f16 v159, v158, v159
v_fma_mix_f32 v228, v135, v135, v228 op_sel_hi:[1,1,0]
v_exp_f16_sdwa v155, v155 dst_sel:WORD_0 dst_unused:UNUSED_PRESERVE src0_sel:WORD_0
v_cvt_pkrtz_f16_f32 v149, v148, v149
v_and_b32_e64 v149, s49, v149
v_bfe_u32 v148, v149, 2, 14
v_lshrrev_b32 v149, 18, v149
ds_read_u16 v148, v148
ds_read_u16 v149, v149
s_waitcnt lgkmcnt(6)
v_mfma_f32_32x32x16_bf16 v[160:175], v[16:19], v[184:187], v[160:175]
v_exp_f16_sdwa v157, v157 dst_sel:WORD_0 dst_unused:UNUSED_PRESERVE src0_sel:WORD_0
v_fma_mix_f32 v228, v136, v136, v228 op_sel_hi:[1,1,0]
v_exp_f16_sdwa v159, v159 dst_sel:WORD_0 dst_unused:UNUSED_PRESERVE src0_sel:WORD_0
v_fma_mix_f32 v228, v137, v137, v228 op_sel_hi:[1,1,0]
v_cvt_pkrtz_f16_f32 v151, v150, v151
v_and_b32_e64 v151, s49, v151
v_bfe_u32 v150, v151, 2, 14
v_lshrrev_b32_e64 v151, 18, v151
ds_read_u16 v150, v150
ds_read_u16 v151, v151
v_exp_f16_sdwa v155, v155 dst_sel:WORD_1 dst_unused:UNUSED_PRESERVE src0_sel:WORD_1
v_fma_mix_f32 v228, v138, v138, v228 op_sel_hi:[1,1,0]
v_exp_f16_sdwa v157, v157 dst_sel:WORD_1 dst_unused:UNUSED_PRESERVE src0_sel:WORD_1
v_fma_mix_f32 v228, v139, v139, v228 op_sel_hi:[1,1,0]
v_mfma_f32_32x32x16_bf16 v[96:111], v[40:43], v[184:187], v[96:111]
v_exp_f16_sdwa v159, v159 dst_sel:WORD_1 dst_unused:UNUSED_PRESERVE src0_sel:WORD_1
ds_read_b128 v[180:183], v250 offset:37888
v_cvt_pkrtz_f16_f32 v153, v152, v153
v_and_b32_e64 v153, s49, v153
v_bfe_u32 v152, v153, 2, 14
v_lshrrev_b32_e64 v153, 18, v153
ds_read_u16 v152, v152
ds_read_u16 v153, v153
v_pk_add_f16 v155, v155, 1.0 op_sel_hi:[1,0]
v_pk_add_f16 v157, v157, 1.0 op_sel_hi:[1,0]
v_pk_add_f16 v159, v159, 1.0 op_sel_hi:[1,0]
v_rcp_f16_sdwa v155, v155 dst_sel:WORD_0 dst_unused:UNUSED_PRESERVE src0_sel:WORD_0
v_mfma_f32_32x32x16_bf16 v[160:175], v[20:23], v[188:191], v[160:175]
v_rcp_f16_sdwa v157, v157 dst_sel:WORD_0 dst_unused:UNUSED_PRESERVE src0_sel:WORD_0
v_rcp_f16_sdwa v159, v159 dst_sel:WORD_0 dst_unused:UNUSED_PRESERVE src0_sel:WORD_0
v_rcp_f16_sdwa v155, v155 dst_sel:WORD_1 dst_unused:UNUSED_PRESERVE src0_sel:WORD_1
v_rcp_f16_sdwa v157, v157 dst_sel:WORD_1 dst_unused:UNUSED_PRESERVE src0_sel:WORD_1
v_mfma_f32_32x32x16_bf16 v[96:111], v[44:47], v[188:191], v[96:111]
v_rcp_f16_sdwa v159, v159 dst_sel:WORD_1 dst_unused:UNUSED_PRESERVE src0_sel:WORD_1
ds_read_b128 v[184:187], v250 offset:38912
v_pk_mul_f16 v154, v154, v155
v_pk_mul_f16 v156, v156, v157
v_pk_mul_f16 v158, v158, v159
v_fma_mix_f32 v228, v154, v154, v228 op_sel_hi:[1,1,0]
s_waitcnt lgkmcnt(4)
v_mfma_f32_32x32x16_bf16 v[112:127], v[0:3], v[176:179], 0
v_fma_mix_f32 v228, v156, v156, v228 op_sel_hi:[1,1,0]
s_getpc_b64 s[74:75]
Lcq2:
s_lshl_b32 s43, s40, 10
s_add_u32 s43, s43, 6144
s_min_u32 s43, s43, Lend-Lcq2-1024
s_add_u32 s74, s74, s43
s_addc_u32 s75, s75, 0
s_sub_u32 s74, s74, 16384
s_subb_u32 s75, s75, 0
s_mov_b32 m0, 163840
s_nop 0
global_load_lds_dword v250, s[74:75]
v_cvt_pkrtz_f16_f32 v161, v160, v161
v_fma_mix_f32 v228, v158, v158, v228 op_sel_hi:[1,1,0]
v_and_b32 v161, s49, v161
v_fma_mix_f32 v228, v154, v154, v228 op_sel:[1,1,0] op_sel_hi:[1,1,0]
v_bfe_u32 v160, v161, 2, 14
v_fma_mix_f32 v228, v156, v156, v228 op_sel:[1,1,0] op_sel_hi:[1,1,0]
v_lshrrev_b32_e64 v161, 18, v161
v_fma_mix_f32 v228, v158, v158, v228 op_sel:[1,1,0] op_sel_hi:[1,1,0]
ds_read_u16 v160, v160
v_fma_mix_f32 v228, v144, v144, v228 op_sel_hi:[1,1,0]
ds_read_u16 v161, v161
v_fma_mix_f32 v228, v145, v145, v228 op_sel_hi:[1,1,0]
v_cvt_pk_f16_f32 v172, v172, v173
v_fma_mix_f32 v228, v146, v146, v228 op_sel_hi:[1,1,0]
v_cvt_pk_f16_f32 v174, v174, v175
v_fma_mix_f32 v228, v147, v147, v228 op_sel_hi:[1,1,0]
v_pk_fma_f16 v173, v172, v172, s48
v_mfma_f32_32x32x16_bf16 v[128:143], v[24:27], v[176:179], 0
v_cvt_pkrtz_f16_f32 v163, v162, v163
v_and_b32_e64 v163, s49, v163
v_bfe_u32 v162, v163, 2, 14
v_lshrrev_b32_e64 v163, 18, v163
ds_read_u16 v162, v162
ds_read_u16 v163, v163
ds_read_b128 v[188:191], v250 offset:39936
v_pk_fma_f16 v175, v174, v174, s48
v_fma_mix_f32 v228, v148, v148, v228 op_sel_hi:[1,1,0]
v_pk_mul_f16 v173, v172, v173
v_fma_mix_f32 v228, v149, v149, v228 op_sel_hi:[1,1,0]
v_pk_mul_f16 v175, v174, v175
v_cvt_pkrtz_f16_f32 v165, v164, v165
v_and_b32_e64 v165, s49, v165
v_bfe_u32 v164, v165, 2, 14
v_lshrrev_b32 v165, 18, v165
ds_read_u16 v164, v164
ds_read_u16 v165, v165
v_exp_f16_sdwa v173, v173 dst_sel:WORD_0 dst_unused:UNUSED_PRESERVE src0_sel:WORD_0
v_fma_mix_f32 v228, v150, v150, v228 op_sel_hi:[1,1,0]
s_waitcnt lgkmcnt(6)
v_mfma_f32_32x32x16_bf16 v[112:127], v[4:7], v[180:183], v[112:127]
v_fma_mix_f32 v228, v151, v151, v228 op_sel_hi:[1,1,0]
v_exp_f16_sdwa v175, v175 dst_sel:WORD_0 dst_unused:UNUSED_PRESERVE src0_sel:WORD_0
v_cvt_pkrtz_f16_f32 v167, v166, v167
v_and_b32_e64 v167, s49, v167
v_bfe_u32 v166, v167, 2, 14
v_lshrrev_b32_e64 v167, 18, v167
ds_read_u16 v166, v166
ds_read_u16 v167, v167
v_exp_f16_sdwa v173, v173 dst_sel:WORD_1 dst_unused:UNUSED_PRESERVE src0_sel:WORD_1
v_fma_mix_f32 v228, v152, v152, v228 op_sel_hi:[1,1,0]
v_cvt_pkrtz_f16_f32 v169, v168, v169
v_fma_mix_f32 v228, v153, v153, v228 op_sel_hi:[1,1,0]
v_and_b32_e64 v169, s49, v169
v_bfe_u32 v168, v169, 2, 14
v_lshrrev_b32_e64 v169, 18, v169
ds_read_u16 v168, v168
ds_read_u16 v169, v169
v_exp_f16_sdwa v175, v175 dst_sel:WORD_1 dst_unused:UNUSED_PRESERVE src0_sel:WORD_1
v_mfma_f32_32x32x16_bf16 v[128:143], v[28:31], v[180:183], v[128:143]
ds_read_b128 v[176:179], v250 offset:40960
v_cvt_pkrtz_f16_f32 v171, v170, v171
v_and_b32_e64 v171, s49, v171
v_bfe_u32 v170, v171, 2, 14
v_lshrrev_b32_e64 v171, 18, v171
ds_read_u16 v170, v170
ds_read_u16 v171, v171
v_pk_add_f16 v173, v173, 1.0 op_sel_hi:[1,0]
v_pk_add_f16 v175, v175, 1.0 op_sel_hi:[1,0]
v_rcp_f16_sdwa v173, v173 dst_sel:WORD_0 dst_unused:UNUSED_PRESERVE src0_sel:WORD_0
v_mfma_f32_32x32x16_bf16 v[112:127], v[8:11], v[184:187], v[112:127]
v_rcp_f16_sdwa v175, v175 dst_sel:WORD_0 dst_unused:UNUSED_PRESERVE src0_sel:WORD_0
v_rcp_f16_sdwa v173, v173 dst_sel:WORD_1 dst_unused:UNUSED_PRESERVE src0_sel:WORD_1
v_rcp_f16_sdwa v175, v175 dst_sel:WORD_1 dst_unused:UNUSED_PRESERVE src0_sel:WORD_1
v_mfma_f32_32x32x16_bf16 v[128:143], v[32:35], v[184:187], v[128:143]
ds_read_b128 v[180:183], v250 offset:41984
v_pk_mul_f16 v172, v172, v173
v_pk_mul_f16 v174, v174, v175
v_fma_mix_f32 v229, v172, v172, v229 op_sel_hi:[1,1,0]
v_cvt_pkrtz_f16_f32 v97, v96, v97
s_waitcnt lgkmcnt(7)
v_mfma_f32_32x32x16_bf16 v[112:127], v[12:15], v[188:191], v[112:127]
v_fma_mix_f32 v229, v174, v174, v229 op_sel_hi:[1,1,0]
v_and_b32 v97, s49, v97
v_fma_mix_f32 v229, v172, v172, v229 op_sel:[1,1,0] op_sel_hi:[1,1,0]
v_bfe_u32 v96, v97, 2, 14
v_fma_mix_f32 v229, v174, v174, v229 op_sel:[1,1,0] op_sel_hi:[1,1,0]
v_lshrrev_b32_e64 v97, 18, v97
v_fma_mix_f32 v229, v160, v160, v229 op_sel_hi:[1,1,0]
ds_read_u16 v96, v96
v_fma_mix_f32 v229, v161, v161, v229 op_sel_hi:[1,1,0]
ds_read_u16 v97, v97
v_fma_mix_f32 v229, v162, v162, v229 op_sel_hi:[1,1,0]
v_cvt_pk_f16_f32 v106, v106, v107
v_fma_mix_f32 v229, v163, v163, v229 op_sel_hi:[1,1,0]
v_cvt_pk_f16_f32 v108, v108, v109
v_cvt_pk_f16_f32 v110, v110, v111
v_pk_fma_f16 v107, v106, v106, s48
v_mfma_f32_32x32x16_bf16 v[128:143], v[36:39], v[188:191], v[128:143]
v_fma_mix_f32 v229, v164, v164, v229 op_sel_hi:[1,1,0]
v_pk_fma_f16 v109, v108, v108, s48
v_fma_mix_f32 v229, v165, v165, v229 op_sel_hi:[1,1,0]
ds_read_b128 v[184:187], v250 offset:43008
v_cvt_pkrtz_f16_f32 v99, v98, v99
v_and_b32_e64 v99, s49, v99
v_bfe_u32 v98, v99, 2, 14
v_lshrrev_b32_e64 v99, 18, v99
ds_read_u16 v98, v98
ds_read_u16 v99, v99
v_pk_fma_f16 v111, v110, v110, s48
v_pk_mul_f16 v107, v106, v107
v_pk_mul_f16 v109, v108, v109
v_fma_mix_f32 v229, v166, v166, v229 op_sel_hi:[1,1,0]
v_pk_mul_f16 v111, v110, v111
s_waitcnt lgkmcnt(7)
v_fma_mix_f32 v229, v167, v167, v229 op_sel_hi:[1,1,0]
v_exp_f16_sdwa v107, v107 dst_sel:WORD_0 dst_unused:UNUSED_PRESERVE src0_sel:WORD_0
v_cvt_pkrtz_f16_f32 v101, v100, v101
v_and_b32 v101, s49, v101
v_bfe_u32 v100, v101, 2, 14
v_lshrrev_b32_e64 v101, 18, v101
ds_read_u16 v100, v100
ds_read_u16 v101, v101
v_mfma_f32_32x32x16_bf16 v[112:127], v[16:19], v[176:179], v[112:127]
v_exp_f16_sdwa v109, v109 dst_sel:WORD_0 dst_unused:UNUSED_PRESERVE src0_sel:WORD_0
v_fma_mix_f32 v229, v168, v168, v229 op_sel_hi:[1,1,0]
v_exp_f16_sdwa v111, v111 dst_sel:WORD_0 dst_unused:UNUSED_PRESERVE src0_sel:WORD_0
v_fma_mix_f32 v229, v169, v169, v229 op_sel_hi:[1,1,0]
v_cvt_pkrtz_f16_f32 v103, v102, v103
v_and_b32_e64 v103, s49, v103
v_bfe_u32 v102, v103, 2, 14
v_lshrrev_b32 v103, 18, v103
ds_read_u16 v102, v102
ds_read_u16 v103, v103
v_exp_f16_sdwa v107, v107 dst_sel:WORD_1 dst_unused:UNUSED_PRESERVE src0_sel:WORD_1
v_fma_mix_f32 v229, v170, v170, v229 op_sel_hi:[1,1,0]
v_exp_f16_sdwa v109, v109 dst_sel:WORD_1 dst_unused:UNUSED_PRESERVE src0_sel:WORD_1
s_waitcnt lgkmcnt(6)
v_fma_mix_f32 v229, v171, v171, v229 op_sel_hi:[1,1,0]
v_mfma_f32_32x32x16_bf16 v[128:143], v[40:43], v[176:179], v[128:143]
v_exp_f16_sdwa v111, v111 dst_sel:WORD_1 dst_unused:UNUSED_PRESERVE src0_sel:WORD_1
ds_read_b128 v[188:191], v250 offset:44032
v_cvt_pkrtz_f16_f32 v105, v104, v105
v_and_b32_e64 v105, s49, v105
v_bfe_u32 v104, v105, 2, 14
v_lshrrev_b32_e64 v105, 18, v105
ds_read_u16 v104, v104
ds_read_u16 v105, v105
v_pk_add_f16 v107, v107, 1.0 op_sel_hi:[1,0]
v_pk_add_f16 v109, v109, 1.0 op_sel_hi:[1,0]
v_pk_add_f16 v111, v111, 1.0 op_sel_hi:[1,0]
v_rcp_f16_sdwa v107, v107 dst_sel:WORD_0 dst_unused:UNUSED_PRESERVE src0_sel:WORD_0
v_mfma_f32_32x32x16_bf16 v[112:127], v[20:23], v[180:183], v[112:127]
v_rcp_f16_sdwa v109, v109 dst_sel:WORD_0 dst_unused:UNUSED_PRESERVE src0_sel:WORD_0
v_rcp_f16_sdwa v111, v111 dst_sel:WORD_0 dst_unused:UNUSED_PRESERVE src0_sel:WORD_0
v_rcp_f16_sdwa v107, v107 dst_sel:WORD_1 dst_unused:UNUSED_PRESERVE src0_sel:WORD_1
v_rcp_f16_sdwa v109, v109 dst_sel:WORD_1 dst_unused:UNUSED_PRESERVE src0_sel:WORD_1
v_mfma_f32_32x32x16_bf16 v[128:143], v[44:47], v[180:183], v[128:143]
v_rcp_f16_sdwa v111, v111 dst_sel:WORD_1 dst_unused:UNUSED_PRESERVE src0_sel:WORD_1
ds_read_b128 v[176:179], v250 offset:45056
v_pk_mul_f16 v106, v106, v107
v_pk_mul_f16 v108, v108, v109
v_pk_mul_f16 v110, v110, v111
v_fma_mix_f32 v229, v106, v106, v229 op_sel_hi:[1,1,0]
v_mfma_f32_32x32x16_bf16 v[144:159], v[0:3], v[184:187], 0
v_fma_mix_f32 v229, v108, v108, v229 op_sel_hi:[1,1,0]
v_cvt_pkrtz_f16_f32 v113, v112, v113
v_fma_mix_f32 v229, v110, v110, v229 op_sel_hi:[1,1,0]
v_and_b32_e64 v113, s49, v113
v_fma_mix_f32 v229, v106, v106, v229 op_sel:[1,1,0] op_sel_hi:[1,1,0]
v_bfe_u32 v112, v113, 2, 14
v_fma_mix_f32 v229, v108, v108, v229 op_sel:[1,1,0] op_sel_hi:[1,1,0]
v_lshrrev_b32 v113, 18, v113
v_fma_mix_f32 v229, v110, v110, v229 op_sel:[1,1,0] op_sel_hi:[1,1,0]
ds_read_u16 v112, v112
v_fma_mix_f32 v229, v96, v96, v229 op_sel_hi:[1,1,0]
ds_read_u16 v113, v113
v_fma_mix_f32 v229, v97, v97, v229 op_sel_hi:[1,1,0]
v_cvt_pk_f16_f32 v124, v124, v125
s_waitcnt lgkmcnt(4)
v_fma_mix_f32 v229, v98, v98, v229 op_sel_hi:[1,1,0]
v_cvt_pk_f16_f32 v126, v126, v127
v_fma_mix_f32 v229, v99, v99, v229 op_sel_hi:[1,1,0]
v_pk_fma_f16 v125, v124, v124, s48
v_mfma_f32_32x32x16_bf16 v[160:175], v[24:27], v[184:187], 0
v_cvt_pkrtz_f16_f32 v115, v114, v115
v_and_b32_e64 v115, s49, v115
v_bfe_u32 v114, v115, 2, 14
v_lshrrev_b32_e64 v115, 18, v115
ds_read_u16 v114, v114
ds_read_u16 v115, v115
ds_read_b128 v[180:183], v250 offset:46080
v_pk_fma_f16 v127, v126, v126, s48
v_fma_mix_f32 v229, v100, v100, v229 op_sel_hi:[1,1,0]
v_pk_mul_f16 v125, v124, v125
v_fma_mix_f32 v229, v101, v101, v229 op_sel_hi:[1,1,0]
v_pk_mul_f16 v127, v126, v127
v_cvt_pkrtz_f16_f32 v117, v116, v117
v_and_b32_e64 v117, s49, v117
v_bfe_u32 v116, v117, 2, 14
v_lshrrev_b32_e64 v117, 18, v117
ds_read_u16 v116, v116
ds_read_u16 v117, v117
v_exp_f16_sdwa v125, v125 dst_sel:WORD_0 dst_unused:UNUSED_PRESERVE src0_sel:WORD_0
v_fma_mix_f32 v229, v102, v102, v229 op_sel_hi:[1,1,0]
v_mfma_f32_32x32x16_bf16 v[144:159], v[4:7], v[188:191], v[144:159]
v_fma_mix_f32 v229, v103, v103, v229 op_sel_hi:[1,1,0]
v_exp_f16_sdwa v127, v127 dst_sel:WORD_0 dst_unused:UNUSED_PRESERVE src0_sel:WORD_0
v_cvt_pkrtz_f16_f32 v119, v118, v119
v_and_b32_e64 v119, s49, v119
v_bfe_u32 v118, v119, 2, 14
v_lshrrev_b32_e64 v119, 18, v119
ds_read_u16 v118, v118
ds_read_u16 v119, v119
v_exp_f16_sdwa v125, v125 dst_sel:WORD_1 dst_unused:UNUSED_PRESERVE src0_sel:WORD_1
v_fma_mix_f32 v229, v104, v104, v229 op_sel_hi:[1,1,0]
v_cvt_pkrtz_f16_f32 v121, v120, v121
s_waitcnt lgkmcnt(6)
v_fma_mix_f32 v229, v105, v105, v229 op_sel_hi:[1,1,0]
v_and_b32 v121, s49, v121
v_bfe_u32 v120, v121, 2, 14
v_lshrrev_b32_e64 v121, 18, v121
ds_read_u16 v120, v120
ds_read_u16 v121, v121
v_exp_f16_sdwa v127, v127 dst_sel:WORD_1 dst_unused:UNUSED_PRESERVE src0_sel:WORD_1
v_mfma_f32_32x32x16_bf16 v[160:175], v[28:31], v[188:191], v[160:175]
ds_read_b128 v[184:187], v250 offset:47104
v_cvt_pkrtz_f16_f32 v123, v122, v123
v_and_b32_e64 v123, s49, v123
v_bfe_u32 v122, v123, 2, 14
v_lshrrev_b32_e64 v123, 18, v123
ds_read_u16 v122, v122
ds_read_u16 v123, v123
v_pk_add_f16 v125, v125, 1.0 op_sel_hi:[1,0]
v_pk_add_f16 v127, v127, 1.0 op_sel_hi:[1,0]
v_rcp_f16_sdwa v125, v125 dst_sel:WORD_0 dst_unused:UNUSED_PRESERVE src0_sel:WORD_0
v_mfma_f32_32x32x16_bf16 v[144:159], v[8:11], v[176:179], v[144:159]
v_rcp_f16_sdwa v127, v127 dst_sel:WORD_0 dst_unused:UNUSED_PRESERVE src0_sel:WORD_0
v_rcp_f16_sdwa v125, v125 dst_sel:WORD_1 dst_unused:UNUSED_PRESERVE src0_sel:WORD_1
v_rcp_f16_sdwa v127, v127 dst_sel:WORD_1 dst_unused:UNUSED_PRESERVE src0_sel:WORD_1
v_mfma_f32_32x32x16_bf16 v[160:175], v[32:35], v[176:179], v[160:175]
ds_read_b128 v[188:191], v250 offset:48128
v_pk_mul_f16 v124, v124, v125
v_pk_mul_f16 v126, v126, v127
v_fma_mix_f32 v230, v124, v124, v230 op_sel_hi:[1,1,0]
v_cvt_pkrtz_f16_f32 v129, v128, v129
s_waitcnt lgkmcnt(7)
v_mfma_f32_32x32x16_bf16 v[144:159], v[12:15], v[180:183], v[144:159]
v_fma_mix_f32 v230, v126, v126, v230 op_sel_hi:[1,1,0]
v_and_b32 v129, s49, v129
v_fma_mix_f32 v230, v124, v124, v230 op_sel:[1,1,0] op_sel_hi:[1,1,0]
v_bfe_u32 v128, v129, 2, 14
v_fma_mix_f32 v230, v126, v126, v230 op_sel:[1,1,0] op_sel_hi:[1,1,0]
v_lshrrev_b32_e64 v129, 18, v129
v_fma_mix_f32 v230, v112, v112, v230 op_sel_hi:[1,1,0]
ds_read_u16 v128, v128
v_fma_mix_f32 v230, v113, v113, v230 op_sel_hi:[1,1,0]
ds_read_u16 v129, v129
v_fma_mix_f32 v230, v114, v114, v230 op_sel_hi:[1,1,0]
v_cvt_pk_f16_f32 v138, v138, v139
v_fma_mix_f32 v230, v115, v115, v230 op_sel_hi:[1,1,0]
v_cvt_pk_f16_f32 v140, v140, v141
v_cvt_pk_f16_f32 v142, v142, v143
v_pk_fma_f16 v139, v138, v138, s48
v_mfma_f32_32x32x16_bf16 v[160:175], v[36:39], v[180:183], v[160:175]
v_fma_mix_f32 v230, v116, v116, v230 op_sel_hi:[1,1,0]
v_pk_fma_f16 v141, v140, v140, s48
v_fma_mix_f32 v230, v117, v117, v230 op_sel_hi:[1,1,0]
ds_read_b128 v[176:179], v250 offset:49152
v_cvt_pkrtz_f16_f32 v131, v130, v131
v_and_b32_e64 v131, s49, v131
v_bfe_u32 v130, v131, 2, 14
v_lshrrev_b32_e64 v131, 18, v131
ds_read_u16 v130, v130
ds_read_u16 v131, v131
v_pk_fma_f16 v143, v142, v142, s48
v_pk_mul_f16 v139, v138, v139
v_pk_mul_f16 v141, v140, v141
v_fma_mix_f32 v230, v118, v118, v230 op_sel_hi:[1,1,0]
v_pk_mul_f16 v143, v142, v143
s_waitcnt lgkmcnt(7)
v_fma_mix_f32 v230, v119, v119, v230 op_sel_hi:[1,1,0]
v_exp_f16_sdwa v139, v139 dst_sel:WORD_0 dst_unused:UNUSED_PRESERVE src0_sel:WORD_0
v_cvt_pkrtz_f16_f32 v133, v132, v133
v_and_b32 v133, s49, v133
v_bfe_u32 v132, v133, 2, 14
v_lshrrev_b32_e64 v133, 18, v133
ds_read_u16 v132, v132
ds_read_u16 v133, v133
v_mfma_f32_32x32x16_bf16 v[144:159], v[16:19], v[184:187], v[144:159]
v_exp_f16_sdwa v141, v141 dst_sel:WORD_0 dst_unused:UNUSED_PRESERVE src0_sel:WORD_0
v_fma_mix_f32 v230, v120, v120, v230 op_sel_hi:[1,1,0]
v_exp_f16_sdwa v143, v143 dst_sel:WORD_0 dst_unused:UNUSED_PRESERVE src0_sel:WORD_0
v_fma_mix_f32 v230, v121, v121, v230 op_sel_hi:[1,1,0]
v_cvt_pkrtz_f16_f32 v135, v134, v135
v_and_b32_e64 v135, s49, v135
v_bfe_u32 v134, v135, 2, 14
v_lshrrev_b32 v135, 18, v135
ds_read_u16 v134, v134
ds_read_u16 v135, v135
v_exp_f16_sdwa v139, v139 dst_sel:WORD_1 dst_unused:UNUSED_PRESERVE src0_sel:WORD_1
v_fma_mix_f32 v230, v122, v122, v230 op_sel_hi:[1,1,0]
v_exp_f16_sdwa v141, v141 dst_sel:WORD_1 dst_unused:UNUSED_PRESERVE src0_sel:WORD_1
s_waitcnt lgkmcnt(6)
v_fma_mix_f32 v230, v123, v123, v230 op_sel_hi:[1,1,0]
v_mfma_f32_32x32x16_bf16 v[160:175], v[40:43], v[184:187], v[160:175]
v_exp_f16_sdwa v143, v143 dst_sel:WORD_1 dst_unused:UNUSED_PRESERVE src0_sel:WORD_1
ds_read_b128 v[180:183], v250 offset:50176
v_cvt_pkrtz_f16_f32 v137, v136, v137
v_and_b32_e64 v137, s49, v137
v_bfe_u32 v136, v137, 2, 14
v_lshrrev_b32_e64 v137, 18, v137
ds_read_u16 v136, v136
ds_read_u16 v137, v137
v_pk_add_f16 v139, v139, 1.0 op_sel_hi:[1,0]
v_pk_add_f16 v141, v141, 1.0 op_sel_hi:[1,0]
v_pk_add_f16 v143, v143, 1.0 op_sel_hi:[1,0]
v_rcp_f16_sdwa v139, v139 dst_sel:WORD_0 dst_unused:UNUSED_PRESERVE src0_sel:WORD_0
v_mfma_f32_32x32x16_bf16 v[144:159], v[20:23], v[188:191], v[144:159]
v_rcp_f16_sdwa v141, v141 dst_sel:WORD_0 dst_unused:UNUSED_PRESERVE src0_sel:WORD_0
v_rcp_f16_sdwa v143, v143 dst_sel:WORD_0 dst_unused:UNUSED_PRESERVE src0_sel:WORD_0
v_rcp_f16_sdwa v139, v139 dst_sel:WORD_1 dst_unused:UNUSED_PRESERVE src0_sel:WORD_1
v_rcp_f16_sdwa v141, v141 dst_sel:WORD_1 dst_unused:UNUSED_PRESERVE src0_sel:WORD_1
v_mfma_f32_32x32x16_bf16 v[160:175], v[44:47], v[188:191], v[160:175]
v_rcp_f16_sdwa v143, v143 dst_sel:WORD_1 dst_unused:UNUSED_PRESERVE src0_sel:WORD_1
ds_read_b128 v[184:187], v250 offset:51200
v_pk_mul_f16 v138, v138, v139
v_pk_mul_f16 v140, v140, v141
v_pk_mul_f16 v142, v142, v143
v_fma_mix_f32 v230, v138, v138, v230 op_sel_hi:[1,1,0]
v_mfma_f32_32x32x16_bf16 v[96:111], v[0:3], v[176:179], 0
v_fma_mix_f32 v230, v140, v140, v230 op_sel_hi:[1,1,0]
v_cvt_pkrtz_f16_f32 v145, v144, v145
v_fma_mix_f32 v230, v142, v142, v230 op_sel_hi:[1,1,0]
v_and_b32_e64 v145, s49, v145
v_fma_mix_f32 v230, v138, v138, v230 op_sel:[1,1,0] op_sel_hi:[1,1,0]
v_bfe_u32 v144, v145, 2, 14
v_fma_mix_f32 v230, v140, v140, v230 op_sel:[1,1,0] op_sel_hi:[1,1,0]
v_lshrrev_b32 v145, 18, v145
v_fma_mix_f32 v230, v142, v142, v230 op_sel:[1,1,0] op_sel_hi:[1,1,0]
ds_read_u16 v144, v144
v_fma_mix_f32 v230, v128, v128, v230 op_sel_hi:[1,1,0]
ds_read_u16 v145, v145
v_fma_mix_f32 v230, v129, v129, v230 op_sel_hi:[1,1,0]
v_cvt_pk_f16_f32 v156, v156, v157
s_waitcnt lgkmcnt(4)
v_fma_mix_f32 v230, v130, v130, v230 op_sel_hi:[1,1,0]
v_cvt_pk_f16_f32 v158, v158, v159
v_fma_mix_f32 v230, v131, v131, v230 op_sel_hi:[1,1,0]
v_pk_fma_f16 v157, v156, v156, s48
v_mfma_f32_32x32x16_bf16 v[112:127], v[24:27], v[176:179], 0
v_cvt_pkrtz_f16_f32 v147, v146, v147
v_and_b32_e64 v147, s49, v147
v_bfe_u32 v146, v147, 2, 14
v_lshrrev_b32_e64 v147, 18, v147
ds_read_u16 v146, v146
ds_read_u16 v147, v147
ds_read_b128 v[188:191], v250 offset:52224
v_pk_fma_f16 v159, v158, v158, s48
v_fma_mix_f32 v230, v132, v132, v230 op_sel_hi:[1,1,0]
v_pk_mul_f16 v157, v156, v157
v_fma_mix_f32 v230, v133, v133, v230 op_sel_hi:[1,1,0]
v_pk_mul_f16 v159, v158, v159
v_cvt_pkrtz_f16_f32 v149, v148, v149
v_and_b32_e64 v149, s49, v149
v_bfe_u32 v148, v149, 2, 14
v_lshrrev_b32_e64 v149, 18, v149
ds_read_u16 v148, v148
ds_read_u16 v149, v149
v_exp_f16_sdwa v157, v157 dst_sel:WORD_0 dst_unused:UNUSED_PRESERVE src0_sel:WORD_0
v_fma_mix_f32 v230, v134, v134, v230 op_sel_hi:[1,1,0]
v_mfma_f32_32x32x16_bf16 v[96:111], v[4:7], v[180:183], v[96:111]
v_fma_mix_f32 v230, v135, v135, v230 op_sel_hi:[1,1,0]
v_exp_f16_sdwa v159, v159 dst_sel:WORD_0 dst_unused:UNUSED_PRESERVE src0_sel:WORD_0
v_cvt_pkrtz_f16_f32 v151, v150, v151
v_and_b32_e64 v151, s49, v151
v_bfe_u32 v150, v151, 2, 14
v_lshrrev_b32_e64 v151, 18, v151
ds_read_u16 v150, v150
ds_read_u16 v151, v151
v_exp_f16_sdwa v157, v157 dst_sel:WORD_1 dst_unused:UNUSED_PRESERVE src0_sel:WORD_1
v_fma_mix_f32 v230, v136, v136, v230 op_sel_hi:[1,1,0]
v_cvt_pkrtz_f16_f32 v153, v152, v153
s_waitcnt lgkmcnt(6)
v_fma_mix_f32 v230, v137, v137, v230 op_sel_hi:[1,1,0]
v_and_b32 v153, s49, v153
v_bfe_u32 v152, v153, 2, 14
v_lshrrev_b32_e64 v153, 18, v153
ds_read_u16 v152, v152
ds_read_u16 v153, v153
v_exp_f16_sdwa v159, v159 dst_sel:WORD_1 dst_unused:UNUSED_PRESERVE src0_sel:WORD_1
v_mfma_f32_32x32x16_bf16 v[112:127], v[28:31], v[180:183], v[112:127]
ds_read_b128 v[176:179], v250 offset:53248
v_cvt_pkrtz_f16_f32 v155, v154, v155
v_and_b32_e64 v155, s49, v155
v_bfe_u32 v154, v155, 2, 14
v_lshrrev_b32_e64 v155, 18, v155
ds_read_u16 v154, v154
ds_read_u16 v155, v155
v_pk_add_f16 v157, v157, 1.0 op_sel_hi:[1,0]
v_pk_add_f16 v159, v159, 1.0 op_sel_hi:[1,0]
v_rcp_f16_sdwa v157, v157 dst_sel:WORD_0 dst_unused:UNUSED_PRESERVE src0_sel:WORD_0
v_mfma_f32_32x32x16_bf16 v[96:111], v[8:11], v[184:187], v[96:111]
v_rcp_f16_sdwa v159, v159 dst_sel:WORD_0 dst_unused:UNUSED_PRESERVE src0_sel:WORD_0
v_rcp_f16_sdwa v157, v157 dst_sel:WORD_1 dst_unused:UNUSED_PRESERVE src0_sel:WORD_1
v_rcp_f16_sdwa v159, v159 dst_sel:WORD_1 dst_unused:UNUSED_PRESERVE src0_sel:WORD_1
v_mfma_f32_32x32x16_bf16 v[112:127], v[32:35], v[184:187], v[112:127]
ds_read_b128 v[180:183], v250 offset:54272
v_pk_mul_f16 v156, v156, v157
v_pk_mul_f16 v158, v158, v159
v_fma_mix_f32 v231, v156, v156, v231 op_sel_hi:[1,1,0]
v_cvt_pkrtz_f16_f32 v161, v160, v161
s_waitcnt lgkmcnt(7)
v_mfma_f32_32x32x16_bf16 v[96:111], v[12:15], v[188:191], v[96:111]
v_fma_mix_f32 v231, v158, v158, v231 op_sel_hi:[1,1,0]
v_and_b32 v161, s49, v161
v_fma_mix_f32 v231, v156, v156, v231 op_sel:[1,1,0] op_sel_hi:[1,1,0]
v_bfe_u32 v160, v161, 2, 14
v_fma_mix_f32 v231, v158, v158, v231 op_sel:[1,1,0] op_sel_hi:[1,1,0]
v_lshrrev_b32_e64 v161, 18, v161
v_fma_mix_f32 v231, v144, v144, v231 op_sel_hi:[1,1,0]
ds_read_u16 v160, v160
v_fma_mix_f32 v231, v145, v145, v231 op_sel_hi:[1,1,0]
ds_read_u16 v161, v161
v_fma_mix_f32 v231, v146, v146, v231 op_sel_hi:[1,1,0]
v_cvt_pk_f16_f32 v170, v170, v171
v_fma_mix_f32 v231, v147, v147, v231 op_sel_hi:[1,1,0]
v_cvt_pk_f16_f32 v172, v172, v173
v_cvt_pk_f16_f32 v174, v174, v175
v_pk_fma_f16 v171, v170, v170, s48
v_mfma_f32_32x32x16_bf16 v[112:127], v[36:39], v[188:191], v[112:127]
v_fma_mix_f32 v231, v148, v148, v231 op_sel_hi:[1,1,0]
v_pk_fma_f16 v173, v172, v172, s48
v_fma_mix_f32 v231, v149, v149, v231 op_sel_hi:[1,1,0]
ds_read_b128 v[184:187], v250 offset:55296
v_cvt_pkrtz_f16_f32 v163, v162, v163
v_and_b32_e64 v163, s49, v163
v_bfe_u32 v162, v163, 2, 14
v_lshrrev_b32_e64 v163, 18, v163
ds_read_u16 v162, v162
ds_read_u16 v163, v163
v_pk_fma_f16 v175, v174, v174, s48
v_pk_mul_f16 v171, v170, v171
v_pk_mul_f16 v173, v172, v173
v_fma_mix_f32 v231, v150, v150, v231 op_sel_hi:[1,1,0]
v_pk_mul_f16 v175, v174, v175
s_waitcnt lgkmcnt(7)
v_fma_mix_f32 v231, v151, v151, v231 op_sel_hi:[1,1,0]
v_exp_f16_sdwa v171, v171 dst_sel:WORD_0 dst_unused:UNUSED_PRESERVE src0_sel:WORD_0
v_cvt_pkrtz_f16_f32 v165, v164, v165
v_and_b32 v165, s49, v165
v_bfe_u32 v164, v165, 2, 14
v_lshrrev_b32_e64 v165, 18, v165
ds_read_u16 v164, v164
ds_read_u16 v165, v165
v_mfma_f32_32x32x16_bf16 v[96:111], v[16:19], v[176:179], v[96:111]
v_exp_f16_sdwa v173, v173 dst_sel:WORD_0 dst_unused:UNUSED_PRESERVE src0_sel:WORD_0
v_fma_mix_f32 v231, v152, v152, v231 op_sel_hi:[1,1,0]
v_exp_f16_sdwa v175, v175 dst_sel:WORD_0 dst_unused:UNUSED_PRESERVE src0_sel:WORD_0
v_fma_mix_f32 v231, v153, v153, v231 op_sel_hi:[1,1,0]
v_cvt_pkrtz_f16_f32 v167, v166, v167
v_and_b32_e64 v167, s49, v167
v_bfe_u32 v166, v167, 2, 14
v_lshrrev_b32 v167, 18, v167
ds_read_u16 v166, v166
ds_read_u16 v167, v167
v_exp_f16_sdwa v171, v171 dst_sel:WORD_1 dst_unused:UNUSED_PRESERVE src0_sel:WORD_1
v_fma_mix_f32 v231, v154, v154, v231 op_sel_hi:[1,1,0]
v_exp_f16_sdwa v173, v173 dst_sel:WORD_1 dst_unused:UNUSED_PRESERVE src0_sel:WORD_1
s_waitcnt lgkmcnt(6)
v_fma_mix_f32 v231, v155, v155, v231 op_sel_hi:[1,1,0]
v_mfma_f32_32x32x16_bf16 v[112:127], v[40:43], v[176:179], v[112:127]
v_exp_f16_sdwa v175, v175 dst_sel:WORD_1 dst_unused:UNUSED_PRESERVE src0_sel:WORD_1
ds_read_b128 v[188:191], v250 offset:56320
v_cvt_pkrtz_f16_f32 v169, v168, v169
v_and_b32_e64 v169, s49, v169
v_bfe_u32 v168, v169, 2, 14
v_lshrrev_b32_e64 v169, 18, v169
ds_read_u16 v168, v168
ds_read_u16 v169, v169
v_pk_add_f16 v171, v171, 1.0 op_sel_hi:[1,0]
v_pk_add_f16 v173, v173, 1.0 op_sel_hi:[1,0]
v_pk_add_f16 v175, v175, 1.0 op_sel_hi:[1,0]
v_rcp_f16_sdwa v171, v171 dst_sel:WORD_0 dst_unused:UNUSED_PRESERVE src0_sel:WORD_0
v_mfma_f32_32x32x16_bf16 v[96:111], v[20:23], v[180:183], v[96:111]
v_rcp_f16_sdwa v173, v173 dst_sel:WORD_0 dst_unused:UNUSED_PRESERVE src0_sel:WORD_0
v_rcp_f16_sdwa v175, v175 dst_sel:WORD_0 dst_unused:UNUSED_PRESERVE src0_sel:WORD_0
v_rcp_f16_sdwa v171, v171 dst_sel:WORD_1 dst_unused:UNUSED_PRESERVE src0_sel:WORD_1
v_rcp_f16_sdwa v173, v173 dst_sel:WORD_1 dst_unused:UNUSED_PRESERVE src0_sel:WORD_1
v_mfma_f32_32x32x16_bf16 v[112:127], v[44:47], v[180:183], v[112:127]
v_rcp_f16_sdwa v175, v175 dst_sel:WORD_1 dst_unused:UNUSED_PRESERVE src0_sel:WORD_1
ds_read_b128 v[176:179], v250 offset:57344
v_pk_mul_f16 v170, v170, v171
v_pk_mul_f16 v172, v172, v173
v_pk_mul_f16 v174, v174, v175
v_fma_mix_f32 v231, v170, v170, v231 op_sel_hi:[1,1,0]
v_mfma_f32_32x32x16_bf16 v[128:143], v[0:3], v[184:187], 0
v_fma_mix_f32 v231, v172, v172, v231 op_sel_hi:[1,1,0]
v_cvt_pkrtz_f16_f32 v97, v96, v97
v_fma_mix_f32 v231, v174, v174, v231 op_sel_hi:[1,1,0]
v_and_b32_e64 v97, s49, v97
v_fma_mix_f32 v231, v170, v170, v231 op_sel:[1,1,0] op_sel_hi:[1,1,0]
v_bfe_u32 v96, v97, 2, 14
v_fma_mix_f32 v231, v172, v172, v231 op_sel:[1,1,0] op_sel_hi:[1,1,0]
v_lshrrev_b32 v97, 18, v97
v_fma_mix_f32 v231, v174, v174, v231 op_sel:[1,1,0] op_sel_hi:[1,1,0]
ds_read_u16 v96, v96
v_fma_mix_f32 v231, v160, v160, v231 op_sel_hi:[1,1,0]
ds_read_u16 v97, v97
v_fma_mix_f32 v231, v161, v161, v231 op_sel_hi:[1,1,0]
v_cvt_pk_f16_f32 v108, v108, v109
s_waitcnt lgkmcnt(4)
v_fma_mix_f32 v231, v162, v162, v231 op_sel_hi:[1,1,0]
v_cvt_pk_f16_f32 v110, v110, v111
v_fma_mix_f32 v231, v163, v163, v231 op_sel_hi:[1,1,0]
v_pk_fma_f16 v109, v108, v108, s48
v_mfma_f32_32x32x16_bf16 v[144:159], v[24:27], v[184:187], 0
v_cvt_pkrtz_f16_f32 v99, v98, v99
v_and_b32_e64 v99, s49, v99
v_bfe_u32 v98, v99, 2, 14
v_lshrrev_b32_e64 v99, 18, v99
ds_read_u16 v98, v98
ds_read_u16 v99, v99
ds_read_b128 v[180:183], v250 offset:58368
v_pk_fma_f16 v111, v110, v110, s48
v_fma_mix_f32 v231, v164, v164, v231 op_sel_hi:[1,1,0]
v_pk_mul_f16 v109, v108, v109
v_fma_mix_f32 v231, v165, v165, v231 op_sel_hi:[1,1,0]
v_pk_mul_f16 v111, v110, v111
v_cvt_pkrtz_f16_f32 v101, v100, v101
v_and_b32_e64 v101, s49, v101
v_bfe_u32 v100, v101, 2, 14
v_lshrrev_b32_e64 v101, 18, v101
ds_read_u16 v100, v100
ds_read_u16 v101, v101
v_exp_f16_sdwa v109, v109 dst_sel:WORD_0 dst_unused:UNUSED_PRESERVE src0_sel:WORD_0
v_fma_mix_f32 v231, v166, v166, v231 op_sel_hi:[1,1,0]
v_mfma_f32_32x32x16_bf16 v[128:143], v[4:7], v[188:191], v[128:143]
v_fma_mix_f32 v231, v167, v167, v231 op_sel_hi:[1,1,0]
v_exp_f16_sdwa v111, v111 dst_sel:WORD_0 dst_unused:UNUSED_PRESERVE src0_sel:WORD_0
v_cvt_pkrtz_f16_f32 v103, v102, v103
v_and_b32_e64 v103, s49, v103
v_bfe_u32 v102, v103, 2, 14
v_lshrrev_b32_e64 v103, 18, v103
ds_read_u16 v102, v102
ds_read_u16 v103, v103
v_exp_f16_sdwa v109, v109 dst_sel:WORD_1 dst_unused:UNUSED_PRESERVE src0_sel:WORD_1
v_fma_mix_f32 v231, v168, v168, v231 op_sel_hi:[1,1,0]
v_cvt_pkrtz_f16_f32 v105, v104, v105
s_waitcnt lgkmcnt(6)
v_fma_mix_f32 v231, v169, v169, v231 op_sel_hi:[1,1,0]
v_and_b32 v105, s49, v105
v_bfe_u32 v104, v105, 2, 14
v_lshrrev_b32_e64 v105, 18, v105
ds_read_u16 v104, v104
ds_read_u16 v105, v105
v_exp_f16_sdwa v111, v111 dst_sel:WORD_1 dst_unused:UNUSED_PRESERVE src0_sel:WORD_1
v_mfma_f32_32x32x16_bf16 v[144:159], v[28:31], v[188:191], v[144:159]
ds_read_b128 v[184:187], v250 offset:59392
v_cvt_pkrtz_f16_f32 v107, v106, v107
v_and_b32_e64 v107, s49, v107
v_bfe_u32 v106, v107, 2, 14
v_lshrrev_b32_e64 v107, 18, v107
ds_read_u16 v106, v106
ds_read_u16 v107, v107
v_pk_add_f16 v109, v109, 1.0 op_sel_hi:[1,0]
v_pk_add_f16 v111, v111, 1.0 op_sel_hi:[1,0]
v_rcp_f16_sdwa v109, v109 dst_sel:WORD_0 dst_unused:UNUSED_PRESERVE src0_sel:WORD_0
v_mfma_f32_32x32x16_bf16 v[128:143], v[8:11], v[176:179], v[128:143]
v_rcp_f16_sdwa v111, v111 dst_sel:WORD_0 dst_unused:UNUSED_PRESERVE src0_sel:WORD_0
v_rcp_f16_sdwa v109, v109 dst_sel:WORD_1 dst_unused:UNUSED_PRESERVE src0_sel:WORD_1
v_rcp_f16_sdwa v111, v111 dst_sel:WORD_1 dst_unused:UNUSED_PRESERVE src0_sel:WORD_1
v_mfma_f32_32x32x16_bf16 v[144:159], v[32:35], v[176:179], v[144:159]
ds_read_b128 v[188:191], v250 offset:60416
v_pk_mul_f16 v108, v108, v109
v_pk_mul_f16 v110, v110, v111
v_fma_mix_f32 v232, v108, v108, v232 op_sel_hi:[1,1,0]
v_add_u32_e64 v222, s83, v247
v_mov_b32 v223, 0
s_branch Law4
Lax4:
s_sleep 2
Law4:
ds_read_b32 v223, v222 offset:20
s_sub_u32 s76, s76, 1
s_cselect_b32 s44, 4, 0
s_cselect_b32 s76, 0, s76
s_waitcnt lgkmcnt(0)
v_readfirstlane_b32 s43, v223
s_nop 1
s_max_u32 s43, s43, s44
s_cmp_lt_u32 s43, 4
s_cbranch_scc1 Lax4
v_mfma_f32_32x32x16_bf16 v[128:143], v[12:15], v[180:183], v[128:143]
s_add_u32 s81, s81, 6592
s_cmp_eq_u32 s81, 65920
s_cselect_b32 s81, 0, s81
s_add_u32 s43, s81, s67
s_add_u32 m0, s43, 16
s_add_u32 s66, s66, 98304
buffer_load_dwordx4 v236, s[4:7], s66 offen lds
s_add_u32 m0, s43, 912
s_nop 0
buffer_load_dwordx4 v237, s[4:7], s66 offen lds
v_fma_mix_f32 v232, v110, v110, v232 op_sel_hi:[1,1,0]
v_cvt_pkrtz_f16_f32 v113, v112, v113
v_fma_mix_f32 v232, v108, v108, v232 op_sel:[1,1,0] op_sel_hi:[1,1,0]
v_and_b32_e64 v113, s49, v113
v_fma_mix_f32 v232, v110, v110, v232 op_sel:[1,1,0] op_sel_hi:[1,1,0]
v_bfe_u32 v112, v113, 2, 14
v_fma_mix_f32 v232, v96, v96, v232 op_sel_hi:[1,1,0]
v_lshrrev_b32_e64 v113, 18, v113
v_fma_mix_f32 v232, v97, v97, v232 op_sel_hi:[1,1,0]
ds_read_u16 v112, v112
v_fma_mix_f32 v232, v98, v98, v232 op_sel_hi:[1,1,0]
ds_read_u16 v113, v113
v_fma_mix_f32 v232, v99, v99, v232 op_sel_hi:[1,1,0]
v_cvt_pk_f16_f32 v122, v122, v123
v_cvt_pk_f16_f32 v124, v124, v125
v_cvt_pk_f16_f32 v126, v126, v127
v_pk_fma_f16 v123, v122, v122, s48
v_mfma_f32_32x32x16_bf16 v[144:159], v[36:39], v[180:183], v[144:159]
v_fma_mix_f32 v232, v100, v100, v232 op_sel_hi:[1,1,0]
v_pk_fma_f16 v125, v124, v124, s48
v_fma_mix_f32 v232, v101, v101, v232 op_sel_hi:[1,1,0]
ds_read_b128 v[176:179], v250 offset:61440
v_cvt_pkrtz_f16_f32 v115, v114, v115
v_and_b32_e64 v115, s49, v115
v_bfe_u32 v114, v115, 2, 14
v_lshrrev_b32_e64 v115, 18, v115
ds_read_u16 v114, v114
ds_read_u16 v115, v115
v_pk_fma_f16 v127, v126, v126, s48
v_pk_mul_f16 v123, v122, v123
v_pk_mul_f16 v125, v124, v125
v_fma_mix_f32 v232, v102, v102, v232 op_sel_hi:[1,1,0]
v_pk_mul_f16 v127, v126, v127
v_fma_mix_f32 v232, v103, v103, v232 op_sel_hi:[1,1,0]
v_exp_f16_sdwa v123, v123 dst_sel:WORD_0 dst_unused:UNUSED_PRESERVE src0_sel:WORD_0
s_add_u32 s81, s81, 6592
s_cmp_eq_u32 s81, 65920
s_cselect_b32 s81, 0, s81
s_add_u32 s43, s81, s67
s_add_u32 m0, s43, 16
s_add_u32 s66, s66, 98304
buffer_load_dwordx4 v236, s[4:7], s66 offen lds
s_add_u32 m0, s43, 912
s_nop 0
buffer_load_dwordx4 v237, s[4:7], s66 offen lds
v_cvt_pkrtz_f16_f32 v117, v116, v117
v_and_b32_e64 v117, s49, v117
v_bfe_u32 v116, v117, 2, 14
v_lshrrev_b32_e64 v117, 18, v117
ds_read_u16 v116, v116
ds_read_u16 v117, v117
v_mfma_f32_32x32x16_bf16 v[128:143], v[16:19], v[184:187], v[128:143]
v_exp_f16_sdwa v125, v125 dst_sel:WORD_0 dst_unused:UNUSED_PRESERVE src0_sel:WORD_0
v_fma_mix_f32 v232, v104, v104, v232 op_sel_hi:[1,1,0]
v_exp_f16_sdwa v127, v127 dst_sel:WORD_0 dst_unused:UNUSED_PRESERVE src0_sel:WORD_0
v_fma_mix_f32 v232, v105, v105, v232 op_sel_hi:[1,1,0]
v_cvt_pkrtz_f16_f32 v119, v118, v119
v_and_b32_e64 v119, s49, v119
v_bfe_u32 v118, v119, 2, 14
v_lshrrev_b32_e64 v119, 18, v119
ds_read_u16 v118, v118
ds_read_u16 v119, v119
v_exp_f16_sdwa v123, v123 dst_sel:WORD_1 dst_unused:UNUSED_PRESERVE src0_sel:WORD_1
v_fma_mix_f32 v232, v106, v106, v232 op_sel_hi:[1,1,0]
v_exp_f16_sdwa v125, v125 dst_sel:WORD_1 dst_unused:UNUSED_PRESERVE src0_sel:WORD_1
v_fma_mix_f32 v232, v107, v107, v232 op_sel_hi:[1,1,0]
v_mfma_f32_32x32x16_bf16 v[144:159], v[40:43], v[184:187], v[144:159]
v_exp_f16_sdwa v127, v127 dst_sel:WORD_1 dst_unused:UNUSED_PRESERVE src0_sel:WORD_1
ds_read_b128 v[180:183], v250 offset:62464
v_cvt_pkrtz_f16_f32 v121, v120, v121
v_and_b32_e64 v121, s49, v121
v_bfe_u32 v120, v121, 2, 14
v_lshrrev_b32_e64 v121, 18, v121
ds_read_u16 v120, v120
ds_read_u16 v121, v121
v_pk_add_f16 v123, v123, 1.0 op_sel_hi:[1,0]
v_pk_add_f16 v125, v125, 1.0 op_sel_hi:[1,0]
v_pk_add_f16 v127, v127, 1.0 op_sel_hi:[1,0]
s_add_u32 s81, s81, 6592
s_cmp_eq_u32 s81, 65920
s_cselect_b32 s81, 0, s81
s_add_u32 s43, s81, s67
s_add_u32 m0, s43, 32
s_add_u32 s66, s66, 98304
buffer_load_dwordx4 v236, s[4:7], s66 offen lds
s_add_u32 m0, s43, 928
s_nop 0
buffer_load_dwordx4 v237, s[4:7], s66 offen lds
v_rcp_f16_sdwa v123, v123 dst_sel:WORD_0 dst_unused:UNUSED_PRESERVE src0_sel:WORD_0
v_mfma_f32_32x32x16_bf16 v[128:143], v[20:23], v[188:191], v[128:143]
v_rcp_f16_sdwa v125, v125 dst_sel:WORD_0 dst_unused:UNUSED_PRESERVE src0_sel:WORD_0
v_rcp_f16_sdwa v127, v127 dst_sel:WORD_0 dst_unused:UNUSED_PRESERVE src0_sel:WORD_0
v_rcp_f16_sdwa v123, v123 dst_sel:WORD_1 dst_unused:UNUSED_PRESERVE src0_sel:WORD_1
v_rcp_f16_sdwa v125, v125 dst_sel:WORD_1 dst_unused:UNUSED_PRESERVE src0_sel:WORD_1
v_mfma_f32_32x32x16_bf16 v[144:159], v[44:47], v[188:191], v[144:159]
v_rcp_f16_sdwa v127, v127 dst_sel:WORD_1 dst_unused:UNUSED_PRESERVE src0_sel:WORD_1
ds_read_b128 v[184:187], v250 offset:63488
v_pk_mul_f16 v122, v122, v123
v_pk_mul_f16 v124, v124, v125
s_add_u32 s81, s81, 6592
s_cmp_eq_u32 s81, 65920
s_cselect_b32 s81, 0, s81
s_add_u32 s43, s81, s67
s_add_u32 m0, s43, 32
s_add_u32 s66, s66, 98304
buffer_load_dwordx4 v236, s[4:7], s66 offen lds
s_add_u32 m0, s43, 928
s_nop 0
buffer_load_dwordx4 v237, s[4:7], s66 offen lds
v_pk_mul_f16 v126, v126, v127
v_fma_mix_f32 v232, v122, v122, v232 op_sel_hi:[1,1,0]
s_waitcnt lgkmcnt(3)
v_mfma_f32_32x32x16_bf16 v[160:175], v[0:3], v[176:179], 0
v_fma_mix_f32 v232, v124, v124, v232 op_sel_hi:[1,1,0]
v_cvt_pkrtz_f16_f32 v129, v128, v129
v_fma_mix_f32 v232, v126, v126, v232 op_sel_hi:[1,1,0]
v_and_b32 v129, s49, v129
v_fma_mix_f32 v232, v122, v122, v232 op_sel:[1,1,0] op_sel_hi:[1,1,0]
v_bfe_u32 v128, v129, 2, 14
v_fma_mix_f32 v232, v124, v124, v232 op_sel:[1,1,0] op_sel_hi:[1,1,0]
v_lshrrev_b32_e64 v129, 18, v129
v_fma_mix_f32 v232, v126, v126, v232 op_sel:[1,1,0] op_sel_hi:[1,1,0]
ds_read_u16 v128, v128
v_fma_mix_f32 v232, v112, v112, v232 op_sel_hi:[1,1,0]
ds_read_u16 v129, v129
v_fma_mix_f32 v232, v113, v113, v232 op_sel_hi:[1,1,0]
v_cvt_pk_f16_f32 v140, v140, v141
v_fma_mix_f32 v232, v114, v114, v232 op_sel_hi:[1,1,0]
v_cvt_pk_f16_f32 v142, v142, v143
v_fma_mix_f32 v232, v115, v115, v232 op_sel_hi:[1,1,0]
v_pk_fma_f16 v141, v140, v140, s48
v_mfma_f32_32x32x16_bf16 v[96:111], v[24:27], v[176:179], 0
v_cvt_pkrtz_f16_f32 v131, v130, v131
v_and_b32_e64 v131, s49, v131
v_bfe_u32 v130, v131, 2, 14
v_lshrrev_b32_e64 v131, 18, v131
ds_read_u16 v130, v130
ds_read_u16 v131, v131
ds_read_b128 v[188:191], v250 offset:64512
v_pk_fma_f16 v143, v142, v142, s48
v_fma_mix_f32 v232, v116, v116, v232 op_sel_hi:[1,1,0]
v_pk_mul_f16 v141, v140, v141
v_fma_mix_f32 v232, v117, v117, v232 op_sel_hi:[1,1,0]
s_add_u32 s81, s81, 6592
s_cmp_eq_u32 s81, 65920
s_cselect_b32 s81, 0, s81
s_add_u32 s43, s81, s67
s_add_u32 m0, s43, 48
s_add_u32 s66, s66, 98304
buffer_load_dwordx4 v236, s[4:7], s66 offen lds
s_add_u32 m0, s43, 944
s_nop 0
buffer_load_dwordx4 v237, s[4:7], s66 offen lds
v_pk_mul_f16 v143, v142, v143
v_cvt_pkrtz_f16_f32 v133, v132, v133
v_and_b32_e64 v133, s49, v133
v_bfe_u32 v132, v133, 2, 14
v_lshrrev_b32_e64 v133, 18, v133
ds_read_u16 v132, v132
ds_read_u16 v133, v133
v_exp_f16_sdwa v141, v141 dst_sel:WORD_0 dst_unused:UNUSED_PRESERVE src0_sel:WORD_0
v_fma_mix_f32 v232, v118, v118, v232 op_sel_hi:[1,1,0]
v_mfma_f32_32x32x16_bf16 v[160:175], v[4:7], v[180:183], v[160:175]
v_fma_mix_f32 v232, v119, v119, v232 op_sel_hi:[1,1,0]
v_exp_f16_sdwa v143, v143 dst_sel:WORD_0 dst_unused:UNUSED_PRESERVE src0_sel:WORD_0
v_cvt_pkrtz_f16_f32 v135, v134, v135
v_and_b32_e64 v135, s49, v135
v_bfe_u32 v134, v135, 2, 14
v_lshrrev_b32 v135, 18, v135
ds_read_u16 v134, v134
ds_read_u16 v135, v135
v_exp_f16_sdwa v141, v141 dst_sel:WORD_1 dst_unused:UNUSED_PRESERVE src0_sel:WORD_1
s_waitcnt lgkmcnt(7)
v_fma_mix_f32 v232, v120, v120, v232 op_sel_hi:[1,1,0]
v_cvt_pkrtz_f16_f32 v137, v136, v137
v_fma_mix_f32 v232, v121, v121, v232 op_sel_hi:[1,1,0]
v_and_b32_e64 v137, s49, v137
v_bfe_u32 v136, v137, 2, 14
v_lshrrev_b32_e64 v137, 18, v137
ds_read_u16 v136, v136
ds_read_u16 v137, v137
v_exp_f16_sdwa v143, v143 dst_sel:WORD_1 dst_unused:UNUSED_PRESERVE src0_sel:WORD_1
v_mfma_f32_32x32x16_bf16 v[96:111], v[28:31], v[180:183], v[96:111]
ds_read_b128 v[176:179], v251
v_cvt_pkrtz_f16_f32 v139, v138, v139
v_and_b32_e64 v139, s49, v139
v_bfe_u32 v138, v139, 2, 14
v_lshrrev_b32_e64 v139, 18, v139
ds_read_u16 v138, v138
ds_read_u16 v139, v139
s_add_u32 s81, s81, 6592
s_cmp_eq_u32 s81, 65920
s_cselect_b32 s81, 0, s81
s_add_u32 s43, s81, s67
s_add_u32 m0, s43, 48
s_add_u32 s66, s66, 98304
buffer_load_dwordx4 v236, s[4:7], s66 offen lds
s_add_u32 m0, s43, 944
s_nop 0
buffer_load_dwordx4 v237, s[4:7], s66 offen lds
v_pk_add_f16 v141, v141, 1.0 op_sel_hi:[1,0]
v_pk_add_f16 v143, v143, 1.0 op_sel_hi:[1,0]
v_rcp_f16_sdwa v141, v141 dst_sel:WORD_0 dst_unused:UNUSED_PRESERVE src0_sel:WORD_0
v_mfma_f32_32x32x16_bf16 v[160:175], v[8:11], v[184:187], v[160:175]
v_rcp_f16_sdwa v143, v143 dst_sel:WORD_0 dst_unused:UNUSED_PRESERVE src0_sel:WORD_0
v_rcp_f16_sdwa v141, v141 dst_sel:WORD_1 dst_unused:UNUSED_PRESERVE src0_sel:WORD_1
v_rcp_f16_sdwa v143, v143 dst_sel:WORD_1 dst_unused:UNUSED_PRESERVE src0_sel:WORD_1
v_mfma_f32_32x32x16_bf16 v[96:111], v[32:35], v[184:187], v[96:111]
ds_read_b128 v[180:183], v251 offset:1024
s_add_u32 s81, s81, 6592
s_cmp_eq_u32 s81, 65920
s_cselect_b32 s81, 0, s81
s_add_u32 s43, s81, s67
s_add_u32 m0, s43, 0
s_add_u32 s66, s66, 98304
buffer_load_dwordx4 v236, s[4:7], s66 offen lds
s_add_u32 m0, s43, 896
s_nop 0
buffer_load_dwordx4 v237, s[4:7], s66 offen lds
v_pk_mul_f16 v140, v140, v141
v_pk_mul_f16 v142, v142, v143
v_fma_mix_f32 v233, v140, v140, v233 op_sel_hi:[1,1,0]
s_waitcnt lgkmcnt(7)
v_mfma_f32_32x32x16_bf16 v[160:175], v[12:15], v[188:191], v[160:175]
v_fma_mix_f32 v233, v142, v142, v233 op_sel_hi:[1,1,0]
v_cvt_pkrtz_f16_f32 v145, v144, v145
v_fma_mix_f32 v233, v140, v140, v233 op_sel:[1,1,0] op_sel_hi:[1,1,0]
v_and_b32 v145, s49, v145
v_fma_mix_f32 v233, v142, v142, v233 op_sel:[1,1,0] op_sel_hi:[1,1,0]
v_bfe_u32 v144, v145, 2, 14
v_fma_mix_f32 v233, v128, v128, v233 op_sel_hi:[1,1,0]
v_lshrrev_b32_e64 v145, 18, v145
v_fma_mix_f32 v233, v129, v129, v233 op_sel_hi:[1,1,0]
ds_read_u16 v144, v144
v_fma_mix_f32 v233, v130, v130, v233 op_sel_hi:[1,1,0]
ds_read_u16 v145, v145
v_fma_mix_f32 v233, v131, v131, v233 op_sel_hi:[1,1,0]
v_cvt_pk_f16_f32 v154, v154, v155
v_cvt_pk_f16_f32 v156, v156, v157
v_cvt_pk_f16_f32 v158, v158, v159
v_pk_fma_f16 v155, v154, v154, s48
v_mfma_f32_32x32x16_bf16 v[96:111], v[36:39], v[188:191], v[96:111]
v_fma_mix_f32 v233, v132, v132, v233 op_sel_hi:[1,1,0]
v_pk_fma_f16 v157, v156, v156, s48
v_fma_mix_f32 v233, v133, v133, v233 op_sel_hi:[1,1,0]
s_add_u32 s81, s81, 6592
s_cmp_eq_u32 s81, 65920
s_cselect_b32 s81, 0, s81
s_add_u32 s43, s81, s67
s_add_u32 m0, s43, 0
s_add_u32 s66, s66, 98304
buffer_load_dwordx4 v236, s[4:7], s66 offen lds
s_add_u32 m0, s43, 896
s_nop 0
buffer_load_dwordx4 v237, s[4:7], s66 offen lds
ds_read_b128 v[184:187], v251 offset:2048
v_cvt_pkrtz_f16_f32 v147, v146, v147
v_and_b32_e64 v147, s49, v147
v_bfe_u32 v146, v147, 2, 14
v_lshrrev_b32_e64 v147, 18, v147
ds_read_u16 v146, v146
ds_read_u16 v147, v147
v_pk_fma_f16 v159, v158, v158, s48
v_pk_mul_f16 v155, v154, v155
v_pk_mul_f16 v157, v156, v157
v_fma_mix_f32 v233, v134, v134, v233 op_sel_hi:[1,1,0]
v_pk_mul_f16 v159, v158, v159
s_waitcnt lgkmcnt(6)
v_fma_mix_f32 v233, v135, v135, v233 op_sel_hi:[1,1,0]
v_exp_f16_sdwa v155, v155 dst_sel:WORD_0 dst_unused:UNUSED_PRESERVE src0_sel:WORD_0
v_cvt_pkrtz_f16_f32 v149, v148, v149
v_and_b32 v149, s49, v149
v_bfe_u32 v148, v149, 2, 14
v_lshrrev_b32_e64 v149, 18, v149
ds_read_u16 v148, v148
ds_read_u16 v149, v149
v_mfma_f32_32x32x16_bf16 v[160:175], v[16:19], v[176:179], v[160:175]
v_exp_f16_sdwa v157, v157 dst_sel:WORD_0 dst_unused:UNUSED_PRESERVE src0_sel:WORD_0
v_fma_mix_f32 v233, v136, v136, v233 op_sel_hi:[1,1,0]
v_exp_f16_sdwa v159, v159 dst_sel:WORD_0 dst_unused:UNUSED_PRESERVE src0_sel:WORD_0
v_fma_mix_f32 v233, v137, v137, v233 op_sel_hi:[1,1,0]
v_cvt_pkrtz_f16_f32 v151, v150, v151
v_and_b32_e64 v151, s49, v151
v_bfe_u32 v150, v151, 2, 14
v_lshrrev_b32_e64 v151, 18, v151
ds_read_u16 v150, v150
ds_read_u16 v151, v151
v_exp_f16_sdwa v155, v155 dst_sel:WORD_1 dst_unused:UNUSED_PRESERVE src0_sel:WORD_1
v_fma_mix_f32 v233, v138, v138, v233 op_sel_hi:[1,1,0]
v_exp_f16_sdwa v157, v157 dst_sel:WORD_1 dst_unused:UNUSED_PRESERVE src0_sel:WORD_1
v_fma_mix_f32 v233, v139, v139, v233 op_sel_hi:[1,1,0]
v_mfma_f32_32x32x16_bf16 v[96:111], v[40:43], v[176:179], v[96:111]
v_exp_f16_sdwa v159, v159 dst_sel:WORD_1 dst_unused:UNUSED_PRESERVE src0_sel:WORD_1
ds_read_b128 v[188:191], v251 offset:3072
v_cvt_pkrtz_f16_f32 v153, v152, v153
v_and_b32_e64 v153, s49, v153
v_bfe_u32 v152, v153, 2, 14
v_lshrrev_b32 v153, 18, v153
ds_read_u16 v152, v152
ds_read_u16 v153, v153
v_pk_add_f16 v155, v155, 1.0 op_sel_hi:[1,0]
v_pk_add_f16 v157, v157, 1.0 op_sel_hi:[1,0]
v_pk_add_f16 v159, v159, 1.0 op_sel_hi:[1,0]
v_rcp_f16_sdwa v155, v155 dst_sel:WORD_0 dst_unused:UNUSED_PRESERVE src0_sel:WORD_0
s_waitcnt lgkmcnt(6)
v_mfma_f32_32x32x16_bf16 v[160:175], v[20:23], v[180:183], v[160:175]
v_rcp_f16_sdwa v157, v157 dst_sel:WORD_0 dst_unused:UNUSED_PRESERVE src0_sel:WORD_0
v_rcp_f16_sdwa v159, v159 dst_sel:WORD_0 dst_unused:UNUSED_PRESERVE src0_sel:WORD_0
v_rcp_f16_sdwa v155, v155 dst_sel:WORD_1 dst_unused:UNUSED_PRESERVE src0_sel:WORD_1
v_rcp_f16_sdwa v157, v157 dst_sel:WORD_1 dst_unused:UNUSED_PRESERVE src0_sel:WORD_1
v_mfma_f32_32x32x16_bf16 v[96:111], v[44:47], v[180:183], v[96:111]
v_rcp_f16_sdwa v159, v159 dst_sel:WORD_1 dst_unused:UNUSED_PRESERVE src0_sel:WORD_1
ds_read_b128 v[176:179], v251 offset:4096
v_pk_mul_f16 v154, v154, v155
v_pk_mul_f16 v156, v156, v157
v_pk_mul_f16 v158, v158, v159
v_fma_mix_f32 v233, v154, v154, v233 op_sel_hi:[1,1,0]
v_mfma_f32_32x32x16_bf16 v[112:127], v[0:3], v[184:187], 0
v_fma_mix_f32 v233, v156, v156, v233 op_sel_hi:[1,1,0]
s_getpc_b64 s[74:75]
Lcq3:
s_lshl_b32 s43, s40, 10
s_add_u32 s43, s43, 6144
s_min_u32 s43, s43, Lend-Lcq3-1024
s_add_u32 s74, s74, s43
s_addc_u32 s75, s75, 0
s_sub_u32 s74, s74, 16384
s_subb_u32 s75, s75, 0
s_mov_b32 m0, 163840
s_nop 0
global_load_lds_dword v250, s[74:75]
v_cvt_pkrtz_f16_f32 v161, v160, v161
v_fma_mix_f32 v233, v158, v158, v233 op_sel_hi:[1,1,0]
v_and_b32_e64 v161, s49, v161
v_fma_mix_f32 v233, v154, v154, v233 op_sel:[1,1,0] op_sel_hi:[1,1,0]
v_bfe_u32 v160, v161, 2, 14
v_fma_mix_f32 v233, v156, v156, v233 op_sel:[1,1,0] op_sel_hi:[1,1,0]
v_lshrrev_b32_e64 v161, 18, v161
v_fma_mix_f32 v233, v158, v158, v233 op_sel:[1,1,0] op_sel_hi:[1,1,0]
ds_read_u16 v160, v160
v_fma_mix_f32 v233, v144, v144, v233 op_sel_hi:[1,1,0]
ds_read_u16 v161, v161
v_fma_mix_f32 v233, v145, v145, v233 op_sel_hi:[1,1,0]
v_cvt_pk_f16_f32 v172, v172, v173
v_fma_mix_f32 v233, v146, v146, v233 op_sel_hi:[1,1,0]
v_cvt_pk_f16_f32 v174, v174, v175
v_fma_mix_f32 v233, v147, v147, v233 op_sel_hi:[1,1,0]
v_pk_fma_f16 v173, v172, v172, s48
v_mfma_f32_32x32x16_bf16 v[128:143], v[24:27], v[184:187], 0
v_cvt_pkrtz_f16_f32 v163, v162, v163
v_and_b32_e64 v163, s49, v163
v_bfe_u32 v162, v163, 2, 14
v_lshrrev_b32_e64 v163, 18, v163
ds_read_u16 v162, v162
ds_read_u16 v163, v163
ds_read_b128 v[180:183], v251 offset:5120
v_pk_fma_f16 v175, v174, v174, s48
v_fma_mix_f32 v233, v148, v148, v233 op_sel_hi:[1,1,0]
v_pk_mul_f16 v173, v172, v173
s_waitcnt lgkmcnt(5)
v_fma_mix_f32 v233, v149, v149, v233 op_sel_hi:[1,1,0]
v_pk_mul_f16 v175, v174, v175
v_cvt_pkrtz_f16_f32 v165, v164, v165
v_and_b32 v165, s49, v165
v_bfe_u32 v164, v165, 2, 14
v_lshrrev_b32_e64 v165, 18, v165
ds_read_u16 v164, v164
ds_read_u16 v165, v165
v_exp_f16_sdwa v173, v173 dst_sel:WORD_0 dst_unused:UNUSED_PRESERVE src0_sel:WORD_0
v_fma_mix_f32 v233, v150, v150, v233 op_sel_hi:[1,1,0]
v_mfma_f32_32x32x16_bf16 v[112:127], v[4:7], v[188:191], v[112:127]
v_fma_mix_f32 v233, v151, v151, v233 op_sel_hi:[1,1,0]
v_exp_f16_sdwa v175, v175 dst_sel:WORD_0 dst_unused:UNUSED_PRESERVE src0_sel:WORD_0
v_cvt_pkrtz_f16_f32 v167, v166, v167
v_and_b32_e64 v167, s49, v167
v_bfe_u32 v166, v167, 2, 14
v_lshrrev_b32_e64 v167, 18, v167
ds_read_u16 v166, v166
ds_read_u16 v167, v167
v_exp_f16_sdwa v173, v173 dst_sel:WORD_1 dst_unused:UNUSED_PRESERVE src0_sel:WORD_1
v_fma_mix_f32 v233, v152, v152, v233 op_sel_hi:[1,1,0]
v_cvt_pkrtz_f16_f32 v169, v168, v169
v_fma_mix_f32 v233, v153, v153, v233 op_sel_hi:[1,1,0]
v_and_b32_e64 v169, s49, v169
v_bfe_u32 v168, v169, 2, 14
v_lshrrev_b32_e64 v169, 18, v169
ds_read_u16 v168, v168
ds_read_u16 v169, v169
v_exp_f16_sdwa v175, v175 dst_sel:WORD_1 dst_unused:UNUSED_PRESERVE src0_sel:WORD_1
v_mfma_f32_32x32x16_bf16 v[128:143], v[28:31], v[188:191], v[128:143]
ds_read_b128 v[184:187], v251 offset:6144
v_cvt_pkrtz_f16_f32 v171, v170, v171
v_and_b32_e64 v171, s49, v171
v_bfe_u32 v170, v171, 2, 14
v_lshrrev_b32_e64 v171, 18, v171
ds_read_u16 v170, v170
ds_read_u16 v171, v171
v_pk_add_f16 v173, v173, 1.0 op_sel_hi:[1,0]
v_pk_add_f16 v175, v175, 1.0 op_sel_hi:[1,0]
v_rcp_f16_sdwa v173, v173 dst_sel:WORD_0 dst_unused:UNUSED_PRESERVE src0_sel:WORD_0
v_mfma_f32_32x32x16_bf16 v[112:127], v[8:11], v[176:179], v[112:127]
v_rcp_f16_sdwa v175, v175 dst_sel:WORD_0 dst_unused:UNUSED_PRESERVE src0_sel:WORD_0
v_rcp_f16_sdwa v173, v173 dst_sel:WORD_1 dst_unused:UNUSED_PRESERVE src0_sel:WORD_1
v_rcp_f16_sdwa v175, v175 dst_sel:WORD_1 dst_unused:UNUSED_PRESERVE src0_sel:WORD_1
v_mfma_f32_32x32x16_bf16 v[128:143], v[32:35], v[176:179], v[128:143]
ds_read_b128 v[188:191], v251 offset:7168
v_pk_mul_f16 v172, v172, v173
v_pk_mul_f16 v174, v174, v175
v_fma_mix_f32 v234, v172, v172, v234 op_sel_hi:[1,1,0]
v_cvt_pkrtz_f16_f32 v97, v96, v97
s_waitcnt lgkmcnt(7)
v_mfma_f32_32x32x16_bf16 v[112:127], v[12:15], v[180:183], v[112:127]
v_fma_mix_f32 v234, v174, v174, v234 op_sel_hi:[1,1,0]
v_and_b32 v97, s49, v97
v_fma_mix_f32 v234, v172, v172, v234 op_sel:[1,1,0] op_sel_hi:[1,1,0]
v_bfe_u32 v96, v97, 2, 14
v_fma_mix_f32 v234, v174, v174, v234 op_sel:[1,1,0] op_sel_hi:[1,1,0]
v_lshrrev_b32_e64 v97, 18, v97
v_fma_mix_f32 v234, v160, v160, v234 op_sel_hi:[1,1,0]
ds_read_u16 v96, v96
v_fma_mix_f32 v234, v161, v161, v234 op_sel_hi:[1,1,0]
ds_read_u16 v97, v97
v_fma_mix_f32 v234, v162, v162, v234 op_sel_hi:[1,1,0]
v_cvt_pk_f16_f32 v106, v106, v107
v_fma_mix_f32 v234, v163, v163, v234 op_sel_hi:[1,1,0]
v_cvt_pk_f16_f32 v108, v108, v109
v_cvt_pk_f16_f32 v110, v110, v111
v_pk_fma_f16 v107, v106, v106, s48
v_mfma_f32_32x32x16_bf16 v[128:143], v[36:39], v[180:183], v[128:143]
v_fma_mix_f32 v234, v164, v164, v234 op_sel_hi:[1,1,0]
v_pk_fma_f16 v109, v108, v108, s48
v_fma_mix_f32 v234, v165, v165, v234 op_sel_hi:[1,1,0]
v_cvt_pkrtz_f16_f32 v99, v98, v99
v_and_b32_e64 v99, s49, v99
v_bfe_u32 v98, v99, 2, 14
v_lshrrev_b32_e64 v99, 18, v99
ds_read_u16 v98, v98
ds_read_u16 v99, v99
v_pk_fma_f16 v111, v110, v110, s48
v_pk_mul_f16 v107, v106, v107
v_pk_mul_f16 v109, v108, v109
v_fma_mix_f32 v234, v166, v166, v234 op_sel_hi:[1,1,0]
v_pk_mul_f16 v111, v110, v111
s_waitcnt lgkmcnt(6)
v_fma_mix_f32 v234, v167, v167, v234 op_sel_hi:[1,1,0]
v_exp_f16_sdwa v107, v107 dst_sel:WORD_0 dst_unused:UNUSED_PRESERVE src0_sel:WORD_0
v_cvt_pkrtz_f16_f32 v101, v100, v101
v_and_b32 v101, s49, v101
v_bfe_u32 v100, v101, 2, 14
v_lshrrev_b32_e64 v101, 18, v101
ds_read_u16 v100, v100
ds_read_u16 v101, v101
v_mfma_f32_32x32x16_bf16 v[112:127], v[16:19], v[184:187], v[112:127]
v_exp_f16_sdwa v109, v109 dst_sel:WORD_0 dst_unused:UNUSED_PRESERVE src0_sel:WORD_0
v_fma_mix_f32 v234, v168, v168, v234 op_sel_hi:[1,1,0]
v_exp_f16_sdwa v111, v111 dst_sel:WORD_0 dst_unused:UNUSED_PRESERVE src0_sel:WORD_0
v_fma_mix_f32 v234, v169, v169, v234 op_sel_hi:[1,1,0]
v_cvt_pkrtz_f16_f32 v103, v102, v103
v_and_b32_e64 v103, s49, v103
v_bfe_u32 v102, v103, 2, 14
v_lshrrev_b32_e64 v103, 18, v103
ds_read_u16 v102, v102
ds_read_u16 v103, v103
v_exp_f16_sdwa v107, v107 dst_sel:WORD_1 dst_unused:UNUSED_PRESERVE src0_sel:WORD_1
v_fma_mix_f32 v234, v170, v170, v234 op_sel_hi:[1,1,0]
v_exp_f16_sdwa v109, v109 dst_sel:WORD_1 dst_unused:UNUSED_PRESERVE src0_sel:WORD_1
s_waitcnt lgkmcnt(5)
v_fma_mix_f32 v234, v171, v171, v234 op_sel_hi:[1,1,0]
v_mfma_f32_32x32x16_bf16 v[128:143], v[40:43], v[184:187], v[128:143]
v_exp_f16_sdwa v111, v111 dst_sel:WORD_1 dst_unused:UNUSED_PRESERVE src0_sel:WORD_1
v_cvt_pkrtz_f16_f32 v105, v104, v105
v_and_b32 v105, s49, v105
v_bfe_u32 v104, v105, 2, 14
v_lshrrev_b32_e64 v105, 18, v105
ds_read_u16 v104, v104
ds_read_u16 v105, v105
v_pk_add_f16 v107, v107, 1.0 op_sel_hi:[1,0]
v_pk_add_f16 v109, v109, 1.0 op_sel_hi:[1,0]
v_pk_add_f16 v111, v111, 1.0 op_sel_hi:[1,0]
v_rcp_f16_sdwa v107, v107 dst_sel:WORD_0 dst_unused:UNUSED_PRESERVE src0_sel:WORD_0
v_mfma_f32_32x32x16_bf16 v[112:127], v[20:23], v[188:191], v[112:127]
v_rcp_f16_sdwa v109, v109 dst_sel:WORD_0 dst_unused:UNUSED_PRESERVE src0_sel:WORD_0
v_rcp_f16_sdwa v111, v111 dst_sel:WORD_0 dst_unused:UNUSED_PRESERVE src0_sel:WORD_0
v_rcp_f16_sdwa v107, v107 dst_sel:WORD_1 dst_unused:UNUSED_PRESERVE src0_sel:WORD_1
v_rcp_f16_sdwa v109, v109 dst_sel:WORD_1 dst_unused:UNUSED_PRESERVE src0_sel:WORD_1
v_mfma_f32_32x32x16_bf16 v[128:143], v[44:47], v[188:191], v[128:143]
v_rcp_f16_sdwa v111, v111 dst_sel:WORD_1 dst_unused:UNUSED_PRESERVE src0_sel:WORD_1
v_pk_mul_f16 v106, v106, v107
v_pk_mul_f16 v108, v108, v109
v_pk_mul_f16 v110, v110, v111
v_fma_mix_f32 v234, v106, v106, v234 op_sel_hi:[1,1,0]
s_nop 1
v_cvt_pkrtz_f16_f32 v113, v112, v113
v_fma_mix_f32 v234, v108, v108, v234 op_sel_hi:[1,1,0]
v_and_b32 v113, s49, v113
v_fma_mix_f32 v234, v110, v110, v234 op_sel_hi:[1,1,0]
v_bfe_u32 v112, v113, 2, 14
v_fma_mix_f32 v234, v106, v106, v234 op_sel:[1,1,0] op_sel_hi:[1,1,0]
v_lshrrev_b32_e64 v113, 18, v113
v_fma_mix_f32 v234, v108, v108, v234 op_sel:[1,1,0] op_sel_hi:[1,1,0]
ds_read_u16 v112, v112
v_fma_mix_f32 v234, v110, v110, v234 op_sel:[1,1,0] op_sel_hi:[1,1,0]
ds_read_u16 v113, v113
v_fma_mix_f32 v234, v96, v96, v234 op_sel_hi:[1,1,0]
v_cvt_pk_f16_f32 v124, v124, v125
v_fma_mix_f32 v234, v97, v97, v234 op_sel_hi:[1,1,0]
v_cvt_pk_f16_f32 v126, v126, v127
v_fma_mix_f32 v234, v98, v98, v234 op_sel_hi:[1,1,0]
v_pk_fma_f16 v125, v124, v124, s48
s_waitcnt lgkmcnt(2)
v_fma_mix_f32 v234, v99, v99, v234 op_sel_hi:[1,1,0]
v_cvt_pkrtz_f16_f32 v115, v114, v115
v_and_b32 v115, s49, v115
v_bfe_u32 v114, v115, 2, 14
v_lshrrev_b32_e64 v115, 18, v115
ds_read_u16 v114, v114
ds_read_u16 v115, v115
s_add_u32 s43, s81, 6592
v_add_u32_e64 v212, s43, v246
v_subrev_u32 v222, 65920, v212
v_min_u32_e64 v212, v212, v222
v_add_u32 v212, 90112, v212
v_add_u32_e64 v213, s43, v246
v_add_u32 v213, 6592, v213
v_subrev_u32 v222, 65920, v213
v_min_u32_e64 v213, v213, v222
v_add_u32 v213, 90112, v213
v_add_u32_e64 v214, s43, v246
v_add_u32 v214, 13184, v214
v_add_u32_e64 v222, 16, v214
v_bfi_b32 v214, 48, v222, v214
v_subrev_u32 v222, 65920, v214
v_min_u32_e64 v214, v214, v222
v_add_u32 v214, 90112, v214
v_add_u32_e64 v215, s43, v246
v_add_u32 v215, 19776, v215
v_add_u32_e64 v222, 16, v215
v_bfi_b32 v215, 48, v222, v215
v_subrev_u32 v222, 65920, v215
v_min_u32_e64 v215, v215, v222
v_add_u32 v215, 90112, v215
v_pk_fma_f16 v127, v126, v126, s48
v_fma_mix_f32 v234, v100, v100, v234 op_sel_hi:[1,1,0]
v_pk_mul_f16 v125, v124, v125
v_fma_mix_f32 v234, v101, v101, v234 op_sel_hi:[1,1,0]
v_pk_mul_f16 v127, v126, v127
v_cvt_pkrtz_f16_f32 v117, v116, v117
v_and_b32_e64 v117, s49, v117
v_bfe_u32 v116, v117, 2, 14
v_lshrrev_b32_e64 v117, 18, v117
ds_read_u16 v116, v116
ds_read_u16 v117, v117
v_exp_f16_sdwa v125, v125 dst_sel:WORD_0 dst_unused:UNUSED_PRESERVE src0_sel:WORD_0
v_fma_mix_f32 v234, v102, v102, v234 op_sel_hi:[1,1,0]
v_exp_f16_sdwa v127, v127 dst_sel:WORD_0 dst_unused:UNUSED_PRESERVE src0_sel:WORD_0
v_fma_mix_f32 v234, v103, v103, v234 op_sel_hi:[1,1,0]
v_cvt_pkrtz_f16_f32 v119, v118, v119
v_and_b32_e64 v119, s49, v119
v_bfe_u32 v118, v119, 2, 14
v_lshrrev_b32 v119, 18, v119
ds_read_u16 v118, v118
ds_read_u16 v119, v119
s_waitcnt vmcnt(1)
v_exp_f16_sdwa v125, v125 dst_sel:WORD_1 dst_unused:UNUSED_PRESERVE src0_sel:WORD_1
v_fma_mix_f32 v234, v104, v104, v234 op_sel_hi:[1,1,0]
v_cvt_pkrtz_f16_f32 v121, v120, v121
v_fma_mix_f32 v234, v105, v105, v234 op_sel_hi:[1,1,0]
v_and_b32_e64 v121, s49, v121
v_bfe_u32 v120, v121, 2, 14
v_lshrrev_b32_e64 v121, 18, v121
ds_read_u16 v120, v120
ds_read_b128 v[144:147], v212
ds_read_b64 v[196:197], v238
ds_read_b64 v[198:199], v239
ds_read_u16 v121, v121
ds_read_b128 v[148:151], v213
v_exp_f16_sdwa v127, v127 dst_sel:WORD_1 dst_unused:UNUSED_PRESERVE src0_sel:WORD_1
v_cvt_pkrtz_f16_f32 v123, v122, v123
v_and_b32_e64 v123, s49, v123
v_bfe_u32 v122, v123, 2, 14
v_lshrrev_b32 v123, 18, v123
ds_read_u16 v122, v122
s_waitcnt lgkmcnt(10)
ds_read_b128 v[152:155], v214
ds_read_b64 v[200:201], v238 offset:2400
ds_read_b64 v[202:203], v239 offset:2400
ds_read_b128 v[156:159], v215
ds_read_u16 v123, v123
v_pk_add_f16 v125, v125, 1.0 op_sel_hi:[1,0]
v_pk_add_f16 v127, v127, 1.0 op_sel_hi:[1,0]
v_rcp_f16_sdwa v125, v125 dst_sel:WORD_0 dst_unused:UNUSED_PRESERVE src0_sel:WORD_0
v_rcp_f16_sdwa v127, v127 dst_sel:WORD_0 dst_unused:UNUSED_PRESERVE src0_sel:WORD_0
v_rcp_f16_sdwa v125, v125 dst_sel:WORD_1 dst_unused:UNUSED_PRESERVE src0_sel:WORD_1
v_rcp_f16_sdwa v127, v127 dst_sel:WORD_1 dst_unused:UNUSED_PRESERVE src0_sel:WORD_1
v_pk_mul_f16 v124, v124, v125
s_waitcnt lgkmcnt(13)
ds_read_b64 v[204:205], v238 offset:4800
ds_read_b64 v[206:207], v239 offset:4800
v_pk_mul_f16 v126, v126, v127
v_fma_mix_f32 v235, v124, v124, v235 op_sel_hi:[1,1,0]
v_cvt_pkrtz_f16_f32 v129, v128, v129
v_fma_mix_f32 v235, v126, v126, v235 op_sel_hi:[1,1,0]
v_and_b32_e64 v129, s49, v129
v_fma_mix_f32 v235, v124, v124, v235 op_sel:[1,1,0] op_sel_hi:[1,1,0]
v_bfe_u32 v128, v129, 2, 14
s_waitcnt lgkmcnt(14)
ds_read_b128 v[160:163], v212 offset:16
s_waitcnt lgkmcnt(14)
ds_read_b64 v[208:209], v238 offset:200
s_waitcnt lgkmcnt(14)
ds_read_b64 v[210:211], v239 offset:200
s_waitcnt lgkmcnt(14)
ds_read_b128 v[164:167], v213 offset:16
s_waitcnt lgkmcnt(14)
v_mfma_f32_16x16x32_bf16 v[48:51], v[196:199], v[144:147], 0
v_fma_mix_f32 v235, v126, v126, v235 op_sel:[1,1,0] op_sel_hi:[1,1,0]
v_lshrrev_b32 v129, 18, v129
v_fma_mix_f32 v235, v112, v112, v235 op_sel_hi:[1,1,0]
v_cvt_pk_f16_f32 v138, v138, v139
v_fma_mix_f32 v235, v113, v113, v235 op_sel_hi:[1,1,0]
ds_read_u16 v128, v128
v_fma_mix_f32 v235, v114, v114, v235 op_sel_hi:[1,1,0]
v_cvt_pk_f16_f32 v140, v140, v141
s_waitcnt lgkmcnt(13)
v_mfma_f32_16x16x32_bf16 v[96:99], v[196:199], v[148:151], 0
ds_read_b128 v[168:171], v214 offset:16
v_fma_mix_f32 v235, v115, v115, v235 op_sel_hi:[1,1,0]
v_cvt_pk_f16_f32 v142, v142, v143
v_pk_fma_f16 v139, v138, v138, s48
v_fma_mix_f32 v235, v116, v116, v235 op_sel_hi:[1,1,0]
ds_read_u16 v129, v129
v_fma_mix_f32 v235, v117, v117, v235 op_sel_hi:[1,1,0]
v_pk_fma_f16 v141, v140, v140, s48
v_cvt_pkrtz_f16_f32 v131, v130, v131
v_and_b32_e64 v131, s49, v131
v_bfe_u32 v130, v131, 2, 14
v_lshrrev_b32_e64 v131, 18, v131
s_waitcnt lgkmcnt(14)
ds_read_u16 v130, v130
s_waitcnt lgkmcnt(14)
ds_read_b64 v[192:193], v238 offset:2600
s_waitcnt lgkmcnt(14)
ds_read_b64 v[194:195], v239 offset:2600
s_waitcnt lgkmcnt(14)
v_mfma_f32_16x16x32_bf16 v[48:51], v[200:203], v[148:151], v[48:51]
v_pk_fma_f16 v143, v142, v142, s48
v_mfma_f32_16x16x32_bf16 v[96:99], v[200:203], v[152:155], v[96:99]
ds_read_b128 v[172:175], v215 offset:16
v_pk_mul_f16 v139, v138, v139
v_pk_mul_f16 v141, v140, v141
v_fma_mix_f32 v235, v118, v118, v235 op_sel_hi:[1,1,0]
v_pk_mul_f16 v143, v142, v143
s_waitcnt lgkmcnt(14)
ds_read_u16 v131, v131
v_fma_mix_f32 v235, v119, v119, v235 op_sel_hi:[1,1,0]
v_exp_f16_sdwa v139, v139 dst_sel:WORD_0 dst_unused:UNUSED_PRESERVE src0_sel:WORD_0
v_cvt_pkrtz_f16_f32 v133, v132, v133
s_waitcnt lgkmcnt(12)
v_mfma_f32_16x16x32_bf16 v[48:51], v[204:207], v[152:155], v[48:51]
ds_read_b64 v[196:197], v238 offset:5000
ds_read_b64 v[198:199], v239 offset:5000
v_mfma_f32_16x16x32_bf16 v[96:99], v[204:207], v[156:159], v[96:99]
ds_read_b128 v[144:147], v212 offset:32
s_waitcnt lgkmcnt(14)
ds_read_b64 v[200:201], v238 offset:400
v_and_b32 v133, s49, v133
s_waitcnt lgkmcnt(13)
v_mfma_f32_16x16x32_bf16 v[52:55], v[208:211], v[160:163], 0
ds_read_b64 v[202:203], v239 offset:400
v_bfe_u32 v132, v133, 2, 14
s_waitcnt lgkmcnt(13)
v_mfma_f32_16x16x32_bf16 v[100:103], v[208:211], v[164:167], 0
ds_read_b128 v[148:151], v213 offset:32
v_lshrrev_b32_e64 v133, 18, v133
v_exp_f16_sdwa v141, v141 dst_sel:WORD_0 dst_unused:UNUSED_PRESERVE src0_sel:WORD_0
v_fma_mix_f32 v235, v120, v120, v235 op_sel_hi:[1,1,0]
ds_read_u16 v132, v132
v_fma_mix_f32 v235, v121, v121, v235 op_sel_hi:[1,1,0]
v_exp_f16_sdwa v143, v143 dst_sel:WORD_0 dst_unused:UNUSED_PRESERVE src0_sel:WORD_0
s_waitcnt lgkmcnt(14)
ds_read_u16 v133, v133
v_cvt_pkrtz_f16_f32 v135, v134, v135
v_and_b32 v135, s49, v135
v_bfe_u32 v134, v135, 2, 14
v_lshrrev_b32 v135, 18, v135
v_exp_f16_sdwa v139, v139 dst_sel:WORD_1 dst_unused:UNUSED_PRESERVE src0_sel:WORD_1
s_waitcnt lgkmcnt(14)
ds_read_u16 v134, v134
v_fma_mix_f32 v235, v122, v122, v235 op_sel_hi:[1,1,0]
v_exp_f16_sdwa v141, v141 dst_sel:WORD_1 dst_unused:UNUSED_PRESERVE src0_sel:WORD_1
v_fma_mix_f32 v235, v123, v123, v235 op_sel_hi:[1,1,0]
v_exp_f16_sdwa v143, v143 dst_sel:WORD_1 dst_unused:UNUSED_PRESERVE src0_sel:WORD_1
s_waitcnt lgkmcnt(14)
ds_read_u16 v135, v135
v_cvt_pkrtz_f16_f32 v137, v136, v137
v_and_b32_e64 v137, s49, v137
v_bfe_u32 v136, v137, 2, 14
s_waitcnt lgkmcnt(12)
v_mfma_f32_16x16x32_bf16 v[52:55], v[192:195], v[164:167], v[52:55]
ds_read_b128 v[152:155], v214 offset:32
ds_read_b64 v[204:205], v238 offset:2800
v_mfma_f32_16x16x32_bf16 v[100:103], v[192:195], v[168:171], v[100:103]
ds_read_b64 v[206:207], v239 offset:2800
v_lshrrev_b32_e64 v137, 18, v137
v_pk_add_f16 v139, v139, 1.0 op_sel_hi:[1,0]
v_pk_add_f16 v141, v141, 1.0 op_sel_hi:[1,0]
v_pk_add_f16 v143, v143, 1.0 op_sel_hi:[1,0]
v_rcp_f16_sdwa v139, v139 dst_sel:WORD_0 dst_unused:UNUSED_PRESERVE src0_sel:WORD_0
s_waitcnt lgkmcnt(14)
ds_read_u16 v136, v136
s_waitcnt lgkmcnt(14)
ds_read_b128 v[156:159], v215 offset:32
v_rcp_f16_sdwa v141, v141 dst_sel:WORD_0 dst_unused:UNUSED_PRESERVE src0_sel:WORD_0
s_waitcnt lgkmcnt(13)
v_mfma_f32_16x16x32_bf16 v[52:55], v[196:199], v[168:171], v[52:55]
ds_read_b64 v[208:209], v238 offset:5200
v_rcp_f16_sdwa v143, v143 dst_sel:WORD_0 dst_unused:UNUSED_PRESERVE src0_sel:WORD_0
v_mfma_f32_16x16x32_bf16 v[100:103], v[196:199], v[172:175], v[100:103]
ds_read_b64 v[210:211], v239 offset:5200
s_waitcnt lgkmcnt(14)
ds_read_b128 v[160:163], v212 offset:48
s_waitcnt lgkmcnt(14)
ds_read_b64 v[192:193], v238 offset:600
s_waitcnt lgkmcnt(14)
v_mfma_f32_16x16x32_bf16 v[56:59], v[200:203], v[144:147], 0
ds_read_b64 v[194:195], v239 offset:600
v_rcp_f16_sdwa v139, v139 dst_sel:WORD_1 dst_unused:UNUSED_PRESERVE src0_sel:WORD_1
s_waitcnt lgkmcnt(14)
v_mfma_f32_16x16x32_bf16 v[104:107], v[200:203], v[148:151], 0
v_rcp_f16_sdwa v141, v141 dst_sel:WORD_1 dst_unused:UNUSED_PRESERVE src0_sel:WORD_1
ds_read_u16 v137, v137
v_rcp_f16_sdwa v143, v143 dst_sel:WORD_1 dst_unused:UNUSED_PRESERVE src0_sel:WORD_1
v_pk_mul_f16 v138, v138, v139
v_pk_mul_f16 v140, v140, v141
v_pk_mul_f16 v142, v142, v143
v_fma_mix_f32 v235, v138, v138, v235 op_sel_hi:[1,1,0]
s_waitcnt lgkmcnt(14)
ds_read_b128 v[164:167], v213 offset:48
v_fma_mix_f32 v235, v140, v140, v235 op_sel_hi:[1,1,0]
s_nop 0
v_fma_mix_f32 v235, v142, v142, v235 op_sel_hi:[1,1,0]
s_nop 0
v_fma_mix_f32 v235, v138, v138, v235 op_sel:[1,1,0] op_sel_hi:[1,1,0]
s_nop 0
v_fma_mix_f32 v235, v140, v140, v235 op_sel:[1,1,0] op_sel_hi:[1,1,0]
s_nop 0
v_fma_mix_f32 v235, v142, v142, v235 op_sel:[1,1,0] op_sel_hi:[1,1,0]
s_waitcnt lgkmcnt(14)
ds_read_b128 v[168:171], v214 offset:48
v_fma_mix_f32 v235, v128, v128, v235 op_sel_hi:[1,1,0]
s_nop 0
v_fma_mix_f32 v235, v129, v129, v235 op_sel_hi:[1,1,0]
s_nop 0
v_fma_mix_f32 v235, v130, v130, v235 op_sel_hi:[1,1,0]
s_nop 0
v_fma_mix_f32 v235, v131, v131, v235 op_sel_hi:[1,1,0]
s_waitcnt lgkmcnt(14)
ds_read_b64 v[196:197], v238 offset:3000
s_waitcnt lgkmcnt(14)
ds_read_b64 v[198:199], v239 offset:3000
s_waitcnt lgkmcnt(14)
ds_read_b128 v[172:175], v215 offset:48
s_waitcnt lgkmcnt(13)
v_mfma_f32_16x16x32_bf16 v[56:59], v[204:207], v[148:151], v[56:59]
ds_read_b64 v[200:201], v238 offset:5400
v_fma_mix_f32 v235, v132, v132, v235 op_sel_hi:[1,1,0]
v_mfma_f32_16x16x32_bf16 v[104:107], v[204:207], v[152:155], v[104:107]
v_fma_mix_f32 v235, v133, v133, v235 op_sel_hi:[1,1,0]
ds_read_b64 v[202:203], v239 offset:5400
s_waitcnt lgkmcnt(14)
ds_read_b128 v[144:147], v212 offset:64
s_waitcnt lgkmcnt(14)
ds_read_b64 v[204:205], v238 offset:800
s_waitcnt lgkmcnt(13)
v_mfma_f32_16x16x32_bf16 v[56:59], v[208:211], v[152:155], v[56:59]
ds_read_b64 v[206:207], v239 offset:800
v_mfma_f32_16x16x32_bf16 v[104:107], v[208:211], v[156:159], v[104:107]
ds_read_b128 v[148:151], v213 offset:64
v_fma_mix_f32 v235, v134, v134, v235 op_sel_hi:[1,1,0]
s_waitcnt lgkmcnt(14)
ds_read_b128 v[152:155], v214 offset:64
v_fma_mix_f32 v235, v135, v135, v235 op_sel_hi:[1,1,0]
s_waitcnt lgkmcnt(13)
v_mfma_f32_16x16x32_bf16 v[60:63], v[192:195], v[160:163], 0
ds_read_b64 v[208:209], v238 offset:3200
ds_read_b64 v[210:211], v239 offset:3200
s_waitcnt lgkmcnt(13)
v_mfma_f32_16x16x32_bf16 v[108:111], v[192:195], v[164:167], 0
ds_read_b128 v[156:159], v215 offset:64
ds_read_b64 v[192:193], v238 offset:5600
s_waitcnt lgkmcnt(14)
ds_read_b64 v[194:195], v239 offset:5600
s_waitcnt lgkmcnt(13)
v_mfma_f32_16x16x32_bf16 v[60:63], v[196:199], v[164:167], v[60:63]
ds_read_b128 v[160:163], v212 offset:80
v_fma_mix_f32 v235, v136, v136, v235 op_sel_hi:[1,1,0]
v_mfma_f32_16x16x32_bf16 v[108:111], v[196:199], v[168:171], v[108:111]
ds_read_b64 v[196:197], v238 offset:1000
s_waitcnt lgkmcnt(14)
ds_read_b64 v[198:199], v239 offset:1000
v_fma_mix_f32 v235, v137, v137, v235 op_sel_hi:[1,1,0]
s_waitcnt lgkmcnt(13)
v_mfma_f32_16x16x32_bf16 v[60:63], v[200:203], v[168:171], v[60:63]
ds_read_b128 v[164:167], v213 offset:80
v_mfma_f32_16x16x32_bf16 v[108:111], v[200:203], v[172:175], v[108:111]
ds_read_b128 v[168:171], v214 offset:80
s_waitcnt lgkmcnt(14)
ds_read_b64 v[200:201], v238 offset:3400
s_waitcnt lgkmcnt(13)
v_mfma_f32_16x16x32_bf16 v[64:67], v[204:207], v[144:147], 0
ds_read_b64 v[202:203], v239 offset:3400
s_waitcnt lgkmcnt(13)
v_mfma_f32_16x16x32_bf16 v[112:115], v[204:207], v[148:151], 0
ds_read_b128 v[172:175], v215 offset:80
ds_read_b64 v[204:205], v238 offset:5800
s_waitcnt lgkmcnt(14)
ds_read_b64 v[206:207], v239 offset:5800
s_waitcnt lgkmcnt(13)
v_mfma_f32_16x16x32_bf16 v[64:67], v[208:211], v[148:151], v[64:67]
ds_read_b128 v[144:147], v212 offset:96
v_mfma_f32_16x16x32_bf16 v[112:115], v[208:211], v[152:155], v[112:115]
ds_read_b64 v[208:209], v238 offset:1200
s_waitcnt lgkmcnt(14)
ds_read_b64 v[210:211], v239 offset:1200
s_waitcnt lgkmcnt(13)
v_mfma_f32_16x16x32_bf16 v[64:67], v[192:195], v[152:155], v[64:67]
ds_read_b128 v[148:151], v213 offset:96
v_mfma_f32_16x16x32_bf16 v[112:115], v[192:195], v[156:159], v[112:115]
ds_read_b128 v[152:155], v214 offset:96
s_waitcnt lgkmcnt(14)
ds_read_b64 v[192:193], v238 offset:3600
s_waitcnt lgkmcnt(13)
v_mfma_f32_16x16x32_bf16 v[68:71], v[196:199], v[160:163], 0
ds_read_b64 v[194:195], v239 offset:3600
s_waitcnt lgkmcnt(13)
v_mfma_f32_16x16x32_bf16 v[116:119], v[196:199], v[164:167], 0
ds_read_b128 v[156:159], v215 offset:96
ds_read_b64 v[196:197], v238 offset:6000
s_waitcnt lgkmcnt(14)
ds_read_b64 v[198:199], v239 offset:6000
s_waitcnt lgkmcnt(13)
v_mfma_f32_16x16x32_bf16 v[68:71], v[200:203], v[164:167], v[68:71]
ds_read_b128 v[160:163], v212 offset:112
v_mfma_f32_16x16x32_bf16 v[116:119], v[200:203], v[168:171], v[116:119]
ds_read_b64 v[200:201], v238 offset:1400
s_waitcnt lgkmcnt(14)
ds_read_b64 v[202:203], v239 offset:1400
s_waitcnt lgkmcnt(13)
v_mfma_f32_16x16x32_bf16 v[68:71], v[204:207], v[168:171], v[68:71]
ds_read_b128 v[164:167], v213 offset:112
v_mfma_f32_16x16x32_bf16 v[116:119], v[204:207], v[172:175], v[116:119]
s_getpc_b64 s[74:75]
Lcq4:
s_lshl_b32 s43, s40, 10
s_add_u32 s43, s43, 6144
s_min_u32 s43, s43, Lend-Lcq4-1024
s_add_u32 s74, s74, s43
s_addc_u32 s75, s75, 0
s_sub_u32 s74, s74, 16384
s_subb_u32 s75, s75, 0
s_mov_b32 m0, 163840
s_nop 0
global_load_lds_dword v250, s[74:75]
ds_read_b128 v[168:171], v214 offset:112
s_waitcnt lgkmcnt(14)
ds_read_b64 v[204:205], v238 offset:3800
s_waitcnt lgkmcnt(13)
v_mfma_f32_16x16x32_bf16 v[72:75], v[208:211], v[144:147], 0
ds_read_b64 v[206:207], v239 offset:3800
s_waitcnt lgkmcnt(13)
v_mfma_f32_16x16x32_bf16 v[120:123], v[208:211], v[148:151], 0
ds_read_b128 v[172:175], v215 offset:112
ds_read_b64 v[208:209], v238 offset:6200
s_waitcnt lgkmcnt(14)
ds_read_b64 v[210:211], v239 offset:6200
s_waitcnt lgkmcnt(13)
v_mfma_f32_16x16x32_bf16 v[72:75], v[192:195], v[148:151], v[72:75]
ds_read_b128 v[144:147], v212 offset:128
v_mfma_f32_16x16x32_bf16 v[120:123], v[192:195], v[152:155], v[120:123]
ds_read_b64 v[192:193], v238 offset:1600
s_waitcnt lgkmcnt(14)
ds_read_b64 v[194:195], v239 offset:1600
s_waitcnt lgkmcnt(13)
v_mfma_f32_16x16x32_bf16 v[72:75], v[196:199], v[152:155], v[72:75]
ds_read_b128 v[148:151], v213 offset:128
v_mfma_f32_16x16x32_bf16 v[120:123], v[196:199], v[156:159], v[120:123]
ds_read_b128 v[152:155], v214 offset:128
s_waitcnt lgkmcnt(14)
ds_read_b64 v[196:197], v238 offset:4000
s_waitcnt lgkmcnt(13)
v_mfma_f32_16x16x32_bf16 v[76:79], v[200:203], v[160:163], 0
ds_read_b64 v[198:199], v239 offset:4000
s_waitcnt lgkmcnt(13)
v_mfma_f32_16x16x32_bf16 v[124:127], v[200:203], v[164:167], 0
ds_read_b128 v[156:159], v215 offset:128
ds_read_b64 v[200:201], v238 offset:6400
s_waitcnt lgkmcnt(14)
ds_read_b64 v[202:203], v239 offset:6400
s_waitcnt lgkmcnt(13)
v_mfma_f32_16x16x32_bf16 v[76:79], v[204:207], v[164:167], v[76:79]
ds_read_b128 v[160:163], v212 offset:144
v_mfma_f32_16x16x32_bf16 v[124:127], v[204:207], v[168:171], v[124:127]
ds_read_b64 v[204:205], v238 offset:1800
s_waitcnt lgkmcnt(14)
ds_read_b64 v[206:207], v239 offset:1800
s_waitcnt lgkmcnt(13)
v_mfma_f32_16x16x32_bf16 v[76:79], v[208:211], v[168:171], v[76:79]
ds_read_b128 v[164:167], v213 offset:144
v_mfma_f32_16x16x32_bf16 v[124:127], v[208:211], v[172:175], v[124:127]
ds_read_b128 v[168:171], v214 offset:144
s_waitcnt lgkmcnt(14)
ds_read_b64 v[208:209], v238 offset:4200
s_waitcnt lgkmcnt(13)
v_mfma_f32_16x16x32_bf16 v[80:83], v[192:195], v[144:147], 0
ds_read_b64 v[210:211], v239 offset:4200
s_waitcnt lgkmcnt(13)
v_mfma_f32_16x16x32_bf16 v[128:131], v[192:195], v[148:151], 0
ds_read_b128 v[172:175], v215 offset:144
ds_read_b64 v[192:193], v238 offset:6600
s_waitcnt lgkmcnt(14)
ds_read_b64 v[194:195], v239 offset:6600
s_waitcnt lgkmcnt(13)
v_mfma_f32_16x16x32_bf16 v[80:83], v[196:199], v[148:151], v[80:83]
ds_read_b128 v[144:147], v212 offset:160
v_mfma_f32_16x16x32_bf16 v[128:131], v[196:199], v[152:155], v[128:131]
ds_read_b64 v[196:197], v238 offset:2000
s_waitcnt lgkmcnt(14)
ds_read_b64 v[198:199], v239 offset:2000
s_waitcnt lgkmcnt(13)
v_mfma_f32_16x16x32_bf16 v[80:83], v[200:203], v[152:155], v[80:83]
ds_read_b128 v[148:151], v213 offset:160
v_mfma_f32_16x16x32_bf16 v[128:131], v[200:203], v[156:159], v[128:131]
ds_read_b128 v[152:155], v214 offset:160
s_waitcnt lgkmcnt(14)
ds_read_b64 v[200:201], v238 offset:4400
s_waitcnt lgkmcnt(13)
v_mfma_f32_16x16x32_bf16 v[84:87], v[204:207], v[160:163], 0
ds_read_b64 v[202:203], v239 offset:4400
s_waitcnt lgkmcnt(13)
v_mfma_f32_16x16x32_bf16 v[132:135], v[204:207], v[164:167], 0
ds_read_b128 v[156:159], v215 offset:160
ds_read_b64 v[204:205], v238 offset:6800
s_waitcnt lgkmcnt(14)
ds_read_b64 v[206:207], v239 offset:6800
s_waitcnt lgkmcnt(13)
v_mfma_f32_16x16x32_bf16 v[84:87], v[208:211], v[164:167], v[84:87]
ds_read_b128 v[160:163], v212 offset:176
v_mfma_f32_16x16x32_bf16 v[132:135], v[208:211], v[168:171], v[132:135]
ds_read_b64 v[208:209], v238 offset:2200
s_waitcnt lgkmcnt(14)
ds_read_b64 v[210:211], v239 offset:2200
s_waitcnt lgkmcnt(13)
v_mfma_f32_16x16x32_bf16 v[84:87], v[192:195], v[168:171], v[84:87]
ds_read_b128 v[164:167], v213 offset:176
v_mfma_f32_16x16x32_bf16 v[132:135], v[192:195], v[172:175], v[132:135]
ds_read_b128 v[168:171], v214 offset:176
s_waitcnt lgkmcnt(14)
ds_read_b64 v[192:193], v238 offset:4600
s_waitcnt lgkmcnt(13)
v_mfma_f32_16x16x32_bf16 v[88:91], v[196:199], v[144:147], 0
ds_read_b64 v[194:195], v239 offset:4600
s_waitcnt lgkmcnt(13)
v_mfma_f32_16x16x32_bf16 v[136:139], v[196:199], v[148:151], 0
ds_read_b128 v[172:175], v215 offset:176
ds_read_b64 v[196:197], v238 offset:7000
s_waitcnt lgkmcnt(14)
ds_read_b64 v[198:199], v239 offset:7000
s_waitcnt lgkmcnt(13)
v_mfma_f32_16x16x32_bf16 v[88:91], v[200:203], v[148:151], v[88:91]
ds_read_b128 v[176:179], v250
v_mfma_f32_16x16x32_bf16 v[136:139], v[200:203], v[152:155], v[136:139]
s_waitcnt lgkmcnt(11)
v_mfma_f32_16x16x32_bf16 v[88:91], v[204:207], v[152:155], v[88:91]
v_mfma_f32_16x16x32_bf16 v[136:139], v[204:207], v[156:159], v[136:139]
s_waitcnt lgkmcnt(8)
v_mfma_f32_16x16x32_bf16 v[92:95], v[208:211], v[160:163], 0
s_waitcnt lgkmcnt(7)
v_mfma_f32_16x16x32_bf16 v[140:143], v[208:211], v[164:167], 0
s_waitcnt lgkmcnt(4)
v_mfma_f32_16x16x32_bf16 v[92:95], v[192:195], v[164:167], v[92:95]
v_mfma_f32_16x16x32_bf16 v[140:143], v[192:195], v[168:171], v[140:143]
s_waitcnt lgkmcnt(1)
v_mfma_f32_16x16x32_bf16 v[92:95], v[196:199], v[168:171], v[92:95]
ds_read_b128 v[180:183], v250 offset:1024
v_mfma_f32_16x16x32_bf16 v[140:143], v[196:199], v[172:175], v[140:143]
v_mov_b32 v223, 1
v_add_u32 v222, s83, v247
s_waitcnt lgkmcnt(0)
s_nop 6
s_mov_b64 exec, 1
ds_add_u32 v222, v223 offset:24
s_mov_b64 exec, -1
v_pk_mul_f32 v[242:243], v[48:49], v[48:49]
v_pk_add_f32 v[240:241], v[48:49], v[50:51]
v_pk_fma_f32 v[242:243], v[50:51], v[50:51], v[242:243]
v_pk_mul_f32 v[218:219], v[96:97], v[96:97]
v_pk_add_f32 v[216:217], v[96:97], v[98:99]
v_pk_fma_f32 v[218:219], v[98:99], v[98:99], v[218:219]
v_pk_fma_f32 v[242:243], v[52:53], v[52:53], v[242:243]
v_pk_add_f32 v[240:241], v[240:241], v[52:53]
v_pk_fma_f32 v[242:243], v[54:55], v[54:55], v[242:243]
v_pk_add_f32 v[240:241], v[240:241], v[54:55]
v_pk_fma_f32 v[218:219], v[100:101], v[100:101], v[218:219]
v_pk_add_f32 v[216:217], v[216:217], v[100:101]
v_pk_fma_f32 v[218:219], v[102:103], v[102:103], v[218:219]
v_pk_add_f32 v[216:217], v[216:217], v[102:103]
v_pk_fma_f32 v[242:243], v[56:57], v[56:57], v[242:243]
v_pk_add_f32 v[240:241], v[240:241], v[56:57]
v_pk_fma_f32 v[242:243], v[58:59], v[58:59], v[242:243]
v_pk_add_f32 v[240:241], v[240:241], v[58:59]
v_pk_fma_f32 v[218:219], v[104:105], v[104:105], v[218:219]
v_pk_add_f32 v[216:217], v[216:217], v[104:105]
v_pk_fma_f32 v[218:219], v[106:107], v[106:107], v[218:219]
v_pk_add_f32 v[216:217], v[216:217], v[106:107]
v_pk_fma_f32 v[242:243], v[60:61], v[60:61], v[242:243]
v_pk_add_f32 v[240:241], v[240:241], v[60:61]
v_pk_fma_f32 v[242:243], v[62:63], v[62:63], v[242:243]
v_pk_add_f32 v[240:241], v[240:241], v[62:63]
v_pk_fma_f32 v[218:219], v[108:109], v[108:109], v[218:219]
v_pk_add_f32 v[216:217], v[216:217], v[108:109]
v_pk_fma_f32 v[218:219], v[110:111], v[110:111], v[218:219]
v_pk_add_f32 v[216:217], v[216:217], v[110:111]
v_pk_fma_f32 v[242:243], v[64:65], v[64:65], v[242:243]
v_pk_add_f32 v[240:241], v[240:241], v[64:65]
v_pk_fma_f32 v[242:243], v[66:67], v[66:67], v[242:243]
v_pk_add_f32 v[240:241], v[240:241], v[66:67]
v_pk_fma_f32 v[218:219], v[112:113], v[112:113], v[218:219]
v_pk_add_f32 v[216:217], v[216:217], v[112:113]
v_pk_fma_f32 v[218:219], v[114:115], v[114:115], v[218:219]
v_pk_add_f32 v[216:217], v[216:217], v[114:115]
v_pk_fma_f32 v[242:243], v[68:69], v[68:69], v[242:243]
v_pk_add_f32 v[240:241], v[240:241], v[68:69]
v_pk_fma_f32 v[242:243], v[70:71], v[70:71], v[242:243]
v_pk_add_f32 v[240:241], v[240:241], v[70:71]
v_pk_fma_f32 v[218:219], v[116:117], v[116:117], v[218:219]
v_pk_add_f32 v[216:217], v[216:217], v[116:117]
v_pk_fma_f32 v[218:219], v[118:119], v[118:119], v[218:219]
v_pk_add_f32 v[216:217], v[216:217], v[118:119]
v_pk_fma_f32 v[242:243], v[72:73], v[72:73], v[242:243]
v_pk_add_f32 v[240:241], v[240:241], v[72:73]
v_pk_fma_f32 v[242:243], v[74:75], v[74:75], v[242:243]
v_pk_add_f32 v[240:241], v[240:241], v[74:75]
v_pk_fma_f32 v[218:219], v[120:121], v[120:121], v[218:219]
v_pk_add_f32 v[216:217], v[216:217], v[120:121]
v_pk_fma_f32 v[218:219], v[122:123], v[122:123], v[218:219]
v_pk_add_f32 v[216:217], v[216:217], v[122:123]
v_pk_fma_f32 v[242:243], v[76:77], v[76:77], v[242:243]
v_pk_add_f32 v[240:241], v[240:241], v[76:77]
v_pk_fma_f32 v[242:243], v[78:79], v[78:79], v[242:243]
v_pk_add_f32 v[240:241], v[240:241], v[78:79]
v_pk_fma_f32 v[218:219], v[124:125], v[124:125], v[218:219]
v_pk_add_f32 v[216:217], v[216:217], v[124:125]
v_pk_fma_f32 v[218:219], v[126:127], v[126:127], v[218:219]
v_pk_add_f32 v[216:217], v[216:217], v[126:127]
v_pk_fma_f32 v[242:243], v[80:81], v[80:81], v[242:243]
v_pk_add_f32 v[240:241], v[240:241], v[80:81]
v_pk_fma_f32 v[242:243], v[82:83], v[82:83], v[242:243]
v_pk_add_f32 v[240:241], v[240:241], v[82:83]
v_pk_fma_f32 v[218:219], v[128:129], v[128:129], v[218:219]
v_pk_add_f32 v[216:217], v[216:217], v[128:129]
v_pk_fma_f32 v[218:219], v[130:131], v[130:131], v[218:219]
v_pk_add_f32 v[216:217], v[216:217], v[130:131]
v_pk_fma_f32 v[242:243], v[84:85], v[84:85], v[242:243]
v_pk_add_f32 v[240:241], v[240:241], v[84:85]
v_pk_fma_f32 v[242:243], v[86:87], v[86:87], v[242:243]
v_pk_add_f32 v[240:241], v[240:241], v[86:87]
v_pk_fma_f32 v[218:219], v[132:133], v[132:133], v[218:219]
v_pk_add_f32 v[216:217], v[216:217], v[132:133]
v_pk_fma_f32 v[218:219], v[134:135], v[134:135], v[218:219]
v_pk_add_f32 v[216:217], v[216:217], v[134:135]
v_pk_fma_f32 v[242:243], v[88:89], v[88:89], v[242:243]
v_pk_add_f32 v[240:241], v[240:241], v[88:89]
v_pk_fma_f32 v[242:243], v[90:91], v[90:91], v[242:243]
v_pk_add_f32 v[240:241], v[240:241], v[90:91]
v_pk_fma_f32 v[218:219], v[136:137], v[136:137], v[218:219]
v_pk_add_f32 v[216:217], v[216:217], v[136:137]
v_pk_fma_f32 v[218:219], v[138:139], v[138:139], v[218:219]
v_pk_add_f32 v[216:217], v[216:217], v[138:139]
v_pk_fma_f32 v[242:243], v[92:93], v[92:93], v[242:243]
v_pk_add_f32 v[240:241], v[240:241], v[92:93]
v_pk_fma_f32 v[242:243], v[94:95], v[94:95], v[242:243]
v_pk_add_f32 v[240:241], v[240:241], v[94:95]
v_pk_fma_f32 v[218:219], v[140:141], v[140:141], v[218:219]
v_pk_add_f32 v[216:217], v[216:217], v[140:141]
v_pk_fma_f32 v[218:219], v[142:143], v[142:143], v[218:219]
v_pk_add_f32 v[216:217], v[216:217], v[142:143]
v_add_f32 v218, v218, v219
v_add_f32 v216, v216, v217
s_nop 1
v_permlane32_swap_b32 v216, v218
v_add_f32_e64 v216, v216, v218
v_mul_f32 v216, 1009429163, v216
v_mov_b32_e64 v218, v216
s_nop 1
v_permlane32_swap_b32 v216, v218
v_fma_f32 v218, -v216, v216, v218
v_max_f32_e64 v218, 0, v218
v_add_f32 v218, 925353388, v218
v_rsq_f32 v218, v218
v_add_f32 v240, v240, v241
v_mul_f32 v220, 3203396952, v218
v_mul_f32 v221, 3203396952, v218
v_mul_f32 v218, v216, v220
v_mul_f32 v219, v216, v220
v_add_f32 v242, v242, v243
s_nop 1
v_permlane32_swap_b32 v240, v242
v_add_f32 v240, v240, v242
v_mul_f32 v240, 1009429163, v240
v_mov_b32_e64 v242, v240
s_nop 1
v_permlane32_swap_b32 v240, v242
v_fma_f32 v242, -v240, v240, v242
v_max_f32_e64 v242, 0, v242
v_add_f32 v242, 925353388, v242
v_rsq_f32_e64 v242, v242
v_pk_fma_f32 v[96:97], v[96:97], v[220:221], v[218:219] neg_lo:[0,0,1] neg_hi:[0,0,1]
v_mul_f32 v244, 3203396952, v242
v_mul_f32 v245, 3203396952, v242
v_mul_f32 v242, v240, v244
v_mul_f32 v243, v240, v244
v_pk_fma_f32 v[48:49], v[48:49], v[244:245], v[242:243] neg_lo:[0,0,1] neg_hi:[0,0,1]
v_pk_fma_f32 v[50:51], v[50:51], v[244:245], v[242:243] neg_lo:[0,0,1] neg_hi:[0,0,1]
v_cvt_pk_bf16_f32 v48, v48, v49
v_cvt_pk_bf16_f32 v49, v50, v51
v_pk_fma_f32 v[52:53], v[52:53], v[244:245], v[242:243] neg_lo:[0,0,1] neg_hi:[0,0,1]
v_pk_fma_f32 v[54:55], v[54:55], v[244:245], v[242:243] neg_lo:[0,0,1] neg_hi:[0,0,1]
v_cvt_pk_bf16_f32 v50, v52, v53
v_cvt_pk_bf16_f32 v51, v54, v55
v_pk_fma_f32 v[56:57], v[56:57], v[244:245], v[242:243] neg_lo:[0,0,1] neg_hi:[0,0,1]
v_pk_fma_f32 v[58:59], v[58:59], v[244:245], v[242:243] neg_lo:[0,0,1] neg_hi:[0,0,1]
v_cvt_pk_bf16_f32 v52, v56, v57
v_cvt_pk_bf16_f32 v53, v58, v59
v_pk_fma_f32 v[60:61], v[60:61], v[244:245], v[242:243] neg_lo:[0,0,1] neg_hi:[0,0,1]
v_pk_fma_f32 v[62:63], v[62:63], v[244:245], v[242:243] neg_lo:[0,0,1] neg_hi:[0,0,1]
v_cvt_pk_bf16_f32 v54, v60, v61
v_cvt_pk_bf16_f32 v55, v62, v63
v_pk_fma_f32 v[64:65], v[64:65], v[244:245], v[242:243] neg_lo:[0,0,1] neg_hi:[0,0,1]
v_pk_fma_f32 v[66:67], v[66:67], v[244:245], v[242:243] neg_lo:[0,0,1] neg_hi:[0,0,1]
v_cvt_pk_bf16_f32 v56, v64, v65
v_cvt_pk_bf16_f32 v57, v66, v67
v_pk_fma_f32 v[68:69], v[68:69], v[244:245], v[242:243] neg_lo:[0,0,1] neg_hi:[0,0,1]
v_pk_fma_f32 v[70:71], v[70:71], v[244:245], v[242:243] neg_lo:[0,0,1] neg_hi:[0,0,1]
v_cvt_pk_bf16_f32 v58, v68, v69
v_cvt_pk_bf16_f32 v59, v70, v71
v_pk_fma_f32 v[72:73], v[72:73], v[244:245], v[242:243] neg_lo:[0,0,1] neg_hi:[0,0,1]
v_pk_fma_f32 v[74:75], v[74:75], v[244:245], v[242:243] neg_lo:[0,0,1] neg_hi:[0,0,1]
v_cvt_pk_bf16_f32 v60, v72, v73
v_cvt_pk_bf16_f32 v61, v74, v75
v_pk_fma_f32 v[76:77], v[76:77], v[244:245], v[242:243] neg_lo:[0,0,1] neg_hi:[0,0,1]
v_pk_fma_f32 v[78:79], v[78:79], v[244:245], v[242:243] neg_lo:[0,0,1] neg_hi:[0,0,1]
v_cvt_pk_bf16_f32 v62, v76, v77
v_cvt_pk_bf16_f32 v63, v78, v79
v_pk_fma_f32 v[80:81], v[80:81], v[244:245], v[242:243] neg_lo:[0,0,1] neg_hi:[0,0,1]
v_pk_fma_f32 v[82:83], v[82:83], v[244:245], v[242:243] neg_lo:[0,0,1] neg_hi:[0,0,1]
v_cvt_pk_bf16_f32 v64, v80, v81
v_cvt_pk_bf16_f32 v65, v82, v83
v_pk_fma_f32 v[84:85], v[84:85], v[244:245], v[242:243] neg_lo:[0,0,1] neg_hi:[0,0,1]
v_pk_fma_f32 v[86:87], v[86:87], v[244:245], v[242:243] neg_lo:[0,0,1] neg_hi:[0,0,1]
v_cvt_pk_bf16_f32 v66, v84, v85
v_cvt_pk_bf16_f32 v67, v86, v87
v_pk_fma_f32 v[88:89], v[88:89], v[244:245], v[242:243] neg_lo:[0,0,1] neg_hi:[0,0,1]
v_pk_fma_f32 v[90:91], v[90:91], v[244:245], v[242:243] neg_lo:[0,0,1] neg_hi:[0,0,1]
v_cvt_pk_bf16_f32 v68, v88, v89
v_cvt_pk_bf16_f32 v69, v90, v91
v_pk_fma_f32 v[92:93], v[92:93], v[244:245], v[242:243] neg_lo:[0,0,1] neg_hi:[0,0,1]
v_pk_fma_f32 v[94:95], v[94:95], v[244:245], v[242:243] neg_lo:[0,0,1] neg_hi:[0,0,1]
v_cvt_pk_bf16_f32 v70, v92, v93
v_cvt_pk_bf16_f32 v71, v94, v95
v_cvt_pk_bf16_f32 v72, v96, v97
v_pk_fma_f32 v[98:99], v[98:99], v[220:221], v[218:219] neg_lo:[0,0,1] neg_hi:[0,0,1]
v_pk_fma_f32 v[100:101], v[100:101], v[220:221], v[218:219] neg_lo:[0,0,1] neg_hi:[0,0,1]
v_cvt_pk_bf16_f32 v73, v98, v99
v_cvt_pk_bf16_f32 v74, v100, v101
v_pk_fma_f32 v[102:103], v[102:103], v[220:221], v[218:219] neg_lo:[0,0,1] neg_hi:[0,0,1]
v_pk_fma_f32 v[104:105], v[104:105], v[220:221], v[218:219] neg_lo:[0,0,1] neg_hi:[0,0,1]
v_cvt_pk_bf16_f32 v75, v102, v103
v_cvt_pk_bf16_f32 v76, v104, v105
v_pk_fma_f32 v[106:107], v[106:107], v[220:221], v[218:219] neg_lo:[0,0,1] neg_hi:[0,0,1]
v_pk_fma_f32 v[108:109], v[108:109], v[220:221], v[218:219] neg_lo:[0,0,1] neg_hi:[0,0,1]
v_cvt_pk_bf16_f32 v77, v106, v107
v_cvt_pk_bf16_f32 v78, v108, v109
v_pk_fma_f32 v[110:111], v[110:111], v[220:221], v[218:219] neg_lo:[0,0,1] neg_hi:[0,0,1]
v_pk_fma_f32 v[112:113], v[112:113], v[220:221], v[218:219] neg_lo:[0,0,1] neg_hi:[0,0,1]
v_cvt_pk_bf16_f32 v79, v110, v111
v_cvt_pk_bf16_f32 v80, v112, v113
v_pk_fma_f32 v[114:115], v[114:115], v[220:221], v[218:219] neg_lo:[0,0,1] neg_hi:[0,0,1]
v_pk_fma_f32 v[116:117], v[116:117], v[220:221], v[218:219] neg_lo:[0,0,1] neg_hi:[0,0,1]
v_cvt_pk_bf16_f32 v81, v114, v115
v_cvt_pk_bf16_f32 v82, v116, v117
v_pk_fma_f32 v[118:119], v[118:119], v[220:221], v[218:219] neg_lo:[0,0,1] neg_hi:[0,0,1]
v_pk_fma_f32 v[120:121], v[120:121], v[220:221], v[218:219] neg_lo:[0,0,1] neg_hi:[0,0,1]
v_cvt_pk_bf16_f32 v83, v118, v119
v_cvt_pk_bf16_f32 v84, v120, v121
v_pk_fma_f32 v[122:123], v[122:123], v[220:221], v[218:219] neg_lo:[0,0,1] neg_hi:[0,0,1]
v_pk_fma_f32 v[124:125], v[124:125], v[220:221], v[218:219] neg_lo:[0,0,1] neg_hi:[0,0,1]
v_cvt_pk_bf16_f32 v85, v122, v123
v_cvt_pk_bf16_f32 v86, v124, v125
v_pk_fma_f32 v[126:127], v[126:127], v[220:221], v[218:219] neg_lo:[0,0,1] neg_hi:[0,0,1]
v_pk_fma_f32 v[128:129], v[128:129], v[220:221], v[218:219] neg_lo:[0,0,1] neg_hi:[0,0,1]
v_cvt_pk_bf16_f32 v87, v126, v127
v_cvt_pk_bf16_f32 v88, v128, v129
v_pk_fma_f32 v[130:131], v[130:131], v[220:221], v[218:219] neg_lo:[0,0,1] neg_hi:[0,0,1]
v_pk_fma_f32 v[132:133], v[132:133], v[220:221], v[218:219] neg_lo:[0,0,1] neg_hi:[0,0,1]
v_cvt_pk_bf16_f32 v89, v130, v131
v_cvt_pk_bf16_f32 v90, v132, v133
v_pk_fma_f32 v[134:135], v[134:135], v[220:221], v[218:219] neg_lo:[0,0,1] neg_hi:[0,0,1]
ds_read_b128 v[184:187], v250 offset:2048
v_cvt_pk_bf16_f32 v91, v134, v135
v_pk_fma_f32 v[136:137], v[136:137], v[220:221], v[218:219] neg_lo:[0,0,1] neg_hi:[0,0,1]
v_pk_fma_f32 v[138:139], v[138:139], v[220:221], v[218:219] neg_lo:[0,0,1] neg_hi:[0,0,1]
v_cvt_pk_bf16_f32 v92, v136, v137
v_cvt_pk_bf16_f32 v93, v138, v139
v_pk_fma_f32 v[140:141], v[140:141], v[220:221], v[218:219] neg_lo:[0,0,1] neg_hi:[0,0,1]
v_pk_fma_f32 v[142:143], v[142:143], v[220:221], v[218:219] neg_lo:[0,0,1] neg_hi:[0,0,1]
v_cvt_pk_bf16_f32 v94, v140, v141
v_cvt_pk_bf16_f32 v95, v142, v143
v_cndmask_b32 v216, 0, v255, s[50:51]
v_and_b32 v216, 1006648320, v216
v_cndmask_b32 v217, 0, v255, s[52:53]
v_and_b32 v217, 1006648320, v217
v_cndmask_b32 v218, 0, v255, s[54:55]
v_and_b32 v218, 1006648320, v218
v_cndmask_b32 v219, 0, v255, s[56:57]
v_and_b32 v219, 1006648320, v219
v_cndmask_b32 v220, 0, v255, s[58:59]
v_and_b32 v220, 1006648320, v220
v_cndmask_b32 v221, 0, v255, s[60:61]
v_and_b32 v221, 1006648320, v221
v_cndmask_b32 v222, 0, v255, s[62:63]
v_and_b32 v222, 1006648320, v222
v_cndmask_b32 v223, 0, v255, s[64:65]
v_and_b32 v223, 1006648320, v223
v_mfma_f32_32x32x16_bf16 v[144:159], v[48:51], v[176:179], 0
s_cmp_lt_u32 s40, 4
s_cbranch_scc0 Lbk
s_setprio 2
Lbk:
ds_read_b128 v[188:191], v250 offset:3072
v_mfma_f32_32x32x16_bf16 v[160:175], v[72:75], v[176:179], 0
ds_read_b128 v[176:179], v250 offset:4096
v_mfma_f32_32x32x16_bf16 v[144:159], v[52:55], v[180:183], v[144:159]
v_mfma_f32_32x32x16_bf16 v[160:175], v[76:79], v[180:183], v[160:175]
ds_read_b128 v[180:183], v250 offset:5120
s_waitcnt lgkmcnt(3)
v_mfma_f32_32x32x16_bf16 v[144:159], v[56:59], v[184:187], v[144:159]
v_mfma_f32_32x32x16_bf16 v[160:175], v[80:83], v[184:187], v[160:175]
ds_read_b128 v[184:187], v250 offset:6144
s_waitcnt lgkmcnt(2)
v_mfma_f32_32x32x16_bf16 v[144:159], v[60:63], v[188:191], v[144:159]
v_mfma_f32_32x32x16_bf16 v[160:175], v[84:87], v[188:191], v[160:175]
ds_read_b128 v[188:191], v250 offset:7168
v_mfma_f32_32x32x16_bf16 v[144:159], v[64:67], v[176:179], v[144:159]
v_mfma_f32_32x32x16_bf16 v[160:175], v[88:91], v[176:179], v[160:175]
ds_read_b128 v[176:179], v250 offset:8192
s_waitcnt lgkmcnt(2)
v_mfma_f32_32x32x16_bf16 v[144:159], v[68:71], v[180:183], v[144:159]
v_mfma_f32_32x32x16_bf16 v[160:175], v[92:95], v[180:183], v[160:175]
ds_read_b128 v[180:183], v250 offset:9216
v_mfma_f32_32x32x16_bf16 v[112:127], v[48:51], v[184:187], 0
s_nop 8
v_cvt_pkrtz_f16_f32 v145, v144, v145
v_and_b32 v145, s49, v145
v_bfe_u32 v144, v145, 2, 14
v_lshrrev_b32_e64 v145, 18, v145
ds_read_u16 v144, v144
ds_read_u16 v145, v145
v_cvt_pk_f16_f32 v156, v156, v157
v_cvt_pk_f16_f32 v158, v158, v159
v_mfma_f32_32x32x16_bf16 v[128:143], v[72:75], v[184:187], 0
v_pk_fma_f16 v157, v156, v156, s48
v_cvt_pkrtz_f16_f32 v147, v146, v147
v_and_b32_e64 v147, s49, v147
v_bfe_u32 v146, v147, 2, 14
v_lshrrev_b32_e64 v147, 18, v147
ds_read_u16 v146, v146
ds_read_u16 v147, v147
v_pk_fma_f16 v159, v158, v158, s48
v_pk_mul_f16 v157, v156, v157
v_pk_mul_f16 v159, v158, v159
v_cvt_pkrtz_f16_f32 v149, v148, v149
v_and_b32_e64 v149, s49, v149
v_bfe_u32 v148, v149, 2, 14
v_lshrrev_b32 v149, 18, v149
ds_read_u16 v148, v148
ds_read_u16 v149, v149
v_exp_f16_sdwa v157, v157 dst_sel:WORD_0 dst_unused:UNUSED_PRESERVE src0_sel:WORD_0
s_waitcnt lgkmcnt(6)
v_mfma_f32_32x32x16_bf16 v[112:127], v[52:55], v[188:191], v[112:127]
v_exp_f16_sdwa v159, v159 dst_sel:WORD_0 dst_unused:UNUSED_PRESERVE src0_sel:WORD_0
v_cvt_pkrtz_f16_f32 v151, v150, v151
v_and_b32_e64 v151, s49, v151
v_bfe_u32 v150, v151, 2, 14
v_lshrrev_b32_e64 v151, 18, v151
ds_read_u16 v150, v150
ds_read_u16 v151, v151
v_exp_f16_sdwa v157, v157 dst_sel:WORD_1 dst_unused:UNUSED_PRESERVE src0_sel:WORD_1
v_cvt_pkrtz_f16_f32 v153, v152, v153
v_and_b32_e64 v153, s49, v153
v_bfe_u32 v152, v153, 2, 14
v_lshrrev_b32_e64 v153, 18, v153
ds_read_u16 v152, v152
ds_read_u16 v153, v153
v_mfma_f32_32x32x16_bf16 v[128:143], v[76:79], v[188:191], v[128:143]
v_exp_f16_sdwa v159, v159 dst_sel:WORD_1 dst_unused:UNUSED_PRESERVE src0_sel:WORD_1
ds_read_b128 v[184:187], v250 offset:10240
v_cvt_pkrtz_f16_f32 v155, v154, v155
v_and_b32_e64 v155, s49, v155
v_bfe_u32 v154, v155, 2, 14
v_lshrrev_b32_e64 v155, 18, v155
ds_read_u16 v154, v154
ds_read_u16 v155, v155
v_pk_add_f16 v157, v157, 1.0 op_sel_hi:[1,0]
v_pk_add_f16 v159, v159, 1.0 op_sel_hi:[1,0]
v_rcp_f16_sdwa v157, v157 dst_sel:WORD_0 dst_unused:UNUSED_PRESERVE src0_sel:WORD_0
v_mfma_f32_32x32x16_bf16 v[112:127], v[56:59], v[176:179], v[112:127]
v_rcp_f16_sdwa v159, v159 dst_sel:WORD_0 dst_unused:UNUSED_PRESERVE src0_sel:WORD_0
v_rcp_f16_sdwa v157, v157 dst_sel:WORD_1 dst_unused:UNUSED_PRESERVE src0_sel:WORD_1
v_mfma_f32_32x32x16_bf16 v[128:143], v[80:83], v[176:179], v[128:143]
v_rcp_f16_sdwa v159, v159 dst_sel:WORD_1 dst_unused:UNUSED_PRESERVE src0_sel:WORD_1
ds_read_b128 v[188:191], v250 offset:11264
v_pk_mul_f16 v156, v156, v157
v_pk_mul_f16 v158, v158, v159
v_fma_mix_f32 v224, v156, v156, v224 op_sel_hi:[1,1,0]
v_mfma_f32_32x32x16_bf16 v[112:127], v[60:63], v[180:183], v[112:127]
v_fma_mix_f32 v224, v158, v158, v224 op_sel_hi:[1,1,0]
v_cvt_pkrtz_f16_f32 v161, v160, v161
v_fma_mix_f32 v224, v156, v156, v224 op_sel:[1,1,0] op_sel_hi:[1,1,0]
v_and_b32_e64 v161, s49, v161
v_fma_mix_f32 v224, v158, v158, v224 op_sel:[1,1,0] op_sel_hi:[1,1,0]
v_bfe_u32 v160, v161, 2, 14
s_waitcnt lgkmcnt(7)
v_fma_mix_f32 v224, v144, v144, v224 op_sel_hi:[1,1,0]
v_lshrrev_b32 v161, 18, v161
v_fma_mix_f32 v224, v145, v145, v224 op_sel_hi:[1,1,0]
ds_read_u16 v160, v160
v_fma_mix_f32 v224, v146, v146, v224 op_sel_hi:[1,1,0]
ds_read_u16 v161, v161
v_fma_mix_f32 v224, v147, v147, v224 op_sel_hi:[1,1,0]
v_cvt_pk_f16_f32 v170, v170, v171
v_cvt_pk_f16_f32 v172, v172, v173
v_cvt_pk_f16_f32 v174, v174, v175
v_mfma_f32_32x32x16_bf16 v[128:143], v[84:87], v[180:183], v[128:143]
v_pk_fma_f16 v171, v170, v170, s48
v_fma_mix_f32 v224, v148, v148, v224 op_sel_hi:[1,1,0]
v_pk_fma_f16 v173, v172, v172, s48
v_fma_mix_f32 v224, v149, v149, v224 op_sel_hi:[1,1,0]
ds_read_b128 v[176:179], v250 offset:12288
v_cvt_pkrtz_f16_f32 v163, v162, v163
v_and_b32_e64 v163, s49, v163
v_bfe_u32 v162, v163, 2, 14
v_lshrrev_b32_e64 v163, 18, v163
ds_read_u16 v162, v162
ds_read_u16 v163, v163
v_pk_fma_f16 v175, v174, v174, s48
v_pk_mul_f16 v171, v170, v171
v_pk_mul_f16 v173, v172, v173
v_fma_mix_f32 v224, v150, v150, v224 op_sel_hi:[1,1,0]
v_pk_mul_f16 v175, v174, v175
s_waitcnt lgkmcnt(7)
v_fma_mix_f32 v224, v151, v151, v224 op_sel_hi:[1,1,0]
v_exp_f16_sdwa v171, v171 dst_sel:WORD_0 dst_unused:UNUSED_PRESERVE src0_sel:WORD_0
v_cvt_pkrtz_f16_f32 v165, v164, v165
v_and_b32 v165, s49, v165
v_bfe_u32 v164, v165, 2, 14
v_lshrrev_b32_e64 v165, 18, v165
ds_read_u16 v164, v164
ds_read_u16 v165, v165
v_mfma_f32_32x32x16_bf16 v[112:127], v[64:67], v[184:187], v[112:127]
v_exp_f16_sdwa v173, v173 dst_sel:WORD_0 dst_unused:UNUSED_PRESERVE src0_sel:WORD_0
v_fma_mix_f32 v224, v152, v152, v224 op_sel_hi:[1,1,0]
v_exp_f16_sdwa v175, v175 dst_sel:WORD_0 dst_unused:UNUSED_PRESERVE src0_sel:WORD_0
v_fma_mix_f32 v224, v153, v153, v224 op_sel_hi:[1,1,0]
v_cvt_pkrtz_f16_f32 v167, v166, v167
v_and_b32_e64 v167, s49, v167
v_bfe_u32 v166, v167, 2, 14
v_lshrrev_b32 v167, 18, v167
ds_read_u16 v166, v166
ds_read_u16 v167, v167
v_exp_f16_sdwa v171, v171 dst_sel:WORD_1 dst_unused:UNUSED_PRESERVE src0_sel:WORD_1
v_fma_mix_f32 v224, v154, v154, v224 op_sel_hi:[1,1,0]
v_exp_f16_sdwa v173, v173 dst_sel:WORD_1 dst_unused:UNUSED_PRESERVE src0_sel:WORD_1
s_waitcnt lgkmcnt(7)
v_fma_mix_f32 v224, v155, v155, v224 op_sel_hi:[1,1,0]
v_mfma_f32_32x32x16_bf16 v[128:143], v[88:91], v[184:187], v[128:143]
v_exp_f16_sdwa v175, v175 dst_sel:WORD_1 dst_unused:UNUSED_PRESERVE src0_sel:WORD_1
ds_read_b128 v[180:183], v250 offset:13312
v_cvt_pkrtz_f16_f32 v169, v168, v169
v_and_b32_e64 v169, s49, v169
v_bfe_u32 v168, v169, 2, 14
v_lshrrev_b32_e64 v169, 18, v169
ds_read_u16 v168, v168
ds_read_u16 v169, v169
v_pk_add_f16 v171, v171, 1.0 op_sel_hi:[1,0]
v_pk_add_f16 v173, v173, 1.0 op_sel_hi:[1,0]
v_pk_add_f16 v175, v175, 1.0 op_sel_hi:[1,0]
v_rcp_f16_sdwa v171, v171 dst_sel:WORD_0 dst_unused:UNUSED_PRESERVE src0_sel:WORD_0
v_mfma_f32_32x32x16_bf16 v[112:127], v[68:71], v[188:191], v[112:127]
v_rcp_f16_sdwa v173, v173 dst_sel:WORD_0 dst_unused:UNUSED_PRESERVE src0_sel:WORD_0
v_rcp_f16_sdwa v175, v175 dst_sel:WORD_0 dst_unused:UNUSED_PRESERVE src0_sel:WORD_0
v_rcp_f16_sdwa v171, v171 dst_sel:WORD_1 dst_unused:UNUSED_PRESERVE src0_sel:WORD_1
v_rcp_f16_sdwa v173, v173 dst_sel:WORD_1 dst_unused:UNUSED_PRESERVE src0_sel:WORD_1
v_mfma_f32_32x32x16_bf16 v[128:143], v[92:95], v[188:191], v[128:143]
v_rcp_f16_sdwa v175, v175 dst_sel:WORD_1 dst_unused:UNUSED_PRESERVE src0_sel:WORD_1
ds_read_b128 v[184:187], v250 offset:14336
v_pk_mul_f16 v170, v170, v171
v_pk_mul_f16 v172, v172, v173
v_pk_mul_f16 v174, v174, v175
v_fma_mix_f32 v224, v170, v170, v224 op_sel_hi:[1,1,0]
s_waitcnt lgkmcnt(5)
v_mfma_f32_32x32x16_bf16 v[96:111], v[48:51], v[176:179], 0
v_fma_mix_f32 v224, v172, v172, v224 op_sel_hi:[1,1,0]
v_cvt_pkrtz_f16_f32 v113, v112, v113
v_fma_mix_f32 v224, v174, v174, v224 op_sel_hi:[1,1,0]
v_and_b32 v113, s49, v113
v_fma_mix_f32 v224, v170, v170, v224 op_sel:[1,1,0] op_sel_hi:[1,1,0]
v_bfe_u32 v112, v113, 2, 14
v_fma_mix_f32 v224, v172, v172, v224 op_sel:[1,1,0] op_sel_hi:[1,1,0]
v_lshrrev_b32_e64 v113, 18, v113
v_fma_mix_f32 v224, v174, v174, v224 op_sel:[1,1,0] op_sel_hi:[1,1,0]
ds_read_u16 v112, v112
v_fma_mix_f32 v224, v160, v160, v224 op_sel_hi:[1,1,0]
ds_read_u16 v113, v113
v_fma_mix_f32 v224, v161, v161, v224 op_sel_hi:[1,1,0]
v_cvt_pk_f16_f32 v124, v124, v125
v_fma_mix_f32 v224, v162, v162, v224 op_sel_hi:[1,1,0]
v_cvt_pk_f16_f32 v126, v126, v127
v_fma_mix_f32 v224, v163, v163, v224 op_sel_hi:[1,1,0]
v_mfma_f32_32x32x16_bf16 v[144:159], v[176:179], v[72:75], 0
v_pk_fma_f16 v125, v124, v124, s48
v_cvt_pkrtz_f16_f32 v115, v114, v115
v_and_b32_e64 v115, s49, v115
v_bfe_u32 v114, v115, 2, 14
v_lshrrev_b32_e64 v115, 18, v115
ds_read_u16 v114, v114
ds_read_u16 v115, v115
v_pk_fma_f16 v127, v126, v126, s48
ds_read_b128 v[188:191], v250 offset:15360
v_fma_mix_f32 v224, v164, v164, v224 op_sel_hi:[1,1,0]
v_pk_mul_f16 v125, v124, v125
v_fma_mix_f32 v224, v165, v165, v224 op_sel_hi:[1,1,0]
v_pk_mul_f16 v127, v126, v127
v_cvt_pkrtz_f16_f32 v117, v116, v117
v_and_b32_e64 v117, s49, v117
v_bfe_u32 v116, v117, 2, 14
v_lshrrev_b32 v117, 18, v117
ds_read_u16 v116, v116
ds_read_u16 v117, v117
v_exp_f16_sdwa v125, v125 dst_sel:WORD_0 dst_unused:UNUSED_PRESERVE src0_sel:WORD_0
v_fma_mix_f32 v224, v166, v166, v224 op_sel_hi:[1,1,0]
s_waitcnt lgkmcnt(6)
v_mfma_f32_32x32x16_bf16 v[96:111], v[52:55], v[180:183], v[96:111]
v_fma_mix_f32 v224, v167, v167, v224 op_sel_hi:[1,1,0]
v_exp_f16_sdwa v127, v127 dst_sel:WORD_0 dst_unused:UNUSED_PRESERVE src0_sel:WORD_0
v_cvt_pkrtz_f16_f32 v119, v118, v119
v_and_b32_e64 v119, s49, v119
v_bfe_u32 v118, v119, 2, 14
v_lshrrev_b32_e64 v119, 18, v119
ds_read_u16 v118, v118
ds_read_u16 v119, v119
v_exp_f16_sdwa v125, v125 dst_sel:WORD_1 dst_unused:UNUSED_PRESERVE src0_sel:WORD_1
v_fma_mix_f32 v224, v168, v168, v224 op_sel_hi:[1,1,0]
v_cvt_pkrtz_f16_f32 v121, v120, v121
v_fma_mix_f32 v224, v169, v169, v224 op_sel_hi:[1,1,0]
v_and_b32_e64 v121, s49, v121
v_bfe_u32 v120, v121, 2, 14
v_lshrrev_b32_e64 v121, 18, v121
ds_read_u16 v120, v120
ds_read_u16 v121, v121
v_mfma_f32_32x32x16_bf16 v[144:159], v[180:183], v[76:79], v[144:159]
v_exp_f16_sdwa v127, v127 dst_sel:WORD_1 dst_unused:UNUSED_PRESERVE src0_sel:WORD_1
ds_read_b128 v[176:179], v250 offset:16384
v_cvt_pkrtz_f16_f32 v123, v122, v123
v_and_b32_e64 v123, s49, v123
v_bfe_u32 v122, v123, 2, 14
v_lshrrev_b32_e64 v123, 18, v123
ds_read_u16 v122, v122
ds_read_u16 v123, v123
v_pk_add_f16 v125, v125, 1.0 op_sel_hi:[1,0]
v_pk_add_f16 v127, v127, 1.0 op_sel_hi:[1,0]
v_rcp_f16_sdwa v125, v125 dst_sel:WORD_0 dst_unused:UNUSED_PRESERVE src0_sel:WORD_0
v_mfma_f32_32x32x16_bf16 v[96:111], v[56:59], v[184:187], v[96:111]
v_rcp_f16_sdwa v127, v127 dst_sel:WORD_0 dst_unused:UNUSED_PRESERVE src0_sel:WORD_0
v_rcp_f16_sdwa v125, v125 dst_sel:WORD_1 dst_unused:UNUSED_PRESERVE src0_sel:WORD_1
v_mfma_f32_32x32x16_bf16 v[144:159], v[184:187], v[80:83], v[144:159]
v_rcp_f16_sdwa v127, v127 dst_sel:WORD_1 dst_unused:UNUSED_PRESERVE src0_sel:WORD_1
ds_read_b128 v[180:183], v250 offset:17408
v_pk_mul_f16 v124, v124, v125
v_pk_mul_f16 v126, v126, v127
v_fma_mix_f32 v225, v124, v124, v225 op_sel_hi:[1,1,0]
s_waitcnt lgkmcnt(7)
v_mfma_f32_32x32x16_bf16 v[96:111], v[60:63], v[188:191], v[96:111]
v_fma_mix_f32 v225, v126, v126, v225 op_sel_hi:[1,1,0]
v_cvt_pkrtz_f16_f32 v129, v128, v129
v_fma_mix_f32 v225, v124, v124, v225 op_sel:[1,1,0] op_sel_hi:[1,1,0]
v_and_b32 v129, s49, v129
v_fma_mix_f32 v225, v126, v126, v225 op_sel:[1,1,0] op_sel_hi:[1,1,0]
v_bfe_u32 v128, v129, 2, 14
v_fma_mix_f32 v225, v112, v112, v225 op_sel_hi:[1,1,0]
v_lshrrev_b32_e64 v129, 18, v129
v_fma_mix_f32 v225, v113, v113, v225 op_sel_hi:[1,1,0]
ds_read_u16 v128, v128
v_fma_mix_f32 v225, v114, v114, v225 op_sel_hi:[1,1,0]
ds_read_u16 v129, v129
v_fma_mix_f32 v225, v115, v115, v225 op_sel_hi:[1,1,0]
v_cvt_pk_f16_f32 v138, v138, v139
v_cvt_pk_f16_f32 v140, v140, v141
v_cvt_pk_f16_f32 v142, v142, v143
v_mfma_f32_32x32x16_bf16 v[144:159], v[188:191], v[84:87], v[144:159]
v_pk_fma_f16 v139, v138, v138, s48
v_fma_mix_f32 v225, v116, v116, v225 op_sel_hi:[1,1,0]
v_pk_fma_f16 v141, v140, v140, s48
v_fma_mix_f32 v225, v117, v117, v225 op_sel_hi:[1,1,0]
ds_read_b128 v[184:187], v250 offset:18432
v_cvt_pkrtz_f16_f32 v131, v130, v131
v_and_b32_e64 v131, s49, v131
v_bfe_u32 v130, v131, 2, 14
v_lshrrev_b32_e64 v131, 18, v131
ds_read_u16 v130, v130
ds_read_u16 v131, v131
v_pk_fma_f16 v143, v142, v142, s48
v_pk_mul_f16 v139, v138, v139
v_pk_mul_f16 v141, v140, v141
v_fma_mix_f32 v225, v118, v118, v225 op_sel_hi:[1,1,0]
v_pk_mul_f16 v143, v142, v143
s_waitcnt lgkmcnt(7)
v_fma_mix_f32 v225, v119, v119, v225 op_sel_hi:[1,1,0]
s_getpc_b64 s[74:75]
Lcq5:
s_lshl_b32 s43, s40, 10
s_add_u32 s43, s43, 6144
s_min_u32 s43, s43, Lend-Lcq5-1024
s_add_u32 s74, s74, s43
s_addc_u32 s75, s75, 0
s_sub_u32 s74, s74, 16384
s_subb_u32 s75, s75, 0
s_mov_b32 m0, 163840
s_nop 0
global_load_lds_dword v250, s[74:75]
v_exp_f16_sdwa v139, v139 dst_sel:WORD_0 dst_unused:UNUSED_PRESERVE src0_sel:WORD_0
v_cvt_pkrtz_f16_f32 v133, v132, v133
v_and_b32 v133, s49, v133
v_bfe_u32 v132, v133, 2, 14
v_lshrrev_b32_e64 v133, 18, v133
ds_read_u16 v132, v132
ds_read_u16 v133, v133
v_mfma_f32_32x32x16_bf16 v[96:111], v[64:67], v[176:179], v[96:111]
v_exp_f16_sdwa v141, v141 dst_sel:WORD_0 dst_unused:UNUSED_PRESERVE src0_sel:WORD_0
v_fma_mix_f32 v225, v120, v120, v225 op_sel_hi:[1,1,0]
v_exp_f16_sdwa v143, v143 dst_sel:WORD_0 dst_unused:UNUSED_PRESERVE src0_sel:WORD_0
v_fma_mix_f32 v225, v121, v121, v225 op_sel_hi:[1,1,0]
v_cvt_pkrtz_f16_f32 v135, v134, v135
v_and_b32_e64 v135, s49, v135
v_bfe_u32 v134, v135, 2, 14
v_lshrrev_b32 v135, 18, v135
ds_read_u16 v134, v134
ds_read_u16 v135, v135
v_exp_f16_sdwa v139, v139 dst_sel:WORD_1 dst_unused:UNUSED_PRESERVE src0_sel:WORD_1
v_fma_mix_f32 v225, v122, v122, v225 op_sel_hi:[1,1,0]
v_exp_f16_sdwa v141, v141 dst_sel:WORD_1 dst_unused:UNUSED_PRESERVE src0_sel:WORD_1
s_waitcnt lgkmcnt(6)
v_fma_mix_f32 v225, v123, v123, v225 op_sel_hi:[1,1,0]
v_mfma_f32_32x32x16_bf16 v[144:159], v[176:179], v[88:91], v[144:159]
v_exp_f16_sdwa v143, v143 dst_sel:WORD_1 dst_unused:UNUSED_PRESERVE src0_sel:WORD_1
ds_read_b128 v[188:191], v250 offset:19456
v_cvt_pkrtz_f16_f32 v137, v136, v137
v_and_b32_e64 v137, s49, v137
v_bfe_u32 v136, v137, 2, 14
v_lshrrev_b32_e64 v137, 18, v137
ds_read_u16 v136, v136
ds_read_u16 v137, v137
v_pk_add_f16 v139, v139, 1.0 op_sel_hi:[1,0]
v_pk_add_f16 v141, v141, 1.0 op_sel_hi:[1,0]
v_pk_add_f16 v143, v143, 1.0 op_sel_hi:[1,0]
v_rcp_f16_sdwa v139, v139 dst_sel:WORD_0 dst_unused:UNUSED_PRESERVE src0_sel:WORD_0
v_mfma_f32_32x32x16_bf16 v[96:111], v[68:71], v[180:183], v[96:111]
v_rcp_f16_sdwa v141, v141 dst_sel:WORD_0 dst_unused:UNUSED_PRESERVE src0_sel:WORD_0
v_rcp_f16_sdwa v143, v143 dst_sel:WORD_0 dst_unused:UNUSED_PRESERVE src0_sel:WORD_0
v_rcp_f16_sdwa v139, v139 dst_sel:WORD_1 dst_unused:UNUSED_PRESERVE src0_sel:WORD_1
v_rcp_f16_sdwa v141, v141 dst_sel:WORD_1 dst_unused:UNUSED_PRESERVE src0_sel:WORD_1
v_mfma_f32_32x32x16_bf16 v[144:159], v[180:183], v[92:95], v[144:159]
v_rcp_f16_sdwa v143, v143 dst_sel:WORD_1 dst_unused:UNUSED_PRESERVE src0_sel:WORD_1
ds_read_b128 v[176:179], v250 offset:20480
v_pk_mul_f16 v138, v138, v139
v_pk_mul_f16 v140, v140, v141
v_pk_mul_f16 v142, v142, v143
v_fma_mix_f32 v225, v138, v138, v225 op_sel_hi:[1,1,0]
v_mfma_f32_32x32x16_bf16 v[160:175], v[48:51], v[184:187], 0
v_fma_mix_f32 v225, v140, v140, v225 op_sel_hi:[1,1,0]
v_cvt_pkrtz_f16_f32 v97, v96, v97
v_fma_mix_f32 v225, v142, v142, v225 op_sel_hi:[1,1,0]
v_and_b32_e64 v97, s49, v97
v_fma_mix_f32 v225, v138, v138, v225 op_sel:[1,1,0] op_sel_hi:[1,1,0]
v_bfe_u32 v96, v97, 2, 14
v_fma_mix_f32 v225, v140, v140, v225 op_sel:[1,1,0] op_sel_hi:[1,1,0]
v_lshrrev_b32 v97, 18, v97
v_fma_mix_f32 v225, v142, v142, v225 op_sel:[1,1,0] op_sel_hi:[1,1,0]
ds_read_u16 v96, v96
v_fma_mix_f32 v225, v128, v128, v225 op_sel_hi:[1,1,0]
ds_read_u16 v97, v97
v_fma_mix_f32 v225, v129, v129, v225 op_sel_hi:[1,1,0]
v_cvt_pk_f16_f32 v108, v108, v109
s_waitcnt lgkmcnt(4)
v_fma_mix_f32 v225, v130, v130, v225 op_sel_hi:[1,1,0]
v_cvt_pk_f16_f32 v110, v110, v111
v_fma_mix_f32 v225, v131, v131, v225 op_sel_hi:[1,1,0]
v_mfma_f32_32x32x16_bf16 v[112:127], v[184:187], v[72:75], 0
v_pk_fma_f16 v109, v108, v108, s48
v_cvt_pkrtz_f16_f32 v99, v98, v99
v_and_b32_e64 v99, s49, v99
v_bfe_u32 v98, v99, 2, 14
v_lshrrev_b32_e64 v99, 18, v99
ds_read_u16 v98, v98
ds_read_u16 v99, v99
v_pk_fma_f16 v111, v110, v110, s48
ds_read_b128 v[180:183], v250 offset:21504
v_fma_mix_f32 v225, v132, v132, v225 op_sel_hi:[1,1,0]
v_pk_mul_f16 v109, v108, v109
v_fma_mix_f32 v225, v133, v133, v225 op_sel_hi:[1,1,0]
v_pk_mul_f16 v111, v110, v111
v_cvt_pkrtz_f16_f32 v101, v100, v101
v_and_b32_e64 v101, s49, v101
v_bfe_u32 v100, v101, 2, 14
v_lshrrev_b32_e64 v101, 18, v101
ds_read_u16 v100, v100
ds_read_u16 v101, v101
v_exp_f16_sdwa v109, v109 dst_sel:WORD_0 dst_unused:UNUSED_PRESERVE src0_sel:WORD_0
v_fma_mix_f32 v225, v134, v134, v225 op_sel_hi:[1,1,0]
v_mfma_f32_32x32x16_bf16 v[160:175], v[52:55], v[188:191], v[160:175]
v_fma_mix_f32 v225, v135, v135, v225 op_sel_hi:[1,1,0]
v_exp_f16_sdwa v111, v111 dst_sel:WORD_0 dst_unused:UNUSED_PRESERVE src0_sel:WORD_0
v_cvt_pkrtz_f16_f32 v103, v102, v103
v_and_b32_e64 v103, s49, v103
v_bfe_u32 v102, v103, 2, 14
v_lshrrev_b32_e64 v103, 18, v103
ds_read_u16 v102, v102
ds_read_u16 v103, v103
v_exp_f16_sdwa v109, v109 dst_sel:WORD_1 dst_unused:UNUSED_PRESERVE src0_sel:WORD_1
v_fma_mix_f32 v225, v136, v136, v225 op_sel_hi:[1,1,0]
v_cvt_pkrtz_f16_f32 v105, v104, v105
s_waitcnt lgkmcnt(6)
v_fma_mix_f32 v225, v137, v137, v225 op_sel_hi:[1,1,0]
v_and_b32 v105, s49, v105
v_bfe_u32 v104, v105, 2, 14
v_lshrrev_b32_e64 v105, 18, v105
ds_read_u16 v104, v104
ds_read_u16 v105, v105
v_mfma_f32_32x32x16_bf16 v[112:127], v[188:191], v[76:79], v[112:127]
v_exp_f16_sdwa v111, v111 dst_sel:WORD_1 dst_unused:UNUSED_PRESERVE src0_sel:WORD_1
ds_read_b128 v[184:187], v250 offset:22528
v_cvt_pkrtz_f16_f32 v107, v106, v107
v_and_b32_e64 v107, s49, v107
v_bfe_u32 v106, v107, 2, 14
v_lshrrev_b32_e64 v107, 18, v107
ds_read_u16 v106, v106
ds_read_u16 v107, v107
v_pk_add_f16 v109, v109, 1.0 op_sel_hi:[1,0]
v_pk_add_f16 v111, v111, 1.0 op_sel_hi:[1,0]
v_rcp_f16_sdwa v109, v109 dst_sel:WORD_0 dst_unused:UNUSED_PRESERVE src0_sel:WORD_0
v_mfma_f32_32x32x16_bf16 v[160:175], v[56:59], v[176:179], v[160:175]
v_rcp_f16_sdwa v111, v111 dst_sel:WORD_0 dst_unused:UNUSED_PRESERVE src0_sel:WORD_0
v_rcp_f16_sdwa v109, v109 dst_sel:WORD_1 dst_unused:UNUSED_PRESERVE src0_sel:WORD_1
v_mfma_f32_32x32x16_bf16 v[112:127], v[176:179], v[80:83], v[112:127]
v_rcp_f16_sdwa v111, v111 dst_sel:WORD_1 dst_unused:UNUSED_PRESERVE src0_sel:WORD_1
ds_read_b128 v[188:191], v250 offset:23552
v_pk_mul_f16 v108, v108, v109
v_pk_mul_f16 v110, v110, v111
v_fma_mix_f32 v226, v108, v108, v226 op_sel_hi:[1,1,0]
s_waitcnt lgkmcnt(7)
v_mfma_f32_32x32x16_bf16 v[160:175], v[60:63], v[180:183], v[160:175]
v_fma_mix_f32 v226, v110, v110, v226 op_sel_hi:[1,1,0]
v_cvt_pkrtz_f16_f32 v145, v144, v145
v_fma_mix_f32 v226, v108, v108, v226 op_sel:[1,1,0] op_sel_hi:[1,1,0]
v_and_b32 v145, s49, v145
v_fma_mix_f32 v226, v110, v110, v226 op_sel:[1,1,0] op_sel_hi:[1,1,0]
v_bfe_u32 v144, v145, 2, 14
v_fma_mix_f32 v226, v96, v96, v226 op_sel_hi:[1,1,0]
v_lshrrev_b32_e64 v145, 18, v145
v_fma_mix_f32 v226, v97, v97, v226 op_sel_hi:[1,1,0]
ds_read_u16 v144, v144
v_fma_mix_f32 v226, v98, v98, v226 op_sel_hi:[1,1,0]
ds_read_u16_d16_hi v145, v145
v_fma_mix_f32 v226, v99, v99, v226 op_sel_hi:[1,1,0]
v_cvt_pk_f16_f32 v154, v154, v155
v_cvt_pk_f16_f32 v156, v156, v157
v_cvt_pk_f16_f32 v158, v158, v159
v_mfma_f32_32x32x16_bf16 v[112:127], v[180:183], v[84:87], v[112:127]
v_pk_fma_f16 v155, v154, v154, s48
v_fma_mix_f32 v226, v100, v100, v226 op_sel_hi:[1,1,0]
ds_read_b128 v[176:179], v250 offset:24576
v_fma_mix_f32 v226, v101, v101, v226 op_sel_hi:[1,1,0]
v_pk_fma_f16 v157, v156, v156, s48
v_cvt_pkrtz_f16_f32 v147, v146, v147
v_and_b32_e64 v147, s49, v147
v_bfe_u32 v146, v147, 2, 14
v_lshrrev_b32_e64 v147, 18, v147
ds_read_u16 v146, v146
ds_read_u16_d16_hi v147, v147
v_pk_fma_f16 v159, v158, v158, s48
v_pk_mul_f16 v155, v154, v155
v_fma_mix_f32 v226, v102, v102, v226 op_sel_hi:[1,1,0]
v_pk_mul_f16 v157, v156, v157
s_waitcnt lgkmcnt(7)
v_fma_mix_f32 v226, v103, v103, v226 op_sel_hi:[1,1,0]
v_pk_mul_f16 v159, v158, v159
v_cvt_pkrtz_f16_f32 v149, v148, v149
v_and_b32 v149, s49, v149
v_bfe_u32 v148, v149, 2, 14
v_lshrrev_b32_e64 v149, 18, v149
ds_read_u16 v148, v148
ds_read_u16_d16_hi v149, v149
v_exp_f16_sdwa v155, v155 dst_sel:WORD_0 dst_unused:UNUSED_PRESERVE src0_sel:WORD_0
v_mfma_f32_32x32x16_bf16 v[160:175], v[64:67], v[184:187], v[160:175]
v_fma_mix_f32 v226, v104, v104, v226 op_sel_hi:[1,1,0]
v_exp_f16_sdwa v157, v157 dst_sel:WORD_0 dst_unused:UNUSED_PRESERVE src0_sel:WORD_0
v_fma_mix_f32 v226, v105, v105, v226 op_sel_hi:[1,1,0]
v_cvt_pkrtz_f16_f32 v151, v150, v151
v_and_b32_e64 v151, s49, v151
v_bfe_u32 v150, v151, 2, 14
v_lshrrev_b32 v151, 18, v151
ds_read_u16 v150, v150
ds_read_u16_d16_hi v151, v151
v_exp_f16_sdwa v159, v159 dst_sel:WORD_0 dst_unused:UNUSED_PRESERVE src0_sel:WORD_0
v_fma_mix_f32 v226, v106, v106, v226 op_sel_hi:[1,1,0]
v_exp_f16_sdwa v155, v155 dst_sel:WORD_1 dst_unused:UNUSED_PRESERVE src0_sel:WORD_1
s_waitcnt lgkmcnt(6)
v_fma_mix_f32 v226, v107, v107, v226 op_sel_hi:[1,1,0]
v_mfma_f32_32x32x16_bf16 v[112:127], v[184:187], v[88:91], v[112:127]
ds_read_b128 v[180:183], v250 offset:25600
v_exp_f16_sdwa v157, v157 dst_sel:WORD_1 dst_unused:UNUSED_PRESERVE src0_sel:WORD_1
v_cvt_pkrtz_f16_f32 v153, v152, v153
v_and_b32_e64 v153, s49, v153
v_bfe_u32 v152, v153, 2, 14
v_lshrrev_b32_e64 v153, 18, v153
ds_read_u16 v152, v152
ds_read_u16_d16_hi v153, v153
v_exp_f16_sdwa v159, v159 dst_sel:WORD_1 dst_unused:UNUSED_PRESERVE src0_sel:WORD_1
v_pk_add_f16 v155, v155, 1.0 op_sel_hi:[1,0]
v_pk_add_f16 v157, v157, 1.0 op_sel_hi:[1,0]
v_mfma_f32_32x32x16_bf16 v[160:175], v[68:71], v[188:191], v[160:175]
v_pk_add_f16 v159, v159, 1.0 op_sel_hi:[1,0]
v_rcp_f16_sdwa v155, v155 dst_sel:WORD_0 dst_unused:UNUSED_PRESERVE src0_sel:WORD_0
v_rcp_f16_sdwa v157, v157 dst_sel:WORD_0 dst_unused:UNUSED_PRESERVE src0_sel:WORD_0
v_rcp_f16_sdwa v159, v159 dst_sel:WORD_0 dst_unused:UNUSED_PRESERVE src0_sel:WORD_0
v_mfma_f32_32x32x16_bf16 v[112:127], v[188:191], v[92:95], v[112:127]
ds_read_b128 v[184:187], v250 offset:26624
v_rcp_f16_sdwa v155, v155 dst_sel:WORD_1 dst_unused:UNUSED_PRESERVE src0_sel:WORD_1
v_rcp_f16_sdwa v157, v157 dst_sel:WORD_1 dst_unused:UNUSED_PRESERVE src0_sel:WORD_1
v_rcp_f16_sdwa v159, v159 dst_sel:WORD_1 dst_unused:UNUSED_PRESERVE src0_sel:WORD_1
v_or_b32_e64 v0, v144, v145
v_mfma_f32_32x32x16_bf16 v[128:143], v[48:51], v[176:179], 0
v_pk_mul_f16 v3, v154, v155
v_pk_mul_f16 v6, v156, v157
v_pk_mul_f16 v7, v158, v159
v_cvt_pkrtz_f16_f32 v161, v160, v161
v_and_b32_e64 v161, s49, v161
v_bfe_u32 v160, v161, 2, 14
v_lshrrev_b32_e64 v161, 18, v161
ds_read_u16 v160, v160
ds_read_u16 v161, v161
v_cvt_pk_f16_f32 v172, v172, v173
s_waitcnt lgkmcnt(5)
v_or_b32 v1, v146, v147
v_cvt_pk_f16_f32 v174, v174, v175
v_mfma_f32_32x32x16_bf16 v[96:111], v[176:179], v[72:75], 0
v_pk_fma_f16 v173, v172, v172, s48
v_cvt_pkrtz_f16_f32 v163, v162, v163
v_and_b32_e64 v163, s49, v163
v_bfe_u32 v162, v163, 2, 14
v_lshrrev_b32_e64 v163, 18, v163
ds_read_u16 v162, v162
ds_read_u16 v163, v163
v_pk_fma_f16 v175, v174, v174, s48
ds_read_b128 v[188:191], v250 offset:27648
v_or_b32_e64 v4, v148, v149
v_pk_mul_f16 v173, v172, v173
v_pk_mul_f16 v175, v174, v175
v_cvt_pkrtz_f16_f32 v165, v164, v165
v_and_b32_e64 v165, s49, v165
v_bfe_u32 v164, v165, 2, 14
v_lshrrev_b32_e64 v165, 18, v165
ds_read_u16 v164, v164
ds_read_u16 v165, v165
v_exp_f16_sdwa v173, v173 dst_sel:WORD_0 dst_unused:UNUSED_PRESERVE src0_sel:WORD_0
v_or_b32_e64 v5, v150, v151
v_mfma_f32_32x32x16_bf16 v[128:143], v[52:55], v[180:183], v[128:143]
v_exp_f16_sdwa v175, v175 dst_sel:WORD_0 dst_unused:UNUSED_PRESERVE src0_sel:WORD_0
v_cvt_pkrtz_f16_f32 v167, v166, v167
v_and_b32_e64 v167, s49, v167
v_bfe_u32 v166, v167, 2, 14
v_lshrrev_b32_e64 v167, 18, v167
ds_read_u16 v166, v166
ds_read_u16 v167, v167
v_exp_f16_sdwa v173, v173 dst_sel:WORD_1 dst_unused:UNUSED_PRESERVE src0_sel:WORD_1
s_waitcnt lgkmcnt(7)
v_or_b32 v2, v152, v153
v_cvt_pkrtz_f16_f32 v169, v168, v169
v_and_b32_e64 v169, s49, v169
v_bfe_u32 v168, v169, 2, 14
v_lshrrev_b32_e64 v169, 18, v169
ds_read_u16 v168, v168
ds_read_u16 v169, v169
v_mfma_f32_32x32x16_bf16 v[96:111], v[180:183], v[76:79], v[96:111]
v_exp_f16_sdwa v175, v175 dst_sel:WORD_1 dst_unused:UNUSED_PRESERVE src0_sel:WORD_1
ds_read_b128 v[176:179], v250 offset:28672
v_cvt_pkrtz_f16_f32 v171, v170, v171
v_and_b32_e64 v171, s49, v171
v_mfma_f32_32x32x16_f16 v[144:159], v[0:3], v[216:219], 0
v_bfe_u32 v170, v171, 2, 14
v_lshrrev_b32_e64 v171, 18, v171
ds_read_u16 v170, v170
ds_read_u16 v171, v171
v_pk_add_f16 v173, v173, 1.0 op_sel_hi:[1,0]
v_pk_add_f16 v175, v175, 1.0 op_sel_hi:[1,0]
v_rcp_f16_sdwa v173, v173 dst_sel:WORD_0 dst_unused:UNUSED_PRESERVE src0_sel:WORD_0
v_mfma_f32_32x32x16_f16 v[144:159], v[4:7], v[220:223], v[144:159]
v_permlane16_swap_b32 v0, v4
v_permlane16_swap_b32 v1, v5
v_permlane16_swap_b32 v2, v6
v_permlane16_swap_b32 v3, v7
v_mfma_f32_32x32x16_bf16 v[128:143], v[56:59], v[184:187], v[128:143]
v_rcp_f16_sdwa v175, v175 dst_sel:WORD_0 dst_unused:UNUSED_PRESERVE src0_sel:WORD_0
v_rcp_f16_sdwa v173, v173 dst_sel:WORD_1 dst_unused:UNUSED_PRESERVE src0_sel:WORD_1
v_mfma_f32_32x32x16_bf16 v[96:111], v[184:187], v[80:83], v[96:111]
v_rcp_f16_sdwa v175, v175 dst_sel:WORD_1 dst_unused:UNUSED_PRESERVE src0_sel:WORD_1
ds_read_b128 v[180:183], v250 offset:29696
s_nop 1
v_fmac_f32 v226, v144, v144
v_pk_mul_f16 v172, v172, v173
v_fmac_f32_e64 v226, v145, v145
v_pk_mul_f16 v174, v174, v175
v_fmac_f32 v226, v146, v146
v_fmac_f32 v226, v147, v147
v_fma_mix_f32 v227, v172, v172, v227 op_sel_hi:[1,1,0]
v_fmac_f32 v226, v148, v148
v_fmac_f32 v226, v149, v149
v_fma_mix_f32 v227, v174, v174, v227 op_sel_hi:[1,1,0]
s_waitcnt lgkmcnt(6)
v_mfma_f32_32x32x16_bf16 v[128:143], v[60:63], v[188:191], v[128:143]
v_fmac_f32 v226, v150, v150
v_fma_mix_f32 v227, v172, v172, v227 op_sel:[1,1,0] op_sel_hi:[1,1,0]
v_fmac_f32 v226, v151, v151
v_fmac_f32 v226, v152, v152
v_fma_mix_f32 v227, v174, v174, v227 op_sel:[1,1,0] op_sel_hi:[1,1,0]
v_fmac_f32_e64 v226, v153, v153
v_fma_mix_f32 v227, v160, v160, v227 op_sel_hi:[1,1,0]
v_fmac_f32_e64 v226, v154, v154
v_fma_mix_f32 v227, v161, v161, v227 op_sel_hi:[1,1,0]
v_cvt_pkrtz_f16_f32 v113, v112, v113
v_fma_mix_f32 v227, v162, v162, v227 op_sel_hi:[1,1,0]
v_and_b32_e64 v113, s49, v113
v_fma_mix_f32 v227, v163, v163, v227 op_sel_hi:[1,1,0]
v_bfe_u32 v112, v113, 2, 14
v_lshrrev_b32_e64 v113, 18, v113
ds_read_u16 v112, v112
ds_read_u16_d16_hi v113, v113
v_cvt_pk_f16_f32 v122, v122, v123
v_fmac_f32_e64 v226, v155, v155
v_cvt_pk_f16_f32 v124, v124, v125
v_fmac_f32_e64 v226, v156, v156
v_cvt_pk_f16_f32 v126, v126, v127
v_fmac_f32_e64 v226, v157, v157
v_mfma_f32_32x32x16_bf16 v[96:111], v[188:191], v[84:87], v[96:111]
v_pk_fma_f16 v123, v122, v122, s48
v_fmac_f32_e64 v226, v158, v158
v_fma_mix_f32 v227, v164, v164, v227 op_sel_hi:[1,1,0]
v_fmac_f32_e64 v226, v159, v159
v_fma_mix_f32 v227, v165, v165, v227 op_sel_hi:[1,1,0]
ds_read_b128 v[184:187], v250 offset:30720
v_pk_fma_f16 v125, v124, v124, s48
v_cvt_pkrtz_f16_f32 v115, v114, v115
v_and_b32_e64 v115, s49, v115
v_bfe_u32 v114, v115, 2, 14
v_lshrrev_b32_e64 v115, 18, v115
ds_read_u16 v114, v114
ds_read_u16_d16_hi v115, v115
v_pk_fma_f16 v127, v126, v126, s48
v_pk_mul_f16 v123, v122, v123
v_fma_mix_f32 v227, v166, v166, v227 op_sel_hi:[1,1,0]
v_pk_mul_f16 v125, v124, v125
v_fma_mix_f32 v227, v167, v167, v227 op_sel_hi:[1,1,0]
v_pk_mul_f16 v127, v126, v127
v_cvt_pkrtz_f16_f32 v117, v116, v117
v_and_b32_e64 v117, s49, v117
v_bfe_u32 v116, v117, 2, 14
v_lshrrev_b32 v117, 18, v117
ds_read_u16 v116, v116
ds_read_u16_d16_hi v117, v117
v_exp_f16_sdwa v123, v123 dst_sel:WORD_0 dst_unused:UNUSED_PRESERVE src0_sel:WORD_0
s_waitcnt lgkmcnt(6)
v_mfma_f32_32x32x16_bf16 v[128:143], v[64:67], v[176:179], v[128:143]
v_fma_mix_f32 v227, v168, v168, v227 op_sel_hi:[1,1,0]
v_exp_f16_sdwa v125, v125 dst_sel:WORD_0 dst_unused:UNUSED_PRESERVE src0_sel:WORD_0
v_fma_mix_f32 v227, v169, v169, v227 op_sel_hi:[1,1,0]
v_cvt_pkrtz_f16_f32 v119, v118, v119
v_and_b32_e64 v119, s49, v119
v_bfe_u32 v118, v119, 2, 14
v_lshrrev_b32_e64 v119, 18, v119
ds_read_u16 v118, v118
ds_read_u16_d16_hi v119, v119
v_exp_f16_sdwa v127, v127 dst_sel:WORD_0 dst_unused:UNUSED_PRESERVE src0_sel:WORD_0
v_fma_mix_f32 v227, v170, v170, v227 op_sel_hi:[1,1,0]
v_exp_f16_sdwa v123, v123 dst_sel:WORD_1 dst_unused:UNUSED_PRESERVE src0_sel:WORD_1
v_fma_mix_f32 v227, v171, v171, v227 op_sel_hi:[1,1,0]
v_mfma_f32_32x32x16_bf16 v[96:111], v[176:179], v[88:91], v[96:111]
ds_read_b128 v[188:191], v250 offset:31744
v_exp_f16_sdwa v125, v125 dst_sel:WORD_1 dst_unused:UNUSED_PRESERVE src0_sel:WORD_1
v_cvt_pkrtz_f16_f32 v121, v120, v121
v_and_b32_e64 v121, s49, v121
v_bfe_u32 v120, v121, 2, 14
v_lshrrev_b32_e64 v121, 18, v121
ds_read_u16 v120, v120
ds_read_u16_d16_hi v121, v121
v_exp_f16_sdwa v127, v127 dst_sel:WORD_1 dst_unused:UNUSED_PRESERVE src0_sel:WORD_1
v_pk_add_f16 v123, v123, 1.0 op_sel_hi:[1,0]
v_pk_add_f16 v125, v125, 1.0 op_sel_hi:[1,0]
v_mfma_f32_32x32x16_bf16 v[128:143], v[68:71], v[180:183], v[128:143]
v_pk_add_f16 v127, v127, 1.0 op_sel_hi:[1,0]
v_rcp_f16_sdwa v123, v123 dst_sel:WORD_0 dst_unused:UNUSED_PRESERVE src0_sel:WORD_0
v_rcp_f16_sdwa v125, v125 dst_sel:WORD_0 dst_unused:UNUSED_PRESERVE src0_sel:WORD_0
v_rcp_f16_sdwa v127, v127 dst_sel:WORD_0 dst_unused:UNUSED_PRESERVE src0_sel:WORD_0
v_mfma_f32_32x32x16_bf16 v[96:111], v[180:183], v[92:95], v[96:111]
ds_read_b128 v[176:179], v250 offset:32768
v_rcp_f16_sdwa v123, v123 dst_sel:WORD_1 dst_unused:UNUSED_PRESERVE src0_sel:WORD_1
v_rcp_f16_sdwa v125, v125 dst_sel:WORD_1 dst_unused:UNUSED_PRESERVE src0_sel:WORD_1
v_rcp_f16_sdwa v127, v127 dst_sel:WORD_1 dst_unused:UNUSED_PRESERVE src0_sel:WORD_1
s_waitcnt lgkmcnt(4)
v_or_b32 v8, v112, v113
v_mfma_f32_32x32x16_bf16 v[144:159], v[48:51], v[184:187], 0
s_cmp_lg_u32 s40, 0
s_cbranch_scc1 Lpix
v_mov_b32_e64 v244, 0
Lpi:
buffer_load_dword v245, v244, s[36:39], 0 offen sc1
s_waitcnt vmcnt(0)
v_readfirstlane_b32 s43, v245
s_cmp_eq_u32 s76, 0
s_cbranch_scc1 Lpix
s_sub_u32 s76, s76, 1
s_cmp_lt_u32 s43, 256
s_cbranch_scc1 Lpi
Lpix:
v_pk_mul_f16 v11, v122, v123
v_pk_mul_f16 v14, v124, v125
v_pk_mul_f16 v15, v126, v127
v_cvt_pkrtz_f16_f32 v129, v128, v129
v_and_b32_e64 v129, s49, v129
v_bfe_u32 v128, v129, 2, 14
v_lshrrev_b32_e64 v129, 18, v129
ds_read_u16 v128, v128
ds_read_u16 v129, v129
v_cvt_pk_f16_f32 v140, v140, v141
v_or_b32_e64 v9, v114, v115
v_cvt_pk_f16_f32 v142, v142, v143
v_mfma_f32_32x32x16_bf16 v[160:175], v[184:187], v[72:75], 0
v_pk_fma_f16 v141, v140, v140, s48
v_cvt_pkrtz_f16_f32 v131, v130, v131
v_and_b32_e64 v131, s49, v131
v_bfe_u32 v130, v131, 2, 14
v_lshrrev_b32_e64 v131, 18, v131
ds_read_u16 v130, v130
ds_read_u16 v131, v131
v_pk_fma_f16 v143, v142, v142, s48
ds_read_b128 v[180:183], v250 offset:33792
v_or_b32_e64 v12, v116, v117
v_pk_mul_f16 v141, v140, v141
v_pk_mul_f16 v143, v142, v143
v_cvt_pkrtz_f16_f32 v133, v132, v133
v_and_b32_e64 v133, s49, v133
v_bfe_u32 v132, v133, 2, 14
v_lshrrev_b32_e64 v133, 18, v133
ds_read_u16 v132, v132
ds_read_u16 v133, v133
v_exp_f16_sdwa v141, v141 dst_sel:WORD_0 dst_unused:UNUSED_PRESERVE src0_sel:WORD_0
v_or_b32 v13, v118, v119
s_waitcnt lgkmcnt(7)
v_mfma_f32_32x32x16_bf16 v[144:159], v[52:55], v[188:191], v[144:159]
v_exp_f16_sdwa v143, v143 dst_sel:WORD_0 dst_unused:UNUSED_PRESERVE src0_sel:WORD_0
v_cvt_pkrtz_f16_f32 v135, v134, v135
v_and_b32_e64 v135, s49, v135
v_bfe_u32 v134, v135, 2, 14
v_lshrrev_b32_e64 v135, 18, v135
ds_read_u16 v134, v134
ds_read_u16 v135, v135
v_exp_f16_sdwa v141, v141 dst_sel:WORD_1 dst_unused:UNUSED_PRESERVE src0_sel:WORD_1
v_or_b32_e64 v10, v120, v121
v_cvt_pkrtz_f16_f32 v137, v136, v137
v_and_b32_e64 v137, s49, v137
v_bfe_u32 v136, v137, 2, 14
v_lshrrev_b32_e64 v137, 18, v137
ds_read_u16 v136, v136
ds_read_u16 v137, v137
v_mfma_f32_32x32x16_bf16 v[160:175], v[188:191], v[76:79], v[160:175]
v_exp_f16_sdwa v143, v143 dst_sel:WORD_1 dst_unused:UNUSED_PRESERVE src0_sel:WORD_1
ds_read_b128 v[184:187], v250 offset:34816
v_cvt_pkrtz_f16_f32 v139, v138, v139
v_and_b32_e64 v139, s49, v139
v_mfma_f32_32x32x16_f16 v[112:127], v[8:11], v[216:219], 0
v_bfe_u32 v138, v139, 2, 14
v_lshrrev_b32_e64 v139, 18, v139
ds_read_u16 v138, v138
ds_read_u16 v139, v139
v_pk_add_f16 v141, v141, 1.0 op_sel_hi:[1,0]
v_pk_add_f16 v143, v143, 1.0 op_sel_hi:[1,0]
v_rcp_f16_sdwa v141, v141 dst_sel:WORD_0 dst_unused:UNUSED_PRESERVE src0_sel:WORD_0
v_mfma_f32_32x32x16_f16 v[112:127], v[12:15], v[220:223], v[112:127]
v_permlane16_swap_b32 v8, v12
v_permlane16_swap_b32 v9, v13
v_permlane16_swap_b32 v10, v14
v_permlane16_swap_b32 v11, v15
v_mfma_f32_32x32x16_bf16 v[144:159], v[56:59], v[176:179], v[144:159]
v_rcp_f16_sdwa v143, v143 dst_sel:WORD_0 dst_unused:UNUSED_PRESERVE src0_sel:WORD_0
v_rcp_f16_sdwa v141, v141 dst_sel:WORD_1 dst_unused:UNUSED_PRESERVE src0_sel:WORD_1
v_mfma_f32_32x32x16_bf16 v[160:175], v[176:179], v[80:83], v[160:175]
v_rcp_f16_sdwa v143, v143 dst_sel:WORD_1 dst_unused:UNUSED_PRESERVE src0_sel:WORD_1
ds_read_b128 v[188:191], v250 offset:35840
s_nop 1
v_fmac_f32 v227, v112, v112
v_pk_mul_f16 v140, v140, v141
v_fmac_f32_e64 v227, v113, v113
v_pk_mul_f16 v142, v142, v143
v_fmac_f32 v227, v114, v114
v_fmac_f32 v227, v115, v115
v_fma_mix_f32 v228, v140, v140, v228 op_sel_hi:[1,1,0]
v_fmac_f32 v227, v116, v116
v_fmac_f32 v227, v117, v117
v_fma_mix_f32 v228, v142, v142, v228 op_sel_hi:[1,1,0]
s_waitcnt lgkmcnt(6)
v_mfma_f32_32x32x16_bf16 v[144:159], v[60:63], v[180:183], v[144:159]
v_fmac_f32 v227, v118, v118
v_fma_mix_f32 v228, v140, v140, v228 op_sel:[1,1,0] op_sel_hi:[1,1,0]
v_fmac_f32 v227, v119, v119
v_fmac_f32 v227, v120, v120
v_fma_mix_f32 v228, v142, v142, v228 op_sel:[1,1,0] op_sel_hi:[1,1,0]
v_fmac_f32_e64 v227, v121, v121
v_fma_mix_f32 v228, v128, v128, v228 op_sel_hi:[1,1,0]
v_fmac_f32_e64 v227, v122, v122
v_fma_mix_f32 v228, v129, v129, v228 op_sel_hi:[1,1,0]
v_cvt_pkrtz_f16_f32 v97, v96, v97
v_fma_mix_f32 v228, v130, v130, v228 op_sel_hi:[1,1,0]
v_and_b32_e64 v97, s49, v97
v_fma_mix_f32 v228, v131, v131, v228 op_sel_hi:[1,1,0]
v_bfe_u32 v96, v97, 2, 14
v_lshrrev_b32_e64 v97, 18, v97
ds_read_u16 v96, v96
ds_read_u16_d16_hi v97, v97
v_cvt_pk_f16_f32 v106, v106, v107
v_fmac_f32_e64 v227, v123, v123
v_cvt_pk_f16_f32 v108, v108, v109
v_fmac_f32_e64 v227, v124, v124
v_cvt_pk_f16_f32 v110, v110, v111
v_fmac_f32_e64 v227, v125, v125
v_mfma_f32_32x32x16_bf16 v[160:175], v[180:183], v[84:87], v[160:175]
v_pk_fma_f16 v107, v106, v106, s48
v_fmac_f32_e64 v227, v126, v126
v_fma_mix_f32 v228, v132, v132, v228 op_sel_hi:[1,1,0]
v_fmac_f32_e64 v227, v127, v127
v_fma_mix_f32 v228, v133, v133, v228 op_sel_hi:[1,1,0]
ds_read_b128 v[176:179], v250 offset:36864
v_pk_fma_f16 v109, v108, v108, s48
v_cvt_pkrtz_f16_f32 v99, v98, v99
v_and_b32_e64 v99, s49, v99
v_bfe_u32 v98, v99, 2, 14
v_lshrrev_b32_e64 v99, 18, v99
ds_read_u16 v98, v98
ds_read_u16_d16_hi v99, v99
v_pk_fma_f16 v111, v110, v110, s48
v_pk_mul_f16 v107, v106, v107
v_fma_mix_f32 v228, v134, v134, v228 op_sel_hi:[1,1,0]
v_pk_mul_f16 v109, v108, v109
v_fma_mix_f32 v228, v135, v135, v228 op_sel_hi:[1,1,0]
v_pk_mul_f16 v111, v110, v111
v_cvt_pkrtz_f16_f32 v101, v100, v101
v_and_b32_e64 v101, s49, v101
v_bfe_u32 v100, v101, 2, 14
v_lshrrev_b32 v101, 18, v101
ds_read_u16 v100, v100
ds_read_u16_d16_hi v101, v101
v_exp_f16_sdwa v107, v107 dst_sel:WORD_0 dst_unused:UNUSED_PRESERVE src0_sel:WORD_0
s_waitcnt lgkmcnt(6)
v_mfma_f32_32x32x16_bf16 v[144:159], v[64:67], v[184:187], v[144:159]
v_fma_mix_f32 v228, v136, v136, v228 op_sel_hi:[1,1,0]
v_exp_f16_sdwa v109, v109 dst_sel:WORD_0 dst_unused:UNUSED_PRESERVE src0_sel:WORD_0
v_fma_mix_f32 v228, v137, v137, v228 op_sel_hi:[1,1,0]
v_cvt_pkrtz_f16_f32 v103, v102, v103
v_and_b32_e64 v103, s49, v103
v_bfe_u32 v102, v103, 2, 14
v_lshrrev_b32_e64 v103, 18, v103
ds_read_u16 v102, v102
ds_read_u16_d16_hi v103, v103
v_exp_f16_sdwa v111, v111 dst_sel:WORD_0 dst_unused:UNUSED_PRESERVE src0_sel:WORD_0
v_fma_mix_f32 v228, v138, v138, v228 op_sel_hi:[1,1,0]
v_exp_f16_sdwa v107, v107 dst_sel:WORD_1 dst_unused:UNUSED_PRESERVE src0_sel:WORD_1
v_fma_mix_f32 v228, v139, v139, v228 op_sel_hi:[1,1,0]
v_mfma_f32_32x32x16_bf16 v[160:175], v[184:187], v[88:91], v[160:175]
ds_read_b128 v[180:183], v250 offset:37888
v_exp_f16_sdwa v109, v109 dst_sel:WORD_1 dst_unused:UNUSED_PRESERVE src0_sel:WORD_1
v_cvt_pkrtz_f16_f32 v105, v104, v105
v_and_b32_e64 v105, s49, v105
v_bfe_u32 v104, v105, 2, 14
v_lshrrev_b32_e64 v105, 18, v105
ds_read_u16 v104, v104
ds_read_u16_d16_hi v105, v105
v_exp_f16_sdwa v111, v111 dst_sel:WORD_1 dst_unused:UNUSED_PRESERVE src0_sel:WORD_1
v_pk_add_f16 v107, v107, 1.0 op_sel_hi:[1,0]
v_pk_add_f16 v109, v109, 1.0 op_sel_hi:[1,0]
v_mfma_f32_32x32x16_bf16 v[144:159], v[68:71], v[188:191], v[144:159]
v_pk_add_f16 v111, v111, 1.0 op_sel_hi:[1,0]
v_rcp_f16_sdwa v107, v107 dst_sel:WORD_0 dst_unused:UNUSED_PRESERVE src0_sel:WORD_0
v_rcp_f16_sdwa v109, v109 dst_sel:WORD_0 dst_unused:UNUSED_PRESERVE src0_sel:WORD_0
v_rcp_f16_sdwa v111, v111 dst_sel:WORD_0 dst_unused:UNUSED_PRESERVE src0_sel:WORD_0
v_mfma_f32_32x32x16_bf16 v[160:175], v[188:191], v[92:95], v[160:175]
ds_read_b128 v[184:187], v250 offset:38912
v_rcp_f16_sdwa v107, v107 dst_sel:WORD_1 dst_unused:UNUSED_PRESERVE src0_sel:WORD_1
v_rcp_f16_sdwa v109, v109 dst_sel:WORD_1 dst_unused:UNUSED_PRESERVE src0_sel:WORD_1
v_rcp_f16_sdwa v111, v111 dst_sel:WORD_1 dst_unused:UNUSED_PRESERVE src0_sel:WORD_1
s_waitcnt lgkmcnt(4)
v_or_b32 v16, v96, v97
v_mfma_f32_32x32x16_bf16 v[112:127], v[48:51], v[176:179], 0
v_pk_mul_f16 v19, v106, v107
v_pk_mul_f16 v22, v108, v109
v_pk_mul_f16 v23, v110, v111
v_cvt_pkrtz_f16_f32 v145, v144, v145
v_and_b32_e64 v145, s49, v145
v_bfe_u32 v144, v145, 2, 14
v_lshrrev_b32_e64 v145, 18, v145
ds_read_u16 v144, v144
ds_read_u16 v145, v145
v_cvt_pk_f16_f32 v156, v156, v157
v_or_b32_e64 v17, v98, v99
v_cvt_pk_f16_f32 v158, v158, v159
v_mfma_f32_32x32x16_bf16 v[128:143], v[176:179], v[72:75], 0
v_pk_fma_f16 v157, v156, v156, s48
v_cvt_pkrtz_f16_f32 v147, v146, v147
v_and_b32_e64 v147, s49, v147
v_bfe_u32 v146, v147, 2, 14
v_lshrrev_b32_e64 v147, 18, v147
ds_read_u16 v146, v146
ds_read_u16 v147, v147
v_pk_fma_f16 v159, v158, v158, s48
ds_read_b128 v[188:191], v250 offset:39936
v_or_b32_e64 v20, v100, v101
v_pk_mul_f16 v157, v156, v157
v_pk_mul_f16 v159, v158, v159
v_cvt_pkrtz_f16_f32 v149, v148, v149
v_and_b32_e64 v149, s49, v149
v_bfe_u32 v148, v149, 2, 14
v_lshrrev_b32_e64 v149, 18, v149
ds_read_u16 v148, v148
ds_read_u16 v149, v149
v_exp_f16_sdwa v157, v157 dst_sel:WORD_0 dst_unused:UNUSED_PRESERVE src0_sel:WORD_0
v_or_b32 v21, v102, v103
s_waitcnt lgkmcnt(7)
v_mfma_f32_32x32x16_bf16 v[112:127], v[52:55], v[180:183], v[112:127]
v_exp_f16_sdwa v159, v159 dst_sel:WORD_0 dst_unused:UNUSED_PRESERVE src0_sel:WORD_0
v_cvt_pkrtz_f16_f32 v151, v150, v151
v_and_b32_e64 v151, s49, v151
v_bfe_u32 v150, v151, 2, 14
v_lshrrev_b32_e64 v151, 18, v151
ds_read_u16 v150, v150
ds_read_u16 v151, v151
v_exp_f16_sdwa v157, v157 dst_sel:WORD_1 dst_unused:UNUSED_PRESERVE src0_sel:WORD_1
v_or_b32_e64 v18, v104, v105
v_cvt_pkrtz_f16_f32 v153, v152, v153
v_and_b32_e64 v153, s49, v153
v_bfe_u32 v152, v153, 2, 14
v_lshrrev_b32_e64 v153, 18, v153
ds_read_u16 v152, v152
ds_read_u16 v153, v153
v_mfma_f32_32x32x16_bf16 v[128:143], v[180:183], v[76:79], v[128:143]
v_exp_f16_sdwa v159, v159 dst_sel:WORD_1 dst_unused:UNUSED_PRESERVE src0_sel:WORD_1
ds_read_b128 v[176:179], v250 offset:40960
v_cvt_pkrtz_f16_f32 v155, v154, v155
v_and_b32_e64 v155, s49, v155
v_mfma_f32_32x32x16_f16 v[96:111], v[16:19], v[216:219], 0
v_bfe_u32 v154, v155, 2, 14
v_lshrrev_b32_e64 v155, 18, v155
ds_read_u16 v154, v154
ds_read_u16 v155, v155
v_pk_add_f16 v157, v157, 1.0 op_sel_hi:[1,0]
v_pk_add_f16 v159, v159, 1.0 op_sel_hi:[1,0]
v_rcp_f16_sdwa v157, v157 dst_sel:WORD_0 dst_unused:UNUSED_PRESERVE src0_sel:WORD_0
v_mfma_f32_32x32x16_f16 v[96:111], v[20:23], v[220:223], v[96:111]
v_permlane16_swap_b32 v16, v20
v_permlane16_swap_b32 v17, v21
v_permlane16_swap_b32 v18, v22
v_permlane16_swap_b32 v19, v23
v_mfma_f32_32x32x16_bf16 v[112:127], v[56:59], v[184:187], v[112:127]
v_rcp_f16_sdwa v159, v159 dst_sel:WORD_0 dst_unused:UNUSED_PRESERVE src0_sel:WORD_0
v_rcp_f16_sdwa v157, v157 dst_sel:WORD_1 dst_unused:UNUSED_PRESERVE src0_sel:WORD_1
v_mfma_f32_32x32x16_bf16 v[128:143], v[184:187], v[80:83], v[128:143]
v_rcp_f16_sdwa v159, v159 dst_sel:WORD_1 dst_unused:UNUSED_PRESERVE src0_sel:WORD_1
ds_read_b128 v[180:183], v250 offset:41984
s_nop 1
v_fmac_f32 v228, v96, v96
v_pk_mul_f16 v156, v156, v157
v_fmac_f32_e64 v228, v97, v97
v_pk_mul_f16 v158, v158, v159
v_fmac_f32 v228, v98, v98
v_fmac_f32 v228, v99, v99
v_fma_mix_f32 v229, v156, v156, v229 op_sel_hi:[1,1,0]
v_fmac_f32 v228, v100, v100
v_fmac_f32 v228, v101, v101
v_fma_mix_f32 v229, v158, v158, v229 op_sel_hi:[1,1,0]
s_waitcnt lgkmcnt(6)
v_mfma_f32_32x32x16_bf16 v[112:127], v[60:63], v[188:191], v[112:127]
v_fmac_f32 v228, v102, v102
v_fma_mix_f32 v229, v156, v156, v229 op_sel:[1,1,0] op_sel_hi:[1,1,0]
v_fmac_f32 v228, v103, v103
v_fmac_f32 v228, v104, v104
v_fma_mix_f32 v229, v158, v158, v229 op_sel:[1,1,0] op_sel_hi:[1,1,0]
v_fmac_f32_e64 v228, v105, v105
v_fma_mix_f32 v229, v144, v144, v229 op_sel_hi:[1,1,0]
v_fmac_f32_e64 v228, v106, v106
v_fma_mix_f32 v229, v145, v145, v229 op_sel_hi:[1,1,0]
v_cvt_pkrtz_f16_f32 v161, v160, v161
v_fma_mix_f32 v229, v146, v146, v229 op_sel_hi:[1,1,0]
v_and_b32_e64 v161, s49, v161
v_fma_mix_f32 v229, v147, v147, v229 op_sel_hi:[1,1,0]
v_bfe_u32 v160, v161, 2, 14
v_lshrrev_b32_e64 v161, 18, v161
ds_read_u16 v160, v160
ds_read_u16_d16_hi v161, v161
v_cvt_pk_f16_f32 v170, v170, v171
v_fmac_f32_e64 v228, v107, v107
v_cvt_pk_f16_f32 v172, v172, v173
v_fmac_f32_e64 v228, v108, v108
v_cvt_pk_f16_f32 v174, v174, v175
v_fmac_f32_e64 v228, v109, v109
v_mfma_f32_32x32x16_bf16 v[128:143], v[188:191], v[84:87], v[128:143]
v_pk_fma_f16 v171, v170, v170, s48
v_fmac_f32_e64 v228, v110, v110
v_fma_mix_f32 v229, v148, v148, v229 op_sel_hi:[1,1,0]
v_fmac_f32_e64 v228, v111, v111
v_fma_mix_f32 v229, v149, v149, v229 op_sel_hi:[1,1,0]
ds_read_b128 v[184:187], v250 offset:43008
v_pk_fma_f16 v173, v172, v172, s48
v_cvt_pkrtz_f16_f32 v163, v162, v163
v_and_b32_e64 v163, s49, v163
v_bfe_u32 v162, v163, 2, 14
v_lshrrev_b32_e64 v163, 18, v163
ds_read_u16 v162, v162
ds_read_u16_d16_hi v163, v163
v_pk_fma_f16 v175, v174, v174, s48
v_pk_mul_f16 v171, v170, v171
v_fma_mix_f32 v229, v150, v150, v229 op_sel_hi:[1,1,0]
v_pk_mul_f16 v173, v172, v173
v_fma_mix_f32 v229, v151, v151, v229 op_sel_hi:[1,1,0]
v_pk_mul_f16 v175, v174, v175
v_cvt_pkrtz_f16_f32 v165, v164, v165
v_and_b32_e64 v165, s49, v165
v_bfe_u32 v164, v165, 2, 14
v_lshrrev_b32 v165, 18, v165
ds_read_u16 v164, v164
ds_read_u16_d16_hi v165, v165
v_exp_f16_sdwa v171, v171 dst_sel:WORD_0 dst_unused:UNUSED_PRESERVE src0_sel:WORD_0
s_waitcnt lgkmcnt(6)
v_mfma_f32_32x32x16_bf16 v[112:127], v[64:67], v[176:179], v[112:127]
v_fma_mix_f32 v229, v152, v152, v229 op_sel_hi:[1,1,0]
v_exp_f16_sdwa v173, v173 dst_sel:WORD_0 dst_unused:UNUSED_PRESERVE src0_sel:WORD_0
v_fma_mix_f32 v229, v153, v153, v229 op_sel_hi:[1,1,0]
v_cvt_pkrtz_f16_f32 v167, v166, v167
v_and_b32_e64 v167, s49, v167
v_bfe_u32 v166, v167, 2, 14
v_lshrrev_b32_e64 v167, 18, v167
ds_read_u16 v166, v166
ds_read_u16_d16_hi v167, v167
v_exp_f16_sdwa v175, v175 dst_sel:WORD_0 dst_unused:UNUSED_PRESERVE src0_sel:WORD_0
v_fma_mix_f32 v229, v154, v154, v229 op_sel_hi:[1,1,0]
v_exp_f16_sdwa v171, v171 dst_sel:WORD_1 dst_unused:UNUSED_PRESERVE src0_sel:WORD_1
v_fma_mix_f32 v229, v155, v155, v229 op_sel_hi:[1,1,0]
v_mfma_f32_32x32x16_bf16 v[128:143], v[176:179], v[88:91], v[128:143]
ds_read_b128 v[188:191], v250 offset:44032
v_exp_f16_sdwa v173, v173 dst_sel:WORD_1 dst_unused:UNUSED_PRESERVE src0_sel:WORD_1
v_cvt_pkrtz_f16_f32 v169, v168, v169
v_and_b32_e64 v169, s49, v169
v_bfe_u32 v168, v169, 2, 14
v_lshrrev_b32_e64 v169, 18, v169
ds_read_u16 v168, v168
ds_read_u16_d16_hi v169, v169
v_exp_f16_sdwa v175, v175 dst_sel:WORD_1 dst_unused:UNUSED_PRESERVE src0_sel:WORD_1
v_pk_add_f16 v171, v171, 1.0 op_sel_hi:[1,0]
v_pk_add_f16 v173, v173, 1.0 op_sel_hi:[1,0]
v_mfma_f32_32x32x16_bf16 v[112:127], v[68:71], v[180:183], v[112:127]
v_pk_add_f16 v175, v175, 1.0 op_sel_hi:[1,0]
v_rcp_f16_sdwa v171, v171 dst_sel:WORD_0 dst_unused:UNUSED_PRESERVE src0_sel:WORD_0
v_rcp_f16_sdwa v173, v173 dst_sel:WORD_0 dst_unused:UNUSED_PRESERVE src0_sel:WORD_0
v_rcp_f16_sdwa v175, v175 dst_sel:WORD_0 dst_unused:UNUSED_PRESERVE src0_sel:WORD_0
v_mfma_f32_32x32x16_bf16 v[128:143], v[180:183], v[92:95], v[128:143]
ds_read_b128 v[176:179], v250 offset:45056
v_rcp_f16_sdwa v171, v171 dst_sel:WORD_1 dst_unused:UNUSED_PRESERVE src0_sel:WORD_1
v_rcp_f16_sdwa v173, v173 dst_sel:WORD_1 dst_unused:UNUSED_PRESERVE src0_sel:WORD_1
v_rcp_f16_sdwa v175, v175 dst_sel:WORD_1 dst_unused:UNUSED_PRESERVE src0_sel:WORD_1
s_waitcnt lgkmcnt(4)
v_or_b32 v192, v160, v161
v_mfma_f32_32x32x16_bf16 v[96:111], v[48:51], v[184:187], 0
v_pk_mul_f16 v195, v170, v171
v_pk_mul_f16 v198, v172, v173
v_pk_mul_f16 v199, v174, v175
v_cvt_pkrtz_f16_f32 v113, v112, v113
v_and_b32_e64 v113, s49, v113
v_bfe_u32 v112, v113, 2, 14
v_lshrrev_b32_e64 v113, 18, v113
ds_read_u16 v112, v112
ds_read_u16 v113, v113
v_cvt_pk_f16_f32 v124, v124, v125
v_or_b32_e64 v193, v162, v163
v_cvt_pk_f16_f32 v126, v126, v127
v_mfma_f32_32x32x16_bf16 v[144:159], v[184:187], v[72:75], 0
v_pk_fma_f16 v125, v124, v124, s48
v_cvt_pkrtz_f16_f32 v115, v114, v115
v_and_b32_e64 v115, s49, v115
v_bfe_u32 v114, v115, 2, 14
v_lshrrev_b32_e64 v115, 18, v115
ds_read_u16 v114, v114
ds_read_u16 v115, v115
v_pk_fma_f16 v127, v126, v126, s48
ds_read_b128 v[180:183], v250 offset:46080
v_or_b32_e64 v196, v164, v165
v_pk_mul_f16 v125, v124, v125
v_pk_mul_f16 v127, v126, v127
v_cvt_pkrtz_f16_f32 v117, v116, v117
v_and_b32_e64 v117, s49, v117
v_bfe_u32 v116, v117, 2, 14
v_lshrrev_b32_e64 v117, 18, v117
ds_read_u16 v116, v116
ds_read_u16 v117, v117
v_exp_f16_sdwa v125, v125 dst_sel:WORD_0 dst_unused:UNUSED_PRESERVE src0_sel:WORD_0
v_or_b32 v197, v166, v167
s_waitcnt lgkmcnt(7)
v_mfma_f32_32x32x16_bf16 v[96:111], v[52:55], v[188:191], v[96:111]
v_exp_f16_sdwa v127, v127 dst_sel:WORD_0 dst_unused:UNUSED_PRESERVE src0_sel:WORD_0
v_cvt_pkrtz_f16_f32 v119, v118, v119
v_and_b32_e64 v119, s49, v119
v_bfe_u32 v118, v119, 2, 14
v_lshrrev_b32_e64 v119, 18, v119
ds_read_u16 v118, v118
ds_read_u16 v119, v119
v_exp_f16_sdwa v125, v125 dst_sel:WORD_1 dst_unused:UNUSED_PRESERVE src0_sel:WORD_1
v_or_b32_e64 v194, v168, v169
v_cvt_pkrtz_f16_f32 v121, v120, v121
v_and_b32_e64 v121, s49, v121
v_bfe_u32 v120, v121, 2, 14
v_lshrrev_b32_e64 v121, 18, v121
ds_read_u16 v120, v120
ds_read_u16 v121, v121
v_mfma_f32_32x32x16_bf16 v[144:159], v[188:191], v[76:79], v[144:159]
v_exp_f16_sdwa v127, v127 dst_sel:WORD_1 dst_unused:UNUSED_PRESERVE src0_sel:WORD_1
ds_read_b128 v[184:187], v250 offset:47104
v_cvt_pkrtz_f16_f32 v123, v122, v123
v_and_b32_e64 v123, s49, v123
v_mfma_f32_32x32x16_f16 v[160:175], v[192:195], v[216:219], 0
v_bfe_u32 v122, v123, 2, 14
v_lshrrev_b32_e64 v123, 18, v123
ds_read_u16 v122, v122
ds_read_u16 v123, v123
v_pk_add_f16 v125, v125, 1.0 op_sel_hi:[1,0]
v_pk_add_f16 v127, v127, 1.0 op_sel_hi:[1,0]
v_rcp_f16_sdwa v125, v125 dst_sel:WORD_0 dst_unused:UNUSED_PRESERVE src0_sel:WORD_0
v_mfma_f32_32x32x16_f16 v[160:175], v[196:199], v[220:223], v[160:175]
v_permlane16_swap_b32 v192, v196
v_permlane16_swap_b32 v193, v197
v_permlane16_swap_b32 v194, v198
v_permlane16_swap_b32 v195, v199
v_mfma_f32_32x32x16_bf16 v[96:111], v[56:59], v[176:179], v[96:111]
v_rcp_f16_sdwa v127, v127 dst_sel:WORD_0 dst_unused:UNUSED_PRESERVE src0_sel:WORD_0
v_rcp_f16_sdwa v125, v125 dst_sel:WORD_1 dst_unused:UNUSED_PRESERVE src0_sel:WORD_1
v_mfma_f32_32x32x16_bf16 v[144:159], v[176:179], v[80:83], v[144:159]
v_rcp_f16_sdwa v127, v127 dst_sel:WORD_1 dst_unused:UNUSED_PRESERVE src0_sel:WORD_1
ds_read_b128 v[188:191], v250 offset:48128
s_nop 1
v_fmac_f32 v229, v160, v160
v_pk_mul_f16 v124, v124, v125
v_fmac_f32_e64 v229, v161, v161
v_pk_mul_f16 v126, v126, v127
v_fmac_f32 v229, v162, v162
v_fmac_f32 v229, v163, v163
v_fma_mix_f32 v230, v124, v124, v230 op_sel_hi:[1,1,0]
v_fmac_f32 v229, v164, v164
v_fmac_f32 v229, v165, v165
v_fma_mix_f32 v230, v126, v126, v230 op_sel_hi:[1,1,0]
s_waitcnt lgkmcnt(6)
v_mfma_f32_32x32x16_bf16 v[96:111], v[60:63], v[180:183], v[96:111]
v_fmac_f32 v229, v166, v166
v_fma_mix_f32 v230, v124, v124, v230 op_sel:[1,1,0] op_sel_hi:[1,1,0]
v_fmac_f32 v229, v167, v167
v_fmac_f32 v229, v168, v168
v_fma_mix_f32 v230, v126, v126, v230 op_sel:[1,1,0] op_sel_hi:[1,1,0]
v_fmac_f32_e64 v229, v169, v169
v_fma_mix_f32 v230, v112, v112, v230 op_sel_hi:[1,1,0]
v_fmac_f32_e64 v229, v170, v170
v_fma_mix_f32 v230, v113, v113, v230 op_sel_hi:[1,1,0]
v_cvt_pkrtz_f16_f32 v129, v128, v129
v_fma_mix_f32 v230, v114, v114, v230 op_sel_hi:[1,1,0]
v_and_b32_e64 v129, s49, v129
v_fma_mix_f32 v230, v115, v115, v230 op_sel_hi:[1,1,0]
v_bfe_u32 v128, v129, 2, 14
v_lshrrev_b32_e64 v129, 18, v129
ds_read_u16 v128, v128
ds_read_u16_d16_hi v129, v129
v_cvt_pk_f16_f32 v138, v138, v139
v_fmac_f32_e64 v229, v171, v171
v_cvt_pk_f16_f32 v140, v140, v141
v_fmac_f32_e64 v229, v172, v172
v_cvt_pk_f16_f32 v142, v142, v143
v_fmac_f32_e64 v229, v173, v173
v_mfma_f32_32x32x16_bf16 v[144:159], v[180:183], v[84:87], v[144:159]
v_pk_fma_f16 v139, v138, v138, s48
v_fmac_f32_e64 v229, v174, v174
v_fma_mix_f32 v230, v116, v116, v230 op_sel_hi:[1,1,0]
v_fmac_f32_e64 v229, v175, v175
v_fma_mix_f32 v230, v117, v117, v230 op_sel_hi:[1,1,0]
ds_read_b128 v[176:179], v250 offset:49152
v_pk_fma_f16 v141, v140, v140, s48
v_cvt_pkrtz_f16_f32 v131, v130, v131
v_and_b32_e64 v131, s49, v131
v_bfe_u32 v130, v131, 2, 14
v_lshrrev_b32_e64 v131, 18, v131
ds_read_u16 v130, v130
ds_read_u16_d16_hi v131, v131
v_pk_fma_f16 v143, v142, v142, s48
v_pk_mul_f16 v139, v138, v139
v_fma_mix_f32 v230, v118, v118, v230 op_sel_hi:[1,1,0]
v_pk_mul_f16 v141, v140, v141
v_fma_mix_f32 v230, v119, v119, v230 op_sel_hi:[1,1,0]
s_getpc_b64 s[74:75]
Lcq6:
s_lshl_b32 s43, s40, 10
s_add_u32 s43, s43, 6144
s_min_u32 s43, s43, Lend-Lcq6-1024
s_add_u32 s74, s74, s43
s_addc_u32 s75, s75, 0
s_sub_u32 s74, s74, 16384
s_subb_u32 s75, s75, 0
s_mov_b32 m0, 163840
s_nop 0
global_load_lds_dword v250, s[74:75]
v_pk_mul_f16 v143, v142, v143
v_cvt_pkrtz_f16_f32 v133, v132, v133
v_and_b32_e64 v133, s49, v133
v_bfe_u32 v132, v133, 2, 14
v_lshrrev_b32 v133, 18, v133
ds_read_u16 v132, v132
ds_read_u16_d16_hi v133, v133
v_exp_f16_sdwa v139, v139 dst_sel:WORD_0 dst_unused:UNUSED_PRESERVE src0_sel:WORD_0
s_waitcnt lgkmcnt(6)
v_mfma_f32_32x32x16_bf16 v[96:111], v[64:67], v[184:187], v[96:111]
v_fma_mix_f32 v230, v120, v120, v230 op_sel_hi:[1,1,0]
v_exp_f16_sdwa v141, v141 dst_sel:WORD_0 dst_unused:UNUSED_PRESERVE src0_sel:WORD_0
v_fma_mix_f32 v230, v121, v121, v230 op_sel_hi:[1,1,0]
v_cvt_pkrtz_f16_f32 v135, v134, v135
v_and_b32_e64 v135, s49, v135
v_bfe_u32 v134, v135, 2, 14
v_lshrrev_b32_e64 v135, 18, v135
ds_read_u16 v134, v134
ds_read_u16_d16_hi v135, v135
v_exp_f16_sdwa v143, v143 dst_sel:WORD_0 dst_unused:UNUSED_PRESERVE src0_sel:WORD_0
v_fma_mix_f32 v230, v122, v122, v230 op_sel_hi:[1,1,0]
v_exp_f16_sdwa v139, v139 dst_sel:WORD_1 dst_unused:UNUSED_PRESERVE src0_sel:WORD_1
v_fma_mix_f32 v230, v123, v123, v230 op_sel_hi:[1,1,0]
v_mfma_f32_32x32x16_bf16 v[144:159], v[184:187], v[88:91], v[144:159]
ds_read_b128 v[180:183], v250 offset:50176
v_exp_f16_sdwa v141, v141 dst_sel:WORD_1 dst_unused:UNUSED_PRESERVE src0_sel:WORD_1
v_cvt_pkrtz_f16_f32 v137, v136, v137
v_and_b32_e64 v137, s49, v137
v_bfe_u32 v136, v137, 2, 14
v_lshrrev_b32_e64 v137, 18, v137
ds_read_u16 v136, v136
ds_read_u16_d16_hi v137, v137
v_exp_f16_sdwa v143, v143 dst_sel:WORD_1 dst_unused:UNUSED_PRESERVE src0_sel:WORD_1
v_pk_add_f16 v139, v139, 1.0 op_sel_hi:[1,0]
v_pk_add_f16 v141, v141, 1.0 op_sel_hi:[1,0]
v_mfma_f32_32x32x16_bf16 v[96:111], v[68:71], v[188:191], v[96:111]
v_pk_add_f16 v143, v143, 1.0 op_sel_hi:[1,0]
v_rcp_f16_sdwa v139, v139 dst_sel:WORD_0 dst_unused:UNUSED_PRESERVE src0_sel:WORD_0
v_rcp_f16_sdwa v141, v141 dst_sel:WORD_0 dst_unused:UNUSED_PRESERVE src0_sel:WORD_0
v_rcp_f16_sdwa v143, v143 dst_sel:WORD_0 dst_unused:UNUSED_PRESERVE src0_sel:WORD_0
v_mfma_f32_32x32x16_bf16 v[144:159], v[188:191], v[92:95], v[144:159]
ds_read_b128 v[184:187], v250 offset:51200
v_rcp_f16_sdwa v139, v139 dst_sel:WORD_1 dst_unused:UNUSED_PRESERVE src0_sel:WORD_1
v_rcp_f16_sdwa v141, v141 dst_sel:WORD_1 dst_unused:UNUSED_PRESERVE src0_sel:WORD_1
v_rcp_f16_sdwa v143, v143 dst_sel:WORD_1 dst_unused:UNUSED_PRESERVE src0_sel:WORD_1
s_waitcnt lgkmcnt(4)
v_or_b32 v200, v128, v129
v_mfma_f32_32x32x16_bf16 v[160:175], v[48:51], v[176:179], 0
v_mov_b32 v239, 0
s_branch Law5
Lax5:
s_sleep 2
Law5:
ds_read_b32 v239, v247 offset:28
s_sub_u32 s76, s76, 1
s_cselect_b32 s44, 4, 0
s_cselect_b32 s76, 0, s76
s_waitcnt lgkmcnt(0)
v_readfirstlane_b32 s43, v239
s_nop 1
s_max_u32 s43, s43, s44
s_cmp_lt_u32 s43, 4
s_cbranch_scc1 Lax5
v_bfe_u32 v237, v250, 4, 6
v_lshrrev_b32_e64 v246, 2, v237
v_mul_u32_u24 v246, 192, v246
v_and_b32_e64 v237, 3, v237
v_lshl_add_u32 v246, v237, 4, v246
v_permlane32_swap_b32 v224, v225
v_add_f32 v224, v224, v225
ds_write_b32 v248, v224 offset:5120
v_permlane32_swap_b32 v226, v227
v_add_f32 v226, v226, v227
ds_write_b32 v248, v226 offset:5376
v_permlane32_swap_b32 v228, v229
v_add_f32 v228, v228, v229
ds_write_b32 v248, v228 offset:5632
v_pk_mul_f16 v203, v138, v139
v_pk_mul_f16 v206, v140, v141
v_pk_mul_f16 v207, v142, v143
v_cvt_pkrtz_f16_f32 v97, v96, v97
v_and_b32_e64 v97, s49, v97
v_bfe_u32 v96, v97, 2, 14
v_lshrrev_b32_e64 v97, 18, v97
ds_read_u16 v96, v96
ds_read_u16 v97, v97
v_cvt_pk_f16_f32 v108, v108, v109
v_or_b32_e64 v201, v130, v131
v_cvt_pk_f16_f32 v110, v110, v111
v_mfma_f32_32x32x16_bf16 v[112:127], v[176:179], v[72:75], 0
v_pk_fma_f16 v109, v108, v108, s48
v_cvt_pkrtz_f16_f32 v99, v98, v99
v_and_b32_e64 v99, s49, v99
v_bfe_u32 v98, v99, 2, 14
v_lshrrev_b32_e64 v99, 18, v99
ds_read_u16 v98, v98
ds_read_u16 v99, v99
v_pk_fma_f16 v111, v110, v110, s48
ds_read_b128 v[188:191], v250 offset:52224
v_or_b32_e64 v204, v132, v133
v_pk_mul_f16 v109, v108, v109
v_pk_mul_f16 v111, v110, v111
v_cvt_pkrtz_f16_f32 v101, v100, v101
v_and_b32_e64 v101, s49, v101
v_bfe_u32 v100, v101, 2, 14
v_lshrrev_b32_e64 v101, 18, v101
ds_read_u16 v100, v100
ds_read_u16 v101, v101
s_add_u32 m0, s72, 0
s_add_u32 s43, s82, 0
buffer_load_dwordx4 v246, s[16:19], s43 offen lds
v_exp_f16_sdwa v109, v109 dst_sel:WORD_0 dst_unused:UNUSED_PRESERVE src0_sel:WORD_0
v_or_b32_e64 v205, v134, v135
v_mfma_f32_32x32x16_bf16 v[160:175], v[52:55], v[180:183], v[160:175]
v_exp_f16_sdwa v111, v111 dst_sel:WORD_0 dst_unused:UNUSED_PRESERVE src0_sel:WORD_0
v_cvt_pkrtz_f16_f32 v103, v102, v103
v_and_b32_e64 v103, s49, v103
v_bfe_u32 v102, v103, 2, 14
v_lshrrev_b32_e64 v103, 18, v103
ds_read_u16 v102, v102
ds_read_u16 v103, v103
v_exp_f16_sdwa v109, v109 dst_sel:WORD_1 dst_unused:UNUSED_PRESERVE src0_sel:WORD_1
v_or_b32_e64 v202, v136, v137
v_cvt_pkrtz_f16_f32 v105, v104, v105
v_and_b32_e64 v105, s49, v105
v_bfe_u32 v104, v105, 2, 14
v_lshrrev_b32_e64 v105, 18, v105
ds_read_u16 v104, v104
ds_read_u16 v105, v105
v_mfma_f32_32x32x16_bf16 v[112:127], v[180:183], v[76:79], v[112:127]
v_exp_f16_sdwa v111, v111 dst_sel:WORD_1 dst_unused:UNUSED_PRESERVE src0_sel:WORD_1
ds_read_b128 v[176:179], v250 offset:53248
v_cvt_pkrtz_f16_f32 v107, v106, v107
v_and_b32_e64 v107, s49, v107
v_mfma_f32_32x32x16_f16 v[128:143], v[200:203], v[216:219], 0
v_bfe_u32 v106, v107, 2, 14
v_lshrrev_b32 v107, 18, v107
s_waitcnt lgkmcnt(7)
ds_read_u16 v106, v106
ds_read_u16 v107, v107
v_pk_add_f16 v109, v109, 1.0 op_sel_hi:[1,0]
v_pk_add_f16 v111, v111, 1.0 op_sel_hi:[1,0]
v_rcp_f16_sdwa v109, v109 dst_sel:WORD_0 dst_unused:UNUSED_PRESERVE src0_sel:WORD_0
v_mfma_f32_32x32x16_f16 v[128:143], v[204:207], v[220:223], v[128:143]
v_permlane16_swap_b32 v200, v204
v_permlane16_swap_b32 v201, v205
v_permlane16_swap_b32 v202, v206
v_permlane16_swap_b32 v203, v207
v_mfma_f32_32x32x16_bf16 v[160:175], v[56:59], v[184:187], v[160:175]
v_rcp_f16_sdwa v111, v111 dst_sel:WORD_0 dst_unused:UNUSED_PRESERVE src0_sel:WORD_0
v_rcp_f16_sdwa v109, v109 dst_sel:WORD_1 dst_unused:UNUSED_PRESERVE src0_sel:WORD_1
s_add_u32 m0, s72, 1024
s_add_u32 s43, s82, 64
buffer_load_dwordx4 v246, s[16:19], s43 offen lds
v_mfma_f32_32x32x16_bf16 v[112:127], v[184:187], v[80:83], v[112:127]
v_rcp_f16_sdwa v111, v111 dst_sel:WORD_1 dst_unused:UNUSED_PRESERVE src0_sel:WORD_1
ds_read_b128 v[180:183], v250 offset:54272
v_fmac_f32 v230, v128, v128
v_pk_mul_f16 v108, v108, v109
v_fmac_f32_e64 v230, v129, v129
v_pk_mul_f16 v110, v110, v111
v_fmac_f32 v230, v130, v130
v_fmac_f32 v230, v131, v131
v_fma_mix_f32 v231, v108, v108, v231 op_sel_hi:[1,1,0]
v_fmac_f32 v230, v132, v132
v_fmac_f32 v230, v133, v133
v_fma_mix_f32 v231, v110, v110, v231 op_sel_hi:[1,1,0]
v_mfma_f32_32x32x16_bf16 v[160:175], v[60:63], v[188:191], v[160:175]
v_fmac_f32_e64 v230, v134, v134
v_fma_mix_f32 v231, v108, v108, v231 op_sel:[1,1,0] op_sel_hi:[1,1,0]
v_fmac_f32 v230, v135, v135
v_fmac_f32 v230, v136, v136
v_fma_mix_f32 v231, v110, v110, v231 op_sel:[1,1,0] op_sel_hi:[1,1,0]
v_fmac_f32_e64 v230, v137, v137
v_fma_mix_f32 v231, v96, v96, v231 op_sel_hi:[1,1,0]
v_fmac_f32_e64 v230, v138, v138
v_fma_mix_f32 v231, v97, v97, v231 op_sel_hi:[1,1,0]
v_cvt_pkrtz_f16_f32 v145, v144, v145
v_fma_mix_f32 v231, v98, v98, v231 op_sel_hi:[1,1,0]
v_and_b32_e64 v145, s49, v145
v_fma_mix_f32 v231, v99, v99, v231 op_sel_hi:[1,1,0]
v_bfe_u32 v144, v145, 2, 14
v_lshrrev_b32_e64 v145, 18, v145
ds_read_u16 v144, v144
ds_read_u16_d16_hi v145, v145
v_cvt_pk_f16_f32 v154, v154, v155
v_fmac_f32_e64 v230, v139, v139
v_cvt_pk_f16_f32 v156, v156, v157
v_fmac_f32_e64 v230, v140, v140
v_cvt_pk_f16_f32 v158, v158, v159
v_fmac_f32_e64 v230, v141, v141
v_mfma_f32_32x32x16_bf16 v[112:127], v[188:191], v[84:87], v[112:127]
v_pk_fma_f16 v155, v154, v154, s48
v_fmac_f32 v230, v142, v142
s_waitcnt lgkmcnt(2)
v_fma_mix_f32 v231, v100, v100, v231 op_sel_hi:[1,1,0]
v_fmac_f32_e64 v230, v143, v143
v_fma_mix_f32 v231, v101, v101, v231 op_sel_hi:[1,1,0]
ds_read_b128 v[184:187], v250 offset:55296
v_pk_fma_f16 v157, v156, v156, s48
v_cvt_pkrtz_f16_f32 v147, v146, v147
v_and_b32_e64 v147, s49, v147
v_bfe_u32 v146, v147, 2, 14
v_lshrrev_b32_e64 v147, 18, v147
ds_read_u16 v146, v146
ds_read_u16_d16_hi v147, v147
v_pk_fma_f16 v159, v158, v158, s48
v_pk_mul_f16 v155, v154, v155
v_fma_mix_f32 v231, v102, v102, v231 op_sel_hi:[1,1,0]
v_pk_mul_f16 v157, v156, v157
v_fma_mix_f32 v231, v103, v103, v231 op_sel_hi:[1,1,0]
s_add_u32 m0, s72, 2048
s_add_u32 s43, s82, 128
buffer_load_dwordx4 v246, s[16:19], s43 offen lds
v_pk_mul_f16 v159, v158, v159
v_cvt_pkrtz_f16_f32 v149, v148, v149
v_and_b32_e64 v149, s49, v149
v_bfe_u32 v148, v149, 2, 14
v_lshrrev_b32_e64 v149, 18, v149
ds_read_u16 v148, v148
ds_read_u16_d16_hi v149, v149
v_exp_f16_sdwa v155, v155 dst_sel:WORD_0 dst_unused:UNUSED_PRESERVE src0_sel:WORD_0
v_mfma_f32_32x32x16_bf16 v[160:175], v[64:67], v[176:179], v[160:175]
v_fma_mix_f32 v231, v104, v104, v231 op_sel_hi:[1,1,0]
v_exp_f16_sdwa v157, v157 dst_sel:WORD_0 dst_unused:UNUSED_PRESERVE src0_sel:WORD_0
v_fma_mix_f32 v231, v105, v105, v231 op_sel_hi:[1,1,0]
v_cvt_pkrtz_f16_f32 v151, v150, v151
v_and_b32_e64 v151, s49, v151
v_bfe_u32 v150, v151, 2, 14
v_lshrrev_b32_e64 v151, 18, v151
ds_read_u16 v150, v150
ds_read_u16_d16_hi v151, v151
v_exp_f16_sdwa v159, v159 dst_sel:WORD_0 dst_unused:UNUSED_PRESERVE src0_sel:WORD_0
v_fma_mix_f32 v231, v106, v106, v231 op_sel_hi:[1,1,0]
v_exp_f16_sdwa v155, v155 dst_sel:WORD_1 dst_unused:UNUSED_PRESERVE src0_sel:WORD_1
v_fma_mix_f32 v231, v107, v107, v231 op_sel_hi:[1,1,0]
v_mfma_f32_32x32x16_bf16 v[112:127], v[176:179], v[88:91], v[112:127]
ds_read_b128 v[188:191], v250 offset:56320
v_exp_f16_sdwa v157, v157 dst_sel:WORD_1 dst_unused:UNUSED_PRESERVE src0_sel:WORD_1
v_cvt_pkrtz_f16_f32 v153, v152, v153
v_and_b32_e64 v153, s49, v153
v_bfe_u32 v152, v153, 2, 14
v_lshrrev_b32_e64 v153, 18, v153
ds_read_u16 v152, v152
ds_read_u16_d16_hi v153, v153
v_exp_f16_sdwa v159, v159 dst_sel:WORD_1 dst_unused:UNUSED_PRESERVE src0_sel:WORD_1
v_pk_add_f16 v155, v155, 1.0 op_sel_hi:[1,0]
v_pk_add_f16 v157, v157, 1.0 op_sel_hi:[1,0]
v_mfma_f32_32x32x16_bf16 v[160:175], v[68:71], v[180:183], v[160:175]
v_pk_add_f16 v159, v159, 1.0 op_sel_hi:[1,0]
v_rcp_f16_sdwa v155, v155 dst_sel:WORD_0 dst_unused:UNUSED_PRESERVE src0_sel:WORD_0
v_rcp_f16_sdwa v157, v157 dst_sel:WORD_0 dst_unused:UNUSED_PRESERVE src0_sel:WORD_0
s_add_u32 m0, s72, 3072
s_add_u32 s43, s82, 3072
buffer_load_dwordx4 v246, s[16:19], s43 offen lds
v_rcp_f16_sdwa v159, v159 dst_sel:WORD_0 dst_unused:UNUSED_PRESERVE src0_sel:WORD_0
v_mfma_f32_32x32x16_bf16 v[112:127], v[180:183], v[92:95], v[112:127]
ds_read_b128 v[176:179], v250 offset:57344
v_rcp_f16_sdwa v155, v155 dst_sel:WORD_1 dst_unused:UNUSED_PRESERVE src0_sel:WORD_1
v_rcp_f16_sdwa v157, v157 dst_sel:WORD_1 dst_unused:UNUSED_PRESERVE src0_sel:WORD_1
v_rcp_f16_sdwa v159, v159 dst_sel:WORD_1 dst_unused:UNUSED_PRESERVE src0_sel:WORD_1
s_waitcnt lgkmcnt(4)
v_or_b32 v208, v144, v145
v_mfma_f32_32x32x16_bf16 v[128:143], v[48:51], v[184:187], 0
v_pk_mul_f16 v211, v154, v155
v_pk_mul_f16 v214, v156, v157
v_pk_mul_f16 v215, v158, v159
v_cvt_pkrtz_f16_f32 v161, v160, v161
v_and_b32_e64 v161, s49, v161
v_bfe_u32 v160, v161, 2, 14
v_lshrrev_b32_e64 v161, 18, v161
ds_read_u16 v160, v160
ds_read_u16 v161, v161
v_cvt_pk_f16_f32 v172, v172, v173
v_or_b32_e64 v209, v146, v147
v_cvt_pk_f16_f32 v174, v174, v175
v_mfma_f32_32x32x16_bf16 v[96:111], v[72:75], v[184:187], 0
v_pk_fma_f16 v173, v172, v172, s48
v_cvt_pkrtz_f16_f32 v163, v162, v163
v_and_b32_e64 v163, s49, v163
v_bfe_u32 v162, v163, 2, 14
v_lshrrev_b32_e64 v163, 18, v163
ds_read_u16 v162, v162
ds_read_u16 v163, v163
v_pk_fma_f16 v175, v174, v174, s48
ds_read_b128 v[180:183], v250 offset:58368
v_or_b32_e64 v212, v148, v149
v_pk_mul_f16 v173, v172, v173
v_pk_mul_f16 v175, v174, v175
v_cvt_pkrtz_f16_f32 v165, v164, v165
v_and_b32_e64 v165, s49, v165
v_bfe_u32 v164, v165, 2, 14
v_lshrrev_b32_e64 v165, 18, v165
ds_read_u16 v164, v164
ds_read_u16 v165, v165
s_add_u32 m0, s72, 4096
s_add_u32 s43, s82, 3136
buffer_load_dwordx4 v246, s[16:19], s43 offen lds
v_exp_f16_sdwa v173, v173 dst_sel:WORD_0 dst_unused:UNUSED_PRESERVE src0_sel:WORD_0
v_or_b32 v213, v150, v151
s_waitcnt lgkmcnt(7)
v_mfma_f32_32x32x16_bf16 v[128:143], v[52:55], v[188:191], v[128:143]
v_exp_f16_sdwa v175, v175 dst_sel:WORD_0 dst_unused:UNUSED_PRESERVE src0_sel:WORD_0
v_cvt_pkrtz_f16_f32 v167, v166, v167
v_and_b32_e64 v167, s49, v167
v_bfe_u32 v166, v167, 2, 14
v_lshrrev_b32_e64 v167, 18, v167
ds_read_u16 v166, v166
ds_read_u16 v167, v167
v_exp_f16_sdwa v173, v173 dst_sel:WORD_1 dst_unused:UNUSED_PRESERVE src0_sel:WORD_1
v_or_b32_e64 v210, v152, v153
v_cvt_pkrtz_f16_f32 v169, v168, v169
v_and_b32_e64 v169, s49, v169
v_bfe_u32 v168, v169, 2, 14
v_lshrrev_b32_e64 v169, 18, v169
ds_read_u16 v168, v168
ds_read_u16 v169, v169
v_mfma_f32_32x32x16_bf16 v[96:111], v[76:79], v[188:191], v[96:111]
v_exp_f16_sdwa v175, v175 dst_sel:WORD_1 dst_unused:UNUSED_PRESERVE src0_sel:WORD_1
ds_read_b128 v[184:187], v250 offset:59392
v_cvt_pkrtz_f16_f32 v171, v170, v171
v_and_b32_e64 v171, s49, v171
v_mfma_f32_32x32x16_f16 v[144:159], v[208:211], v[216:219], 0
v_bfe_u32 v170, v171, 2, 14
v_lshrrev_b32_e64 v171, 18, v171
ds_read_u16 v170, v170
ds_read_u16 v171, v171
v_pk_add_f16 v173, v173, 1.0 op_sel_hi:[1,0]
v_pk_add_f16 v175, v175, 1.0 op_sel_hi:[1,0]
v_rcp_f16_sdwa v173, v173 dst_sel:WORD_0 dst_unused:UNUSED_PRESERVE src0_sel:WORD_0
v_mfma_f32_32x32x16_f16 v[144:159], v[212:215], v[220:223], v[144:159]
v_permlane16_swap_b32 v208, v212
v_permlane16_swap_b32 v209, v213
v_permlane16_swap_b32 v210, v214
v_permlane16_swap_b32 v211, v215
v_mfma_f32_32x32x16_bf16 v[128:143], v[56:59], v[176:179], v[128:143]
v_rcp_f16_sdwa v175, v175 dst_sel:WORD_0 dst_unused:UNUSED_PRESERVE src0_sel:WORD_0
v_rcp_f16_sdwa v173, v173 dst_sel:WORD_1 dst_unused:UNUSED_PRESERVE src0_sel:WORD_1
s_add_u32 m0, s72, 6144
s_add_u32 s43, s82, 6144
buffer_load_dwordx4 v246, s[16:19], s43 offen lds
v_mfma_f32_32x32x16_bf16 v[96:111], v[80:83], v[176:179], v[96:111]
v_rcp_f16_sdwa v175, v175 dst_sel:WORD_1 dst_unused:UNUSED_PRESERVE src0_sel:WORD_1
ds_read_b128 v[188:191], v250 offset:60416
v_fmac_f32_e64 v231, v144, v144
v_pk_mul_f16 v172, v172, v173
v_fmac_f32_e64 v231, v145, v145
v_pk_mul_f16 v174, v174, v175
v_fmac_f32 v231, v146, v146
v_fmac_f32 v231, v147, v147
v_fma_mix_f32 v232, v172, v172, v232 op_sel_hi:[1,1,0]
v_fmac_f32 v231, v148, v148
v_fmac_f32 v231, v149, v149
v_fma_mix_f32 v232, v174, v174, v232 op_sel_hi:[1,1,0]
s_waitcnt lgkmcnt(5)
v_mfma_f32_32x32x16_bf16 v[128:143], v[60:63], v[180:183], v[128:143]
v_fmac_f32 v231, v150, v150
v_fma_mix_f32 v232, v172, v172, v232 op_sel:[1,1,0] op_sel_hi:[1,1,0]
v_fmac_f32 v231, v151, v151
v_fmac_f32 v231, v152, v152
v_fma_mix_f32 v232, v174, v174, v232 op_sel:[1,1,0] op_sel_hi:[1,1,0]
v_fmac_f32_e64 v231, v153, v153
v_fma_mix_f32 v232, v160, v160, v232 op_sel_hi:[1,1,0]
v_fmac_f32_e64 v231, v154, v154
v_fma_mix_f32 v232, v161, v161, v232 op_sel_hi:[1,1,0]
v_cvt_pkrtz_f16_f32 v113, v112, v113
v_fma_mix_f32 v232, v162, v162, v232 op_sel_hi:[1,1,0]
v_and_b32_e64 v113, s49, v113
v_fma_mix_f32 v232, v163, v163, v232 op_sel_hi:[1,1,0]
v_bfe_u32 v112, v113, 2, 14
v_lshrrev_b32_e64 v113, 18, v113
ds_read_u16 v112, v112
ds_read_u16_d16_hi v113, v113
v_cvt_pk_f16_f32 v122, v122, v123
v_fmac_f32_e64 v231, v155, v155
v_cvt_pk_f16_f32 v124, v124, v125
v_fmac_f32_e64 v231, v156, v156
v_cvt_pk_f16_f32 v126, v126, v127
v_fmac_f32_e64 v231, v157, v157
v_mfma_f32_32x32x16_bf16 v[96:111], v[84:87], v[180:183], v[96:111]
v_pk_fma_f16 v123, v122, v122, s48
v_fmac_f32_e64 v231, v158, v158
v_fma_mix_f32 v232, v164, v164, v232 op_sel_hi:[1,1,0]
v_fmac_f32_e64 v231, v159, v159
v_fma_mix_f32 v232, v165, v165, v232 op_sel_hi:[1,1,0]
s_nop 0
v_permlane32_swap_b32 v230, v231
v_add_f32_e64 v230, v230, v231
ds_write_b32 v248, v230 offset:8192
ds_read_b128 v[176:179], v250 offset:61440
v_pk_fma_f16 v125, v124, v124, s48
v_cvt_pkrtz_f16_f32 v115, v114, v115
v_and_b32_e64 v115, s49, v115
v_bfe_u32 v114, v115, 2, 14
v_lshrrev_b32_e64 v115, 18, v115
ds_read_u16 v114, v114
ds_read_u16_d16_hi v115, v115
v_pk_fma_f16 v127, v126, v126, s48
v_pk_mul_f16 v123, v122, v123
v_fma_mix_f32 v232, v166, v166, v232 op_sel_hi:[1,1,0]
v_pk_mul_f16 v125, v124, v125
v_fma_mix_f32 v232, v167, v167, v232 op_sel_hi:[1,1,0]
s_add_u32 m0, s72, 7168
s_add_u32 s43, s82, 6208
buffer_load_dwordx4 v246, s[16:19], s43 offen lds
v_pk_mul_f16 v127, v126, v127
v_cvt_pkrtz_f16_f32 v117, v116, v117
v_and_b32_e64 v117, s49, v117
v_bfe_u32 v116, v117, 2, 14
v_lshrrev_b32 v117, 18, v117
ds_read_u16 v116, v116
ds_read_u16_d16_hi v117, v117
v_exp_f16_sdwa v123, v123 dst_sel:WORD_0 dst_unused:UNUSED_PRESERVE src0_sel:WORD_0
s_waitcnt lgkmcnt(6)
v_mfma_f32_32x32x16_bf16 v[128:143], v[64:67], v[184:187], v[128:143]
v_fma_mix_f32 v232, v168, v168, v232 op_sel_hi:[1,1,0]
v_exp_f16_sdwa v125, v125 dst_sel:WORD_0 dst_unused:UNUSED_PRESERVE src0_sel:WORD_0
v_fma_mix_f32 v232, v169, v169, v232 op_sel_hi:[1,1,0]
v_cvt_pkrtz_f16_f32 v119, v118, v119
v_and_b32_e64 v119, s49, v119
v_bfe_u32 v118, v119, 2, 14
v_lshrrev_b32_e64 v119, 18, v119
ds_read_u16 v118, v118
ds_read_u16_d16_hi v119, v119
v_exp_f16_sdwa v127, v127 dst_sel:WORD_0 dst_unused:UNUSED_PRESERVE src0_sel:WORD_0
v_fma_mix_f32 v232, v170, v170, v232 op_sel_hi:[1,1,0]
v_exp_f16_sdwa v123, v123 dst_sel:WORD_1 dst_unused:UNUSED_PRESERVE src0_sel:WORD_1
v_fma_mix_f32 v232, v171, v171, v232 op_sel_hi:[1,1,0]
v_mfma_f32_32x32x16_bf16 v[96:111], v[88:91], v[184:187], v[96:111]
ds_read_b128 v[180:183], v250 offset:62464
v_exp_f16_sdwa v125, v125 dst_sel:WORD_1 dst_unused:UNUSED_PRESERVE src0_sel:WORD_1
v_cvt_pkrtz_f16_f32 v121, v120, v121
v_and_b32_e64 v121, s49, v121
v_bfe_u32 v120, v121, 2, 14
v_lshrrev_b32_e64 v121, 18, v121
ds_read_u16 v120, v120
ds_read_u16_d16_hi v121, v121
v_exp_f16_sdwa v127, v127 dst_sel:WORD_1 dst_unused:UNUSED_PRESERVE src0_sel:WORD_1
v_pk_add_f16 v123, v123, 1.0 op_sel_hi:[1,0]
v_pk_add_f16 v125, v125, 1.0 op_sel_hi:[1,0]
v_mfma_f32_32x32x16_bf16 v[128:143], v[68:71], v[188:191], v[128:143]
v_pk_add_f16 v127, v127, 1.0 op_sel_hi:[1,0]
v_rcp_f16_sdwa v123, v123 dst_sel:WORD_0 dst_unused:UNUSED_PRESERVE src0_sel:WORD_0
v_rcp_f16_sdwa v125, v125 dst_sel:WORD_0 dst_unused:UNUSED_PRESERVE src0_sel:WORD_0
v_rcp_f16_sdwa v127, v127 dst_sel:WORD_0 dst_unused:UNUSED_PRESERVE src0_sel:WORD_0
v_mfma_f32_32x32x16_bf16 v[96:111], v[92:95], v[188:191], v[96:111]
ds_read_b128 v[184:187], v250 offset:63488
v_rcp_f16_sdwa v123, v123 dst_sel:WORD_1 dst_unused:UNUSED_PRESERVE src0_sel:WORD_1
v_rcp_f16_sdwa v125, v125 dst_sel:WORD_1 dst_unused:UNUSED_PRESERVE src0_sel:WORD_1
v_rcp_f16_sdwa v127, v127 dst_sel:WORD_1 dst_unused:UNUSED_PRESERVE src0_sel:WORD_1
v_or_b32 v224, v112, v113
s_waitcnt lgkmcnt(4)
v_mfma_f32_32x32x16_bf16 v[144:159], v[48:51], v[176:179], 0
v_pk_mul_f16 v227, v122, v123
v_pk_mul_f16 v230, v124, v125
v_pk_mul_f16 v231, v126, v127
v_cvt_pkrtz_f16_f32 v129, v128, v129
v_and_b32_e64 v129, s49, v129
v_bfe_u32 v128, v129, 2, 14
v_lshrrev_b32_e64 v129, 18, v129
ds_read_u16 v128, v128
ds_read_u16 v129, v129
v_cvt_pk_f16_f32 v140, v140, v141
v_or_b32_e64 v225, v114, v115
v_cvt_pk_f16_f32 v142, v142, v143
v_mfma_f32_32x32x16_bf16 v[160:175], v[176:179], v[72:75], 0
v_pk_fma_f16 v141, v140, v140, s48
v_cvt_pkrtz_f16_f32 v131, v130, v131
v_and_b32_e64 v131, s49, v131
v_bfe_u32 v130, v131, 2, 14
v_lshrrev_b32_e64 v131, 18, v131
ds_read_u16 v130, v130
ds_read_u16 v131, v131
v_pk_fma_f16 v143, v142, v142, s48
ds_read_b128 v[188:191], v250 offset:64512
v_or_b32_e64 v228, v116, v117
v_pk_mul_f16 v141, v140, v141
v_pk_mul_f16 v143, v142, v143
v_cvt_pkrtz_f16_f32 v133, v132, v133
v_and_b32_e64 v133, s49, v133
v_bfe_u32 v132, v133, 2, 14
v_lshrrev_b32_e64 v133, 18, v133
ds_read_u16 v132, v132
ds_read_u16 v133, v133
v_exp_f16_sdwa v141, v141 dst_sel:WORD_0 dst_unused:UNUSED_PRESERVE src0_sel:WORD_0
v_or_b32 v229, v118, v119
s_waitcnt lgkmcnt(7)
v_mfma_f32_32x32x16_bf16 v[144:159], v[52:55], v[180:183], v[144:159]
v_exp_f16_sdwa v143, v143 dst_sel:WORD_0 dst_unused:UNUSED_PRESERVE src0_sel:WORD_0
v_cvt_pkrtz_f16_f32 v135, v134, v135
v_and_b32_e64 v135, s49, v135
v_bfe_u32 v134, v135, 2, 14
v_lshrrev_b32_e64 v135, 18, v135
ds_read_u16 v134, v134
ds_read_u16 v135, v135
v_exp_f16_sdwa v141, v141 dst_sel:WORD_1 dst_unused:UNUSED_PRESERVE src0_sel:WORD_1
v_or_b32_e64 v226, v120, v121
v_cvt_pkrtz_f16_f32 v137, v136, v137
v_and_b32_e64 v137, s49, v137
v_bfe_u32 v136, v137, 2, 14
v_lshrrev_b32_e64 v137, 18, v137
ds_read_u16 v136, v136
ds_read_u16 v137, v137
v_mfma_f32_32x32x16_bf16 v[160:175], v[180:183], v[76:79], v[160:175]
v_exp_f16_sdwa v143, v143 dst_sel:WORD_1 dst_unused:UNUSED_PRESERVE src0_sel:WORD_1
ds_read_b128 v[176:179], v251
v_cvt_pkrtz_f16_f32 v139, v138, v139
v_and_b32_e64 v139, s49, v139
v_mfma_f32_32x32x16_f16 v[112:127], v[224:227], v[216:219], 0
v_bfe_u32 v138, v139, 2, 14
v_lshrrev_b32_e64 v139, 18, v139
ds_read_u16 v138, v138
ds_read_u16 v139, v139
v_pk_add_f16 v141, v141, 1.0 op_sel_hi:[1,0]
v_pk_add_f16 v143, v143, 1.0 op_sel_hi:[1,0]
v_rcp_f16_sdwa v141, v141 dst_sel:WORD_0 dst_unused:UNUSED_PRESERVE src0_sel:WORD_0
v_mfma_f32_32x32x16_f16 v[112:127], v[228:231], v[220:223], v[112:127]
v_permlane16_swap_b32 v224, v228
v_permlane16_swap_b32 v225, v229
v_permlane16_swap_b32 v226, v230
v_permlane16_swap_b32 v227, v231
v_mfma_f32_32x32x16_bf16 v[144:159], v[56:59], v[184:187], v[144:159]
v_rcp_f16_sdwa v143, v143 dst_sel:WORD_0 dst_unused:UNUSED_PRESERVE src0_sel:WORD_0
v_rcp_f16_sdwa v141, v141 dst_sel:WORD_1 dst_unused:UNUSED_PRESERVE src0_sel:WORD_1
v_mfma_f32_32x32x16_bf16 v[160:175], v[184:187], v[80:83], v[160:175]
v_rcp_f16_sdwa v143, v143 dst_sel:WORD_1 dst_unused:UNUSED_PRESERVE src0_sel:WORD_1
ds_read_b128 v[180:183], v251 offset:1024
s_nop 1
v_fmac_f32 v232, v112, v112
v_pk_mul_f16 v140, v140, v141
v_fmac_f32_e64 v232, v113, v113
v_pk_mul_f16 v142, v142, v143
v_fmac_f32 v232, v114, v114
v_fmac_f32 v232, v115, v115
v_fma_mix_f32 v233, v140, v140, v233 op_sel_hi:[1,1,0]
v_fmac_f32 v232, v116, v116
v_fmac_f32 v232, v117, v117
v_fma_mix_f32 v233, v142, v142, v233 op_sel_hi:[1,1,0]
s_waitcnt lgkmcnt(6)
v_mfma_f32_32x32x16_bf16 v[144:159], v[60:63], v[188:191], v[144:159]
v_fmac_f32 v232, v118, v118
v_fma_mix_f32 v233, v140, v140, v233 op_sel:[1,1,0] op_sel_hi:[1,1,0]
v_fmac_f32 v232, v119, v119
v_fmac_f32 v232, v120, v120
v_fma_mix_f32 v233, v142, v142, v233 op_sel:[1,1,0] op_sel_hi:[1,1,0]
v_fmac_f32_e64 v232, v121, v121
v_fma_mix_f32 v233, v128, v128, v233 op_sel_hi:[1,1,0]
v_fmac_f32_e64 v232, v122, v122
v_fma_mix_f32 v233, v129, v129, v233 op_sel_hi:[1,1,0]
v_cvt_pkrtz_f16_f32 v97, v96, v97
v_fma_mix_f32 v233, v130, v130, v233 op_sel_hi:[1,1,0]
v_and_b32_e64 v97, s49, v97
v_fma_mix_f32 v233, v131, v131, v233 op_sel_hi:[1,1,0]
v_bfe_u32 v96, v97, 2, 14
v_lshrrev_b32_e64 v97, 18, v97
ds_read_u16 v96, v96
ds_read_u16 v97, v97
v_cvt_pk_f16_f32 v106, v106, v107
v_fmac_f32_e64 v232, v123, v123
v_cvt_pk_f16_f32 v108, v108, v109
v_fmac_f32_e64 v232, v124, v124
v_cvt_pk_f16_f32 v110, v110, v111
v_fmac_f32_e64 v232, v125, v125
v_mfma_f32_32x32x16_bf16 v[160:175], v[188:191], v[84:87], v[160:175]
v_pk_fma_f16 v107, v106, v106, s48
v_fmac_f32_e64 v232, v126, v126
v_fma_mix_f32 v233, v132, v132, v233 op_sel_hi:[1,1,0]
v_pk_fma_f16 v109, v108, v108, s48
v_fma_mix_f32 v233, v133, v133, v233 op_sel_hi:[1,1,0]
v_fmac_f32_e64 v232, v127, v127
ds_read_b128 v[184:187], v251 offset:2048
v_cvt_pkrtz_f16_f32 v99, v98, v99
v_and_b32_e64 v99, s49, v99
v_bfe_u32 v98, v99, 2, 14
v_lshrrev_b32_e64 v99, 18, v99
ds_read_u16 v98, v98
ds_read_u16 v99, v99
v_pk_fma_f16 v111, v110, v110, s48
v_pk_mul_f16 v107, v106, v107
v_pk_mul_f16 v109, v108, v109
v_fma_mix_f32 v233, v134, v134, v233 op_sel_hi:[1,1,0]
v_pk_mul_f16 v111, v110, v111
v_fma_mix_f32 v233, v135, v135, v233 op_sel_hi:[1,1,0]
v_exp_f16_sdwa v107, v107 dst_sel:WORD_0 dst_unused:UNUSED_PRESERVE src0_sel:WORD_0
v_cvt_pkrtz_f16_f32 v101, v100, v101
v_and_b32_e64 v101, s49, v101
v_bfe_u32 v100, v101, 2, 14
v_lshrrev_b32 v101, 18, v101
ds_read_u16 v100, v100
ds_read_u16 v101, v101
s_waitcnt lgkmcnt(6)
v_mfma_f32_32x32x16_bf16 v[144:159], v[64:67], v[176:179], v[144:159]
v_exp_f16_sdwa v109, v109 dst_sel:WORD_0 dst_unused:UNUSED_PRESERVE src0_sel:WORD_0
v_fma_mix_f32 v233, v136, v136, v233 op_sel_hi:[1,1,0]
v_exp_f16_sdwa v111, v111 dst_sel:WORD_0 dst_unused:UNUSED_PRESERVE src0_sel:WORD_0
v_fma_mix_f32 v233, v137, v137, v233 op_sel_hi:[1,1,0]
v_cvt_pkrtz_f16_f32 v103, v102, v103
v_and_b32_e64 v103, s49, v103
v_bfe_u32 v102, v103, 2, 14
v_lshrrev_b32_e64 v103, 18, v103
ds_read_u16 v102, v102
ds_read_u16 v103, v103
v_exp_f16_sdwa v107, v107 dst_sel:WORD_1 dst_unused:UNUSED_PRESERVE src0_sel:WORD_1
v_fma_mix_f32 v233, v138, v138, v233 op_sel_hi:[1,1,0]
v_exp_f16_sdwa v109, v109 dst_sel:WORD_1 dst_unused:UNUSED_PRESERVE src0_sel:WORD_1
v_fma_mix_f32 v233, v139, v139, v233 op_sel_hi:[1,1,0]
v_mfma_f32_32x32x16_bf16 v[160:175], v[176:179], v[88:91], v[160:175]
v_exp_f16_sdwa v111, v111 dst_sel:WORD_1 dst_unused:UNUSED_PRESERVE src0_sel:WORD_1
ds_read_b128 v[188:191], v251 offset:3072
v_cvt_pkrtz_f16_f32 v105, v104, v105
v_and_b32_e64 v105, s49, v105
v_bfe_u32 v104, v105, 2, 14
v_lshrrev_b32_e64 v105, 18, v105
ds_read_u16 v104, v104
ds_read_u16 v105, v105
v_pk_add_f16 v107, v107, 1.0 op_sel_hi:[1,0]
v_pk_add_f16 v109, v109, 1.0 op_sel_hi:[1,0]
v_pk_add_f16 v111, v111, 1.0 op_sel_hi:[1,0]
v_rcp_f16_sdwa v107, v107 dst_sel:WORD_0 dst_unused:UNUSED_PRESERVE src0_sel:WORD_0
v_mfma_f32_32x32x16_bf16 v[144:159], v[68:71], v[180:183], v[144:159]
v_rcp_f16_sdwa v109, v109 dst_sel:WORD_0 dst_unused:UNUSED_PRESERVE src0_sel:WORD_0
v_rcp_f16_sdwa v111, v111 dst_sel:WORD_0 dst_unused:UNUSED_PRESERVE src0_sel:WORD_0
v_rcp_f16_sdwa v107, v107 dst_sel:WORD_1 dst_unused:UNUSED_PRESERVE src0_sel:WORD_1
v_rcp_f16_sdwa v109, v109 dst_sel:WORD_1 dst_unused:UNUSED_PRESERVE src0_sel:WORD_1
v_mfma_f32_32x32x16_bf16 v[160:175], v[180:183], v[92:95], v[160:175]
v_rcp_f16_sdwa v111, v111 dst_sel:WORD_1 dst_unused:UNUSED_PRESERVE src0_sel:WORD_1
ds_read_b128 v[176:179], v251 offset:4096
v_pk_mul_f16 v106, v106, v107
v_pk_mul_f16 v108, v108, v109
v_pk_mul_f16 v110, v110, v111
v_fma_mix_f32 v233, v106, v106, v233 op_sel_hi:[1,1,0]
s_waitcnt lgkmcnt(3)
v_mfma_f32_32x32x16_bf16 v[112:127], v[48:51], v[184:187], 0
v_fma_mix_f32 v233, v108, v108, v233 op_sel_hi:[1,1,0]
v_bfe_u32 v237, v250, 4, 6
v_min_u32 v237, 47, v237
v_lshlrev_b32_e64 v244, 5, v237
v_add_u32 v244, 95232, v244
v_add_u32 v245, 2304, v244
v_cmp_gt_u32 vcc, 24, v237
s_nop 1
v_cndmask_b32 v244, v245, v244, vcc
v_lshlrev_b32 v237, 13, v237
v_add_u32 v245, 4096, v237
v_fma_mix_f32 v233, v110, v110, v233 op_sel_hi:[1,1,0]
v_cvt_pkrtz_f16_f32 v145, v144, v145
v_fma_mix_f32 v233, v106, v106, v233 op_sel:[1,1,0] op_sel_hi:[1,1,0]
v_and_b32_e64 v145, s49, v145
v_fma_mix_f32 v233, v108, v108, v233 op_sel:[1,1,0] op_sel_hi:[1,1,0]
v_bfe_u32 v144, v145, 2, 14
v_fma_mix_f32 v233, v110, v110, v233 op_sel:[1,1,0] op_sel_hi:[1,1,0]
v_lshrrev_b32_e64 v145, 18, v145
v_fma_mix_f32 v233, v96, v96, v233 op_sel_hi:[1,1,0]
ds_read_u16 v144, v144
v_fma_mix_f32 v233, v97, v97, v233 op_sel_hi:[1,1,0]
ds_read_u16 v145, v145
v_cvt_pk_f16_f32 v156, v156, v157
v_fma_mix_f32 v233, v98, v98, v233 op_sel_hi:[1,1,0]
v_cvt_pk_f16_f32 v158, v158, v159
v_fma_mix_f32 v233, v99, v99, v233 op_sel_hi:[1,1,0]
v_mfma_f32_32x32x16_bf16 v[128:143], v[184:187], v[72:75], 0
v_pk_fma_f16 v157, v156, v156, s48
v_cvt_pkrtz_f16_f32 v147, v146, v147
v_and_b32_e64 v147, s49, v147
v_bfe_u32 v146, v147, 2, 14
v_lshrrev_b32_e64 v147, 18, v147
ds_read_u16 v146, v146
ds_read_u16 v147, v147
v_pk_fma_f16 v159, v158, v158, s48
ds_read_b128 v[180:183], v251 offset:5120
v_fma_mix_f32 v233, v100, v100, v233 op_sel_hi:[1,1,0]
v_pk_mul_f16 v157, v156, v157
v_fma_mix_f32 v233, v101, v101, v233 op_sel_hi:[1,1,0]
v_pk_mul_f16 v159, v158, v159
v_cvt_pkrtz_f16_f32 v149, v148, v149
v_and_b32_e64 v149, s49, v149
v_bfe_u32 v148, v149, 2, 14
v_lshrrev_b32_e64 v149, 18, v149
ds_read_u16 v148, v148
ds_read_u16 v149, v149
v_exp_f16_sdwa v157, v157 dst_sel:WORD_0 dst_unused:UNUSED_PRESERVE src0_sel:WORD_0
v_fma_mix_f32 v233, v102, v102, v233 op_sel_hi:[1,1,0]
v_mfma_f32_32x32x16_bf16 v[112:127], v[52:55], v[188:191], v[112:127]
v_fma_mix_f32 v233, v103, v103, v233 op_sel_hi:[1,1,0]
v_exp_f16_sdwa v159, v159 dst_sel:WORD_0 dst_unused:UNUSED_PRESERVE src0_sel:WORD_0
v_cvt_pkrtz_f16_f32 v151, v150, v151
v_and_b32_e64 v151, s49, v151
v_bfe_u32 v150, v151, 2, 14
v_lshrrev_b32 v151, 18, v151
ds_read_u16 v150, v150
ds_read_u16 v151, v151
v_exp_f16_sdwa v157, v157 dst_sel:WORD_1 dst_unused:UNUSED_PRESERVE src0_sel:WORD_1
s_waitcnt lgkmcnt(7)
v_fma_mix_f32 v233, v104, v104, v233 op_sel_hi:[1,1,0]
v_cvt_pkrtz_f16_f32 v153, v152, v153
v_fma_mix_f32 v233, v105, v105, v233 op_sel_hi:[1,1,0]
v_and_b32_e64 v153, s49, v153
v_bfe_u32 v152, v153, 2, 14
v_lshrrev_b32_e64 v153, 18, v153
ds_read_u16 v152, v152
ds_read_u16 v153, v153
v_mfma_f32_32x32x16_bf16 v[128:143], v[188:191], v[76:79], v[128:143]
v_exp_f16_sdwa v159, v159 dst_sel:WORD_1 dst_unused:UNUSED_PRESERVE src0_sel:WORD_1
ds_read_b128 v[184:187], v251 offset:6144
v_cvt_pkrtz_f16_f32 v155, v154, v155
v_and_b32_e64 v155, s49, v155
v_bfe_u32 v154, v155, 2, 14
v_lshrrev_b32_e64 v155, 18, v155
ds_read_u16 v154, v154
ds_read_u16 v155, v155
v_pk_add_f16 v157, v157, 1.0 op_sel_hi:[1,0]
v_pk_add_f16 v159, v159, 1.0 op_sel_hi:[1,0]
v_rcp_f16_sdwa v157, v157 dst_sel:WORD_0 dst_unused:UNUSED_PRESERVE src0_sel:WORD_0
v_mfma_f32_32x32x16_bf16 v[112:127], v[56:59], v[176:179], v[112:127]
v_rcp_f16_sdwa v159, v159 dst_sel:WORD_0 dst_unused:UNUSED_PRESERVE src0_sel:WORD_0
v_rcp_f16_sdwa v157, v157 dst_sel:WORD_1 dst_unused:UNUSED_PRESERVE src0_sel:WORD_1
v_mfma_f32_32x32x16_bf16 v[128:143], v[176:179], v[80:83], v[128:143]
v_rcp_f16_sdwa v159, v159 dst_sel:WORD_1 dst_unused:UNUSED_PRESERVE src0_sel:WORD_1
ds_read_b128 v[188:191], v251 offset:7168
v_pk_mul_f16 v156, v156, v157
v_pk_mul_f16 v158, v158, v159
v_fma_mix_f32 v234, v156, v156, v234 op_sel_hi:[1,1,0]
s_waitcnt lgkmcnt(7)
v_mfma_f32_32x32x16_bf16 v[112:127], v[60:63], v[180:183], v[112:127]
v_fma_mix_f32 v234, v158, v158, v234 op_sel_hi:[1,1,0]
v_permlane32_swap_b32 v232, v233
v_add_f32 v232, v232, v233
ds_write_b32 v248, v232 offset:8448
s_setprio 1
v_fma_mix_f32 v234, v156, v156, v234 op_sel:[1,1,0] op_sel_hi:[1,1,0]
v_cvt_pkrtz_f16_f32 v161, v160, v161
v_fma_mix_f32 v234, v158, v158, v234 op_sel:[1,1,0] op_sel_hi:[1,1,0]
v_and_b32_e64 v161, s49, v161
v_fma_mix_f32 v234, v144, v144, v234 op_sel_hi:[1,1,0]
v_bfe_u32 v160, v161, 2, 14
v_fma_mix_f32 v234, v145, v145, v234 op_sel_hi:[1,1,0]
v_lshrrev_b32_e64 v161, 18, v161
v_fma_mix_f32 v234, v146, v146, v234 op_sel_hi:[1,1,0]
ds_read_u16 v160, v160
v_fma_mix_f32 v234, v147, v147, v234 op_sel_hi:[1,1,0]
ds_read_u16_d16_hi v161, v161
v_cvt_pk_f16_f32 v170, v170, v171
v_cvt_pk_f16_f32 v172, v172, v173
v_cvt_pk_f16_f32 v174, v174, v175
v_mfma_f32_32x32x16_bf16 v[128:143], v[180:183], v[84:87], v[128:143]
v_pk_fma_f16 v171, v170, v170, s48
v_fma_mix_f32 v234, v148, v148, v234 op_sel_hi:[1,1,0]
v_pk_fma_f16 v173, v172, v172, s48
v_fma_mix_f32 v234, v149, v149, v234 op_sel_hi:[1,1,0]
v_cvt_pkrtz_f16_f32 v163, v162, v163
v_and_b32_e64 v163, s49, v163
v_bfe_u32 v162, v163, 2, 14
v_lshrrev_b32 v163, 18, v163
ds_read_u16 v162, v162
ds_read_u16_d16_hi v163, v163
v_pk_fma_f16 v175, v174, v174, s48
v_pk_mul_f16 v171, v170, v171
v_fma_mix_f32 v234, v150, v150, v234 op_sel_hi:[1,1,0]
v_pk_mul_f16 v173, v172, v173
s_waitcnt lgkmcnt(6)
v_fma_mix_f32 v234, v151, v151, v234 op_sel_hi:[1,1,0]
s_getpc_b64 s[74:75]
Lcq7:
s_lshl_b32 s43, s40, 10
s_add_u32 s43, s43, 6144
s_min_u32 s43, s43, Lend-Lcq7-1024
s_add_u32 s74, s74, s43
s_addc_u32 s75, s75, 0
s_sub_u32 s74, s74, 16384
s_subb_u32 s75, s75, 0
s_mov_b32 m0, 163840
s_nop 0
global_load_lds_dword v250, s[74:75]
v_pk_mul_f16 v175, v174, v175
v_cvt_pkrtz_f16_f32 v165, v164, v165
v_and_b32_e64 v165, s49, v165
v_bfe_u32 v164, v165, 2, 14
v_lshrrev_b32_e64 v165, 18, v165
ds_read_u16 v164, v164
ds_read_u16_d16_hi v165, v165
v_exp_f16_sdwa v171, v171 dst_sel:WORD_0 dst_unused:UNUSED_PRESERVE src0_sel:WORD_0
v_mfma_f32_32x32x16_bf16 v[112:127], v[64:67], v[184:187], v[112:127]
v_fma_mix_f32 v234, v152, v152, v234 op_sel_hi:[1,1,0]
v_exp_f16_sdwa v173, v173 dst_sel:WORD_0 dst_unused:UNUSED_PRESERVE src0_sel:WORD_0
v_fma_mix_f32 v234, v153, v153, v234 op_sel_hi:[1,1,0]
v_cvt_pkrtz_f16_f32 v167, v166, v167
v_and_b32_e64 v167, s49, v167
v_bfe_u32 v166, v167, 2, 14
v_lshrrev_b32_e64 v167, 18, v167
ds_read_u16 v166, v166
ds_read_u16_d16_hi v167, v167
v_exp_f16_sdwa v175, v175 dst_sel:WORD_0 dst_unused:UNUSED_PRESERVE src0_sel:WORD_0
v_fma_mix_f32 v234, v154, v154, v234 op_sel_hi:[1,1,0]
v_exp_f16_sdwa v171, v171 dst_sel:WORD_1 dst_unused:UNUSED_PRESERVE src0_sel:WORD_1
v_fma_mix_f32 v234, v155, v155, v234 op_sel_hi:[1,1,0]
v_mfma_f32_32x32x16_bf16 v[128:143], v[184:187], v[88:91], v[128:143]
v_exp_f16_sdwa v173, v173 dst_sel:WORD_1 dst_unused:UNUSED_PRESERVE src0_sel:WORD_1
v_cvt_pkrtz_f16_f32 v169, v168, v169
v_and_b32_e64 v169, s49, v169
v_bfe_u32 v168, v169, 2, 14
v_lshrrev_b32 v169, 18, v169
ds_read_u16 v168, v168
ds_read_u16_d16_hi v169, v169
v_exp_f16_sdwa v175, v175 dst_sel:WORD_1 dst_unused:UNUSED_PRESERVE src0_sel:WORD_1
v_pk_add_f16 v171, v171, 1.0 op_sel_hi:[1,0]
v_pk_add_f16 v173, v173, 1.0 op_sel_hi:[1,0]
s_waitcnt lgkmcnt(6)
v_mfma_f32_32x32x16_bf16 v[112:127], v[68:71], v[188:191], v[112:127]
v_pk_add_f16 v175, v175, 1.0 op_sel_hi:[1,0]
v_rcp_f16_sdwa v171, v171 dst_sel:WORD_0 dst_unused:UNUSED_PRESERVE src0_sel:WORD_0
v_rcp_f16_sdwa v173, v173 dst_sel:WORD_0 dst_unused:UNUSED_PRESERVE src0_sel:WORD_0
v_rcp_f16_sdwa v175, v175 dst_sel:WORD_0 dst_unused:UNUSED_PRESERVE src0_sel:WORD_0
v_mfma_f32_32x32x16_bf16 v[128:143], v[188:191], v[92:95], v[128:143]
v_rcp_f16_sdwa v171, v171 dst_sel:WORD_1 dst_unused:UNUSED_PRESERVE src0_sel:WORD_1
v_rcp_f16_sdwa v173, v173 dst_sel:WORD_1 dst_unused:UNUSED_PRESERVE src0_sel:WORD_1
v_rcp_f16_sdwa v175, v175 dst_sel:WORD_1 dst_unused:UNUSED_PRESERVE src0_sel:WORD_1
v_or_b32_e64 v96, v160, v161
v_pk_mul_f16 v99, v170, v171
v_pk_mul_f16 v102, v172, v173
v_pk_mul_f16 v103, v174, v175
v_or_b32 v97, v162, v163
ds_read_b128 v[176:179], v250
s_nop 2
v_cvt_pkrtz_f16_f32 v129, v128, v129
v_and_b32_e64 v129, s49, v129
v_bfe_u32 v128, v129, 2, 14
v_lshrrev_b32_e64 v129, 18, v129
ds_read_u16 v128, v128
ds_read_u16_d16_hi v129, v129
v_cvt_pk_f16_f32 v138, v138, v139
v_cvt_pk_f16_f32 v140, v140, v141
v_cvt_pk_f16_f32 v142, v142, v143
v_pk_fma_f16 v139, v138, v138, s48
v_pk_fma_f16 v141, v140, v140, s48
v_cvt_pkrtz_f16_f32 v131, v130, v131
v_and_b32_e64 v131, s49, v131
v_bfe_u32 v130, v131, 2, 14
v_lshrrev_b32_e64 v131, 18, v131
ds_read_u16 v130, v130
ds_read_u16_d16_hi v131, v131
s_waitcnt lgkmcnt(5)
v_or_b32 v100, v164, v165
v_pk_fma_f16 v143, v142, v142, s48
v_pk_mul_f16 v139, v138, v139
v_pk_mul_f16 v141, v140, v141
v_pk_mul_f16 v143, v142, v143
v_cvt_pkrtz_f16_f32 v133, v132, v133
v_and_b32_e64 v133, s49, v133
v_bfe_u32 v132, v133, 2, 14
v_lshrrev_b32_e64 v133, 18, v133
ds_read_u16 v132, v132
ds_read_u16_d16_hi v133, v133
v_or_b32_e64 v101, v166, v167
v_exp_f16_sdwa v139, v139 dst_sel:WORD_0 dst_unused:UNUSED_PRESERVE src0_sel:WORD_0
ds_read_b128 v[180:183], v250 offset:1024
v_exp_f16_sdwa v141, v141 dst_sel:WORD_0 dst_unused:UNUSED_PRESERVE src0_sel:WORD_0
v_cvt_pkrtz_f16_f32 v135, v134, v135
v_and_b32_e64 v135, s49, v135
v_bfe_u32 v134, v135, 2, 14
v_lshrrev_b32_e64 v135, 18, v135
ds_read_u16 v134, v134
ds_read_u16_d16_hi v135, v135
v_exp_f16_sdwa v143, v143 dst_sel:WORD_0 dst_unused:UNUSED_PRESERVE src0_sel:WORD_0
v_or_b32_e64 v98, v168, v169
v_exp_f16_sdwa v139, v139 dst_sel:WORD_1 dst_unused:UNUSED_PRESERVE src0_sel:WORD_1
ds_read_b128 v[184:187], v250 offset:2048
v_exp_f16_sdwa v141, v141 dst_sel:WORD_1 dst_unused:UNUSED_PRESERVE src0_sel:WORD_1
v_cvt_pkrtz_f16_f32 v137, v136, v137
v_and_b32_e64 v137, s49, v137
v_bfe_u32 v136, v137, 2, 14
v_lshrrev_b32_e64 v137, 18, v137
ds_read_u16 v136, v136
ds_read_u16_d16_hi v137, v137
v_mfma_f32_32x32x16_f16 v[160:175], v[96:99], v[216:219], 0
v_exp_f16_sdwa v143, v143 dst_sel:WORD_1 dst_unused:UNUSED_PRESERVE src0_sel:WORD_1
v_pk_add_f16 v139, v139, 1.0 op_sel_hi:[1,0]
v_pk_add_f16 v141, v141, 1.0 op_sel_hi:[1,0]
v_mfma_f32_32x32x16_f16 v[160:175], v[100:103], v[220:223], v[160:175]
v_pk_add_f16 v143, v143, 1.0 op_sel_hi:[1,0]
v_permlane16_swap_b32 v96, v100
v_permlane16_swap_b32 v97, v101
v_permlane16_swap_b32 v98, v102
v_permlane16_swap_b32 v99, v103
ds_read_b128 v[188:191], v250 offset:3072
v_rcp_f16_sdwa v139, v139 dst_sel:WORD_0 dst_unused:UNUSED_PRESERVE src0_sel:WORD_0
v_rcp_f16_sdwa v141, v141 dst_sel:WORD_0 dst_unused:UNUSED_PRESERVE src0_sel:WORD_0
v_rcp_f16_sdwa v143, v143 dst_sel:WORD_0 dst_unused:UNUSED_PRESERVE src0_sel:WORD_0
v_rcp_f16_sdwa v139, v139 dst_sel:WORD_1 dst_unused:UNUSED_PRESERVE src0_sel:WORD_1
s_nop 1
v_fmac_f32 v234, v160, v160
v_fmac_f32_e64 v234, v161, v161
v_rcp_f16_sdwa v141, v141 dst_sel:WORD_1 dst_unused:UNUSED_PRESERVE src0_sel:WORD_1
v_fmac_f32 v234, v162, v162
v_fmac_f32 v234, v163, v163
v_rcp_f16_sdwa v143, v143 dst_sel:WORD_1 dst_unused:UNUSED_PRESERVE src0_sel:WORD_1
v_fmac_f32 v234, v164, v164
v_fmac_f32 v234, v165, v165
s_waitcnt lgkmcnt(5)
v_or_b32 v104, v128, v129
v_mfma_f32_32x32x16_bf16 v[144:159], v[176:179], v[72:75], 0
ds_read_b128 v[176:179], v250 offset:4096
v_fmac_f32_e64 v234, v166, v166
v_pk_mul_f16 v107, v138, v139
v_fmac_f32_e64 v234, v167, v167
v_pk_mul_f16 v110, v140, v141
v_fmac_f32_e64 v234, v168, v168
v_pk_mul_f16 v111, v142, v143
v_fmac_f32 v234, v169, v169
v_fmac_f32 v234, v170, v170
v_cvt_pkrtz_f16_f32 v113, v112, v113
v_and_b32_e64 v113, s49, v113
v_bfe_u32 v112, v113, 2, 14
v_lshrrev_b32_e64 v113, 18, v113
ds_read_u16 v112, v112
ds_read_u16 v113, v113
v_cvt_pk_f16_f32 v124, v124, v125
v_or_b32 v105, v130, v131
v_fmac_f32 v234, v171, v171
v_cvt_pk_f16_f32 v126, v126, v127
v_fmac_f32 v234, v172, v172
v_fmac_f32 v234, v173, v173
v_mfma_f32_32x32x16_bf16 v[144:159], v[180:183], v[76:79], v[144:159]
ds_read_b128 v[180:183], v250 offset:5120
v_pk_fma_f16 v125, v124, v124, s48
v_fmac_f32_e64 v234, v174, v174
v_cvt_pkrtz_f16_f32 v115, v114, v115
v_and_b32_e64 v115, s49, v115
v_bfe_u32 v114, v115, 2, 14
v_lshrrev_b32_e64 v115, 18, v115
ds_read_u16 v114, v114
ds_read_u16 v115, v115
v_fmac_f32_e64 v234, v175, v175
v_pk_fma_f16 v127, v126, v126, s48
v_or_b32_e64 v108, v132, v133
v_pk_mul_f16 v125, v124, v125
v_pk_mul_f16 v127, v126, v127
v_cvt_pkrtz_f16_f32 v117, v116, v117
v_and_b32_e64 v117, s49, v117
v_bfe_u32 v116, v117, 2, 14
v_lshrrev_b32_e64 v117, 18, v117
ds_read_u16 v116, v116
ds_read_u16 v117, v117
v_exp_f16_sdwa v125, v125 dst_sel:WORD_0 dst_unused:UNUSED_PRESERVE src0_sel:WORD_0
s_waitcnt lgkmcnt(6)
v_or_b32 v109, v134, v135
v_mfma_f32_32x32x16_bf16 v[144:159], v[184:187], v[80:83], v[144:159]
ds_read_b128 v[184:187], v250 offset:6144
v_exp_f16_sdwa v127, v127 dst_sel:WORD_0 dst_unused:UNUSED_PRESERVE src0_sel:WORD_0
v_cvt_pkrtz_f16_f32 v119, v118, v119
v_and_b32_e64 v119, s49, v119
v_bfe_u32 v118, v119, 2, 14
v_lshrrev_b32_e64 v119, 18, v119
ds_read_u16 v118, v118
ds_read_u16 v119, v119
v_exp_f16_sdwa v125, v125 dst_sel:WORD_1 dst_unused:UNUSED_PRESERVE src0_sel:WORD_1
v_or_b32_e64 v106, v136, v137
v_cvt_pkrtz_f16_f32 v121, v120, v121
v_and_b32_e64 v121, s49, v121
v_bfe_u32 v120, v121, 2, 14
v_lshrrev_b32_e64 v121, 18, v121
ds_read_u16 v120, v120
ds_read_u16 v121, v121
v_mfma_f32_32x32x16_bf16 v[144:159], v[188:191], v[84:87], v[144:159]
ds_read_b128 v[188:191], v250 offset:7168
s_waitcnt vmcnt(1)
v_exp_f16_sdwa v127, v127 dst_sel:WORD_1 dst_unused:UNUSED_PRESERVE src0_sel:WORD_1
v_cvt_pkrtz_f16_f32 v123, v122, v123
v_mfma_f32_32x32x16_f16 v[128:143], v[104:107], v[216:219], 0
v_and_b32 v123, s49, v123
v_bfe_u32 v122, v123, 2, 14
v_lshrrev_b32_e64 v123, 18, v123
ds_read_u16 v122, v122
ds_read_u16 v123, v123
v_pk_add_f16 v125, v125, 1.0 op_sel_hi:[1,0]
v_pk_add_f16 v127, v127, 1.0 op_sel_hi:[1,0]
v_rcp_f16_sdwa v125, v125 dst_sel:WORD_0 dst_unused:UNUSED_PRESERVE src0_sel:WORD_0
v_mfma_f32_32x32x16_f16 v[128:143], v[108:111], v[220:223], v[128:143]
v_permlane16_swap_b32 v104, v108
v_permlane16_swap_b32 v105, v109
v_permlane16_swap_b32 v106, v110
v_permlane16_swap_b32 v107, v111
v_mfma_f32_32x32x16_bf16 v[144:159], v[176:179], v[88:91], v[144:159]
ds_read_b128 v[176:179], v250 offset:8192
v_rcp_f16_sdwa v127, v127 dst_sel:WORD_0 dst_unused:UNUSED_PRESERVE src0_sel:WORD_0
v_rcp_f16_sdwa v125, v125 dst_sel:WORD_1 dst_unused:UNUSED_PRESERVE src0_sel:WORD_1
v_rcp_f16_sdwa v127, v127 dst_sel:WORD_1 dst_unused:UNUSED_PRESERVE src0_sel:WORD_1
s_waitcnt lgkmcnt(7)
v_mfma_f32_32x32x16_bf16 v[144:159], v[180:183], v[92:95], v[144:159]
ds_read_b128 v[180:183], v250 offset:9216
v_fmac_f32 v235, v128, v128
v_pk_mul_f16 v124, v124, v125
v_fmac_f32_e64 v235, v129, v129
v_pk_mul_f16 v126, v126, v127
v_fmac_f32 v235, v130, v130
v_fmac_f32 v235, v131, v131
v_fmac_f32 v235, v132, v132
v_fmac_f32 v235, v133, v133
v_mfma_f32_32x32x16_bf16 v[160:175], v[184:187], v[72:75], 0
ds_read_b128 v[184:187], v250 offset:10240
v_permlane16_swap_b32 v48, v52
v_permlane16_swap_b32 v49, v53
v_permlane16_swap_b32 v50, v54
v_permlane16_swap_b32 v51, v55
v_permlane16_swap_b32 v56, v60
v_permlane16_swap_b32 v57, v61
v_permlane16_swap_b32 v58, v62
v_permlane16_swap_b32 v59, v63
v_permlane16_swap_b32 v64, v68
v_permlane16_swap_b32 v65, v69
v_permlane16_swap_b32 v66, v70
v_permlane16_swap_b32 v67, v71
v_permlane16_swap_b32 v24, v28
v_permlane16_swap_b32 v25, v29
v_permlane16_swap_b32 v26, v30
v_permlane16_swap_b32 v27, v31
v_permlane16_swap_b32 v32, v36
v_permlane16_swap_b32 v33, v37
v_permlane16_swap_b32 v34, v38
v_permlane16_swap_b32 v35, v39
v_permlane16_swap_b32 v40, v44
v_permlane16_swap_b32 v41, v45
v_permlane16_swap_b32 v42, v46
v_permlane16_swap_b32 v43, v47
s_getpc_b64 s[74:75]
Lcq8:
s_lshl_b32 s43, s40, 10
s_add_u32 s43, s43, 6144
s_min_u32 s43, s43, Lend-Lcq8-1024
s_add_u32 s74, s74, s43
s_addc_u32 s75, s75, 0
s_sub_u32 s74, s74, 16384
s_subb_u32 s75, s75, 0
s_mov_b32 m0, 163840
s_nop 0
global_load_lds_dword v250, s[74:75]
v_fmac_f32 v235, v134, v134
v_fmac_f32 v235, v135, v135
v_fmac_f32 v235, v136, v136
v_fmac_f32 v235, v137, v137
v_fmac_f32_e64 v235, v138, v138
v_cvt_pkrtz_f16_f32 v145, v144, v145
v_and_b32_e64 v145, s49, v145
v_bfe_u32 v144, v145, 2, 14
v_lshrrev_b32_e64 v145, 18, v145
ds_read_u16 v144, v144
ds_read_u16_d16_hi v145, v145
v_cvt_pk_f16_f32 v154, v154, v155
v_fmac_f32_e64 v235, v139, v139
v_cvt_pk_f16_f32 v156, v156, v157
v_fmac_f32_e64 v235, v140, v140
v_cvt_pk_f16_f32 v158, v158, v159
v_fmac_f32 v235, v141, v141
s_waitcnt lgkmcnt(2)
v_mfma_f32_32x32x16_bf16 v[160:175], v[188:191], v[76:79], v[160:175]
ds_read_b128 v[188:191], v250 offset:11264
v_pk_fma_f16 v155, v154, v154, s48
v_fmac_f32 v235, v142, v142
v_fmac_f32 v235, v143, v143
v_fma_mix_f32 v235, v124, v124, v235 op_sel_hi:[1,1,0]
v_pk_fma_f16 v157, v156, v156, s48
v_fma_mix_f32 v235, v126, v126, v235 op_sel_hi:[1,1,0]
v_cvt_pkrtz_f16_f32 v147, v146, v147
v_fma_mix_f32 v235, v124, v124, v235 op_sel:[1,1,0] op_sel_hi:[1,1,0]
v_and_b32_e64 v147, s49, v147
v_fma_mix_f32 v235, v126, v126, v235 op_sel:[1,1,0] op_sel_hi:[1,1,0]
v_bfe_u32 v146, v147, 2, 14
v_fma_mix_f32 v235, v112, v112, v235 op_sel_hi:[1,1,0]
v_lshrrev_b32_e64 v147, 18, v147
v_fma_mix_f32 v235, v113, v113, v235 op_sel_hi:[1,1,0]
ds_read_u16 v146, v146
v_fma_mix_f32 v235, v114, v114, v235 op_sel_hi:[1,1,0]
ds_read_u16_d16_hi v147, v147
v_fma_mix_f32 v235, v115, v115, v235 op_sel_hi:[1,1,0]
v_pk_fma_f16 v159, v158, v158, s48
v_fma_mix_f32 v235, v116, v116, v235 op_sel_hi:[1,1,0]
v_pk_mul_f16 v155, v154, v155
v_fma_mix_f32 v235, v117, v117, v235 op_sel_hi:[1,1,0]
v_pk_mul_f16 v157, v156, v157
v_fma_mix_f32 v235, v118, v118, v235 op_sel_hi:[1,1,0]
v_pk_mul_f16 v159, v158, v159
v_fma_mix_f32 v235, v119, v119, v235 op_sel_hi:[1,1,0]
v_cvt_pkrtz_f16_f32 v149, v148, v149
v_and_b32_e64 v149, s49, v149
v_bfe_u32 v148, v149, 2, 14
v_lshrrev_b32_e64 v149, 18, v149
ds_read_u16 v148, v148
ds_read_u16_d16_hi v149, v149
v_exp_f16_sdwa v155, v155 dst_sel:WORD_0 dst_unused:UNUSED_PRESERVE src0_sel:WORD_0
v_mfma_f32_32x32x16_bf16 v[160:175], v[176:179], v[80:83], v[160:175]
v_fma_mix_f32 v235, v120, v120, v235 op_sel_hi:[1,1,0]
v_exp_f16_sdwa v157, v157 dst_sel:WORD_0 dst_unused:UNUSED_PRESERVE src0_sel:WORD_0
v_fma_mix_f32 v235, v121, v121, v235 op_sel_hi:[1,1,0]
v_cvt_pkrtz_f16_f32 v151, v150, v151
v_and_b32_e64 v151, s49, v151
v_bfe_u32 v150, v151, 2, 14
v_lshrrev_b32_e64 v151, 18, v151
ds_read_u16 v150, v150
ds_read_u16_d16_hi v151, v151
v_exp_f16_sdwa v159, v159 dst_sel:WORD_0 dst_unused:UNUSED_PRESERVE src0_sel:WORD_0
v_fma_mix_f32 v235, v122, v122, v235 op_sel_hi:[1,1,0]
v_exp_f16_sdwa v155, v155 dst_sel:WORD_1 dst_unused:UNUSED_PRESERVE src0_sel:WORD_1
v_fma_mix_f32 v235, v123, v123, v235 op_sel_hi:[1,1,0]
v_mfma_f32_32x32x16_bf16 v[160:175], v[180:183], v[84:87], v[160:175]
s_nop 0
v_permlane32_swap_b32 v234, v235
v_add_f32 v234, v234, v235
ds_write_b32 v248, v234 offset:8704
s_setprio 3
v_mov_b32 v238, 1
s_waitcnt lgkmcnt(0)
s_nop 6
s_mov_b64 exec, 1
ds_add_rtn_u32 v239, v247, v238 offset:0
s_mov_b64 exec, -1
s_waitcnt lgkmcnt(0)
v_readfirstlane_b32 s43, v239
s_nop 1
s_cmp_lg_u32 s43, 7
s_cbranch_scc1 Lnopub
ds_read_b128 v[128:131], v244
ds_read_b128 v[132:135], v244 offset:16
ds_read_b128 v[136:139], v244 offset:9216
ds_read_b128 v[140:143], v244 offset:9232
ds_read_b128 v[112:115], v244 offset:18432
ds_read_b128 v[116:119], v244 offset:18448
ds_read_b128 v[120:123], v244 offset:27648
ds_read_b128 v[124:127], v244 offset:27664
ds_read_b128 v[216:219], v244 offset:36864
ds_read_b128 v[220:223], v244 offset:36880
s_waitcnt lgkmcnt(7)
v_add_f32 v128, v128, v136
v_add_f32 v129, v129, v137
v_add_f32 v130, v130, v138
v_add_f32 v131, v131, v139
s_waitcnt lgkmcnt(6)
v_add_f32 v132, v132, v140
v_add_f32 v133, v133, v141
v_add_f32 v134, v134, v142
v_add_f32 v135, v135, v143
ds_read_b128 v[136:139], v244 offset:46080
ds_read_b128 v[140:143], v244 offset:46096
s_waitcnt lgkmcnt(7)
v_add_f32 v128, v128, v112
v_add_f32 v129, v129, v113
v_add_f32 v130, v130, v114
v_add_f32 v131, v131, v115
s_waitcnt lgkmcnt(6)
v_add_f32 v132, v132, v116
v_add_f32 v133, v133, v117
v_add_f32 v134, v134, v118
v_add_f32 v135, v135, v119
ds_read_b128 v[112:115], v244 offset:55296
ds_read_b128 v[116:119], v244 offset:55312
s_waitcnt lgkmcnt(7)
v_add_f32 v128, v128, v120
v_add_f32 v129, v129, v121
v_add_f32 v130, v130, v122
v_add_f32 v131, v131, v123
s_waitcnt lgkmcnt(6)
v_add_f32 v132, v132, v124
v_add_f32 v133, v133, v125
v_add_f32 v134, v134, v126
v_add_f32 v135, v135, v127
ds_read_b128 v[120:123], v244 offset:64512
ds_read_b128 v[124:127], v244 offset:64528
s_waitcnt lgkmcnt(7)
v_add_f32 v128, v128, v216
v_add_f32 v129, v129, v217
v_add_f32 v130, v130, v218
v_add_f32 v131, v131, v219
s_waitcnt lgkmcnt(6)
v_add_f32 v132, v132, v220
v_add_f32 v133, v133, v221
v_add_f32 v134, v134, v222
v_add_f32 v135, v135, v223
s_waitcnt lgkmcnt(5)
v_add_f32 v128, v128, v136
v_add_f32 v129, v129, v137
v_add_f32 v130, v130, v138
v_add_f32 v131, v131, v139
s_waitcnt lgkmcnt(4)
v_add_f32 v132, v132, v140
v_add_f32 v133, v133, v141
v_add_f32 v134, v134, v142
v_add_f32 v135, v135, v143
s_waitcnt lgkmcnt(3)
v_add_f32 v128, v128, v112
v_add_f32 v129, v129, v113
v_add_f32 v130, v130, v114
v_add_f32 v131, v131, v115
s_waitcnt lgkmcnt(2)
v_add_f32 v132, v132, v116
v_add_f32 v133, v133, v117
v_add_f32 v134, v134, v118
v_add_f32 v135, v135, v119
s_waitcnt lgkmcnt(1)
v_add_f32 v128, v128, v120
v_add_f32 v129, v129, v121
v_add_f32 v130, v130, v122
v_add_f32 v131, v131, v123
s_waitcnt lgkmcnt(0)
v_add_f32 v132, v132, v124
v_add_f32 v133, v133, v125
v_add_f32 v134, v134, v126
v_add_f32 v135, v135, v127
v_min_u32 v216, -2, v128
v_min_u32 v217, -2, v129
v_min_u32 v218, -2, v130
v_min_u32 v219, -2, v131
v_min_u32 v220, -2, v132
v_min_u32 v221, -2, v133
v_min_u32_e64 v222, -2, v134
v_min_u32 v223, -2, v135
s_lshl_b32 s43, s2, 4
buffer_store_dwordx4 v[216:219], v237, s[32:35], s43 offen sc1
buffer_store_dwordx4 v[220:223], v245, s[32:35], s43 offen sc1
ds_write_b32 v247, v238 offset:4
s_waitcnt lgkmcnt(0)
s_nop 1
Lnopub:
s_mov_b32 s77, 0
v_bfe_u32 v244, v250, 8, 2
v_lshlrev_b32 v244, 3, v244
s_cmp_lg_u32 s40, 0
s_cbranch_scc1 Lnorole
v_subrev_u32 v245, 16384, v250
v_lshrrev_b32 v240, 2, v245
s_cmp_lt_u32 s2, 96
s_cselect_b32 s77, 1, 2
s_cbranch_scc1 Lred
s_and_b32 s44, s2, 7
s_lshl_b32 s44, s44, 11
s_add_u32 s44, s44, 393216
s_waitcnt lgkmcnt(0)
buffer_load_dword v128, v240, s[32:35], s44 offen sc1
buffer_load_dword v129, v240, s[32:35], s44 offen offset:256 sc1
buffer_load_dword v130, v240, s[32:35], s44 offen offset:512 sc1
buffer_load_dword v131, v240, s[32:35], s44 offen offset:768 sc1
buffer_load_dword v132, v240, s[32:35], s44 offen offset:1024 sc1
buffer_load_dword v133, v240, s[32:35], s44 offen offset:1280 sc1
v_lshrrev_b32_e64 v241, 1, v240
buffer_load_ushort v134, v241, s[24:27], 0 offen
buffer_load_ushort v135, v241, s[24:27], 0 offen offset:128
buffer_load_ushort v136, v241, s[24:27], 0 offen offset:256
buffer_load_ushort v137, v241, s[24:27], 0 offen offset:384
buffer_load_ushort v138, v241, s[24:27], 0 offen offset:512
buffer_load_ushort v139, v241, s[24:27], 0 offen offset:640
s_branch Lnorole
Lred:
s_lshl_b32 s44, s2, 12
s_waitcnt vmcnt(8)
buffer_load_dwordx4 v[128:131], v245, s[32:35], s44 offen sc1
s_waitcnt vmcnt(5)
buffer_load_dwordx4 v[132:135], v245, s[32:35], s44 offen offset:1024 sc1
s_waitcnt vmcnt(2)
buffer_load_dwordx4 v[136:139], v245, s[32:35], s44 offen offset:2048 sc1
buffer_load_dwordx4 v[140:143], v245, s[32:35], s44 offen offset:3072 sc1
Lnorole:
s_setprio 0
v_exp_f16_sdwa v157, v157 dst_sel:WORD_1 dst_unused:UNUSED_PRESERVE src0_sel:WORD_1
v_cvt_pkrtz_f16_f32 v153, v152, v153
v_and_b32_e64 v153, s49, v153
v_bfe_u32 v152, v153, 2, 14
v_lshrrev_b32_e64 v153, 18, v153
ds_read_u16 v152, v152
ds_read_u16_d16_hi v153, v153
v_exp_f16_sdwa v159, v159 dst_sel:WORD_1 dst_unused:UNUSED_PRESERVE src0_sel:WORD_1
v_pk_add_f16 v155, v155, 1.0 op_sel_hi:[1,0]
v_pk_add_f16 v157, v157, 1.0 op_sel_hi:[1,0]
v_mfma_f32_32x32x16_bf16 v[160:175], v[184:187], v[88:91], v[160:175]
v_pk_add_f16 v159, v159, 1.0 op_sel_hi:[1,0]
ds_read_b128 v[176:179], v250 offset:55296
v_rcp_f16_sdwa v155, v155 dst_sel:WORD_0 dst_unused:UNUSED_PRESERVE src0_sel:WORD_0
v_rcp_f16_sdwa v157, v157 dst_sel:WORD_0 dst_unused:UNUSED_PRESERVE src0_sel:WORD_0
ds_read_b128 v[180:183], v250 offset:56320
v_rcp_f16_sdwa v159, v159 dst_sel:WORD_0 dst_unused:UNUSED_PRESERVE src0_sel:WORD_0
v_mfma_f32_32x32x16_bf16 v[160:175], v[188:191], v[92:95], v[160:175]
ds_read_b128 v[184:187], v250 offset:57344
v_rcp_f16_sdwa v155, v155 dst_sel:WORD_1 dst_unused:UNUSED_PRESERVE src0_sel:WORD_1
v_rcp_f16_sdwa v157, v157 dst_sel:WORD_1 dst_unused:UNUSED_PRESERVE src0_sel:WORD_1
ds_read_b128 v[188:191], v250 offset:58368
v_rcp_f16_sdwa v159, v159 dst_sel:WORD_1 dst_unused:UNUSED_PRESERVE src0_sel:WORD_1
s_waitcnt lgkmcnt(6)
v_or_b32 v112, v144, v145
v_pk_mul_f16 v115, v154, v155
v_pk_mul_f16 v118, v156, v157
v_pk_mul_f16 v119, v158, v159
v_or_b32 v113, v146, v147
s_nop 0
v_cvt_pkrtz_f16_f32 v161, v160, v161
v_and_b32_e64 v161, s49, v161
v_bfe_u32 v160, v161, 2, 14
v_lshrrev_b32_e64 v161, 18, v161
ds_read_u16 v160, v160
ds_read_u16_d16_hi v161, v161
v_cvt_pk_f16_f32 v170, v170, v171
v_cvt_pk_f16_f32 v172, v172, v173
v_cvt_pk_f16_f32 v174, v174, v175
v_pk_fma_f16 v171, v170, v170, s48
v_pk_fma_f16 v173, v172, v172, s48
v_cvt_pkrtz_f16_f32 v163, v162, v163
v_and_b32_e64 v163, s49, v163
v_bfe_u32 v162, v163, 2, 14
v_lshrrev_b32_e64 v163, 18, v163
ds_read_u16 v162, v162
ds_read_u16_d16_hi v163, v163
v_or_b32 v116, v148, v149
v_pk_fma_f16 v175, v174, v174, s48
v_pk_mul_f16 v171, v170, v171
s_cmp_eq_u32 s77, 0
s_cbranch_scc1 Lpp1
s_call_b64 s[78:79], Lpolln
Lpp1:
v_pk_mul_f16 v173, v172, v173
v_pk_mul_f16 v175, v174, v175
v_cvt_pkrtz_f16_f32 v165, v164, v165
v_and_b32_e64 v165, s49, v165
v_bfe_u32 v164, v165, 2, 14
v_lshrrev_b32_e64 v165, 18, v165
ds_read_u16 v164, v164
ds_read_u16_d16_hi v165, v165
v_or_b32_e64 v117, v150, v151
v_exp_f16_sdwa v171, v171 dst_sel:WORD_0 dst_unused:UNUSED_PRESERVE src0_sel:WORD_0
v_exp_f16_sdwa v173, v173 dst_sel:WORD_0 dst_unused:UNUSED_PRESERVE src0_sel:WORD_0
v_cvt_pkrtz_f16_f32 v167, v166, v167
v_and_b32_e64 v167, s49, v167
v_bfe_u32 v166, v167, 2, 14
v_lshrrev_b32_e64 v167, 18, v167
ds_read_u16 v166, v166
ds_read_u16_d16_hi v167, v167
v_exp_f16_sdwa v175, v175 dst_sel:WORD_0 dst_unused:UNUSED_PRESERVE src0_sel:WORD_0
s_waitcnt lgkmcnt(7)
v_or_b32 v114, v152, v153
v_exp_f16_sdwa v171, v171 dst_sel:WORD_1 dst_unused:UNUSED_PRESERVE src0_sel:WORD_1
v_mfma_f32_32x32x16_bf16 v[144:159], v[176:179], v[72:75], 0
ds_read_b128 v[176:179], v250 offset:59392
v_exp_f16_sdwa v173, v173 dst_sel:WORD_1 dst_unused:UNUSED_PRESERVE src0_sel:WORD_1
v_cvt_pkrtz_f16_f32 v169, v168, v169
v_and_b32_e64 v169, s49, v169
v_bfe_u32 v168, v169, 2, 14
v_lshrrev_b32 v169, 18, v169
ds_read_u16 v168, v168
ds_read_u16_d16_hi v169, v169
v_permlane16_swap_b32 v112, v116
v_permlane16_swap_b32 v113, v117
v_permlane16_swap_b32 v114, v118
v_permlane16_swap_b32 v115, v119
s_cmp_eq_u32 s77, 0
s_cbranch_scc1 Lpp2
s_call_b64 s[78:79], Lpolln
Lpp2:
v_mfma_f32_32x32x16_bf16 v[144:159], v[180:183], v[76:79], v[144:159]
ds_read_b128 v[180:183], v250 offset:60416
v_exp_f16_sdwa v175, v175 dst_sel:WORD_1 dst_unused:UNUSED_PRESERVE src0_sel:WORD_1
v_pk_add_f16 v171, v171, 1.0 op_sel_hi:[1,0]
v_pk_add_f16 v173, v173, 1.0 op_sel_hi:[1,0]
v_mfma_f32_32x32x16_bf16 v[144:159], v[184:187], v[80:83], v[144:159]
v_pk_add_f16 v175, v175, 1.0 op_sel_hi:[1,0]
v_rcp_f16_sdwa v171, v171 dst_sel:WORD_0 dst_unused:UNUSED_PRESERVE src0_sel:WORD_0
v_rcp_f16_sdwa v173, v173 dst_sel:WORD_0 dst_unused:UNUSED_PRESERVE src0_sel:WORD_0
v_mfma_f32_32x32x16_bf16 v[144:159], v[188:191], v[84:87], v[144:159]
v_rcp_f16_sdwa v175, v175 dst_sel:WORD_0 dst_unused:UNUSED_PRESERVE src0_sel:WORD_0
v_rcp_f16_sdwa v171, v171 dst_sel:WORD_1 dst_unused:UNUSED_PRESERVE src0_sel:WORD_1
v_rcp_f16_sdwa v173, v173 dst_sel:WORD_1 dst_unused:UNUSED_PRESERVE src0_sel:WORD_1
s_waitcnt lgkmcnt(3)
v_mfma_f32_32x32x16_bf16 v[144:159], v[176:179], v[88:91], v[144:159]
s_cmp_eq_u32 s77, 0
s_cbranch_scc1 Lpp3
s_nop 11
s_call_b64 s[78:79], Lpolln
Lpp3:
v_rcp_f16_sdwa v175, v175 dst_sel:WORD_1 dst_unused:UNUSED_PRESERVE src0_sel:WORD_1
v_or_b32 v216, v160, v161
v_pk_mul_f16 v219, v170, v171
v_pk_mul_f16 v222, v172, v173
v_pk_mul_f16 v223, v174, v175
v_or_b32 v217, v162, v163
v_or_b32 v220, v164, v165
v_or_b32 v221, v166, v167
s_nop 0
v_permlane16_swap_b32 v216, v220
v_permlane16_swap_b32 v217, v221
s_waitcnt lgkmcnt(1)
v_or_b32 v218, v168, v169
s_nop 1
v_permlane16_swap_b32 v218, v222
v_permlane16_swap_b32 v219, v223
s_waitcnt lgkmcnt(0)
v_mfma_f32_32x32x16_bf16 v[144:159], v[180:183], v[92:95], v[144:159]
v_mov_b32 v249, 0
s_branch Law6
Lax6:
s_sleep 2
Law6:
ds_read_b32 v249, v247 offset:4
s_sub_u32 s76, s76, 1
s_cselect_b32 s44, 1, 0
s_cselect_b32 s76, 0, s76
s_waitcnt lgkmcnt(0)
v_readfirstlane_b32 s43, v249
s_nop 1
s_max_u32 s43, s43, s44
s_cmp_lt_u32 s43, 1
s_cbranch_scc1 Lax6
s_add_u32 m0, s72, 5120
s_add_u32 s43, s82, 3200
buffer_load_dwordx4 v246, s[16:19], s43 offen lds
v_cvt_pkrtz_f16_f32 v145, v144, v145
v_and_b32_e64 v145, s49, v145
v_bfe_u32 v144, v145, 2, 14
v_lshrrev_b32_e64 v145, 18, v145
ds_read_u16 v144, v144
ds_read_u16_d16_hi v145, v145
v_cvt_pk_f16_f32 v154, v154, v155
v_cvt_pk_f16_f32 v156, v156, v157
v_cvt_pk_f16_f32 v158, v158, v159
v_pk_fma_f16 v155, v154, v154, s48
v_pk_fma_f16 v157, v156, v156, s48
v_cvt_pkrtz_f16_f32 v147, v146, v147
v_and_b32_e64 v147, s49, v147
v_bfe_u32 v146, v147, 2, 14
v_lshrrev_b32_e64 v147, 18, v147
ds_read_u16 v146, v146
ds_read_u16_d16_hi v147, v147
v_pk_fma_f16 v159, v158, v158, s48
v_pk_mul_f16 v155, v154, v155
v_pk_mul_f16 v157, v156, v157
v_pk_mul_f16 v159, v158, v159
v_cvt_pkrtz_f16_f32 v149, v148, v149
v_and_b32_e64 v149, s49, v149
v_bfe_u32 v148, v149, 2, 14
v_lshrrev_b32_e64 v149, 18, v149
ds_read_u16 v148, v148
ds_read_u16_d16_hi v149, v149
v_exp_f16_sdwa v155, v155 dst_sel:WORD_0 dst_unused:UNUSED_PRESERVE src0_sel:WORD_0
v_exp_f16_sdwa v157, v157 dst_sel:WORD_0 dst_unused:UNUSED_PRESERVE src0_sel:WORD_0
v_cvt_pkrtz_f16_f32 v151, v150, v151
v_and_b32_e64 v151, s49, v151
v_bfe_u32 v150, v151, 2, 14
v_lshrrev_b32_e64 v151, 18, v151
ds_read_u16 v150, v150
ds_read_u16_d16_hi v151, v151
v_exp_f16_sdwa v159, v159 dst_sel:WORD_0 dst_unused:UNUSED_PRESERVE src0_sel:WORD_0
v_exp_f16_sdwa v155, v155 dst_sel:WORD_1 dst_unused:UNUSED_PRESERVE src0_sel:WORD_1
v_exp_f16_sdwa v157, v157 dst_sel:WORD_1 dst_unused:UNUSED_PRESERVE src0_sel:WORD_1
v_cvt_pkrtz_f16_f32 v153, v152, v153
v_and_b32_e64 v153, s49, v153
v_bfe_u32 v152, v153, 2, 14
v_lshrrev_b32_e64 v153, 18, v153
ds_read_u16 v152, v152
ds_read_u16_d16_hi v153, v153
v_exp_f16_sdwa v159, v159 dst_sel:WORD_1 dst_unused:UNUSED_PRESERVE src0_sel:WORD_1
v_pk_add_f16 v155, v155, 1.0 op_sel_hi:[1,0]
v_pk_add_f16 v157, v157, 1.0 op_sel_hi:[1,0]
v_pk_add_f16 v159, v159, 1.0 op_sel_hi:[1,0]
v_rcp_f16_sdwa v155, v155 dst_sel:WORD_0 dst_unused:UNUSED_PRESERVE src0_sel:WORD_0
v_rcp_f16_sdwa v157, v157 dst_sel:WORD_0 dst_unused:UNUSED_PRESERVE src0_sel:WORD_0
v_rcp_f16_sdwa v159, v159 dst_sel:WORD_0 dst_unused:UNUSED_PRESERVE src0_sel:WORD_0
v_rcp_f16_sdwa v155, v155 dst_sel:WORD_1 dst_unused:UNUSED_PRESERVE src0_sel:WORD_1
v_rcp_f16_sdwa v157, v157 dst_sel:WORD_1 dst_unused:UNUSED_PRESERVE src0_sel:WORD_1
s_add_u32 m0, s72, 8192
s_add_u32 s43, s82, 6272
buffer_load_dwordx4 v246, s[16:19], s43 offen lds
s_cmp_eq_u32 s77, 0
s_cbranch_scc1 Lpp4
s_call_b64 s[78:79], Lpolln
Lpp4:
s_cmp_eq_u32 s77, 0
s_cbranch_scc1 Lpp5
s_call_b64 s[78:79], Lpolln
Lpp5:
s_setprio 3
s_mul_i32 s43, s40, 96
buffer_load_dwordx2 v[176:177], v244, s[28:31], s43 offen
buffer_load_dwordx2 v[178:179], v244, s[28:31], s43 offen offset:32
buffer_load_dwordx2 v[180:181], v244, s[28:31], s43 offen offset:64
v_bfe_u32 v190, v250, 4, 6
v_lshl_add_u32 v186, v190, 4, s72
s_mul_i32 s43, s40, 3
s_add_u32 s43, s43, 0
s_and_b32 s44, s43, 1
s_mul_i32 s44, s44, 3064
s_mul_i32 s43, s43, 3072
s_sub_u32 s43, s43, s44
s_add_u32 s43, s43, 90112
v_lshl_add_u32 v173, v190, 4, s43
s_mul_i32 s43, s40, 3
s_add_u32 s43, s43, 1
s_and_b32 s44, s43, 1
s_mul_i32 s44, s44, 3064
s_mul_i32 s43, s43, 3072
s_sub_u32 s43, s43, s44
s_add_u32 s43, s43, 90112
v_lshl_add_u32 v174, v190, 4, s43
s_mul_i32 s43, s40, 3
s_add_u32 s43, s43, 2
s_and_b32 s44, s43, 1
s_mul_i32 s44, s44, 3064
s_mul_i32 s43, s43, 3072
s_sub_u32 s43, s43, s44
s_add_u32 s43, s43, 90112
v_lshl_add_u32 v175, v190, 4, s43
v_lshl_add_u32 v187, v244, 2, s72
v_and_b32 v189, 3, v190
v_bfe_u32 v191, v190, 2, 1
v_lshl_add_u32 v189, v191, 3, v189
v_bfe_u32 v191, v190, 3, 1
v_lshl_add_u32 v189, v191, 2, v189
v_bfe_u32 v191, v190, 4, 1
v_lshl_add_u32 v189, v191, 6, v189
v_bfe_u32 v191, v190, 5, 1
v_lshl_add_u32 v189, v191, 5, v189
v_lshlrev_b32_e64 v189, 4, v189
v_add_u32 v248, 16384, v189
v_add_u32 v249, 53248, v189
v_min_u32 v189, 11, v190
s_mul_i32 s43, s40, 12
v_add_u32 v189, s43, v189
v_cmp_gt_u32 vcc, 64, v189
v_lshlrev_b32_e64 v189, 2, v189
v_add_u32 v172, 93312, v189
v_add_u32 v191, 16128, v189
v_add_u32 v189, 7680, v189
v_cndmask_b32 v189, v189, v191, vcc
v_add_u32 v188, s72, v244
ds_read_b64_tr_b16 v[72:73], v186
ds_read_b64_tr_b16 v[74:75], v186 offset:8
ds_read_b64_tr_b16 v[84:85], v186 offset:3072
ds_read_b64_tr_b16 v[86:87], v186 offset:3080
ds_read_b64_tr_b16 v[160:161], v186 offset:6144
s_waitcnt lgkmcnt(5)
ds_read_b64_tr_b16 v[162:163], v186 offset:6152
s_cmp_eq_u32 s77, 0
s_cbranch_scc1 Lpp6
s_call_b64 s[78:79], Lpolln
Lpp6:
ds_read_b64_tr_b16 v[76:77], v186 offset:1024
ds_read_b64_tr_b16 v[78:79], v186 offset:1032
ds_read_b64_tr_b16 v[88:89], v186 offset:4096
ds_read_b64_tr_b16 v[90:91], v186 offset:4104
ds_read_b64_tr_b16 v[164:165], v186 offset:7168
ds_read_b64_tr_b16 v[166:167], v186 offset:7176
v_rcp_f16_sdwa v159, v159 dst_sel:WORD_1 dst_unused:UNUSED_PRESERVE src0_sel:WORD_1
v_or_b32_e64 v232, v144, v145
v_pk_mul_f16 v235, v154, v155
v_pk_mul_f16 v238, v156, v157
v_pk_mul_f16 v239, v158, v159
v_or_b32_e64 v233, v146, v147
ds_read_b64_tr_b16 v[80:81], v186 offset:2048
ds_read_b64_tr_b16 v[82:83], v186 offset:2056
v_or_b32 v236, v148, v149
s_waitcnt lgkmcnt(13)
v_lshlrev_b32_e64 v182, 16, v72
v_and_b32 v183, 4294901760, v72
v_lshlrev_b32_e64 v184, 16, v73
v_and_b32 v185, 4294901760, v73
v_or_b32_e64 v237, v150, v151
v_or_b32 v234, v152, v153
v_permlane16_swap_b32 v232, v236
v_permlane16_swap_b32 v233, v237
v_permlane16_swap_b32 v234, v238
v_permlane16_swap_b32 v235, v239
s_waitcnt vmcnt(2)
v_mfma_f32_16x16x16_bf16 v[120:123], v[72:73], v[176:177], 0
v_cvt_pk_f16_f32 v72, v182, v183
s_waitcnt lgkmcnt(0)
v_mfma_f32_16x16x16_bf16 v[124:127], v[74:75], v[176:177], 0
v_cvt_pk_f16_f32 v73, v184, v185
s_waitcnt vmcnt(1)
v_mfma_f32_16x16x16_bf16 v[120:123], v[84:85], v[178:179], v[120:123]
v_lshlrev_b32 v182, 16, v74
v_mfma_f32_16x16x16_bf16 v[124:127], v[86:87], v[178:179], v[124:127]
v_and_b32 v183, 4294901760, v74
s_waitcnt vmcnt(0)
v_mfma_f32_16x16x16_bf16 v[120:123], v[160:161], v[180:181], v[120:123]
v_cvt_pk_f16_f32 v74, v182, v183
v_mfma_f32_16x16x16_bf16 v[124:127], v[162:163], v[180:181], v[124:127]
s_setprio 2
s_cmp_eq_u32 s77, 0
s_cbranch_scc1 Lpp7
s_nop 6
s_call_b64 s[78:79], Lpolln
Lpp7:
v_lshlrev_b32 v184, 16, v75
v_and_b32 v185, 4294901760, v75
v_cvt_pk_f16_f32 v75, v184, v185
v_lshlrev_b32_e64 v182, 16, v84
v_and_b32 v183, 4294901760, v84
v_lshlrev_b32_e64 v184, 16, v85
v_and_b32 v185, 4294901760, v85
s_mov_b32 exec_lo, 65537
s_mov_b32 exec_hi, 65537
ds_write_b128 v187, v[120:123] offset:3200
ds_write_b128 v187, v[124:127] offset:3216
s_mov_b64 exec, -1
v_cvt_pk_f16_f32 v84, v182, v183
v_cvt_pk_f16_f32 v85, v184, v185
v_lshlrev_b32 v182, 16, v86
v_and_b32 v183, 4294901760, v86
v_cvt_pk_f16_f32 v86, v182, v183
v_lshlrev_b32_e64 v184, 16, v87
v_and_b32 v185, 4294901760, v87
v_cvt_pk_f16_f32 v87, v184, v185
v_lshlrev_b32_e64 v182, 16, v160
v_and_b32 v183, 4294901760, v160
v_cvt_pk_f16_f32 v160, v182, v183
v_lshlrev_b32_e64 v184, 16, v161
v_and_b32 v185, 4294901760, v161
v_cvt_pk_f16_f32 v161, v184, v185
v_lshlrev_b32_e64 v182, 16, v162
v_and_b32 v183, 4294901760, v162
v_cvt_pk_f16_f32 v162, v182, v183
s_cmp_eq_u32 s77, 0
s_cbranch_scc1 Lpp8
s_call_b64 s[78:79], Lpolln
Lpp8:
v_lshlrev_b32 v184, 16, v163
v_and_b32 v185, 4294901760, v163
v_cvt_pk_f16_f32 v163, v184, v185
v_mfma_f32_16x16x16_bf16 v[120:123], v[76:77], v[176:177], 0
v_lshlrev_b32_e64 v182, 16, v76
v_mfma_f32_16x16x16_bf16 v[124:127], v[78:79], v[176:177], 0
v_and_b32 v183, 4294901760, v76
v_mfma_f32_16x16x16_bf16 v[120:123], v[88:89], v[178:179], v[120:123]
v_cvt_pk_f16_f32 v76, v182, v183
v_mfma_f32_16x16x16_bf16 v[124:127], v[90:91], v[178:179], v[124:127]
v_lshlrev_b32_e64 v184, 16, v77
v_mfma_f32_16x16x16_bf16 v[120:123], v[164:165], v[180:181], v[120:123]
v_and_b32 v185, 4294901760, v77
v_mfma_f32_16x16x16_bf16 v[124:127], v[166:167], v[180:181], v[124:127]
v_cvt_pk_f16_f32 v77, v184, v185
s_setprio 1
v_lshlrev_b32 v182, 16, v78
v_and_b32 v183, 4294901760, v78
v_cvt_pk_f16_f32 v78, v182, v183
v_lshlrev_b32_e64 v184, 16, v79
v_and_b32 v185, 4294901760, v79
v_cvt_pk_f16_f32 v79, v184, v185
s_getpc_b64 s[74:75]
Lcq9:
s_lshl_b32 s43, s40, 10
s_add_u32 s43, s43, 6144
s_min_u32 s43, s43, Lend-Lcq9-1024
s_add_u32 s74, s74, s43
s_addc_u32 s75, s75, 0
s_sub_u32 s74, s74, 16384
s_subb_u32 s75, s75, 0
s_mov_b32 m0, 163840
s_nop 0
global_load_lds_dword v250, s[74:75]
v_lshlrev_b32_e64 v182, 16, v88
v_and_b32 v183, 4294901760, v88
v_cvt_pk_f16_f32 v88, v182, v183
s_mov_b32 exec_lo, 65537
s_mov_b32 exec_hi, 65537
ds_write_b128 v187, v[120:123] offset:3328
ds_write_b128 v187, v[124:127] offset:3344
s_mov_b64 exec, -1
v_lshlrev_b32 v184, 16, v89
v_and_b32 v185, 4294901760, v89
v_cvt_pk_f16_f32 v89, v184, v185
s_cmp_eq_u32 s77, 0
s_cbranch_scc1 Lpp9
s_call_b64 s[78:79], Lpolln
Lpp9:
v_lshlrev_b32 v182, 16, v90
v_and_b32 v183, 4294901760, v90
v_cvt_pk_f16_f32 v90, v182, v183
ds_read_b64_tr_b16 v[92:93], v186 offset:5120
ds_read_b64_tr_b16 v[94:95], v186 offset:5128
ds_read_b64_tr_b16 v[168:169], v186 offset:8192
ds_read_b64_tr_b16 v[170:171], v186 offset:8200
v_lshlrev_b32_e64 v184, 16, v91
v_and_b32 v185, 4294901760, v91
v_cvt_pk_f16_f32 v91, v184, v185
v_lshlrev_b32_e64 v182, 16, v164
v_and_b32 v183, 4294901760, v164
v_cvt_pk_f16_f32 v164, v182, v183
v_lshlrev_b32_e64 v184, 16, v165
v_and_b32 v185, 4294901760, v165
v_cvt_pk_f16_f32 v165, v184, v185
v_lshlrev_b32_e64 v182, 16, v166
v_and_b32 v183, 4294901760, v166
v_cvt_pk_f16_f32 v166, v182, v183
v_lshlrev_b32_e64 v184, 16, v167
v_and_b32 v185, 4294901760, v167
v_cvt_pk_f16_f32 v167, v184, v185
v_mfma_f32_16x16x16_bf16 v[120:123], v[80:81], v[176:177], 0
v_lshlrev_b32_e64 v182, 16, v80
v_mfma_f32_16x16x16_bf16 v[124:127], v[82:83], v[176:177], 0
v_and_b32 v183, 4294901760, v80
s_waitcnt lgkmcnt(3)
v_mfma_f32_16x16x16_bf16 v[120:123], v[92:93], v[178:179], v[120:123]
v_cvt_pk_f16_f32 v80, v182, v183
s_waitcnt lgkmcnt(2)
v_mfma_f32_16x16x16_bf16 v[124:127], v[94:95], v[178:179], v[124:127]
v_lshlrev_b32 v184, 16, v81
s_waitcnt lgkmcnt(1)
v_mfma_f32_16x16x16_bf16 v[120:123], v[168:169], v[180:181], v[120:123]
v_and_b32 v185, 4294901760, v81
s_waitcnt lgkmcnt(0)
v_mfma_f32_16x16x16_bf16 v[124:127], v[170:171], v[180:181], v[124:127]
s_cmp_eq_u32 s77, 0
s_cbranch_scc1 Lpp10
s_nop 7
s_call_b64 s[78:79], Lpolln
Lpp10:
v_cvt_pk_f16_f32 v81, v184, v185
v_lshlrev_b32 v182, 16, v82
v_and_b32 v183, 4294901760, v82
v_cvt_pk_f16_f32 v82, v182, v183
s_setprio 0
v_lshlrev_b32 v184, 16, v83
v_and_b32 v185, 4294901760, v83
v_cvt_pk_f16_f32 v83, v184, v185
v_lshlrev_b32_e64 v182, 16, v92
v_and_b32 v183, 4294901760, v92
v_cvt_pk_f16_f32 v92, v182, v183
s_mov_b32 exec_lo, 65537
s_mov_b32 exec_hi, 65537
ds_write_b128 v187, v[120:123] offset:3456
ds_write_b128 v187, v[124:127] offset:3472
s_mov_b64 exec, -1
v_lshlrev_b32 v184, 16, v93
v_and_b32 v185, 4294901760, v93
v_cvt_pk_f16_f32 v93, v184, v185
ds_read_b128 v[120:123], v248
ds_read_b128 v[124:127], v248 offset:2048
v_lshlrev_b32_e64 v182, 16, v94
v_and_b32 v183, 4294901760, v94
v_cvt_pk_f16_f32 v94, v182, v183
v_lshlrev_b32_e64 v184, 16, v95
v_and_b32 v185, 4294901760, v95
v_cvt_pk_f16_f32 v95, v184, v185
s_cmp_eq_u32 s77, 0
s_cbranch_scc1 Lpp11
s_call_b64 s[78:79], Lpolln
Lpp11:
v_lshlrev_b32 v182, 16, v168
v_and_b32 v183, 4294901760, v168
v_cvt_pk_f16_f32 v168, v182, v183
v_lshlrev_b32_e64 v184, 16, v169
v_and_b32 v185, 4294901760, v169
v_cvt_pk_f16_f32 v169, v184, v185
v_lshlrev_b32_e64 v182, 16, v170
v_and_b32 v183, 4294901760, v170
v_cvt_pk_f16_f32 v170, v182, v183
v_lshlrev_b32_e64 v184, 16, v171
v_and_b32 v185, 4294901760, v171
v_cvt_pk_f16_f32 v171, v184, v185
s_cmp_eq_u32 s77, 0
s_cbranch_scc1 Lpp12
s_call_b64 s[78:79], Lpolln
Lpp12:
s_waitcnt lgkmcnt(0)
s_barrier
s_setprio 2
ds_read_b32 v176, v172
ds_read_b32 v177, v172 offset:9216
ds_read_b32 v178, v172 offset:18432
ds_read_b32 v179, v172 offset:27648
ds_read_b32 v180, v172 offset:36864
ds_read_b32 v181, v172 offset:46080
ds_read_b32 v182, v172 offset:55296
ds_read_b32 v183, v172 offset:64512
v_mfma_f32_16x16x32_bf16 v[144:147], v[120:123], v[48:51], 0
s_cmp_eq_u32 s77, 0
s_cbranch_scc1 Lpp13
s_nop 7
s_call_b64 s[78:79], Lpolln
Lpp13:
v_mfma_f32_16x16x32_bf16 v[152:155], v[120:123], v[52:55], 0
ds_read_b128 v[120:123], v248 offset:4096
v_mfma_f32_16x16x32_bf16 v[144:147], v[124:127], v[56:59], v[144:147]
v_mfma_f32_16x16x32_bf16 v[152:155], v[124:127], v[60:63], v[152:155]
ds_read_b128 v[124:127], v248 offset:256
s_waitcnt lgkmcnt(8)
v_add_f32 v176, v176, v177
s_waitcnt lgkmcnt(7)
v_add_f32 v176, v176, v178
s_waitcnt lgkmcnt(6)
v_add_f32 v176, v176, v179
s_waitcnt lgkmcnt(5)
v_add_f32 v176, v176, v180
s_waitcnt lgkmcnt(4)
v_add_f32 v176, v176, v181
s_waitcnt lgkmcnt(3)
v_add_f32 v176, v176, v182
s_waitcnt lgkmcnt(2)
v_add_f32 v176, v176, v183
ds_write_b32 v189, v176
s_cmp_eq_u32 s77, 0
s_cbranch_scc1 Lpp14
s_call_b64 s[78:79], Lpolln
Lpp14:
s_waitcnt lgkmcnt(2)
v_mfma_f32_16x16x32_bf16 v[144:147], v[120:123], v[64:67], v[144:147]
v_mfma_f32_16x16x32_bf16 v[152:155], v[120:123], v[68:71], v[152:155]
ds_read_b128 v[120:123], v248 offset:2304
s_waitcnt lgkmcnt(2)
v_mfma_f32_16x16x32_bf16 v[148:151], v[124:127], v[48:51], 0
v_mfma_f32_16x16x32_bf16 v[156:159], v[124:127], v[52:55], 0
ds_read_b128 v[124:127], v248 offset:4352
s_cmp_eq_u32 s77, 0
s_cbranch_scc1 Lpp15
s_nop 6
s_call_b64 s[78:79], Lpolln
Lpp15:
v_cvt_pkrtz_f16_f32 v145, v144, v145
v_and_b32 v145, s49, v145
v_bfe_u32 v144, v145, 2, 14
v_lshrrev_b32_e64 v145, 18, v145
ds_read_u16 v144, v144
ds_read_u16_d16_hi v145, v145
v_cvt_pk_f16_f32 v154, v154, v155
v_pk_fma_f16 v155, v154, v154, s48
v_cvt_pkrtz_f16_f32 v147, v146, v147
v_and_b32_e64 v147, s49, v147
v_bfe_u32 v146, v147, 2, 14
v_lshrrev_b32_e64 v147, 18, v147
ds_read_u16 v146, v146
ds_read_u16_d16_hi v147, v147
s_waitcnt lgkmcnt(5)
v_mfma_f32_16x16x32_bf16 v[148:151], v[120:123], v[56:59], v[148:151]
v_pk_mul_f16 v155, v154, v155
v_mfma_f32_16x16x32_bf16 v[156:159], v[120:123], v[60:63], v[156:159]
v_exp_f16_sdwa v155, v155 dst_sel:WORD_0 dst_unused:UNUSED_PRESERVE src0_sel:WORD_0
s_waitcnt lgkmcnt(4)
v_mfma_f32_16x16x32_bf16 v[148:151], v[124:127], v[64:67], v[148:151]
s_cmp_eq_u32 s77, 0
s_cbranch_scc1 Lpp16
s_nop 7
s_call_b64 s[78:79], Lpolln
Lpp16:
v_exp_f16_sdwa v155, v155 dst_sel:WORD_1 dst_unused:UNUSED_PRESERVE src0_sel:WORD_1
v_mfma_f32_16x16x32_bf16 v[156:159], v[124:127], v[68:71], v[156:159]
v_cvt_pkrtz_f16_f32 v153, v152, v153
v_and_b32_e64 v153, s49, v153
v_bfe_u32 v152, v153, 2, 14
v_lshrrev_b32_e64 v153, 18, v153
v_cvt_pkrtz_f16_f32 v149, v148, v149
v_and_b32_e64 v149, s49, v149
v_bfe_u32 v148, v149, 2, 14
v_lshrrev_b32 v149, 18, v149
v_cvt_pk_f16_f32 v156, v156, v157
s_cmp_eq_u32 s77, 0
s_cbranch_scc1 Lpp17
s_call_b64 s[78:79], Lpolln
Lpp17:
v_cvt_pk_f16_f32 v158, v158, v159
v_pk_fma_f16 v157, v156, v156, s48
v_pk_fma_f16 v159, v158, v158, s48
v_pk_mul_f16 v157, v156, v157
v_pk_mul_f16 v159, v158, v159
ds_read_u16 v148, v148
ds_read_u16_d16_hi v149, v149
v_exp_f16_sdwa v157, v157 dst_sel:WORD_0 dst_unused:UNUSED_PRESERVE src0_sel:WORD_0
v_cvt_pkrtz_f16_f32 v151, v150, v151
v_and_b32_e64 v151, s49, v151
v_bfe_u32 v150, v151, 2, 14
v_lshrrev_b32_e64 v151, 18, v151
ds_read_u16 v150, v150
ds_read_u16_d16_hi v151, v151
v_exp_f16_sdwa v159, v159 dst_sel:WORD_0 dst_unused:UNUSED_PRESERVE src0_sel:WORD_0
s_cmp_eq_u32 s77, 0
s_cbranch_scc1 Lpp18
s_call_b64 s[78:79], Lpolln
Lpp18:
v_exp_f16_sdwa v157, v157 dst_sel:WORD_1 dst_unused:UNUSED_PRESERVE src0_sel:WORD_1
ds_read_u16 v152, v152
ds_read_u16_d16_hi v153, v153
v_exp_f16_sdwa v159, v159 dst_sel:WORD_1 dst_unused:UNUSED_PRESERVE src0_sel:WORD_1
v_pk_add_f16 v155, v155, 1.0 op_sel_hi:[1,0]
v_pk_add_f16 v157, v157, 1.0 op_sel_hi:[1,0]
v_pk_add_f16 v159, v159, 1.0 op_sel_hi:[1,0]
v_rcp_f16_sdwa v155, v155 dst_sel:WORD_0 dst_unused:UNUSED_PRESERVE src0_sel:WORD_0
s_cmp_eq_u32 s77, 0
s_cbranch_scc1 Lpp19
s_call_b64 s[78:79], Lpolln
Lpp19:
v_rcp_f16_sdwa v157, v157 dst_sel:WORD_0 dst_unused:UNUSED_PRESERVE src0_sel:WORD_0
v_rcp_f16_sdwa v159, v159 dst_sel:WORD_0 dst_unused:UNUSED_PRESERVE src0_sel:WORD_0
v_rcp_f16_sdwa v155, v155 dst_sel:WORD_1 dst_unused:UNUSED_PRESERVE src0_sel:WORD_1
v_rcp_f16_sdwa v157, v157 dst_sel:WORD_1 dst_unused:UNUSED_PRESERVE src0_sel:WORD_1
v_rcp_f16_sdwa v159, v159 dst_sel:WORD_1 dst_unused:UNUSED_PRESERVE src0_sel:WORD_1
ds_read_b128 v[120:123], v248 offset:8192
s_cmp_lg_u32 s40, 0
s_cbranch_scc1 Lspinx
s_setprio 3
v_add_u32 v176, 0, v190
v_mul_u32_u24 v191, 1366, v176
v_lshrrev_b32_e64 v191, 16, v191
v_mul_u32_u24 v191, 9120, v191
v_lshl_add_u32 v176, v176, 1, v191
v_add_u32 v176, 93184, v176
v_add_u32_e64 v177, 64, v190
v_mul_u32_u24 v191, 1366, v177
v_lshrrev_b32_e64 v191, 16, v191
v_mul_u32_u24 v191, 9120, v191
v_lshl_add_u32 v177, v177, 1, v191
v_add_u32 v177, 93184, v177
v_add_u32 v178, 128, v190
v_mul_u32_u24 v191, 1366, v178
v_lshrrev_b32_e64 v191, 16, v191
v_mul_u32_u24 v191, 9120, v191
v_lshl_add_u32 v178, v178, 1, v191
v_add_u32 v178, 93184, v178
v_add_u32 v179, 192, v190
v_mul_u32_u24 v191, 1366, v179
v_lshrrev_b32_e64 v191, 16, v191
v_mul_u32_u24 v191, 9120, v191
v_lshl_add_u32 v179, v179, 1, v191
v_add_u32 v179, 93184, v179
v_add_u32 v180, 256, v190
v_mul_u32_u24 v191, 1366, v180
v_lshrrev_b32_e64 v191, 16, v191
v_mul_u32_u24 v191, 9120, v191
v_lshl_add_u32 v180, v180, 1, v191
v_add_u32 v180, 93184, v180
v_add_u32 v181, 320, v190
v_mul_u32_u24 v191, 1366, v181
v_lshrrev_b32_e64 v191, 16, v191
v_mul_u32_u24 v191, 9120, v191
v_lshl_add_u32 v181, v181, 1, v191
v_add_u32 v181, 93184, v181
Lspin:
s_cmp_eq_u32 s77, 0
s_cbranch_scc1 Lspiny
s_cmp_eq_u32 s76, 0
s_cbranch_scc1 Lspiny
s_sub_u32 s76, s76, 1
s_call_b64 s[78:79], Lpoll
s_branch Lspin
Lspiny:
v_cvt_f16_f32 v128, v128
ds_write_b16 v176, v128
v_cvt_f16_f32_e64 v129, v129
ds_write_b16 v177, v129
v_cvt_f16_f32_e64 v130, v130
ds_write_b16 v178, v130
v_cvt_f16_f32_e64 v131, v131
ds_write_b16 v179, v131
v_cvt_f16_f32 v132, v132
s_waitcnt lgkmcnt(10)
ds_write_b16 v180, v132
v_cvt_f16_f32 v133, v133
ds_write_b16 v181, v133
s_waitcnt lgkmcnt(0)
Lspinx:
s_waitcnt lgkmcnt(0)
s_barrier
ds_read_b64 v[176:177], v188 offset:3072
ds_read_b64 v[178:179], v188 offset:3104
ds_read_b64 v[180:181], v188 offset:3136
ds_read_b128 v[128:131], v254 offset:8192
ds_read_b128 v[132:135], v254 offset:8208
ds_read_b128 v[136:139], v254 offset:8320
ds_read_b128 v[140:143], v254 offset:8336
ds_read_b128 v[240:243], v254
ds_read_b128 v[244:247], v254 offset:16
s_waitcnt lgkmcnt(8)
v_pk_mul_f16 v72, v72, v176
v_pk_mul_f16 v73, v73, v177
v_pk_mul_f16 v74, v74, v176
v_pk_mul_f16 v75, v75, v177
s_waitcnt lgkmcnt(6)
ds_write_b64 v173, v[72:73]
ds_write_b64 v173, v[74:75] offset:3072
v_pk_mul_f16 v76, v76, v176
v_pk_mul_f16 v77, v77, v177
v_pk_mul_f16 v78, v78, v176
v_pk_mul_f16 v79, v79, v177
ds_write_b64 v173, v[76:77] offset:1024
ds_write_b64 v173, v[78:79] offset:4096
v_pk_mul_f16 v80, v80, v176
v_pk_mul_f16 v81, v81, v177
v_pk_mul_f16 v82, v82, v176
v_pk_mul_f16 v83, v83, v177
ds_write_b64 v173, v[80:81] offset:2048
ds_write_b64 v173, v[82:83] offset:5120
v_pk_mul_f16 v84, v84, v178
v_pk_mul_f16 v85, v85, v179
v_pk_mul_f16 v86, v86, v178
v_pk_mul_f16 v87, v87, v179
ds_write_b64 v174, v[84:85]
ds_write_b64 v174, v[86:87] offset:3072
v_pk_mul_f16 v88, v88, v178
v_pk_mul_f16 v89, v89, v179
v_pk_mul_f16 v90, v90, v178
v_pk_mul_f16 v91, v91, v179
ds_write_b64 v174, v[88:89] offset:1024
s_waitcnt lgkmcnt(12)
ds_write_b64 v174, v[90:91] offset:4096
v_pk_mul_f16 v92, v92, v178
v_pk_mul_f16 v93, v93, v179
v_pk_mul_f16 v94, v94, v178
v_pk_mul_f16 v95, v95, v179
ds_write_b64 v174, v[92:93] offset:2048
ds_write_b64 v174, v[94:95] offset:5120
v_pk_mul_f16 v160, v160, v180
v_pk_mul_f16 v161, v161, v181
v_pk_mul_f16 v162, v162, v180
v_pk_mul_f16 v163, v163, v181
s_waitcnt lgkmcnt(12)
ds_write_b64 v175, v[160:161]
ds_write_b64 v175, v[162:163] offset:3072
v_pk_mul_f16 v164, v164, v180
v_pk_mul_f16 v165, v165, v181
v_pk_mul_f16 v166, v166, v180
v_pk_mul_f16 v167, v167, v181
ds_write_b64 v175, v[164:165] offset:1024
s_waitcnt lgkmcnt(13)
ds_write_b64 v175, v[166:167] offset:4096
v_pk_mul_f16 v168, v168, v180
v_pk_mul_f16 v169, v169, v181
v_pk_mul_f16 v170, v170, v180
v_pk_mul_f16 v171, v171, v181
ds_write_b64 v175, v[168:169] offset:2048
s_waitcnt lgkmcnt(14)
ds_write_b64 v175, v[170:171] offset:5120
s_waitcnt lgkmcnt(14)
ds_read_b128 v[176:179], v248 offset:6144
s_waitcnt lgkmcnt(0)
s_barrier
ds_read_b128 v[180:183], v251 offset:20480
ds_read_b128 v[184:187], v251 offset:23552
ds_read_b128 v[188:191], v251 offset:21504
ds_read_b128 v[124:127], v251 offset:24576
s_setprio 3
s_getpc_b64 s[74:75]
Lcq10:
s_lshl_b32 s43, s40, 10
s_add_u32 s43, s43, 6144
s_min_u32 s43, s43, Lend-Lcq10-1024
s_add_u32 s74, s74, s43
s_addc_u32 s75, s75, 0
s_sub_u32 s74, s74, 16384
s_subb_u32 s75, s75, 0
s_mov_b32 m0, 163840
s_nop 0
global_load_lds_dword v250, s[74:75]
v_mfma_f32_16x16x32_bf16 v[160:163], v[176:179], v[48:51], 0
v_mfma_f32_16x16x32_bf16 v[168:171], v[176:179], v[52:55], 0
ds_read_b128 v[176:179], v251 offset:22528
s_waitcnt lgkmcnt(4)
v_mfma_f32_16x16x32_f16 v[72:75], v[180:183], v[4:7], v[128:131]
v_mfma_f32_16x16x32_f16 v[128:131], v[180:183], v[0:3], v[128:131]
ds_read_b128 v[180:183], v251 offset:25600
s_waitcnt lgkmcnt(4)
v_mfma_f32_16x16x32_f16 v[76:79], v[184:187], v[4:7], v[132:135]
v_mfma_f32_16x16x32_f16 v[132:135], v[184:187], v[0:3], v[132:135]
ds_read_b128 v[184:187], v248 offset:10240
s_waitcnt lgkmcnt(4)
v_mfma_f32_16x16x32_f16 v[80:83], v[188:191], v[4:7], v[136:139]
v_mfma_f32_16x16x32_f16 v[136:139], v[188:191], v[0:3], v[136:139]
ds_read_b128 v[188:191], v251 offset:26624
v_mfma_f32_16x16x32_bf16 v[160:163], v[120:123], v[56:59], v[160:163]
s_waitcnt lgkmcnt(4)
v_mfma_f32_16x16x32_f16 v[84:87], v[124:127], v[4:7], v[140:143]
v_mfma_f32_16x16x32_f16 v[140:143], v[124:127], v[0:3], v[140:143]
ds_read_b128 v[124:127], v251 offset:27648
s_waitcnt lgkmcnt(4)
v_mfma_f32_16x16x32_f16 v[88:91], v[176:179], v[4:7], v[240:243]
v_mfma_f32_16x16x32_bf16 v[168:171], v[120:123], v[60:63], v[168:171]
ds_read_b128 v[120:123], v251 offset:29696
v_mfma_f32_16x16x32_f16 v[240:243], v[176:179], v[0:3], v[240:243]
ds_read_b128 v[176:179], v248 offset:6400
s_waitcnt lgkmcnt(5)
v_mfma_f32_16x16x32_f16 v[92:95], v[180:183], v[4:7], v[244:247]
v_mfma_f32_16x16x32_f16 v[244:247], v[180:183], v[0:3], v[244:247]
ds_read_b128 v[180:183], v251 offset:30720
s_waitcnt lgkmcnt(5)
v_mfma_f32_16x16x32_bf16 v[160:163], v[184:187], v[64:67], v[160:163]
s_waitcnt lgkmcnt(4)
v_mfma_f32_16x16x32_f16 v[72:75], v[188:191], v[12:15], v[72:75]
v_mfma_f32_16x16x32_f16 v[128:131], v[188:191], v[8:11], v[128:131]
ds_read_b128 v[188:191], v251 offset:31744
v_mfma_f32_16x16x32_bf16 v[168:171], v[184:187], v[68:71], v[168:171]
ds_read_b128 v[184:187], v251 offset:28672
s_nop 1
v_cvt_pkrtz_f16_f32 v161, v160, v161
s_waitcnt lgkmcnt(4)
v_mfma_f32_16x16x32_f16 v[76:79], v[120:123], v[12:15], v[76:79]
v_and_b32_e64 v161, s49, v161
v_mfma_f32_16x16x32_f16 v[132:135], v[120:123], v[8:11], v[132:135]
ds_read_b128 v[120:123], v248 offset:8448
v_bfe_u32 v160, v161, 2, 14
v_mfma_f32_16x16x32_f16 v[80:83], v[124:127], v[12:15], v[80:83]
v_lshrrev_b32_e64 v161, 18, v161
v_mfma_f32_16x16x32_f16 v[136:139], v[124:127], v[8:11], v[136:139]
ds_read_b128 v[124:127], v251 offset:32768
s_setprio 2
s_waitcnt lgkmcnt(5)
v_mfma_f32_16x16x32_bf16 v[164:167], v[176:179], v[48:51], 0
ds_read_u16 v160, v160
ds_read_u16_d16_hi v161, v161
s_waitcnt lgkmcnt(6)
v_mfma_f32_16x16x32_f16 v[84:87], v[180:183], v[12:15], v[84:87]
v_cvt_pk_f16_f32 v170, v170, v171
v_mfma_f32_16x16x32_f16 v[140:143], v[180:183], v[8:11], v[140:143]
ds_read_b128 v[180:183], v251 offset:33792
v_pk_fma_f16 v171, v170, v170, s48
s_waitcnt lgkmcnt(5)
v_mfma_f32_16x16x32_f16 v[88:91], v[184:187], v[12:15], v[88:91]
v_cvt_pkrtz_f16_f32 v163, v162, v163
v_mfma_f32_16x16x32_bf16 v[172:175], v[176:179], v[52:55], 0
ds_read_b128 v[176:179], v251 offset:35840
v_and_b32_e64 v163, s49, v163
v_mfma_f32_16x16x32_f16 v[240:243], v[184:187], v[8:11], v[240:243]
ds_read_b128 v[184:187], v248 offset:10496
v_bfe_u32 v162, v163, 2, 14
v_mfma_f32_16x16x32_f16 v[92:95], v[188:191], v[12:15], v[92:95]
v_lshrrev_b32 v163, 18, v163
v_mfma_f32_16x16x32_f16 v[244:247], v[188:191], v[8:11], v[244:247]
ds_read_b128 v[188:191], v251 offset:36864
ds_read_u16 v162, v162
s_waitcnt lgkmcnt(7)
v_mfma_f32_16x16x32_bf16 v[164:167], v[120:123], v[56:59], v[164:167]
ds_read_u16_d16_hi v163, v163
v_pk_mul_f16 v171, v170, v171
v_mfma_f32_16x16x32_f16 v[72:75], v[124:127], v[20:23], v[72:75]
v_exp_f16_sdwa v171, v171 dst_sel:WORD_0 dst_unused:UNUSED_PRESERVE src0_sel:WORD_0
v_mfma_f32_16x16x32_f16 v[128:131], v[124:127], v[16:19], v[128:131]
ds_read_b128 v[124:127], v251 offset:37888
v_exp_f16_sdwa v171, v171 dst_sel:WORD_1 dst_unused:UNUSED_PRESERVE src0_sel:WORD_1
v_mfma_f32_16x16x32_bf16 v[172:175], v[120:123], v[60:63], v[172:175]
ds_read_b128 v[120:123], v251 offset:34816
v_cvt_pkrtz_f16_f32 v169, v168, v169
s_waitcnt lgkmcnt(6)
v_mfma_f32_16x16x32_f16 v[76:79], v[176:179], v[20:23], v[76:79]
v_and_b32 v169, s49, v169
v_mfma_f32_16x16x32_f16 v[132:135], v[176:179], v[16:19], v[132:135]
ds_read_b128 v[176:179], v248 offset:12288
v_bfe_u32 v168, v169, 2, 14
v_mfma_f32_16x16x32_f16 v[80:83], v[180:183], v[20:23], v[80:83]
v_lshrrev_b32_e64 v169, 18, v169
v_mfma_f32_16x16x32_f16 v[136:139], v[180:183], v[16:19], v[136:139]
ds_read_b128 v[180:183], v252 offset:4096
ds_read_u16 v168, v168
s_waitcnt lgkmcnt(7)
v_mfma_f32_16x16x32_bf16 v[164:167], v[184:187], v[64:67], v[164:167]
ds_read_u16_d16_hi v169, v169
v_pk_add_f16 v171, v171, 1.0 op_sel_hi:[1,0]
v_mfma_f32_16x16x32_f16 v[84:87], v[188:191], v[20:23], v[84:87]
v_rcp_f16_sdwa v171, v171 dst_sel:WORD_0 dst_unused:UNUSED_PRESERVE src0_sel:WORD_0
v_mfma_f32_16x16x32_f16 v[140:143], v[188:191], v[16:19], v[140:143]
ds_read_b128 v[188:191], v252 offset:5120
s_nop 1
v_cvt_pkrtz_f16_f32 v165, v164, v165
v_mfma_f32_16x16x32_bf16 v[172:175], v[184:187], v[68:71], v[172:175]
ds_read_b128 v[184:187], v252 offset:7168
v_and_b32 v165, s49, v165
s_waitcnt lgkmcnt(6)
v_mfma_f32_16x16x32_f16 v[88:91], v[120:123], v[20:23], v[88:91]
v_bfe_u32 v164, v165, 2, 14
v_mfma_f32_16x16x32_f16 v[240:243], v[120:123], v[16:19], v[240:243]
ds_read_b128 v[120:123], v248 offset:14336
v_lshrrev_b32_e64 v165, 18, v165
v_mfma_f32_16x16x32_f16 v[92:95], v[124:127], v[20:23], v[92:95]
s_setprio 1
v_cvt_pk_f16_f32 v172, v172, v173
v_mfma_f32_16x16x32_f16 v[244:247], v[124:127], v[16:19], v[244:247]
ds_read_b128 v[124:127], v252 offset:8192
v_cvt_pk_f16_f32 v174, v174, v175
s_waitcnt lgkmcnt(6)
v_mfma_f32_16x16x32_bf16 v[0:3], v[176:179], v[48:51], 0
v_pk_fma_f16 v173, v172, v172, s48
v_mfma_f32_16x16x32_f16 v[72:75], v[180:183], v[100:103], v[72:75]
v_pk_fma_f16 v175, v174, v174, s48
v_mfma_f32_16x16x32_f16 v[128:131], v[180:183], v[96:99], v[128:131]
ds_read_b128 v[180:183], v252 offset:9216
v_pk_mul_f16 v173, v172, v173
v_mfma_f32_16x16x32_bf16 v[8:11], v[176:179], v[52:55], 0
ds_read_b128 v[176:179], v252 offset:6144
v_pk_mul_f16 v175, v174, v175
s_waitcnt lgkmcnt(5)
v_mfma_f32_16x16x32_f16 v[80:83], v[188:191], v[100:103], v[80:83]
ds_read_u16 v164, v164
ds_read_u16_d16_hi v165, v165
s_waitcnt lgkmcnt(6)
v_mfma_f32_16x16x32_f16 v[76:79], v[184:187], v[100:103], v[76:79]
v_exp_f16_sdwa v173, v173 dst_sel:WORD_0 dst_unused:UNUSED_PRESERVE src0_sel:WORD_0
v_mfma_f32_16x16x32_f16 v[132:135], v[184:187], v[96:99], v[132:135]
ds_read_b128 v[184:187], v248 offset:16384
v_cvt_pkrtz_f16_f32 v167, v166, v167
s_waitcnt lgkmcnt(6)
v_mfma_f32_16x16x32_bf16 v[0:3], v[120:123], v[56:59], v[0:3]
v_and_b32 v167, s49, v167
v_mfma_f32_16x16x32_f16 v[136:139], v[188:191], v[96:99], v[136:139]
ds_read_b128 v[188:191], v252 offset:10240
v_bfe_u32 v166, v167, 2, 14
s_waitcnt lgkmcnt(6)
v_mfma_f32_16x16x32_f16 v[84:87], v[124:127], v[100:103], v[84:87]
v_lshrrev_b32_e64 v167, 18, v167
v_mfma_f32_16x16x32_f16 v[140:143], v[124:127], v[96:99], v[140:143]
ds_read_b128 v[124:127], v252 offset:11264
ds_read_u16 v166, v166
v_mfma_f32_16x16x32_bf16 v[8:11], v[120:123], v[60:63], v[8:11]
ds_read_b128 v[120:123], v252 offset:13312
ds_read_u16_d16_hi v167, v167
s_waitcnt lgkmcnt(8)
v_mfma_f32_16x16x32_f16 v[88:91], v[176:179], v[100:103], v[88:91]
v_exp_f16_sdwa v175, v175 dst_sel:WORD_0 dst_unused:UNUSED_PRESERVE src0_sel:WORD_0
v_mfma_f32_16x16x32_f16 v[240:243], v[176:179], v[96:99], v[240:243]
ds_read_b128 v[176:179], v248 offset:12544
v_exp_f16_sdwa v173, v173 dst_sel:WORD_1 dst_unused:UNUSED_PRESERVE src0_sel:WORD_1
v_mfma_f32_16x16x32_f16 v[92:95], v[180:183], v[100:103], v[92:95]
v_pk_mul_f16 v101, v154, v155
v_pk_mul_f16 v102, v156, v157
v_pk_mul_f16 v103, v158, v159
v_or_b32 v100, v152, v153
s_waitcnt lgkmcnt(6)
v_mfma_f32_16x16x32_bf16 v[0:3], v[184:187], v[64:67], v[0:3]
v_exp_f16_sdwa v175, v175 dst_sel:WORD_1 dst_unused:UNUSED_PRESERVE src0_sel:WORD_1
v_mfma_f32_16x16x32_f16 v[244:247], v[180:183], v[96:99], v[244:247]
v_or_b32 v96, v144, v145
v_or_b32 v97, v146, v147
v_or_b32_e64 v98, v148, v149
v_or_b32 v99, v150, v151
ds_read_b128 v[180:183], v252 offset:14336
s_waitcnt lgkmcnt(5)
v_mfma_f32_16x16x32_f16 v[72:75], v[188:191], v[108:111], v[72:75]
v_pk_add_f16 v173, v173, 1.0 op_sel_hi:[1,0]
v_mfma_f32_16x16x32_f16 v[128:131], v[188:191], v[104:107], v[128:131]
ds_read_b128 v[188:191], v252 offset:15360
v_pk_add_f16 v175, v175, 1.0 op_sel_hi:[1,0]
v_mfma_f32_16x16x32_bf16 v[8:11], v[184:187], v[68:71], v[8:11]
ds_read_b128 v[184:187], v252 offset:12288
v_rcp_f16_sdwa v173, v173 dst_sel:WORD_0 dst_unused:UNUSED_PRESERVE src0_sel:WORD_0
s_waitcnt lgkmcnt(5)
v_mfma_f32_16x16x32_f16 v[76:79], v[120:123], v[108:111], v[76:79]
v_rcp_f16_sdwa v175, v175 dst_sel:WORD_0 dst_unused:UNUSED_PRESERVE src0_sel:WORD_0
v_mfma_f32_16x16x32_f16 v[132:135], v[120:123], v[104:107], v[132:135]
ds_read_b128 v[120:123], v248 offset:14592
s_setprio 0
v_mfma_f32_16x16x32_f16 v[80:83], v[124:127], v[108:111], v[80:83]
v_rcp_f16_sdwa v171, v171 dst_sel:WORD_1 dst_unused:UNUSED_PRESERVE src0_sel:WORD_1
s_waitcnt lgkmcnt(4)
v_mfma_f32_16x16x32_bf16 v[4:7], v[176:179], v[48:51], 0
v_rcp_f16_sdwa v173, v173 dst_sel:WORD_1 dst_unused:UNUSED_PRESERVE src0_sel:WORD_1
v_mfma_f32_16x16x32_f16 v[136:139], v[124:127], v[104:107], v[136:139]
ds_read_b128 v[124:127], v251 offset:38912
v_rcp_f16_sdwa v175, v175 dst_sel:WORD_1 dst_unused:UNUSED_PRESERVE src0_sel:WORD_1
s_waitcnt lgkmcnt(4)
v_mfma_f32_16x16x32_f16 v[84:87], v[180:183], v[108:111], v[84:87]
v_cvt_pkrtz_f16_f32 v1, v0, v1
v_mfma_f32_16x16x32_f16 v[140:143], v[180:183], v[104:107], v[140:143]
ds_read_b128 v[180:183], v251 offset:39936
v_and_b32_e64 v1, s49, v1
v_mfma_f32_16x16x32_bf16 v[12:15], v[176:179], v[52:55], 0
ds_read_b128 v[176:179], v251 offset:41984
v_bfe_u32 v0, v1, 2, 14
s_waitcnt lgkmcnt(4)
v_mfma_f32_16x16x32_f16 v[88:91], v[184:187], v[108:111], v[88:91]
v_lshrrev_b32 v1, 18, v1
v_mfma_f32_16x16x32_f16 v[240:243], v[184:187], v[104:107], v[240:243]
ds_read_b128 v[184:187], v248 offset:16640
ds_read_u16 v0, v0
v_mfma_f32_16x16x32_f16 v[92:95], v[188:191], v[108:111], v[92:95]
v_pk_mul_f16 v109, v170, v171
s_waitcnt lgkmcnt(5)
v_mfma_f32_16x16x32_bf16 v[4:7], v[120:123], v[56:59], v[4:7]
v_pk_mul_f16 v110, v172, v173
v_mfma_f32_16x16x32_f16 v[244:247], v[188:191], v[104:107], v[244:247]
ds_read_b128 v[188:191], v251 offset:43008
v_or_b32_e64 v104, v160, v161
s_waitcnt lgkmcnt(5)
v_mfma_f32_16x16x32_f16 v[72:75], v[124:127], v[196:199], v[72:75]
v_pk_mul_f16 v111, v174, v175
v_mfma_f32_16x16x32_f16 v[128:131], v[124:127], v[192:195], v[128:131]
ds_read_b128 v[124:127], v248 offset:18432
ds_read_u16_d16_hi v1, v1
v_mfma_f32_16x16x32_bf16 v[12:15], v[120:123], v[60:63], v[12:15]
ds_read_b128 v[120:123], v251 offset:40960
v_cvt_pk_f16_f32 v10, v10, v11
s_waitcnt lgkmcnt(6)
v_mfma_f32_16x16x32_f16 v[76:79], v[176:179], v[196:199], v[76:79]
v_or_b32 v105, v162, v163
v_mfma_f32_16x16x32_f16 v[132:135], v[176:179], v[192:195], v[132:135]
ds_read_b128 v[176:179], v251 offset:44032
v_pk_fma_f16 v11, v10, v10, s48
v_mfma_f32_16x16x32_f16 v[80:83], v[180:183], v[196:199], v[80:83]
v_cvt_pkrtz_f16_f32 v3, v2, v3
s_waitcnt lgkmcnt(6)
v_mfma_f32_16x16x32_bf16 v[4:7], v[184:187], v[64:67], v[4:7]
v_and_b32 v3, s49, v3
v_mfma_f32_16x16x32_f16 v[136:139], v[180:183], v[192:195], v[136:139]
ds_read_b128 v[180:183], v251 offset:45056
v_bfe_u32 v2, v3, 2, 14
s_waitcnt lgkmcnt(5)
v_mfma_f32_16x16x32_f16 v[84:87], v[188:191], v[196:199], v[84:87]
v_lshrrev_b32 v3, 18, v3
v_mfma_f32_16x16x32_f16 v[140:143], v[188:191], v[192:195], v[140:143]
ds_read_b128 v[188:191], v248 offset:20480
ds_read_u16 v2, v2
v_mfma_f32_16x16x32_bf16 v[12:15], v[184:187], v[68:71], v[12:15]
ds_read_b128 v[184:187], v251 offset:48128
ds_read_u16_d16_hi v3, v3
s_waitcnt lgkmcnt(6)
v_mfma_f32_16x16x32_f16 v[88:91], v[120:123], v[196:199], v[88:91]
v_or_b32 v106, v164, v165
v_mfma_f32_16x16x32_f16 v[240:243], v[120:123], v[192:195], v[240:243]
ds_read_b128 v[120:123], v251 offset:46080
s_setprio 3
v_mfma_f32_16x16x32_bf16 v[144:147], v[124:127], v[48:51], 0
v_cvt_pk_f16_f32 v12, v12, v13
s_waitcnt lgkmcnt(6)
v_mfma_f32_16x16x32_f16 v[92:95], v[176:179], v[196:199], v[92:95]
v_cvt_pk_f16_f32 v14, v14, v15
v_mfma_f32_16x16x32_f16 v[244:247], v[176:179], v[192:195], v[244:247]
ds_read_b128 v[176:179], v251 offset:47104
v_pk_fma_f16 v13, v12, v12, s48
s_waitcnt lgkmcnt(6)
v_mfma_f32_16x16x32_f16 v[72:75], v[180:183], v[204:207], v[72:75]
v_pk_fma_f16 v15, v14, v14, s48
v_mfma_f32_16x16x32_bf16 v[152:155], v[124:127], v[52:55], 0
ds_read_b128 v[124:127], v251 offset:49152
v_pk_mul_f16 v11, v10, v11
v_mfma_f32_16x16x32_f16 v[128:131], v[180:183], v[200:203], v[128:131]
ds_read_b128 v[180:183], v248 offset:22528
v_pk_mul_f16 v13, v12, v13
s_waitcnt lgkmcnt(5)
v_mfma_f32_16x16x32_f16 v[76:79], v[184:187], v[204:207], v[76:79]
v_pk_mul_f16 v15, v14, v15
v_mfma_f32_16x16x32_f16 v[132:135], v[184:187], v[200:203], v[132:135]
ds_read_b128 v[184:187], v251 offset:50176
v_cvt_pkrtz_f16_f32 v5, v4, v5
v_mfma_f32_16x16x32_bf16 v[144:147], v[188:191], v[56:59], v[144:147]
v_and_b32_e64 v5, s49, v5
v_mfma_f32_16x16x32_bf16 v[152:155], v[188:191], v[60:63], v[152:155]
ds_read_b128 v[188:191], v251 offset:51200
v_bfe_u32 v4, v5, 2, 14
s_waitcnt lgkmcnt(5)
v_mfma_f32_16x16x32_f16 v[80:83], v[120:123], v[204:207], v[80:83]
v_lshrrev_b32 v5, 18, v5
v_mfma_f32_16x16x32_f16 v[136:139], v[120:123], v[200:203], v[136:139]
ds_read_b128 v[120:123], v248 offset:18688
ds_read_u16 v4, v4
s_waitcnt lgkmcnt(5)
v_mfma_f32_16x16x32_f16 v[84:87], v[124:127], v[204:207], v[84:87]
ds_read_u16_d16_hi v5, v5
v_or_b32 v107, v166, v167
v_mfma_f32_16x16x32_f16 v[140:143], v[124:127], v[200:203], v[140:143]
ds_read_b128 v[124:127], v251 offset:54272
v_exp_f16_sdwa v11, v11 dst_sel:WORD_0 dst_unused:UNUSED_PRESERVE src0_sel:WORD_0
v_mfma_f32_16x16x32_f16 v[88:91], v[176:179], v[204:207], v[88:91]
v_exp_f16_sdwa v13, v13 dst_sel:WORD_0 dst_unused:UNUSED_PRESERVE src0_sel:WORD_0
v_mfma_f32_16x16x32_f16 v[240:243], v[176:179], v[200:203], v[240:243]
ds_read_b128 v[176:179], v248 offset:20736
v_cvt_pkrtz_f16_f32 v7, v6, v7
s_waitcnt lgkmcnt(6)
v_mfma_f32_16x16x32_bf16 v[144:147], v[180:183], v[64:67], v[144:147]
v_and_b32 v7, s49, v7
v_mfma_f32_16x16x32_f16 v[92:95], v[184:187], v[204:207], v[92:95]
v_bfe_u32 v6, v7, 2, 14
v_mfma_f32_16x16x32_f16 v[244:247], v[184:187], v[200:203], v[244:247]
ds_read_b128 v[184:187], v251 offset:55296
buffer_load_dwordx4 v[192:195], v253, s[4:7], s71 offen
buffer_load_dwordx4 v[196:199], v253, s[4:7], s71 offen offset:64
s_waitcnt lgkmcnt(5)
v_mfma_f32_16x16x32_f16 v[72:75], v[188:191], v[212:215], v[72:75]
v_lshrrev_b32 v7, 18, v7
v_mfma_f32_16x16x32_bf16 v[152:155], v[180:183], v[68:71], v[152:155]
ds_read_b128 v[180:183], v251 offset:52224
ds_read_u16 v6, v6
v_mfma_f32_16x16x32_f16 v[128:131], v[188:191], v[208:211], v[128:131]
ds_read_b128 v[188:191], v248 offset:22784
s_setprio 2
ds_read_u16_d16_hi v7, v7
v_exp_f16_sdwa v15, v15 dst_sel:WORD_0 dst_unused:UNUSED_PRESERVE src0_sel:WORD_0
v_or_b32_e64 v108, v168, v169
v_mfma_f32_16x16x32_bf16 v[148:151], v[120:123], v[48:51], 0
v_exp_f16_sdwa v11, v11 dst_sel:WORD_1 dst_unused:UNUSED_PRESERVE src0_sel:WORD_1
s_waitcnt lgkmcnt(6)
v_mfma_f32_16x16x32_f16 v[76:79], v[124:127], v[212:215], v[76:79]
v_exp_f16_sdwa v13, v13 dst_sel:WORD_1 dst_unused:UNUSED_PRESERVE src0_sel:WORD_1
v_mfma_f32_16x16x32_bf16 v[156:159], v[120:123], v[52:55], 0
ds_read_b128 v[120:123], v251 offset:53248
v_cvt_pkrtz_f16_f32 v9, v8, v9
v_and_b32_e64 v9, s49, v9
v_bfe_u32 v8, v9, 2, 14
v_lshrrev_b32 v9, 18, v9
ds_read_u16 v8, v8
ds_read_u16_d16_hi v9, v9
v_mfma_f32_16x16x32_f16 v[132:135], v[124:127], v[208:211], v[132:135]
ds_read_b128 v[124:127], v248 offset:24576
v_exp_f16_sdwa v15, v15 dst_sel:WORD_1 dst_unused:UNUSED_PRESERVE src0_sel:WORD_1
s_waitcnt lgkmcnt(7)
v_mfma_f32_16x16x32_bf16 v[148:151], v[176:179], v[56:59], v[148:151]
v_pk_add_f16 v11, v11, 1.0 op_sel_hi:[1,0]
v_mfma_f32_16x16x32_f16 v[80:83], v[180:183], v[212:215], v[80:83]
v_pk_add_f16 v13, v13, 1.0 op_sel_hi:[1,0]
v_pk_add_f16 v15, v15, 1.0 op_sel_hi:[1,0]
v_mfma_f32_16x16x32_bf16 v[156:159], v[176:179], v[60:63], v[156:159]
ds_read_b128 v[176:179], v251 offset:56320
v_rcp_f16_sdwa v11, v11 dst_sel:WORD_0 dst_unused:UNUSED_PRESERVE src0_sel:WORD_0
v_mfma_f32_16x16x32_f16 v[136:139], v[180:183], v[208:211], v[136:139]
ds_read_b128 v[180:183], v248 offset:26624
v_rcp_f16_sdwa v13, v13 dst_sel:WORD_0 dst_unused:UNUSED_PRESERVE src0_sel:WORD_0
v_mfma_f32_16x16x32_f16 v[84:87], v[184:187], v[212:215], v[84:87]
v_rcp_f16_sdwa v15, v15 dst_sel:WORD_0 dst_unused:UNUSED_PRESERVE src0_sel:WORD_0
s_waitcnt lgkmcnt(5)
v_mfma_f32_16x16x32_bf16 v[148:151], v[188:191], v[64:67], v[148:151]
v_rcp_f16_sdwa v11, v11 dst_sel:WORD_1 dst_unused:UNUSED_PRESERVE src0_sel:WORD_1
v_mfma_f32_16x16x32_f16 v[140:143], v[184:187], v[208:211], v[140:143]
ds_read_b128 v[184:187], v251 offset:57344
v_rcp_f16_sdwa v13, v13 dst_sel:WORD_1 dst_unused:UNUSED_PRESERVE src0_sel:WORD_1
v_mfma_f32_16x16x32_bf16 v[156:159], v[188:191], v[68:71], v[156:159]
ds_read_b128 v[188:191], v248 offset:28672
s_setprio 1
v_mfma_f32_16x16x32_f16 v[88:91], v[120:123], v[212:215], v[88:91]
v_rcp_f16_sdwa v15, v15 dst_sel:WORD_1 dst_unused:UNUSED_PRESERVE src0_sel:WORD_1
s_waitcnt lgkmcnt(4)
v_mfma_f32_16x16x32_bf16 v[160:163], v[124:127], v[48:51], 0
v_or_b32 v200, v0, v1
v_mfma_f32_16x16x32_f16 v[240:243], v[120:123], v[208:211], v[240:243]
ds_read_b128 v[120:123], v251 offset:60416
v_pk_mul_f16 v205, v10, v11
v_mfma_f32_16x16x32_bf16 v[168:171], v[124:127], v[52:55], 0
ds_read_b128 v[124:127], v248 offset:24832
v_pk_mul_f16 v206, v12, v13
s_waitcnt lgkmcnt(4)
v_mfma_f32_16x16x32_f16 v[92:95], v[176:179], v[212:215], v[92:95]
v_pk_mul_f16 v207, v14, v15
v_cvt_pkrtz_f16_f32 v145, v144, v145
v_and_b32 v145, s49, v145
v_bfe_u32 v144, v145, 2, 14
v_lshrrev_b32_e64 v145, 18, v145
ds_read_u16 v144, v144
ds_read_u16_d16_hi v145, v145
v_cvt_pk_f16_f32 v154, v154, v155
v_or_b32_e64 v201, v2, v3
v_mfma_f32_16x16x32_bf16 v[160:163], v[180:183], v[56:59], v[160:163]
v_cvt_pk_f16_f32 v156, v156, v157
v_mfma_f32_16x16x32_f16 v[244:247], v[176:179], v[208:211], v[244:247]
ds_read_b128 v[176:179], v251 offset:58368
v_cvt_pk_f16_f32 v158, v158, v159
v_pk_fma_f16 v155, v154, v154, s48
v_mfma_f32_16x16x32_bf16 v[168:171], v[180:183], v[60:63], v[168:171]
ds_read_b128 v[180:183], v248 offset:26880
v_pk_fma_f16 v157, v156, v156, s48
s_waitcnt lgkmcnt(5)
v_mfma_f32_16x16x32_f16 v[72:75], v[184:187], v[228:231], v[72:75]
v_cvt_pkrtz_f16_f32 v147, v146, v147
v_and_b32 v147, s49, v147
v_bfe_u32 v146, v147, 2, 14
v_lshrrev_b32_e64 v147, 18, v147
ds_read_u16 v146, v146
ds_read_u16_d16_hi v147, v147
v_or_b32_e64 v202, v4, v5
v_pk_fma_f16 v159, v158, v158, s48
v_pk_mul_f16 v155, v154, v155
v_mfma_f32_16x16x32_f16 v[128:131], v[184:187], v[224:227], v[128:131]
ds_read_b128 v[184:187], v251 offset:61440
v_pk_mul_f16 v157, v156, v157
v_mfma_f32_16x16x32_bf16 v[160:163], v[188:191], v[64:67], v[160:163]
v_pk_mul_f16 v159, v158, v159
v_cvt_pkrtz_f16_f32 v149, v148, v149
v_and_b32_e64 v149, s49, v149
v_bfe_u32 v148, v149, 2, 14
v_lshrrev_b32_e64 v149, 18, v149
ds_read_u16 v148, v148
ds_read_u16_d16_hi v149, v149
v_or_b32_e64 v203, v6, v7
v_exp_f16_sdwa v155, v155 dst_sel:WORD_0 dst_unused:UNUSED_PRESERVE src0_sel:WORD_0
v_mfma_f32_16x16x32_f16 v[76:79], v[120:123], v[228:231], v[76:79]
v_exp_f16_sdwa v157, v157 dst_sel:WORD_0 dst_unused:UNUSED_PRESERVE src0_sel:WORD_0
v_mfma_f32_16x16x32_bf16 v[168:171], v[188:191], v[68:71], v[168:171]
ds_read_b128 v[188:191], v251 offset:59392
s_setprio 0
v_mfma_f32_16x16x32_f16 v[132:135], v[120:123], v[224:227], v[132:135]
ds_read_b128 v[120:123], v248 offset:28928
v_cvt_pkrtz_f16_f32 v151, v150, v151
v_and_b32 v151, s49, v151
v_bfe_u32 v150, v151, 2, 14
v_lshrrev_b32_e64 v151, 18, v151
ds_read_u16 v150, v150
ds_read_u16_d16_hi v151, v151
v_exp_f16_sdwa v159, v159 dst_sel:WORD_0 dst_unused:UNUSED_PRESERVE src0_sel:WORD_0
v_or_b32 v204, v8, v9
s_waitcnt lgkmcnt(7)
v_mfma_f32_16x16x32_bf16 v[164:167], v[124:127], v[48:51], 0
v_exp_f16_sdwa v155, v155 dst_sel:WORD_1 dst_unused:UNUSED_PRESERVE src0_sel:WORD_1
v_mfma_f32_16x16x32_f16 v[80:83], v[176:179], v[228:231], v[80:83]
v_exp_f16_sdwa v157, v157 dst_sel:WORD_1 dst_unused:UNUSED_PRESERVE src0_sel:WORD_1
v_mfma_f32_16x16x32_bf16 v[172:175], v[124:127], v[52:55], 0
ds_read_b128 v[124:127], v251 offset:62464
v_cvt_pkrtz_f16_f32 v153, v152, v153
v_and_b32_e64 v153, s49, v153
v_bfe_u32 v152, v153, 2, 14
v_lshrrev_b32_e64 v153, 18, v153
ds_read_u16 v152, v152
ds_read_u16_d16_hi v153, v153
v_mfma_f32_16x16x32_f16 v[136:139], v[176:179], v[224:227], v[136:139]
ds_read_b128 v[176:179], v248 offset:30720
v_exp_f16_sdwa v159, v159 dst_sel:WORD_1 dst_unused:UNUSED_PRESERVE src0_sel:WORD_1
v_mfma_f32_16x16x32_bf16 v[164:167], v[180:183], v[56:59], v[164:167]
v_pk_add_f16 v155, v155, 1.0 op_sel_hi:[1,0]
s_waitcnt lgkmcnt(7)
v_mfma_f32_16x16x32_f16 v[84:87], v[184:187], v[228:231], v[84:87]
v_pk_add_f16 v157, v157, 1.0 op_sel_hi:[1,0]
v_pk_add_f16 v159, v159, 1.0 op_sel_hi:[1,0]
v_mfma_f32_16x16x32_bf16 v[172:175], v[180:183], v[60:63], v[172:175]
ds_read_b128 v[180:183], v251 offset:8192
v_rcp_f16_sdwa v155, v155 dst_sel:WORD_0 dst_unused:UNUSED_PRESERVE src0_sel:WORD_0
v_mfma_f32_16x16x32_f16 v[140:143], v[184:187], v[224:227], v[140:143]
ds_read_b128 v[184:187], v248 offset:32768
v_rcp_f16_sdwa v157, v157 dst_sel:WORD_0 dst_unused:UNUSED_PRESERVE src0_sel:WORD_0
v_mfma_f32_16x16x32_f16 v[88:91], v[188:191], v[228:231], v[88:91]
v_rcp_f16_sdwa v159, v159 dst_sel:WORD_0 dst_unused:UNUSED_PRESERVE src0_sel:WORD_0
s_waitcnt lgkmcnt(6)
v_mfma_f32_16x16x32_bf16 v[164:167], v[120:123], v[64:67], v[164:167]
v_rcp_f16_sdwa v155, v155 dst_sel:WORD_1 dst_unused:UNUSED_PRESERVE src0_sel:WORD_1
v_mfma_f32_16x16x32_f16 v[240:243], v[188:191], v[224:227], v[240:243]
ds_read_b128 v[188:191], v251 offset:11264
v_rcp_f16_sdwa v157, v157 dst_sel:WORD_1 dst_unused:UNUSED_PRESERVE src0_sel:WORD_1
v_mfma_f32_16x16x32_bf16 v[172:175], v[120:123], v[68:71], v[172:175]
ds_read_b128 v[120:123], v248 offset:34816
s_setprio 3
s_waitcnt lgkmcnt(6)
v_mfma_f32_16x16x32_f16 v[92:95], v[124:127], v[228:231], v[92:95]
v_rcp_f16_sdwa v159, v159 dst_sel:WORD_1 dst_unused:UNUSED_PRESERVE src0_sel:WORD_1
s_waitcnt lgkmcnt(4)
v_mfma_f32_16x16x32_bf16 v[0:3], v[176:179], v[48:51], 0
v_or_b32 v208, v144, v145
v_mfma_f32_16x16x32_f16 v[244:247], v[124:127], v[224:227], v[244:247]
ds_read_b128 v[124:127], v251 offset:9216
v_pk_mul_f16 v213, v154, v155
v_mfma_f32_16x16x32_bf16 v[8:11], v[176:179], v[52:55], 0
ds_read_b128 v[176:179], v248 offset:30976
v_pk_mul_f16 v214, v156, v157
s_waitcnt lgkmcnt(5)
v_mfma_f32_16x16x32_f16 v[72:75], v[180:183], v[116:119], v[72:75]
v_pk_mul_f16 v215, v158, v159
v_cvt_pkrtz_f16_f32 v161, v160, v161
v_and_b32 v161, s49, v161
v_bfe_u32 v160, v161, 2, 14
v_lshrrev_b32_e64 v161, 18, v161
ds_read_u16 v160, v160
ds_read_u16_d16_hi v161, v161
v_cvt_pk_f16_f32 v170, v170, v171
v_or_b32 v209, v146, v147
s_waitcnt lgkmcnt(5)
v_mfma_f32_16x16x32_bf16 v[0:3], v[184:187], v[56:59], v[0:3]
v_cvt_pk_f16_f32 v172, v172, v173
v_mfma_f32_16x16x32_f16 v[128:131], v[180:183], v[112:115], v[128:131]
ds_read_b128 v[180:183], v251 offset:12288
v_cvt_pk_f16_f32 v174, v174, v175
v_pk_fma_f16 v171, v170, v170, s48
v_mfma_f32_16x16x32_bf16 v[8:11], v[184:187], v[60:63], v[8:11]
ds_read_b128 v[184:187], v248 offset:33024
v_pk_fma_f16 v173, v172, v172, s48
v_mfma_f32_16x16x32_f16 v[76:79], v[188:191], v[116:119], v[76:79]
v_cvt_pkrtz_f16_f32 v163, v162, v163
v_and_b32_e64 v163, s49, v163
v_bfe_u32 v162, v163, 2, 14
v_lshrrev_b32_e64 v163, 18, v163
ds_read_u16 v162, v162
ds_read_u16_d16_hi v163, v163
v_or_b32_e64 v210, v148, v149
v_pk_fma_f16 v175, v174, v174, s48
v_pk_mul_f16 v171, v170, v171
v_mfma_f32_16x16x32_f16 v[132:135], v[188:191], v[112:115], v[132:135]
ds_read_b128 v[188:191], v251 offset:10240
v_pk_mul_f16 v173, v172, v173
s_waitcnt lgkmcnt(7)
v_mfma_f32_16x16x32_bf16 v[0:3], v[120:123], v[64:67], v[0:3]
v_pk_mul_f16 v175, v174, v175
v_cvt_pkrtz_f16_f32 v165, v164, v165
v_and_b32 v165, s49, v165
v_bfe_u32 v164, v165, 2, 14
v_lshrrev_b32_e64 v165, 18, v165
ds_read_u16 v164, v164
ds_read_u16_d16_hi v165, v165
v_or_b32_e64 v211, v150, v151
v_exp_f16_sdwa v171, v171 dst_sel:WORD_0 dst_unused:UNUSED_PRESERVE src0_sel:WORD_0
v_mfma_f32_16x16x32_f16 v[80:83], v[124:127], v[116:119], v[80:83]
v_exp_f16_sdwa v173, v173 dst_sel:WORD_0 dst_unused:UNUSED_PRESERVE src0_sel:WORD_0
v_mfma_f32_16x16x32_bf16 v[8:11], v[120:123], v[68:71], v[8:11]
ds_read_b128 v[120:123], v251 offset:13312
v_mov_b32 v16, 0
v_mov_b32 v17, 0
v_cndmask_b32 v18, 0, v255, s[88:89]
v_cndmask_b32 v19, 0, v255, s[90:91]
v_mov_b32_e64 v20, 0
v_mov_b32 v21, 0
s_setprio 2
v_mfma_f32_16x16x32_f16 v[136:139], v[124:127], v[112:115], v[136:139]
ds_read_b128 v[124:127], v248 offset:35072
v_cvt_pkrtz_f16_f32 v167, v166, v167
v_and_b32_e64 v167, s49, v167
v_bfe_u32 v166, v167, 2, 14
v_lshrrev_b32_e64 v167, 18, v167
ds_read_u16 v166, v166
ds_read_u16_d16_hi v167, v167
v_exp_f16_sdwa v175, v175 dst_sel:WORD_0 dst_unused:UNUSED_PRESERVE src0_sel:WORD_0
v_or_b32 v212, v152, v153
v_mfma_f32_16x16x32_bf16 v[4:7], v[176:179], v[48:51], 0
v_exp_f16_sdwa v171, v171 dst_sel:WORD_1 dst_unused:UNUSED_PRESERVE src0_sel:WORD_1
s_waitcnt lgkmcnt(6)
v_mfma_f32_16x16x32_f16 v[84:87], v[180:183], v[116:119], v[84:87]
v_exp_f16_sdwa v173, v173 dst_sel:WORD_1 dst_unused:UNUSED_PRESERVE src0_sel:WORD_1
v_mfma_f32_16x16x32_bf16 v[12:15], v[176:179], v[52:55], 0
ds_read_b128 v[176:179], v251 offset:14336
v_cvt_pkrtz_f16_f32 v169, v168, v169
v_and_b32_e64 v169, s49, v169
v_bfe_u32 v168, v169, 2, 14
v_lshrrev_b32_e64 v169, 18, v169
ds_read_u16 v168, v168
ds_read_u16_d16_hi v169, v169
v_mfma_f32_16x16x32_f16 v[140:143], v[180:183], v[112:115], v[140:143]
ds_read_b128 v[180:183], v249
v_exp_f16_sdwa v175, v175 dst_sel:WORD_1 dst_unused:UNUSED_PRESERVE src0_sel:WORD_1
v_mfma_f32_16x16x32_bf16 v[4:7], v[184:187], v[56:59], v[4:7]
v_pk_add_f16 v171, v171, 1.0 op_sel_hi:[1,0]
v_mfma_f32_16x16x32_f16 v[88:91], v[188:191], v[116:119], v[88:91]
v_pk_add_f16 v173, v173, 1.0 op_sel_hi:[1,0]
v_pk_add_f16 v175, v175, 1.0 op_sel_hi:[1,0]
v_mfma_f32_16x16x32_bf16 v[12:15], v[184:187], v[60:63], v[12:15]
ds_read_b128 v[184:187], v251 offset:17408
v_rcp_f16_sdwa v171, v171 dst_sel:WORD_0 dst_unused:UNUSED_PRESERVE src0_sel:WORD_0
v_mfma_f32_16x16x32_f16 v[240:243], v[188:191], v[112:115], v[240:243]
ds_read_b128 v[188:191], v249 offset:2048
v_rcp_f16_sdwa v173, v173 dst_sel:WORD_0 dst_unused:UNUSED_PRESERVE src0_sel:WORD_0
s_waitcnt lgkmcnt(5)
v_mfma_f32_16x16x32_f16 v[92:95], v[120:123], v[116:119], v[92:95]
v_rcp_f16_sdwa v175, v175 dst_sel:WORD_0 dst_unused:UNUSED_PRESERVE src0_sel:WORD_0
v_mfma_f32_16x16x32_bf16 v[4:7], v[124:127], v[64:67], v[4:7]
v_rcp_f16_sdwa v171, v171 dst_sel:WORD_1 dst_unused:UNUSED_PRESERVE src0_sel:WORD_1
v_mfma_f32_16x16x32_f16 v[244:247], v[120:123], v[112:115], v[244:247]
ds_read_b128 v[120:123], v251 offset:15360
v_rcp_f16_sdwa v173, v173 dst_sel:WORD_1 dst_unused:UNUSED_PRESERVE src0_sel:WORD_1
v_mfma_f32_16x16x32_bf16 v[12:15], v[124:127], v[68:71], v[12:15]
ds_read_b128 v[124:127], v249 offset:4096
s_setprio 1
s_waitcnt vmcnt(1)
v_mfma_f32_16x16x32_bf16 v[128:131], v[18:21], v[192:195], v[128:131]
v_rcp_f16_sdwa v175, v175 dst_sel:WORD_1 dst_unused:UNUSED_PRESERVE src0_sel:WORD_1
v_mfma_f32_16x16x32_bf16 v[132:135], v[16:19], v[192:195], v[132:135]
v_or_b32_e64 v192, v160, v161
s_waitcnt vmcnt(0)
v_mfma_f32_16x16x32_bf16 v[136:139], v[18:21], v[196:199], v[136:139]
v_cvt_pkrtz_f16_f32 v1, v0, v1
v_mfma_f32_16x16x32_bf16 v[140:143], v[16:19], v[196:199], v[140:143]
buffer_load_dwordx4 v[224:227], v253, s[4:7], s71 offen offset:128
buffer_load_dwordx4 v[228:231], v253, s[4:7], s71 offen offset:192
buffer_load_dwordx4 v[112:115], v253, s[4:7], s71 offen offset:256
buffer_load_dwordx4 v[116:119], v253, s[4:7], s71 offen offset:320
v_mfma_f32_16x16x32_f16 v[72:75], v[176:179], v[220:223], v[72:75]
v_pk_mul_f16 v197, v170, v171
s_waitcnt lgkmcnt(2)
v_mfma_f32_16x16x32_bf16 v[144:147], v[180:183], v[48:51], 0
v_pk_mul_f16 v198, v172, v173
v_mfma_f32_16x16x32_f16 v[128:131], v[176:179], v[216:219], v[128:131]
ds_read_b128 v[176:179], v251 offset:18432
v_pk_mul_f16 v199, v174, v175
v_mfma_f32_16x16x32_bf16 v[152:155], v[180:183], v[52:55], 0
ds_read_b128 v[180:183], v249 offset:256
v_and_b32 v1, s49, v1
v_mfma_f32_16x16x32_f16 v[76:79], v[184:187], v[220:223], v[76:79]
v_bfe_u32 v0, v1, 2, 14
v_lshrrev_b32_e64 v1, 18, v1
ds_read_u16 v0, v0
ds_read_u16_d16_hi v1, v1
v_cvt_pk_f16_f32 v10, v10, v11
v_or_b32_e64 v193, v162, v163
v_mfma_f32_16x16x32_bf16 v[144:147], v[188:191], v[56:59], v[144:147]
v_cvt_pk_f16_f32 v12, v12, v13
v_mfma_f32_16x16x32_f16 v[132:135], v[184:187], v[216:219], v[132:135]
ds_read_b128 v[184:187], v251 offset:16384
v_cvt_pk_f16_f32 v14, v14, v15
v_pk_fma_f16 v11, v10, v10, s48
v_mfma_f32_16x16x32_bf16 v[152:155], v[188:191], v[60:63], v[152:155]
ds_read_b128 v[188:191], v249 offset:2304
v_pk_fma_f16 v13, v12, v12, s48
s_waitcnt lgkmcnt(6)
v_mfma_f32_16x16x32_f16 v[80:83], v[120:123], v[220:223], v[80:83]
v_cvt_pkrtz_f16_f32 v3, v2, v3
v_and_b32 v3, s49, v3
v_bfe_u32 v2, v3, 2, 14
v_lshrrev_b32_e64 v3, 18, v3
ds_read_u16 v2, v2
ds_read_u16_d16_hi v3, v3
v_or_b32_e64 v194, v164, v165
v_pk_fma_f16 v15, v14, v14, s48
v_pk_mul_f16 v11, v10, v11
v_mfma_f32_16x16x32_f16 v[136:139], v[120:123], v[216:219], v[136:139]
ds_read_b128 v[120:123], v251 offset:19456
v_pk_mul_f16 v13, v12, v13
v_mfma_f32_16x16x32_bf16 v[144:147], v[124:127], v[64:67], v[144:147]
v_pk_mul_f16 v15, v14, v15
v_cvt_pkrtz_f16_f32 v5, v4, v5
v_and_b32_e64 v5, s49, v5
v_bfe_u32 v4, v5, 2, 14
v_lshrrev_b32_e64 v5, 18, v5
ds_read_u16 v4, v4
ds_read_u16_d16_hi v5, v5
v_or_b32 v195, v166, v167
v_exp_f16_sdwa v11, v11 dst_sel:WORD_0 dst_unused:UNUSED_PRESERVE src0_sel:WORD_0
s_waitcnt lgkmcnt(7)
v_mfma_f32_16x16x32_f16 v[84:87], v[176:179], v[220:223], v[84:87]
v_exp_f16_sdwa v13, v13 dst_sel:WORD_0 dst_unused:UNUSED_PRESERVE src0_sel:WORD_0
v_mfma_f32_16x16x32_bf16 v[152:155], v[124:127], v[68:71], v[152:155]
ds_read_b128 v[124:127], v251 offset:63488
s_setprio 0
v_mfma_f32_16x16x32_f16 v[140:143], v[176:179], v[216:219], v[140:143]
ds_read_b128 v[176:179], v249 offset:4352
v_cvt_pkrtz_f16_f32 v7, v6, v7
v_and_b32 v7, s49, v7
v_bfe_u32 v6, v7, 2, 14
v_lshrrev_b32_e64 v7, 18, v7
ds_read_u16 v6, v6
ds_read_u16_d16_hi v7, v7
v_exp_f16_sdwa v15, v15 dst_sel:WORD_0 dst_unused:UNUSED_PRESERVE src0_sel:WORD_0
v_or_b32 v196, v168, v169
v_mfma_f32_16x16x32_bf16 v[148:151], v[180:183], v[48:51], 0
v_exp_f16_sdwa v11, v11 dst_sel:WORD_1 dst_unused:UNUSED_PRESERVE src0_sel:WORD_1
s_waitcnt lgkmcnt(6)
v_mfma_f32_16x16x32_f16 v[88:91], v[184:187], v[220:223], v[88:91]
v_exp_f16_sdwa v13, v13 dst_sel:WORD_1 dst_unused:UNUSED_PRESERVE src0_sel:WORD_1
v_mfma_f32_16x16x32_bf16 v[156:159], v[180:183], v[52:55], 0
ds_read_b128 v[180:183], v252 offset:1024
v_cvt_pkrtz_f16_f32 v9, v8, v9
v_and_b32_e64 v9, s49, v9
v_bfe_u32 v8, v9, 2, 14
v_lshrrev_b32_e64 v9, 18, v9
ds_read_u16 v8, v8
ds_read_u16_d16_hi v9, v9
v_mfma_f32_16x16x32_f16 v[240:243], v[184:187], v[216:219], v[240:243]
ds_read_b128 v[184:187], v249 offset:6144
v_exp_f16_sdwa v15, v15 dst_sel:WORD_1 dst_unused:UNUSED_PRESERVE src0_sel:WORD_1
v_mfma_f32_16x16x32_bf16 v[148:151], v[188:191], v[56:59], v[148:151]
v_pk_add_f16 v11, v11, 1.0 op_sel_hi:[1,0]
v_mfma_f32_16x16x32_f16 v[92:95], v[120:123], v[220:223], v[92:95]
v_pk_add_f16 v13, v13, 1.0 op_sel_hi:[1,0]
v_pk_add_f16 v15, v15, 1.0 op_sel_hi:[1,0]
v_mfma_f32_16x16x32_f16 v[244:247], v[120:123], v[216:219], v[244:247]
ds_read_b128 v[120:123], v249 offset:8192
v_rcp_f16_sdwa v11, v11 dst_sel:WORD_0 dst_unused:UNUSED_PRESERVE src0_sel:WORD_0
v_mfma_f32_16x16x32_bf16 v[156:159], v[188:191], v[60:63], v[156:159]
ds_read_b128 v[188:191], v251 offset:64512
v_rcp_f16_sdwa v13, v13 dst_sel:WORD_0 dst_unused:UNUSED_PRESERVE src0_sel:WORD_0
s_waitcnt lgkmcnt(7)
v_mfma_f32_16x16x32_bf16 v[148:151], v[176:179], v[64:67], v[148:151]
v_rcp_f16_sdwa v15, v15 dst_sel:WORD_0 dst_unused:UNUSED_PRESERVE src0_sel:WORD_0
v_mfma_f32_16x16x32_f16 v[128:131], v[124:127], v[232:235], v[128:131]
v_rcp_f16_sdwa v11, v11 dst_sel:WORD_1 dst_unused:UNUSED_PRESERVE src0_sel:WORD_1
v_mfma_f32_16x16x32_bf16 v[156:159], v[176:179], v[68:71], v[156:159]
ds_read_b128 v[176:179], v249 offset:10240
v_rcp_f16_sdwa v13, v13 dst_sel:WORD_1 dst_unused:UNUSED_PRESERVE src0_sel:WORD_1
v_rcp_f16_sdwa v15, v15 dst_sel:WORD_1 dst_unused:UNUSED_PRESERVE src0_sel:WORD_1
s_waitcnt lgkmcnt(5)
v_mfma_f32_16x16x32_f16 v[132:135], v[180:183], v[232:235], v[132:135]
s_setprio 3
v_or_b32_e64 v216, v0, v1
s_waitcnt lgkmcnt(3)
v_mfma_f32_16x16x32_bf16 v[160:163], v[184:187], v[48:51], 0
v_pk_mul_f16 v221, v10, v11
v_mfma_f32_16x16x32_bf16 v[168:171], v[184:187], v[52:55], 0
ds_read_b128 v[184:187], v249 offset:6400
v_pk_mul_f16 v222, v12, v13
s_waitcnt lgkmcnt(2)
v_mfma_f32_16x16x32_f16 v[80:83], v[188:191], v[236:239], v[80:83]
v_pk_mul_f16 v223, v14, v15
v_cvt_pkrtz_f16_f32 v145, v144, v145
v_and_b32 v145, s49, v145
v_bfe_u32 v144, v145, 2, 14
v_lshrrev_b32_e64 v145, 18, v145
ds_read_u16 v144, v144
ds_read_u16_d16_hi v145, v145
v_cvt_pk_f16_f32 v154, v154, v155
v_or_b32_e64 v217, v2, v3
v_mfma_f32_16x16x32_bf16 v[160:163], v[120:123], v[56:59], v[160:163]
v_cvt_pk_f16_f32 v156, v156, v157
v_mfma_f32_16x16x32_f16 v[136:139], v[188:191], v[232:235], v[136:139]
ds_read_b128 v[188:191], v252 offset:3072
v_cvt_pk_f16_f32 v158, v158, v159
v_pk_fma_f16 v155, v154, v154, s48
v_mfma_f32_16x16x32_bf16 v[168:171], v[120:123], v[60:63], v[168:171]
ds_read_b128 v[120:123], v249 offset:8448
v_pk_fma_f16 v157, v156, v156, s48
v_cvt_pkrtz_f16_f32 v147, v146, v147
v_and_b32_e64 v147, s49, v147
v_bfe_u32 v146, v147, 2, 14
v_lshrrev_b32_e64 v147, 18, v147
ds_read_u16 v146, v146
ds_read_u16_d16_hi v147, v147
v_or_b32 v218, v4, v5
v_pk_fma_f16 v159, v158, v158, s48
v_pk_mul_f16 v155, v154, v155
v_pk_mul_f16 v157, v156, v157
s_waitcnt lgkmcnt(6)
v_mfma_f32_16x16x32_bf16 v[160:163], v[176:179], v[64:67], v[160:163]
v_pk_mul_f16 v159, v158, v159
v_cvt_pkrtz_f16_f32 v149, v148, v149
v_and_b32_e64 v149, s49, v149
v_bfe_u32 v148, v149, 2, 14
v_lshrrev_b32_e64 v149, 18, v149
ds_read_u16 v148, v148
ds_read_u16_d16_hi v149, v149
v_or_b32_e64 v219, v6, v7
v_exp_f16_sdwa v155, v155 dst_sel:WORD_0 dst_unused:UNUSED_PRESERVE src0_sel:WORD_0
v_mfma_f32_16x16x32_bf16 v[168:171], v[176:179], v[68:71], v[168:171]
ds_read_b128 v[176:179], v251 offset:11264
v_exp_f16_sdwa v157, v157 dst_sel:WORD_0 dst_unused:UNUSED_PRESERVE src0_sel:WORD_0
v_cvt_pkrtz_f16_f32 v151, v150, v151
v_and_b32_e64 v151, s49, v151
v_bfe_u32 v150, v151, 2, 14
v_lshrrev_b32_e64 v151, 18, v151
ds_read_u16 v150, v150
ds_read_u16_d16_hi v151, v151
v_exp_f16_sdwa v159, v159 dst_sel:WORD_0 dst_unused:UNUSED_PRESERVE src0_sel:WORD_0
v_or_b32_e64 v220, v8, v9
v_mfma_f32_16x16x32_bf16 v[164:167], v[184:187], v[48:51], 0
s_setprio 2
v_exp_f16_sdwa v155, v155 dst_sel:WORD_1 dst_unused:UNUSED_PRESERVE src0_sel:WORD_1
s_waitcnt lgkmcnt(6)
v_mfma_f32_16x16x32_f16 v[92:95], v[188:191], v[236:239], v[92:95]
v_exp_f16_sdwa v157, v157 dst_sel:WORD_1 dst_unused:UNUSED_PRESERVE src0_sel:WORD_1
v_mfma_f32_16x16x32_bf16 v[172:175], v[184:187], v[52:55], 0
ds_read_b128 v[184:187], v251 offset:9216
v_cvt_pkrtz_f16_f32 v153, v152, v153
v_and_b32_e64 v153, s49, v153
v_bfe_u32 v152, v153, 2, 14
v_lshrrev_b32_e64 v153, 18, v153
ds_read_u16 v152, v152
ds_read_u16_d16_hi v153, v153
v_exp_f16_sdwa v159, v159 dst_sel:WORD_1 dst_unused:UNUSED_PRESERVE src0_sel:WORD_1
v_mfma_f32_16x16x32_bf16 v[164:167], v[120:123], v[56:59], v[164:167]
v_pk_add_f16 v155, v155, 1.0 op_sel_hi:[1,0]
v_pk_add_f16 v157, v157, 1.0 op_sel_hi:[1,0]
v_pk_add_f16 v159, v159, 1.0 op_sel_hi:[1,0]
v_mfma_f32_16x16x32_bf16 v[172:175], v[120:123], v[60:63], v[172:175]
ds_read_b128 v[120:123], v251 offset:12288
v_rcp_f16_sdwa v155, v155 dst_sel:WORD_0 dst_unused:UNUSED_PRESERVE src0_sel:WORD_0
s_waitcnt vmcnt(3)
v_mfma_f32_16x16x32_bf16 v[240:243], v[18:21], v[224:227], v[240:243]
v_mfma_f32_16x16x32_bf16 v[244:247], v[16:19], v[224:227], v[244:247]
v_cvt_pk_bf16_f32 v224, v128, v129
s_waitcnt vmcnt(2)
v_mfma_f32_16x16x32_bf16 v[72:75], v[18:21], v[228:231], v[72:75]
v_cvt_pk_bf16_f32 v225, v130, v131
v_mfma_f32_16x16x32_bf16 v[76:79], v[16:19], v[228:231], v[76:79]
v_cvt_pk_bf16_f32 v226, v132, v133
v_mfma_f32_16x16x32_f16 v[72:75], v[124:127], v[236:239], v[72:75]
ds_read_b128 v[124:127], v252 offset:2048
v_cvt_pk_bf16_f32 v227, v134, v135
v_mfma_f32_16x16x32_f16 v[76:79], v[180:183], v[236:239], v[76:79]
ds_read_b128 v[180:183], v252
ds_read_b128 v[128:131], v254 offset:8192
ds_read_b128 v[132:135], v254 offset:8208
v_cvt_pk_bf16_f32 v228, v136, v137
v_cvt_pk_bf16_f32 v229, v138, v139
ds_read_b128 v[136:139], v254 offset:8320
v_mfma_f32_16x16x32_f16 v[244:247], v[188:191], v[232:235], v[244:247]
s_waitcnt lgkmcnt(5)
ds_read_b128 v[188:191], v249 offset:12288
v_rcp_f16_sdwa v157, v157 dst_sel:WORD_0 dst_unused:UNUSED_PRESERVE src0_sel:WORD_0
s_waitcnt vmcnt(1)
v_mfma_f32_16x16x32_bf16 v[80:83], v[18:21], v[112:115], v[80:83]
v_rcp_f16_sdwa v159, v159 dst_sel:WORD_0 dst_unused:UNUSED_PRESERVE src0_sel:WORD_0
s_waitcnt vmcnt(0)
v_mfma_f32_16x16x32_bf16 v[92:95], v[16:19], v[116:119], v[92:95]
v_rcp_f16_sdwa v155, v155 dst_sel:WORD_1 dst_unused:UNUSED_PRESERVE src0_sel:WORD_1
s_waitcnt lgkmcnt(5)
v_mfma_f32_16x16x32_f16 v[84:87], v[124:127], v[236:239], v[84:87]
v_rcp_f16_sdwa v157, v157 dst_sel:WORD_1 dst_unused:UNUSED_PRESERVE src0_sel:WORD_1
v_mfma_f32_16x16x32_f16 v[140:143], v[124:127], v[232:235], v[140:143]
ds_read_b128 v[124:127], v251 offset:8192
s_nop 1
v_cvt_pk_bf16_f32 v22, v92, v93
s_waitcnt lgkmcnt(5)
v_mfma_f32_16x16x32_f16 v[88:91], v[180:183], v[236:239], v[88:91]
v_cvt_pk_bf16_f32 v236, v72, v73
v_mfma_f32_16x16x32_f16 v[240:243], v[180:183], v[232:235], v[240:243]
ds_read_b128 v[180:183], v249 offset:10496
v_cvt_pk_bf16_f32 v237, v74, v75
v_cvt_pk_bf16_f32 v230, v140, v141
v_cvt_pk_bf16_f32 v231, v142, v143
ds_read_b128 v[140:143], v254 offset:8336
v_cvt_pk_bf16_f32 v238, v76, v77
v_cvt_pk_bf16_f32 v239, v78, v79
v_cvt_pk_bf16_f32 v234, v244, v245
v_cvt_pk_bf16_f32 v235, v246, v247
v_cvt_pk_bf16_f32 v232, v240, v241
v_cvt_pk_bf16_f32 v233, v242, v243
ds_read_b128 v[240:243], v254
ds_read_b128 v[244:247], v254 offset:16
v_mfma_f32_16x16x32_bf16 v[84:87], v[16:19], v[112:115], v[84:87]
v_cvt_pk_bf16_f32 v16, v80, v81
v_mfma_f32_16x16x32_bf16 v[88:91], v[18:21], v[116:119], v[88:91]
v_cvt_pk_bf16_f32 v17, v82, v83
v_cvt_pk_bf16_f32 v23, v94, v95
s_waitcnt lgkmcnt(4)
v_mfma_f32_16x16x32_f16 v[72:75], v[124:127], v[100:103], v[128:131]
v_rcp_f16_sdwa v159, v159 dst_sel:WORD_1 dst_unused:UNUSED_PRESERVE src0_sel:WORD_1
s_nop 0
v_cvt_pk_bf16_f32 v18, v84, v85
v_cvt_pk_bf16_f32 v19, v86, v87
v_cvt_pk_bf16_f32 v20, v88, v89
v_cvt_pk_bf16_f32 v21, v90, v91
v_mfma_f32_16x16x32_f16 v[128:131], v[124:127], v[96:99], v[128:131]
ds_read_b128 v[124:127], v249 offset:14336
buffer_store_dwordx4 v[224:227], v253, s[8:11], s71 offen sc1
buffer_store_dwordx4 v[228:231], v253, s[8:11], s71 offen offset:64 sc1
v_mfma_f32_16x16x32_f16 v[76:79], v[176:179], v[100:103], v[132:135]
v_or_b32_e64 v112, v144, v145
s_waitcnt lgkmcnt(3)
v_mfma_f32_16x16x32_bf16 v[164:167], v[180:183], v[64:67], v[164:167]
v_pk_mul_f16 v117, v154, v155
v_mfma_f32_16x16x32_f16 v[132:135], v[176:179], v[96:99], v[132:135]
ds_read_b128 v[176:179], v251 offset:10240
v_pk_mul_f16 v118, v156, v157
v_mfma_f32_16x16x32_bf16 v[172:175], v[180:183], v[68:71], v[172:175]
ds_read_b128 v[180:183], v249 offset:16384
s_setprio 1
v_mfma_f32_16x16x32_f16 v[80:83], v[184:187], v[100:103], v[136:139]
s_getpc_b64 s[74:75]
Lcq11:
s_lshl_b32 s43, s40, 10
s_add_u32 s43, s43, 6144
s_min_u32 s43, s43, Lend-Lcq11-1024
s_add_u32 s74, s74, s43
s_addc_u32 s75, s75, 0
s_sub_u32 s74, s74, 16384
s_subb_u32 s75, s75, 0
s_mov_b32 m0, 163840
s_nop 0
global_load_lds_dword v250, s[74:75]
v_pk_mul_f16 v119, v158, v159
v_mfma_f32_16x16x32_bf16 v[0:3], v[188:191], v[48:51], 0
v_cvt_pkrtz_f16_f32 v161, v160, v161
v_mfma_f32_16x16x32_f16 v[136:139], v[184:187], v[96:99], v[136:139]
ds_read_b128 v[184:187], v251 offset:13312
v_and_b32_e64 v161, s49, v161
v_mfma_f32_16x16x32_bf16 v[8:11], v[188:191], v[52:55], 0
ds_read_b128 v[188:191], v249 offset:12544
v_bfe_u32 v160, v161, 2, 14
v_mfma_f32_16x16x32_f16 v[84:87], v[120:123], v[100:103], v[140:143]
v_lshrrev_b32_e64 v161, 18, v161
ds_read_u16 v160, v160
ds_read_u16_d16_hi v161, v161
v_cvt_pk_f16_f32 v170, v170, v171
v_or_b32 v113, v146, v147
s_waitcnt lgkmcnt(6)
v_mfma_f32_16x16x32_bf16 v[0:3], v[124:127], v[56:59], v[0:3]
v_cvt_pk_f16_f32 v172, v172, v173
v_mfma_f32_16x16x32_f16 v[140:143], v[120:123], v[96:99], v[140:143]
ds_read_b128 v[120:123], v251 offset:14336
v_cvt_pk_f16_f32 v174, v174, v175
v_pk_fma_f16 v171, v170, v170, s48
s_waitcnt lgkmcnt(5)
v_mfma_f32_16x16x32_f16 v[88:91], v[176:179], v[100:103], v[240:243]
v_pk_fma_f16 v173, v172, v172, s48
v_mfma_f32_16x16x32_bf16 v[8:11], v[124:127], v[60:63], v[8:11]
ds_read_b128 v[124:127], v249 offset:14592
v_cvt_pkrtz_f16_f32 v163, v162, v163
v_and_b32 v163, s49, v163
v_bfe_u32 v162, v163, 2, 14
v_lshrrev_b32_e64 v163, 18, v163
ds_read_u16 v162, v162
ds_read_u16_d16_hi v163, v163
v_or_b32_e64 v114, v148, v149
v_pk_fma_f16 v175, v174, v174, s48
v_pk_mul_f16 v171, v170, v171
v_mfma_f32_16x16x32_f16 v[240:243], v[176:179], v[96:99], v[240:243]
ds_read_b128 v[176:179], v251 offset:17408
v_pk_mul_f16 v173, v172, v173
v_mfma_f32_16x16x32_bf16 v[0:3], v[180:183], v[64:67], v[0:3]
v_pk_mul_f16 v175, v174, v175
v_cvt_pkrtz_f16_f32 v165, v164, v165
v_and_b32_e64 v165, s49, v165
v_bfe_u32 v164, v165, 2, 14
v_lshrrev_b32_e64 v165, 18, v165
ds_read_u16 v164, v164
ds_read_u16_d16_hi v165, v165
v_or_b32 v115, v150, v151
v_exp_f16_sdwa v171, v171 dst_sel:WORD_0 dst_unused:UNUSED_PRESERVE src0_sel:WORD_0
s_waitcnt lgkmcnt(7)
v_mfma_f32_16x16x32_f16 v[92:95], v[184:187], v[100:103], v[244:247]
v_exp_f16_sdwa v173, v173 dst_sel:WORD_0 dst_unused:UNUSED_PRESERVE src0_sel:WORD_0
v_mfma_f32_16x16x32_bf16 v[8:11], v[180:183], v[68:71], v[8:11]
ds_read_b128 v[180:183], v251 offset:15360
s_setprio 0
v_mfma_f32_16x16x32_f16 v[244:247], v[184:187], v[96:99], v[244:247]
ds_read_b128 v[184:187], v249 offset:16640
v_cvt_pkrtz_f16_f32 v167, v166, v167
v_and_b32 v167, s49, v167
v_bfe_u32 v166, v167, 2, 14
v_lshrrev_b32_e64 v167, 18, v167
ds_read_u16 v166, v166
ds_read_u16_d16_hi v167, v167
v_exp_f16_sdwa v175, v175 dst_sel:WORD_0 dst_unused:UNUSED_PRESERVE src0_sel:WORD_0
v_or_b32 v116, v152, v153
v_mfma_f32_16x16x32_bf16 v[4:7], v[188:191], v[48:51], 0
v_exp_f16_sdwa v171, v171 dst_sel:WORD_1 dst_unused:UNUSED_PRESERVE src0_sel:WORD_1
s_waitcnt lgkmcnt(6)
v_mfma_f32_16x16x32_f16 v[72:75], v[120:123], v[108:111], v[72:75]
v_exp_f16_sdwa v173, v173 dst_sel:WORD_1 dst_unused:UNUSED_PRESERVE src0_sel:WORD_1
v_mfma_f32_16x16x32_bf16 v[12:15], v[188:191], v[52:55], 0
ds_read_b128 v[188:191], v251 offset:18432
v_cvt_pkrtz_f16_f32 v169, v168, v169
v_and_b32_e64 v169, s49, v169
v_bfe_u32 v168, v169, 2, 14
v_lshrrev_b32_e64 v169, 18, v169
ds_read_u16 v168, v168
ds_read_u16_d16_hi v169, v169
v_mfma_f32_16x16x32_f16 v[128:131], v[120:123], v[104:107], v[128:131]
ds_read_b128 v[120:123], v249 offset:18432
v_exp_f16_sdwa v175, v175 dst_sel:WORD_1 dst_unused:UNUSED_PRESERVE src0_sel:WORD_1
v_mfma_f32_16x16x32_bf16 v[4:7], v[124:127], v[56:59], v[4:7]
v_pk_add_f16 v171, v171, 1.0 op_sel_hi:[1,0]
v_mfma_f32_16x16x32_f16 v[76:79], v[176:179], v[108:111], v[76:79]
v_pk_add_f16 v173, v173, 1.0 op_sel_hi:[1,0]
v_pk_add_f16 v175, v175, 1.0 op_sel_hi:[1,0]
v_mfma_f32_16x16x32_f16 v[132:135], v[176:179], v[104:107], v[132:135]
ds_read_b128 v[176:179], v249 offset:20480
v_rcp_f16_sdwa v171, v171 dst_sel:WORD_0 dst_unused:UNUSED_PRESERVE src0_sel:WORD_0
v_mfma_f32_16x16x32_bf16 v[12:15], v[124:127], v[60:63], v[12:15]
ds_read_b128 v[124:127], v251 offset:16384
v_rcp_f16_sdwa v173, v173 dst_sel:WORD_0 dst_unused:UNUSED_PRESERVE src0_sel:WORD_0
s_waitcnt lgkmcnt(7)
v_mfma_f32_16x16x32_f16 v[80:83], v[180:183], v[108:111], v[80:83]
v_rcp_f16_sdwa v175, v175 dst_sel:WORD_0 dst_unused:UNUSED_PRESERVE src0_sel:WORD_0
v_mfma_f32_16x16x32_bf16 v[4:7], v[184:187], v[64:67], v[4:7]
v_rcp_f16_sdwa v171, v171 dst_sel:WORD_1 dst_unused:UNUSED_PRESERVE src0_sel:WORD_1
v_mfma_f32_16x16x32_f16 v[136:139], v[180:183], v[104:107], v[136:139]
ds_read_b128 v[180:183], v251 offset:19456
s_setprio 3
v_mfma_f32_16x16x32_bf16 v[12:15], v[184:187], v[68:71], v[12:15]
ds_read_b128 v[184:187], v249 offset:22528
v_rcp_f16_sdwa v173, v173 dst_sel:WORD_1 dst_unused:UNUSED_PRESERVE src0_sel:WORD_1
s_waitcnt lgkmcnt(6)
v_mfma_f32_16x16x32_f16 v[84:87], v[188:191], v[108:111], v[84:87]
v_rcp_f16_sdwa v175, v175 dst_sel:WORD_1 dst_unused:UNUSED_PRESERVE src0_sel:WORD_1
s_waitcnt lgkmcnt(4)
v_mfma_f32_16x16x32_bf16 v[144:147], v[120:123], v[48:51], 0
v_or_b32_e64 v224, v160, v161
v_mfma_f32_16x16x32_f16 v[140:143], v[188:191], v[104:107], v[140:143]
ds_read_b128 v[188:191], v251 offset:20480
v_pk_mul_f16 v229, v170, v171
v_mfma_f32_16x16x32_bf16 v[152:155], v[120:123], v[52:55], 0
ds_read_b128 v[120:123], v249 offset:18688
v_pk_mul_f16 v230, v172, v173
s_waitcnt lgkmcnt(4)
v_mfma_f32_16x16x32_f16 v[88:91], v[124:127], v[108:111], v[88:91]
v_pk_mul_f16 v231, v174, v175
v_cvt_pkrtz_f16_f32 v1, v0, v1
v_and_b32 v1, s49, v1
v_bfe_u32 v0, v1, 2, 14
v_lshrrev_b32_e64 v1, 18, v1
ds_read_u16 v0, v0
ds_read_u16_d16_hi v1, v1
v_cvt_pk_f16_f32 v10, v10, v11
v_or_b32_e64 v225, v162, v163
v_mfma_f32_16x16x32_bf16 v[144:147], v[176:179], v[56:59], v[144:147]
v_cvt_pk_f16_f32 v12, v12, v13
v_mfma_f32_16x16x32_f16 v[240:243], v[124:127], v[104:107], v[240:243]
ds_read_b128 v[124:127], v251 offset:23552
v_cvt_pk_f16_f32 v14, v14, v15
v_pk_fma_f16 v11, v10, v10, s48
s_waitcnt lgkmcnt(5)
v_mfma_f32_16x16x32_f16 v[92:95], v[180:183], v[108:111], v[92:95]
v_pk_fma_f16 v13, v12, v12, s48
v_mfma_f32_16x16x32_bf16 v[152:155], v[176:179], v[60:63], v[152:155]
ds_read_b128 v[176:179], v249 offset:20736
v_cvt_pkrtz_f16_f32 v3, v2, v3
v_and_b32 v3, s49, v3
v_bfe_u32 v2, v3, 2, 14
v_lshrrev_b32_e64 v3, 18, v3
ds_read_u16 v2, v2
ds_read_u16_d16_hi v3, v3
v_or_b32_e64 v226, v164, v165
v_pk_fma_f16 v15, v14, v14, s48
v_pk_mul_f16 v11, v10, v11
v_mfma_f32_16x16x32_f16 v[244:247], v[180:183], v[104:107], v[244:247]
ds_read_b128 v[180:183], v251 offset:21504
v_pk_mul_f16 v13, v12, v13
v_mfma_f32_16x16x32_bf16 v[144:147], v[184:187], v[64:67], v[144:147]
v_pk_mul_f16 v15, v14, v15
buffer_store_dwordx4 v[232:235], v253, s[8:11], s71 offen offset:128 sc1
buffer_store_dwordx4 v[236:239], v253, s[8:11], s71 offen offset:192 sc1
v_cvt_pkrtz_f16_f32 v5, v4, v5
v_and_b32_e64 v5, s49, v5
v_bfe_u32 v4, v5, 2, 14
v_lshrrev_b32_e64 v5, 18, v5
ds_read_u16 v4, v4
ds_read_u16_d16_hi v5, v5
v_or_b32_e64 v227, v166, v167
v_exp_f16_sdwa v11, v11 dst_sel:WORD_0 dst_unused:UNUSED_PRESERVE src0_sel:WORD_0
s_waitcnt lgkmcnt(6)
v_mfma_f32_16x16x32_f16 v[72:75], v[188:191], v[204:207], v[72:75]
s_setprio 2
v_exp_f16_sdwa v13, v13 dst_sel:WORD_0 dst_unused:UNUSED_PRESERVE src0_sel:WORD_0
v_mfma_f32_16x16x32_bf16 v[152:155], v[184:187], v[68:71], v[152:155]
ds_read_b128 v[184:187], v251 offset:24576
v_cvt_pkrtz_f16_f32 v7, v6, v7
v_mfma_f32_16x16x32_f16 v[128:131], v[188:191], v[200:203], v[128:131]
ds_read_b128 v[188:191], v249 offset:22784
v_and_b32_e64 v7, s49, v7
v_bfe_u32 v6, v7, 2, 14
v_lshrrev_b32_e64 v7, 18, v7
ds_read_u16 v6, v6
ds_read_u16_d16_hi v7, v7
v_exp_f16_sdwa v15, v15 dst_sel:WORD_0 dst_unused:UNUSED_PRESERVE src0_sel:WORD_0
v_or_b32_e64 v228, v168, v169
v_mfma_f32_16x16x32_bf16 v[148:151], v[120:123], v[48:51], 0
v_exp_f16_sdwa v11, v11 dst_sel:WORD_1 dst_unused:UNUSED_PRESERVE src0_sel:WORD_1
v_mfma_f32_16x16x32_f16 v[76:79], v[124:127], v[204:207], v[76:79]
v_exp_f16_sdwa v13, v13 dst_sel:WORD_1 dst_unused:UNUSED_PRESERVE src0_sel:WORD_1
v_mfma_f32_16x16x32_bf16 v[156:159], v[120:123], v[52:55], 0
ds_read_b128 v[120:123], v251 offset:22528
v_cvt_pkrtz_f16_f32 v9, v8, v9
v_and_b32_e64 v9, s49, v9
v_bfe_u32 v8, v9, 2, 14
v_lshrrev_b32 v9, 18, v9
ds_read_u16 v8, v8
ds_read_u16_d16_hi v9, v9
v_mfma_f32_16x16x32_f16 v[132:135], v[124:127], v[200:203], v[132:135]
ds_read_b128 v[124:127], v249 offset:24576
v_exp_f16_sdwa v15, v15 dst_sel:WORD_1 dst_unused:UNUSED_PRESERVE src0_sel:WORD_1
s_waitcnt lgkmcnt(7)
v_mfma_f32_16x16x32_bf16 v[148:151], v[176:179], v[56:59], v[148:151]
v_pk_add_f16 v11, v11, 1.0 op_sel_hi:[1,0]
v_mfma_f32_16x16x32_f16 v[80:83], v[180:183], v[204:207], v[80:83]
v_pk_add_f16 v13, v13, 1.0 op_sel_hi:[1,0]
v_pk_add_f16 v15, v15, 1.0 op_sel_hi:[1,0]
v_mfma_f32_16x16x32_f16 v[136:139], v[180:183], v[200:203], v[136:139]
ds_read_b128 v[180:183], v249 offset:26624
v_rcp_f16_sdwa v11, v11 dst_sel:WORD_0 dst_unused:UNUSED_PRESERVE src0_sel:WORD_0
v_mfma_f32_16x16x32_bf16 v[156:159], v[176:179], v[60:63], v[156:159]
ds_read_b128 v[176:179], v251 offset:25600
v_rcp_f16_sdwa v13, v13 dst_sel:WORD_0 dst_unused:UNUSED_PRESERVE src0_sel:WORD_0
v_mfma_f32_16x16x32_f16 v[84:87], v[184:187], v[204:207], v[84:87]
v_rcp_f16_sdwa v15, v15 dst_sel:WORD_0 dst_unused:UNUSED_PRESERVE src0_sel:WORD_0
s_waitcnt lgkmcnt(5)
v_mfma_f32_16x16x32_bf16 v[148:151], v[188:191], v[64:67], v[148:151]
v_rcp_f16_sdwa v11, v11 dst_sel:WORD_1 dst_unused:UNUSED_PRESERVE src0_sel:WORD_1
v_mfma_f32_16x16x32_f16 v[140:143], v[184:187], v[200:203], v[140:143]
ds_read_b128 v[184:187], v251 offset:26624
s_setprio 1
v_mfma_f32_16x16x32_bf16 v[156:159], v[188:191], v[68:71], v[156:159]
ds_read_b128 v[188:191], v249 offset:28672
v_rcp_f16_sdwa v13, v13 dst_sel:WORD_1 dst_unused:UNUSED_PRESERVE src0_sel:WORD_1
v_mfma_f32_16x16x32_f16 v[88:91], v[120:123], v[204:207], v[88:91]
v_rcp_f16_sdwa v15, v15 dst_sel:WORD_1 dst_unused:UNUSED_PRESERVE src0_sel:WORD_1
s_waitcnt lgkmcnt(4)
v_mfma_f32_16x16x32_bf16 v[160:163], v[124:127], v[48:51], 0
v_or_b32 v96, v0, v1
v_mfma_f32_16x16x32_f16 v[240:243], v[120:123], v[200:203], v[240:243]
ds_read_b128 v[120:123], v251 offset:29696
v_pk_mul_f16 v101, v10, v11
v_mfma_f32_16x16x32_bf16 v[168:171], v[124:127], v[52:55], 0
ds_read_b128 v[124:127], v249 offset:24832
v_pk_mul_f16 v102, v12, v13
s_waitcnt lgkmcnt(4)
v_mfma_f32_16x16x32_f16 v[92:95], v[176:179], v[204:207], v[92:95]
v_pk_mul_f16 v103, v14, v15
v_cvt_pkrtz_f16_f32 v145, v144, v145
v_and_b32 v145, s49, v145
v_bfe_u32 v144, v145, 2, 14
v_lshrrev_b32_e64 v145, 18, v145
ds_read_u16 v144, v144
ds_read_u16_d16_hi v145, v145
v_cvt_pk_f16_f32 v154, v154, v155
v_or_b32_e64 v97, v2, v3
v_mfma_f32_16x16x32_bf16 v[160:163], v[180:183], v[56:59], v[160:163]
v_cvt_pk_f16_f32 v156, v156, v157
v_mfma_f32_16x16x32_f16 v[244:247], v[176:179], v[200:203], v[244:247]
ds_read_b128 v[176:179], v251 offset:27648
v_cvt_pk_f16_f32 v158, v158, v159
v_pk_fma_f16 v155, v154, v154, s48
s_waitcnt lgkmcnt(5)
v_mfma_f32_16x16x32_f16 v[72:75], v[184:187], v[212:215], v[72:75]
v_pk_fma_f16 v157, v156, v156, s48
v_mfma_f32_16x16x32_bf16 v[168:171], v[180:183], v[60:63], v[168:171]
ds_read_b128 v[180:183], v249 offset:26880
v_cvt_pkrtz_f16_f32 v147, v146, v147
v_and_b32 v147, s49, v147
v_bfe_u32 v146, v147, 2, 14
v_lshrrev_b32_e64 v147, 18, v147
ds_read_u16 v146, v146
ds_read_u16_d16_hi v147, v147
v_or_b32_e64 v98, v4, v5
v_pk_fma_f16 v159, v158, v158, s48
v_pk_mul_f16 v155, v154, v155
v_mfma_f32_16x16x32_f16 v[128:131], v[184:187], v[208:211], v[128:131]
ds_read_b128 v[184:187], v251 offset:30720
v_pk_mul_f16 v157, v156, v157
v_mfma_f32_16x16x32_bf16 v[160:163], v[188:191], v[64:67], v[160:163]
v_pk_mul_f16 v159, v158, v159
v_cvt_pkrtz_f16_f32 v149, v148, v149
v_and_b32_e64 v149, s49, v149
v_bfe_u32 v148, v149, 2, 14
v_lshrrev_b32_e64 v149, 18, v149
ds_read_u16 v148, v148
ds_read_u16_d16_hi v149, v149
v_or_b32_e64 v99, v6, v7
v_exp_f16_sdwa v155, v155 dst_sel:WORD_0 dst_unused:UNUSED_PRESERVE src0_sel:WORD_0
buffer_load_dwordx4 v[232:235], v253, s[4:7], s70 offen
buffer_load_dwordx4 v[236:239], v253, s[4:7], s70 offen offset:64
s_waitcnt lgkmcnt(6)
v_mfma_f32_16x16x32_f16 v[76:79], v[120:123], v[212:215], v[76:79]
s_setprio 0
v_exp_f16_sdwa v157, v157 dst_sel:WORD_0 dst_unused:UNUSED_PRESERVE src0_sel:WORD_0
v_mfma_f32_16x16x32_bf16 v[168:171], v[188:191], v[68:71], v[168:171]
ds_read_b128 v[188:191], v251 offset:28672
v_cvt_pkrtz_f16_f32 v151, v150, v151
v_mfma_f32_16x16x32_f16 v[132:135], v[120:123], v[208:211], v[132:135]
ds_read_b128 v[120:123], v249 offset:28928
v_and_b32_e64 v151, s49, v151
v_bfe_u32 v150, v151, 2, 14
v_lshrrev_b32_e64 v151, 18, v151
ds_read_u16 v150, v150
ds_read_u16_d16_hi v151, v151
v_exp_f16_sdwa v159, v159 dst_sel:WORD_0 dst_unused:UNUSED_PRESERVE src0_sel:WORD_0
v_or_b32_e64 v100, v8, v9
v_mfma_f32_16x16x32_bf16 v[164:167], v[124:127], v[48:51], 0
v_exp_f16_sdwa v155, v155 dst_sel:WORD_1 dst_unused:UNUSED_PRESERVE src0_sel:WORD_1
v_mfma_f32_16x16x32_f16 v[80:83], v[176:179], v[212:215], v[80:83]
v_exp_f16_sdwa v157, v157 dst_sel:WORD_1 dst_unused:UNUSED_PRESERVE src0_sel:WORD_1
v_mfma_f32_16x16x32_bf16 v[172:175], v[124:127], v[52:55], 0
ds_read_b128 v[124:127], v251 offset:31744
v_cvt_pkrtz_f16_f32 v153, v152, v153
v_and_b32_e64 v153, s49, v153
v_bfe_u32 v152, v153, 2, 14
v_lshrrev_b32 v153, 18, v153
ds_read_u16 v152, v152
ds_read_u16_d16_hi v153, v153
v_mfma_f32_16x16x32_f16 v[136:139], v[176:179], v[208:211], v[136:139]
ds_read_b128 v[176:179], v249 offset:30720
v_exp_f16_sdwa v159, v159 dst_sel:WORD_1 dst_unused:UNUSED_PRESERVE src0_sel:WORD_1
s_waitcnt lgkmcnt(7)
v_mfma_f32_16x16x32_bf16 v[164:167], v[180:183], v[56:59], v[164:167]
v_pk_add_f16 v155, v155, 1.0 op_sel_hi:[1,0]
v_mfma_f32_16x16x32_f16 v[84:87], v[184:187], v[212:215], v[84:87]
v_pk_add_f16 v157, v157, 1.0 op_sel_hi:[1,0]
v_mfma_f32_16x16x32_f16 v[140:143], v[184:187], v[208:211], v[140:143]
ds_read_b128 v[184:187], v249 offset:32768
v_pk_add_f16 v159, v159, 1.0 op_sel_hi:[1,0]
v_mfma_f32_16x16x32_bf16 v[172:175], v[180:183], v[60:63], v[172:175]
ds_read_b128 v[180:183], v251 offset:32768
v_rcp_f16_sdwa v155, v155 dst_sel:WORD_0 dst_unused:UNUSED_PRESERVE src0_sel:WORD_0
v_mfma_f32_16x16x32_f16 v[88:91], v[188:191], v[212:215], v[88:91]
v_rcp_f16_sdwa v157, v157 dst_sel:WORD_0 dst_unused:UNUSED_PRESERVE src0_sel:WORD_0
s_waitcnt lgkmcnt(6)
v_mfma_f32_16x16x32_bf16 v[164:167], v[120:123], v[64:67], v[164:167]
v_rcp_f16_sdwa v159, v159 dst_sel:WORD_0 dst_unused:UNUSED_PRESERVE src0_sel:WORD_0
v_mfma_f32_16x16x32_f16 v[240:243], v[188:191], v[208:211], v[240:243]
ds_read_b128 v[188:191], v251 offset:35840
s_setprio 3
v_mfma_f32_16x16x32_bf16 v[172:175], v[120:123], v[68:71], v[172:175]
ds_read_b128 v[120:123], v249 offset:34816
v_rcp_f16_sdwa v155, v155 dst_sel:WORD_1 dst_unused:UNUSED_PRESERVE src0_sel:WORD_1
s_waitcnt lgkmcnt(6)
v_mfma_f32_16x16x32_f16 v[92:95], v[124:127], v[212:215], v[92:95]
buffer_store_dwordx4 v[16:19], v253, s[8:11], s71 offen offset:256 sc1
buffer_store_dwordx4 v[20:23], v253, s[8:11], s71 offen offset:320 sc1
v_rcp_f16_sdwa v157, v157 dst_sel:WORD_1 dst_unused:UNUSED_PRESERVE src0_sel:WORD_1
s_waitcnt lgkmcnt(4)
v_mfma_f32_16x16x32_bf16 v[0:3], v[176:179], v[48:51], 0
v_rcp_f16_sdwa v159, v159 dst_sel:WORD_1 dst_unused:UNUSED_PRESERVE src0_sel:WORD_1
v_mfma_f32_16x16x32_f16 v[244:247], v[124:127], v[208:211], v[244:247]
ds_read_b128 v[124:127], v251 offset:33792
v_or_b32_e64 v104, v144, v145
v_pk_mul_f16 v109, v154, v155
v_mfma_f32_16x16x32_bf16 v[8:11], v[176:179], v[52:55], 0
ds_read_b128 v[176:179], v249 offset:30976
v_pk_mul_f16 v110, v156, v157
s_waitcnt lgkmcnt(4)
v_mfma_f32_16x16x32_f16 v[72:75], v[180:183], v[196:199], v[72:75]
v_pk_mul_f16 v111, v158, v159
v_cvt_pkrtz_f16_f32 v161, v160, v161
v_and_b32 v161, s49, v161
v_bfe_u32 v160, v161, 2, 14
v_lshrrev_b32_e64 v161, 18, v161
ds_read_u16 v160, v160
ds_read_u16_d16_hi v161, v161
v_cvt_pk_f16_f32 v170, v170, v171
v_or_b32_e64 v105, v146, v147
v_mfma_f32_16x16x32_f16 v[128:131], v[180:183], v[192:195], v[128:131]
ds_read_b128 v[180:183], v251 offset:36864
v_cvt_pk_f16_f32 v172, v172, v173
v_mfma_f32_16x16x32_bf16 v[0:3], v[184:187], v[56:59], v[0:3]
v_cvt_pk_f16_f32 v174, v174, v175
v_pk_fma_f16 v171, v170, v170, s48
buffer_load_dwordx4 v[200:203], v253, s[4:7], s70 offen offset:128
buffer_load_dwordx4 v[204:207], v253, s[4:7], s70 offen offset:192
s_waitcnt lgkmcnt(5)
v_mfma_f32_16x16x32_f16 v[76:79], v[188:191], v[196:199], v[76:79]
v_pk_fma_f16 v173, v172, v172, s48
v_mfma_f32_16x16x32_bf16 v[8:11], v[184:187], v[60:63], v[8:11]
ds_read_b128 v[184:187], v251 offset:34816
v_cvt_pkrtz_f16_f32 v163, v162, v163
v_and_b32 v163, s49, v163
v_bfe_u32 v162, v163, 2, 14
v_lshrrev_b32_e64 v163, 18, v163
ds_read_u16 v162, v162
ds_read_u16_d16_hi v163, v163
v_or_b32_e64 v106, v148, v149
v_pk_fma_f16 v175, v174, v174, s48
v_pk_mul_f16 v171, v170, v171
v_mfma_f32_16x16x32_f16 v[132:135], v[188:191], v[192:195], v[132:135]
ds_read_b128 v[188:191], v249 offset:33024
v_pk_mul_f16 v173, v172, v173
v_mfma_f32_16x16x32_bf16 v[0:3], v[120:123], v[64:67], v[0:3]
v_pk_mul_f16 v175, v174, v175
v_cvt_pkrtz_f16_f32 v165, v164, v165
v_and_b32_e64 v165, s49, v165
v_bfe_u32 v164, v165, 2, 14
v_lshrrev_b32 v165, 18, v165
ds_read_u16 v164, v164
ds_read_u16_d16_hi v165, v165
s_waitcnt lgkmcnt(7)
v_mfma_f32_16x16x32_f16 v[80:83], v[124:127], v[196:199], v[80:83]
v_or_b32 v107, v150, v151
v_exp_f16_sdwa v171, v171 dst_sel:WORD_0 dst_unused:UNUSED_PRESERVE src0_sel:WORD_0
s_setprio 2
v_mfma_f32_16x16x32_bf16 v[8:11], v[120:123], v[68:71], v[8:11]
ds_read_b128 v[120:123], v251 offset:37888
v_exp_f16_sdwa v173, v173 dst_sel:WORD_0 dst_unused:UNUSED_PRESERVE src0_sel:WORD_0
v_mfma_f32_16x16x32_f16 v[136:139], v[124:127], v[192:195], v[136:139]
ds_read_b128 v[124:127], v249 offset:35072
v_cvt_pkrtz_f16_f32 v167, v166, v167
v_and_b32_e64 v167, s49, v167
v_bfe_u32 v166, v167, 2, 14
v_lshrrev_b32_e64 v167, 18, v167
ds_read_u16 v166, v166
ds_read_u16_d16_hi v167, v167
v_exp_f16_sdwa v175, v175 dst_sel:WORD_0 dst_unused:UNUSED_PRESERVE src0_sel:WORD_0
v_or_b32 v108, v152, v153
v_mfma_f32_16x16x32_bf16 v[4:7], v[176:179], v[48:51], 0
v_exp_f16_sdwa v171, v171 dst_sel:WORD_1 dst_unused:UNUSED_PRESERVE src0_sel:WORD_1
s_waitcnt lgkmcnt(6)
v_mfma_f32_16x16x32_f16 v[84:87], v[180:183], v[196:199], v[84:87]
v_exp_f16_sdwa v173, v173 dst_sel:WORD_1 dst_unused:UNUSED_PRESERVE src0_sel:WORD_1
v_mfma_f32_16x16x32_bf16 v[12:15], v[176:179], v[52:55], 0
ds_read_b128 v[176:179], v251 offset:38912
v_cvt_pkrtz_f16_f32 v169, v168, v169
v_and_b32_e64 v169, s49, v169
v_bfe_u32 v168, v169, 2, 14
v_lshrrev_b32_e64 v169, 18, v169
ds_read_u16 v168, v168
ds_read_u16_d16_hi v169, v169
v_mfma_f32_16x16x32_f16 v[140:143], v[180:183], v[192:195], v[140:143]
ds_read_b128 v[180:183], v248
v_exp_f16_sdwa v175, v175 dst_sel:WORD_1 dst_unused:UNUSED_PRESERVE src0_sel:WORD_1
v_mfma_f32_16x16x32_f16 v[88:91], v[184:187], v[196:199], v[88:91]
v_pk_add_f16 v171, v171, 1.0 op_sel_hi:[1,0]
v_mfma_f32_16x16x32_bf16 v[4:7], v[188:191], v[56:59], v[4:7]
v_pk_add_f16 v173, v173, 1.0 op_sel_hi:[1,0]
v_mfma_f32_16x16x32_f16 v[240:243], v[184:187], v[192:195], v[240:243]
ds_read_b128 v[184:187], v251 offset:41984
v_pk_add_f16 v175, v175, 1.0 op_sel_hi:[1,0]
v_mfma_f32_16x16x32_bf16 v[12:15], v[188:191], v[60:63], v[12:15]
ds_read_b128 v[188:191], v248 offset:2048
v_rcp_f16_sdwa v171, v171 dst_sel:WORD_0 dst_unused:UNUSED_PRESERVE src0_sel:WORD_0
s_waitcnt lgkmcnt(7)
v_mfma_f32_16x16x32_f16 v[92:95], v[120:123], v[196:199], v[92:95]
v_rcp_f16_sdwa v173, v173 dst_sel:WORD_0 dst_unused:UNUSED_PRESERVE src0_sel:WORD_0
v_mfma_f32_16x16x32_bf16 v[4:7], v[124:127], v[64:67], v[4:7]
v_rcp_f16_sdwa v175, v175 dst_sel:WORD_0 dst_unused:UNUSED_PRESERVE src0_sel:WORD_0
v_mfma_f32_16x16x32_f16 v[244:247], v[120:123], v[192:195], v[244:247]
ds_read_b128 v[120:123], v251 offset:39936
s_setprio 1
v_mfma_f32_16x16x32_bf16 v[12:15], v[124:127], v[68:71], v[12:15]
ds_read_b128 v[124:127], v248 offset:4096
v_rcp_f16_sdwa v171, v171 dst_sel:WORD_1 dst_unused:UNUSED_PRESERVE src0_sel:WORD_1
s_waitcnt lgkmcnt(6)
v_mfma_f32_16x16x32_f16 v[72:75], v[176:179], v[220:223], v[72:75]
v_rcp_f16_sdwa v173, v173 dst_sel:WORD_1 dst_unused:UNUSED_PRESERVE src0_sel:WORD_1
s_waitcnt lgkmcnt(4)
v_mfma_f32_16x16x32_bf16 v[144:147], v[180:183], v[24:27], 0
v_rcp_f16_sdwa v175, v175 dst_sel:WORD_1 dst_unused:UNUSED_PRESERVE src0_sel:WORD_1
v_mfma_f32_16x16x32_f16 v[128:131], v[176:179], v[216:219], v[128:131]
ds_read_b128 v[176:179], v251 offset:43008
v_or_b32_e64 v208, v160, v161
v_pk_mul_f16 v213, v170, v171
v_mfma_f32_16x16x32_bf16 v[152:155], v[180:183], v[28:31], 0
ds_read_b128 v[180:183], v248 offset:256
v_pk_mul_f16 v214, v172, v173
s_waitcnt lgkmcnt(4)
v_mfma_f32_16x16x32_f16 v[76:79], v[184:187], v[220:223], v[76:79]
v_pk_mul_f16 v215, v174, v175
v_cvt_pkrtz_f16_f32 v1, v0, v1
v_and_b32 v1, s49, v1
v_bfe_u32 v0, v1, 2, 14
v_lshrrev_b32_e64 v1, 18, v1
ds_read_u16 v0, v0
ds_read_u16_d16_hi v1, v1
v_cvt_pk_f16_f32 v10, v10, v11
v_or_b32_e64 v209, v162, v163
v_mfma_f32_16x16x32_f16 v[132:135], v[184:187], v[216:219], v[132:135]
ds_read_b128 v[184:187], v251 offset:40960
v_cvt_pk_f16_f32 v12, v12, v13
v_mfma_f32_16x16x32_bf16 v[144:147], v[188:191], v[32:35], v[144:147]
v_cvt_pk_f16_f32 v14, v14, v15
v_pk_fma_f16 v11, v10, v10, s48
s_waitcnt lgkmcnt(5)
v_mfma_f32_16x16x32_f16 v[80:83], v[120:123], v[220:223], v[80:83]
v_pk_fma_f16 v13, v12, v12, s48
v_mfma_f32_16x16x32_bf16 v[152:155], v[188:191], v[36:39], v[152:155]
ds_read_b128 v[188:191], v251 offset:44032
v_cvt_pkrtz_f16_f32 v3, v2, v3
v_and_b32 v3, s49, v3
v_bfe_u32 v2, v3, 2, 14
v_lshrrev_b32_e64 v3, 18, v3
ds_read_u16 v2, v2
ds_read_u16_d16_hi v3, v3
v_or_b32_e64 v210, v164, v165
v_pk_fma_f16 v15, v14, v14, s48
v_pk_mul_f16 v11, v10, v11
v_mfma_f32_16x16x32_f16 v[136:139], v[120:123], v[216:219], v[136:139]
ds_read_b128 v[120:123], v248 offset:2304
v_pk_mul_f16 v13, v12, v13
v_mfma_f32_16x16x32_bf16 v[144:147], v[124:127], v[40:43], v[144:147]
v_pk_mul_f16 v15, v14, v15
v_cvt_pkrtz_f16_f32 v5, v4, v5
v_and_b32_e64 v5, s49, v5
v_bfe_u32 v4, v5, 2, 14
v_lshrrev_b32_e64 v5, 18, v5
ds_read_u16 v4, v4
ds_read_u16_d16_hi v5, v5
s_waitcnt lgkmcnt(7)
v_mfma_f32_16x16x32_f16 v[84:87], v[176:179], v[220:223], v[84:87]
s_setprio 0
v_or_b32_e64 v211, v166, v167
v_exp_f16_sdwa v11, v11 dst_sel:WORD_0 dst_unused:UNUSED_PRESERVE src0_sel:WORD_0
v_mfma_f32_16x16x32_bf16 v[152:155], v[124:127], v[44:47], v[152:155]
ds_read_b128 v[124:127], v251 offset:45056
v_exp_f16_sdwa v13, v13 dst_sel:WORD_0 dst_unused:UNUSED_PRESERVE src0_sel:WORD_0
v_mfma_f32_16x16x32_f16 v[140:143], v[176:179], v[216:219], v[140:143]
ds_read_b128 v[176:179], v248 offset:4352
v_cvt_pkrtz_f16_f32 v7, v6, v7
v_and_b32_e64 v7, s49, v7
v_bfe_u32 v6, v7, 2, 14
v_lshrrev_b32_e64 v7, 18, v7
ds_read_u16 v6, v6
ds_read_u16_d16_hi v7, v7
v_exp_f16_sdwa v15, v15 dst_sel:WORD_0 dst_unused:UNUSED_PRESERVE src0_sel:WORD_0
v_or_b32 v212, v168, v169
v_mfma_f32_16x16x32_bf16 v[148:151], v[180:183], v[24:27], 0
buffer_load_dwordx4 v[48:51], v250, s[32:35], s80 offen
v_exp_f16_sdwa v11, v11 dst_sel:WORD_1 dst_unused:UNUSED_PRESERVE src0_sel:WORD_1
s_waitcnt lgkmcnt(6)
v_mfma_f32_16x16x32_f16 v[88:91], v[184:187], v[220:223], v[88:91]
v_exp_f16_sdwa v13, v13 dst_sel:WORD_1 dst_unused:UNUSED_PRESERVE src0_sel:WORD_1
v_mfma_f32_16x16x32_bf16 v[156:159], v[180:183], v[28:31], 0
ds_read_b128 v[180:183], v251 offset:48128
v_cvt_pkrtz_f16_f32 v9, v8, v9
v_and_b32_e64 v9, s49, v9
v_bfe_u32 v8, v9, 2, 14
v_lshrrev_b32_e64 v9, 18, v9
ds_read_u16 v8, v8
ds_read_u16_d16_hi v9, v9
v_mfma_f32_16x16x32_f16 v[240:243], v[184:187], v[216:219], v[240:243]
ds_read_b128 v[184:187], v248 offset:6144
v_exp_f16_sdwa v15, v15 dst_sel:WORD_1 dst_unused:UNUSED_PRESERVE src0_sel:WORD_1
v_mfma_f32_16x16x32_f16 v[92:95], v[188:191], v[220:223], v[92:95]
v_pk_add_f16 v11, v11, 1.0 op_sel_hi:[1,0]
v_mfma_f32_16x16x32_bf16 v[148:151], v[120:123], v[32:35], v[148:151]
v_pk_add_f16 v13, v13, 1.0 op_sel_hi:[1,0]
v_mfma_f32_16x16x32_f16 v[244:247], v[188:191], v[216:219], v[244:247]
ds_read_b128 v[188:191], v251 offset:46080
v_pk_add_f16 v15, v15, 1.0 op_sel_hi:[1,0]
v_mfma_f32_16x16x32_bf16 v[156:159], v[120:123], v[36:39], v[156:159]
ds_read_b128 v[120:123], v248 offset:8192
v_rcp_f16_sdwa v11, v11 dst_sel:WORD_0 dst_unused:UNUSED_PRESERVE src0_sel:WORD_0
buffer_load_dwordx4 v[192:195], v253, s[4:7], s70 offen offset:256
buffer_load_dwordx4 v[196:199], v253, s[4:7], s70 offen offset:320
s_waitcnt lgkmcnt(7)
v_mfma_f32_16x16x32_f16 v[72:75], v[124:127], v[116:119], v[72:75]
v_rcp_f16_sdwa v13, v13 dst_sel:WORD_0 dst_unused:UNUSED_PRESERVE src0_sel:WORD_0
v_mfma_f32_16x16x32_bf16 v[148:151], v[176:179], v[40:43], v[148:151]
v_rcp_f16_sdwa v15, v15 dst_sel:WORD_0 dst_unused:UNUSED_PRESERVE src0_sel:WORD_0
s_setprio 3
v_mfma_f32_16x16x32_f16 v[128:131], v[124:127], v[112:115], v[128:131]
ds_read_b128 v[124:127], v251 offset:49152
v_rcp_f16_sdwa v11, v11 dst_sel:WORD_1 dst_unused:UNUSED_PRESERVE src0_sel:WORD_1
v_mfma_f32_16x16x32_bf16 v[156:159], v[176:179], v[44:47], v[156:159]
ds_read_b128 v[176:179], v248 offset:10240
v_rcp_f16_sdwa v13, v13 dst_sel:WORD_1 dst_unused:UNUSED_PRESERVE src0_sel:WORD_1
s_waitcnt lgkmcnt(6)
v_mfma_f32_16x16x32_f16 v[76:79], v[180:183], v[116:119], v[76:79]
v_rcp_f16_sdwa v15, v15 dst_sel:WORD_1 dst_unused:UNUSED_PRESERVE src0_sel:WORD_1
s_waitcnt lgkmcnt(4)
v_mfma_f32_16x16x32_bf16 v[160:163], v[184:187], v[24:27], 0
v_or_b32_e64 v216, v0, v1
v_mfma_f32_16x16x32_f16 v[132:135], v[180:183], v[112:115], v[132:135]
ds_read_b128 v[180:183], v251 offset:47104
v_pk_mul_f16 v221, v10, v11
v_mfma_f32_16x16x32_bf16 v[168:171], v[184:187], v[28:31], 0
ds_read_b128 v[184:187], v248 offset:6400
v_pk_mul_f16 v222, v12, v13
s_waitcnt lgkmcnt(4)
v_mfma_f32_16x16x32_f16 v[80:83], v[188:191], v[116:119], v[80:83]
v_pk_mul_f16 v223, v14, v15
v_cvt_pkrtz_f16_f32 v145, v144, v145
v_and_b32 v145, s49, v145
v_bfe_u32 v144, v145, 2, 14
v_lshrrev_b32_e64 v145, 18, v145
ds_read_u16 v144, v144
ds_read_u16_d16_hi v145, v145
v_cvt_pk_f16_f32 v154, v154, v155
v_or_b32_e64 v217, v2, v3
v_mfma_f32_16x16x32_f16 v[136:139], v[188:191], v[112:115], v[136:139]
ds_read_b128 v[188:191], v251 offset:50176
v_cvt_pk_f16_f32 v156, v156, v157
v_mfma_f32_16x16x32_bf16 v[160:163], v[120:123], v[32:35], v[160:163]
s_add_u32 s46, s80, 2097152
buffer_load_dwordx4 v[52:55], v250, s[32:35], s46 offen
v_cvt_pk_f16_f32 v158, v158, v159
v_pk_fma_f16 v155, v154, v154, s48
s_waitcnt lgkmcnt(5)
v_mfma_f32_16x16x32_f16 v[84:87], v[124:127], v[116:119], v[84:87]
v_pk_fma_f16 v157, v156, v156, s48
v_mfma_f32_16x16x32_bf16 v[168:171], v[120:123], v[36:39], v[168:171]
ds_read_b128 v[120:123], v251 offset:51200
v_cvt_pkrtz_f16_f32 v147, v146, v147
v_and_b32 v147, s49, v147
v_bfe_u32 v146, v147, 2, 14
v_lshrrev_b32_e64 v147, 18, v147
ds_read_u16 v146, v146
ds_read_u16_d16_hi v147, v147
v_or_b32_e64 v218, v4, v5
v_pk_fma_f16 v159, v158, v158, s48
v_mfma_f32_16x16x32_f16 v[140:143], v[124:127], v[112:115], v[140:143]
ds_read_b128 v[124:127], v248 offset:8448
v_pk_mul_f16 v155, v154, v155
v_pk_mul_f16 v157, v156, v157
v_mfma_f32_16x16x32_bf16 v[160:163], v[176:179], v[40:43], v[160:163]
v_pk_mul_f16 v159, v158, v159
s_setprio 2
v_cvt_pkrtz_f16_f32 v149, v148, v149
v_and_b32 v149, s49, v149
v_bfe_u32 v148, v149, 2, 14
v_lshrrev_b32_e64 v149, 18, v149
ds_read_u16 v148, v148
ds_read_u16_d16_hi v149, v149
s_waitcnt lgkmcnt(7)
v_mfma_f32_16x16x32_f16 v[88:91], v[180:183], v[116:119], v[88:91]
v_or_b32 v219, v6, v7
v_exp_f16_sdwa v155, v155 dst_sel:WORD_0 dst_unused:UNUSED_PRESERVE src0_sel:WORD_0
v_mfma_f32_16x16x32_bf16 v[168:171], v[176:179], v[44:47], v[168:171]
ds_read_b128 v[176:179], v251 offset:54272
v_exp_f16_sdwa v157, v157 dst_sel:WORD_0 dst_unused:UNUSED_PRESERVE src0_sel:WORD_0
v_mfma_f32_16x16x32_f16 v[240:243], v[180:183], v[112:115], v[240:243]
ds_read_b128 v[180:183], v248 offset:10496
v_cvt_pkrtz_f16_f32 v151, v150, v151
v_and_b32_e64 v151, s49, v151
v_bfe_u32 v150, v151, 2, 14
v_lshrrev_b32_e64 v151, 18, v151
ds_read_u16 v150, v150
ds_read_u16_d16_hi v151, v151
v_exp_f16_sdwa v159, v159 dst_sel:WORD_0 dst_unused:UNUSED_PRESERVE src0_sel:WORD_0
v_or_b32 v220, v8, v9
v_mfma_f32_16x16x32_bf16 v[164:167], v[184:187], v[24:27], 0
v_exp_f16_sdwa v155, v155 dst_sel:WORD_1 dst_unused:UNUSED_PRESERVE src0_sel:WORD_1
s_waitcnt lgkmcnt(6)
v_mfma_f32_16x16x32_f16 v[92:95], v[188:191], v[116:119], v[92:95]
v_exp_f16_sdwa v157, v157 dst_sel:WORD_1 dst_unused:UNUSED_PRESERVE src0_sel:WORD_1
v_mfma_f32_16x16x32_bf16 v[172:175], v[184:187], v[28:31], 0
ds_read_b128 v[184:187], v251 offset:52224
v_cvt_pkrtz_f16_f32 v153, v152, v153
v_mfma_f32_16x16x32_f16 v[244:247], v[188:191], v[112:115], v[244:247]
ds_read_b128 v[188:191], v248 offset:12288
v_and_b32_e64 v153, s49, v153
v_bfe_u32 v152, v153, 2, 14
v_lshrrev_b32_e64 v153, 18, v153
ds_read_u16 v152, v152
ds_read_u16_d16_hi v153, v153
v_exp_f16_sdwa v159, v159 dst_sel:WORD_1 dst_unused:UNUSED_PRESERVE src0_sel:WORD_1
v_mfma_f32_16x16x32_f16 v[72:75], v[120:123], v[228:231], v[72:75]
v_pk_add_f16 v155, v155, 1.0 op_sel_hi:[1,0]
v_mfma_f32_16x16x32_bf16 v[164:167], v[124:127], v[32:35], v[164:167]
v_pk_add_f16 v157, v157, 1.0 op_sel_hi:[1,0]
v_mfma_f32_16x16x32_f16 v[128:131], v[120:123], v[224:227], v[128:131]
ds_read_b128 v[120:123], v251 offset:55296
v_pk_add_f16 v159, v159, 1.0 op_sel_hi:[1,0]
v_mfma_f32_16x16x32_bf16 v[172:175], v[124:127], v[36:39], v[172:175]
ds_read_b128 v[124:127], v248 offset:14336
v_rcp_f16_sdwa v155, v155 dst_sel:WORD_0 dst_unused:UNUSED_PRESERVE src0_sel:WORD_0
s_waitcnt lgkmcnt(7)
v_mfma_f32_16x16x32_f16 v[76:79], v[176:179], v[228:231], v[76:79]
v_rcp_f16_sdwa v157, v157 dst_sel:WORD_0 dst_unused:UNUSED_PRESERVE src0_sel:WORD_0
v_mfma_f32_16x16x32_bf16 v[164:167], v[180:183], v[40:43], v[164:167]
s_setprio 1
v_rcp_f16_sdwa v159, v159 dst_sel:WORD_0 dst_unused:UNUSED_PRESERVE src0_sel:WORD_0
v_mfma_f32_16x16x32_f16 v[132:135], v[176:179], v[224:227], v[132:135]
ds_read_b128 v[176:179], v251 offset:53248
s_add_u32 s46, s80, 4194304
buffer_load_dwordx4 v[56:59], v250, s[32:35], s46 offen
v_mfma_f32_16x16x32_bf16 v[172:175], v[180:183], v[44:47], v[172:175]
ds_read_b128 v[180:183], v248 offset:16384
v_rcp_f16_sdwa v155, v155 dst_sel:WORD_1 dst_unused:UNUSED_PRESERVE src0_sel:WORD_1
s_waitcnt lgkmcnt(6)
v_mfma_f32_16x16x32_f16 v[80:83], v[184:187], v[228:231], v[80:83]
v_rcp_f16_sdwa v157, v157 dst_sel:WORD_1 dst_unused:UNUSED_PRESERVE src0_sel:WORD_1
v_mfma_f32_16x16x32_bf16 v[0:3], v[188:191], v[24:27], 0
v_rcp_f16_sdwa v159, v159 dst_sel:WORD_1 dst_unused:UNUSED_PRESERVE src0_sel:WORD_1
v_mfma_f32_16x16x32_f16 v[136:139], v[184:187], v[224:227], v[136:139]
ds_read_b128 v[184:187], v251 offset:56320
v_or_b32 v112, v144, v145
v_pk_mul_f16 v117, v154, v155
v_mfma_f32_16x16x32_bf16 v[8:11], v[188:191], v[28:31], 0
ds_read_b128 v[188:191], v248 offset:12544
v_pk_mul_f16 v118, v156, v157
s_waitcnt lgkmcnt(4)
v_mfma_f32_16x16x32_f16 v[84:87], v[120:123], v[228:231], v[84:87]
v_pk_mul_f16 v119, v158, v159
v_cvt_pkrtz_f16_f32 v161, v160, v161
v_and_b32 v161, s49, v161
v_bfe_u32 v160, v161, 2, 14
v_lshrrev_b32_e64 v161, 18, v161
ds_read_u16 v160, v160
ds_read_u16_d16_hi v161, v161
v_cvt_pk_f16_f32 v170, v170, v171
v_mfma_f32_16x16x32_f16 v[140:143], v[120:123], v[224:227], v[140:143]
ds_read_b128 v[120:123], v251 offset:57344
v_or_b32 v113, v146, v147
v_mfma_f32_16x16x32_bf16 v[0:3], v[124:127], v[32:35], v[0:3]
v_cvt_pk_f16_f32 v172, v172, v173
v_cvt_pk_f16_f32 v174, v174, v175
v_pk_fma_f16 v171, v170, v170, s48
s_waitcnt lgkmcnt(5)
v_mfma_f32_16x16x32_f16 v[88:91], v[176:179], v[228:231], v[88:91]
v_pk_fma_f16 v173, v172, v172, s48
v_mfma_f32_16x16x32_bf16 v[8:11], v[124:127], v[36:39], v[8:11]
ds_read_b128 v[124:127], v251 offset:60416
v_cvt_pkrtz_f16_f32 v163, v162, v163
v_and_b32_e64 v163, s49, v163
v_bfe_u32 v162, v163, 2, 14
v_lshrrev_b32_e64 v163, 18, v163
ds_read_u16 v162, v162
ds_read_u16_d16_hi v163, v163
v_or_b32_e64 v114, v148, v149
v_pk_fma_f16 v175, v174, v174, s48
v_mfma_f32_16x16x32_f16 v[240:243], v[176:179], v[224:227], v[240:243]
ds_read_b128 v[176:179], v248 offset:14592
v_pk_mul_f16 v171, v170, v171
v_pk_mul_f16 v173, v172, v173
v_mfma_f32_16x16x32_bf16 v[0:3], v[180:183], v[40:43], v[0:3]
v_pk_mul_f16 v175, v174, v175
s_setprio 0
v_cvt_pkrtz_f16_f32 v165, v164, v165
v_and_b32 v165, s49, v165
v_bfe_u32 v164, v165, 2, 14
v_lshrrev_b32_e64 v165, 18, v165
ds_read_u16 v164, v164
ds_read_u16_d16_hi v165, v165
s_waitcnt lgkmcnt(7)
v_mfma_f32_16x16x32_f16 v[92:95], v[184:187], v[228:231], v[92:95]
v_or_b32 v115, v150, v151
v_exp_f16_sdwa v171, v171 dst_sel:WORD_0 dst_unused:UNUSED_PRESERVE src0_sel:WORD_0
v_mfma_f32_16x16x32_bf16 v[8:11], v[180:183], v[44:47], v[8:11]
ds_read_b128 v[180:183], v251 offset:58368
v_exp_f16_sdwa v173, v173 dst_sel:WORD_0 dst_unused:UNUSED_PRESERVE src0_sel:WORD_0
v_mfma_f32_16x16x32_f16 v[244:247], v[184:187], v[224:227], v[244:247]
ds_read_b128 v[184:187], v248 offset:16640
v_cvt_pkrtz_f16_f32 v167, v166, v167
v_and_b32_e64 v167, s49, v167
v_bfe_u32 v166, v167, 2, 14
v_lshrrev_b32_e64 v167, 18, v167
ds_read_u16 v166, v166
ds_read_u16_d16_hi v167, v167
v_exp_f16_sdwa v175, v175 dst_sel:WORD_0 dst_unused:UNUSED_PRESERVE src0_sel:WORD_0
v_or_b32 v116, v152, v153
v_mfma_f32_16x16x32_bf16 v[4:7], v[188:191], v[24:27], 0
v_exp_f16_sdwa v171, v171 dst_sel:WORD_1 dst_unused:UNUSED_PRESERVE src0_sel:WORD_1
s_waitcnt lgkmcnt(6)
v_mfma_f32_16x16x32_f16 v[72:75], v[120:123], v[100:103], v[72:75]
v_exp_f16_sdwa v173, v173 dst_sel:WORD_1 dst_unused:UNUSED_PRESERVE src0_sel:WORD_1
v_mfma_f32_16x16x32_bf16 v[12:15], v[188:191], v[28:31], 0
ds_read_b128 v[188:191], v251 offset:61440
v_cvt_pkrtz_f16_f32 v169, v168, v169
v_mfma_f32_16x16x32_f16 v[128:131], v[120:123], v[96:99], v[128:131]
ds_read_b128 v[120:123], v248 offset:18432
v_and_b32_e64 v169, s49, v169
v_bfe_u32 v168, v169, 2, 14
v_lshrrev_b32_e64 v169, 18, v169
ds_read_u16 v168, v168
ds_read_u16_d16_hi v169, v169
s_add_u32 s46, s80, 6291456
buffer_load_dwordx4 v[60:63], v250, s[32:35], s46 offen
v_exp_f16_sdwa v175, v175 dst_sel:WORD_1 dst_unused:UNUSED_PRESERVE src0_sel:WORD_1
v_mfma_f32_16x16x32_f16 v[76:79], v[124:127], v[100:103], v[76:79]
v_pk_add_f16 v171, v171, 1.0 op_sel_hi:[1,0]
v_mfma_f32_16x16x32_bf16 v[4:7], v[176:179], v[32:35], v[4:7]
v_pk_add_f16 v173, v173, 1.0 op_sel_hi:[1,0]
v_mfma_f32_16x16x32_f16 v[132:135], v[124:127], v[96:99], v[132:135]
ds_read_b128 v[124:127], v251 offset:59392
v_pk_add_f16 v175, v175, 1.0 op_sel_hi:[1,0]
v_mfma_f32_16x16x32_bf16 v[12:15], v[176:179], v[36:39], v[12:15]
ds_read_b128 v[176:179], v248 offset:20480
v_rcp_f16_sdwa v171, v171 dst_sel:WORD_0 dst_unused:UNUSED_PRESERVE src0_sel:WORD_0
s_waitcnt lgkmcnt(7)
v_mfma_f32_16x16x32_f16 v[80:83], v[180:183], v[100:103], v[80:83]
v_rcp_f16_sdwa v173, v173 dst_sel:WORD_0 dst_unused:UNUSED_PRESERVE src0_sel:WORD_0
v_mfma_f32_16x16x32_bf16 v[4:7], v[184:187], v[40:43], v[4:7]
s_setprio 3
v_rcp_f16_sdwa v175, v175 dst_sel:WORD_0 dst_unused:UNUSED_PRESERVE src0_sel:WORD_0
v_mfma_f32_16x16x32_f16 v[136:139], v[180:183], v[96:99], v[136:139]
ds_read_b128 v[180:183], v251 offset:62464
v_rcp_f16_sdwa v171, v171 dst_sel:WORD_1 dst_unused:UNUSED_PRESERVE src0_sel:WORD_1
v_mfma_f32_16x16x32_bf16 v[12:15], v[184:187], v[44:47], v[12:15]
ds_read_b128 v[184:187], v248 offset:22528
v_rcp_f16_sdwa v173, v173 dst_sel:WORD_1 dst_unused:UNUSED_PRESERVE src0_sel:WORD_1
s_waitcnt lgkmcnt(5)
v_mfma_f32_16x16x32_f16 v[84:87], v[188:191], v[100:103], v[84:87]
s_getpc_b64 s[74:75]
Lcq12:
s_lshl_b32 s43, s40, 10
s_add_u32 s43, s43, 6144
s_min_u32 s43, s43, Lend-Lcq12-1024
s_add_u32 s74, s74, s43
s_addc_u32 s75, s75, 0
s_sub_u32 s74, s74, 16384
s_subb_u32 s75, s75, 0
s_mov_b32 m0, 163840
s_nop 0
global_load_lds_dword v250, s[74:75]
v_rcp_f16_sdwa v175, v175 dst_sel:WORD_1 dst_unused:UNUSED_PRESERVE src0_sel:WORD_1
v_mfma_f32_16x16x32_bf16 v[144:147], v[120:123], v[24:27], 0
v_or_b32 v224, v160, v161
v_mfma_f32_16x16x32_f16 v[140:143], v[188:191], v[96:99], v[140:143]
ds_read_b128 v[188:191], v251 offset:63488
v_pk_mul_f16 v229, v170, v171
v_mfma_f32_16x16x32_bf16 v[152:155], v[120:123], v[28:31], 0
ds_read_b128 v[120:123], v248 offset:18688
v_pk_mul_f16 v230, v172, v173
s_waitcnt lgkmcnt(4)
v_mfma_f32_16x16x32_f16 v[88:91], v[124:127], v[100:103], v[88:91]
v_pk_mul_f16 v231, v174, v175
v_cvt_pkrtz_f16_f32 v1, v0, v1
v_and_b32 v1, s49, v1
v_bfe_u32 v0, v1, 2, 14
v_lshrrev_b32_e64 v1, 18, v1
ds_read_u16 v0, v0
ds_read_u16_d16_hi v1, v1
v_cvt_pk_f16_f32 v10, v10, v11
v_mfma_f32_16x16x32_f16 v[240:243], v[124:127], v[96:99], v[240:243]
ds_read_b128 v[124:127], v252 offset:1024
v_or_b32 v225, v162, v163
v_mfma_f32_16x16x32_bf16 v[144:147], v[176:179], v[32:35], v[144:147]
v_cvt_pk_f16_f32 v12, v12, v13
v_cvt_pk_f16_f32 v14, v14, v15
v_pk_fma_f16 v11, v10, v10, s48
s_waitcnt lgkmcnt(5)
v_mfma_f32_16x16x32_f16 v[92:95], v[180:183], v[100:103], v[92:95]
v_pk_fma_f16 v13, v12, v12, s48
v_mfma_f32_16x16x32_bf16 v[152:155], v[176:179], v[36:39], v[152:155]
ds_read_b128 v[176:179], v251 offset:64512
v_cvt_pkrtz_f16_f32 v3, v2, v3
v_and_b32_e64 v3, s49, v3
v_bfe_u32 v2, v3, 2, 14
v_lshrrev_b32_e64 v3, 18, v3
ds_read_u16 v2, v2
ds_read_u16_d16_hi v3, v3
v_or_b32_e64 v226, v164, v165
v_pk_fma_f16 v15, v14, v14, s48
v_mfma_f32_16x16x32_f16 v[244:247], v[180:183], v[96:99], v[244:247]
ds_read_b128 v[180:183], v248 offset:20736
s_add_u32 s46, s80, 8388608
buffer_load_dwordx4 v[64:67], v250, s[32:35], s46 offen
v_pk_mul_f16 v11, v10, v11
v_pk_mul_f16 v13, v12, v13
v_mfma_f32_16x16x32_bf16 v[144:147], v[184:187], v[40:43], v[144:147]
s_setprio 2
v_pk_mul_f16 v15, v14, v15
s_waitcnt lgkmcnt(6)
v_mfma_f32_16x16x32_f16 v[72:75], v[188:191], v[108:111], v[72:75]
v_cvt_pkrtz_f16_f32 v5, v4, v5
v_and_b32_e64 v5, s49, v5
v_bfe_u32 v4, v5, 2, 14
v_lshrrev_b32_e64 v5, 18, v5
ds_read_u16 v4, v4
ds_read_u16_d16_hi v5, v5
v_or_b32_e64 v227, v166, v167
v_exp_f16_sdwa v11, v11 dst_sel:WORD_0 dst_unused:UNUSED_PRESERVE src0_sel:WORD_0
v_mfma_f32_16x16x32_bf16 v[152:155], v[184:187], v[44:47], v[152:155]
ds_read_b128 v[184:187], v252 offset:2048
v_exp_f16_sdwa v13, v13 dst_sel:WORD_0 dst_unused:UNUSED_PRESERVE src0_sel:WORD_0
v_mfma_f32_16x16x32_f16 v[128:131], v[188:191], v[104:107], v[128:131]
ds_read_b128 v[188:191], v248 offset:22784
v_cvt_pkrtz_f16_f32 v7, v6, v7
v_and_b32_e64 v7, s49, v7
v_bfe_u32 v6, v7, 2, 14
v_lshrrev_b32_e64 v7, 18, v7
ds_read_u16 v6, v6
ds_read_u16_d16_hi v7, v7
v_exp_f16_sdwa v15, v15 dst_sel:WORD_0 dst_unused:UNUSED_PRESERVE src0_sel:WORD_0
v_or_b32 v228, v168, v169
v_mfma_f32_16x16x32_bf16 v[148:151], v[120:123], v[24:27], 0
v_exp_f16_sdwa v11, v11 dst_sel:WORD_1 dst_unused:UNUSED_PRESERVE src0_sel:WORD_1
s_waitcnt lgkmcnt(6)
v_mfma_f32_16x16x32_f16 v[76:79], v[124:127], v[108:111], v[76:79]
v_exp_f16_sdwa v13, v13 dst_sel:WORD_1 dst_unused:UNUSED_PRESERVE src0_sel:WORD_1
v_mfma_f32_16x16x32_bf16 v[156:159], v[120:123], v[28:31], 0
ds_read_b128 v[120:123], v252
v_cvt_pkrtz_f16_f32 v9, v8, v9
v_mfma_f32_16x16x32_f16 v[132:135], v[124:127], v[104:107], v[132:135]
ds_read_b128 v[124:127], v248 offset:24576
v_and_b32_e64 v9, s49, v9
v_bfe_u32 v8, v9, 2, 14
v_lshrrev_b32_e64 v9, 18, v9
ds_read_u16 v8, v8
ds_read_u16_d16_hi v9, v9
v_exp_f16_sdwa v15, v15 dst_sel:WORD_1 dst_unused:UNUSED_PRESERVE src0_sel:WORD_1
v_mfma_f32_16x16x32_f16 v[80:83], v[176:179], v[108:111], v[80:83]
v_pk_add_f16 v11, v11, 1.0 op_sel_hi:[1,0]
v_mfma_f32_16x16x32_bf16 v[148:151], v[180:183], v[32:35], v[148:151]
v_mov_b32 v16, 0
v_mov_b32 v17, 0
v_cndmask_b32 v18, 0, v255, s[88:89]
v_cndmask_b32 v19, 0, v255, s[90:91]
v_mov_b32 v20, 0
v_mov_b32 v21, 0
v_pk_add_f16 v13, v13, 1.0 op_sel_hi:[1,0]
v_mfma_f32_16x16x32_f16 v[136:139], v[176:179], v[104:107], v[136:139]
ds_read_b128 v[176:179], v252 offset:3072
v_pk_add_f16 v15, v15, 1.0 op_sel_hi:[1,0]
v_mfma_f32_16x16x32_bf16 v[156:159], v[180:183], v[36:39], v[156:159]
ds_read_b128 v[180:183], v248 offset:26624
v_rcp_f16_sdwa v11, v11 dst_sel:WORD_0 dst_unused:UNUSED_PRESERVE src0_sel:WORD_0
s_waitcnt lgkmcnt(6)
v_mfma_f32_16x16x32_f16 v[84:87], v[184:187], v[108:111], v[84:87]
v_rcp_f16_sdwa v13, v13 dst_sel:WORD_0 dst_unused:UNUSED_PRESERVE src0_sel:WORD_0
v_mfma_f32_16x16x32_bf16 v[148:151], v[188:191], v[40:43], v[148:151]
s_setprio 1
v_rcp_f16_sdwa v15, v15 dst_sel:WORD_0 dst_unused:UNUSED_PRESERVE src0_sel:WORD_0
v_mfma_f32_16x16x32_f16 v[140:143], v[184:187], v[104:107], v[140:143]
ds_read_b128 v[184:187], v252 offset:4096
v_rcp_f16_sdwa v11, v11 dst_sel:WORD_1 dst_unused:UNUSED_PRESERVE src0_sel:WORD_1
v_mfma_f32_16x16x32_bf16 v[156:159], v[188:191], v[44:47], v[156:159]
ds_read_b128 v[188:191], v248 offset:28672
v_rcp_f16_sdwa v13, v13 dst_sel:WORD_1 dst_unused:UNUSED_PRESERVE src0_sel:WORD_1
s_waitcnt lgkmcnt(5)
v_mfma_f32_16x16x32_f16 v[88:91], v[120:123], v[108:111], v[88:91]
s_add_u32 s46, s80, 10485760
buffer_load_dwordx4 v[68:71], v250, s[32:35], s46 offen
v_rcp_f16_sdwa v15, v15 dst_sel:WORD_1 dst_unused:UNUSED_PRESERVE src0_sel:WORD_1
v_mfma_f32_16x16x32_bf16 v[160:163], v[124:127], v[24:27], 0
v_or_b32_e64 v96, v0, v1
v_mfma_f32_16x16x32_f16 v[240:243], v[120:123], v[104:107], v[240:243]
ds_read_b128 v[120:123], v252 offset:7168
v_pk_mul_f16 v101, v10, v11
s_waitcnt lgkmcnt(3)
v_mfma_f32_16x16x32_f16 v[92:95], v[176:179], v[108:111], v[92:95]
v_pk_mul_f16 v102, v12, v13
v_mfma_f32_16x16x32_bf16 v[168:171], v[124:127], v[28:31], 0
ds_read_b128 v[124:127], v248 offset:24832
v_pk_mul_f16 v103, v14, v15
v_cvt_pkrtz_f16_f32 v145, v144, v145
v_and_b32_e64 v145, s49, v145
v_bfe_u32 v144, v145, 2, 14
v_lshrrev_b32_e64 v145, 18, v145
ds_read_u16 v144, v144
ds_read_u16_d16_hi v145, v145
v_cvt_pk_f16_f32 v154, v154, v155
v_mfma_f32_16x16x32_f16 v[244:247], v[176:179], v[104:107], v[244:247]
ds_read_b128 v[176:179], v252 offset:5120
v_or_b32_e64 v97, v2, v3
v_mfma_f32_16x16x32_bf16 v[160:163], v[180:183], v[32:35], v[160:163]
v_cvt_pk_f16_f32 v156, v156, v157
v_cvt_pk_f16_f32 v158, v158, v159
s_waitcnt vmcnt(14)
v_mfma_f32_16x16x32_bf16 v[128:131], v[18:21], v[232:235], v[128:131]
v_pk_fma_f16 v155, v154, v154, s48
v_mfma_f32_16x16x32_bf16 v[132:135], v[16:19], v[232:235], v[132:135]
v_pk_fma_f16 v157, v156, v156, s48
s_waitcnt vmcnt(13)
v_mfma_f32_16x16x32_bf16 v[136:139], v[18:21], v[236:239], v[136:139]
v_cvt_pkrtz_f16_f32 v147, v146, v147
v_mfma_f32_16x16x32_bf16 v[140:143], v[16:19], v[236:239], v[140:143]
v_and_b32 v147, s49, v147
s_waitcnt lgkmcnt(3)
v_mfma_f32_16x16x32_f16 v[72:75], v[184:187], v[212:215], v[72:75]
v_bfe_u32 v146, v147, 2, 14
v_mfma_f32_16x16x32_bf16 v[168:171], v[180:183], v[36:39], v[168:171]
ds_read_b128 v[180:183], v252 offset:8192
v_lshrrev_b32_e64 v147, 18, v147
ds_read_u16 v146, v146
ds_read_u16_d16_hi v147, v147
v_or_b32_e64 v98, v4, v5
v_pk_fma_f16 v159, v158, v158, s48
v_mfma_f32_16x16x32_f16 v[128:131], v[184:187], v[208:211], v[128:131]
ds_read_b128 v[184:187], v248 offset:26880
v_pk_mul_f16 v155, v154, v155
v_pk_mul_f16 v157, v156, v157
v_mfma_f32_16x16x32_bf16 v[160:163], v[188:191], v[40:43], v[160:163]
s_setprio 0
v_pk_mul_f16 v159, v158, v159
v_mfma_f32_16x16x32_f16 v[76:79], v[120:123], v[212:215], v[76:79]
v_cvt_pkrtz_f16_f32 v149, v148, v149
v_and_b32 v149, s49, v149
v_bfe_u32 v148, v149, 2, 14
v_lshrrev_b32_e64 v149, 18, v149
ds_read_u16 v148, v148
ds_read_u16_d16_hi v149, v149
v_or_b32_e64 v99, v6, v7
v_exp_f16_sdwa v155, v155 dst_sel:WORD_0 dst_unused:UNUSED_PRESERVE src0_sel:WORD_0
v_mfma_f32_16x16x32_bf16 v[168:171], v[188:191], v[44:47], v[168:171]
ds_read_b128 v[188:191], v252 offset:6144
v_exp_f16_sdwa v157, v157 dst_sel:WORD_0 dst_unused:UNUSED_PRESERVE src0_sel:WORD_0
v_mfma_f32_16x16x32_f16 v[132:135], v[120:123], v[208:211], v[132:135]
ds_read_b128 v[120:123], v248 offset:28928
v_cvt_pkrtz_f16_f32 v151, v150, v151
v_and_b32_e64 v151, s49, v151
v_bfe_u32 v150, v151, 2, 14
v_lshrrev_b32_e64 v151, 18, v151
ds_read_u16 v150, v150
ds_read_u16_d16_hi v151, v151
v_exp_f16_sdwa v159, v159 dst_sel:WORD_0 dst_unused:UNUSED_PRESERVE src0_sel:WORD_0
v_or_b32 v100, v8, v9
v_mfma_f32_16x16x32_bf16 v[164:167], v[124:127], v[24:27], 0
v_exp_f16_sdwa v155, v155 dst_sel:WORD_1 dst_unused:UNUSED_PRESERVE src0_sel:WORD_1
s_waitcnt lgkmcnt(7)
v_mfma_f32_16x16x32_f16 v[80:83], v[176:179], v[212:215], v[80:83]
v_exp_f16_sdwa v157, v157 dst_sel:WORD_1 dst_unused:UNUSED_PRESERVE src0_sel:WORD_1
v_mfma_f32_16x16x32_f16 v[136:139], v[176:179], v[208:211], v[136:139]
ds_read_b128 v[176:179], v248 offset:30720
v_cvt_pkrtz_f16_f32 v153, v152, v153
v_mfma_f32_16x16x32_bf16 v[172:175], v[124:127], v[28:31], 0
ds_read_b128 v[124:127], v252 offset:9216
v_and_b32_e64 v153, s49, v153
v_bfe_u32 v152, v153, 2, 14
v_lshrrev_b32 v153, 18, v153
ds_read_u16 v152, v152
ds_read_u16_d16_hi v153, v153
v_exp_f16_sdwa v159, v159 dst_sel:WORD_1 dst_unused:UNUSED_PRESERVE src0_sel:WORD_1
v_mfma_f32_16x16x32_f16 v[84:87], v[180:183], v[212:215], v[84:87]
v_pk_add_f16 v155, v155, 1.0 op_sel_hi:[1,0]
s_waitcnt lgkmcnt(7)
v_mfma_f32_16x16x32_bf16 v[164:167], v[184:187], v[32:35], v[164:167]
v_pk_add_f16 v157, v157, 1.0 op_sel_hi:[1,0]
v_mfma_f32_16x16x32_f16 v[140:143], v[180:183], v[208:211], v[140:143]
ds_read_b128 v[180:183], v252 offset:10240
v_pk_add_f16 v159, v159, 1.0 op_sel_hi:[1,0]
v_mfma_f32_16x16x32_bf16 v[172:175], v[184:187], v[36:39], v[172:175]
ds_read_b128 v[184:187], v248 offset:32768
v_rcp_f16_sdwa v155, v155 dst_sel:WORD_0 dst_unused:UNUSED_PRESERVE src0_sel:WORD_0
v_mfma_f32_16x16x32_f16 v[88:91], v[188:191], v[212:215], v[88:91]
v_rcp_f16_sdwa v157, v157 dst_sel:WORD_0 dst_unused:UNUSED_PRESERVE src0_sel:WORD_0
s_setprio 3
s_waitcnt lgkmcnt(7)
v_mfma_f32_16x16x32_bf16 v[164:167], v[120:123], v[40:43], v[164:167]
v_rcp_f16_sdwa v159, v159 dst_sel:WORD_0 dst_unused:UNUSED_PRESERVE src0_sel:WORD_0
v_mfma_f32_16x16x32_f16 v[240:243], v[188:191], v[208:211], v[240:243]
ds_read_b128 v[188:191], v252 offset:13312
v_rcp_f16_sdwa v155, v155 dst_sel:WORD_1 dst_unused:UNUSED_PRESERVE src0_sel:WORD_1
v_mfma_f32_16x16x32_bf16 v[172:175], v[120:123], v[44:47], v[172:175]
ds_read_b128 v[120:123], v248 offset:34816
v_rcp_f16_sdwa v157, v157 dst_sel:WORD_1 dst_unused:UNUSED_PRESERVE src0_sel:WORD_1
s_waitcnt lgkmcnt(6)
v_mfma_f32_16x16x32_f16 v[92:95], v[124:127], v[212:215], v[92:95]
v_rcp_f16_sdwa v159, v159 dst_sel:WORD_1 dst_unused:UNUSED_PRESERVE src0_sel:WORD_1
v_mfma_f32_16x16x32_bf16 v[0:3], v[176:179], v[24:27], 0
v_or_b32 v104, v144, v145
v_mfma_f32_16x16x32_f16 v[244:247], v[124:127], v[208:211], v[244:247]
ds_read_b128 v[124:127], v252 offset:11264
v_pk_mul_f16 v109, v154, v155
s_waitcnt vmcnt(10)
v_mfma_f32_16x16x32_bf16 v[240:243], v[18:21], v[200:203], v[240:243]
v_pk_mul_f16 v110, v156, v157
v_mfma_f32_16x16x32_bf16 v[244:247], v[16:19], v[200:203], v[244:247]
v_pk_mul_f16 v111, v158, v159
s_waitcnt vmcnt(9)
v_mfma_f32_16x16x32_bf16 v[72:75], v[18:21], v[204:207], v[72:75]
v_cvt_pkrtz_f16_f32 v161, v160, v161
v_mfma_f32_16x16x32_bf16 v[76:79], v[16:19], v[204:207], v[76:79]
v_and_b32 v161, s49, v161
s_waitcnt lgkmcnt(2)
v_mfma_f32_16x16x32_f16 v[72:75], v[180:183], v[220:223], v[72:75]
v_bfe_u32 v160, v161, 2, 14
v_mfma_f32_16x16x32_bf16 v[8:11], v[176:179], v[28:31], 0
ds_read_b128 v[176:179], v248 offset:30976
v_lshrrev_b32_e64 v161, 18, v161
ds_read_u16 v160, v160
ds_read_u16_d16_hi v161, v161
v_cvt_pk_f16_f32 v170, v170, v171
v_mfma_f32_16x16x32_f16 v[128:131], v[180:183], v[216:219], v[128:131]
ds_read_b128 v[180:183], v252 offset:14336
v_or_b32_e64 v105, v146, v147
v_mfma_f32_16x16x32_bf16 v[0:3], v[184:187], v[32:35], v[0:3]
v_cvt_pk_f16_f32 v172, v172, v173
v_cvt_pk_f16_f32 v174, v174, v175
v_mfma_f32_16x16x32_f16 v[76:79], v[188:191], v[220:223], v[76:79]
v_pk_fma_f16 v171, v170, v170, s48
v_mfma_f32_16x16x32_bf16 v[8:11], v[184:187], v[36:39], v[8:11]
ds_read_b128 v[184:187], v252 offset:12288
v_pk_fma_f16 v173, v172, v172, s48
v_cvt_pkrtz_f16_f32 v163, v162, v163
v_and_b32_e64 v163, s49, v163
v_bfe_u32 v162, v163, 2, 14
v_lshrrev_b32_e64 v163, 18, v163
ds_read_u16 v162, v162
ds_read_u16_d16_hi v163, v163
v_or_b32_e64 v106, v148, v149
v_pk_fma_f16 v175, v174, v174, s48
v_mfma_f32_16x16x32_f16 v[132:135], v[188:191], v[216:219], v[132:135]
ds_read_b128 v[188:191], v248 offset:33024
v_pk_mul_f16 v171, v170, v171
s_setprio 2
v_pk_mul_f16 v173, v172, v173
s_waitcnt lgkmcnt(7)
v_mfma_f32_16x16x32_bf16 v[0:3], v[120:123], v[40:43], v[0:3]
v_pk_mul_f16 v175, v174, v175
v_mfma_f32_16x16x32_f16 v[80:83], v[124:127], v[220:223], v[80:83]
v_cvt_pkrtz_f16_f32 v165, v164, v165
v_and_b32_e64 v165, s49, v165
v_bfe_u32 v164, v165, 2, 14
v_lshrrev_b32_e64 v165, 18, v165
ds_read_u16 v164, v164
ds_read_u16_d16_hi v165, v165
v_or_b32_e64 v107, v150, v151
v_exp_f16_sdwa v171, v171 dst_sel:WORD_0 dst_unused:UNUSED_PRESERVE src0_sel:WORD_0
v_mfma_f32_16x16x32_bf16 v[8:11], v[120:123], v[44:47], v[8:11]
ds_read_b128 v[120:123], v252 offset:15360
v_exp_f16_sdwa v173, v173 dst_sel:WORD_0 dst_unused:UNUSED_PRESERVE src0_sel:WORD_0
v_mfma_f32_16x16x32_f16 v[136:139], v[124:127], v[216:219], v[136:139]
ds_read_b128 v[124:127], v248 offset:35072
v_cvt_pkrtz_f16_f32 v167, v166, v167
v_and_b32_e64 v167, s49, v167
v_bfe_u32 v166, v167, 2, 14
v_lshrrev_b32_e64 v167, 18, v167
ds_read_u16 v166, v166
ds_read_u16_d16_hi v167, v167
v_exp_f16_sdwa v175, v175 dst_sel:WORD_0 dst_unused:UNUSED_PRESERVE src0_sel:WORD_0
v_or_b32 v108, v152, v153
v_mfma_f32_16x16x32_bf16 v[4:7], v[176:179], v[24:27], 0
v_exp_f16_sdwa v171, v171 dst_sel:WORD_1 dst_unused:UNUSED_PRESERVE src0_sel:WORD_1
s_waitcnt lgkmcnt(7)
v_mfma_f32_16x16x32_f16 v[84:87], v[180:183], v[220:223], v[84:87]
v_exp_f16_sdwa v173, v173 dst_sel:WORD_1 dst_unused:UNUSED_PRESERVE src0_sel:WORD_1
v_mfma_f32_16x16x32_f16 v[140:143], v[180:183], v[216:219], v[140:143]
ds_read_b128 v[180:183], v249
v_cvt_pkrtz_f16_f32 v169, v168, v169
v_mfma_f32_16x16x32_bf16 v[12:15], v[176:179], v[28:31], 0
ds_read_b128 v[176:179], v251 offset:8192
v_and_b32_e64 v169, s49, v169
v_bfe_u32 v168, v169, 2, 14
v_lshrrev_b32 v169, 18, v169
ds_read_u16 v168, v168
ds_read_u16_d16_hi v169, v169
v_cvt_pk_bf16_f32 v232, v128, v129
v_cvt_pk_bf16_f32 v233, v130, v131
v_cvt_pk_bf16_f32 v234, v132, v133
v_cvt_pk_bf16_f32 v235, v134, v135
v_cvt_pk_bf16_f32 v212, v72, v73
v_cvt_pk_bf16_f32 v213, v74, v75
v_cvt_pk_bf16_f32 v214, v76, v77
v_cvt_pk_bf16_f32 v215, v78, v79
ds_read_b128 v[128:131], v254 offset:8192
ds_read_b128 v[132:135], v254 offset:8208
v_exp_f16_sdwa v175, v175 dst_sel:WORD_1 dst_unused:UNUSED_PRESERVE src0_sel:WORD_1
v_mfma_f32_16x16x32_f16 v[88:91], v[184:187], v[220:223], v[88:91]
v_cvt_pk_bf16_f32 v236, v136, v137
s_waitcnt lgkmcnt(8)
v_mfma_f32_16x16x32_bf16 v[4:7], v[188:191], v[32:35], v[4:7]
v_cvt_pk_bf16_f32 v237, v138, v139
v_cvt_pk_bf16_f32 v238, v140, v141
v_cvt_pk_bf16_f32 v239, v142, v143
ds_read_b128 v[136:139], v254 offset:8320
ds_read_b128 v[140:143], v254 offset:8336
v_pk_add_f16 v171, v171, 1.0 op_sel_hi:[1,0]
v_pk_add_f16 v173, v173, 1.0 op_sel_hi:[1,0]
v_mfma_f32_16x16x32_f16 v[240:243], v[184:187], v[216:219], v[240:243]
ds_read_b128 v[184:187], v251 offset:11264
v_pk_add_f16 v175, v175, 1.0 op_sel_hi:[1,0]
v_mfma_f32_16x16x32_bf16 v[12:15], v[188:191], v[36:39], v[12:15]
ds_read_b128 v[188:191], v249 offset:2048
v_rcp_f16_sdwa v171, v171 dst_sel:WORD_0 dst_unused:UNUSED_PRESERVE src0_sel:WORD_0
v_mfma_f32_16x16x32_f16 v[92:95], v[120:123], v[220:223], v[92:95]
s_nop 1
v_cvt_pk_bf16_f32 v208, v240, v241
v_cvt_pk_bf16_f32 v209, v242, v243
ds_read_b128 v[240:243], v254
v_rcp_f16_sdwa v173, v173 dst_sel:WORD_0 dst_unused:UNUSED_PRESERVE src0_sel:WORD_0
s_setprio 1
v_mfma_f32_16x16x32_bf16 v[4:7], v[124:127], v[40:43], v[4:7]
v_rcp_f16_sdwa v175, v175 dst_sel:WORD_0 dst_unused:UNUSED_PRESERVE src0_sel:WORD_0
v_mfma_f32_16x16x32_f16 v[244:247], v[120:123], v[216:219], v[244:247]
ds_read_b128 v[120:123], v251 offset:9216
v_rcp_f16_sdwa v171, v171 dst_sel:WORD_1 dst_unused:UNUSED_PRESERVE src0_sel:WORD_1
v_mfma_f32_16x16x32_bf16 v[12:15], v[124:127], v[44:47], v[12:15]
ds_read_b128 v[124:127], v249 offset:4096
v_rcp_f16_sdwa v173, v173 dst_sel:WORD_1 dst_unused:UNUSED_PRESERVE src0_sel:WORD_1
s_waitcnt vmcnt(7)
v_mfma_f32_16x16x32_bf16 v[80:83], v[18:21], v[192:195], v[80:83]
s_nop 0
v_cvt_pk_bf16_f32 v210, v244, v245
v_cvt_pk_bf16_f32 v211, v246, v247
s_waitcnt lgkmcnt(6)
ds_read_b128 v[244:247], v254 offset:16
v_mfma_f32_16x16x32_bf16 v[84:87], v[16:19], v[192:195], v[84:87]
v_rcp_f16_sdwa v175, v175 dst_sel:WORD_1 dst_unused:UNUSED_PRESERVE src0_sel:WORD_1
s_waitcnt vmcnt(6)
v_mfma_f32_16x16x32_bf16 v[88:91], v[18:21], v[196:199], v[88:91]
v_or_b32 v200, v160, v161
v_mfma_f32_16x16x32_bf16 v[92:95], v[16:19], v[196:199], v[92:95]
v_cvt_pk_bf16_f32 v16, v80, v81
v_cvt_pk_bf16_f32 v17, v82, v83
s_nop 0
v_cvt_pk_bf16_f32 v18, v84, v85
v_cvt_pk_bf16_f32 v19, v86, v87
v_mfma_f32_16x16x32_f16 v[72:75], v[176:179], v[116:119], v[128:131]
v_cvt_pk_bf16_f32 v20, v88, v89
v_cvt_pk_bf16_f32 v21, v90, v91
v_cvt_pk_bf16_f32 v22, v92, v93
v_cvt_pk_bf16_f32 v23, v94, v95
v_mfma_f32_16x16x32_bf16 v[144:147], v[180:183], v[24:27], 0
v_pk_mul_f16 v205, v170, v171
v_mfma_f32_16x16x32_f16 v[128:131], v[176:179], v[112:115], v[128:131]
ds_read_b128 v[176:179], v251 offset:12288
buffer_store_dwordx4 v[232:235], v253, s[8:11], s70 offen sc1
buffer_store_dwordx4 v[236:239], v253, s[8:11], s70 offen offset:64 sc1
s_waitcnt lgkmcnt(2)
v_mfma_f32_16x16x32_f16 v[76:79], v[184:187], v[116:119], v[132:135]
v_pk_mul_f16 v206, v172, v173
v_mfma_f32_16x16x32_bf16 v[152:155], v[180:183], v[28:31], 0
ds_read_b128 v[180:183], v249 offset:256
v_pk_mul_f16 v207, v174, v175
v_mfma_f32_16x16x32_f16 v[132:135], v[184:187], v[112:115], v[132:135]
ds_read_b128 v[184:187], v251 offset:10240
v_cvt_pkrtz_f16_f32 v1, v0, v1
v_and_b32 v1, s49, v1
v_bfe_u32 v0, v1, 2, 14
v_lshrrev_b32_e64 v1, 18, v1
ds_read_u16 v0, v0
ds_read_u16_d16_hi v1, v1
v_cvt_pk_f16_f32 v10, v10, v11
v_or_b32_e64 v201, v162, v163
v_mfma_f32_16x16x32_bf16 v[144:147], v[188:191], v[32:35], v[144:147]
v_cvt_pk_f16_f32 v12, v12, v13
v_cvt_pk_f16_f32 v14, v14, v15
v_mfma_f32_16x16x32_f16 v[80:83], v[120:123], v[116:119], v[136:139]
v_pk_fma_f16 v11, v10, v10, s48
v_mfma_f32_16x16x32_bf16 v[152:155], v[188:191], v[36:39], v[152:155]
ds_read_b128 v[188:191], v251 offset:13312
v_pk_fma_f16 v13, v12, v12, s48
v_cvt_pkrtz_f16_f32 v3, v2, v3
v_and_b32_e64 v3, s49, v3
v_bfe_u32 v2, v3, 2, 14
v_lshrrev_b32_e64 v3, 18, v3
ds_read_u16 v2, v2
ds_read_u16_d16_hi v3, v3
v_or_b32_e64 v202, v164, v165
v_pk_fma_f16 v15, v14, v14, s48
v_mfma_f32_16x16x32_f16 v[136:139], v[120:123], v[112:115], v[136:139]
ds_read_b128 v[120:123], v249 offset:2304
v_pk_mul_f16 v11, v10, v11
s_setprio 0
v_pk_mul_f16 v13, v12, v13
v_mfma_f32_16x16x32_bf16 v[144:147], v[124:127], v[40:43], v[144:147]
v_pk_mul_f16 v15, v14, v15
s_waitcnt lgkmcnt(6)
v_mfma_f32_16x16x32_f16 v[84:87], v[176:179], v[116:119], v[140:143]
v_cvt_pkrtz_f16_f32 v5, v4, v5
v_and_b32_e64 v5, s49, v5
v_bfe_u32 v4, v5, 2, 14
v_lshrrev_b32_e64 v5, 18, v5
ds_read_u16 v4, v4
ds_read_u16_d16_hi v5, v5
v_or_b32_e64 v203, v166, v167
v_exp_f16_sdwa v11, v11 dst_sel:WORD_0 dst_unused:UNUSED_PRESERVE src0_sel:WORD_0
v_mfma_f32_16x16x32_bf16 v[152:155], v[124:127], v[44:47], v[152:155]
ds_read_b128 v[124:127], v251 offset:14336
v_exp_f16_sdwa v13, v13 dst_sel:WORD_0 dst_unused:UNUSED_PRESERVE src0_sel:WORD_0
v_mfma_f32_16x16x32_f16 v[140:143], v[176:179], v[112:115], v[140:143]
ds_read_b128 v[176:179], v249 offset:4352
v_cvt_pkrtz_f16_f32 v7, v6, v7
v_and_b32_e64 v7, s49, v7
v_bfe_u32 v6, v7, 2, 14
v_lshrrev_b32_e64 v7, 18, v7
ds_read_u16 v6, v6
ds_read_u16_d16_hi v7, v7
v_exp_f16_sdwa v15, v15 dst_sel:WORD_0 dst_unused:UNUSED_PRESERVE src0_sel:WORD_0
v_or_b32_e64 v204, v168, v169
v_mfma_f32_16x16x32_bf16 v[148:151], v[180:183], v[24:27], 0
v_exp_f16_sdwa v11, v11 dst_sel:WORD_1 dst_unused:UNUSED_PRESERVE src0_sel:WORD_1
v_mfma_f32_16x16x32_f16 v[88:91], v[184:187], v[116:119], v[240:243]
v_exp_f16_sdwa v13, v13 dst_sel:WORD_1 dst_unused:UNUSED_PRESERVE src0_sel:WORD_1
v_mfma_f32_16x16x32_f16 v[240:243], v[184:187], v[112:115], v[240:243]
ds_read_b128 v[184:187], v249 offset:6144
v_cvt_pkrtz_f16_f32 v9, v8, v9
v_mfma_f32_16x16x32_bf16 v[156:159], v[180:183], v[28:31], 0
ds_read_b128 v[180:183], v251 offset:17408
v_and_b32_e64 v9, s49, v9
v_bfe_u32 v8, v9, 2, 14
v_lshrrev_b32 v9, 18, v9
ds_read_u16 v8, v8
s_waitcnt lgkmcnt(7)
ds_read_u16_d16_hi v9, v9
v_exp_f16_sdwa v15, v15 dst_sel:WORD_1 dst_unused:UNUSED_PRESERVE src0_sel:WORD_1
v_mfma_f32_16x16x32_f16 v[92:95], v[188:191], v[116:119], v[244:247]
v_pk_add_f16 v11, v11, 1.0 op_sel_hi:[1,0]
v_mfma_f32_16x16x32_bf16 v[148:151], v[120:123], v[32:35], v[148:151]
v_pk_add_f16 v13, v13, 1.0 op_sel_hi:[1,0]
v_mfma_f32_16x16x32_f16 v[244:247], v[188:191], v[112:115], v[244:247]
ds_read_b128 v[188:191], v251 offset:15360
v_pk_add_f16 v15, v15, 1.0 op_sel_hi:[1,0]
v_mfma_f32_16x16x32_bf16 v[156:159], v[120:123], v[36:39], v[156:159]
ds_read_b128 v[120:123], v249 offset:8192
v_rcp_f16_sdwa v11, v11 dst_sel:WORD_0 dst_unused:UNUSED_PRESERVE src0_sel:WORD_0
s_waitcnt lgkmcnt(7)
v_mfma_f32_16x16x32_f16 v[72:75], v[124:127], v[228:231], v[72:75]
s_setprio 3
v_rcp_f16_sdwa v13, v13 dst_sel:WORD_0 dst_unused:UNUSED_PRESERVE src0_sel:WORD_0
v_mfma_f32_16x16x32_bf16 v[148:151], v[176:179], v[40:43], v[148:151]
v_rcp_f16_sdwa v15, v15 dst_sel:WORD_0 dst_unused:UNUSED_PRESERVE src0_sel:WORD_0
v_mfma_f32_16x16x32_f16 v[128:131], v[124:127], v[224:227], v[128:131]
ds_read_b128 v[124:127], v251 offset:18432
v_rcp_f16_sdwa v11, v11 dst_sel:WORD_1 dst_unused:UNUSED_PRESERVE src0_sel:WORD_1
v_mfma_f32_16x16x32_bf16 v[156:159], v[176:179], v[44:47], v[156:159]
ds_read_b128 v[176:179], v249 offset:10240
v_rcp_f16_sdwa v13, v13 dst_sel:WORD_1 dst_unused:UNUSED_PRESERVE src0_sel:WORD_1
s_waitcnt lgkmcnt(5)
v_mfma_f32_16x16x32_f16 v[76:79], v[180:183], v[228:231], v[76:79]
v_rcp_f16_sdwa v15, v15 dst_sel:WORD_1 dst_unused:UNUSED_PRESERVE src0_sel:WORD_1
v_mfma_f32_16x16x32_bf16 v[160:163], v[184:187], v[24:27], 0
v_or_b32_e64 v216, v0, v1
v_mfma_f32_16x16x32_f16 v[132:135], v[180:183], v[224:227], v[132:135]
ds_read_b128 v[180:183], v251 offset:16384
v_pk_mul_f16 v221, v10, v11
s_waitcnt lgkmcnt(4)
v_mfma_f32_16x16x32_f16 v[80:83], v[188:191], v[228:231], v[80:83]
v_pk_mul_f16 v222, v12, v13
v_mfma_f32_16x16x32_bf16 v[168:171], v[184:187], v[28:31], 0
ds_read_b128 v[184:187], v249 offset:6400
v_pk_mul_f16 v223, v14, v15
v_mfma_f32_16x16x32_f16 v[136:139], v[188:191], v[224:227], v[136:139]
ds_read_b128 v[188:191], v251 offset:19456
v_cvt_pkrtz_f16_f32 v145, v144, v145
v_and_b32_e64 v145, s49, v145
v_bfe_u32 v144, v145, 2, 14
v_lshrrev_b32_e64 v145, 18, v145
ds_read_u16 v144, v144
ds_read_u16_d16_hi v145, v145
v_cvt_pk_f16_f32 v154, v154, v155
v_or_b32 v217, v2, v3
s_waitcnt lgkmcnt(5)
v_mfma_f32_16x16x32_bf16 v[160:163], v[120:123], v[32:35], v[160:163]
v_cvt_pk_f16_f32 v156, v156, v157
v_cvt_pk_f16_f32 v158, v158, v159
v_mfma_f32_16x16x32_f16 v[84:87], v[124:127], v[228:231], v[84:87]
v_pk_fma_f16 v155, v154, v154, s48
v_mfma_f32_16x16x32_bf16 v[168:171], v[120:123], v[36:39], v[168:171]
ds_read_b128 v[120:123], v251 offset:20480
v_pk_fma_f16 v157, v156, v156, s48
v_cvt_pkrtz_f16_f32 v147, v146, v147
v_and_b32_e64 v147, s49, v147
v_bfe_u32 v146, v147, 2, 14
v_lshrrev_b32_e64 v147, 18, v147
ds_read_u16 v146, v146
ds_read_u16_d16_hi v147, v147
v_or_b32_e64 v218, v4, v5
v_pk_fma_f16 v159, v158, v158, s48
v_mfma_f32_16x16x32_f16 v[140:143], v[124:127], v[224:227], v[140:143]
ds_read_b128 v[124:127], v249 offset:8448
v_pk_mul_f16 v155, v154, v155
s_setprio 2
v_pk_mul_f16 v157, v156, v157
v_mfma_f32_16x16x32_bf16 v[160:163], v[176:179], v[40:43], v[160:163]
v_pk_mul_f16 v159, v158, v159
s_waitcnt lgkmcnt(6)
v_mfma_f32_16x16x32_f16 v[88:91], v[180:183], v[228:231], v[88:91]
v_cvt_pkrtz_f16_f32 v149, v148, v149
v_and_b32_e64 v149, s49, v149
v_bfe_u32 v148, v149, 2, 14
v_lshrrev_b32_e64 v149, 18, v149
ds_read_u16 v148, v148
ds_read_u16_d16_hi v149, v149
v_or_b32_e64 v219, v6, v7
v_exp_f16_sdwa v155, v155 dst_sel:WORD_0 dst_unused:UNUSED_PRESERVE src0_sel:WORD_0
v_mfma_f32_16x16x32_bf16 v[168:171], v[176:179], v[44:47], v[168:171]
ds_read_b128 v[176:179], v251 offset:23552
v_exp_f16_sdwa v157, v157 dst_sel:WORD_0 dst_unused:UNUSED_PRESERVE src0_sel:WORD_0
v_mfma_f32_16x16x32_f16 v[240:243], v[180:183], v[224:227], v[240:243]
ds_read_b128 v[180:183], v249 offset:10496
v_cvt_pkrtz_f16_f32 v151, v150, v151
v_and_b32_e64 v151, s49, v151
v_bfe_u32 v150, v151, 2, 14
v_lshrrev_b32_e64 v151, 18, v151
ds_read_u16 v150, v150
ds_read_u16_d16_hi v151, v151
v_exp_f16_sdwa v159, v159 dst_sel:WORD_0 dst_unused:UNUSED_PRESERVE src0_sel:WORD_0
v_or_b32_e64 v220, v8, v9
v_mfma_f32_16x16x32_bf16 v[164:167], v[184:187], v[24:27], 0
v_exp_f16_sdwa v155, v155 dst_sel:WORD_1 dst_unused:UNUSED_PRESERVE src0_sel:WORD_1
v_mfma_f32_16x16x32_f16 v[92:95], v[188:191], v[228:231], v[92:95]
v_exp_f16_sdwa v157, v157 dst_sel:WORD_1 dst_unused:UNUSED_PRESERVE src0_sel:WORD_1
v_mfma_f32_16x16x32_f16 v[244:247], v[188:191], v[224:227], v[244:247]
ds_read_b128 v[188:191], v249 offset:12288
v_cvt_pkrtz_f16_f32 v153, v152, v153
v_mfma_f32_16x16x32_bf16 v[172:175], v[184:187], v[28:31], 0
ds_read_b128 v[184:187], v251 offset:21504
v_and_b32_e64 v153, s49, v153
v_bfe_u32 v152, v153, 2, 14
v_lshrrev_b32 v153, 18, v153
ds_read_u16 v152, v152
s_waitcnt lgkmcnt(7)
ds_read_u16_d16_hi v153, v153
buffer_store_dwordx4 v[208:211], v253, s[8:11], s70 offen offset:128 sc1
buffer_store_dwordx4 v[212:215], v253, s[8:11], s70 offen offset:192 sc1
v_exp_f16_sdwa v159, v159 dst_sel:WORD_1 dst_unused:UNUSED_PRESERVE src0_sel:WORD_1
v_mfma_f32_16x16x32_f16 v[72:75], v[120:123], v[100:103], v[72:75]
v_pk_add_f16 v155, v155, 1.0 op_sel_hi:[1,0]
v_mfma_f32_16x16x32_bf16 v[164:167], v[124:127], v[32:35], v[164:167]
v_pk_add_f16 v157, v157, 1.0 op_sel_hi:[1,0]
v_mfma_f32_16x16x32_f16 v[128:131], v[120:123], v[96:99], v[128:131]
ds_read_b128 v[120:123], v251 offset:24576
v_pk_add_f16 v159, v159, 1.0 op_sel_hi:[1,0]
v_mfma_f32_16x16x32_bf16 v[172:175], v[124:127], v[36:39], v[172:175]
ds_read_b128 v[124:127], v249 offset:14336
v_rcp_f16_sdwa v155, v155 dst_sel:WORD_0 dst_unused:UNUSED_PRESERVE src0_sel:WORD_0
s_waitcnt lgkmcnt(7)
v_mfma_f32_16x16x32_f16 v[76:79], v[176:179], v[100:103], v[76:79]
s_setprio 1
v_rcp_f16_sdwa v157, v157 dst_sel:WORD_0 dst_unused:UNUSED_PRESERVE src0_sel:WORD_0
v_mfma_f32_16x16x32_bf16 v[164:167], v[180:183], v[40:43], v[164:167]
v_rcp_f16_sdwa v159, v159 dst_sel:WORD_0 dst_unused:UNUSED_PRESERVE src0_sel:WORD_0
v_mfma_f32_16x16x32_f16 v[132:135], v[176:179], v[96:99], v[132:135]
ds_read_b128 v[176:179], v251 offset:22528
v_rcp_f16_sdwa v155, v155 dst_sel:WORD_1 dst_unused:UNUSED_PRESERVE src0_sel:WORD_1
v_mfma_f32_16x16x32_bf16 v[172:175], v[180:183], v[44:47], v[172:175]
ds_read_b128 v[180:183], v249 offset:16384
v_rcp_f16_sdwa v157, v157 dst_sel:WORD_1 dst_unused:UNUSED_PRESERVE src0_sel:WORD_1
s_waitcnt lgkmcnt(5)
v_mfma_f32_16x16x32_f16 v[80:83], v[184:187], v[100:103], v[80:83]
v_rcp_f16_sdwa v159, v159 dst_sel:WORD_1 dst_unused:UNUSED_PRESERVE src0_sel:WORD_1
v_mfma_f32_16x16x32_bf16 v[0:3], v[188:191], v[24:27], 0
v_or_b32_e64 v192, v144, v145
v_mfma_f32_16x16x32_f16 v[136:139], v[184:187], v[96:99], v[136:139]
ds_read_b128 v[184:187], v251 offset:25600
v_pk_mul_f16 v197, v154, v155
s_waitcnt lgkmcnt(4)
v_mfma_f32_16x16x32_f16 v[84:87], v[120:123], v[100:103], v[84:87]
v_pk_mul_f16 v198, v156, v157
v_mfma_f32_16x16x32_bf16 v[8:11], v[188:191], v[28:31], 0
ds_read_b128 v[188:191], v249 offset:12544
v_pk_mul_f16 v199, v158, v159
v_mfma_f32_16x16x32_f16 v[140:143], v[120:123], v[96:99], v[140:143]
ds_read_b128 v[120:123], v251 offset:26624
v_cvt_pkrtz_f16_f32 v161, v160, v161
v_and_b32_e64 v161, s49, v161
v_bfe_u32 v160, v161, 2, 14
v_lshrrev_b32_e64 v161, 18, v161
ds_read_u16 v160, v160
ds_read_u16_d16_hi v161, v161
v_cvt_pk_f16_f32 v170, v170, v171
v_or_b32 v193, v146, v147
s_waitcnt lgkmcnt(5)
v_mfma_f32_16x16x32_bf16 v[0:3], v[124:127], v[32:35], v[0:3]
v_cvt_pk_f16_f32 v172, v172, v173
v_cvt_pk_f16_f32 v174, v174, v175
v_mfma_f32_16x16x32_f16 v[88:91], v[176:179], v[100:103], v[88:91]
v_pk_fma_f16 v171, v170, v170, s48
v_mfma_f32_16x16x32_bf16 v[8:11], v[124:127], v[36:39], v[8:11]
ds_read_b128 v[124:127], v251 offset:29696
v_pk_fma_f16 v173, v172, v172, s48
v_cvt_pkrtz_f16_f32 v163, v162, v163
v_and_b32_e64 v163, s49, v163
v_bfe_u32 v162, v163, 2, 14
v_lshrrev_b32_e64 v163, 18, v163
ds_read_u16 v162, v162
ds_read_u16_d16_hi v163, v163
v_or_b32_e64 v194, v148, v149
v_pk_fma_f16 v175, v174, v174, s48
v_mfma_f32_16x16x32_f16 v[240:243], v[176:179], v[96:99], v[240:243]
ds_read_b128 v[176:179], v249 offset:14592
s_setprio 0
v_pk_mul_f16 v171, v170, v171
v_pk_mul_f16 v173, v172, v173
v_mfma_f32_16x16x32_bf16 v[0:3], v[180:183], v[40:43], v[0:3]
v_pk_mul_f16 v175, v174, v175
s_waitcnt lgkmcnt(6)
v_mfma_f32_16x16x32_f16 v[92:95], v[184:187], v[100:103], v[92:95]
v_cvt_pkrtz_f16_f32 v165, v164, v165
v_and_b32_e64 v165, s49, v165
v_bfe_u32 v164, v165, 2, 14
v_lshrrev_b32_e64 v165, 18, v165
ds_read_u16 v164, v164
ds_read_u16_d16_hi v165, v165
v_or_b32_e64 v195, v150, v151
v_exp_f16_sdwa v171, v171 dst_sel:WORD_0 dst_unused:UNUSED_PRESERVE src0_sel:WORD_0
v_mfma_f32_16x16x32_bf16 v[8:11], v[180:183], v[44:47], v[8:11]
ds_read_b128 v[180:183], v251 offset:27648
v_exp_f16_sdwa v173, v173 dst_sel:WORD_0 dst_unused:UNUSED_PRESERVE src0_sel:WORD_0
v_mfma_f32_16x16x32_f16 v[244:247], v[184:187], v[96:99], v[244:247]
ds_read_b128 v[184:187], v249 offset:16640
v_cvt_pkrtz_f16_f32 v167, v166, v167
v_and_b32_e64 v167, s49, v167
v_bfe_u32 v166, v167, 2, 14
v_lshrrev_b32_e64 v167, 18, v167
ds_read_u16 v166, v166
ds_read_u16_d16_hi v167, v167
v_exp_f16_sdwa v175, v175 dst_sel:WORD_0 dst_unused:UNUSED_PRESERVE src0_sel:WORD_0
v_or_b32_e64 v196, v152, v153
v_mfma_f32_16x16x32_bf16 v[4:7], v[188:191], v[24:27], 0
v_exp_f16_sdwa v171, v171 dst_sel:WORD_1 dst_unused:UNUSED_PRESERVE src0_sel:WORD_1
v_mfma_f32_16x16x32_f16 v[72:75], v[120:123], v[108:111], v[72:75]
v_exp_f16_sdwa v173, v173 dst_sel:WORD_1 dst_unused:UNUSED_PRESERVE src0_sel:WORD_1
v_mfma_f32_16x16x32_f16 v[128:131], v[120:123], v[104:107], v[128:131]
ds_read_b128 v[120:123], v249 offset:18432
v_cvt_pkrtz_f16_f32 v169, v168, v169
v_mfma_f32_16x16x32_bf16 v[12:15], v[188:191], v[28:31], 0
ds_read_b128 v[188:191], v251 offset:30720
v_and_b32_e64 v169, s49, v169
v_bfe_u32 v168, v169, 2, 14
v_lshrrev_b32 v169, 18, v169
ds_read_u16 v168, v168
s_waitcnt lgkmcnt(7)
ds_read_u16_d16_hi v169, v169
v_exp_f16_sdwa v175, v175 dst_sel:WORD_1 dst_unused:UNUSED_PRESERVE src0_sel:WORD_1
buffer_load_dwordx4 v[232:235], v253, s[4:7], s69 offen
buffer_load_dwordx4 v[236:239], v253, s[4:7], s69 offen offset:64
v_mfma_f32_16x16x32_f16 v[76:79], v[124:127], v[108:111], v[76:79]
v_pk_add_f16 v171, v171, 1.0 op_sel_hi:[1,0]
v_mfma_f32_16x16x32_bf16 v[4:7], v[176:179], v[32:35], v[4:7]
v_pk_add_f16 v173, v173, 1.0 op_sel_hi:[1,0]
v_mfma_f32_16x16x32_f16 v[132:135], v[124:127], v[104:107], v[132:135]
ds_read_b128 v[124:127], v251 offset:28672
v_pk_add_f16 v175, v175, 1.0 op_sel_hi:[1,0]
v_mfma_f32_16x16x32_bf16 v[12:15], v[176:179], v[36:39], v[12:15]
ds_read_b128 v[176:179], v249 offset:20480
v_rcp_f16_sdwa v171, v171 dst_sel:WORD_0 dst_unused:UNUSED_PRESERVE src0_sel:WORD_0
s_waitcnt lgkmcnt(7)
v_mfma_f32_16x16x32_f16 v[80:83], v[180:183], v[108:111], v[80:83]
s_setprio 3
v_rcp_f16_sdwa v173, v173 dst_sel:WORD_0 dst_unused:UNUSED_PRESERVE src0_sel:WORD_0
v_mfma_f32_16x16x32_bf16 v[4:7], v[184:187], v[40:43], v[4:7]
v_rcp_f16_sdwa v175, v175 dst_sel:WORD_0 dst_unused:UNUSED_PRESERVE src0_sel:WORD_0
v_mfma_f32_16x16x32_f16 v[136:139], v[180:183], v[104:107], v[136:139]
ds_read_b128 v[180:183], v251 offset:31744
v_rcp_f16_sdwa v171, v171 dst_sel:WORD_1 dst_unused:UNUSED_PRESERVE src0_sel:WORD_1
v_mfma_f32_16x16x32_bf16 v[12:15], v[184:187], v[44:47], v[12:15]
ds_read_b128 v[184:187], v249 offset:22528
v_rcp_f16_sdwa v173, v173 dst_sel:WORD_1 dst_unused:UNUSED_PRESERVE src0_sel:WORD_1
s_waitcnt lgkmcnt(5)
v_mfma_f32_16x16x32_f16 v[84:87], v[188:191], v[108:111], v[84:87]
v_rcp_f16_sdwa v175, v175 dst_sel:WORD_1 dst_unused:UNUSED_PRESERVE src0_sel:WORD_1
v_mfma_f32_16x16x32_f16 v[140:143], v[188:191], v[104:107], v[140:143]
ds_read_b128 v[188:191], v251 offset:32768
v_or_b32_e64 v112, v160, v161
v_mfma_f32_16x16x32_bf16 v[144:147], v[120:123], v[24:27], 0
v_pk_mul_f16 v117, v170, v171
s_waitcnt lgkmcnt(4)
v_mfma_f32_16x16x32_f16 v[88:91], v[124:127], v[108:111], v[88:91]
v_pk_mul_f16 v118, v172, v173
v_mfma_f32_16x16x32_bf16 v[152:155], v[120:123], v[28:31], 0
ds_read_b128 v[120:123], v251 offset:35840
v_pk_mul_f16 v119, v174, v175
v_mfma_f32_16x16x32_f16 v[240:243], v[124:127], v[104:107], v[240:243]
ds_read_b128 v[124:127], v249 offset:18688
v_cvt_pkrtz_f16_f32 v1, v0, v1
v_and_b32_e64 v1, s49, v1
v_bfe_u32 v0, v1, 2, 14
v_lshrrev_b32_e64 v1, 18, v1
ds_read_u16 v0, v0
ds_read_u16_d16_hi v1, v1
v_cvt_pk_f16_f32 v10, v10, v11
v_or_b32 v113, v162, v163
s_waitcnt lgkmcnt(5)
v_mfma_f32_16x16x32_bf16 v[144:147], v[176:179], v[32:35], v[144:147]
v_cvt_pk_f16_f32 v12, v12, v13
v_cvt_pk_f16_f32 v14, v14, v15
v_mfma_f32_16x16x32_f16 v[92:95], v[180:183], v[108:111], v[92:95]
buffer_store_dwordx4 v[16:19], v253, s[8:11], s70 offen offset:256 sc1
buffer_store_dwordx4 v[20:23], v253, s[8:11], s70 offen offset:320 sc1
v_pk_fma_f16 v11, v10, v10, s48
v_mfma_f32_16x16x32_bf16 v[152:155], v[176:179], v[36:39], v[152:155]
ds_read_b128 v[176:179], v251 offset:33792
v_pk_fma_f16 v13, v12, v12, s48
v_cvt_pkrtz_f16_f32 v3, v2, v3
v_and_b32_e64 v3, s49, v3
v_bfe_u32 v2, v3, 2, 14
v_lshrrev_b32_e64 v3, 18, v3
ds_read_u16 v2, v2
ds_read_u16_d16_hi v3, v3
v_or_b32_e64 v114, v164, v165
v_pk_fma_f16 v15, v14, v14, s48
v_mfma_f32_16x16x32_f16 v[244:247], v[180:183], v[104:107], v[244:247]
ds_read_b128 v[180:183], v249 offset:20736
s_setprio 2
v_pk_mul_f16 v11, v10, v11
v_pk_mul_f16 v13, v12, v13
v_mfma_f32_16x16x32_bf16 v[144:147], v[184:187], v[40:43], v[144:147]
v_pk_mul_f16 v15, v14, v15
s_waitcnt lgkmcnt(5)
v_mfma_f32_16x16x32_f16 v[72:75], v[188:191], v[204:207], v[72:75]
v_cvt_pkrtz_f16_f32 v5, v4, v5
v_and_b32_e64 v5, s49, v5
v_bfe_u32 v4, v5, 2, 14
v_lshrrev_b32_e64 v5, 18, v5
ds_read_u16 v4, v4
ds_read_u16_d16_hi v5, v5
v_or_b32_e64 v115, v166, v167
v_exp_f16_sdwa v11, v11 dst_sel:WORD_0 dst_unused:UNUSED_PRESERVE src0_sel:WORD_0
v_mfma_f32_16x16x32_bf16 v[152:155], v[184:187], v[44:47], v[152:155]
ds_read_b128 v[184:187], v251 offset:36864
v_exp_f16_sdwa v13, v13 dst_sel:WORD_0 dst_unused:UNUSED_PRESERVE src0_sel:WORD_0
v_mfma_f32_16x16x32_f16 v[128:131], v[188:191], v[200:203], v[128:131]
ds_read_b128 v[188:191], v249 offset:22784
v_cvt_pkrtz_f16_f32 v7, v6, v7
v_and_b32_e64 v7, s49, v7
v_bfe_u32 v6, v7, 2, 14
v_lshrrev_b32_e64 v7, 18, v7
ds_read_u16 v6, v6
ds_read_u16_d16_hi v7, v7
v_exp_f16_sdwa v15, v15 dst_sel:WORD_0 dst_unused:UNUSED_PRESERVE src0_sel:WORD_0
v_or_b32_e64 v116, v168, v169
buffer_load_dwordx4 v[208:211], v253, s[4:7], s69 offen offset:128
buffer_load_dwordx4 v[212:215], v253, s[4:7], s69 offen offset:192
v_mfma_f32_16x16x32_f16 v[76:79], v[120:123], v[204:207], v[76:79]
v_exp_f16_sdwa v11, v11 dst_sel:WORD_1 dst_unused:UNUSED_PRESERVE src0_sel:WORD_1
v_mfma_f32_16x16x32_bf16 v[148:151], v[124:127], v[24:27], 0
v_exp_f16_sdwa v13, v13 dst_sel:WORD_1 dst_unused:UNUSED_PRESERVE src0_sel:WORD_1
v_mfma_f32_16x16x32_f16 v[132:135], v[120:123], v[200:203], v[132:135]
ds_read_b128 v[120:123], v251 offset:34816
v_cvt_pkrtz_f16_f32 v9, v8, v9
v_mfma_f32_16x16x32_bf16 v[156:159], v[124:127], v[28:31], 0
ds_read_b128 v[124:127], v249 offset:24576
v_and_b32_e64 v9, s49, v9
v_bfe_u32 v8, v9, 2, 14
v_lshrrev_b32 v9, 18, v9
ds_read_u16 v8, v8
ds_read_u16_d16_hi v9, v9
v_exp_f16_sdwa v15, v15 dst_sel:WORD_1 dst_unused:UNUSED_PRESERVE src0_sel:WORD_1
s_waitcnt lgkmcnt(7)
v_mfma_f32_16x16x32_f16 v[80:83], v[176:179], v[204:207], v[80:83]
v_pk_add_f16 v11, v11, 1.0 op_sel_hi:[1,0]
v_mfma_f32_16x16x32_bf16 v[148:151], v[180:183], v[32:35], v[148:151]
v_pk_add_f16 v13, v13, 1.0 op_sel_hi:[1,0]
v_mfma_f32_16x16x32_f16 v[136:139], v[176:179], v[200:203], v[136:139]
ds_read_b128 v[176:179], v251 offset:37888
v_pk_add_f16 v15, v15, 1.0 op_sel_hi:[1,0]
v_mfma_f32_16x16x32_bf16 v[156:159], v[180:183], v[36:39], v[156:159]
ds_read_b128 v[180:183], v249 offset:26624
v_rcp_f16_sdwa v11, v11 dst_sel:WORD_0 dst_unused:UNUSED_PRESERVE src0_sel:WORD_0
s_setprio 1
v_mfma_f32_16x16x32_f16 v[84:87], v[184:187], v[204:207], v[84:87]
v_rcp_f16_sdwa v13, v13 dst_sel:WORD_0 dst_unused:UNUSED_PRESERVE src0_sel:WORD_0
s_waitcnt lgkmcnt(6)
v_mfma_f32_16x16x32_bf16 v[148:151], v[188:191], v[40:43], v[148:151]
v_rcp_f16_sdwa v15, v15 dst_sel:WORD_0 dst_unused:UNUSED_PRESERVE src0_sel:WORD_0
v_mfma_f32_16x16x32_f16 v[140:143], v[184:187], v[200:203], v[140:143]
ds_read_b128 v[184:187], v251 offset:38912
v_rcp_f16_sdwa v11, v11 dst_sel:WORD_1 dst_unused:UNUSED_PRESERVE src0_sel:WORD_1
v_mfma_f32_16x16x32_bf16 v[156:159], v[188:191], v[44:47], v[156:159]
ds_read_b128 v[188:191], v249 offset:28672
v_rcp_f16_sdwa v13, v13 dst_sel:WORD_1 dst_unused:UNUSED_PRESERVE src0_sel:WORD_1
s_waitcnt lgkmcnt(5)
v_mfma_f32_16x16x32_f16 v[88:91], v[120:123], v[204:207], v[88:91]
v_rcp_f16_sdwa v15, v15 dst_sel:WORD_1 dst_unused:UNUSED_PRESERVE src0_sel:WORD_1
v_mfma_f32_16x16x32_f16 v[240:243], v[120:123], v[200:203], v[240:243]
ds_read_b128 v[120:123], v251 offset:41984
s_getpc_b64 s[74:75]
Lcq13:
s_lshl_b32 s43, s40, 10
s_add_u32 s43, s43, 6144
s_min_u32 s43, s43, Lend-Lcq13-1024
s_add_u32 s74, s74, s43
s_addc_u32 s75, s75, 0
s_sub_u32 s74, s74, 16384
s_subb_u32 s75, s75, 0
s_mov_b32 m0, 163840
s_nop 0
global_load_lds_dword v250, s[74:75]
v_mfma_f32_16x16x32_bf16 v[160:163], v[124:127], v[24:27], 0
v_or_b32_e64 v224, v0, v1
s_waitcnt lgkmcnt(4)
v_mfma_f32_16x16x32_f16 v[92:95], v[176:179], v[204:207], v[92:95]
v_pk_mul_f16 v229, v10, v11
v_mfma_f32_16x16x32_bf16 v[168:171], v[124:127], v[28:31], 0
ds_read_b128 v[124:127], v251 offset:39936
v_pk_mul_f16 v230, v12, v13
v_pk_mul_f16 v231, v14, v15
v_mfma_f32_16x16x32_f16 v[244:247], v[176:179], v[200:203], v[244:247]
ds_read_b128 v[176:179], v249 offset:24832
v_cvt_pkrtz_f16_f32 v145, v144, v145
v_and_b32_e64 v145, s49, v145
v_bfe_u32 v144, v145, 2, 14
v_lshrrev_b32_e64 v145, 18, v145
ds_read_u16 v144, v144
ds_read_u16_d16_hi v145, v145
v_cvt_pk_f16_f32 v154, v154, v155
v_or_b32 v225, v2, v3
s_waitcnt lgkmcnt(5)
v_mfma_f32_16x16x32_bf16 v[160:163], v[180:183], v[32:35], v[160:163]
v_cvt_pk_f16_f32 v156, v156, v157
v_cvt_pk_f16_f32 v158, v158, v159
v_mfma_f32_16x16x32_f16 v[72:75], v[184:187], v[220:223], v[72:75]
v_pk_fma_f16 v155, v154, v154, s48
v_mfma_f32_16x16x32_bf16 v[168:171], v[180:183], v[36:39], v[168:171]
ds_read_b128 v[180:183], v251 offset:43008
v_pk_fma_f16 v157, v156, v156, s48
v_cvt_pkrtz_f16_f32 v147, v146, v147
v_and_b32_e64 v147, s49, v147
v_bfe_u32 v146, v147, 2, 14
v_lshrrev_b32_e64 v147, 18, v147
ds_read_u16 v146, v146
ds_read_u16_d16_hi v147, v147
v_or_b32 v226, v4, v5
s_setprio 0
v_pk_fma_f16 v159, v158, v158, s48
v_mfma_f32_16x16x32_f16 v[128:131], v[184:187], v[216:219], v[128:131]
ds_read_b128 v[184:187], v249 offset:26880
v_pk_mul_f16 v155, v154, v155
v_pk_mul_f16 v157, v156, v157
v_mfma_f32_16x16x32_bf16 v[160:163], v[188:191], v[40:43], v[160:163]
buffer_load_dwordx4 v[96:99], v253, s[4:7], s69 offen offset:256
buffer_load_dwordx4 v[100:103], v253, s[4:7], s69 offen offset:320
s_waitcnt lgkmcnt(6)
v_mfma_f32_16x16x32_f16 v[76:79], v[120:123], v[220:223], v[76:79]
v_pk_mul_f16 v159, v158, v159
v_cvt_pkrtz_f16_f32 v149, v148, v149
v_and_b32 v149, s49, v149
v_bfe_u32 v148, v149, 2, 14
v_lshrrev_b32_e64 v149, 18, v149
ds_read_u16 v148, v148
ds_read_u16_d16_hi v149, v149
v_or_b32_e64 v227, v6, v7
v_exp_f16_sdwa v155, v155 dst_sel:WORD_0 dst_unused:UNUSED_PRESERVE src0_sel:WORD_0
v_mfma_f32_16x16x32_bf16 v[168:171], v[188:191], v[44:47], v[168:171]
ds_read_b128 v[188:191], v251 offset:40960
v_exp_f16_sdwa v157, v157 dst_sel:WORD_0 dst_unused:UNUSED_PRESERVE src0_sel:WORD_0
v_mfma_f32_16x16x32_f16 v[132:135], v[120:123], v[216:219], v[132:135]
ds_read_b128 v[120:123], v249 offset:28928
v_cvt_pkrtz_f16_f32 v151, v150, v151
v_and_b32_e64 v151, s49, v151
v_bfe_u32 v150, v151, 2, 14
v_lshrrev_b32_e64 v151, 18, v151
ds_read_u16 v150, v150
ds_read_u16_d16_hi v151, v151
v_exp_f16_sdwa v159, v159 dst_sel:WORD_0 dst_unused:UNUSED_PRESERVE src0_sel:WORD_0
v_or_b32_e64 v228, v8, v9
v_mfma_f32_16x16x32_f16 v[80:83], v[124:127], v[220:223], v[80:83]
v_exp_f16_sdwa v155, v155 dst_sel:WORD_1 dst_unused:UNUSED_PRESERVE src0_sel:WORD_1
v_mfma_f32_16x16x32_bf16 v[164:167], v[176:179], v[24:27], 0
v_exp_f16_sdwa v157, v157 dst_sel:WORD_1 dst_unused:UNUSED_PRESERVE src0_sel:WORD_1
v_mfma_f32_16x16x32_f16 v[136:139], v[124:127], v[216:219], v[136:139]
ds_read_b128 v[124:127], v251 offset:44032
v_cvt_pkrtz_f16_f32 v153, v152, v153
v_mfma_f32_16x16x32_bf16 v[172:175], v[176:179], v[28:31], 0
ds_read_b128 v[176:179], v249 offset:30720
v_and_b32_e64 v153, s49, v153
v_bfe_u32 v152, v153, 2, 14
v_lshrrev_b32 v153, 18, v153
ds_read_u16 v152, v152
s_waitcnt lgkmcnt(7)
ds_read_u16_d16_hi v153, v153
v_exp_f16_sdwa v159, v159 dst_sel:WORD_1 dst_unused:UNUSED_PRESERVE src0_sel:WORD_1
v_mfma_f32_16x16x32_f16 v[84:87], v[180:183], v[220:223], v[84:87]
v_pk_add_f16 v155, v155, 1.0 op_sel_hi:[1,0]
v_mfma_f32_16x16x32_bf16 v[164:167], v[184:187], v[32:35], v[164:167]
v_pk_add_f16 v157, v157, 1.0 op_sel_hi:[1,0]
v_mfma_f32_16x16x32_f16 v[140:143], v[180:183], v[216:219], v[140:143]
ds_read_b128 v[180:183], v251 offset:45056
v_pk_add_f16 v159, v159, 1.0 op_sel_hi:[1,0]
v_mfma_f32_16x16x32_bf16 v[172:175], v[184:187], v[36:39], v[172:175]
ds_read_b128 v[184:187], v249 offset:32768
v_rcp_f16_sdwa v155, v155 dst_sel:WORD_0 dst_unused:UNUSED_PRESERVE src0_sel:WORD_0
s_setprio 3
s_waitcnt lgkmcnt(7)
v_mfma_f32_16x16x32_f16 v[88:91], v[188:191], v[220:223], v[88:91]
v_rcp_f16_sdwa v157, v157 dst_sel:WORD_0 dst_unused:UNUSED_PRESERVE src0_sel:WORD_0
v_mfma_f32_16x16x32_bf16 v[164:167], v[120:123], v[40:43], v[164:167]
v_rcp_f16_sdwa v159, v159 dst_sel:WORD_0 dst_unused:UNUSED_PRESERVE src0_sel:WORD_0
v_mfma_f32_16x16x32_f16 v[240:243], v[188:191], v[216:219], v[240:243]
ds_read_b128 v[188:191], v251 offset:48128
v_rcp_f16_sdwa v155, v155 dst_sel:WORD_1 dst_unused:UNUSED_PRESERVE src0_sel:WORD_1
v_mfma_f32_16x16x32_bf16 v[172:175], v[120:123], v[44:47], v[172:175]
ds_read_b128 v[120:123], v249 offset:34816
v_rcp_f16_sdwa v157, v157 dst_sel:WORD_1 dst_unused:UNUSED_PRESERVE src0_sel:WORD_1
s_waitcnt lgkmcnt(5)
v_mfma_f32_16x16x32_f16 v[92:95], v[124:127], v[220:223], v[92:95]
s_waitcnt vmcnt(18)
v_permlane16_swap_b32 v48, v52
v_mfma_f32_16x16x32_f16 v[244:247], v[124:127], v[216:219], v[244:247]
ds_read_b128 v[124:127], v251 offset:46080
v_permlane16_swap_b32 v49, v53
v_mfma_f32_16x16x32_bf16 v[0:3], v[176:179], v[24:27], 0
v_permlane16_swap_b32 v50, v54
v_permlane16_swap_b32 v51, v55
s_waitcnt vmcnt(16)
v_permlane16_swap_b32 v56, v60
v_permlane16_swap_b32 v57, v61
v_permlane16_swap_b32 v58, v62
v_permlane16_swap_b32 v59, v63
s_waitcnt vmcnt(13)
v_permlane16_swap_b32 v64, v68
v_permlane16_swap_b32 v65, v69
v_permlane16_swap_b32 v66, v70
v_permlane16_swap_b32 v67, v71
v_rcp_f16_sdwa v159, v159 dst_sel:WORD_1 dst_unused:UNUSED_PRESERVE src0_sel:WORD_1
v_or_b32 v104, v144, v145
s_waitcnt lgkmcnt(2)
v_mfma_f32_16x16x32_f16 v[72:75], v[180:183], v[196:199], v[72:75]
v_pk_mul_f16 v109, v154, v155
v_mfma_f32_16x16x32_bf16 v[8:11], v[176:179], v[28:31], 0
ds_read_b128 v[176:179], v251 offset:49152
v_pk_mul_f16 v110, v156, v157
v_pk_mul_f16 v111, v158, v159
v_mfma_f32_16x16x32_f16 v[128:131], v[180:183], v[192:195], v[128:131]
ds_read_b128 v[180:183], v249 offset:30976
v_cvt_pkrtz_f16_f32 v161, v160, v161
v_and_b32_e64 v161, s49, v161
v_bfe_u32 v160, v161, 2, 14
v_lshrrev_b32_e64 v161, 18, v161
ds_read_u16 v160, v160
ds_read_u16_d16_hi v161, v161
v_cvt_pk_f16_f32 v170, v170, v171
v_or_b32_e64 v105, v146, v147
v_mfma_f32_16x16x32_bf16 v[0:3], v[184:187], v[32:35], v[0:3]
v_cvt_pk_f16_f32 v172, v172, v173
v_cvt_pk_f16_f32 v174, v174, v175
v_mfma_f32_16x16x32_f16 v[76:79], v[188:191], v[196:199], v[76:79]
v_pk_fma_f16 v171, v170, v170, s48
v_mfma_f32_16x16x32_bf16 v[8:11], v[184:187], v[36:39], v[8:11]
ds_read_b128 v[184:187], v251 offset:47104
v_pk_fma_f16 v173, v172, v172, s48
v_cvt_pkrtz_f16_f32 v163, v162, v163
v_and_b32_e64 v163, s49, v163
v_bfe_u32 v162, v163, 2, 14
v_lshrrev_b32_e64 v163, 18, v163
ds_read_u16 v162, v162
ds_read_u16_d16_hi v163, v163
s_setprio 2
v_or_b32 v106, v148, v149
v_pk_fma_f16 v175, v174, v174, s48
v_mfma_f32_16x16x32_f16 v[132:135], v[188:191], v[192:195], v[132:135]
ds_read_b128 v[188:191], v249 offset:33024
v_pk_mul_f16 v171, v170, v171
v_pk_mul_f16 v173, v172, v173
s_waitcnt lgkmcnt(6)
v_mfma_f32_16x16x32_bf16 v[0:3], v[120:123], v[40:43], v[0:3]
v_pk_mul_f16 v175, v174, v175
v_mfma_f32_16x16x32_f16 v[80:83], v[124:127], v[196:199], v[80:83]
v_cvt_pkrtz_f16_f32 v165, v164, v165
v_and_b32 v165, s49, v165
v_bfe_u32 v164, v165, 2, 14
v_lshrrev_b32_e64 v165, 18, v165
ds_read_u16 v164, v164
ds_read_u16_d16_hi v165, v165
v_or_b32_e64 v107, v150, v151
v_exp_f16_sdwa v171, v171 dst_sel:WORD_0 dst_unused:UNUSED_PRESERVE src0_sel:WORD_0
v_mfma_f32_16x16x32_bf16 v[8:11], v[120:123], v[44:47], v[8:11]
ds_read_b128 v[120:123], v251 offset:50176
v_exp_f16_sdwa v173, v173 dst_sel:WORD_0 dst_unused:UNUSED_PRESERVE src0_sel:WORD_0
v_mfma_f32_16x16x32_f16 v[136:139], v[124:127], v[192:195], v[136:139]
ds_read_b128 v[124:127], v249 offset:35072
v_cvt_pkrtz_f16_f32 v167, v166, v167
v_and_b32_e64 v167, s49, v167
v_bfe_u32 v166, v167, 2, 14
v_lshrrev_b32_e64 v167, 18, v167
ds_read_u16 v166, v166
ds_read_u16_d16_hi v167, v167
v_exp_f16_sdwa v175, v175 dst_sel:WORD_0 dst_unused:UNUSED_PRESERVE src0_sel:WORD_0
v_or_b32_e64 v108, v152, v153
v_mfma_f32_16x16x32_f16 v[84:87], v[176:179], v[196:199], v[84:87]
v_exp_f16_sdwa v171, v171 dst_sel:WORD_1 dst_unused:UNUSED_PRESERVE src0_sel:WORD_1
v_mfma_f32_16x16x32_bf16 v[4:7], v[180:183], v[24:27], 0
v_exp_f16_sdwa v173, v173 dst_sel:WORD_1 dst_unused:UNUSED_PRESERVE src0_sel:WORD_1
v_mfma_f32_16x16x32_f16 v[140:143], v[176:179], v[192:195], v[140:143]
ds_read_b128 v[176:179], v251 offset:51200
v_cvt_pkrtz_f16_f32 v169, v168, v169
v_mfma_f32_16x16x32_bf16 v[12:15], v[180:183], v[28:31], 0
ds_read_b128 v[180:183], v248
v_and_b32_e64 v169, s49, v169
v_bfe_u32 v168, v169, 2, 14
v_lshrrev_b32 v169, 18, v169
ds_read_u16 v168, v168
s_waitcnt lgkmcnt(7)
ds_read_u16_d16_hi v169, v169
v_mfma_f32_16x16x32_f16 v[88:91], v[184:187], v[196:199], v[88:91]
v_exp_f16_sdwa v175, v175 dst_sel:WORD_1 dst_unused:UNUSED_PRESERVE src0_sel:WORD_1
v_mfma_f32_16x16x32_bf16 v[4:7], v[188:191], v[32:35], v[4:7]
v_pk_add_f16 v171, v171, 1.0 op_sel_hi:[1,0]
v_mfma_f32_16x16x32_f16 v[240:243], v[184:187], v[192:195], v[240:243]
ds_read_b128 v[184:187], v251 offset:54272
v_pk_add_f16 v173, v173, 1.0 op_sel_hi:[1,0]
v_pk_add_f16 v175, v175, 1.0 op_sel_hi:[1,0]
v_mfma_f32_16x16x32_bf16 v[12:15], v[188:191], v[36:39], v[12:15]
ds_read_b128 v[188:191], v248 offset:2048
s_setprio 1
v_rcp_f16_sdwa v171, v171 dst_sel:WORD_0 dst_unused:UNUSED_PRESERVE src0_sel:WORD_0
s_waitcnt lgkmcnt(7)
v_mfma_f32_16x16x32_f16 v[92:95], v[120:123], v[196:199], v[92:95]
v_rcp_f16_sdwa v173, v173 dst_sel:WORD_0 dst_unused:UNUSED_PRESERVE src0_sel:WORD_0
v_mfma_f32_16x16x32_bf16 v[4:7], v[124:127], v[40:43], v[4:7]
v_rcp_f16_sdwa v175, v175 dst_sel:WORD_0 dst_unused:UNUSED_PRESERVE src0_sel:WORD_0
v_mfma_f32_16x16x32_f16 v[244:247], v[120:123], v[192:195], v[244:247]
ds_read_b128 v[120:123], v251 offset:52224
v_rcp_f16_sdwa v171, v171 dst_sel:WORD_1 dst_unused:UNUSED_PRESERVE src0_sel:WORD_1
v_mfma_f32_16x16x32_bf16 v[12:15], v[124:127], v[44:47], v[12:15]
ds_read_b128 v[124:127], v248 offset:4096
v_rcp_f16_sdwa v173, v173 dst_sel:WORD_1 dst_unused:UNUSED_PRESERVE src0_sel:WORD_1
s_waitcnt lgkmcnt(5)
v_mfma_f32_16x16x32_f16 v[72:75], v[176:179], v[116:119], v[72:75]
v_rcp_f16_sdwa v175, v175 dst_sel:WORD_1 dst_unused:UNUSED_PRESERVE src0_sel:WORD_1
v_mfma_f32_16x16x32_f16 v[128:131], v[176:179], v[112:115], v[128:131]
ds_read_b128 v[176:179], v251 offset:55296
v_or_b32_e64 v200, v160, v161
v_mfma_f32_16x16x32_bf16 v[144:147], v[180:183], v[48:51], 0
v_pk_mul_f16 v205, v170, v171
s_waitcnt lgkmcnt(4)
v_mfma_f32_16x16x32_f16 v[76:79], v[184:187], v[116:119], v[76:79]
v_pk_mul_f16 v206, v172, v173
v_mfma_f32_16x16x32_bf16 v[152:155], v[180:183], v[52:55], 0
ds_read_b128 v[180:183], v251 offset:53248
v_pk_mul_f16 v207, v174, v175
v_mfma_f32_16x16x32_f16 v[132:135], v[184:187], v[112:115], v[132:135]
ds_read_b128 v[184:187], v248 offset:256
v_cvt_pkrtz_f16_f32 v1, v0, v1
v_and_b32_e64 v1, s49, v1
v_bfe_u32 v0, v1, 2, 14
v_lshrrev_b32_e64 v1, 18, v1
ds_read_u16 v0, v0
ds_read_u16_d16_hi v1, v1
v_cvt_pk_f16_f32 v10, v10, v11
v_or_b32 v201, v162, v163
s_waitcnt lgkmcnt(5)
v_mfma_f32_16x16x32_bf16 v[144:147], v[188:191], v[56:59], v[144:147]
v_cvt_pk_f16_f32 v12, v12, v13
v_cvt_pk_f16_f32 v14, v14, v15
v_mfma_f32_16x16x32_f16 v[80:83], v[120:123], v[116:119], v[80:83]
v_pk_fma_f16 v11, v10, v10, s48
v_mfma_f32_16x16x32_bf16 v[152:155], v[188:191], v[60:63], v[152:155]
ds_read_b128 v[188:191], v251 offset:56320
v_pk_fma_f16 v13, v12, v12, s48
s_setprio 0
v_cvt_pkrtz_f16_f32 v3, v2, v3
v_and_b32 v3, s49, v3
v_bfe_u32 v2, v3, 2, 14
v_lshrrev_b32_e64 v3, 18, v3
ds_read_u16 v2, v2
ds_read_u16_d16_hi v3, v3
v_or_b32_e64 v202, v164, v165
v_mfma_f32_16x16x32_f16 v[136:139], v[120:123], v[112:115], v[136:139]
ds_read_b128 v[120:123], v248 offset:2304
v_pk_fma_f16 v15, v14, v14, s48
v_pk_mul_f16 v11, v10, v11
v_pk_mul_f16 v13, v12, v13
v_mfma_f32_16x16x32_bf16 v[144:147], v[124:127], v[64:67], v[144:147]
v_pk_mul_f16 v15, v14, v15
s_waitcnt lgkmcnt(6)
v_mfma_f32_16x16x32_f16 v[84:87], v[176:179], v[116:119], v[84:87]
v_cvt_pkrtz_f16_f32 v5, v4, v5
v_and_b32 v5, s49, v5
v_bfe_u32 v4, v5, 2, 14
v_lshrrev_b32_e64 v5, 18, v5
ds_read_u16 v4, v4
ds_read_u16_d16_hi v5, v5
v_or_b32_e64 v203, v166, v167
v_exp_f16_sdwa v11, v11 dst_sel:WORD_0 dst_unused:UNUSED_PRESERVE src0_sel:WORD_0
v_mfma_f32_16x16x32_bf16 v[152:155], v[124:127], v[68:71], v[152:155]
ds_read_b128 v[124:127], v251 offset:57344
v_exp_f16_sdwa v13, v13 dst_sel:WORD_0 dst_unused:UNUSED_PRESERVE src0_sel:WORD_0
v_mfma_f32_16x16x32_f16 v[140:143], v[176:179], v[112:115], v[140:143]
ds_read_b128 v[176:179], v248 offset:4352
v_cvt_pkrtz_f16_f32 v7, v6, v7
v_and_b32_e64 v7, s49, v7
v_bfe_u32 v6, v7, 2, 14
v_lshrrev_b32_e64 v7, 18, v7
ds_read_u16 v6, v6
ds_read_u16_d16_hi v7, v7
v_exp_f16_sdwa v15, v15 dst_sel:WORD_0 dst_unused:UNUSED_PRESERVE src0_sel:WORD_0
v_or_b32_e64 v204, v168, v169
v_mfma_f32_16x16x32_f16 v[88:91], v[180:183], v[116:119], v[88:91]
v_exp_f16_sdwa v11, v11 dst_sel:WORD_1 dst_unused:UNUSED_PRESERVE src0_sel:WORD_1
v_mfma_f32_16x16x32_bf16 v[148:151], v[184:187], v[48:51], 0
v_exp_f16_sdwa v13, v13 dst_sel:WORD_1 dst_unused:UNUSED_PRESERVE src0_sel:WORD_1
v_mfma_f32_16x16x32_f16 v[240:243], v[180:183], v[112:115], v[240:243]
ds_read_b128 v[180:183], v251 offset:60416
v_cvt_pkrtz_f16_f32 v9, v8, v9
v_mfma_f32_16x16x32_bf16 v[156:159], v[184:187], v[52:55], 0
ds_read_b128 v[184:187], v248 offset:6144
v_and_b32_e64 v9, s49, v9
v_bfe_u32 v8, v9, 2, 14
v_lshrrev_b32 v9, 18, v9
ds_read_u16 v8, v8
s_waitcnt lgkmcnt(7)
ds_read_u16_d16_hi v9, v9
v_mfma_f32_16x16x32_f16 v[92:95], v[188:191], v[116:119], v[92:95]
v_exp_f16_sdwa v15, v15 dst_sel:WORD_1 dst_unused:UNUSED_PRESERVE src0_sel:WORD_1
v_mfma_f32_16x16x32_bf16 v[148:151], v[120:123], v[56:59], v[148:151]
v_pk_add_f16 v11, v11, 1.0 op_sel_hi:[1,0]
v_mfma_f32_16x16x32_f16 v[244:247], v[188:191], v[112:115], v[244:247]
ds_read_b128 v[188:191], v251 offset:58368
v_pk_add_f16 v13, v13, 1.0 op_sel_hi:[1,0]
v_pk_add_f16 v15, v15, 1.0 op_sel_hi:[1,0]
s_setprio 3
v_mfma_f32_16x16x32_bf16 v[156:159], v[120:123], v[60:63], v[156:159]
ds_read_b128 v[120:123], v248 offset:8192
v_rcp_f16_sdwa v11, v11 dst_sel:WORD_0 dst_unused:UNUSED_PRESERVE src0_sel:WORD_0
s_waitcnt lgkmcnt(7)
v_mfma_f32_16x16x32_f16 v[72:75], v[124:127], v[228:231], v[72:75]
v_rcp_f16_sdwa v13, v13 dst_sel:WORD_0 dst_unused:UNUSED_PRESERVE src0_sel:WORD_0
v_mfma_f32_16x16x32_bf16 v[148:151], v[176:179], v[64:67], v[148:151]
v_rcp_f16_sdwa v15, v15 dst_sel:WORD_0 dst_unused:UNUSED_PRESERVE src0_sel:WORD_0
v_mfma_f32_16x16x32_f16 v[128:131], v[124:127], v[224:227], v[128:131]
ds_read_b128 v[124:127], v251 offset:61440
v_rcp_f16_sdwa v11, v11 dst_sel:WORD_1 dst_unused:UNUSED_PRESERVE src0_sel:WORD_1
v_mfma_f32_16x16x32_bf16 v[156:159], v[176:179], v[68:71], v[156:159]
ds_read_b128 v[176:179], v248 offset:10240
v_rcp_f16_sdwa v13, v13 dst_sel:WORD_1 dst_unused:UNUSED_PRESERVE src0_sel:WORD_1
s_waitcnt lgkmcnt(5)
v_mfma_f32_16x16x32_f16 v[76:79], v[180:183], v[228:231], v[76:79]
v_rcp_f16_sdwa v15, v15 dst_sel:WORD_1 dst_unused:UNUSED_PRESERVE src0_sel:WORD_1
v_mfma_f32_16x16x32_f16 v[132:135], v[180:183], v[224:227], v[132:135]
ds_read_b128 v[180:183], v251 offset:59392
v_or_b32_e64 v216, v0, v1
v_mfma_f32_16x16x32_bf16 v[160:163], v[184:187], v[48:51], 0
v_pk_mul_f16 v221, v10, v11
s_waitcnt lgkmcnt(4)
v_mfma_f32_16x16x32_f16 v[80:83], v[188:191], v[228:231], v[80:83]
v_pk_mul_f16 v222, v12, v13
v_mfma_f32_16x16x32_bf16 v[168:171], v[184:187], v[52:55], 0
ds_read_b128 v[184:187], v251 offset:62464
v_pk_mul_f16 v223, v14, v15
v_mfma_f32_16x16x32_f16 v[136:139], v[188:191], v[224:227], v[136:139]
ds_read_b128 v[188:191], v248 offset:6400
v_cvt_pkrtz_f16_f32 v145, v144, v145
v_and_b32_e64 v145, s49, v145
v_bfe_u32 v144, v145, 2, 14
v_lshrrev_b32_e64 v145, 18, v145
ds_read_u16 v144, v144
ds_read_u16_d16_hi v145, v145
v_cvt_pk_f16_f32 v154, v154, v155
v_or_b32 v217, v2, v3
s_waitcnt lgkmcnt(5)
v_mfma_f32_16x16x32_bf16 v[160:163], v[120:123], v[56:59], v[160:163]
v_cvt_pk_f16_f32 v156, v156, v157
v_cvt_pk_f16_f32 v158, v158, v159
v_mfma_f32_16x16x32_f16 v[84:87], v[124:127], v[228:231], v[84:87]
v_pk_fma_f16 v155, v154, v154, s48
s_setprio 2
v_mfma_f32_16x16x32_bf16 v[168:171], v[120:123], v[60:63], v[168:171]
ds_read_b128 v[120:123], v251 offset:63488
v_pk_fma_f16 v157, v156, v156, s48
v_cvt_pkrtz_f16_f32 v147, v146, v147
v_and_b32 v147, s49, v147
v_bfe_u32 v146, v147, 2, 14
v_lshrrev_b32_e64 v147, 18, v147
ds_read_u16 v146, v146
ds_read_u16_d16_hi v147, v147
v_or_b32_e64 v218, v4, v5
v_mfma_f32_16x16x32_f16 v[140:143], v[124:127], v[224:227], v[140:143]
ds_read_b128 v[124:127], v248 offset:8448
v_pk_fma_f16 v159, v158, v158, s48
v_pk_mul_f16 v155, v154, v155
v_pk_mul_f16 v157, v156, v157
v_mfma_f32_16x16x32_bf16 v[160:163], v[176:179], v[64:67], v[160:163]
v_pk_mul_f16 v159, v158, v159
s_waitcnt lgkmcnt(6)
v_mfma_f32_16x16x32_f16 v[88:91], v[180:183], v[228:231], v[88:91]
v_cvt_pkrtz_f16_f32 v149, v148, v149
v_and_b32 v149, s49, v149
v_bfe_u32 v148, v149, 2, 14
v_lshrrev_b32_e64 v149, 18, v149
ds_read_u16 v148, v148
ds_read_u16_d16_hi v149, v149
v_or_b32_e64 v219, v6, v7
v_exp_f16_sdwa v155, v155 dst_sel:WORD_0 dst_unused:UNUSED_PRESERVE src0_sel:WORD_0
v_mfma_f32_16x16x32_f16 v[240:243], v[180:183], v[224:227], v[240:243]
ds_read_b128 v[180:183], v248 offset:10496
v_exp_f16_sdwa v157, v157 dst_sel:WORD_0 dst_unused:UNUSED_PRESERVE src0_sel:WORD_0
v_mfma_f32_16x16x32_bf16 v[168:171], v[176:179], v[68:71], v[168:171]
ds_read_b128 v[176:179], v252 offset:1024
v_cvt_pkrtz_f16_f32 v151, v150, v151
v_and_b32_e64 v151, s49, v151
v_bfe_u32 v150, v151, 2, 14
v_lshrrev_b32_e64 v151, 18, v151
ds_read_u16 v150, v150
ds_read_u16_d16_hi v151, v151
v_exp_f16_sdwa v159, v159 dst_sel:WORD_0 dst_unused:UNUSED_PRESERVE src0_sel:WORD_0
v_mfma_f32_16x16x32_f16 v[92:95], v[184:187], v[228:231], v[92:95]
v_or_b32_e64 v220, v8, v9
v_mfma_f32_16x16x32_bf16 v[164:167], v[188:191], v[48:51], 0
v_exp_f16_sdwa v155, v155 dst_sel:WORD_1 dst_unused:UNUSED_PRESERVE src0_sel:WORD_1
v_mfma_f32_16x16x32_f16 v[244:247], v[184:187], v[224:227], v[244:247]
ds_read_b128 v[184:187], v251 offset:64512
v_exp_f16_sdwa v157, v157 dst_sel:WORD_1 dst_unused:UNUSED_PRESERVE src0_sel:WORD_1
v_mfma_f32_16x16x32_bf16 v[172:175], v[188:191], v[52:55], 0
ds_read_b128 v[188:191], v248 offset:12288
v_cvt_pkrtz_f16_f32 v153, v152, v153
v_and_b32_e64 v153, s49, v153
v_bfe_u32 v152, v153, 2, 14
v_lshrrev_b32 v153, 18, v153
ds_read_u16 v152, v152
s_waitcnt lgkmcnt(7)
ds_read_u16_d16_hi v153, v153
v_mfma_f32_16x16x32_f16 v[72:75], v[120:123], v[108:111], v[72:75]
v_exp_f16_sdwa v159, v159 dst_sel:WORD_1 dst_unused:UNUSED_PRESERVE src0_sel:WORD_1
v_mfma_f32_16x16x32_bf16 v[164:167], v[124:127], v[56:59], v[164:167]
v_pk_add_f16 v155, v155, 1.0 op_sel_hi:[1,0]
v_mfma_f32_16x16x32_f16 v[128:131], v[120:123], v[104:107], v[128:131]
ds_read_b128 v[120:123], v252 offset:2048
v_pk_add_f16 v157, v157, 1.0 op_sel_hi:[1,0]
s_setprio 1
v_pk_add_f16 v159, v159, 1.0 op_sel_hi:[1,0]
v_mfma_f32_16x16x32_bf16 v[172:175], v[124:127], v[60:63], v[172:175]
ds_read_b128 v[124:127], v248 offset:14336
v_rcp_f16_sdwa v155, v155 dst_sel:WORD_0 dst_unused:UNUSED_PRESERVE src0_sel:WORD_0
s_waitcnt lgkmcnt(7)
v_mfma_f32_16x16x32_f16 v[76:79], v[176:179], v[108:111], v[76:79]
v_rcp_f16_sdwa v157, v157 dst_sel:WORD_0 dst_unused:UNUSED_PRESERVE src0_sel:WORD_0
v_mfma_f32_16x16x32_bf16 v[164:167], v[180:183], v[64:67], v[164:167]
v_rcp_f16_sdwa v159, v159 dst_sel:WORD_0 dst_unused:UNUSED_PRESERVE src0_sel:WORD_0
v_mfma_f32_16x16x32_f16 v[132:135], v[176:179], v[104:107], v[132:135]
ds_read_b128 v[176:179], v252
v_rcp_f16_sdwa v155, v155 dst_sel:WORD_1 dst_unused:UNUSED_PRESERVE src0_sel:WORD_1
s_waitcnt lgkmcnt(5)
v_mfma_f32_16x16x32_f16 v[80:83], v[184:187], v[108:111], v[80:83]
v_rcp_f16_sdwa v157, v157 dst_sel:WORD_1 dst_unused:UNUSED_PRESERVE src0_sel:WORD_1
v_mfma_f32_16x16x32_bf16 v[172:175], v[180:183], v[68:71], v[172:175]
ds_read_b128 v[180:183], v248 offset:16384
v_mov_b32 v16, 0
v_mov_b32_e64 v17, 0
v_cndmask_b32 v18, 0, v255, s[88:89]
v_cndmask_b32 v19, 0, v255, s[90:91]
v_mov_b32 v20, 0
v_mov_b32 v21, 0
v_mfma_f32_16x16x32_f16 v[136:139], v[184:187], v[104:107], v[136:139]
ds_read_b128 v[184:187], v252 offset:3072
v_rcp_f16_sdwa v159, v159 dst_sel:WORD_1 dst_unused:UNUSED_PRESERVE src0_sel:WORD_1
v_mfma_f32_16x16x32_bf16 v[0:3], v[188:191], v[48:51], 0
v_or_b32 v192, v144, v145
s_waitcnt lgkmcnt(3)
v_mfma_f32_16x16x32_f16 v[84:87], v[120:123], v[108:111], v[84:87]
v_pk_mul_f16 v197, v154, v155
v_mfma_f32_16x16x32_bf16 v[8:11], v[188:191], v[52:55], 0
ds_read_b128 v[188:191], v252 offset:4096
v_pk_mul_f16 v198, v156, v157
v_pk_mul_f16 v199, v158, v159
v_mfma_f32_16x16x32_f16 v[140:143], v[120:123], v[104:107], v[140:143]
ds_read_b128 v[120:123], v248 offset:12544
v_cvt_pkrtz_f16_f32 v161, v160, v161
v_and_b32_e64 v161, s49, v161
v_bfe_u32 v160, v161, 2, 14
v_lshrrev_b32_e64 v161, 18, v161
ds_read_u16 v160, v160
ds_read_u16_d16_hi v161, v161
v_cvt_pk_f16_f32 v170, v170, v171
v_or_b32_e64 v193, v146, v147
v_mfma_f32_16x16x32_bf16 v[0:3], v[124:127], v[56:59], v[0:3]
v_cvt_pk_f16_f32 v172, v172, v173
s_waitcnt lgkmcnt(5)
v_mfma_f32_16x16x32_f16 v[88:91], v[176:179], v[108:111], v[88:91]
v_cvt_pk_f16_f32 v174, v174, v175
v_pk_fma_f16 v171, v170, v170, s48
s_setprio 0
v_mfma_f32_16x16x32_bf16 v[8:11], v[124:127], v[60:63], v[8:11]
ds_read_b128 v[124:127], v252 offset:7168
v_pk_fma_f16 v173, v172, v172, s48
v_cvt_pkrtz_f16_f32 v163, v162, v163
v_and_b32_e64 v163, s49, v163
v_bfe_u32 v162, v163, 2, 14
v_lshrrev_b32_e64 v163, 18, v163
ds_read_u16 v162, v162
ds_read_u16_d16_hi v163, v163
v_or_b32_e64 v194, v148, v149
v_mfma_f32_16x16x32_f16 v[240:243], v[176:179], v[104:107], v[240:243]
ds_read_b128 v[176:179], v248 offset:14592
v_pk_fma_f16 v175, v174, v174, s48
v_pk_mul_f16 v171, v170, v171
v_pk_mul_f16 v173, v172, v173
v_mfma_f32_16x16x32_bf16 v[0:3], v[180:183], v[64:67], v[0:3]
v_pk_mul_f16 v175, v174, v175
s_waitcnt lgkmcnt(6)
v_mfma_f32_16x16x32_f16 v[92:95], v[184:187], v[108:111], v[92:95]
v_cvt_pkrtz_f16_f32 v165, v164, v165
v_and_b32 v165, s49, v165
v_bfe_u32 v164, v165, 2, 14
v_lshrrev_b32_e64 v165, 18, v165
ds_read_u16 v164, v164
ds_read_u16_d16_hi v165, v165
v_or_b32_e64 v195, v150, v151
v_exp_f16_sdwa v171, v171 dst_sel:WORD_0 dst_unused:UNUSED_PRESERVE src0_sel:WORD_0
v_mfma_f32_16x16x32_f16 v[244:247], v[184:187], v[104:107], v[244:247]
ds_read_b128 v[184:187], v248 offset:16640
v_exp_f16_sdwa v173, v173 dst_sel:WORD_0 dst_unused:UNUSED_PRESERVE src0_sel:WORD_0
v_mfma_f32_16x16x32_bf16 v[8:11], v[180:183], v[68:71], v[8:11]
ds_read_b128 v[180:183], v252 offset:5120
v_cvt_pkrtz_f16_f32 v167, v166, v167
s_waitcnt vmcnt(8)
v_mfma_f32_16x16x32_bf16 v[128:131], v[18:21], v[232:235], v[128:131]
v_and_b32 v167, s49, v167
v_mfma_f32_16x16x32_bf16 v[132:135], v[16:19], v[232:235], v[132:135]
v_bfe_u32 v166, v167, 2, 14
s_waitcnt vmcnt(7)
v_mfma_f32_16x16x32_bf16 v[136:139], v[18:21], v[236:239], v[136:139]
v_lshrrev_b32 v167, 18, v167
v_mfma_f32_16x16x32_bf16 v[140:143], v[16:19], v[236:239], v[140:143]
ds_read_u16 v166, v166
ds_read_u16_d16_hi v167, v167
v_exp_f16_sdwa v175, v175 dst_sel:WORD_0 dst_unused:UNUSED_PRESERVE src0_sel:WORD_0
v_mfma_f32_16x16x32_f16 v[72:75], v[188:191], v[204:207], v[72:75]
v_or_b32_e64 v196, v152, v153
v_mfma_f32_16x16x32_bf16 v[4:7], v[120:123], v[48:51], 0
v_exp_f16_sdwa v171, v171 dst_sel:WORD_1 dst_unused:UNUSED_PRESERVE src0_sel:WORD_1
v_mfma_f32_16x16x32_f16 v[128:131], v[188:191], v[200:203], v[128:131]
ds_read_b128 v[188:191], v252 offset:8192
v_exp_f16_sdwa v173, v173 dst_sel:WORD_1 dst_unused:UNUSED_PRESERVE src0_sel:WORD_1
v_mfma_f32_16x16x32_bf16 v[12:15], v[120:123], v[52:55], 0
ds_read_b128 v[120:123], v248 offset:18432
v_cvt_pkrtz_f16_f32 v169, v168, v169
v_and_b32_e64 v169, s49, v169
v_bfe_u32 v168, v169, 2, 14
v_lshrrev_b32 v169, 18, v169
ds_read_u16 v168, v168
s_waitcnt lgkmcnt(5)
ds_read_u16_d16_hi v169, v169
v_mfma_f32_16x16x32_f16 v[76:79], v[124:127], v[204:207], v[76:79]
v_exp_f16_sdwa v175, v175 dst_sel:WORD_1 dst_unused:UNUSED_PRESERVE src0_sel:WORD_1
v_mfma_f32_16x16x32_bf16 v[4:7], v[176:179], v[56:59], v[4:7]
v_pk_add_f16 v171, v171, 1.0 op_sel_hi:[1,0]
v_mfma_f32_16x16x32_f16 v[132:135], v[124:127], v[200:203], v[132:135]
ds_read_b128 v[124:127], v252 offset:6144
v_pk_add_f16 v173, v173, 1.0 op_sel_hi:[1,0]
s_setprio 3
v_pk_add_f16 v175, v175, 1.0 op_sel_hi:[1,0]
v_mfma_f32_16x16x32_bf16 v[12:15], v[176:179], v[60:63], v[12:15]
ds_read_b128 v[176:179], v248 offset:20480
v_rcp_f16_sdwa v171, v171 dst_sel:WORD_0 dst_unused:UNUSED_PRESERVE src0_sel:WORD_0
v_mfma_f32_16x16x32_f16 v[80:83], v[180:183], v[204:207], v[80:83]
v_rcp_f16_sdwa v173, v173 dst_sel:WORD_0 dst_unused:UNUSED_PRESERVE src0_sel:WORD_0
v_mfma_f32_16x16x32_bf16 v[4:7], v[184:187], v[64:67], v[4:7]
v_rcp_f16_sdwa v175, v175 dst_sel:WORD_0 dst_unused:UNUSED_PRESERVE src0_sel:WORD_0
v_mfma_f32_16x16x32_f16 v[136:139], v[180:183], v[200:203], v[136:139]
ds_read_b128 v[180:183], v252 offset:9216
v_rcp_f16_sdwa v171, v171 dst_sel:WORD_1 dst_unused:UNUSED_PRESERVE src0_sel:WORD_1
s_waitcnt lgkmcnt(4)
v_mfma_f32_16x16x32_f16 v[84:87], v[188:191], v[204:207], v[84:87]
v_rcp_f16_sdwa v173, v173 dst_sel:WORD_1 dst_unused:UNUSED_PRESERVE src0_sel:WORD_1
v_mfma_f32_16x16x32_bf16 v[12:15], v[184:187], v[68:71], v[12:15]
ds_read_b128 v[184:187], v248 offset:22528
v_rcp_f16_sdwa v175, v175 dst_sel:WORD_1 dst_unused:UNUSED_PRESERVE src0_sel:WORD_1
v_mfma_f32_16x16x32_f16 v[140:143], v[188:191], v[200:203], v[140:143]
ds_read_b128 v[188:191], v252 offset:10240
v_or_b32 v24, v160, v161
v_mfma_f32_16x16x32_bf16 v[144:147], v[120:123], v[48:51], 0
v_pk_mul_f16 v29, v170, v171
s_waitcnt lgkmcnt(3)
v_mfma_f32_16x16x32_f16 v[88:91], v[124:127], v[204:207], v[88:91]
v_pk_mul_f16 v30, v172, v173
v_mfma_f32_16x16x32_bf16 v[152:155], v[120:123], v[52:55], 0
ds_read_b128 v[120:123], v252 offset:13312
v_pk_mul_f16 v31, v174, v175
v_mfma_f32_16x16x32_f16 v[240:243], v[124:127], v[200:203], v[240:243]
ds_read_b128 v[124:127], v248 offset:18688
v_cvt_pkrtz_f16_f32 v1, v0, v1
v_and_b32_e64 v1, s49, v1
v_bfe_u32 v0, v1, 2, 14
v_lshrrev_b32_e64 v1, 18, v1
ds_read_u16 v0, v0
ds_read_u16_d16_hi v1, v1
v_cvt_pk_f16_f32 v10, v10, v11
v_or_b32_e64 v25, v162, v163
v_mfma_f32_16x16x32_bf16 v[144:147], v[176:179], v[56:59], v[144:147]
v_cvt_pk_f16_f32 v12, v12, v13
s_waitcnt lgkmcnt(5)
v_mfma_f32_16x16x32_f16 v[92:95], v[180:183], v[204:207], v[92:95]
v_cvt_pk_f16_f32 v14, v14, v15
s_setprio 2
v_pk_fma_f16 v11, v10, v10, s48
v_mfma_f32_16x16x32_bf16 v[152:155], v[176:179], v[60:63], v[152:155]
ds_read_b128 v[176:179], v252 offset:11264
v_pk_fma_f16 v13, v12, v12, s48
v_cvt_pkrtz_f16_f32 v3, v2, v3
v_and_b32_e64 v3, s49, v3
v_bfe_u32 v2, v3, 2, 14
v_lshrrev_b32_e64 v3, 18, v3
ds_read_u16 v2, v2
ds_read_u16_d16_hi v3, v3
v_mfma_f32_16x16x32_f16 v[244:247], v[180:183], v[200:203], v[244:247]
ds_read_b128 v[180:183], v248 offset:20736
v_or_b32_e64 v26, v164, v165
v_pk_fma_f16 v15, v14, v14, s48
v_pk_mul_f16 v11, v10, v11
s_waitcnt vmcnt(4)
v_mfma_f32_16x16x32_bf16 v[240:243], v[18:21], v[208:211], v[240:243]
v_pk_mul_f16 v13, v12, v13
v_mfma_f32_16x16x32_bf16 v[244:247], v[16:19], v[208:211], v[244:247]
v_pk_mul_f16 v15, v14, v15
s_waitcnt vmcnt(3)
v_mfma_f32_16x16x32_bf16 v[72:75], v[18:21], v[212:215], v[72:75]
v_cvt_pkrtz_f16_f32 v5, v4, v5
v_mfma_f32_16x16x32_bf16 v[76:79], v[16:19], v[212:215], v[76:79]
v_and_b32_e64 v5, s49, v5
v_mfma_f32_16x16x32_bf16 v[144:147], v[184:187], v[64:67], v[144:147]
v_bfe_u32 v4, v5, 2, 14
s_waitcnt lgkmcnt(4)
v_mfma_f32_16x16x32_f16 v[72:75], v[188:191], v[220:223], v[72:75]
v_lshrrev_b32 v5, 18, v5
ds_read_u16 v4, v4
ds_read_u16_d16_hi v5, v5
v_or_b32_e64 v27, v166, v167
v_exp_f16_sdwa v11, v11 dst_sel:WORD_0 dst_unused:UNUSED_PRESERVE src0_sel:WORD_0
v_mfma_f32_16x16x32_f16 v[128:131], v[188:191], v[216:219], v[128:131]
ds_read_b128 v[188:191], v248 offset:22784
v_exp_f16_sdwa v13, v13 dst_sel:WORD_0 dst_unused:UNUSED_PRESERVE src0_sel:WORD_0
v_mfma_f32_16x16x32_bf16 v[152:155], v[184:187], v[68:71], v[152:155]
ds_read_b128 v[184:187], v252 offset:14336
v_cvt_pkrtz_f16_f32 v7, v6, v7
v_and_b32_e64 v7, s49, v7
v_bfe_u32 v6, v7, 2, 14
v_lshrrev_b32_e64 v7, 18, v7
ds_read_u16 v6, v6
ds_read_u16_d16_hi v7, v7
v_mfma_f32_16x16x32_f16 v[76:79], v[120:123], v[220:223], v[76:79]
v_exp_f16_sdwa v15, v15 dst_sel:WORD_0 dst_unused:UNUSED_PRESERVE src0_sel:WORD_0
v_or_b32_e64 v28, v168, v169
v_mfma_f32_16x16x32_bf16 v[148:151], v[124:127], v[48:51], 0
v_exp_f16_sdwa v11, v11 dst_sel:WORD_1 dst_unused:UNUSED_PRESERVE src0_sel:WORD_1
v_mfma_f32_16x16x32_f16 v[132:135], v[120:123], v[216:219], v[132:135]
ds_read_b128 v[120:123], v252 offset:12288
v_exp_f16_sdwa v13, v13 dst_sel:WORD_1 dst_unused:UNUSED_PRESERVE src0_sel:WORD_1
v_mfma_f32_16x16x32_bf16 v[156:159], v[124:127], v[52:55], 0
ds_read_b128 v[124:127], v248 offset:24576
v_cvt_pkrtz_f16_f32 v9, v8, v9
v_and_b32_e64 v9, s49, v9
v_bfe_u32 v8, v9, 2, 14
v_lshrrev_b32 v9, 18, v9
ds_read_u16 v8, v8
ds_read_u16_d16_hi v9, v9
s_waitcnt lgkmcnt(8)
v_mfma_f32_16x16x32_f16 v[80:83], v[176:179], v[220:223], v[80:83]
v_exp_f16_sdwa v15, v15 dst_sel:WORD_1 dst_unused:UNUSED_PRESERVE src0_sel:WORD_1
v_mfma_f32_16x16x32_bf16 v[148:151], v[180:183], v[56:59], v[148:151]
v_pk_add_f16 v11, v11, 1.0 op_sel_hi:[1,0]
v_mfma_f32_16x16x32_f16 v[136:139], v[176:179], v[216:219], v[136:139]
ds_read_b128 v[176:179], v252 offset:15360
v_pk_add_f16 v13, v13, 1.0 op_sel_hi:[1,0]
s_setprio 1
v_pk_add_f16 v15, v15, 1.0 op_sel_hi:[1,0]
v_mfma_f32_16x16x32_bf16 v[156:159], v[180:183], v[60:63], v[156:159]
ds_read_b128 v[180:183], v248 offset:26624
v_rcp_f16_sdwa v11, v11 dst_sel:WORD_0 dst_unused:UNUSED_PRESERVE src0_sel:WORD_0
s_waitcnt lgkmcnt(7)
v_mfma_f32_16x16x32_f16 v[84:87], v[184:187], v[220:223], v[84:87]
v_rcp_f16_sdwa v13, v13 dst_sel:WORD_0 dst_unused:UNUSED_PRESERVE src0_sel:WORD_0
v_mfma_f32_16x16x32_bf16 v[148:151], v[188:191], v[64:67], v[148:151]
v_rcp_f16_sdwa v15, v15 dst_sel:WORD_0 dst_unused:UNUSED_PRESERVE src0_sel:WORD_0
v_mfma_f32_16x16x32_f16 v[140:143], v[184:187], v[216:219], v[140:143]
ds_read_b128 v[184:187], v251 offset:8192
v_cvt_pk_bf16_f32 v40, v128, v129
v_cvt_pk_bf16_f32 v41, v130, v131
v_cvt_pk_bf16_f32 v42, v132, v133
v_cvt_pk_bf16_f32 v43, v134, v135
v_cvt_pk_bf16_f32 v116, v72, v73
v_cvt_pk_bf16_f32 v117, v74, v75
v_cvt_pk_bf16_f32 v118, v76, v77
v_cvt_pk_bf16_f32 v119, v78, v79
ds_read_b128 v[128:131], v254 offset:8192
ds_read_b128 v[132:135], v254 offset:8208
s_waitcnt lgkmcnt(6)
v_mfma_f32_16x16x32_f16 v[88:91], v[120:123], v[220:223], v[88:91]
v_rcp_f16_sdwa v11, v11 dst_sel:WORD_1 dst_unused:UNUSED_PRESERVE src0_sel:WORD_1
v_mfma_f32_16x16x32_bf16 v[156:159], v[188:191], v[68:71], v[156:159]
ds_read_b128 v[188:191], v248 offset:28672
v_cvt_pk_bf16_f32 v44, v136, v137
v_cvt_pk_bf16_f32 v45, v138, v139
v_cvt_pk_bf16_f32 v46, v140, v141
v_cvt_pk_bf16_f32 v47, v142, v143
ds_read_b128 v[136:139], v254 offset:8320
ds_read_b128 v[140:143], v254 offset:8336
v_rcp_f16_sdwa v13, v13 dst_sel:WORD_1 dst_unused:UNUSED_PRESERVE src0_sel:WORD_1
v_mfma_f32_16x16x32_f16 v[240:243], v[120:123], v[216:219], v[240:243]
ds_read_b128 v[120:123], v251 offset:11264
v_rcp_f16_sdwa v15, v15 dst_sel:WORD_1 dst_unused:UNUSED_PRESERVE src0_sel:WORD_1
v_mfma_f32_16x16x32_bf16 v[160:163], v[124:127], v[48:51], 0
v_or_b32 v32, v0, v1
s_waitcnt lgkmcnt(6)
v_mfma_f32_16x16x32_f16 v[92:95], v[176:179], v[220:223], v[92:95]
v_pk_mul_f16 v37, v10, v11
s_nop 0
v_cvt_pk_bf16_f32 v112, v240, v241
v_cvt_pk_bf16_f32 v113, v242, v243
ds_read_b128 v[240:243], v254
v_mfma_f32_16x16x32_bf16 v[168:171], v[124:127], v[52:55], 0
ds_read_b128 v[124:127], v251 offset:9216
v_pk_mul_f16 v38, v12, v13
v_mfma_f32_16x16x32_f16 v[244:247], v[176:179], v[216:219], v[244:247]
ds_read_b128 v[176:179], v248 offset:24832
v_pk_mul_f16 v39, v14, v15
v_cvt_pkrtz_f16_f32 v145, v144, v145
v_and_b32_e64 v145, s49, v145
v_bfe_u32 v144, v145, 2, 14
v_lshrrev_b32_e64 v145, 18, v145
ds_read_u16 v144, v144
ds_read_u16_d16_hi v145, v145
v_cvt_pk_f16_f32 v154, v154, v155
v_cvt_pk_bf16_f32 v114, v244, v245
v_cvt_pk_bf16_f32 v115, v246, v247
ds_read_b128 v[244:247], v254 offset:16
v_or_b32 v33, v2, v3
v_mfma_f32_16x16x32_bf16 v[160:163], v[180:183], v[56:59], v[160:163]
v_cvt_pk_f16_f32 v156, v156, v157
s_waitcnt vmcnt(1)
v_mfma_f32_16x16x32_bf16 v[80:83], v[18:21], v[96:99], v[80:83]
v_cvt_pk_f16_f32 v158, v158, v159
v_mfma_f32_16x16x32_bf16 v[84:87], v[16:19], v[96:99], v[84:87]
v_pk_fma_f16 v155, v154, v154, s48
s_waitcnt vmcnt(0)
v_mfma_f32_16x16x32_bf16 v[88:91], v[18:21], v[100:103], v[88:91]
v_pk_fma_f16 v157, v156, v156, s48
v_mfma_f32_16x16x32_bf16 v[92:95], v[16:19], v[100:103], v[92:95]
s_nop 0
v_cvt_pk_bf16_f32 v16, v80, v81
v_cvt_pk_bf16_f32 v17, v82, v83
v_cvt_pk_bf16_f32 v18, v84, v85
v_cvt_pk_bf16_f32 v19, v86, v87
s_waitcnt lgkmcnt(3)
v_mfma_f32_16x16x32_f16 v[72:75], v[184:187], v[196:199], v[128:131]
v_cvt_pk_bf16_f32 v20, v88, v89
v_cvt_pk_bf16_f32 v21, v90, v91
v_cvt_pk_bf16_f32 v22, v92, v93
v_cvt_pk_bf16_f32 v23, v94, v95
s_setprio 0
v_mfma_f32_16x16x32_bf16 v[168:171], v[180:183], v[60:63], v[168:171]
ds_read_b128 v[180:183], v251 offset:12288
v_cvt_pkrtz_f16_f32 v147, v146, v147
v_and_b32_e64 v147, s49, v147
v_bfe_u32 v146, v147, 2, 14
v_lshrrev_b32_e64 v147, 18, v147
ds_read_u16 v146, v146
ds_read_u16_d16_hi v147, v147
v_mfma_f32_16x16x32_f16 v[128:131], v[184:187], v[192:195], v[128:131]
ds_read_b128 v[184:187], v248 offset:26880
v_or_b32_e64 v34, v4, v5
v_pk_fma_f16 v159, v158, v158, s48
buffer_store_dwordx4 v[40:43], v253, s[8:11], s69 offen sc1
buffer_store_dwordx4 v[44:47], v253, s[8:11], s69 offen offset:64 sc1
v_pk_mul_f16 v155, v154, v155
v_pk_mul_f16 v157, v156, v157
v_mfma_f32_16x16x32_bf16 v[160:163], v[188:191], v[64:67], v[160:163]
v_pk_mul_f16 v159, v158, v159
v_mfma_f32_16x16x32_f16 v[76:79], v[120:123], v[196:199], v[132:135]
v_cvt_pkrtz_f16_f32 v149, v148, v149
v_and_b32_e64 v149, s49, v149
v_bfe_u32 v148, v149, 2, 14
v_lshrrev_b32_e64 v149, 18, v149
ds_read_u16 v148, v148
ds_read_u16_d16_hi v149, v149
v_or_b32_e64 v35, v6, v7
v_exp_f16_sdwa v155, v155 dst_sel:WORD_0 dst_unused:UNUSED_PRESERVE src0_sel:WORD_0
v_mfma_f32_16x16x32_f16 v[132:135], v[120:123], v[192:195], v[132:135]
ds_read_b128 v[120:123], v248 offset:28928
v_exp_f16_sdwa v157, v157 dst_sel:WORD_0 dst_unused:UNUSED_PRESERVE src0_sel:WORD_0
v_mfma_f32_16x16x32_bf16 v[168:171], v[188:191], v[68:71], v[168:171]
ds_read_b128 v[188:191], v251 offset:10240
v_cvt_pkrtz_f16_f32 v151, v150, v151
v_mfma_f32_16x16x32_f16 v[80:83], v[124:127], v[196:199], v[136:139]
v_and_b32_e64 v151, s49, v151
v_bfe_u32 v150, v151, 2, 14
v_lshrrev_b32_e64 v151, 18, v151
ds_read_u16 v150, v150
ds_read_u16_d16_hi v151, v151
v_exp_f16_sdwa v159, v159 dst_sel:WORD_0 dst_unused:UNUSED_PRESERVE src0_sel:WORD_0
v_or_b32_e64 v36, v8, v9
v_mfma_f32_16x16x32_bf16 v[164:167], v[176:179], v[48:51], 0
v_exp_f16_sdwa v155, v155 dst_sel:WORD_1 dst_unused:UNUSED_PRESERVE src0_sel:WORD_1
v_mfma_f32_16x16x32_f16 v[136:139], v[124:127], v[192:195], v[136:139]
ds_read_b128 v[124:127], v251 offset:13312
v_exp_f16_sdwa v157, v157 dst_sel:WORD_1 dst_unused:UNUSED_PRESERVE src0_sel:WORD_1
v_mfma_f32_16x16x32_bf16 v[172:175], v[176:179], v[52:55], 0
ds_read_b128 v[176:179], v248 offset:30720
v_cvt_pkrtz_f16_f32 v153, v152, v153
v_and_b32_e64 v153, s49, v153
v_bfe_u32 v152, v153, 2, 14
v_lshrrev_b32 v153, 18, v153
s_waitcnt lgkmcnt(6)
ds_read_u16 v152, v152
ds_read_u16_d16_hi v153, v153
v_mfma_f32_16x16x32_f16 v[84:87], v[180:183], v[196:199], v[140:143]
v_exp_f16_sdwa v159, v159 dst_sel:WORD_1 dst_unused:UNUSED_PRESERVE src0_sel:WORD_1
v_mfma_f32_16x16x32_bf16 v[164:167], v[184:187], v[56:59], v[164:167]
v_pk_add_f16 v155, v155, 1.0 op_sel_hi:[1,0]
v_mfma_f32_16x16x32_f16 v[140:143], v[180:183], v[192:195], v[140:143]
ds_read_b128 v[180:183], v251 offset:14336
s_setprio 3
v_pk_add_f16 v157, v157, 1.0 op_sel_hi:[1,0]
v_pk_add_f16 v159, v159, 1.0 op_sel_hi:[1,0]
v_mfma_f32_16x16x32_bf16 v[172:175], v[184:187], v[60:63], v[172:175]
ds_read_b128 v[184:187], v248 offset:32768
v_rcp_f16_sdwa v155, v155 dst_sel:WORD_0 dst_unused:UNUSED_PRESERVE src0_sel:WORD_0
s_waitcnt lgkmcnt(7)
v_mfma_f32_16x16x32_f16 v[88:91], v[188:191], v[196:199], v[240:243]
v_rcp_f16_sdwa v157, v157 dst_sel:WORD_0 dst_unused:UNUSED_PRESERVE src0_sel:WORD_0
v_mfma_f32_16x16x32_bf16 v[164:167], v[120:123], v[64:67], v[164:167]
v_rcp_f16_sdwa v159, v159 dst_sel:WORD_0 dst_unused:UNUSED_PRESERVE src0_sel:WORD_0
v_mfma_f32_16x16x32_f16 v[240:243], v[188:191], v[192:195], v[240:243]
ds_read_b128 v[188:191], v251 offset:17408
v_rcp_f16_sdwa v155, v155 dst_sel:WORD_1 dst_unused:UNUSED_PRESERVE src0_sel:WORD_1
s_waitcnt lgkmcnt(5)
v_mfma_f32_16x16x32_f16 v[92:95], v[124:127], v[196:199], v[244:247]
v_rcp_f16_sdwa v157, v157 dst_sel:WORD_1 dst_unused:UNUSED_PRESERVE src0_sel:WORD_1
v_mfma_f32_16x16x32_bf16 v[172:175], v[120:123], v[68:71], v[172:175]
ds_read_b128 v[120:123], v248 offset:34816
v_rcp_f16_sdwa v159, v159 dst_sel:WORD_1 dst_unused:UNUSED_PRESERVE src0_sel:WORD_1
v_mfma_f32_16x16x32_f16 v[244:247], v[124:127], v[192:195], v[244:247]
ds_read_b128 v[124:127], v251 offset:15360
v_or_b32_e64 v224, v144, v145
v_mfma_f32_16x16x32_bf16 v[0:3], v[176:179], v[48:51], 0
v_pk_mul_f16 v229, v154, v155
s_waitcnt lgkmcnt(4)
v_mfma_f32_16x16x32_f16 v[72:75], v[180:183], v[28:31], v[72:75]
v_pk_mul_f16 v230, v156, v157
v_mfma_f32_16x16x32_bf16 v[8:11], v[176:179], v[52:55], 0
ds_read_b128 v[176:179], v251 offset:18432
v_pk_mul_f16 v231, v158, v159
v_mfma_f32_16x16x32_f16 v[128:131], v[180:183], v[24:27], v[128:131]
ds_read_b128 v[180:183], v248 offset:30976
v_cvt_pkrtz_f16_f32 v161, v160, v161
v_and_b32_e64 v161, s49, v161
v_bfe_u32 v160, v161, 2, 14
v_lshrrev_b32_e64 v161, 18, v161
ds_read_u16 v160, v160
ds_read_u16_d16_hi v161, v161
v_cvt_pk_f16_f32 v170, v170, v171
v_or_b32_e64 v225, v146, v147
s_waitcnt lgkmcnt(6)
v_mfma_f32_16x16x32_bf16 v[0:3], v[184:187], v[56:59], v[0:3]
v_cvt_pk_f16_f32 v172, v172, v173
v_mfma_f32_16x16x32_f16 v[76:79], v[188:191], v[28:31], v[76:79]
s_setprio 2
v_cvt_pk_f16_f32 v174, v174, v175
v_pk_fma_f16 v171, v170, v170, s48
v_mfma_f32_16x16x32_bf16 v[8:11], v[184:187], v[60:63], v[8:11]
ds_read_b128 v[184:187], v251 offset:16384
v_pk_fma_f16 v173, v172, v172, s48
v_cvt_pkrtz_f16_f32 v163, v162, v163
v_and_b32_e64 v163, s49, v163
v_bfe_u32 v162, v163, 2, 14
v_lshrrev_b32_e64 v163, 18, v163
ds_read_u16 v162, v162
ds_read_u16_d16_hi v163, v163
v_mfma_f32_16x16x32_f16 v[132:135], v[188:191], v[24:27], v[132:135]
ds_read_b128 v[188:191], v248 offset:33024
v_or_b32 v226, v148, v149
v_pk_fma_f16 v175, v174, v174, s48
v_pk_mul_f16 v171, v170, v171
v_pk_mul_f16 v173, v172, v173
s_waitcnt lgkmcnt(6)
v_mfma_f32_16x16x32_bf16 v[0:3], v[120:123], v[64:67], v[0:3]
v_pk_mul_f16 v175, v174, v175
v_mfma_f32_16x16x32_f16 v[80:83], v[124:127], v[28:31], v[80:83]
v_cvt_pkrtz_f16_f32 v165, v164, v165
v_and_b32_e64 v165, s49, v165
v_bfe_u32 v164, v165, 2, 14
v_lshrrev_b32_e64 v165, 18, v165
ds_read_u16 v164, v164
ds_read_u16_d16_hi v165, v165
v_or_b32_e64 v227, v150, v151
v_exp_f16_sdwa v171, v171 dst_sel:WORD_0 dst_unused:UNUSED_PRESERVE src0_sel:WORD_0
v_mfma_f32_16x16x32_f16 v[136:139], v[124:127], v[24:27], v[136:139]
ds_read_b128 v[124:127], v248 offset:35072
v_exp_f16_sdwa v173, v173 dst_sel:WORD_0 dst_unused:UNUSED_PRESERVE src0_sel:WORD_0
v_mfma_f32_16x16x32_bf16 v[8:11], v[120:123], v[68:71], v[8:11]
ds_read_b128 v[120:123], v251 offset:19456
v_cvt_pkrtz_f16_f32 v167, v166, v167
v_mfma_f32_16x16x32_f16 v[84:87], v[176:179], v[28:31], v[84:87]
v_and_b32_e64 v167, s49, v167
v_bfe_u32 v166, v167, 2, 14
v_lshrrev_b32_e64 v167, 18, v167
ds_read_u16 v166, v166
ds_read_u16_d16_hi v167, v167
v_exp_f16_sdwa v175, v175 dst_sel:WORD_0 dst_unused:UNUSED_PRESERVE src0_sel:WORD_0
v_or_b32_e64 v228, v152, v153
v_mfma_f32_16x16x32_bf16 v[4:7], v[180:183], v[48:51], 0
v_exp_f16_sdwa v171, v171 dst_sel:WORD_1 dst_unused:UNUSED_PRESERVE src0_sel:WORD_1
v_mfma_f32_16x16x32_f16 v[140:143], v[176:179], v[24:27], v[140:143]
ds_read_b128 v[176:179], v251 offset:20480
v_exp_f16_sdwa v173, v173 dst_sel:WORD_1 dst_unused:UNUSED_PRESERVE src0_sel:WORD_1
v_mfma_f32_16x16x32_bf16 v[12:15], v[180:183], v[52:55], 0
ds_read_b128 v[180:183], v249
v_cvt_pkrtz_f16_f32 v169, v168, v169
v_and_b32_e64 v169, s49, v169
v_bfe_u32 v168, v169, 2, 14
v_lshrrev_b32_e64 v169, 18, v169
ds_read_u16 v168, v168
s_waitcnt lgkmcnt(7)
ds_read_u16_d16_hi v169, v169
v_mfma_f32_16x16x32_f16 v[88:91], v[184:187], v[28:31], v[88:91]
v_exp_f16_sdwa v175, v175 dst_sel:WORD_1 dst_unused:UNUSED_PRESERVE src0_sel:WORD_1
v_mfma_f32_16x16x32_bf16 v[4:7], v[188:191], v[56:59], v[4:7]
v_pk_add_f16 v171, v171, 1.0 op_sel_hi:[1,0]
v_mfma_f32_16x16x32_f16 v[240:243], v[184:187], v[24:27], v[240:243]
ds_read_b128 v[184:187], v251 offset:23552
s_setprio 1
v_pk_add_f16 v173, v173, 1.0 op_sel_hi:[1,0]
v_pk_add_f16 v175, v175, 1.0 op_sel_hi:[1,0]
v_mfma_f32_16x16x32_bf16 v[12:15], v[188:191], v[60:63], v[12:15]
ds_read_b128 v[188:191], v249 offset:2048
v_rcp_f16_sdwa v171, v171 dst_sel:WORD_0 dst_unused:UNUSED_PRESERVE src0_sel:WORD_0
s_waitcnt lgkmcnt(7)
v_mfma_f32_16x16x32_f16 v[92:95], v[120:123], v[28:31], v[92:95]
v_rcp_f16_sdwa v173, v173 dst_sel:WORD_0 dst_unused:UNUSED_PRESERVE src0_sel:WORD_0
v_mfma_f32_16x16x32_bf16 v[4:7], v[124:127], v[64:67], v[4:7]
v_rcp_f16_sdwa v175, v175 dst_sel:WORD_0 dst_unused:UNUSED_PRESERVE src0_sel:WORD_0
v_mfma_f32_16x16x32_f16 v[244:247], v[120:123], v[24:27], v[244:247]
ds_read_b128 v[120:123], v251 offset:21504
buffer_store_dwordx4 v[112:115], v253, s[8:11], s69 offen offset:128 sc1
buffer_store_dwordx4 v[116:119], v253, s[8:11], s69 offen offset:192 sc1
s_waitcnt lgkmcnt(5)
v_mfma_f32_16x16x32_f16 v[72:75], v[176:179], v[36:39], v[72:75]
v_rcp_f16_sdwa v171, v171 dst_sel:WORD_1 dst_unused:UNUSED_PRESERVE src0_sel:WORD_1
v_mfma_f32_16x16x32_bf16 v[12:15], v[124:127], v[68:71], v[12:15]
ds_read_b128 v[124:127], v251 offset:24576
v_rcp_f16_sdwa v173, v173 dst_sel:WORD_1 dst_unused:UNUSED_PRESERVE src0_sel:WORD_1
v_mfma_f32_16x16x32_f16 v[128:131], v[176:179], v[32:35], v[128:131]
ds_read_b128 v[176:179], v249 offset:4096
v_rcp_f16_sdwa v175, v175 dst_sel:WORD_1 dst_unused:UNUSED_PRESERVE src0_sel:WORD_1
v_mfma_f32_16x16x32_bf16 v[144:147], v[180:183], v[48:51], 0
v_or_b32 v104, v160, v161
s_waitcnt lgkmcnt(4)
v_mfma_f32_16x16x32_f16 v[76:79], v[184:187], v[36:39], v[76:79]
v_pk_mul_f16 v109, v170, v171
v_mfma_f32_16x16x32_bf16 v[152:155], v[180:183], v[52:55], 0
ds_read_b128 v[180:183], v251 offset:22528
v_pk_mul_f16 v110, v172, v173
v_mfma_f32_16x16x32_f16 v[132:135], v[184:187], v[32:35], v[132:135]
ds_read_b128 v[184:187], v249 offset:256
v_pk_mul_f16 v111, v174, v175
v_cvt_pkrtz_f16_f32 v1, v0, v1
v_and_b32_e64 v1, s49, v1
v_bfe_u32 v0, v1, 2, 14
v_lshrrev_b32_e64 v1, 18, v1
ds_read_u16 v0, v0
ds_read_u16_d16_hi v1, v1
v_cvt_pk_f16_f32 v10, v10, v11
v_or_b32_e64 v105, v162, v163
s_waitcnt lgkmcnt(5)
v_mfma_f32_16x16x32_bf16 v[144:147], v[188:191], v[56:59], v[144:147]
v_cvt_pk_f16_f32 v12, v12, v13
s_setprio 0
v_mfma_f32_16x16x32_f16 v[80:83], v[120:123], v[36:39], v[80:83]
v_cvt_pk_f16_f32 v14, v14, v15
v_pk_fma_f16 v11, v10, v10, s48
v_mfma_f32_16x16x32_bf16 v[152:155], v[188:191], v[60:63], v[152:155]
ds_read_b128 v[188:191], v251 offset:25600
v_pk_fma_f16 v13, v12, v12, s48
v_cvt_pkrtz_f16_f32 v3, v2, v3
v_and_b32_e64 v3, s49, v3
v_bfe_u32 v2, v3, 2, 14
v_lshrrev_b32_e64 v3, 18, v3
ds_read_u16 v2, v2
ds_read_u16_d16_hi v3, v3
v_mfma_f32_16x16x32_f16 v[136:139], v[120:123], v[32:35], v[136:139]
ds_read_b128 v[120:123], v249 offset:2304
v_or_b32_e64 v106, v164, v165
v_pk_fma_f16 v15, v14, v14, s48
v_pk_mul_f16 v11, v10, v11
v_pk_mul_f16 v13, v12, v13
v_mfma_f32_16x16x32_f16 v[84:87], v[124:127], v[36:39], v[84:87]
v_pk_mul_f16 v15, v14, v15
s_waitcnt lgkmcnt(6)
v_mfma_f32_16x16x32_bf16 v[144:147], v[176:179], v[64:67], v[144:147]
v_cvt_pkrtz_f16_f32 v5, v4, v5
v_and_b32 v5, s49, v5
v_bfe_u32 v4, v5, 2, 14
v_lshrrev_b32_e64 v5, 18, v5
ds_read_u16 v4, v4
ds_read_u16_d16_hi v5, v5
v_or_b32_e64 v107, v166, v167
v_exp_f16_sdwa v11, v11 dst_sel:WORD_0 dst_unused:UNUSED_PRESERVE src0_sel:WORD_0
v_mfma_f32_16x16x32_f16 v[140:143], v[124:127], v[32:35], v[140:143]
ds_read_b128 v[124:127], v251 offset:26624
v_exp_f16_sdwa v13, v13 dst_sel:WORD_0 dst_unused:UNUSED_PRESERVE src0_sel:WORD_0
v_mfma_f32_16x16x32_bf16 v[152:155], v[176:179], v[68:71], v[152:155]
ds_read_b128 v[176:179], v249 offset:4352
v_cvt_pkrtz_f16_f32 v7, v6, v7
v_mfma_f32_16x16x32_f16 v[88:91], v[180:183], v[36:39], v[88:91]
v_and_b32_e64 v7, s49, v7
v_bfe_u32 v6, v7, 2, 14
v_lshrrev_b32_e64 v7, 18, v7
ds_read_u16 v6, v6
ds_read_u16_d16_hi v7, v7
v_exp_f16_sdwa v15, v15 dst_sel:WORD_0 dst_unused:UNUSED_PRESERVE src0_sel:WORD_0
v_or_b32_e64 v108, v168, v169
v_mfma_f32_16x16x32_bf16 v[148:151], v[184:187], v[48:51], 0
v_exp_f16_sdwa v11, v11 dst_sel:WORD_1 dst_unused:UNUSED_PRESERVE src0_sel:WORD_1
v_mfma_f32_16x16x32_f16 v[240:243], v[180:183], v[32:35], v[240:243]
ds_read_b128 v[180:183], v251 offset:29696
v_exp_f16_sdwa v13, v13 dst_sel:WORD_1 dst_unused:UNUSED_PRESERVE src0_sel:WORD_1
v_mfma_f32_16x16x32_bf16 v[156:159], v[184:187], v[52:55], 0
ds_read_b128 v[184:187], v249 offset:6144
v_cvt_pkrtz_f16_f32 v9, v8, v9
v_and_b32_e64 v9, s49, v9
v_bfe_u32 v8, v9, 2, 14
v_lshrrev_b32_e64 v9, 18, v9
ds_read_u16 v8, v8
s_waitcnt lgkmcnt(7)
ds_read_u16_d16_hi v9, v9
v_mfma_f32_16x16x32_f16 v[92:95], v[188:191], v[36:39], v[92:95]
v_exp_f16_sdwa v15, v15 dst_sel:WORD_1 dst_unused:UNUSED_PRESERVE src0_sel:WORD_1
v_mfma_f32_16x16x32_bf16 v[148:151], v[120:123], v[56:59], v[148:151]
s_setprio 3
v_pk_add_f16 v11, v11, 1.0 op_sel_hi:[1,0]
v_mfma_f32_16x16x32_f16 v[244:247], v[188:191], v[32:35], v[244:247]
ds_read_b128 v[188:191], v251 offset:27648
v_pk_add_f16 v13, v13, 1.0 op_sel_hi:[1,0]
v_pk_add_f16 v15, v15, 1.0 op_sel_hi:[1,0]
v_mfma_f32_16x16x32_bf16 v[156:159], v[120:123], v[60:63], v[156:159]
ds_read_b128 v[120:123], v249 offset:8192
v_rcp_f16_sdwa v11, v11 dst_sel:WORD_0 dst_unused:UNUSED_PRESERVE src0_sel:WORD_0
s_waitcnt lgkmcnt(7)
v_mfma_f32_16x16x32_f16 v[72:75], v[124:127], v[228:231], v[72:75]
v_rcp_f16_sdwa v13, v13 dst_sel:WORD_0 dst_unused:UNUSED_PRESERVE src0_sel:WORD_0
v_mfma_f32_16x16x32_f16 v[128:131], v[124:127], v[224:227], v[128:131]
ds_read_b128 v[124:127], v251 offset:30720
v_rcp_f16_sdwa v15, v15 dst_sel:WORD_0 dst_unused:UNUSED_PRESERVE src0_sel:WORD_0
v_mfma_f32_16x16x32_bf16 v[148:151], v[176:179], v[64:67], v[148:151]
buffer_load_dwordx4 v[232:235], v253, s[4:7], s68 offen
buffer_load_dwordx4 v[236:239], v253, s[4:7], s68 offen offset:64
s_waitcnt lgkmcnt(5)
v_mfma_f32_16x16x32_f16 v[76:79], v[180:183], v[228:231], v[76:79]
v_rcp_f16_sdwa v11, v11 dst_sel:WORD_1 dst_unused:UNUSED_PRESERVE src0_sel:WORD_1
v_mfma_f32_16x16x32_bf16 v[156:159], v[176:179], v[68:71], v[156:159]
ds_read_b128 v[176:179], v251 offset:28672
v_rcp_f16_sdwa v13, v13 dst_sel:WORD_1 dst_unused:UNUSED_PRESERVE src0_sel:WORD_1
v_mfma_f32_16x16x32_f16 v[132:135], v[180:183], v[224:227], v[132:135]
ds_read_b128 v[180:183], v249 offset:10240
v_rcp_f16_sdwa v15, v15 dst_sel:WORD_1 dst_unused:UNUSED_PRESERVE src0_sel:WORD_1
v_mfma_f32_16x16x32_bf16 v[160:163], v[184:187], v[48:51], 0
v_or_b32 v200, v0, v1
s_waitcnt lgkmcnt(4)
v_mfma_f32_16x16x32_f16 v[80:83], v[188:191], v[228:231], v[80:83]
v_pk_mul_f16 v205, v10, v11
v_mfma_f32_16x16x32_bf16 v[168:171], v[184:187], v[52:55], 0
ds_read_b128 v[184:187], v251 offset:31744
v_pk_mul_f16 v206, v12, v13
v_mfma_f32_16x16x32_f16 v[136:139], v[188:191], v[224:227], v[136:139]
ds_read_b128 v[188:191], v249 offset:6400
v_pk_mul_f16 v207, v14, v15
v_cvt_pkrtz_f16_f32 v145, v144, v145
v_and_b32_e64 v145, s49, v145
v_bfe_u32 v144, v145, 2, 14
v_lshrrev_b32_e64 v145, 18, v145
ds_read_u16 v144, v144
ds_read_u16_d16_hi v145, v145
v_cvt_pk_f16_f32 v154, v154, v155
v_or_b32_e64 v201, v2, v3
s_waitcnt lgkmcnt(5)
v_mfma_f32_16x16x32_bf16 v[160:163], v[120:123], v[56:59], v[160:163]
v_cvt_pk_f16_f32 v156, v156, v157
s_setprio 2
v_mfma_f32_16x16x32_f16 v[84:87], v[124:127], v[228:231], v[84:87]
v_cvt_pk_f16_f32 v158, v158, v159
v_pk_fma_f16 v155, v154, v154, s48
v_mfma_f32_16x16x32_bf16 v[168:171], v[120:123], v[60:63], v[168:171]
ds_read_b128 v[120:123], v251 offset:32768
v_pk_fma_f16 v157, v156, v156, s48
v_mfma_f32_16x16x32_f16 v[140:143], v[124:127], v[224:227], v[140:143]
ds_read_b128 v[124:127], v249 offset:8448
v_cvt_pkrtz_f16_f32 v147, v146, v147
v_and_b32_e64 v147, s49, v147
v_bfe_u32 v146, v147, 2, 14
v_lshrrev_b32_e64 v147, 18, v147
ds_read_u16 v146, v146
ds_read_u16_d16_hi v147, v147
v_or_b32_e64 v202, v4, v5
v_pk_fma_f16 v159, v158, v158, s48
v_pk_mul_f16 v155, v154, v155
v_pk_mul_f16 v157, v156, v157
v_mfma_f32_16x16x32_f16 v[88:91], v[176:179], v[228:231], v[88:91]
v_pk_mul_f16 v159, v158, v159
s_waitcnt lgkmcnt(6)
v_mfma_f32_16x16x32_bf16 v[160:163], v[180:183], v[64:67], v[160:163]
v_cvt_pkrtz_f16_f32 v149, v148, v149
v_and_b32 v149, s49, v149
v_bfe_u32 v148, v149, 2, 14
v_lshrrev_b32_e64 v149, 18, v149
ds_read_u16 v148, v148
ds_read_u16_d16_hi v149, v149
v_or_b32_e64 v203, v6, v7
v_exp_f16_sdwa v155, v155 dst_sel:WORD_0 dst_unused:UNUSED_PRESERVE src0_sel:WORD_0
v_mfma_f32_16x16x32_f16 v[240:243], v[176:179], v[224:227], v[240:243]
ds_read_b128 v[176:179], v251 offset:35840
v_exp_f16_sdwa v157, v157 dst_sel:WORD_0 dst_unused:UNUSED_PRESERVE src0_sel:WORD_0
v_mfma_f32_16x16x32_bf16 v[168:171], v[180:183], v[68:71], v[168:171]
ds_read_b128 v[180:183], v249 offset:10496
v_cvt_pkrtz_f16_f32 v151, v150, v151
v_mfma_f32_16x16x32_f16 v[92:95], v[184:187], v[228:231], v[92:95]
v_and_b32_e64 v151, s49, v151
v_bfe_u32 v150, v151, 2, 14
v_lshrrev_b32_e64 v151, 18, v151
ds_read_u16 v150, v150
ds_read_u16_d16_hi v151, v151
buffer_store_dwordx4 v[16:19], v253, s[8:11], s69 offen offset:256 sc1
buffer_store_dwordx4 v[20:23], v253, s[8:11], s69 offen offset:320 sc1
v_exp_f16_sdwa v159, v159 dst_sel:WORD_0 dst_unused:UNUSED_PRESERVE src0_sel:WORD_0
v_or_b32_e64 v204, v8, v9
v_mfma_f32_16x16x32_bf16 v[164:167], v[188:191], v[48:51], 0
v_exp_f16_sdwa v155, v155 dst_sel:WORD_1 dst_unused:UNUSED_PRESERVE src0_sel:WORD_1
v_mfma_f32_16x16x32_f16 v[244:247], v[184:187], v[224:227], v[244:247]
ds_read_b128 v[184:187], v251 offset:33792
v_exp_f16_sdwa v157, v157 dst_sel:WORD_1 dst_unused:UNUSED_PRESERVE src0_sel:WORD_1
v_mfma_f32_16x16x32_bf16 v[172:175], v[188:191], v[52:55], 0
ds_read_b128 v[188:191], v249 offset:12288
v_cvt_pkrtz_f16_f32 v153, v152, v153
v_and_b32_e64 v153, s49, v153
v_bfe_u32 v152, v153, 2, 14
v_lshrrev_b32_e64 v153, 18, v153
ds_read_u16 v152, v152
s_waitcnt lgkmcnt(7)
ds_read_u16_d16_hi v153, v153
v_mfma_f32_16x16x32_f16 v[72:75], v[120:123], v[108:111], v[72:75]
v_exp_f16_sdwa v159, v159 dst_sel:WORD_1 dst_unused:UNUSED_PRESERVE src0_sel:WORD_1
v_mfma_f32_16x16x32_bf16 v[164:167], v[124:127], v[56:59], v[164:167]
s_setprio 1
v_pk_add_f16 v155, v155, 1.0 op_sel_hi:[1,0]
v_mfma_f32_16x16x32_f16 v[128:131], v[120:123], v[104:107], v[128:131]
ds_read_b128 v[120:123], v251 offset:36864
v_pk_add_f16 v157, v157, 1.0 op_sel_hi:[1,0]
v_pk_add_f16 v159, v159, 1.0 op_sel_hi:[1,0]
v_mfma_f32_16x16x32_bf16 v[172:175], v[124:127], v[60:63], v[172:175]
ds_read_b128 v[124:127], v249 offset:14336
buffer_load_dwordx4 v[208:211], v253, s[4:7], s68 offen offset:128
buffer_load_dwordx4 v[212:215], v253, s[4:7], s68 offen offset:192
s_waitcnt lgkmcnt(7)
v_mfma_f32_16x16x32_f16 v[76:79], v[176:179], v[108:111], v[76:79]
v_rcp_f16_sdwa v155, v155 dst_sel:WORD_0 dst_unused:UNUSED_PRESERVE src0_sel:WORD_0
v_rcp_f16_sdwa v157, v157 dst_sel:WORD_0 dst_unused:UNUSED_PRESERVE src0_sel:WORD_0
v_mfma_f32_16x16x32_f16 v[132:135], v[176:179], v[104:107], v[132:135]
ds_read_b128 v[176:179], v251 offset:34816
v_rcp_f16_sdwa v159, v159 dst_sel:WORD_0 dst_unused:UNUSED_PRESERVE src0_sel:WORD_0
v_mfma_f32_16x16x32_bf16 v[164:167], v[180:183], v[64:67], v[164:167]
v_rcp_f16_sdwa v155, v155 dst_sel:WORD_1 dst_unused:UNUSED_PRESERVE src0_sel:WORD_1
s_waitcnt lgkmcnt(5)
v_mfma_f32_16x16x32_f16 v[80:83], v[184:187], v[108:111], v[80:83]
v_rcp_f16_sdwa v157, v157 dst_sel:WORD_1 dst_unused:UNUSED_PRESERVE src0_sel:WORD_1
v_mfma_f32_16x16x32_bf16 v[172:175], v[180:183], v[68:71], v[172:175]
ds_read_b128 v[180:183], v251 offset:37888
v_rcp_f16_sdwa v159, v159 dst_sel:WORD_1 dst_unused:UNUSED_PRESERVE src0_sel:WORD_1
v_mfma_f32_16x16x32_f16 v[136:139], v[184:187], v[104:107], v[136:139]
ds_read_b128 v[184:187], v249 offset:16384
v_or_b32 v216, v144, v145
v_mfma_f32_16x16x32_bf16 v[0:3], v[188:191], v[48:51], 0
v_pk_mul_f16 v221, v154, v155
s_waitcnt lgkmcnt(4)
v_mfma_f32_16x16x32_f16 v[84:87], v[120:123], v[108:111], v[84:87]
v_pk_mul_f16 v222, v156, v157
v_mfma_f32_16x16x32_bf16 v[8:11], v[188:191], v[52:55], 0
ds_read_b128 v[188:191], v251 offset:38912
v_pk_mul_f16 v223, v158, v159
v_mfma_f32_16x16x32_f16 v[140:143], v[120:123], v[104:107], v[140:143]
ds_read_b128 v[120:123], v249 offset:12544
v_cvt_pkrtz_f16_f32 v161, v160, v161
v_and_b32_e64 v161, s49, v161
v_bfe_u32 v160, v161, 2, 14
v_lshrrev_b32_e64 v161, 18, v161
ds_read_u16 v160, v160
ds_read_u16_d16_hi v161, v161
v_cvt_pk_f16_f32 v170, v170, v171
v_or_b32_e64 v217, v146, v147
s_waitcnt lgkmcnt(6)
v_mfma_f32_16x16x32_bf16 v[0:3], v[124:127], v[56:59], v[0:3]
s_setprio 0
v_cvt_pk_f16_f32 v172, v172, v173
v_mfma_f32_16x16x32_f16 v[88:91], v[176:179], v[108:111], v[88:91]
v_cvt_pk_f16_f32 v174, v174, v175
v_pk_fma_f16 v171, v170, v170, s48
v_mfma_f32_16x16x32_bf16 v[8:11], v[124:127], v[60:63], v[8:11]
ds_read_b128 v[124:127], v251 offset:41984
v_pk_fma_f16 v173, v172, v172, s48
v_mfma_f32_16x16x32_f16 v[240:243], v[176:179], v[104:107], v[240:243]
ds_read_b128 v[176:179], v249 offset:14592
v_cvt_pkrtz_f16_f32 v163, v162, v163
v_and_b32_e64 v163, s49, v163
v_bfe_u32 v162, v163, 2, 14
v_lshrrev_b32_e64 v163, 18, v163
ds_read_u16 v162, v162
ds_read_u16_d16_hi v163, v163
v_or_b32 v218, v148, v149
v_pk_fma_f16 v175, v174, v174, s48
v_pk_mul_f16 v171, v170, v171
s_waitcnt lgkmcnt(6)
v_mfma_f32_16x16x32_f16 v[92:95], v[180:183], v[108:111], v[92:95]
v_pk_mul_f16 v173, v172, v173
v_mfma_f32_16x16x32_bf16 v[0:3], v[184:187], v[64:67], v[0:3]
v_pk_mul_f16 v175, v174, v175
v_cvt_pkrtz_f16_f32 v165, v164, v165
v_and_b32_e64 v165, s49, v165
v_bfe_u32 v164, v165, 2, 14
v_lshrrev_b32_e64 v165, 18, v165
ds_read_u16 v164, v164
ds_read_u16_d16_hi v165, v165
v_or_b32_e64 v219, v150, v151
v_exp_f16_sdwa v171, v171 dst_sel:WORD_0 dst_unused:UNUSED_PRESERVE src0_sel:WORD_0
v_mfma_f32_16x16x32_f16 v[244:247], v[180:183], v[104:107], v[244:247]
ds_read_b128 v[180:183], v251 offset:39936
v_exp_f16_sdwa v173, v173 dst_sel:WORD_0 dst_unused:UNUSED_PRESERVE src0_sel:WORD_0
v_mfma_f32_16x16x32_bf16 v[8:11], v[184:187], v[68:71], v[8:11]
ds_read_b128 v[184:187], v249 offset:16640
v_cvt_pkrtz_f16_f32 v167, v166, v167
v_mfma_f32_16x16x32_f16 v[72:75], v[188:191], v[204:207], v[72:75]
v_and_b32_e64 v167, s49, v167
v_bfe_u32 v166, v167, 2, 14
v_lshrrev_b32_e64 v167, 18, v167
ds_read_u16 v166, v166
ds_read_u16_d16_hi v167, v167
v_exp_f16_sdwa v175, v175 dst_sel:WORD_0 dst_unused:UNUSED_PRESERVE src0_sel:WORD_0
v_or_b32_e64 v220, v152, v153
v_mfma_f32_16x16x32_bf16 v[4:7], v[120:123], v[48:51], 0
v_exp_f16_sdwa v171, v171 dst_sel:WORD_1 dst_unused:UNUSED_PRESERVE src0_sel:WORD_1
v_mfma_f32_16x16x32_f16 v[128:131], v[188:191], v[200:203], v[128:131]
ds_read_b128 v[188:191], v251 offset:43008
v_exp_f16_sdwa v173, v173 dst_sel:WORD_1 dst_unused:UNUSED_PRESERVE src0_sel:WORD_1
v_mfma_f32_16x16x32_bf16 v[12:15], v[120:123], v[52:55], 0
ds_read_b128 v[120:123], v249 offset:18432
v_cvt_pkrtz_f16_f32 v169, v168, v169
v_and_b32_e64 v169, s49, v169
v_bfe_u32 v168, v169, 2, 14
v_lshrrev_b32_e64 v169, 18, v169
ds_read_u16 v168, v168
s_waitcnt lgkmcnt(7)
ds_read_u16_d16_hi v169, v169
buffer_load_dwordx4 v[96:99], v253, s[4:7], s68 offen offset:256
buffer_load_dwordx4 v[100:103], v253, s[4:7], s68 offen offset:320
v_mfma_f32_16x16x32_f16 v[76:79], v[124:127], v[204:207], v[76:79]
v_exp_f16_sdwa v175, v175 dst_sel:WORD_1 dst_unused:UNUSED_PRESERVE src0_sel:WORD_1
s_setprio 3
v_mfma_f32_16x16x32_bf16 v[4:7], v[176:179], v[56:59], v[4:7]
v_pk_add_f16 v171, v171, 1.0 op_sel_hi:[1,0]
v_mfma_f32_16x16x32_f16 v[132:135], v[124:127], v[200:203], v[132:135]
ds_read_b128 v[124:127], v251 offset:40960
v_pk_add_f16 v173, v173, 1.0 op_sel_hi:[1,0]
v_pk_add_f16 v175, v175, 1.0 op_sel_hi:[1,0]
v_mfma_f32_16x16x32_bf16 v[12:15], v[176:179], v[60:63], v[12:15]
ds_read_b128 v[176:179], v249 offset:20480
v_rcp_f16_sdwa v171, v171 dst_sel:WORD_0 dst_unused:UNUSED_PRESERVE src0_sel:WORD_0
s_waitcnt lgkmcnt(7)
v_mfma_f32_16x16x32_f16 v[80:83], v[180:183], v[204:207], v[80:83]
v_rcp_f16_sdwa v173, v173 dst_sel:WORD_0 dst_unused:UNUSED_PRESERVE src0_sel:WORD_0
v_mfma_f32_16x16x32_f16 v[136:139], v[180:183], v[200:203], v[136:139]
ds_read_b128 v[180:183], v251 offset:44032
v_rcp_f16_sdwa v175, v175 dst_sel:WORD_0 dst_unused:UNUSED_PRESERVE src0_sel:WORD_0
v_mfma_f32_16x16x32_bf16 v[4:7], v[184:187], v[64:67], v[4:7]
v_rcp_f16_sdwa v171, v171 dst_sel:WORD_1 dst_unused:UNUSED_PRESERVE src0_sel:WORD_1
s_waitcnt lgkmcnt(5)
v_mfma_f32_16x16x32_f16 v[84:87], v[188:191], v[204:207], v[84:87]
v_rcp_f16_sdwa v173, v173 dst_sel:WORD_1 dst_unused:UNUSED_PRESERVE src0_sel:WORD_1
v_mfma_f32_16x16x32_bf16 v[12:15], v[184:187], v[68:71], v[12:15]
ds_read_b128 v[184:187], v251 offset:45056
v_rcp_f16_sdwa v175, v175 dst_sel:WORD_1 dst_unused:UNUSED_PRESERVE src0_sel:WORD_1
v_mfma_f32_16x16x32_f16 v[140:143], v[188:191], v[200:203], v[140:143]
ds_read_b128 v[188:191], v249 offset:22528
v_or_b32 v40, v160, v161
v_mfma_f32_16x16x32_bf16 v[144:147], v[120:123], v[48:51], 0
v_pk_mul_f16 v45, v170, v171
s_waitcnt lgkmcnt(4)
v_mfma_f32_16x16x32_f16 v[88:91], v[124:127], v[204:207], v[88:91]
v_pk_mul_f16 v46, v172, v173
v_mfma_f32_16x16x32_bf16 v[152:155], v[120:123], v[52:55], 0
ds_read_b128 v[120:123], v251 offset:48128
v_pk_mul_f16 v47, v174, v175
v_mfma_f32_16x16x32_f16 v[240:243], v[124:127], v[200:203], v[240:243]
ds_read_b128 v[124:127], v249 offset:18688
v_cvt_pkrtz_f16_f32 v1, v0, v1
v_and_b32_e64 v1, s49, v1
v_bfe_u32 v0, v1, 2, 14
v_lshrrev_b32_e64 v1, 18, v1
ds_read_u16 v0, v0
ds_read_u16_d16_hi v1, v1
v_cvt_pk_f16_f32 v10, v10, v11
s_setprio 2
v_or_b32_e64 v41, v162, v163
s_waitcnt lgkmcnt(6)
v_mfma_f32_16x16x32_bf16 v[144:147], v[176:179], v[56:59], v[144:147]
v_cvt_pk_f16_f32 v12, v12, v13
v_mfma_f32_16x16x32_f16 v[92:95], v[180:183], v[204:207], v[92:95]
v_cvt_pk_f16_f32 v14, v14, v15
v_pk_fma_f16 v11, v10, v10, s48
v_mfma_f32_16x16x32_bf16 v[152:155], v[176:179], v[60:63], v[152:155]
ds_read_b128 v[176:179], v251 offset:46080
v_pk_fma_f16 v13, v12, v12, s48
v_mfma_f32_16x16x32_f16 v[244:247], v[180:183], v[200:203], v[244:247]
ds_read_b128 v[180:183], v249 offset:20736
v_cvt_pkrtz_f16_f32 v3, v2, v3
v_and_b32_e64 v3, s49, v3
v_bfe_u32 v2, v3, 2, 14
v_lshrrev_b32_e64 v3, 18, v3
ds_read_u16 v2, v2
ds_read_u16_d16_hi v3, v3
v_or_b32 v42, v164, v165
v_pk_fma_f16 v15, v14, v14, s48
v_pk_mul_f16 v11, v10, v11
s_waitcnt lgkmcnt(6)
v_mfma_f32_16x16x32_f16 v[72:75], v[184:187], v[220:223], v[72:75]
v_pk_mul_f16 v13, v12, v13
v_mfma_f32_16x16x32_bf16 v[144:147], v[188:191], v[64:67], v[144:147]
v_pk_mul_f16 v15, v14, v15
v_cvt_pkrtz_f16_f32 v5, v4, v5
v_and_b32_e64 v5, s49, v5
v_bfe_u32 v4, v5, 2, 14
v_lshrrev_b32_e64 v5, 18, v5
ds_read_u16 v4, v4
ds_read_u16_d16_hi v5, v5
v_or_b32_e64 v43, v166, v167
v_exp_f16_sdwa v11, v11 dst_sel:WORD_0 dst_unused:UNUSED_PRESERVE src0_sel:WORD_0
v_mfma_f32_16x16x32_f16 v[128:131], v[184:187], v[216:219], v[128:131]
ds_read_b128 v[184:187], v251 offset:49152
v_exp_f16_sdwa v13, v13 dst_sel:WORD_0 dst_unused:UNUSED_PRESERVE src0_sel:WORD_0
v_mfma_f32_16x16x32_bf16 v[152:155], v[188:191], v[68:71], v[152:155]
ds_read_b128 v[188:191], v249 offset:22784
v_cvt_pkrtz_f16_f32 v7, v6, v7
v_mfma_f32_16x16x32_f16 v[76:79], v[120:123], v[220:223], v[76:79]
v_and_b32_e64 v7, s49, v7
v_bfe_u32 v6, v7, 2, 14
v_lshrrev_b32_e64 v7, 18, v7
ds_read_u16 v6, v6
ds_read_u16_d16_hi v7, v7
v_exp_f16_sdwa v15, v15 dst_sel:WORD_0 dst_unused:UNUSED_PRESERVE src0_sel:WORD_0
v_or_b32_e64 v44, v168, v169
v_mfma_f32_16x16x32_bf16 v[148:151], v[124:127], v[48:51], 0
v_exp_f16_sdwa v11, v11 dst_sel:WORD_1 dst_unused:UNUSED_PRESERVE src0_sel:WORD_1
v_mfma_f32_16x16x32_f16 v[132:135], v[120:123], v[216:219], v[132:135]
ds_read_b128 v[120:123], v251 offset:47104
v_exp_f16_sdwa v13, v13 dst_sel:WORD_1 dst_unused:UNUSED_PRESERVE src0_sel:WORD_1
v_mfma_f32_16x16x32_bf16 v[156:159], v[124:127], v[52:55], 0
ds_read_b128 v[124:127], v249 offset:24576
v_cvt_pkrtz_f16_f32 v9, v8, v9
v_and_b32_e64 v9, s49, v9
v_bfe_u32 v8, v9, 2, 14
v_lshrrev_b32_e64 v9, 18, v9
ds_read_u16 v8, v8
s_waitcnt lgkmcnt(7)
ds_read_u16_d16_hi v9, v9
v_mfma_f32_16x16x32_f16 v[80:83], v[176:179], v[220:223], v[80:83]
v_exp_f16_sdwa v15, v15 dst_sel:WORD_1 dst_unused:UNUSED_PRESERVE src0_sel:WORD_1
s_setprio 1
v_mfma_f32_16x16x32_bf16 v[148:151], v[180:183], v[56:59], v[148:151]
v_pk_add_f16 v11, v11, 1.0 op_sel_hi:[1,0]
v_mfma_f32_16x16x32_f16 v[136:139], v[176:179], v[216:219], v[136:139]
ds_read_b128 v[176:179], v251 offset:50176
v_pk_add_f16 v13, v13, 1.0 op_sel_hi:[1,0]
v_pk_add_f16 v15, v15, 1.0 op_sel_hi:[1,0]
v_mfma_f32_16x16x32_bf16 v[156:159], v[180:183], v[60:63], v[156:159]
ds_read_b128 v[180:183], v249 offset:26624
v_rcp_f16_sdwa v11, v11 dst_sel:WORD_0 dst_unused:UNUSED_PRESERVE src0_sel:WORD_0
s_waitcnt lgkmcnt(7)
v_mfma_f32_16x16x32_f16 v[84:87], v[184:187], v[220:223], v[84:87]
v_rcp_f16_sdwa v13, v13 dst_sel:WORD_0 dst_unused:UNUSED_PRESERVE src0_sel:WORD_0
v_mfma_f32_16x16x32_f16 v[140:143], v[184:187], v[216:219], v[140:143]
ds_read_b128 v[184:187], v251 offset:51200
v_rcp_f16_sdwa v15, v15 dst_sel:WORD_0 dst_unused:UNUSED_PRESERVE src0_sel:WORD_0
v_mfma_f32_16x16x32_bf16 v[148:151], v[188:191], v[64:67], v[148:151]
v_rcp_f16_sdwa v11, v11 dst_sel:WORD_1 dst_unused:UNUSED_PRESERVE src0_sel:WORD_1
s_waitcnt lgkmcnt(5)
v_mfma_f32_16x16x32_f16 v[88:91], v[120:123], v[220:223], v[88:91]
v_rcp_f16_sdwa v13, v13 dst_sel:WORD_1 dst_unused:UNUSED_PRESERVE src0_sel:WORD_1
v_mfma_f32_16x16x32_bf16 v[156:159], v[188:191], v[68:71], v[156:159]
ds_read_b128 v[188:191], v251 offset:54272
v_rcp_f16_sdwa v15, v15 dst_sel:WORD_1 dst_unused:UNUSED_PRESERVE src0_sel:WORD_1
v_mfma_f32_16x16x32_f16 v[240:243], v[120:123], v[216:219], v[240:243]
ds_read_b128 v[120:123], v249 offset:28672
v_or_b32 v192, v0, v1
v_mfma_f32_16x16x32_bf16 v[160:163], v[124:127], v[48:51], 0
v_pk_mul_f16 v197, v10, v11
s_waitcnt lgkmcnt(4)
v_mfma_f32_16x16x32_f16 v[92:95], v[176:179], v[220:223], v[92:95]
v_pk_mul_f16 v198, v12, v13
v_mfma_f32_16x16x32_bf16 v[168:171], v[124:127], v[52:55], 0
ds_read_b128 v[124:127], v251 offset:52224
v_pk_mul_f16 v199, v14, v15
v_mfma_f32_16x16x32_f16 v[244:247], v[176:179], v[216:219], v[244:247]
ds_read_b128 v[176:179], v249 offset:24832
s_setprio 0
v_cvt_pkrtz_f16_f32 v145, v144, v145
v_and_b32 v145, s49, v145
v_bfe_u32 v144, v145, 2, 14
v_lshrrev_b32_e64 v145, 18, v145
ds_read_u16 v144, v144
ds_read_u16_d16_hi v145, v145
v_cvt_pk_f16_f32 v154, v154, v155
v_or_b32 v193, v2, v3
s_waitcnt lgkmcnt(6)
v_mfma_f32_16x16x32_bf16 v[160:163], v[180:183], v[56:59], v[160:163]
v_cvt_pk_f16_f32 v156, v156, v157
v_mfma_f32_16x16x32_f16 v[72:75], v[184:187], v[44:47], v[72:75]
v_cvt_pk_f16_f32 v158, v158, v159
v_pk_fma_f16 v155, v154, v154, s48
v_mfma_f32_16x16x32_bf16 v[168:171], v[180:183], v[60:63], v[168:171]
ds_read_b128 v[180:183], v251 offset:55296
v_pk_fma_f16 v157, v156, v156, s48
v_mfma_f32_16x16x32_f16 v[128:131], v[184:187], v[40:43], v[128:131]
ds_read_b128 v[184:187], v249 offset:26880
v_cvt_pkrtz_f16_f32 v147, v146, v147
v_and_b32_e64 v147, s49, v147
v_bfe_u32 v146, v147, 2, 14
v_lshrrev_b32_e64 v147, 18, v147
ds_read_u16 v146, v146
ds_read_u16_d16_hi v147, v147
v_or_b32 v194, v4, v5
v_pk_fma_f16 v159, v158, v158, s48
v_pk_mul_f16 v155, v154, v155
s_waitcnt lgkmcnt(6)
v_mfma_f32_16x16x32_f16 v[76:79], v[188:191], v[44:47], v[76:79]
v_pk_mul_f16 v157, v156, v157
v_mfma_f32_16x16x32_bf16 v[160:163], v[120:123], v[64:67], v[160:163]
v_pk_mul_f16 v159, v158, v159
v_cvt_pkrtz_f16_f32 v149, v148, v149
v_and_b32_e64 v149, s49, v149
v_bfe_u32 v148, v149, 2, 14
v_lshrrev_b32_e64 v149, 18, v149
ds_read_u16 v148, v148
ds_read_u16_d16_hi v149, v149
v_or_b32_e64 v195, v6, v7
v_exp_f16_sdwa v155, v155 dst_sel:WORD_0 dst_unused:UNUSED_PRESERVE src0_sel:WORD_0
v_mfma_f32_16x16x32_f16 v[132:135], v[188:191], v[40:43], v[132:135]
ds_read_b128 v[188:191], v251 offset:53248
v_exp_f16_sdwa v157, v157 dst_sel:WORD_0 dst_unused:UNUSED_PRESERVE src0_sel:WORD_0
v_mfma_f32_16x16x32_bf16 v[168:171], v[120:123], v[68:71], v[168:171]
ds_read_b128 v[120:123], v249 offset:28928
v_cvt_pkrtz_f16_f32 v151, v150, v151
v_mfma_f32_16x16x32_f16 v[80:83], v[124:127], v[44:47], v[80:83]
v_and_b32_e64 v151, s49, v151
v_bfe_u32 v150, v151, 2, 14
v_lshrrev_b32_e64 v151, 18, v151
ds_read_u16 v150, v150
ds_read_u16_d16_hi v151, v151
v_exp_f16_sdwa v159, v159 dst_sel:WORD_0 dst_unused:UNUSED_PRESERVE src0_sel:WORD_0
v_or_b32_e64 v196, v8, v9
v_mfma_f32_16x16x32_bf16 v[164:167], v[176:179], v[48:51], 0
v_exp_f16_sdwa v155, v155 dst_sel:WORD_1 dst_unused:UNUSED_PRESERVE src0_sel:WORD_1
v_mfma_f32_16x16x32_f16 v[136:139], v[124:127], v[40:43], v[136:139]
ds_read_b128 v[124:127], v251 offset:56320
v_exp_f16_sdwa v157, v157 dst_sel:WORD_1 dst_unused:UNUSED_PRESERVE src0_sel:WORD_1
v_mfma_f32_16x16x32_bf16 v[172:175], v[176:179], v[52:55], 0
ds_read_b128 v[176:179], v249 offset:30720
v_cvt_pkrtz_f16_f32 v153, v152, v153
v_and_b32_e64 v153, s49, v153
v_bfe_u32 v152, v153, 2, 14
v_lshrrev_b32_e64 v153, 18, v153
ds_read_u16 v152, v152
s_waitcnt lgkmcnt(7)
ds_read_u16_d16_hi v153, v153
v_mfma_f32_16x16x32_f16 v[84:87], v[180:183], v[44:47], v[84:87]
v_exp_f16_sdwa v159, v159 dst_sel:WORD_1 dst_unused:UNUSED_PRESERVE src0_sel:WORD_1
s_setprio 3
v_mfma_f32_16x16x32_bf16 v[164:167], v[184:187], v[56:59], v[164:167]
v_pk_add_f16 v155, v155, 1.0 op_sel_hi:[1,0]
v_mfma_f32_16x16x32_f16 v[140:143], v[180:183], v[40:43], v[140:143]
ds_read_b128 v[180:183], v251 offset:57344
v_pk_add_f16 v157, v157, 1.0 op_sel_hi:[1,0]
v_pk_add_f16 v159, v159, 1.0 op_sel_hi:[1,0]
v_mfma_f32_16x16x32_bf16 v[172:175], v[184:187], v[60:63], v[172:175]
ds_read_b128 v[184:187], v249 offset:32768
v_rcp_f16_sdwa v155, v155 dst_sel:WORD_0 dst_unused:UNUSED_PRESERVE src0_sel:WORD_0
s_waitcnt lgkmcnt(7)
v_mfma_f32_16x16x32_f16 v[88:91], v[188:191], v[44:47], v[88:91]
v_rcp_f16_sdwa v157, v157 dst_sel:WORD_0 dst_unused:UNUSED_PRESERVE src0_sel:WORD_0
v_mfma_f32_16x16x32_f16 v[240:243], v[188:191], v[40:43], v[240:243]
ds_read_b128 v[188:191], v251 offset:60416
v_rcp_f16_sdwa v159, v159 dst_sel:WORD_0 dst_unused:UNUSED_PRESERVE src0_sel:WORD_0
v_mfma_f32_16x16x32_bf16 v[164:167], v[120:123], v[64:67], v[164:167]
v_rcp_f16_sdwa v155, v155 dst_sel:WORD_1 dst_unused:UNUSED_PRESERVE src0_sel:WORD_1
s_waitcnt lgkmcnt(5)
v_mfma_f32_16x16x32_f16 v[92:95], v[124:127], v[44:47], v[92:95]
v_rcp_f16_sdwa v157, v157 dst_sel:WORD_1 dst_unused:UNUSED_PRESERVE src0_sel:WORD_1
v_mfma_f32_16x16x32_bf16 v[172:175], v[120:123], v[68:71], v[172:175]
ds_read_b128 v[120:123], v251 offset:58368
v_rcp_f16_sdwa v159, v159 dst_sel:WORD_1 dst_unused:UNUSED_PRESERVE src0_sel:WORD_1
v_mfma_f32_16x16x32_f16 v[244:247], v[124:127], v[40:43], v[244:247]
ds_read_b128 v[124:127], v249 offset:34816
v_or_b32 v112, v144, v145
v_mfma_f32_16x16x32_bf16 v[0:3], v[176:179], v[48:51], 0
v_pk_mul_f16 v117, v154, v155
s_waitcnt lgkmcnt(4)
v_mfma_f32_16x16x32_f16 v[72:75], v[180:183], v[196:199], v[72:75]
v_pk_mul_f16 v118, v156, v157
v_mfma_f32_16x16x32_bf16 v[8:11], v[176:179], v[52:55], 0
ds_read_b128 v[176:179], v251 offset:61440
v_pk_mul_f16 v119, v158, v159
v_mfma_f32_16x16x32_f16 v[128:131], v[180:183], v[192:195], v[128:131]
ds_read_b128 v[180:183], v249 offset:30976
s_setprio 2
v_cvt_pkrtz_f16_f32 v161, v160, v161
v_and_b32 v161, s49, v161
v_bfe_u32 v160, v161, 2, 14
v_lshrrev_b32_e64 v161, 18, v161
ds_read_u16 v160, v160
ds_read_u16_d16_hi v161, v161
v_cvt_pk_f16_f32 v170, v170, v171
v_or_b32 v113, v146, v147
s_waitcnt lgkmcnt(6)
v_mfma_f32_16x16x32_bf16 v[0:3], v[184:187], v[56:59], v[0:3]
v_cvt_pk_f16_f32 v172, v172, v173
v_mfma_f32_16x16x32_f16 v[76:79], v[188:191], v[196:199], v[76:79]
v_cvt_pk_f16_f32 v174, v174, v175
v_pk_fma_f16 v171, v170, v170, s48
v_mfma_f32_16x16x32_f16 v[132:135], v[188:191], v[192:195], v[132:135]
ds_read_b128 v[188:191], v249 offset:33024
v_pk_fma_f16 v173, v172, v172, s48
v_mfma_f32_16x16x32_bf16 v[8:11], v[184:187], v[60:63], v[8:11]
ds_read_b128 v[184:187], v251 offset:59392
v_cvt_pkrtz_f16_f32 v163, v162, v163
v_and_b32_e64 v163, s49, v163
v_bfe_u32 v162, v163, 2, 14
v_lshrrev_b32_e64 v163, 18, v163
ds_read_u16 v162, v162
ds_read_u16_d16_hi v163, v163
v_or_b32 v114, v148, v149
v_pk_fma_f16 v175, v174, v174, s48
v_pk_mul_f16 v171, v170, v171
s_waitcnt lgkmcnt(6)
v_mfma_f32_16x16x32_f16 v[80:83], v[120:123], v[196:199], v[80:83]
v_pk_mul_f16 v173, v172, v173
v_mfma_f32_16x16x32_bf16 v[0:3], v[124:127], v[64:67], v[0:3]
v_pk_mul_f16 v175, v174, v175
v_cvt_pkrtz_f16_f32 v165, v164, v165
v_and_b32_e64 v165, s49, v165
v_bfe_u32 v164, v165, 2, 14
v_lshrrev_b32_e64 v165, 18, v165
ds_read_u16 v164, v164
ds_read_u16_d16_hi v165, v165
v_or_b32_e64 v115, v150, v151
v_exp_f16_sdwa v171, v171 dst_sel:WORD_0 dst_unused:UNUSED_PRESERVE src0_sel:WORD_0
v_mfma_f32_16x16x32_f16 v[136:139], v[120:123], v[192:195], v[136:139]
ds_read_b128 v[120:123], v251 offset:62464
v_exp_f16_sdwa v173, v173 dst_sel:WORD_0 dst_unused:UNUSED_PRESERVE src0_sel:WORD_0
v_mfma_f32_16x16x32_bf16 v[8:11], v[124:127], v[68:71], v[8:11]
ds_read_b128 v[124:127], v249 offset:35072
v_cvt_pkrtz_f16_f32 v167, v166, v167
v_mfma_f32_16x16x32_f16 v[84:87], v[176:179], v[196:199], v[84:87]
v_and_b32_e64 v167, s49, v167
v_bfe_u32 v166, v167, 2, 14
v_lshrrev_b32_e64 v167, 18, v167
ds_read_u16 v166, v166
ds_read_u16_d16_hi v167, v167
v_exp_f16_sdwa v175, v175 dst_sel:WORD_0 dst_unused:UNUSED_PRESERVE src0_sel:WORD_0
v_or_b32_e64 v116, v152, v153
v_mfma_f32_16x16x32_bf16 v[4:7], v[180:183], v[48:51], 0
v_exp_f16_sdwa v171, v171 dst_sel:WORD_1 dst_unused:UNUSED_PRESERVE src0_sel:WORD_1
v_mfma_f32_16x16x32_f16 v[140:143], v[176:179], v[192:195], v[140:143]
ds_read_b128 v[176:179], v251 offset:63488
v_exp_f16_sdwa v173, v173 dst_sel:WORD_1 dst_unused:UNUSED_PRESERVE src0_sel:WORD_1
v_mfma_f32_16x16x32_bf16 v[12:15], v[180:183], v[52:55], 0
ds_read_b128 v[180:183], v252 offset:1024
v_cvt_pkrtz_f16_f32 v169, v168, v169
v_and_b32_e64 v169, s49, v169
v_bfe_u32 v168, v169, 2, 14
v_lshrrev_b32_e64 v169, 18, v169
ds_read_u16 v168, v168
s_waitcnt lgkmcnt(7)
ds_read_u16_d16_hi v169, v169
v_mfma_f32_16x16x32_f16 v[88:91], v[184:187], v[196:199], v[88:91]
s_setprio 1
v_exp_f16_sdwa v175, v175 dst_sel:WORD_1 dst_unused:UNUSED_PRESERVE src0_sel:WORD_1
v_mfma_f32_16x16x32_bf16 v[4:7], v[188:191], v[56:59], v[4:7]
v_pk_add_f16 v171, v171, 1.0 op_sel_hi:[1,0]
v_mfma_f32_16x16x32_f16 v[240:243], v[184:187], v[192:195], v[240:243]
ds_read_b128 v[184:187], v251 offset:64512
v_pk_add_f16 v173, v173, 1.0 op_sel_hi:[1,0]
v_pk_add_f16 v175, v175, 1.0 op_sel_hi:[1,0]
s_waitcnt lgkmcnt(7)
v_mfma_f32_16x16x32_f16 v[92:95], v[120:123], v[196:199], v[92:95]
v_rcp_f16_sdwa v171, v171 dst_sel:WORD_0 dst_unused:UNUSED_PRESERVE src0_sel:WORD_0
v_mfma_f32_16x16x32_bf16 v[12:15], v[188:191], v[60:63], v[12:15]
ds_read_b128 v[188:191], v252 offset:2048
v_rcp_f16_sdwa v173, v173 dst_sel:WORD_0 dst_unused:UNUSED_PRESERVE src0_sel:WORD_0
v_mfma_f32_16x16x32_f16 v[244:247], v[120:123], v[192:195], v[244:247]
ds_read_b128 v[120:123], v252
v_rcp_f16_sdwa v175, v175 dst_sel:WORD_0 dst_unused:UNUSED_PRESERVE src0_sel:WORD_0
v_mfma_f32_16x16x32_bf16 v[4:7], v[124:127], v[64:67], v[4:7]
v_rcp_f16_sdwa v171, v171 dst_sel:WORD_1 dst_unused:UNUSED_PRESERVE src0_sel:WORD_1
s_waitcnt lgkmcnt(5)
v_mfma_f32_16x16x32_f16 v[72:75], v[176:179], v[116:119], v[72:75]
v_rcp_f16_sdwa v173, v173 dst_sel:WORD_1 dst_unused:UNUSED_PRESERVE src0_sel:WORD_1
v_mfma_f32_16x16x32_bf16 v[12:15], v[124:127], v[68:71], v[12:15]
ds_read_b128 v[124:127], v252 offset:3072
v_rcp_f16_sdwa v175, v175 dst_sel:WORD_1 dst_unused:UNUSED_PRESERVE src0_sel:WORD_1
v_mfma_f32_16x16x32_f16 v[128:131], v[176:179], v[112:115], v[128:131]
ds_read_b128 v[176:179], v252 offset:4096
v_or_b32_e64 v24, v160, v161
v_mfma_f32_16x16x32_f16 v[76:79], v[180:183], v[116:119], v[76:79]
v_pk_mul_f16 v29, v170, v171
v_pk_mul_f16 v30, v172, v173
v_mfma_f32_16x16x32_f16 v[132:135], v[180:183], v[112:115], v[132:135]
ds_read_b128 v[180:183], v252 offset:7168
v_pk_mul_f16 v31, v174, v175
s_setprio 0
v_cvt_pkrtz_f16_f32 v1, v0, v1
v_and_b32 v1, s49, v1
v_bfe_u32 v0, v1, 2, 14
v_lshrrev_b32_e64 v1, 18, v1
ds_read_u16 v0, v0
ds_read_u16_d16_hi v1, v1
v_cvt_pk_f16_f32 v10, v10, v11
v_or_b32 v25, v162, v163
s_waitcnt lgkmcnt(5)
v_mfma_f32_16x16x32_f16 v[80:83], v[184:187], v[116:119], v[80:83]
v_cvt_pk_f16_f32 v12, v12, v13
v_cvt_pk_f16_f32 v14, v14, v15
v_pk_fma_f16 v11, v10, v10, s48
v_mov_b32 v16, 0
v_mov_b32 v17, 0
v_cndmask_b32 v18, 0, v255, s[88:89]
v_cndmask_b32 v19, 0, v255, s[90:91]
v_mov_b32 v20, 0
v_mov_b32 v21, 0
v_mfma_f32_16x16x32_f16 v[136:139], v[184:187], v[112:115], v[136:139]
ds_read_b128 v[184:187], v252 offset:5120
v_pk_fma_f16 v13, v12, v12, s48
v_cvt_pkrtz_f16_f32 v3, v2, v3
v_and_b32_e64 v3, s49, v3
v_bfe_u32 v2, v3, 2, 14
v_lshrrev_b32_e64 v3, 18, v3
ds_read_u16 v2, v2
ds_read_u16_d16_hi v3, v3
v_or_b32_e64 v26, v164, v165
v_pk_fma_f16 v15, v14, v14, s48
v_pk_mul_f16 v11, v10, v11
v_mfma_f32_16x16x32_f16 v[84:87], v[188:191], v[116:119], v[84:87]
v_pk_mul_f16 v13, v12, v13
v_pk_mul_f16 v15, v14, v15
v_cvt_pkrtz_f16_f32 v5, v4, v5
v_and_b32_e64 v5, s49, v5
v_bfe_u32 v4, v5, 2, 14
v_lshrrev_b32_e64 v5, 18, v5
ds_read_u16 v4, v4
ds_read_u16_d16_hi v5, v5
v_or_b32_e64 v27, v166, v167
v_exp_f16_sdwa v11, v11 dst_sel:WORD_0 dst_unused:UNUSED_PRESERVE src0_sel:WORD_0
v_mfma_f32_16x16x32_f16 v[140:143], v[188:191], v[112:115], v[140:143]
ds_read_b128 v[188:191], v252 offset:8192
v_exp_f16_sdwa v13, v13 dst_sel:WORD_0 dst_unused:UNUSED_PRESERVE src0_sel:WORD_0
v_mfma_f32_16x16x32_f16 v[88:91], v[120:123], v[116:119], v[88:91]
v_cvt_pkrtz_f16_f32 v7, v6, v7
v_and_b32_e64 v7, s49, v7
v_bfe_u32 v6, v7, 2, 14
v_lshrrev_b32_e64 v7, 18, v7
ds_read_u16 v6, v6
ds_read_u16_d16_hi v7, v7
v_exp_f16_sdwa v15, v15 dst_sel:WORD_0 dst_unused:UNUSED_PRESERVE src0_sel:WORD_0
v_or_b32_e64 v28, v168, v169
v_mfma_f32_16x16x32_f16 v[240:243], v[120:123], v[112:115], v[240:243]
ds_read_b128 v[120:123], v252 offset:6144
v_exp_f16_sdwa v11, v11 dst_sel:WORD_1 dst_unused:UNUSED_PRESERVE src0_sel:WORD_1
v_exp_f16_sdwa v13, v13 dst_sel:WORD_1 dst_unused:UNUSED_PRESERVE src0_sel:WORD_1
v_cvt_pkrtz_f16_f32 v9, v8, v9
v_and_b32_e64 v9, s49, v9
v_bfe_u32 v8, v9, 2, 14
v_lshrrev_b32_e64 v9, 18, v9
ds_read_u16 v8, v8
s_waitcnt lgkmcnt(6)
ds_read_u16_d16_hi v9, v9
v_mfma_f32_16x16x32_f16 v[92:95], v[124:127], v[116:119], v[92:95]
s_setprio 3
v_exp_f16_sdwa v15, v15 dst_sel:WORD_1 dst_unused:UNUSED_PRESERVE src0_sel:WORD_1
v_mfma_f32_16x16x32_f16 v[244:247], v[124:127], v[112:115], v[244:247]
ds_read_b128 v[124:127], v252 offset:9216
v_pk_add_f16 v11, v11, 1.0 op_sel_hi:[1,0]
v_pk_add_f16 v13, v13, 1.0 op_sel_hi:[1,0]
s_waitcnt vmcnt(7)
v_mfma_f32_16x16x32_bf16 v[128:131], v[18:21], v[232:235], v[128:131]
v_pk_add_f16 v15, v15, 1.0 op_sel_hi:[1,0]
v_mfma_f32_16x16x32_bf16 v[132:135], v[16:19], v[232:235], v[132:135]
v_rcp_f16_sdwa v11, v11 dst_sel:WORD_0 dst_unused:UNUSED_PRESERVE src0_sel:WORD_0
s_waitcnt vmcnt(6)
v_mfma_f32_16x16x32_bf16 v[136:139], v[18:21], v[236:239], v[136:139]
v_rcp_f16_sdwa v13, v13 dst_sel:WORD_0 dst_unused:UNUSED_PRESERVE src0_sel:WORD_0
v_mfma_f32_16x16x32_bf16 v[140:143], v[16:19], v[236:239], v[140:143]
v_rcp_f16_sdwa v15, v15 dst_sel:WORD_0 dst_unused:UNUSED_PRESERVE src0_sel:WORD_0
v_mfma_f32_16x16x32_f16 v[72:75], v[176:179], v[28:31], v[72:75]
v_rcp_f16_sdwa v11, v11 dst_sel:WORD_1 dst_unused:UNUSED_PRESERVE src0_sel:WORD_1
v_mfma_f32_16x16x32_f16 v[128:131], v[176:179], v[24:27], v[128:131]
ds_read_b128 v[176:179], v252 offset:10240
v_rcp_f16_sdwa v13, v13 dst_sel:WORD_1 dst_unused:UNUSED_PRESERVE src0_sel:WORD_1
v_mfma_f32_16x16x32_f16 v[76:79], v[180:183], v[28:31], v[76:79]
v_rcp_f16_sdwa v15, v15 dst_sel:WORD_1 dst_unused:UNUSED_PRESERVE src0_sel:WORD_1
v_mfma_f32_16x16x32_f16 v[132:135], v[180:183], v[24:27], v[132:135]
ds_read_b128 v[180:183], v252 offset:13312
v_or_b32_e64 v32, v0, v1
v_mfma_f32_16x16x32_f16 v[80:83], v[184:187], v[28:31], v[80:83]
v_pk_mul_f16 v37, v10, v11
v_pk_mul_f16 v38, v12, v13
v_mfma_f32_16x16x32_f16 v[136:139], v[184:187], v[24:27], v[136:139]
ds_read_b128 v[184:187], v252 offset:11264
s_setprio 2
v_pk_mul_f16 v39, v14, v15
v_or_b32 v33, v2, v3
s_waitcnt lgkmcnt(3)
v_mfma_f32_16x16x32_f16 v[84:87], v[188:191], v[28:31], v[84:87]
v_or_b32 v34, v4, v5
v_mfma_f32_16x16x32_f16 v[140:143], v[188:191], v[24:27], v[140:143]
ds_read_b128 v[188:191], v252 offset:14336
v_or_b32_e64 v35, v6, v7
v_mfma_f32_16x16x32_f16 v[88:91], v[120:123], v[28:31], v[88:91]
v_or_b32 v36, v8, v9
v_mfma_f32_16x16x32_f16 v[240:243], v[120:123], v[24:27], v[240:243]
ds_read_b128 v[120:123], v252 offset:12288
v_mfma_f32_16x16x32_f16 v[92:95], v[124:127], v[28:31], v[92:95]
v_mfma_f32_16x16x32_f16 v[244:247], v[124:127], v[24:27], v[244:247]
ds_read_b128 v[124:127], v252 offset:15360
s_waitcnt vmcnt(3)
v_mfma_f32_16x16x32_bf16 v[240:243], v[18:21], v[208:211], v[240:243]
v_mfma_f32_16x16x32_bf16 v[244:247], v[16:19], v[208:211], v[244:247]
s_waitcnt vmcnt(2)
v_mfma_f32_16x16x32_bf16 v[72:75], v[18:21], v[212:215], v[72:75]
v_mfma_f32_16x16x32_bf16 v[76:79], v[16:19], v[212:215], v[76:79]
s_waitcnt lgkmcnt(3)
v_mfma_f32_16x16x32_f16 v[72:75], v[176:179], v[36:39], v[72:75]
s_setprio 1
v_mfma_f32_16x16x32_f16 v[128:131], v[176:179], v[32:35], v[128:131]
v_mfma_f32_16x16x32_f16 v[76:79], v[180:183], v[36:39], v[76:79]
v_mfma_f32_16x16x32_f16 v[132:135], v[180:183], v[32:35], v[132:135]
s_nop 3
v_cvt_pk_bf16_f32 v108, v72, v73
v_mfma_f32_16x16x32_f16 v[80:83], v[184:187], v[36:39], v[80:83]
v_cvt_pk_bf16_f32 v224, v128, v129
v_mfma_f32_16x16x32_f16 v[136:139], v[184:187], v[32:35], v[136:139]
v_cvt_pk_bf16_f32 v225, v130, v131
v_cvt_pk_bf16_f32 v109, v74, v75
v_cvt_pk_bf16_f32 v226, v132, v133
v_cvt_pk_bf16_f32 v227, v134, v135
v_cvt_pk_bf16_f32 v110, v76, v77
v_cvt_pk_bf16_f32 v111, v78, v79
s_waitcnt lgkmcnt(0)
v_mfma_f32_16x16x32_f16 v[84:87], v[188:191], v[36:39], v[84:87]
v_cvt_pk_bf16_f32 v228, v136, v137
v_cvt_pk_bf16_f32 v229, v138, v139
v_mfma_f32_16x16x32_f16 v[140:143], v[188:191], v[32:35], v[140:143]
v_mfma_f32_16x16x32_f16 v[88:91], v[120:123], v[36:39], v[88:91]
v_mfma_f32_16x16x32_f16 v[240:243], v[120:123], v[32:35], v[240:243]
v_mfma_f32_16x16x32_f16 v[92:95], v[124:127], v[36:39], v[92:95]
s_nop 4
v_cvt_pk_bf16_f32 v230, v140, v141
v_cvt_pk_bf16_f32 v231, v142, v143
v_mfma_f32_16x16x32_f16 v[244:247], v[124:127], v[32:35], v[244:247]
s_setprio 0
v_cvt_pk_bf16_f32 v104, v240, v241
v_cvt_pk_bf16_f32 v105, v242, v243
s_waitcnt vmcnt(1)
v_mfma_f32_16x16x32_bf16 v[80:83], v[18:21], v[96:99], v[80:83]
v_mfma_f32_16x16x32_bf16 v[84:87], v[16:19], v[96:99], v[84:87]
s_nop 1
v_cvt_pk_bf16_f32 v106, v244, v245
v_cvt_pk_bf16_f32 v107, v246, v247
s_waitcnt vmcnt(0)
v_mfma_f32_16x16x32_bf16 v[88:91], v[18:21], v[100:103], v[88:91]
v_mfma_f32_16x16x32_bf16 v[92:95], v[16:19], v[100:103], v[92:95]
v_cvt_pk_bf16_f32 v16, v80, v81
v_cvt_pk_bf16_f32 v17, v82, v83
v_cvt_pk_bf16_f32 v18, v84, v85
v_cvt_pk_bf16_f32 v19, v86, v87
s_nop 2
v_cvt_pk_bf16_f32 v20, v88, v89
v_cvt_pk_bf16_f32 v21, v90, v91
v_cvt_pk_bf16_f32 v22, v92, v93
v_cvt_pk_bf16_f32 v23, v94, v95
buffer_store_dwordx4 v[224:227], v253, s[8:11], s68 offen sc1
buffer_store_dwordx4 v[228:231], v253, s[8:11], s68 offen offset:64 sc1
buffer_store_dwordx4 v[104:107], v253, s[8:11], s68 offen offset:128 sc1
buffer_store_dwordx4 v[108:111], v253, s[8:11], s68 offen offset:192 sc1
buffer_store_dwordx4 v[16:19], v253, s[8:11], s68 offen offset:256 sc1
buffer_store_dwordx4 v[20:23], v253, s[8:11], s68 offen offset:320 sc1
s_endpgm
Lpolln:
s_getreg_b32 s43, hwreg(HW_REG_IB_STS, 0, 4)
s_cmp_eq_u32 s43, 0
s_cbranch_scc1 Lpoll
s_setpc_b64 s[78:79]
Lpoll:
s_waitcnt vmcnt(0)
s_cmp_eq_u32 s77, 2
s_cbranch_scc1 LpollC
v_max_u32 v241, v128, v129
v_max3_u32 v241, v241, v130, v131
v_max3_u32 v241, v241, v132, v133
v_max3_u32 v241, v241, v134, v135
v_max3_u32 v241, v241, v136, v137
v_max3_u32 v241, v241, v138, v139
v_max3_u32 v241, v241, v140, v141
v_max3_u32 v241, v241, v142, v143
v_cmp_eq_u32 vcc, -1, v241
s_nop 4
s_cbranch_vccz LpollR
s_lshl_b32 s44, s2, 12
buffer_load_dwordx4 v[128:131], v245, s[32:35], s44 offen sc1
buffer_load_dwordx4 v[132:135], v245, s[32:35], s44 offen offset:1024 sc1
buffer_load_dwordx4 v[136:139], v245, s[32:35], s44 offen offset:2048 sc1
buffer_load_dwordx4 v[140:143], v245, s[32:35], s44 offen offset:3072 sc1
s_setpc_b64 s[78:79]
LpollR:
v_add_f32 v128, v128, v132
v_add_f32 v140, v136, v140
v_add_f32 v140, v128, v140
v_add_f32 v129, v129, v133
v_add_f32 v141, v137, v141
v_add_f32 v141, v129, v141
v_add_f32 v130, v130, v134
v_add_f32 v142, v138, v142
v_add_f32 v142, v130, v142
v_add_f32 v131, v131, v135
v_add_f32 v143, v139, v143
v_add_f32 v143, v131, v143
v_add_f32_dpp v140, v140, v140 row_ror:8 row_mask:0xf bank_mask:0xf
s_nop 1
v_add_f32_dpp v140, v140, v140 row_ror:4 row_mask:0xf bank_mask:0xf
s_nop 1
v_add_f32_dpp v140, v140, v140 row_ror:2 row_mask:0xf bank_mask:0xf
s_nop 1
v_add_f32_dpp v140, v140, v140 row_ror:1 row_mask:0xf bank_mask:0xf
v_mov_b32 v241, v140
s_nop 1
v_permlane16_swap_b32 v140, v241
v_add_f32 v140, v140, v241
v_mov_b32 v241, v140
s_nop 1
v_permlane32_swap_b32 v140, v241
v_add_f32 v140, v140, v241
v_min_u32 v140, -2, v140
v_add_f32_dpp v141, v141, v141 row_ror:8 row_mask:0xf bank_mask:0xf
s_nop 1
v_add_f32_dpp v141, v141, v141 row_ror:4 row_mask:0xf bank_mask:0xf
s_nop 1
v_add_f32_dpp v141, v141, v141 row_ror:2 row_mask:0xf bank_mask:0xf
s_nop 1
v_add_f32_dpp v141, v141, v141 row_ror:1 row_mask:0xf bank_mask:0xf
v_mov_b32 v241, v141
s_nop 1
v_permlane16_swap_b32 v141, v241
v_add_f32 v141, v141, v241
v_mov_b32 v241, v141
s_nop 1
v_permlane32_swap_b32 v141, v241
v_add_f32 v141, v141, v241
v_min_u32 v141, -2, v141
v_add_f32_dpp v142, v142, v142 row_ror:8 row_mask:0xf bank_mask:0xf
s_nop 1
v_add_f32_dpp v142, v142, v142 row_ror:4 row_mask:0xf bank_mask:0xf
s_nop 1
v_add_f32_dpp v142, v142, v142 row_ror:2 row_mask:0xf bank_mask:0xf
s_nop 1
v_add_f32_dpp v142, v142, v142 row_ror:1 row_mask:0xf bank_mask:0xf
v_mov_b32 v241, v142
s_nop 1
v_permlane16_swap_b32 v142, v241
v_add_f32 v142, v142, v241
v_mov_b32 v241, v142
s_nop 1
v_permlane32_swap_b32 v142, v241
v_add_f32 v142, v142, v241
v_min_u32 v142, -2, v142
v_add_f32_dpp v143, v143, v143 row_ror:8 row_mask:0xf bank_mask:0xf
s_nop 1
v_add_f32_dpp v143, v143, v143 row_ror:4 row_mask:0xf bank_mask:0xf
s_nop 1
v_add_f32_dpp v143, v143, v143 row_ror:2 row_mask:0xf bank_mask:0xf
s_nop 1
v_add_f32_dpp v143, v143, v143 row_ror:1 row_mask:0xf bank_mask:0xf
v_mov_b32 v241, v143
s_nop 1
v_permlane16_swap_b32 v143, v241
v_add_f32 v143, v143, v241
v_mov_b32 v241, v143
s_nop 1
v_permlane32_swap_b32 v143, v241
v_add_f32 v143, v143, v241
v_min_u32 v143, -2, v143
s_lshl_b32 s44, s2, 4
s_add_u32 s44, s44, 393216
v_lshlrev_b32_e64 v241, 9, v240
s_mov_b64 exec, 0xff
buffer_store_dwordx4 v[140:143], v241, s[32:35], s44 offen sc1
s_mov_b64 exec, -1
s_mov_b32 s77, 2
s_and_b32 s44, s2, 7
s_lshl_b32 s44, s44, 11
s_add_u32 s44, s44, 393216
buffer_load_dword v128, v240, s[32:35], s44 offen sc1
buffer_load_dword v129, v240, s[32:35], s44 offen offset:256 sc1
buffer_load_dword v130, v240, s[32:35], s44 offen offset:512 sc1
buffer_load_dword v131, v240, s[32:35], s44 offen offset:768 sc1
buffer_load_dword v132, v240, s[32:35], s44 offen offset:1024 sc1
buffer_load_dword v133, v240, s[32:35], s44 offen offset:1280 sc1
v_lshrrev_b32 v241, 1, v240
buffer_load_ushort v134, v241, s[24:27], 0 offen
buffer_load_ushort v135, v241, s[24:27], 0 offen offset:128
buffer_load_ushort v136, v241, s[24:27], 0 offen offset:256
buffer_load_ushort v137, v241, s[24:27], 0 offen offset:384
buffer_load_ushort v138, v241, s[24:27], 0 offen offset:512
buffer_load_ushort v139, v241, s[24:27], 0 offen offset:640
s_setpc_b64 s[78:79]
LpollC:
v_max3_u32 v241, v128, v129, v130
v_max3_u32 v241, v241, v131, v132
v_max_u32 v241, v241, v133
v_cmp_eq_u32 vcc, -1, v241
s_nop 4
s_cbranch_vccz LpollS
s_and_b32 s44, s2, 7
s_lshl_b32 s44, s44, 11
s_add_u32 s44, s44, 393216
buffer_load_dword v128, v240, s[32:35], s44 offen sc1
buffer_load_dword v129, v240, s[32:35], s44 offen offset:256 sc1
buffer_load_dword v130, v240, s[32:35], s44 offen offset:512 sc1
buffer_load_dword v131, v240, s[32:35], s44 offen offset:768 sc1
buffer_load_dword v132, v240, s[32:35], s44 offen offset:1024 sc1
buffer_load_dword v133, v240, s[32:35], s44 offen offset:1280 sc1
s_setpc_b64 s[78:79]
LpollS:
s_mov_b32 s43, 1083289508
v_mov_b32 v242, 897988541
v_fma_f32 v128, v128, s43, v242
v_sqrt_f32 v128, v128
v_lshlrev_b32_e64 v134, 16, v134
v_fma_f32 v129, v129, s43, v242
v_sqrt_f32 v129, v129
v_lshlrev_b32 v135, 16, v135
v_fma_f32 v130, v130, s43, v242
v_sqrt_f32 v130, v130
v_lshlrev_b32 v136, 16, v136
v_fma_f32 v131, v131, s43, v242
v_sqrt_f32 v131, v131
v_lshlrev_b32 v137, 16, v137
v_fma_f32 v132, v132, s43, v242
v_sqrt_f32 v132, v132
v_lshlrev_b32 v138, 16, v138
v_fma_f32 v133, v133, s43, v242
v_sqrt_f32 v133, v133
v_lshlrev_b32 v139, 16, v139
v_add_f32 v243, v128, v129
v_add_f32 v243, v243, v130
v_add_f32 v243, v243, v131
v_add_f32 v243, v243, v132
v_add_f32 v243, v243, v133
s_nop 1
v_add_f32_dpp v243, v243, v243 row_ror:8 row_mask:0xf bank_mask:0xf
s_nop 1
v_add_f32_dpp v243, v243, v243 row_ror:4 row_mask:0xf bank_mask:0xf
s_nop 1
v_add_f32_dpp v243, v243, v243 row_ror:2 row_mask:0xf bank_mask:0xf
s_nop 1
v_add_f32_dpp v243, v243, v243 row_ror:1 row_mask:0xf bank_mask:0xf
v_mov_b32 v241, v243
s_nop 1
v_permlane16_swap_b32 v243, v241
v_add_f32 v243, v243, v241
v_mov_b32 v241, v243
s_nop 1
v_permlane32_swap_b32 v243, v241
v_add_f32_e64 v243, v243, v241
s_mov_b32 s43, 992651947
v_fma_f32 v243, v243, s43, v242
v_rcp_f32 v243, v243
s_nop 0
v_mul_f32_e64 v128, v128, v243
v_fma_f32 v128, v128, v134, 1.0
v_mul_f32 v128, 3221786265, v128
v_mul_f32_e64 v129, v129, v243
v_fma_f32 v129, v129, v135, 1.0
v_mul_f32 v129, 3221786265, v129
v_mul_f32_e64 v130, v130, v243
v_fma_f32 v130, v130, v136, 1.0
v_mul_f32 v130, 3221786265, v130
v_mul_f32_e64 v131, v131, v243
v_fma_f32 v131, v131, v137, 1.0
v_mul_f32 v131, 3221786265, v131
v_mul_f32_e64 v132, v132, v243
v_fma_f32 v132, v132, v138, 1.0
v_mul_f32 v132, 3221786265, v132
v_mul_f32_e64 v133, v133, v243
v_fma_f32 v133, v133, v139, 1.0
v_mul_f32 v133, 3221786265, v133
s_mov_b32 s77, 0
s_nop 1
s_setpc_b64 s[78:79]
Lend:
s_endpgm

.section .rodata,"a"
.p2align 6
.amdhsa_kernel standalone__modern_conv_block_convnext_v2__vision_kernel
  .amdhsa_next_free_vgpr 256
  .amdhsa_next_free_sgpr 102
  .amdhsa_accum_offset 256
  .amdhsa_group_segment_fixed_size 0
  .amdhsa_kernarg_size 72
  .amdhsa_user_sgpr_count 2
  .amdhsa_user_sgpr_kernarg_segment_ptr 1
  .amdhsa_system_sgpr_workgroup_id_x 1
.end_amdhsa_kernel
```

```asm
; @launch grid=(256,1,1) block=(512,1,1) lds=163840
.amdgcn_target "amdgcn-amd-amdhsa--gfx950"
.text
.globl standalone__modern_conv_block_convnext_v2__vision_kernel
.p2align 8
.type standalone__modern_conv_block_convnext_v2__vision_kernel,@function
standalone__modern_conv_block_convnext_v2__vision_kernel:
s_cmp_ge_u32 s2, 256
s_cbranch_scc1 Lend
s_load_dwordx16 s[80:95], s[0:1], 0
s_load_dwordx2 s[96:97], s[0:1], 64
v_mov_b32 v119, v0
v_and_b32 v118, 63, v0
v_lshrrev_b32 v120, 6, v0
s_nop 0
v_readfirstlane_b32 s40, v120
s_getpc_b64 s[74:75]
Lpc:
s_lshr_b32 s43, s2, 3
s_and_b32 s43, s43, 15
s_lshl_b32 s43, s43, 13
v_lshrrev_b32_e64 v122, 3, v0
v_lshl_add_u32 v122, v122, 7, s43
v_min_u32 v122, Lend-Lpc, v122
global_load_dword v112, v122, s[74:75]
s_and_b32 s43, s2, 7
s_lshr_b32 s44, s2, 3
s_and_b32 s41, s43, 3
s_lshl_b32 s41, s41, 2
s_and_b32 s45, s44, 3
s_add_u32 s41, s41, s45
s_lshr_b32 s42, s43, 2
s_lshl_b32 s42, s42, 3
s_lshr_b32 s45, s44, 2
s_add_u32 s42, s42, s45
s_lshl_b32 s41, s41, 5
s_lshl_b32 s42, s42, 5
s_and_b32 s43, s40, 3
s_mul_i32 s43, s43, 1536
s_add_u32 s67, s43, 90112
s_mul_i32 s44, s41, 192
s_add_u32 s43, s43, s44
s_sub_u32 s43, s43, 192
v_lshl_add_u32 v121, v118, 4, s43
v_add_u32 v123, 896, v121
v_mov_b32 v122, 2147483648
s_mov_b32 s44, 98304
v_cmp_gt_u32 vcc, s44, v121
s_nop 1
v_cndmask_b32 v236, v122, v121, vcc
v_cmp_gt_u32 vcc, s44, v123
s_nop 1
v_cndmask_b32 v237, v122, v123, vcc
s_mul_i32 s66, s42, 98304
v_min_u32 v128, 215, v119
v_lshlrev_b32_e64 v130, 3, v128
v_lshlrev_b32 v250, 4, v118
s_waitcnt lgkmcnt(0)
s_mov_b32 s4, s80
s_and_b32 s5, s81, 65535
s_mov_b32 s6, 50331648
s_mov_b32 s7, 131072
s_cmp_ge_u32 s40, 4
s_cbranch_scc1 Lrowb
s_mov_b32 s20, s82
s_and_b32 s21, s83, 65535
s_mov_b32 s22, 1728
s_mov_b32 s23, 131072
buffer_load_dwordx2 v[126:127], v130, s[20:23], 0 offen
s_add_u32 m0, s67, 0
s_sub_u32 s45, s66, 98304
s_cmp_eq_u32 s42, 0
s_cselect_b32 s45, 1073741824, s45
buffer_load_dwordx4 v236, s[4:7], s45 offen lds
s_add_u32 m0, s67, 6592
s_nop 0
buffer_load_dwordx4 v236, s[4:7], s66 offen lds
s_add_u32 m0, s67, 13200
s_add_u32 s66, s66, 98304
buffer_load_dwordx4 v236, s[4:7], s66 offen lds
s_add_u32 m0, s67, 19792
s_add_u32 s66, s66, 98304
buffer_load_dwordx4 v236, s[4:7], s66 offen lds
s_add_u32 m0, s67, 26400
s_add_u32 s66, s66, 98304
buffer_load_dwordx4 v236, s[4:7], s66 offen lds
s_add_u32 m0, s67, 32992
s_add_u32 s66, s66, 98304
buffer_load_dwordx4 v236, s[4:7], s66 offen lds
s_add_u32 m0, s67, 39600
s_add_u32 s66, s66, 98304
buffer_load_dwordx4 v236, s[4:7], s66 offen lds
s_add_u32 m0, s67, 46192
s_add_u32 s66, s66, 98304
buffer_load_dwordx4 v236, s[4:7], s66 offen lds
s_add_u32 m0, s67, 52736
s_add_u32 s66, s66, 98304
buffer_load_dwordx4 v236, s[4:7], s66 offen lds
s_add_u32 m0, s67, 59328
s_add_u32 s66, s66, 98304
buffer_load_dwordx4 v236, s[4:7], s66 offen lds
s_branch Lsetup
Lrowb:
s_add_u32 m0, s67, 896
s_sub_u32 s45, s66, 98304
s_cmp_eq_u32 s42, 0
s_cselect_b32 s45, 1073741824, s45
buffer_load_dwordx4 v237, s[4:7], s45 offen lds
s_add_u32 m0, s67, 7488
s_nop 0
buffer_load_dwordx4 v237, s[4:7], s66 offen lds
s_add_u32 m0, s67, 14096
s_add_u32 s66, s66, 98304
buffer_load_dwordx4 v237, s[4:7], s66 offen lds
s_add_u32 m0, s67, 20688
s_add_u32 s66, s66, 98304
buffer_load_dwordx4 v237, s[4:7], s66 offen lds
s_add_u32 m0, s67, 27296
s_add_u32 s66, s66, 98304
buffer_load_dwordx4 v237, s[4:7], s66 offen lds
s_add_u32 m0, s67, 33888
s_add_u32 s66, s66, 98304
buffer_load_dwordx4 v237, s[4:7], s66 offen lds
s_add_u32 m0, s67, 40496
s_add_u32 s66, s66, 98304
buffer_load_dwordx4 v237, s[4:7], s66 offen lds
s_add_u32 m0, s67, 47088
s_add_u32 s66, s66, 98304
buffer_load_dwordx4 v237, s[4:7], s66 offen lds
s_add_u32 m0, s67, 53632
s_add_u32 s66, s66, 98304
buffer_load_dwordx4 v237, s[4:7], s66 offen lds
s_add_u32 m0, s67, 60224
s_add_u32 s66, s66, 98304
buffer_load_dwordx4 v237, s[4:7], s66 offen lds
s_mov_b32 s12, s84
s_and_b32 s13, s85, 65535
s_mov_b32 s14, 73728
s_mov_b32 s15, 131072
v_lshrrev_b32 v115, 2, v118
v_mul_u32_u24 v115, 768, v115
v_and_b32_e64 v125, 3, v118
v_lshl_add_u32 v115, v125, 4, v115
s_and_b32 s43, s40, 3
s_add_u32 s43, s43, 0
s_mul_i32 s44, s43, 43
s_lshr_b32 s44, s44, 8
s_lshl_b32 s46, s43, 10
s_add_u32 m0, s46, 16384
s_mul_i32 s46, s44, 6
s_sub_u32 s43, s43, s46
s_mul_i32 s43, s43, 12288
s_lshl_b32 s44, s44, 6
s_add_u32 s43, s43, s44
buffer_load_dwordx4 v115, s[12:15], s43 offen lds
s_and_b32 s43, s40, 3
s_add_u32 s43, s43, 4
s_mul_i32 s44, s43, 43
s_lshr_b32 s44, s44, 8
s_lshl_b32 s46, s43, 10
s_add_u32 m0, s46, 16384
s_mul_i32 s46, s44, 6
s_sub_u32 s43, s43, s46
s_mul_i32 s43, s43, 12288
s_lshl_b32 s44, s44, 6
s_add_u32 s43, s43, s44
buffer_load_dwordx4 v115, s[12:15], s43 offen lds
s_and_b32 s43, s40, 3
s_add_u32 s43, s43, 8
s_mul_i32 s44, s43, 43
s_lshr_b32 s44, s44, 8
s_lshl_b32 s46, s43, 10
s_add_u32 m0, s46, 16384
s_mul_i32 s46, s44, 6
s_sub_u32 s43, s43, s46
s_mul_i32 s43, s43, 12288
s_lshl_b32 s44, s44, 6
s_add_u32 s43, s43, s44
buffer_load_dwordx4 v115, s[12:15], s43 offen lds
s_and_b32 s43, s40, 3
s_add_u32 s43, s43, 12
s_mul_i32 s44, s43, 43
s_lshr_b32 s44, s44, 8
s_lshl_b32 s46, s43, 10
s_add_u32 m0, s46, 16384
s_mul_i32 s46, s44, 6
s_sub_u32 s43, s43, s46
s_mul_i32 s43, s43, 12288
s_lshl_b32 s44, s44, 6
s_add_u32 s43, s43, s44
buffer_load_dwordx4 v115, s[12:15], s43 offen lds
s_and_b32 s43, s40, 3
s_add_u32 s43, s43, 16
s_mul_i32 s44, s43, 43
s_lshr_b32 s44, s44, 8
s_lshl_b32 s46, s43, 10
s_add_u32 m0, s46, 16384
s_mul_i32 s46, s44, 6
s_sub_u32 s43, s43, s46
s_mul_i32 s43, s43, 12288
s_lshl_b32 s44, s44, 6
s_add_u32 s43, s43, s44
buffer_load_dwordx4 v115, s[12:15], s43 offen lds
s_and_b32 s43, s40, 3
s_add_u32 s43, s43, 20
s_mul_i32 s44, s43, 43
s_lshr_b32 s44, s44, 8
s_lshl_b32 s46, s43, 10
s_add_u32 m0, s46, 16384
s_mul_i32 s46, s44, 6
s_sub_u32 s43, s43, s46
s_mul_i32 s43, s43, 12288
s_lshl_b32 s44, s44, 6
s_add_u32 s43, s43, s44
buffer_load_dwordx4 v115, s[12:15], s43 offen lds
v_bfe_u32 v141, v250, 4, 6
v_and_b32 v140, 15, v141
v_lshlrev_b32 v140, 7, v140
v_lshrrev_b32 v141, 4, v141
v_mul_u32_u24 v141, 98304, v141
s_sub_u32 s43, s67, -8000
s_mul_i32 s44, s41, 192
s_add_u32 s43, s43, s44
v_add3_u32 v140, v140, v141, s43
s_mov_b32 m0, 163840
s_add_u32 s44, s66, 393216
buffer_load_dword v140, s[4:7], s66 offen lds
buffer_load_dword v140, s[4:7], s44 offen lds
s_waitcnt vmcnt(8)
s_barrier
s_setprio 0
s_and_b32 s43, s40, 3
s_add_u32 s43, s43, 24
s_mul_i32 s44, s43, 43
s_lshr_b32 s44, s44, 8
s_lshl_b32 s46, s43, 10
s_add_u32 m0, s46, 16384
s_mul_i32 s46, s44, 6
s_sub_u32 s43, s43, s46
s_mul_i32 s43, s43, 12288
s_lshl_b32 s44, s44, 6
s_add_u32 s43, s43, s44
buffer_load_dwordx4 v115, s[12:15], s43 offen lds
s_and_b32 s43, s40, 3
s_add_u32 s43, s43, 28
s_mul_i32 s44, s43, 43
s_lshr_b32 s44, s44, 8
s_lshl_b32 s46, s43, 10
s_add_u32 m0, s46, 16384
s_mul_i32 s46, s44, 6
s_sub_u32 s43, s43, s46
s_mul_i32 s43, s43, 12288
s_lshl_b32 s44, s44, 6
s_add_u32 s43, s43, s44
buffer_load_dwordx4 v115, s[12:15], s43 offen lds
s_and_b32 s43, s40, 3
s_add_u32 s43, s43, 32
s_mul_i32 s44, s43, 43
s_lshr_b32 s44, s44, 8
s_lshl_b32 s46, s43, 10
s_add_u32 m0, s46, 16384
s_mul_i32 s46, s44, 6
s_sub_u32 s43, s43, s46
s_mul_i32 s43, s43, 12288
s_lshl_b32 s44, s44, 6
s_add_u32 s43, s43, s44
buffer_load_dwordx4 v115, s[12:15], s43 offen lds
s_and_b32 s43, s40, 3
s_add_u32 s43, s43, 36
s_mul_i32 s44, s43, 43
s_lshr_b32 s44, s44, 8
s_lshl_b32 s46, s43, 10
s_add_u32 m0, s46, 16384
s_mul_i32 s46, s44, 6
s_sub_u32 s43, s43, s46
s_mul_i32 s43, s43, 12288
s_lshl_b32 s44, s44, 6
s_add_u32 s43, s43, s44
buffer_load_dwordx4 v115, s[12:15], s43 offen lds
s_and_b32 s43, s40, 3
s_add_u32 s43, s43, 40
s_mul_i32 s44, s43, 43
s_lshr_b32 s44, s44, 8
s_lshl_b32 s46, s43, 10
s_add_u32 m0, s46, 16384
s_mul_i32 s46, s44, 6
s_sub_u32 s43, s43, s46
s_mul_i32 s43, s43, 12288
s_lshl_b32 s44, s44, 6
s_add_u32 s43, s43, s44
buffer_load_dwordx4 v115, s[12:15], s43 offen lds
s_and_b32 s43, s40, 3
s_add_u32 s43, s43, 44
s_mul_i32 s44, s43, 43
s_lshr_b32 s44, s44, 8
s_lshl_b32 s46, s43, 10
s_add_u32 m0, s46, 16384
s_mul_i32 s46, s44, 6
s_sub_u32 s43, s43, s46
s_mul_i32 s43, s43, 12288
s_lshl_b32 s44, s44, 6
s_add_u32 s43, s43, s44
buffer_load_dwordx4 v115, s[12:15], s43 offen lds
s_and_b32 s43, s40, 3
s_add_u32 s43, s43, 48
s_mul_i32 s44, s43, 43
s_lshr_b32 s44, s44, 8
s_lshl_b32 s46, s43, 10
s_add_u32 m0, s46, 16384
s_mul_i32 s46, s44, 6
s_sub_u32 s43, s43, s46
s_mul_i32 s43, s43, 12288
s_lshl_b32 s44, s44, 6
s_add_u32 s43, s43, s44
buffer_load_dwordx4 v115, s[12:15], s43 offen lds
s_and_b32 s43, s40, 3
s_add_u32 s43, s43, 52
s_mul_i32 s44, s43, 43
s_lshr_b32 s44, s44, 8
s_lshl_b32 s46, s43, 10
s_add_u32 m0, s46, 16384
s_mul_i32 s46, s44, 6
s_sub_u32 s43, s43, s46
s_mul_i32 s43, s43, 12288
s_lshl_b32 s44, s44, 6
s_add_u32 s43, s43, s44
buffer_load_dwordx4 v115, s[12:15], s43 offen lds
s_and_b32 s43, s40, 3
s_add_u32 s43, s43, 56
s_mul_i32 s44, s43, 43
s_lshr_b32 s44, s44, 8
s_lshl_b32 s46, s43, 10
s_add_u32 m0, s46, 16384
s_mul_i32 s46, s44, 6
s_sub_u32 s43, s43, s46
s_mul_i32 s43, s43, 12288
s_lshl_b32 s44, s44, 6
s_add_u32 s43, s43, s44
buffer_load_dwordx4 v115, s[12:15], s43 offen lds
s_and_b32 s43, s40, 3
s_add_u32 s43, s43, 60
s_mul_i32 s44, s43, 43
s_lshr_b32 s44, s44, 8
s_lshl_b32 s46, s43, 10
s_add_u32 m0, s46, 16384
s_mul_i32 s46, s44, 6
s_sub_u32 s43, s43, s46
s_mul_i32 s43, s43, 12288
s_lshl_b32 s44, s44, 6
s_add_u32 s43, s43, s44
buffer_load_dwordx4 v115, s[12:15], s43 offen lds
s_and_b32 s43, s40, 3
s_add_u32 s43, s43, 64
s_mul_i32 s44, s43, 43
s_lshr_b32 s44, s44, 8
s_lshl_b32 s46, s43, 10
s_add_u32 m0, s46, 16384
s_mul_i32 s46, s44, 6
s_sub_u32 s43, s43, s46
s_mul_i32 s43, s43, 12288
s_lshl_b32 s44, s44, 6
s_add_u32 s43, s43, s44
buffer_load_dwordx4 v115, s[12:15], s43 offen lds
s_and_b32 s43, s40, 3
s_add_u32 s43, s43, 68
s_mul_i32 s44, s43, 43
s_lshr_b32 s44, s44, 8
s_lshl_b32 s46, s43, 10
s_add_u32 m0, s46, 16384
s_mul_i32 s46, s44, 6
s_sub_u32 s43, s43, s46
s_mul_i32 s43, s43, 12288
s_lshl_b32 s44, s44, 6
s_add_u32 s43, s43, s44
buffer_load_dwordx4 v115, s[12:15], s43 offen lds
Lsetup:
s_mov_b32 s16, s86
s_and_b32 s17, s87, 65535
s_mov_b32 s18, 73728
s_mov_b32 s19, 131072
s_mov_b32 s24, s88
s_and_b32 s25, s89, 65535
s_mov_b32 s26, 768
s_mov_b32 s27, 131072
s_mov_b32 s28, s90
s_and_b32 s29, s91, 65535
s_mov_b32 s30, 768
s_mov_b32 s31, 131072
s_mov_b32 s8, s92
s_and_b32 s9, s93, 65535
s_mov_b32 s10, 50331648
s_mov_b32 s11, 131072
s_mov_b32 s36, s94
s_and_b32 s37, s95, 65535
s_mov_b32 s38, 256
s_mov_b32 s39, 131072
s_mov_b32 s32, s96
s_and_b32 s33, s97, 65535
s_mov_b32 s34, 83886080
s_mov_b32 s35, 131072
v_lshlrev_b32_e64 v250, 4, v118
v_add_u32 v250, 16384, v250
v_lshlrev_b32_e64 v251, 4, v118
v_add_u32 v251, 81920, v251
v_lshlrev_b32_e64 v252, 4, v118
v_add_u32 v252, 147456, v252
s_lshl_b32 s73, s2, 3
s_add_u32 s73, s73, s40
s_lshl_b32 s80, s73, 10
s_add_u32 s80, s80, 4177920
s_mul_i32 s73, s73, 16
s_add_u32 s73, s73, 1048576
s_mov_b32 s48, 1156203754
s_mov_b32 s49, 4294508536
v_and_b32 v131, 15, v118
v_lshrrev_b32 v132, 4, v118
v_and_b32_e64 v133, 3, v131
v_mul_u32_u24 v134, 13200, v133
v_lshrrev_b32_e64 v133, 2, v131
v_lshl_add_u32 v133, v133, 1, v132
v_mul_u32_u24 v133, 192, v133
s_sub_u32 s43, s67, 90112
v_add3_u32 v246, v133, v134, s43
v_bfe_u32 v133, v131, 2, 1
v_sub_u32 v133, v132, v133
v_lshrrev_b32 v134, 3, v131
v_and_b32_e64 v135, 3, v131
v_lshl_add_u32 v135, v134, 2, v135
v_lshlrev_b32_e64 v136, 6, v133
v_lshl_add_u32 v136, v135, 3, v136
v_add_u32 v136, 156040, v136
v_mov_b32 v137, 156032
v_cmp_gt_u32 vcc, 3, v133
s_nop 1
v_cndmask_b32 v136, v137, v136, vcc
v_cmp_eq_u32 vcc, 0, v134
s_nop 1
v_cndmask_b32 v238, v137, v136, vcc
v_cndmask_b32 v239, v136, v137, vcc
v_lshrrev_b32 v133, 2, v131
v_bfe_u32 v135, v131, 1, 1
v_cmp_eq_u32 vcc, v133, v132
s_nop 1
v_cndmask_b32 v135, 8, v135, vcc
v_cmp_eq_u32 s[88:89], 0, v135
v_cmp_eq_u32 s[90:91], 1, v135
v_lshlrev_b32 v254, 5, v132
v_add_u32 v254, 7936, v254
v_lshlrev_b32 v253, 4, v132
v_and_b32 v131, 31, v118
v_lshrrev_b32_e64 v132, 5, v118
v_bfe_u32 v133, v131, 2, 1
v_bfe_u32 v134, v131, 3, 1
v_bfe_u32 v135, v131, 1, 1
v_lshrrev_b32 v136, 4, v131
v_lshl_add_u32 v135, v136, 1, v135
v_lshl_add_u32 v135, v134, 2, v135
v_cmp_eq_u32 vcc, v133, v132
s_nop 1
v_cndmask_b32 v135, 8, v135, vcc
v_cmp_eq_u32 s[50:51], 0, v135
v_cmp_eq_u32 s[52:53], 1, v135
v_cmp_eq_u32 s[54:55], 2, v135
v_cmp_eq_u32 s[56:57], 3, v135
v_cmp_eq_u32 s[58:59], 4, v135
v_cmp_eq_u32 s[60:61], 5, v135
v_cmp_eq_u32 s[62:63], 6, v135
v_cmp_eq_u32 s[64:65], 7, v135
v_and_b32 v136, 1, v131
v_lshlrev_b32 v136, 4, v136
v_mov_b32 v255, 16256
v_lshlrev_b32 v255, v136, v255
v_and_b32 v137, 19, v131
v_lshl_add_u32 v137, v133, 3, v137
v_lshl_add_u32 v137, v134, 2, v137
v_lshlrev_b32_e64 v137, 2, v137
v_lshl_add_u32 v137, v132, 7, v137
s_mul_i32 s82, s40, 9216
s_add_u32 s72, s82, 90112
v_add_u32 v248, s72, v137
v_and_b32 v133, 3, v118
v_mul_u32_u24 v134, 196608, v133
v_bfe_u32 v133, v118, 2, 2
v_mul_u32_u24 v133, 384, v133
v_add3_u32 v253, v253, v133, v134
s_mul_i32 s46, s41, 192
s_add_u32 s46, s46, s67
s_sub_u32 s46, s46, 90112
s_and_b32 s83, s40, 4
s_lshl_b32 s44, s83, 1
s_add_u32 s44, s44, s42
s_add_u32 s43, s44, 0
s_mul_i32 s43, s43, 98304
s_add_u32 s68, s43, s46
s_add_u32 s43, s44, 1
s_mul_i32 s43, s43, 98304
s_add_u32 s69, s43, s46
s_add_u32 s43, s44, 16
s_mul_i32 s43, s43, 98304
s_add_u32 s70, s43, s46
s_add_u32 s43, s44, 17
s_mul_i32 s43, s43, 98304
s_add_u32 s71, s43, s46
s_mov_b32 s92, 2863311530
s_mov_b32 s94, 3435973836
s_mov_b32 s93, 2863311530
s_mov_b32 s95, 3435973836
s_mov_b32 s81, 59328
s_mov_b32 s76, 200000
v_mov_b32 v247, 8128
v_lshrrev_b32 v148, 5, v118
v_lshlrev_b32 v116, 8, v148
v_bfe_u32 v148, v118, 2, 2
v_lshl_add_u32 v116, v148, 6, v116
v_bfe_u32 v148, v118, 4, 1
v_lshl_add_u32 v116, v148, 5, v116
v_and_b32_e64 v148, 1, v118
v_lshl_add_u32 v116, v148, 4, v116
v_bfe_u32 v148, v118, 1, 1
v_lshl_add_u32 v116, v148, 3, v116
s_and_b32 s43, s40, 3
s_lshl_b32 s43, s43, 10
v_add_u32_e64 v117, s43, v250
s_add_u32 s43, s43, 16384
v_add_u32 v116, s43, v116
v_mov_b32 v224, 0
v_mov_b32 v225, 0
v_mov_b32 v226, 0
v_mov_b32 v227, 0
v_mov_b32 v228, 0
v_mov_b32 v229, 0
v_mov_b32 v230, 0
v_mov_b32 v231, 0
v_mov_b32 v232, 0
v_mov_b32 v233, 0
v_mov_b32 v234, 0
v_mov_b32 v235, 0
s_cmp_ge_u32 s40, 4
s_cbranch_scc1 Lwa
v_mov_b32 v65, 0
v_mov_b32 v67, 0
v_mov_b32 v68, 0
v_mov_b32 v70, 0
v_mov_b32 v72, 0
v_mov_b32 v73, 0
v_min_u32 v140, 35, v119
v_mul_u32_u24 v140, 200, v140
v_add_u32 v140, 156032, v140
v_and_b32 v141, 31, v119
v_lshlrev_b32 v141, 3, v141
v_bfe_u32 v142, v119, 5, 1
v_lshl_add_u32 v141, v142, 13, v141
v_add_u32 v141, 7936, v141
v_cmp_gt_u32 vcc, 64, v119
s_nop 1
v_cndmask_b32 v140, v141, v140, vcc
ds_write_b64 v140, v[72:73]
v_lshrrev_b32 v140, 1, v128
v_mul_u32_u24 v141, 57, v140
v_lshrrev_b32 v141, 11, v141
v_mul_u32_u24 v142, 171, v140
v_lshrrev_b32_e64 v142, 11, v142
v_mul_u32_u24 v140, 200, v140
v_mul_u32_u24 v142, 2336, v142
v_mul_u32_u24 v141, 2208, v141
v_sub_u32 v140, v140, v142
v_add_u32 v140, v140, v141
v_and_b32_e64 v141, 1, v128
v_lshl_add_u32 v140, v141, 5, v140
v_add_u32 v140, 156040, v140
v_and_b32 v120, 255, v119
v_lshlrev_b32 v121, 8, v120
v_add_u32 v0, 4, v121
v_cvt_f32_f16 v0, v0
v_add_u32 v1, 12, v121
v_cvt_f32_f16 v1, v1
v_add_u32 v2, 20, v121
v_cvt_f32_f16 v2, v2
v_add_u32 v3, 28, v121
v_cvt_f32_f16 v3, v3
v_add_u32 v4, 36, v121
v_cvt_f32_f16 v4, v4
v_add_u32 v5, 44, v121
v_cvt_f32_f16 v5, v5
v_add_u32 v6, 52, v121
v_cvt_f32_f16 v6, v6
v_add_u32 v7, 60, v121
v_cvt_f32_f16_e64 v7, v7
v_add_u32 v8, 68, v121
v_cvt_f32_f16_e64 v8, v8
v_add_u32 v9, 76, v121
v_cvt_f32_f16_e64 v9, v9
v_add_u32 v10, 84, v121
v_cvt_f32_f16_e64 v10, v10
v_add_u32 v11, 92, v121
v_cvt_f32_f16_e64 v11, v11
v_add_u32 v12, 100, v121
v_cvt_f32_f16_e64 v12, v12
v_add_u32 v13, 108, v121
v_cvt_f32_f16_e64 v13, v13
v_add_u32 v14, 116, v121
v_cvt_f32_f16_e64 v14, v14
v_add_u32 v15, 124, v121
v_cvt_f32_f16_e64 v15, v15
v_add_u32 v16, 132, v121
v_cvt_f32_f16_e64 v16, v16
v_add_u32 v17, 140, v121
v_cvt_f32_f16_e64 v17, v17
v_add_u32 v18, 148, v121
v_cvt_f32_f16_e64 v18, v18
v_add_u32 v19, 156, v121
v_cvt_f32_f16_e64 v19, v19
v_add_u32 v20, 164, v121
v_cvt_f32_f16_e64 v20, v20
v_add_u32 v21, 172, v121
v_cvt_f32_f16_e64 v21, v21
v_add_u32 v22, 180, v121
v_cvt_f32_f16_e64 v22, v22
v_add_u32 v23, 188, v121
v_cvt_f32_f16_e64 v23, v23
v_add_u32 v24, 196, v121
v_cvt_f32_f16_e64 v24, v24
v_add_u32 v25, 204, v121
v_cvt_f32_f16_e64 v25, v25
v_add_u32 v26, 212, v121
v_cvt_f32_f16_e64 v26, v26
v_add_u32 v27, 220, v121
v_cvt_f32_f16_e64 v27, v27
v_add_u32 v28, 228, v121
v_cvt_f32_f16_e64 v28, v28
v_add_u32 v29, 236, v121
v_cvt_f32_f16_e64 v29, v29
v_add_u32 v30, 244, v121
v_cvt_f32_f16_e64 v30, v30
v_add_u32 v31, 252, v121
v_cvt_f32_f16_e64 v31, v31
v_fmaak_f32 v32, v0, v0, 0x409d30fc
v_mul_f32_e64 v32, v0, v32
v_fmaak_f32 v33, v1, v1, 0x409d30fc
v_mul_f32_e64 v33, v1, v33
v_fmaak_f32 v34, v2, v2, 0x409d30fc
v_mul_f32_e64 v34, v2, v34
v_fmaak_f32 v35, v3, v3, 0x409d30fc
v_mul_f32_e64 v35, v3, v35
v_fmaak_f32 v36, v4, v4, 0x409d30fc
v_mul_f32_e64 v36, v4, v36
v_fmaak_f32 v37, v5, v5, 0x409d30fc
v_mul_f32_e64 v37, v5, v37
v_fmaak_f32 v38, v6, v6, 0x409d30fc
v_mul_f32_e64 v38, v6, v38
v_fmaak_f32 v39, v7, v7, 0x409d30fc
v_mul_f32_e64 v39, v7, v39
v_fmaak_f32 v40, v8, v8, 0x409d30fc
v_mul_f32_e64 v40, v8, v40
v_fmaak_f32 v41, v9, v9, 0x409d30fc
v_mul_f32_e64 v41, v9, v41
v_fmaak_f32 v42, v10, v10, 0x409d30fc
v_mul_f32_e64 v42, v10, v42
v_fmaak_f32 v43, v11, v11, 0x409d30fc
v_mul_f32_e64 v43, v11, v43
v_fmaak_f32 v44, v12, v12, 0x409d30fc
v_mul_f32_e64 v44, v12, v44
v_fmaak_f32 v45, v13, v13, 0x409d30fc
v_mul_f32_e64 v45, v13, v45
v_fmaak_f32 v46, v14, v14, 0x409d30fc
v_mul_f32_e64 v46, v14, v46
v_fmaak_f32 v47, v15, v15, 0x409d30fc
v_mul_f32_e64 v47, v15, v47
v_fmaak_f32 v48, v16, v16, 0x409d30fc
v_mul_f32_e64 v48, v16, v48
v_fmaak_f32 v49, v17, v17, 0x409d30fc
v_mul_f32_e64 v49, v17, v49
v_fmaak_f32 v50, v18, v18, 0x409d30fc
v_mul_f32_e64 v50, v18, v50
v_fmaak_f32 v51, v19, v19, 0x409d30fc
v_mul_f32_e64 v51, v19, v51
v_fmaak_f32 v52, v20, v20, 0x409d30fc
v_mul_f32_e64 v52, v20, v52
v_fmaak_f32 v53, v21, v21, 0x409d30fc
v_mul_f32_e64 v53, v21, v53
v_fmaak_f32 v54, v22, v22, 0x409d30fc
v_mul_f32_e64 v54, v22, v54
v_fmaak_f32 v55, v23, v23, 0x409d30fc
v_mul_f32_e64 v55, v23, v55
v_fmaak_f32 v56, v24, v24, 0x409d30fc
v_mul_f32_e64 v56, v24, v56
v_fmaak_f32 v57, v25, v25, 0x409d30fc
v_mul_f32_e64 v57, v25, v57
v_fmaak_f32 v58, v26, v26, 0x409d30fc
v_mul_f32_e64 v58, v26, v58
v_fmaak_f32 v59, v27, v27, 0x409d30fc
v_mul_f32_e64 v59, v27, v59
v_fmaak_f32 v60, v28, v28, 0x409d30fc
v_mul_f32_e64 v60, v28, v60
v_fmaak_f32 v61, v29, v29, 0x409d30fc
v_mul_f32_e64 v61, v29, v61
v_fmaak_f32 v62, v30, v30, 0x409d30fc
v_mul_f32_e64 v62, v30, v62
v_fmaak_f32 v63, v31, v31, 0x409d30fc
v_mul_f32 v63, v31, v63
v_exp_f32 v32, v32
v_exp_f32 v33, v33
v_exp_f32 v34, v34
v_exp_f32 v35, v35
v_exp_f32 v36, v36
v_exp_f32 v37, v37
v_exp_f32 v38, v38
v_exp_f32 v39, v39
v_exp_f32 v40, v40
v_exp_f32 v41, v41
v_exp_f32 v42, v42
v_exp_f32 v43, v43
v_exp_f32 v44, v44
v_exp_f32 v45, v45
v_exp_f32 v46, v46
v_exp_f32 v47, v47
v_exp_f32 v48, v48
v_exp_f32 v49, v49
v_exp_f32 v50, v50
v_exp_f32 v51, v51
v_exp_f32 v52, v52
v_exp_f32 v53, v53
v_exp_f32 v54, v54
v_exp_f32 v55, v55
v_exp_f32 v56, v56
v_exp_f32 v57, v57
v_exp_f32 v58, v58
v_exp_f32 v59, v59
v_exp_f32 v60, v60
v_exp_f32 v61, v61
v_exp_f32 v62, v62
v_exp_f32 v63, v63
v_add_f32 v32, 1.0, v32
v_add_f32 v33, 1.0, v33
v_add_f32 v34, 1.0, v34
v_add_f32 v35, 1.0, v35
v_add_f32 v36, 1.0, v36
v_add_f32 v37, 1.0, v37
v_add_f32 v38, 1.0, v38
v_add_f32 v39, 1.0, v39
v_add_f32 v40, 1.0, v40
v_add_f32 v41, 1.0, v41
v_add_f32 v42, 1.0, v42
v_add_f32 v43, 1.0, v43
v_add_f32 v44, 1.0, v44
v_add_f32 v45, 1.0, v45
v_add_f32 v46, 1.0, v46
v_add_f32 v47, 1.0, v47
v_add_f32 v48, 1.0, v48
v_add_f32 v49, 1.0, v49
v_add_f32 v50, 1.0, v50
v_add_f32 v51, 1.0, v51
v_add_f32 v52, 1.0, v52
v_add_f32 v53, 1.0, v53
v_add_f32 v54, 1.0, v54
v_add_f32 v55, 1.0, v55
v_add_f32 v56, 1.0, v56
v_add_f32 v57, 1.0, v57
v_add_f32 v58, 1.0, v58
v_add_f32 v59, 1.0, v59
v_add_f32 v60, 1.0, v60
v_add_f32 v61, 1.0, v61
v_add_f32 v62, 1.0, v62
v_add_f32 v63, 1.0, v63
v_rcp_f32 v32, v32
v_rcp_f32 v33, v33
v_rcp_f32 v34, v34
v_rcp_f32 v35, v35
v_rcp_f32 v36, v36
v_rcp_f32 v37, v37
v_rcp_f32 v38, v38
v_rcp_f32 v39, v39
v_rcp_f32 v40, v40
v_rcp_f32 v41, v41
v_rcp_f32 v42, v42
v_rcp_f32 v43, v43
v_rcp_f32 v44, v44
v_rcp_f32 v45, v45
v_rcp_f32 v46, v46
v_rcp_f32 v47, v47
v_rcp_f32 v48, v48
v_rcp_f32 v49, v49
v_rcp_f32 v50, v50
v_rcp_f32 v51, v51
v_rcp_f32 v52, v52
v_rcp_f32 v53, v53
v_rcp_f32 v54, v54
v_rcp_f32 v55, v55
v_rcp_f32 v56, v56
v_rcp_f32 v57, v57
v_rcp_f32 v58, v58
v_rcp_f32 v59, v59
v_rcp_f32 v60, v60
v_rcp_f32 v61, v61
v_rcp_f32 v62, v62
v_rcp_f32 v63, v63
v_mul_f32 v0, v0, v32
v_mul_f32 v1, v1, v33
v_mul_f32 v2, v2, v34
v_mul_f32 v3, v3, v35
v_mul_f32 v4, v4, v36
v_mul_f32 v5, v5, v37
v_mul_f32 v6, v6, v38
v_mul_f32 v7, v7, v39
v_mul_f32 v8, v8, v40
v_mul_f32 v9, v9, v41
v_mul_f32 v10, v10, v42
v_mul_f32 v11, v11, v43
v_mul_f32 v12, v12, v44
v_mul_f32 v13, v13, v45
v_mul_f32 v14, v14, v46
v_mul_f32 v15, v15, v47
v_mul_f32 v16, v16, v48
v_mul_f32 v17, v17, v49
v_mul_f32 v18, v18, v50
v_mul_f32 v19, v19, v51
v_mul_f32 v20, v20, v52
v_mul_f32 v21, v21, v53
v_mul_f32 v22, v22, v54
v_mul_f32 v23, v23, v55
v_mul_f32 v24, v24, v56
v_mul_f32 v25, v25, v57
v_mul_f32 v26, v26, v58
v_mul_f32 v27, v27, v59
v_mul_f32 v28, v28, v60
v_mul_f32 v29, v29, v61
v_mul_f32 v30, v30, v62
v_mul_f32_e64 v31, v31, v63
v_cvt_pk_f16_f32 v32, v0, v1
v_cvt_pk_f16_f32 v33, v2, v3
v_cvt_pk_f16_f32 v34, v4, v5
v_cvt_pk_f16_f32 v35, v6, v7
v_cvt_pk_f16_f32 v36, v8, v9
v_cvt_pk_f16_f32 v37, v10, v11
v_cvt_pk_f16_f32 v38, v12, v13
v_cvt_pk_f16_f32 v39, v14, v15
v_cvt_pk_f16_f32 v40, v16, v17
v_cvt_pk_f16_f32 v41, v18, v19
v_cvt_pk_f16_f32 v42, v20, v21
v_cvt_pk_f16_f32 v43, v22, v23
v_cvt_pk_f16_f32 v44, v24, v25
v_cvt_pk_f16_f32 v45, v26, v27
v_cvt_pk_f16_f32 v46, v28, v29
v_cvt_pk_f16_f32 v47, v30, v31
v_add_u32 v32, 131074, v32
v_and_b32 v32, 4294770684, v32
v_add_u32 v33, 131074, v33
v_and_b32 v33, 4294770684, v33
v_add_u32 v34, 131074, v34
v_and_b32 v34, 4294770684, v34
v_add_u32 v35, 131074, v35
v_and_b32 v35, 4294770684, v35
v_add_u32 v36, 131074, v36
v_and_b32 v36, 4294770684, v36
v_add_u32 v37, 131074, v37
v_and_b32 v37, 4294770684, v37
v_add_u32 v38, 131074, v38
v_and_b32 v38, 4294770684, v38
v_add_u32 v39, 131074, v39
v_and_b32 v39, 4294770684, v39
v_add_u32 v40, 131074, v40
v_and_b32 v40, 4294770684, v40
v_add_u32 v41, 131074, v41
v_and_b32 v41, 4294770684, v41
v_add_u32 v42, 131074, v42
v_and_b32 v42, 4294770684, v42
v_add_u32 v43, 131074, v43
v_and_b32 v43, 4294770684, v43
v_add_u32 v44, 131074, v44
v_and_b32 v44, 4294770684, v44
v_add_u32 v45, 131074, v45
v_and_b32 v45, 4294770684, v45
v_add_u32 v46, 131074, v46
v_and_b32 v46, 4294770684, v46
v_add_u32 v47, 131074, v47
v_and_b32 v47, 4294770684, v47
v_lshlrev_b32 v121, 6, v120
v_bfe_u32 v120, v120, 2, 5
v_cmp_ne_u32 vcc, 31, v120
s_and_saveexec_b64 s[74:75], vcc
ds_write_b128 v121, v[32:35]
ds_write_b128 v121, v[36:39] offset:16
ds_write_b128 v121, v[40:43] offset:32
ds_write_b128 v121, v[44:47] offset:48
s_mov_b64 exec, s[74:75]
s_waitcnt vmcnt(10)
v_and_b32 v64, 65535, v126
ds_write_b64 v140, v[64:65]
v_and_b32 v66, 4294901760, v126
ds_write_b64 v140, v[66:67] offset:8
v_and_b32 v69, 65535, v127
ds_write_b64 v140, v[68:69] offset:16
v_and_b32 v71, 4294901760, v127
ds_write_b64 v140, v[70:71] offset:24
s_waitcnt vmcnt(0) lgkmcnt(0)
s_barrier
Lwa:
s_cmp_lt_u32 s40, 4
s_cbranch_scc1 Lsu1
s_waitcnt vmcnt(14)
v_add_u32 v113, 65536, v116
v_add_u32 v114, 65536, v117
ds_read_b64_tr_b16 v[0:1], v116
ds_read_b64_tr_b16 v[2:3], v116 offset:512
ds_read_b64_tr_b16 v[4:5], v116 offset:4096
ds_read_b64_tr_b16 v[6:7], v116 offset:4608
ds_read_b64_tr_b16 v[8:9], v116 offset:8192
ds_read_b64_tr_b16 v[10:11], v116 offset:8704
ds_read_b64_tr_b16 v[12:13], v116 offset:12288
ds_read_b64_tr_b16 v[14:15], v116 offset:12800
ds_read_b64_tr_b16 v[16:17], v116 offset:16384
ds_read_b64_tr_b16 v[18:19], v116 offset:16896
ds_read_b64_tr_b16 v[20:21], v116 offset:20480
ds_read_b64_tr_b16 v[22:23], v116 offset:20992
s_waitcnt lgkmcnt(10)
ds_write_b128 v117, v[0:3]
s_waitcnt lgkmcnt(9)
ds_write_b128 v117, v[4:7] offset:4096
s_waitcnt lgkmcnt(8)
ds_write_b128 v117, v[8:11] offset:8192
s_waitcnt lgkmcnt(7)
ds_write_b128 v117, v[12:15] offset:12288
s_waitcnt lgkmcnt(6)
ds_write_b128 v117, v[16:19] offset:16384
s_waitcnt lgkmcnt(5)
ds_write_b128 v117, v[20:23] offset:20480
v_mov_b32_e64 v223, 1
s_waitcnt lgkmcnt(0)
s_mov_b64 exec, 1
ds_add_u32 v247, v223 offset:8
s_mov_b64 exec, -1
s_nop 0
v_mov_b32_e64 v223, 0
s_branch Law1
Lax1:
s_sleep 2
Law1:
ds_read_b32 v223, v247 offset:16
s_sub_u32 s76, s76, 1
s_cselect_b32 s44, 4, 0
s_cselect_b32 s76, 0, s76
s_waitcnt lgkmcnt(0)
v_readfirstlane_b32 s43, v223
s_nop 1
s_max_u32 s43, s43, s44
s_cmp_lt_u32 s43, 4
s_cbranch_scc1 Lax1
s_add_u32 s81, s81, 6592
s_cmp_eq_u32 s81, 65920
s_cselect_b32 s81, 0, s81
s_add_u32 s43, s81, s67
s_add_u32 m0, s43, 16
s_add_u32 s66, s66, 98304
buffer_load_dwordx4 v236, s[4:7], s66 offen lds
s_add_u32 m0, s43, 912
s_nop 0
buffer_load_dwordx4 v237, s[4:7], s66 offen lds
s_add_u32 s81, s81, 6592
s_cmp_eq_u32 s81, 65920
s_cselect_b32 s81, 0, s81
s_add_u32 s43, s81, s67
s_add_u32 m0, s43, 16
s_add_u32 s66, s66, 98304
buffer_load_dwordx4 v236, s[4:7], s66 offen lds
s_add_u32 m0, s43, 912
s_nop 0
buffer_load_dwordx4 v237, s[4:7], s66 offen lds
s_add_u32 s81, s81, 6592
s_cmp_eq_u32 s81, 65920
s_cselect_b32 s81, 0, s81
s_add_u32 s43, s81, s67
s_add_u32 m0, s43, 32
s_add_u32 s66, s66, 98304
buffer_load_dwordx4 v236, s[4:7], s66 offen lds
s_add_u32 m0, s43, 928
s_nop 0
buffer_load_dwordx4 v237, s[4:7], s66 offen lds
s_add_u32 s81, s81, 6592
s_cmp_eq_u32 s81, 65920
s_cselect_b32 s81, 0, s81
s_add_u32 s43, s81, s67
s_add_u32 m0, s43, 32
s_add_u32 s66, s66, 98304
buffer_load_dwordx4 v236, s[4:7], s66 offen lds
s_add_u32 m0, s43, 928
s_nop 0
buffer_load_dwordx4 v237, s[4:7], s66 offen lds
s_add_u32 s81, s81, 6592
s_cmp_eq_u32 s81, 65920
s_cselect_b32 s81, 0, s81
s_add_u32 s43, s81, s67
s_add_u32 m0, s43, 48
s_add_u32 s66, s66, 98304
buffer_load_dwordx4 v236, s[4:7], s66 offen lds
s_add_u32 m0, s43, 944
s_nop 0
buffer_load_dwordx4 v237, s[4:7], s66 offen lds
s_add_u32 s81, s81, 6592
s_cmp_eq_u32 s81, 65920
s_cselect_b32 s81, 0, s81
s_add_u32 s43, s81, s67
s_add_u32 m0, s43, 48
s_add_u32 s66, s66, 98304
buffer_load_dwordx4 v236, s[4:7], s66 offen lds
s_add_u32 m0, s43, 944
s_nop 0
buffer_load_dwordx4 v237, s[4:7], s66 offen lds
s_add_u32 s81, s81, 6592
s_cmp_eq_u32 s81, 65920
s_cselect_b32 s81, 0, s81
s_add_u32 s43, s81, s67
s_add_u32 m0, s43, 0
s_add_u32 s66, s66, 98304
buffer_load_dwordx4 v236, s[4:7], s66 offen lds
s_add_u32 m0, s43, 896
s_nop 0
buffer_load_dwordx4 v237, s[4:7], s66 offen lds
s_add_u32 s81, s81, 6592
s_cmp_eq_u32 s81, 65920
s_cselect_b32 s81, 0, s81
s_add_u32 s43, s81, s67
s_add_u32 m0, s43, 0
s_add_u32 s66, s66, 98304
buffer_load_dwordx4 v236, s[4:7], s66 offen lds
s_add_u32 m0, s43, 896
s_nop 0
buffer_load_dwordx4 v237, s[4:7], s66 offen lds
s_waitcnt vmcnt(16)
v_add_u32 v113, 65536, v116
v_add_u32 v114, 65536, v117
ds_read_b64_tr_b16 v[0:1], v116 offset:24576
ds_read_b64_tr_b16 v[2:3], v116 offset:25088
ds_read_b64_tr_b16 v[4:5], v116 offset:28672
ds_read_b64_tr_b16 v[6:7], v116 offset:29184
ds_read_b64_tr_b16 v[8:9], v116 offset:32768
ds_read_b64_tr_b16 v[10:11], v116 offset:33280
ds_read_b64_tr_b16 v[12:13], v116 offset:36864
ds_read_b64_tr_b16 v[14:15], v116 offset:37376
ds_read_b64_tr_b16 v[16:17], v116 offset:40960
ds_read_b64_tr_b16 v[18:19], v116 offset:41472
ds_read_b64_tr_b16 v[20:21], v116 offset:45056
ds_read_b64_tr_b16 v[22:23], v116 offset:45568
ds_read_b64_tr_b16 v[24:25], v116 offset:49152
ds_read_b64_tr_b16 v[26:27], v116 offset:49664
ds_read_b64_tr_b16 v[28:29], v116 offset:53248
s_waitcnt lgkmcnt(14)
ds_read_b64_tr_b16 v[30:31], v116 offset:53760
s_waitcnt lgkmcnt(14)
ds_read_b64_tr_b16 v[32:33], v116 offset:57344
s_waitcnt lgkmcnt(14)
ds_read_b64_tr_b16 v[34:35], v116 offset:57856
s_waitcnt lgkmcnt(14)
ds_read_b64_tr_b16 v[36:37], v116 offset:61440
s_waitcnt lgkmcnt(14)
ds_read_b64_tr_b16 v[38:39], v116 offset:61952
s_waitcnt lgkmcnt(14)
ds_read_b64_tr_b16 v[40:41], v113
s_waitcnt lgkmcnt(14)
ds_read_b64_tr_b16 v[42:43], v113 offset:512
s_waitcnt lgkmcnt(14)
ds_read_b64_tr_b16 v[44:45], v113 offset:4096
s_waitcnt lgkmcnt(14)
ds_read_b64_tr_b16 v[46:47], v113 offset:4608
s_waitcnt lgkmcnt(14)
ds_write_b128 v117, v[0:3] offset:24576
s_waitcnt lgkmcnt(14)
ds_write_b128 v117, v[4:7] offset:28672
s_waitcnt lgkmcnt(14)
ds_write_b128 v117, v[8:11] offset:32768
s_waitcnt lgkmcnt(14)
ds_write_b128 v117, v[12:15] offset:36864
s_waitcnt lgkmcnt(14)
ds_write_b128 v117, v[16:19] offset:40960
s_waitcnt lgkmcnt(14)
ds_write_b128 v117, v[20:23] offset:45056
s_waitcnt lgkmcnt(14)
ds_write_b128 v117, v[24:27] offset:49152
s_waitcnt lgkmcnt(14)
ds_write_b128 v117, v[28:31] offset:53248
s_waitcnt lgkmcnt(14)
ds_write_b128 v117, v[32:35] offset:57344
s_waitcnt lgkmcnt(14)
s_waitcnt lgkmcnt(13)
ds_write_b128 v117, v[36:39] offset:61440
s_waitcnt lgkmcnt(12)
ds_write_b128 v114, v[40:43]
s_waitcnt lgkmcnt(11)
ds_write_b128 v114, v[44:47] offset:4096
v_mov_b32 v223, 1
s_waitcnt lgkmcnt(0)
s_mov_b64 exec, 1
ds_add_u32 v247, v223 offset:12
s_mov_b64 exec, -1
s_cmp_lg_u32 s40, 7
s_cbranch_scc1 Lnosent
v_bfe_u32 v104, v250, 4, 6
v_mov_b32 v108, -1
v_mov_b32 v109, -1
v_mov_b32 v110, -1
v_mov_b32 v111, -1
v_lshlrev_b32_e64 v100, 12, v104
v_add_u32 v101, 262144, v100
v_cmp_gt_u32 vcc, 32, v104
v_mov_b32 v105, 2147483648
s_nop 0
v_cndmask_b32 v101, v105, v101, vcc
s_lshl_b32 s43, s2, 4
buffer_store_dwordx4 v[108:111], v100, s[32:35], s43 offen sc1
buffer_store_dwordx4 v[108:111], v101, s[32:35], s43 offen sc1
s_add_u32 s43, s43, 393216
s_cmp_lt_u32 s2, 96
s_cselect_b32 s43, s43, 1073741824
v_lshlrev_b32 v103, 11, v104
s_mov_b64 exec, 0xff
buffer_store_dwordx4 v[108:111], v103, s[32:35], s43 offen sc1
s_mov_b64 exec, -1
s_nop 1
Lnosent:
s_setprio 3
s_waitcnt vmcnt(0)
Lsu1:
s_add_u32 s43, s81, 6592
v_add_u32_e64 v212, s43, v246
v_subrev_u32 v222, 65920, v212
v_min_u32_e64 v212, v212, v222
v_add_u32 v212, 90112, v212
v_add_u32_e64 v213, s43, v246
v_add_u32 v213, 6592, v213
v_subrev_u32 v222, 65920, v213
v_min_u32_e64 v213, v213, v222
v_add_u32 v213, 90112, v213
v_add_u32_e64 v214, s43, v246
v_add_u32 v214, 13184, v214
v_add_u32_e64 v222, 16, v214
v_bfi_b32 v214, 48, v222, v214
v_subrev_u32 v222, 65920, v214
v_min_u32_e64 v214, v214, v222
v_add_u32 v214, 90112, v214
v_add_u32_e64 v215, s43, v246
v_add_u32 v215, 19776, v215
v_add_u32_e64 v222, 16, v215
v_bfi_b32 v215, 48, v222, v215
v_subrev_u32 v222, 65920, v215
v_min_u32_e64 v215, v215, v222
v_add_u32 v215, 90112, v215
ds_read_b128 v[144:147], v212
ds_read_b64 v[192:193], v238
ds_read_b64 v[194:195], v239
ds_read_b128 v[148:151], v213
ds_read_b128 v[152:155], v214
ds_read_b64 v[196:197], v238 offset:2400
ds_read_b64 v[198:199], v239 offset:2400
ds_read_b128 v[156:159], v215
ds_read_b64 v[200:201], v238 offset:4800
ds_read_b64 v[202:203], v239 offset:4800
ds_read_b128 v[160:163], v212 offset:16
ds_read_b64 v[204:205], v238 offset:200
ds_read_b64 v[206:207], v239 offset:200
ds_read_b128 v[164:167], v213 offset:16
ds_read_b128 v[168:171], v214 offset:16
s_waitcnt lgkmcnt(14)
ds_read_b64 v[208:209], v238 offset:2600
s_waitcnt lgkmcnt(13)
v_mfma_f32_16x16x32_bf16 v[0:3], v[192:195], v[144:147], 0
ds_read_b64 v[210:211], v239 offset:2600
s_waitcnt lgkmcnt(13)
v_mfma_f32_16x16x32_bf16 v[48:51], v[192:195], v[148:151], 0
ds_read_b128 v[172:175], v215 offset:16
ds_read_b64 v[192:193], v238 offset:5000
s_waitcnt lgkmcnt(14)
ds_read_b64 v[194:195], v239 offset:5000
s_waitcnt lgkmcnt(13)
v_mfma_f32_16x16x32_bf16 v[0:3], v[196:199], v[148:151], v[0:3]
ds_read_b128 v[144:147], v212 offset:32
v_mfma_f32_16x16x32_bf16 v[48:51], v[196:199], v[152:155], v[48:51]
ds_read_b64 v[196:197], v238 offset:400
s_waitcnt lgkmcnt(14)
ds_read_b64 v[198:199], v239 offset:400
s_waitcnt lgkmcnt(13)
v_mfma_f32_16x16x32_bf16 v[0:3], v[200:203], v[152:155], v[0:3]
ds_read_b128 v[148:151], v213 offset:32
v_mfma_f32_16x16x32_bf16 v[48:51], v[200:203], v[156:159], v[48:51]
ds_read_b128 v[152:155], v214 offset:32
s_waitcnt lgkmcnt(14)
ds_read_b64 v[200:201], v238 offset:2800
s_waitcnt lgkmcnt(13)
v_mfma_f32_16x16x32_bf16 v[4:7], v[204:207], v[160:163], 0
ds_read_b64 v[202:203], v239 offset:2800
s_waitcnt lgkmcnt(13)
v_mfma_f32_16x16x32_bf16 v[52:55], v[204:207], v[164:167], 0
ds_read_b128 v[156:159], v215 offset:32
ds_read_b64 v[204:205], v238 offset:5200
s_waitcnt lgkmcnt(14)
ds_read_b64 v[206:207], v239 offset:5200
s_waitcnt lgkmcnt(13)
v_mfma_f32_16x16x32_bf16 v[4:7], v[208:211], v[164:167], v[4:7]
ds_read_b128 v[160:163], v212 offset:48
v_mfma_f32_16x16x32_bf16 v[52:55], v[208:211], v[168:171], v[52:55]
ds_read_b64 v[208:209], v238 offset:600
s_waitcnt lgkmcnt(14)
ds_read_b64 v[210:211], v239 offset:600
s_waitcnt lgkmcnt(13)
v_mfma_f32_16x16x32_bf16 v[4:7], v[192:195], v[168:171], v[4:7]
ds_read_b128 v[164:167], v213 offset:48
v_mfma_f32_16x16x32_bf16 v[52:55], v[192:195], v[172:175], v[52:55]
ds_read_b128 v[168:171], v214 offset:48
s_waitcnt lgkmcnt(14)
ds_read_b64 v[192:193], v238 offset:3000
s_waitcnt lgkmcnt(13)
v_mfma_f32_16x16x32_bf16 v[8:11], v[196:199], v[144:147], 0
ds_read_b64 v[194:195], v239 offset:3000
s_waitcnt lgkmcnt(13)
v_mfma_f32_16x16x32_bf16 v[56:59], v[196:199], v[148:151], 0
ds_read_b128 v[172:175], v215 offset:48
ds_read_b64 v[196:197], v238 offset:5400
s_waitcnt lgkmcnt(14)
ds_read_b64 v[198:199], v239 offset:5400
s_waitcnt lgkmcnt(13)
v_mfma_f32_16x16x32_bf16 v[8:11], v[200:203], v[148:151], v[8:11]
ds_read_b128 v[144:147], v212 offset:64
v_mfma_f32_16x16x32_bf16 v[56:59], v[200:203], v[152:155], v[56:59]
ds_read_b64 v[200:201], v238 offset:800
s_waitcnt lgkmcnt(14)
ds_read_b64 v[202:203], v239 offset:800
s_waitcnt lgkmcnt(13)
v_mfma_f32_16x16x32_bf16 v[8:11], v[204:207], v[152:155], v[8:11]
ds_read_b128 v[148:151], v213 offset:64
v_mfma_f32_16x16x32_bf16 v[56:59], v[204:207], v[156:159], v[56:59]
ds_read_b128 v[152:155], v214 offset:64
s_waitcnt lgkmcnt(14)
ds_read_b64 v[204:205], v238 offset:3200
s_waitcnt lgkmcnt(13)
v_mfma_f32_16x16x32_bf16 v[12:15], v[208:211], v[160:163], 0
ds_read_b64 v[206:207], v239 offset:3200
s_waitcnt lgkmcnt(13)
v_mfma_f32_16x16x32_bf16 v[60:63], v[208:211], v[164:167], 0
ds_read_b128 v[156:159], v215 offset:64
ds_read_b64 v[208:209], v238 offset:5600
s_waitcnt lgkmcnt(14)
ds_read_b64 v[210:211], v239 offset:5600
s_waitcnt lgkmcnt(13)
v_mfma_f32_16x16x32_bf16 v[12:15], v[192:195], v[164:167], v[12:15]
ds_read_b128 v[160:163], v212 offset:80
v_mfma_f32_16x16x32_bf16 v[60:63], v[192:195], v[168:171], v[60:63]
ds_read_b64 v[192:193], v238 offset:1000
s_waitcnt lgkmcnt(14)
ds_read_b64 v[194:195], v239 offset:1000
s_waitcnt lgkmcnt(13)
v_mfma_f32_16x16x32_bf16 v[12:15], v[196:199], v[168:171], v[12:15]
ds_read_b128 v[164:167], v213 offset:80
v_mfma_f32_16x16x32_bf16 v[60:63], v[196:199], v[172:175], v[60:63]
ds_read_b128 v[168:171], v214 offset:80
s_waitcnt lgkmcnt(14)
ds_read_b64 v[196:197], v238 offset:3400
s_waitcnt lgkmcnt(13)
v_mfma_f32_16x16x32_bf16 v[16:19], v[200:203], v[144:147], 0
ds_read_b64 v[198:199], v239 offset:3400
s_waitcnt lgkmcnt(13)
v_mfma_f32_16x16x32_bf16 v[64:67], v[200:203], v[148:151], 0
ds_read_b128 v[172:175], v215 offset:80
ds_read_b64 v[200:201], v238 offset:5800
s_waitcnt lgkmcnt(14)
ds_read_b64 v[202:203], v239 offset:5800
s_waitcnt lgkmcnt(13)
v_mfma_f32_16x16x32_bf16 v[16:19], v[204:207], v[148:151], v[16:19]
ds_read_b128 v[144:147], v212 offset:96
v_mfma_f32_16x16x32_bf16 v[64:67], v[204:207], v[152:155], v[64:67]
ds_read_b64 v[204:205], v238 offset:1200
s_waitcnt lgkmcnt(14)
ds_read_b64 v[206:207], v239 offset:1200
s_waitcnt lgkmcnt(13)
v_mfma_f32_16x16x32_bf16 v[16:19], v[208:211], v[152:155], v[16:19]
ds_read_b128 v[148:151], v213 offset:96
v_mfma_f32_16x16x32_bf16 v[64:67], v[208:211], v[156:159], v[64:67]
ds_read_b128 v[152:155], v214 offset:96
s_waitcnt lgkmcnt(14)
ds_read_b64 v[208:209], v238 offset:3600
s_waitcnt lgkmcnt(13)
v_mfma_f32_16x16x32_bf16 v[20:23], v[192:195], v[160:163], 0
ds_read_b64 v[210:211], v239 offset:3600
s_waitcnt lgkmcnt(13)
v_mfma_f32_16x16x32_bf16 v[68:71], v[192:195], v[164:167], 0
ds_read_b128 v[156:159], v215 offset:96
ds_read_b64 v[192:193], v238 offset:6000
s_waitcnt lgkmcnt(14)
ds_read_b64 v[194:195], v239 offset:6000
s_waitcnt lgkmcnt(13)
v_mfma_f32_16x16x32_bf16 v[20:23], v[196:199], v[164:167], v[20:23]
ds_read_b128 v[160:163], v212 offset:112
v_mfma_f32_16x16x32_bf16 v[68:71], v[196:199], v[168:171], v[68:71]
ds_read_b64 v[196:197], v238 offset:1400
s_waitcnt lgkmcnt(14)
ds_read_b64 v[198:199], v239 offset:1400
s_waitcnt lgkmcnt(13)
v_mfma_f32_16x16x32_bf16 v[20:23], v[200:203], v[168:171], v[20:23]
ds_read_b128 v[164:167], v213 offset:112
v_mfma_f32_16x16x32_bf16 v[68:71], v[200:203], v[172:175], v[68:71]
ds_read_b128 v[168:171], v214 offset:112
s_waitcnt lgkmcnt(14)
ds_read_b64 v[200:201], v238 offset:3800
s_waitcnt lgkmcnt(13)
v_mfma_f32_16x16x32_bf16 v[24:27], v[204:207], v[144:147], 0
ds_read_b64 v[202:203], v239 offset:3800
s_waitcnt lgkmcnt(13)
v_mfma_f32_16x16x32_bf16 v[72:75], v[204:207], v[148:151], 0
ds_read_b128 v[172:175], v215 offset:112
ds_read_b64 v[204:205], v238 offset:6200
s_waitcnt lgkmcnt(14)
ds_read_b64 v[206:207], v239 offset:6200
s_waitcnt lgkmcnt(13)
v_mfma_f32_16x16x32_bf16 v[24:27], v[208:211], v[148:151], v[24:27]
ds_read_b128 v[144:147], v212 offset:128
v_mfma_f32_16x16x32_bf16 v[72:75], v[208:211], v[152:155], v[72:75]
ds_read_b64 v[208:209], v238 offset:1600
s_waitcnt lgkmcnt(14)
ds_read_b64 v[210:211], v239 offset:1600
s_waitcnt lgkmcnt(13)
v_mfma_f32_16x16x32_bf16 v[24:27], v[192:195], v[152:155], v[24:27]
ds_read_b128 v[148:151], v213 offset:128
v_mfma_f32_16x16x32_bf16 v[72:75], v[192:195], v[156:159], v[72:75]
ds_read_b128 v[152:155], v214 offset:128
s_waitcnt lgkmcnt(14)
ds_read_b64 v[192:193], v238 offset:4000
s_waitcnt lgkmcnt(13)
v_mfma_f32_16x16x32_bf16 v[28:31], v[196:199], v[160:163], 0
ds_read_b64 v[194:195], v239 offset:4000
s_waitcnt lgkmcnt(13)
v_mfma_f32_16x16x32_bf16 v[76:79], v[196:199], v[164:167], 0
ds_read_b128 v[156:159], v215 offset:128
ds_read_b64 v[196:197], v238 offset:6400
s_waitcnt lgkmcnt(14)
ds_read_b64 v[198:199], v239 offset:6400
s_waitcnt lgkmcnt(13)
v_mfma_f32_16x16x32_bf16 v[28:31], v[200:203], v[164:167], v[28:31]
ds_read_b128 v[160:163], v212 offset:144
v_mfma_f32_16x16x32_bf16 v[76:79], v[200:203], v[168:171], v[76:79]
ds_read_b64 v[200:201], v238 offset:1800
s_waitcnt lgkmcnt(14)
ds_read_b64 v[202:203], v239 offset:1800
s_waitcnt lgkmcnt(13)
v_mfma_f32_16x16x32_bf16 v[28:31], v[204:207], v[168:171], v[28:31]
ds_read_b128 v[164:167], v213 offset:144
v_mfma_f32_16x16x32_bf16 v[76:79], v[204:207], v[172:175], v[76:79]
ds_read_b128 v[168:171], v214 offset:144
s_waitcnt lgkmcnt(14)
ds_read_b64 v[204:205], v238 offset:4200
s_waitcnt lgkmcnt(13)
v_mfma_f32_16x16x32_bf16 v[32:35], v[208:211], v[144:147], 0
ds_read_b64 v[206:207], v239 offset:4200
s_waitcnt lgkmcnt(13)
v_mfma_f32_16x16x32_bf16 v[80:83], v[208:211], v[148:151], 0
ds_read_b128 v[172:175], v215 offset:144
ds_read_b64 v[208:209], v238 offset:6600
s_waitcnt lgkmcnt(14)
ds_read_b64 v[210:211], v239 offset:6600
s_waitcnt lgkmcnt(13)
v_mfma_f32_16x16x32_bf16 v[32:35], v[192:195], v[148:151], v[32:35]
ds_read_b128 v[144:147], v212 offset:160
v_mfma_f32_16x16x32_bf16 v[80:83], v[192:195], v[152:155], v[80:83]
ds_read_b64 v[192:193], v238 offset:2000
s_waitcnt lgkmcnt(14)
ds_read_b64 v[194:195], v239 offset:2000
s_waitcnt lgkmcnt(13)
v_mfma_f32_16x16x32_bf16 v[32:35], v[196:199], v[152:155], v[32:35]
ds_read_b128 v[148:151], v213 offset:160
v_mfma_f32_16x16x32_bf16 v[80:83], v[196:199], v[156:159], v[80:83]
ds_read_b128 v[152:155], v214 offset:160
s_waitcnt lgkmcnt(14)
ds_read_b64 v[196:197], v238 offset:4400
s_waitcnt lgkmcnt(13)
v_mfma_f32_16x16x32_bf16 v[36:39], v[200:203], v[160:163], 0
ds_read_b64 v[198:199], v239 offset:4400
s_waitcnt lgkmcnt(13)
v_mfma_f32_16x16x32_bf16 v[84:87], v[200:203], v[164:167], 0
ds_read_b128 v[156:159], v215 offset:160
ds_read_b64 v[200:201], v238 offset:6800
s_waitcnt lgkmcnt(14)
ds_read_b64 v[202:203], v239 offset:6800
s_waitcnt lgkmcnt(13)
v_mfma_f32_16x16x32_bf16 v[36:39], v[204:207], v[164:167], v[36:39]
ds_read_b128 v[160:163], v212 offset:176
v_mfma_f32_16x16x32_bf16 v[84:87], v[204:207], v[168:171], v[84:87]
ds_read_b64 v[204:205], v238 offset:2200
s_waitcnt lgkmcnt(14)
ds_read_b64 v[206:207], v239 offset:2200
s_waitcnt lgkmcnt(13)
v_mfma_f32_16x16x32_bf16 v[36:39], v[208:211], v[168:171], v[36:39]
ds_read_b128 v[164:167], v213 offset:176
v_mfma_f32_16x16x32_bf16 v[84:87], v[208:211], v[172:175], v[84:87]
ds_read_b128 v[168:171], v214 offset:176
s_waitcnt lgkmcnt(14)
ds_read_b64 v[208:209], v238 offset:4600
s_waitcnt lgkmcnt(13)
v_mfma_f32_16x16x32_bf16 v[40:43], v[192:195], v[144:147], 0
ds_read_b64 v[210:211], v239 offset:4600
s_waitcnt lgkmcnt(13)
v_mfma_f32_16x16x32_bf16 v[88:91], v[192:195], v[148:151], 0
ds_read_b128 v[172:175], v215 offset:176
ds_read_b64 v[192:193], v238 offset:7000
s_waitcnt lgkmcnt(14)
ds_read_b64 v[194:195], v239 offset:7000
s_waitcnt lgkmcnt(13)
v_mfma_f32_16x16x32_bf16 v[40:43], v[196:199], v[148:151], v[40:43]
v_mfma_f32_16x16x32_bf16 v[88:91], v[196:199], v[152:155], v[88:91]
s_waitcnt lgkmcnt(10)
v_mfma_f32_16x16x32_bf16 v[40:43], v[200:203], v[152:155], v[40:43]
v_mfma_f32_16x16x32_bf16 v[88:91], v[200:203], v[156:159], v[88:91]
s_waitcnt lgkmcnt(7)
v_mfma_f32_16x16x32_bf16 v[44:47], v[204:207], v[160:163], 0
s_waitcnt lgkmcnt(6)
v_mfma_f32_16x16x32_bf16 v[92:95], v[204:207], v[164:167], 0
s_waitcnt lgkmcnt(3)
v_mfma_f32_16x16x32_bf16 v[44:47], v[208:211], v[164:167], v[44:47]
v_mfma_f32_16x16x32_bf16 v[92:95], v[208:211], v[168:171], v[92:95]
s_waitcnt lgkmcnt(0)
v_mfma_f32_16x16x32_bf16 v[44:47], v[192:195], v[168:171], v[44:47]
v_mfma_f32_16x16x32_bf16 v[92:95], v[192:195], v[172:175], v[92:95]
v_mov_b32_e64 v223, 1
v_add_u32 v222, s83, v247
s_nop 7
s_mov_b64 exec, 1
ds_add_u32 v222, v223 offset:16
s_mov_b64 exec, -1
v_pk_mul_f32 v[242:243], v[0:1], v[0:1]
v_pk_add_f32 v[240:241], v[0:1], v[2:3]
v_pk_fma_f32 v[242:243], v[2:3], v[2:3], v[242:243]
v_pk_mul_f32 v[218:219], v[48:49], v[48:49]
v_pk_add_f32 v[216:217], v[48:49], v[50:51]
v_pk_fma_f32 v[218:219], v[50:51], v[50:51], v[218:219]
v_pk_fma_f32 v[242:243], v[4:5], v[4:5], v[242:243]
v_pk_add_f32 v[240:241], v[240:241], v[4:5]
v_pk_fma_f32 v[242:243], v[6:7], v[6:7], v[242:243]
v_pk_add_f32 v[240:241], v[240:241], v[6:7]
v_pk_fma_f32 v[218:219], v[52:53], v[52:53], v[218:219]
v_pk_add_f32 v[216:217], v[216:217], v[52:53]
v_pk_fma_f32 v[218:219], v[54:55], v[54:55], v[218:219]
v_pk_add_f32 v[216:217], v[216:217], v[54:55]
v_pk_fma_f32 v[242:243], v[8:9], v[8:9], v[242:243]
v_pk_add_f32 v[240:241], v[240:241], v[8:9]
v_pk_fma_f32 v[242:243], v[10:11], v[10:11], v[242:243]
v_pk_add_f32 v[240:241], v[240:241], v[10:11]
v_pk_fma_f32 v[218:219], v[56:57], v[56:57], v[218:219]
v_pk_add_f32 v[216:217], v[216:217], v[56:57]
v_pk_fma_f32 v[218:219], v[58:59], v[58:59], v[218:219]
v_pk_add_f32 v[216:217], v[216:217], v[58:59]
v_pk_fma_f32 v[242:243], v[12:13], v[12:13], v[242:243]
v_pk_add_f32 v[240:241], v[240:241], v[12:13]
v_pk_fma_f32 v[242:243], v[14:15], v[14:15], v[242:243]
v_pk_add_f32 v[240:241], v[240:241], v[14:15]
v_pk_fma_f32 v[218:219], v[60:61], v[60:61], v[218:219]
v_pk_add_f32 v[216:217], v[216:217], v[60:61]
v_pk_fma_f32 v[218:219], v[62:63], v[62:63], v[218:219]
v_pk_add_f32 v[216:217], v[216:217], v[62:63]
v_pk_fma_f32 v[242:243], v[16:17], v[16:17], v[242:243]
v_pk_add_f32 v[240:241], v[240:241], v[16:17]
v_pk_fma_f32 v[242:243], v[18:19], v[18:19], v[242:243]
v_pk_add_f32 v[240:241], v[240:241], v[18:19]
v_pk_fma_f32 v[218:219], v[64:65], v[64:65], v[218:219]
v_pk_add_f32 v[216:217], v[216:217], v[64:65]
v_pk_fma_f32 v[218:219], v[66:67], v[66:67], v[218:219]
v_pk_add_f32 v[216:217], v[216:217], v[66:67]
v_pk_fma_f32 v[242:243], v[20:21], v[20:21], v[242:243]
v_pk_add_f32 v[240:241], v[240:241], v[20:21]
v_pk_fma_f32 v[242:243], v[22:23], v[22:23], v[242:243]
v_pk_add_f32 v[240:241], v[240:241], v[22:23]
v_pk_fma_f32 v[218:219], v[68:69], v[68:69], v[218:219]
v_pk_add_f32 v[216:217], v[216:217], v[68:69]
v_pk_fma_f32 v[218:219], v[70:71], v[70:71], v[218:219]
v_pk_add_f32 v[216:217], v[216:217], v[70:71]
v_pk_fma_f32 v[242:243], v[24:25], v[24:25], v[242:243]
v_pk_add_f32 v[240:241], v[240:241], v[24:25]
v_pk_fma_f32 v[242:243], v[26:27], v[26:27], v[242:243]
v_pk_add_f32 v[240:241], v[240:241], v[26:27]
v_pk_fma_f32 v[218:219], v[72:73], v[72:73], v[218:219]
v_pk_add_f32 v[216:217], v[216:217], v[72:73]
v_pk_fma_f32 v[218:219], v[74:75], v[74:75], v[218:219]
v_pk_add_f32 v[216:217], v[216:217], v[74:75]
v_pk_fma_f32 v[242:243], v[28:29], v[28:29], v[242:243]
v_pk_add_f32 v[240:241], v[240:241], v[28:29]
v_pk_fma_f32 v[242:243], v[30:31], v[30:31], v[242:243]
v_pk_add_f32 v[240:241], v[240:241], v[30:31]
v_pk_fma_f32 v[218:219], v[76:77], v[76:77], v[218:219]
v_pk_add_f32 v[216:217], v[216:217], v[76:77]
v_pk_fma_f32 v[218:219], v[78:79], v[78:79], v[218:219]
v_pk_add_f32 v[216:217], v[216:217], v[78:79]
v_pk_fma_f32 v[242:243], v[32:33], v[32:33], v[242:243]
v_pk_add_f32 v[240:241], v[240:241], v[32:33]
v_pk_fma_f32 v[242:243], v[34:35], v[34:35], v[242:243]
v_pk_add_f32 v[240:241], v[240:241], v[34:35]
v_pk_fma_f32 v[218:219], v[80:81], v[80:81], v[218:219]
v_pk_add_f32 v[216:217], v[216:217], v[80:81]
v_pk_fma_f32 v[218:219], v[82:83], v[82:83], v[218:219]
v_pk_add_f32 v[216:217], v[216:217], v[82:83]
v_pk_fma_f32 v[242:243], v[36:37], v[36:37], v[242:243]
v_pk_add_f32 v[240:241], v[240:241], v[36:37]
v_pk_fma_f32 v[242:243], v[38:39], v[38:39], v[242:243]
v_pk_add_f32 v[240:241], v[240:241], v[38:39]
v_pk_fma_f32 v[218:219], v[84:85], v[84:85], v[218:219]
v_pk_add_f32 v[216:217], v[216:217], v[84:85]
v_pk_fma_f32 v[218:219], v[86:87], v[86:87], v[218:219]
v_pk_add_f32 v[216:217], v[216:217], v[86:87]
v_pk_fma_f32 v[242:243], v[40:41], v[40:41], v[242:243]
v_pk_add_f32 v[240:241], v[240:241], v[40:41]
v_pk_fma_f32 v[242:243], v[42:43], v[42:43], v[242:243]
v_pk_add_f32 v[240:241], v[240:241], v[42:43]
v_pk_fma_f32 v[218:219], v[88:89], v[88:89], v[218:219]
v_pk_add_f32 v[216:217], v[216:217], v[88:89]
v_pk_fma_f32 v[218:219], v[90:91], v[90:91], v[218:219]
v_pk_add_f32 v[216:217], v[216:217], v[90:91]
v_pk_fma_f32 v[242:243], v[44:45], v[44:45], v[242:243]
v_pk_add_f32 v[240:241], v[240:241], v[44:45]
v_pk_fma_f32 v[242:243], v[46:47], v[46:47], v[242:243]
v_pk_add_f32 v[240:241], v[240:241], v[46:47]
v_pk_fma_f32 v[218:219], v[92:93], v[92:93], v[218:219]
v_pk_add_f32 v[216:217], v[216:217], v[92:93]
v_pk_fma_f32 v[218:219], v[94:95], v[94:95], v[218:219]
v_pk_add_f32 v[216:217], v[216:217], v[94:95]
v_add_f32 v218, v218, v219
v_add_f32 v216, v216, v217
s_nop 1
v_permlane32_swap_b32 v216, v218
v_add_f32_e64 v216, v216, v218
v_mul_f32 v216, 1009429163, v216
v_mov_b32_e64 v218, v216
s_nop 1
v_permlane32_swap_b32 v216, v218
v_fma_f32 v218, -v216, v216, v218
v_max_f32_e64 v218, 0, v218
v_add_f32 v218, 925353388, v218
v_rsq_f32 v218, v218
v_add_f32 v240, v240, v241
v_mul_f32 v220, 3203396952, v218
v_mul_f32 v221, 3203396952, v218
v_mul_f32 v218, v216, v220
v_mul_f32 v219, v216, v220
v_add_f32 v242, v242, v243
s_nop 1
v_permlane32_swap_b32 v240, v242
v_add_f32 v240, v240, v242
v_mul_f32 v240, 1009429163, v240
v_mov_b32_e64 v242, v240
s_nop 1
v_permlane32_swap_b32 v240, v242
v_fma_f32 v242, -v240, v240, v242
v_max_f32_e64 v242, 0, v242
v_add_f32 v242, 925353388, v242
v_rsq_f32_e64 v242, v242
v_pk_fma_f32 v[48:49], v[48:49], v[220:221], v[218:219] neg_lo:[0,0,1] neg_hi:[0,0,1]
v_mul_f32 v244, 3203396952, v242
v_mul_f32 v245, 3203396952, v242
v_mul_f32 v242, v240, v244
v_mul_f32 v243, v240, v244
v_pk_fma_f32 v[0:1], v[0:1], v[244:245], v[242:243] neg_lo:[0,0,1] neg_hi:[0,0,1]
v_pk_fma_f32 v[2:3], v[2:3], v[244:245], v[242:243] neg_lo:[0,0,1] neg_hi:[0,0,1]
v_cvt_pk_bf16_f32 v0, v0, v1
v_cvt_pk_bf16_f32 v1, v2, v3
v_pk_fma_f32 v[4:5], v[4:5], v[244:245], v[242:243] neg_lo:[0,0,1] neg_hi:[0,0,1]
v_pk_fma_f32 v[6:7], v[6:7], v[244:245], v[242:243] neg_lo:[0,0,1] neg_hi:[0,0,1]
v_cvt_pk_bf16_f32 v2, v4, v5
v_cvt_pk_bf16_f32 v3, v6, v7
v_pk_fma_f32 v[8:9], v[8:9], v[244:245], v[242:243] neg_lo:[0,0,1] neg_hi:[0,0,1]
v_pk_fma_f32 v[10:11], v[10:11], v[244:245], v[242:243] neg_lo:[0,0,1] neg_hi:[0,0,1]
v_cvt_pk_bf16_f32 v4, v8, v9
v_cvt_pk_bf16_f32 v5, v10, v11
v_pk_fma_f32 v[12:13], v[12:13], v[244:245], v[242:243] neg_lo:[0,0,1] neg_hi:[0,0,1]
v_pk_fma_f32 v[14:15], v[14:15], v[244:245], v[242:243] neg_lo:[0,0,1] neg_hi:[0,0,1]
v_cvt_pk_bf16_f32 v6, v12, v13
v_cvt_pk_bf16_f32 v7, v14, v15
v_pk_fma_f32 v[16:17], v[16:17], v[244:245], v[242:243] neg_lo:[0,0,1] neg_hi:[0,0,1]
v_pk_fma_f32 v[18:19], v[18:19], v[244:245], v[242:243] neg_lo:[0,0,1] neg_hi:[0,0,1]
v_cvt_pk_bf16_f32 v8, v16, v17
v_cvt_pk_bf16_f32 v9, v18, v19
v_pk_fma_f32 v[20:21], v[20:21], v[244:245], v[242:243] neg_lo:[0,0,1] neg_hi:[0,0,1]
v_pk_fma_f32 v[22:23], v[22:23], v[244:245], v[242:243] neg_lo:[0,0,1] neg_hi:[0,0,1]
v_cvt_pk_bf16_f32 v10, v20, v21
v_cvt_pk_bf16_f32 v11, v22, v23
v_pk_fma_f32 v[24:25], v[24:25], v[244:245], v[242:243] neg_lo:[0,0,1] neg_hi:[0,0,1]
v_pk_fma_f32 v[26:27], v[26:27], v[244:245], v[242:243] neg_lo:[0,0,1] neg_hi:[0,0,1]
v_cvt_pk_bf16_f32 v12, v24, v25
v_cvt_pk_bf16_f32 v13, v26, v27
v_mov_b32 v223, 0
s_branch Law2
Lax2:
s_sleep 2
Law2:
ds_read_b32 v223, v247 offset:8
s_sub_u32 s76, s76, 1
s_cselect_b32 s44, 4, 0
s_cselect_b32 s76, 0, s76
s_waitcnt lgkmcnt(0)
v_readfirstlane_b32 s43, v223
s_nop 1
s_max_u32 s43, s43, s44
s_cmp_lt_u32 s43, 4
s_cbranch_scc1 Lax2
v_pk_fma_f32 v[28:29], v[28:29], v[244:245], v[242:243] neg_lo:[0,0,1] neg_hi:[0,0,1]
v_pk_fma_f32 v[30:31], v[30:31], v[244:245], v[242:243] neg_lo:[0,0,1] neg_hi:[0,0,1]
v_cvt_pk_bf16_f32 v14, v28, v29
v_cvt_pk_bf16_f32 v15, v30, v31
v_pk_fma_f32 v[32:33], v[32:33], v[244:245], v[242:243] neg_lo:[0,0,1] neg_hi:[0,0,1]
v_pk_fma_f32 v[34:35], v[34:35], v[244:245], v[242:243] neg_lo:[0,0,1] neg_hi:[0,0,1]
v_cvt_pk_bf16_f32 v16, v32, v33
v_cvt_pk_bf16_f32 v17, v34, v35
v_pk_fma_f32 v[36:37], v[36:37], v[244:245], v[242:243] neg_lo:[0,0,1] neg_hi:[0,0,1]
v_pk_fma_f32 v[38:39], v[38:39], v[244:245], v[242:243] neg_lo:[0,0,1] neg_hi:[0,0,1]
v_cvt_pk_bf16_f32 v18, v36, v37
v_cvt_pk_bf16_f32 v19, v38, v39
v_pk_fma_f32 v[40:41], v[40:41], v[244:245], v[242:243] neg_lo:[0,0,1] neg_hi:[0,0,1]
v_pk_fma_f32 v[42:43], v[42:43], v[244:245], v[242:243] neg_lo:[0,0,1] neg_hi:[0,0,1]
v_cvt_pk_bf16_f32 v20, v40, v41
v_cvt_pk_bf16_f32 v21, v42, v43
v_pk_fma_f32 v[44:45], v[44:45], v[244:245], v[242:243] neg_lo:[0,0,1] neg_hi:[0,0,1]
v_pk_fma_f32 v[46:47], v[46:47], v[244:245], v[242:243] neg_lo:[0,0,1] neg_hi:[0,0,1]
v_cvt_pk_bf16_f32 v22, v44, v45
v_cvt_pk_bf16_f32 v23, v46, v47
v_cvt_pk_bf16_f32 v24, v48, v49
ds_read_b128 v[176:179], v250
v_pk_fma_f32 v[50:51], v[50:51], v[220:221], v[218:219] neg_lo:[0,0,1] neg_hi:[0,0,1]
v_pk_fma_f32 v[52:53], v[52:53], v[220:221], v[218:219] neg_lo:[0,0,1] neg_hi:[0,0,1]
v_cvt_pk_bf16_f32 v25, v50, v51
v_cvt_pk_bf16_f32 v26, v52, v53
v_pk_fma_f32 v[54:55], v[54:55], v[220:221], v[218:219] neg_lo:[0,0,1] neg_hi:[0,0,1]
v_pk_fma_f32 v[56:57], v[56:57], v[220:221], v[218:219] neg_lo:[0,0,1] neg_hi:[0,0,1]
v_cvt_pk_bf16_f32 v27, v54, v55
v_cvt_pk_bf16_f32 v28, v56, v57
v_pk_fma_f32 v[58:59], v[58:59], v[220:221], v[218:219] neg_lo:[0,0,1] neg_hi:[0,0,1]
v_pk_fma_f32 v[60:61], v[60:61], v[220:221], v[218:219] neg_lo:[0,0,1] neg_hi:[0,0,1]
v_cvt_pk_bf16_f32 v29, v58, v59
v_cvt_pk_bf16_f32 v30, v60, v61
v_pk_fma_f32 v[62:63], v[62:63], v[220:221], v[218:219] neg_lo:[0,0,1] neg_hi:[0,0,1]
v_pk_fma_f32 v[64:65], v[64:65], v[220:221], v[218:219] neg_lo:[0,0,1] neg_hi:[0,0,1]
v_cvt_pk_bf16_f32 v31, v62, v63
v_cvt_pk_bf16_f32 v32, v64, v65
v_pk_fma_f32 v[66:67], v[66:67], v[220:221], v[218:219] neg_lo:[0,0,1] neg_hi:[0,0,1]
v_pk_fma_f32 v[68:69], v[68:69], v[220:221], v[218:219] neg_lo:[0,0,1] neg_hi:[0,0,1]
v_cvt_pk_bf16_f32 v33, v66, v67
v_cvt_pk_bf16_f32 v34, v68, v69
v_pk_fma_f32 v[70:71], v[70:71], v[220:221], v[218:219] neg_lo:[0,0,1] neg_hi:[0,0,1]
v_pk_fma_f32 v[72:73], v[72:73], v[220:221], v[218:219] neg_lo:[0,0,1] neg_hi:[0,0,1]
ds_read_b128 v[180:183], v250 offset:1024
v_cvt_pk_bf16_f32 v35, v70, v71
v_cvt_pk_bf16_f32 v36, v72, v73
v_pk_fma_f32 v[74:75], v[74:75], v[220:221], v[218:219] neg_lo:[0,0,1] neg_hi:[0,0,1]
v_pk_fma_f32 v[76:77], v[76:77], v[220:221], v[218:219] neg_lo:[0,0,1] neg_hi:[0,0,1]
v_cvt_pk_bf16_f32 v37, v74, v75
v_cvt_pk_bf16_f32 v38, v76, v77
v_pk_fma_f32 v[78:79], v[78:79], v[220:221], v[218:219] neg_lo:[0,0,1] neg_hi:[0,0,1]
v_pk_fma_f32 v[80:81], v[80:81], v[220:221], v[218:219] neg_lo:[0,0,1] neg_hi:[0,0,1]
v_cvt_pk_bf16_f32 v39, v78, v79
v_cvt_pk_bf16_f32 v40, v80, v81
v_pk_fma_f32 v[82:83], v[82:83], v[220:221], v[218:219] neg_lo:[0,0,1] neg_hi:[0,0,1]
v_pk_fma_f32 v[84:85], v[84:85], v[220:221], v[218:219] neg_lo:[0,0,1] neg_hi:[0,0,1]
v_cvt_pk_bf16_f32 v41, v82, v83
v_cvt_pk_bf16_f32 v42, v84, v85
v_pk_fma_f32 v[86:87], v[86:87], v[220:221], v[218:219] neg_lo:[0,0,1] neg_hi:[0,0,1]
v_pk_fma_f32 v[88:89], v[88:89], v[220:221], v[218:219] neg_lo:[0,0,1] neg_hi:[0,0,1]
v_cvt_pk_bf16_f32 v43, v86, v87
v_cvt_pk_bf16_f32 v44, v88, v89
v_pk_fma_f32 v[90:91], v[90:91], v[220:221], v[218:219] neg_lo:[0,0,1] neg_hi:[0,0,1]
v_pk_fma_f32 v[92:93], v[92:93], v[220:221], v[218:219] neg_lo:[0,0,1] neg_hi:[0,0,1]
v_cvt_pk_bf16_f32 v45, v90, v91
v_cvt_pk_bf16_f32 v46, v92, v93
v_pk_fma_f32 v[94:95], v[94:95], v[220:221], v[218:219] neg_lo:[0,0,1] neg_hi:[0,0,1]
ds_read_b128 v[184:187], v250 offset:2048
v_cvt_pk_bf16_f32 v47, v94, v95
s_waitcnt lgkmcnt(2)
v_mfma_f32_32x32x16_bf16 v[160:175], v[0:3], v[176:179], 0
ds_read_b128 v[188:191], v250 offset:3072
v_mfma_f32_32x32x16_bf16 v[96:111], v[24:27], v[176:179], 0
ds_read_b128 v[176:179], v250 offset:4096
s_waitcnt lgkmcnt(3)
v_mfma_f32_32x32x16_bf16 v[160:175], v[4:7], v[180:183], v[160:175]
v_mfma_f32_32x32x16_bf16 v[96:111], v[28:31], v[180:183], v[96:111]
ds_read_b128 v[180:183], v250 offset:5120
s_waitcnt lgkmcnt(3)
v_mfma_f32_32x32x16_bf16 v[160:175], v[8:11], v[184:187], v[160:175]
v_mfma_f32_32x32x16_bf16 v[96:111], v[32:35], v[184:187], v[96:111]
ds_read_b128 v[184:187], v250 offset:6144
s_waitcnt lgkmcnt(2)
v_mfma_f32_32x32x16_bf16 v[160:175], v[12:15], v[188:191], v[160:175]
v_mfma_f32_32x32x16_bf16 v[96:111], v[36:39], v[188:191], v[96:111]
ds_read_b128 v[188:191], v250 offset:7168
v_mfma_f32_32x32x16_bf16 v[160:175], v[16:19], v[176:179], v[160:175]
v_mfma_f32_32x32x16_bf16 v[96:111], v[40:43], v[176:179], v[96:111]
ds_read_b128 v[176:179], v250 offset:8192
s_waitcnt lgkmcnt(2)
v_mfma_f32_32x32x16_bf16 v[160:175], v[20:23], v[180:183], v[160:175]
v_mfma_f32_32x32x16_bf16 v[96:111], v[44:47], v[180:183], v[96:111]
ds_read_b128 v[180:183], v250 offset:9216
s_nop 9
v_cvt_pkrtz_f16_f32 v161, v160, v161
v_mfma_f32_32x32x16_bf16 v[112:127], v[0:3], v[184:187], 0
v_and_b32_e64 v161, s49, v161
v_bfe_u32 v160, v161, 2, 14
v_lshrrev_b32_e64 v161, 18, v161
v_cvt_pk_f16_f32 v172, v172, v173
v_cvt_pk_f16_f32 v174, v174, v175
v_pk_fma_f16 v173, v172, v172, s48
v_mfma_f32_32x32x16_bf16 v[128:143], v[24:27], v[184:187], 0
ds_read_u16 v160, v160
ds_read_u16 v161, v161
v_cvt_pkrtz_f16_f32 v163, v162, v163
v_and_b32_e64 v163, s49, v163
v_bfe_u32 v162, v163, 2, 14
v_lshrrev_b32_e64 v163, 18, v163
v_pk_fma_f16 v175, v174, v174, s48
v_pk_mul_f16 v173, v172, v173
v_pk_mul_f16 v175, v174, v175
v_cvt_pkrtz_f16_f32 v165, v164, v165
v_and_b32_e64 v165, s49, v165
v_bfe_u32 v164, v165, 2, 14
ds_read_u16 v162, v162
ds_read_u16 v163, v163
v_lshrrev_b32 v165, 18, v165
v_exp_f16_sdwa v173, v173 dst_sel:WORD_0 dst_unused:UNUSED_PRESERVE src0_sel:WORD_0
s_waitcnt lgkmcnt(4)
v_mfma_f32_32x32x16_bf16 v[112:127], v[4:7], v[188:191], v[112:127]
ds_read_u16 v164, v164
ds_read_u16 v165, v165
v_exp_f16_sdwa v175, v175 dst_sel:WORD_0 dst_unused:UNUSED_PRESERVE src0_sel:WORD_0
v_cvt_pkrtz_f16_f32 v167, v166, v167
v_and_b32_e64 v167, s49, v167
v_bfe_u32 v166, v167, 2, 14
v_lshrrev_b32_e64 v167, 18, v167
v_exp_f16_sdwa v173, v173 dst_sel:WORD_1 dst_unused:UNUSED_PRESERVE src0_sel:WORD_1
v_cvt_pkrtz_f16_f32 v169, v168, v169
v_and_b32_e64 v169, s49, v169
v_bfe_u32 v168, v169, 2, 14
v_lshrrev_b32_e64 v169, 18, v169
v_exp_f16_sdwa v175, v175 dst_sel:WORD_1 dst_unused:UNUSED_PRESERVE src0_sel:WORD_1
ds_read_u16 v166, v166
ds_read_u16 v167, v167
ds_read_u16 v168, v168
ds_read_u16 v169, v169
v_mfma_f32_32x32x16_bf16 v[128:143], v[28:31], v[188:191], v[128:143]
ds_read_b128 v[184:187], v250 offset:10240
v_cvt_pkrtz_f16_f32 v171, v170, v171
v_and_b32_e64 v171, s49, v171
v_bfe_u32 v170, v171, 2, 14
v_lshrrev_b32_e64 v171, 18, v171
v_pk_add_f16 v173, v173, 1.0 op_sel_hi:[1,0]
v_pk_add_f16 v175, v175, 1.0 op_sel_hi:[1,0]
v_rcp_f16_sdwa v173, v173 dst_sel:WORD_0 dst_unused:UNUSED_PRESERVE src0_sel:WORD_0
v_mfma_f32_32x32x16_bf16 v[112:127], v[8:11], v[176:179], v[112:127]
ds_read_u16 v170, v170
ds_read_u16 v171, v171
v_rcp_f16_sdwa v175, v175 dst_sel:WORD_0 dst_unused:UNUSED_PRESERVE src0_sel:WORD_0
v_rcp_f16_sdwa v173, v173 dst_sel:WORD_1 dst_unused:UNUSED_PRESERVE src0_sel:WORD_1
v_rcp_f16_sdwa v175, v175 dst_sel:WORD_1 dst_unused:UNUSED_PRESERVE src0_sel:WORD_1
v_mfma_f32_32x32x16_bf16 v[128:143], v[32:35], v[176:179], v[128:143]
ds_read_b128 v[188:191], v250 offset:11264
v_pk_mul_f16 v172, v172, v173
v_pk_mul_f16 v174, v174, v175
v_fma_mix_f32 v224, v172, v172, v224 op_sel_hi:[1,1,0]
v_cvt_pkrtz_f16_f32 v97, v96, v97
v_fma_mix_f32 v224, v174, v174, v224 op_sel_hi:[1,1,0]
v_mfma_f32_32x32x16_bf16 v[112:127], v[12:15], v[180:183], v[112:127]
v_fma_mix_f32 v224, v172, v172, v224 op_sel:[1,1,0] op_sel_hi:[1,1,0]
v_and_b32_e64 v97, s49, v97
v_fma_mix_f32 v224, v174, v174, v224 op_sel:[1,1,0] op_sel_hi:[1,1,0]
v_bfe_u32 v96, v97, 2, 14
s_waitcnt lgkmcnt(8)
v_fma_mix_f32 v224, v160, v160, v224 op_sel_hi:[1,1,0]
v_lshrrev_b32 v97, 18, v97
v_fma_mix_f32 v224, v161, v161, v224 op_sel_hi:[1,1,0]
v_cvt_pk_f16_f32 v106, v106, v107
v_fma_mix_f32 v224, v162, v162, v224 op_sel_hi:[1,1,0]
v_cvt_pk_f16_f32 v108, v108, v109
v_fma_mix_f32 v224, v163, v163, v224 op_sel_hi:[1,1,0]
v_cvt_pk_f16_f32 v110, v110, v111
v_pk_fma_f16 v107, v106, v106, s48
v_mfma_f32_32x32x16_bf16 v[128:143], v[36:39], v[180:183], v[128:143]
ds_read_u16 v96, v96
ds_read_u16 v97, v97
v_fma_mix_f32 v224, v164, v164, v224 op_sel_hi:[1,1,0]
v_pk_fma_f16 v109, v108, v108, s48
v_fma_mix_f32 v224, v165, v165, v224 op_sel_hi:[1,1,0]
v_cvt_pkrtz_f16_f32 v99, v98, v99
v_and_b32_e64 v99, s49, v99
v_bfe_u32 v98, v99, 2, 14
v_lshrrev_b32_e64 v99, 18, v99
v_pk_fma_f16 v111, v110, v110, s48
v_pk_mul_f16 v107, v106, v107
ds_read_b128 v[176:179], v250 offset:12288
ds_read_u16 v98, v98
ds_read_u16 v99, v99
v_pk_mul_f16 v109, v108, v109
s_waitcnt lgkmcnt(8)
v_fma_mix_f32 v224, v166, v166, v224 op_sel_hi:[1,1,0]
v_pk_mul_f16 v111, v110, v111
v_fma_mix_f32 v224, v167, v167, v224 op_sel_hi:[1,1,0]
v_exp_f16_sdwa v107, v107 dst_sel:WORD_0 dst_unused:UNUSED_PRESERVE src0_sel:WORD_0
v_cvt_pkrtz_f16_f32 v101, v100, v101
v_and_b32 v101, s49, v101
v_bfe_u32 v100, v101, 2, 14
v_lshrrev_b32_e64 v101, 18, v101
v_mfma_f32_32x32x16_bf16 v[112:127], v[16:19], v[184:187], v[112:127]
ds_read_u16 v100, v100
ds_read_u16 v101, v101
v_exp_f16_sdwa v109, v109 dst_sel:WORD_0 dst_unused:UNUSED_PRESERVE src0_sel:WORD_0
v_fma_mix_f32 v224, v168, v168, v224 op_sel_hi:[1,1,0]
v_exp_f16_sdwa v111, v111 dst_sel:WORD_0 dst_unused:UNUSED_PRESERVE src0_sel:WORD_0
v_fma_mix_f32 v224, v169, v169, v224 op_sel_hi:[1,1,0]
v_cvt_pkrtz_f16_f32 v103, v102, v103
v_and_b32_e64 v103, s49, v103
v_bfe_u32 v102, v103, 2, 14
v_lshrrev_b32 v103, 18, v103
v_exp_f16_sdwa v107, v107 dst_sel:WORD_1 dst_unused:UNUSED_PRESERVE src0_sel:WORD_1
s_waitcnt lgkmcnt(6)
v_fma_mix_f32 v224, v170, v170, v224 op_sel_hi:[1,1,0]
v_exp_f16_sdwa v109, v109 dst_sel:WORD_1 dst_unused:UNUSED_PRESERVE src0_sel:WORD_1
v_fma_mix_f32 v224, v171, v171, v224 op_sel_hi:[1,1,0]
v_mfma_f32_32x32x16_bf16 v[128:143], v[40:43], v[184:187], v[128:143]
ds_read_u16 v102, v102
ds_read_u16 v103, v103
v_exp_f16_sdwa v111, v111 dst_sel:WORD_1 dst_unused:UNUSED_PRESERVE src0_sel:WORD_1
v_cvt_pkrtz_f16_f32 v105, v104, v105
v_and_b32_e64 v105, s49, v105
v_bfe_u32 v104, v105, 2, 14
v_lshrrev_b32_e64 v105, 18, v105
v_pk_add_f16 v107, v107, 1.0 op_sel_hi:[1,0]
v_pk_add_f16 v109, v109, 1.0 op_sel_hi:[1,0]
ds_read_b128 v[180:183], v250 offset:13312
ds_read_u16 v104, v104
ds_read_u16 v105, v105
v_pk_add_f16 v111, v111, 1.0 op_sel_hi:[1,0]
v_rcp_f16_sdwa v107, v107 dst_sel:WORD_0 dst_unused:UNUSED_PRESERVE src0_sel:WORD_0
v_mfma_f32_32x32x16_bf16 v[112:127], v[20:23], v[188:191], v[112:127]
v_rcp_f16_sdwa v109, v109 dst_sel:WORD_0 dst_unused:UNUSED_PRESERVE src0_sel:WORD_0
v_rcp_f16_sdwa v111, v111 dst_sel:WORD_0 dst_unused:UNUSED_PRESERVE src0_sel:WORD_0
v_rcp_f16_sdwa v107, v107 dst_sel:WORD_1 dst_unused:UNUSED_PRESERVE src0_sel:WORD_1
v_rcp_f16_sdwa v109, v109 dst_sel:WORD_1 dst_unused:UNUSED_PRESERVE src0_sel:WORD_1
v_mfma_f32_32x32x16_bf16 v[128:143], v[44:47], v[188:191], v[128:143]
v_rcp_f16_sdwa v111, v111 dst_sel:WORD_1 dst_unused:UNUSED_PRESERVE src0_sel:WORD_1
v_pk_mul_f16 v106, v106, v107
v_pk_mul_f16 v108, v108, v109
v_pk_mul_f16 v110, v110, v111
v_fma_mix_f32 v224, v106, v106, v224 op_sel_hi:[1,1,0]
s_waitcnt lgkmcnt(5)
v_mfma_f32_32x32x16_bf16 v[144:159], v[0:3], v[176:179], 0
ds_read_b128 v[184:187], v250 offset:14336
v_fma_mix_f32 v224, v108, v108, v224 op_sel_hi:[1,1,0]
buffer_store_dwordx4 v[0:3], v250, s[32:35], s80 offen
v_fma_mix_f32 v224, v110, v110, v224 op_sel_hi:[1,1,0]
v_cvt_pkrtz_f16_f32 v113, v112, v113
v_fma_mix_f32 v224, v106, v106, v224 op_sel:[1,1,0] op_sel_hi:[1,1,0]
v_and_b32 v113, s49, v113
v_fma_mix_f32 v224, v108, v108, v224 op_sel:[1,1,0] op_sel_hi:[1,1,0]
v_bfe_u32 v112, v113, 2, 14
v_fma_mix_f32 v224, v110, v110, v224 op_sel:[1,1,0] op_sel_hi:[1,1,0]
v_lshrrev_b32_e64 v113, 18, v113
v_fma_mix_f32 v224, v96, v96, v224 op_sel_hi:[1,1,0]
v_cvt_pk_f16_f32 v124, v124, v125
v_fma_mix_f32 v224, v97, v97, v224 op_sel_hi:[1,1,0]
v_cvt_pk_f16_f32 v126, v126, v127
v_fma_mix_f32 v224, v98, v98, v224 op_sel_hi:[1,1,0]
v_pk_fma_f16 v125, v124, v124, s48
v_fma_mix_f32 v224, v99, v99, v224 op_sel_hi:[1,1,0]
v_mfma_f32_32x32x16_bf16 v[160:175], v[24:27], v[176:179], 0
ds_read_u16 v112, v112
ds_read_u16 v113, v113
v_cvt_pkrtz_f16_f32 v115, v114, v115
v_and_b32_e64 v115, s49, v115
v_bfe_u32 v114, v115, 2, 14
v_lshrrev_b32_e64 v115, 18, v115
v_pk_fma_f16 v127, v126, v126, s48
v_fma_mix_f32 v224, v100, v100, v224 op_sel_hi:[1,1,0]
v_pk_mul_f16 v125, v124, v125
v_fma_mix_f32 v224, v101, v101, v224 op_sel_hi:[1,1,0]
v_pk_mul_f16 v127, v126, v127
v_cvt_pkrtz_f16_f32 v117, v116, v117
ds_read_u16 v114, v114
ds_read_u16 v115, v115
ds_read_b128 v[188:191], v250 offset:15360
v_and_b32_e64 v117, s49, v117
v_bfe_u32 v116, v117, 2, 14
v_lshrrev_b32 v117, 18, v117
v_exp_f16_sdwa v125, v125 dst_sel:WORD_0 dst_unused:UNUSED_PRESERVE src0_sel:WORD_0
s_waitcnt lgkmcnt(5)
v_fma_mix_f32 v224, v102, v102, v224 op_sel_hi:[1,1,0]
v_mfma_f32_32x32x16_bf16 v[144:159], v[4:7], v[180:183], v[144:159]
ds_read_u16 v116, v116
ds_read_u16 v117, v117
v_fma_mix_f32 v224, v103, v103, v224 op_sel_hi:[1,1,0]
v_exp_f16_sdwa v127, v127 dst_sel:WORD_0 dst_unused:UNUSED_PRESERVE src0_sel:WORD_0
v_cvt_pkrtz_f16_f32 v119, v118, v119
v_and_b32_e64 v119, s49, v119
v_bfe_u32 v118, v119, 2, 14
v_lshrrev_b32_e64 v119, 18, v119
v_exp_f16_sdwa v125, v125 dst_sel:WORD_1 dst_unused:UNUSED_PRESERVE src0_sel:WORD_1
v_fma_mix_f32 v224, v104, v104, v224 op_sel_hi:[1,1,0]
v_cvt_pkrtz_f16_f32 v121, v120, v121
v_fma_mix_f32 v224, v105, v105, v224 op_sel_hi:[1,1,0]
v_and_b32_e64 v121, s49, v121
v_bfe_u32 v120, v121, 2, 14
ds_read_u16 v118, v118
ds_read_u16 v119, v119
v_lshrrev_b32_e64 v121, 18, v121
v_exp_f16_sdwa v127, v127 dst_sel:WORD_1 dst_unused:UNUSED_PRESERVE src0_sel:WORD_1
v_mfma_f32_32x32x16_bf16 v[160:175], v[28:31], v[180:183], v[160:175]
ds_read_u16 v120, v120
ds_read_u16 v121, v121
ds_read_b128 v[176:179], v250 offset:16384
v_cvt_pkrtz_f16_f32 v123, v122, v123
v_and_b32_e64 v123, s49, v123
v_bfe_u32 v122, v123, 2, 14
v_lshrrev_b32_e64 v123, 18, v123
v_pk_add_f16 v125, v125, 1.0 op_sel_hi:[1,0]
v_pk_add_f16 v127, v127, 1.0 op_sel_hi:[1,0]
v_rcp_f16_sdwa v125, v125 dst_sel:WORD_0 dst_unused:UNUSED_PRESERVE src0_sel:WORD_0
v_mfma_f32_32x32x16_bf16 v[144:159], v[8:11], v[184:187], v[144:159]
ds_read_u16 v122, v122
ds_read_u16 v123, v123
v_rcp_f16_sdwa v127, v127 dst_sel:WORD_0 dst_unused:UNUSED_PRESERVE src0_sel:WORD_0
s_add_u32 s46, s80, 2097152
buffer_store_dwordx4 v[4:7], v250, s[32:35], s46 offen
v_rcp_f16_sdwa v125, v125 dst_sel:WORD_1 dst_unused:UNUSED_PRESERVE src0_sel:WORD_1
v_rcp_f16_sdwa v127, v127 dst_sel:WORD_1 dst_unused:UNUSED_PRESERVE src0_sel:WORD_1
v_mfma_f32_32x32x16_bf16 v[160:175], v[32:35], v[184:187], v[160:175]
ds_read_b128 v[180:183], v250 offset:17408
v_pk_mul_f16 v124, v124, v125
v_pk_mul_f16 v126, v126, v127
v_fma_mix_f32 v225, v124, v124, v225 op_sel_hi:[1,1,0]
v_cvt_pkrtz_f16_f32 v129, v128, v129
v_fma_mix_f32 v225, v126, v126, v225 op_sel_hi:[1,1,0]
s_waitcnt lgkmcnt(8)
v_mfma_f32_32x32x16_bf16 v[144:159], v[12:15], v[188:191], v[144:159]
v_fma_mix_f32 v225, v124, v124, v225 op_sel:[1,1,0] op_sel_hi:[1,1,0]
v_and_b32 v129, s49, v129
v_fma_mix_f32 v225, v126, v126, v225 op_sel:[1,1,0] op_sel_hi:[1,1,0]
v_bfe_u32 v128, v129, 2, 14
v_fma_mix_f32 v225, v112, v112, v225 op_sel_hi:[1,1,0]
v_lshrrev_b32_e64 v129, 18, v129
v_fma_mix_f32 v225, v113, v113, v225 op_sel_hi:[1,1,0]
v_cvt_pk_f16_f32 v138, v138, v139
v_fma_mix_f32 v225, v114, v114, v225 op_sel_hi:[1,1,0]
v_cvt_pk_f16_f32 v140, v140, v141
v_fma_mix_f32 v225, v115, v115, v225 op_sel_hi:[1,1,0]
v_cvt_pk_f16_f32 v142, v142, v143
v_pk_fma_f16 v139, v138, v138, s48
v_mfma_f32_32x32x16_bf16 v[160:175], v[36:39], v[188:191], v[160:175]
ds_read_u16 v128, v128
ds_read_u16 v129, v129
v_fma_mix_f32 v225, v116, v116, v225 op_sel_hi:[1,1,0]
v_pk_fma_f16 v141, v140, v140, s48
v_fma_mix_f32 v225, v117, v117, v225 op_sel_hi:[1,1,0]
v_cvt_pkrtz_f16_f32 v131, v130, v131
v_and_b32_e64 v131, s49, v131
v_bfe_u32 v130, v131, 2, 14
v_lshrrev_b32_e64 v131, 18, v131
v_pk_fma_f16 v143, v142, v142, s48
v_pk_mul_f16 v139, v138, v139
ds_read_b128 v[184:187], v250 offset:18432
ds_read_u16 v130, v130
ds_read_u16 v131, v131
v_pk_mul_f16 v141, v140, v141
s_waitcnt lgkmcnt(8)
v_fma_mix_f32 v225, v118, v118, v225 op_sel_hi:[1,1,0]
v_pk_mul_f16 v143, v142, v143
v_fma_mix_f32 v225, v119, v119, v225 op_sel_hi:[1,1,0]
v_exp_f16_sdwa v139, v139 dst_sel:WORD_0 dst_unused:UNUSED_PRESERVE src0_sel:WORD_0
v_cvt_pkrtz_f16_f32 v133, v132, v133
v_and_b32 v133, s49, v133
v_bfe_u32 v132, v133, 2, 14
v_lshrrev_b32_e64 v133, 18, v133
v_mfma_f32_32x32x16_bf16 v[144:159], v[16:19], v[176:179], v[144:159]
ds_read_u16 v132, v132
ds_read_u16 v133, v133
v_exp_f16_sdwa v141, v141 dst_sel:WORD_0 dst_unused:UNUSED_PRESERVE src0_sel:WORD_0
v_fma_mix_f32 v225, v120, v120, v225 op_sel_hi:[1,1,0]
v_exp_f16_sdwa v143, v143 dst_sel:WORD_0 dst_unused:UNUSED_PRESERVE src0_sel:WORD_0
v_fma_mix_f32 v225, v121, v121, v225 op_sel_hi:[1,1,0]
s_add_u32 s46, s80, 4194304
buffer_store_dwordx4 v[8:11], v250, s[32:35], s46 offen
v_cvt_pkrtz_f16_f32 v135, v134, v135
v_and_b32_e64 v135, s49, v135
v_bfe_u32 v134, v135, 2, 14
v_lshrrev_b32 v135, 18, v135
v_exp_f16_sdwa v139, v139 dst_sel:WORD_1 dst_unused:UNUSED_PRESERVE src0_sel:WORD_1
s_waitcnt lgkmcnt(6)
v_fma_mix_f32 v225, v122, v122, v225 op_sel_hi:[1,1,0]
v_exp_f16_sdwa v141, v141 dst_sel:WORD_1 dst_unused:UNUSED_PRESERVE src0_sel:WORD_1
v_fma_mix_f32 v225, v123, v123, v225 op_sel_hi:[1,1,0]
v_mfma_f32_32x32x16_bf16 v[160:175], v[40:43], v[176:179], v[160:175]
ds_read_u16 v134, v134
ds_read_u16 v135, v135
v_exp_f16_sdwa v143, v143 dst_sel:WORD_1 dst_unused:UNUSED_PRESERVE src0_sel:WORD_1
v_cvt_pkrtz_f16_f32 v137, v136, v137
v_and_b32_e64 v137, s49, v137
v_bfe_u32 v136, v137, 2, 14
v_lshrrev_b32_e64 v137, 18, v137
v_pk_add_f16 v139, v139, 1.0 op_sel_hi:[1,0]
v_pk_add_f16 v141, v141, 1.0 op_sel_hi:[1,0]
ds_read_b128 v[188:191], v250 offset:19456
ds_read_u16 v136, v136
ds_read_u16 v137, v137
v_pk_add_f16 v143, v143, 1.0 op_sel_hi:[1,0]
v_rcp_f16_sdwa v139, v139 dst_sel:WORD_0 dst_unused:UNUSED_PRESERVE src0_sel:WORD_0
v_mfma_f32_32x32x16_bf16 v[144:159], v[20:23], v[180:183], v[144:159]
v_rcp_f16_sdwa v141, v141 dst_sel:WORD_0 dst_unused:UNUSED_PRESERVE src0_sel:WORD_0
v_rcp_f16_sdwa v143, v143 dst_sel:WORD_0 dst_unused:UNUSED_PRESERVE src0_sel:WORD_0
v_rcp_f16_sdwa v139, v139 dst_sel:WORD_1 dst_unused:UNUSED_PRESERVE src0_sel:WORD_1
v_rcp_f16_sdwa v141, v141 dst_sel:WORD_1 dst_unused:UNUSED_PRESERVE src0_sel:WORD_1
v_mfma_f32_32x32x16_bf16 v[160:175], v[44:47], v[180:183], v[160:175]
v_rcp_f16_sdwa v143, v143 dst_sel:WORD_1 dst_unused:UNUSED_PRESERVE src0_sel:WORD_1
v_pk_mul_f16 v138, v138, v139
v_pk_mul_f16 v140, v140, v141
v_pk_mul_f16 v142, v142, v143
v_fma_mix_f32 v225, v138, v138, v225 op_sel_hi:[1,1,0]
s_waitcnt lgkmcnt(5)
v_mfma_f32_32x32x16_bf16 v[96:111], v[0:3], v[184:187], 0
ds_read_b128 v[176:179], v250 offset:20480
v_fma_mix_f32 v225, v140, v140, v225 op_sel_hi:[1,1,0]
v_cvt_pkrtz_f16_f32 v145, v144, v145
v_fma_mix_f32 v225, v142, v142, v225 op_sel_hi:[1,1,0]
v_and_b32 v145, s49, v145
v_fma_mix_f32 v225, v138, v138, v225 op_sel:[1,1,0] op_sel_hi:[1,1,0]
v_bfe_u32 v144, v145, 2, 14
v_fma_mix_f32 v225, v140, v140, v225 op_sel:[1,1,0] op_sel_hi:[1,1,0]
v_lshrrev_b32_e64 v145, 18, v145
v_fma_mix_f32 v225, v142, v142, v225 op_sel:[1,1,0] op_sel_hi:[1,1,0]
v_cvt_pk_f16_f32 v156, v156, v157
v_fma_mix_f32 v225, v128, v128, v225 op_sel_hi:[1,1,0]
v_cvt_pk_f16_f32 v158, v158, v159
v_fma_mix_f32 v225, v129, v129, v225 op_sel_hi:[1,1,0]
s_add_u32 s46, s80, 6291456
buffer_store_dwordx4 v[12:15], v250, s[32:35], s46 offen
ds_read_u16 v144, v144
ds_read_u16 v145, v145
v_fma_mix_f32 v225, v130, v130, v225 op_sel_hi:[1,1,0]
v_pk_fma_f16 v157, v156, v156, s48
v_fma_mix_f32 v225, v131, v131, v225 op_sel_hi:[1,1,0]
v_mfma_f32_32x32x16_bf16 v[112:127], v[24:27], v[184:187], 0
v_cvt_pkrtz_f16_f32 v147, v146, v147
v_and_b32_e64 v147, s49, v147
v_bfe_u32 v146, v147, 2, 14
v_lshrrev_b32_e64 v147, 18, v147
v_pk_fma_f16 v159, v158, v158, s48
v_fma_mix_f32 v225, v132, v132, v225 op_sel_hi:[1,1,0]
v_pk_mul_f16 v157, v156, v157
v_fma_mix_f32 v225, v133, v133, v225 op_sel_hi:[1,1,0]
v_pk_mul_f16 v159, v158, v159
v_cvt_pkrtz_f16_f32 v149, v148, v149
ds_read_u16 v146, v146
ds_read_u16 v147, v147
ds_read_b128 v[180:183], v250 offset:21504
v_and_b32_e64 v149, s49, v149
v_bfe_u32 v148, v149, 2, 14
v_lshrrev_b32 v149, 18, v149
v_exp_f16_sdwa v157, v157 dst_sel:WORD_0 dst_unused:UNUSED_PRESERVE src0_sel:WORD_0
s_waitcnt lgkmcnt(5)
v_fma_mix_f32 v225, v134, v134, v225 op_sel_hi:[1,1,0]
v_mfma_f32_32x32x16_bf16 v[96:111], v[4:7], v[188:191], v[96:111]
ds_read_u16 v148, v148
ds_read_u16 v149, v149
v_fma_mix_f32 v225, v135, v135, v225 op_sel_hi:[1,1,0]
v_exp_f16_sdwa v159, v159 dst_sel:WORD_0 dst_unused:UNUSED_PRESERVE src0_sel:WORD_0
v_cvt_pkrtz_f16_f32 v151, v150, v151
v_and_b32_e64 v151, s49, v151
v_bfe_u32 v150, v151, 2, 14
v_lshrrev_b32_e64 v151, 18, v151
v_exp_f16_sdwa v157, v157 dst_sel:WORD_1 dst_unused:UNUSED_PRESERVE src0_sel:WORD_1
v_fma_mix_f32 v225, v136, v136, v225 op_sel_hi:[1,1,0]
v_cvt_pkrtz_f16_f32 v153, v152, v153
v_fma_mix_f32 v225, v137, v137, v225 op_sel_hi:[1,1,0]
v_and_b32_e64 v153, s49, v153
v_bfe_u32 v152, v153, 2, 14
ds_read_u16 v150, v150
ds_read_u16 v151, v151
v_lshrrev_b32_e64 v153, 18, v153
v_exp_f16_sdwa v159, v159 dst_sel:WORD_1 dst_unused:UNUSED_PRESERVE src0_sel:WORD_1
v_mfma_f32_32x32x16_bf16 v[112:127], v[28:31], v[188:191], v[112:127]
ds_read_u16 v152, v152
ds_read_u16 v153, v153
ds_read_b128 v[184:187], v250 offset:22528
v_cvt_pkrtz_f16_f32 v155, v154, v155
v_and_b32_e64 v155, s49, v155
v_bfe_u32 v154, v155, 2, 14
v_lshrrev_b32_e64 v155, 18, v155
v_pk_add_f16 v157, v157, 1.0 op_sel_hi:[1,0]
v_pk_add_f16 v159, v159, 1.0 op_sel_hi:[1,0]
v_rcp_f16_sdwa v157, v157 dst_sel:WORD_0 dst_unused:UNUSED_PRESERVE src0_sel:WORD_0
v_mfma_f32_32x32x16_bf16 v[96:111], v[8:11], v[176:179], v[96:111]
ds_read_u16 v154, v154
ds_read_u16 v155, v155
v_rcp_f16_sdwa v159, v159 dst_sel:WORD_0 dst_unused:UNUSED_PRESERVE src0_sel:WORD_0
v_rcp_f16_sdwa v157, v157 dst_sel:WORD_1 dst_unused:UNUSED_PRESERVE src0_sel:WORD_1
s_add_u32 s46, s80, 8388608
buffer_store_dwordx4 v[16:19], v250, s[32:35], s46 offen
v_rcp_f16_sdwa v159, v159 dst_sel:WORD_1 dst_unused:UNUSED_PRESERVE src0_sel:WORD_1
v_mfma_f32_32x32x16_bf16 v[112:127], v[32:35], v[176:179], v[112:127]
ds_read_b128 v[188:191], v250 offset:23552
v_mov_b32 v223, 0
s_branch Law3
Lax3:
s_sleep 2
Law3:
ds_read_b32 v223, v247 offset:12
s_sub_u32 s76, s76, 1
s_cselect_b32 s44, 4, 0
s_cselect_b32 s76, 0, s76
s_waitcnt lgkmcnt(0)
v_readfirstlane_b32 s43, v223
s_nop 1
s_max_u32 s43, s43, s44
s_cmp_lt_u32 s43, 4
s_cbranch_scc1 Lax3
v_pk_mul_f16 v156, v156, v157
v_pk_mul_f16 v158, v158, v159
v_fma_mix_f32 v226, v156, v156, v226 op_sel_hi:[1,1,0]
v_mfma_f32_32x32x16_bf16 v[96:111], v[12:15], v[180:183], v[96:111]
v_fma_mix_f32 v226, v158, v158, v226 op_sel_hi:[1,1,0]
s_setprio 3
v_cvt_pkrtz_f16_f32 v161, v160, v161
v_fma_mix_f32 v226, v156, v156, v226 op_sel:[1,1,0] op_sel_hi:[1,1,0]
v_and_b32 v161, s49, v161
v_fma_mix_f32 v226, v158, v158, v226 op_sel:[1,1,0] op_sel_hi:[1,1,0]
v_bfe_u32 v160, v161, 2, 14
v_fma_mix_f32 v226, v144, v144, v226 op_sel_hi:[1,1,0]
v_lshrrev_b32_e64 v161, 18, v161
v_fma_mix_f32 v226, v145, v145, v226 op_sel_hi:[1,1,0]
v_cvt_pk_f16_f32 v170, v170, v171
v_fma_mix_f32 v226, v146, v146, v226 op_sel_hi:[1,1,0]
v_cvt_pk_f16_f32 v172, v172, v173
v_fma_mix_f32 v226, v147, v147, v226 op_sel_hi:[1,1,0]
v_cvt_pk_f16_f32 v174, v174, v175
v_pk_fma_f16 v171, v170, v170, s48
v_mfma_f32_32x32x16_bf16 v[112:127], v[36:39], v[180:183], v[112:127]
ds_read_u16 v160, v160
ds_read_u16 v161, v161
v_fma_mix_f32 v226, v148, v148, v226 op_sel_hi:[1,1,0]
v_pk_fma_f16 v173, v172, v172, s48
v_fma_mix_f32 v226, v149, v149, v226 op_sel_hi:[1,1,0]
v_cvt_pkrtz_f16_f32 v163, v162, v163
v_and_b32_e64 v163, s49, v163
v_bfe_u32 v162, v163, 2, 14
v_lshrrev_b32_e64 v163, 18, v163
v_pk_fma_f16 v175, v174, v174, s48
v_pk_mul_f16 v171, v170, v171
ds_read_b128 v[176:179], v250 offset:24576
ds_read_u16 v162, v162
ds_read_u16 v163, v163
v_pk_mul_f16 v173, v172, v173
v_fma_mix_f32 v226, v150, v150, v226 op_sel_hi:[1,1,0]
v_pk_mul_f16 v175, v174, v175
v_fma_mix_f32 v226, v151, v151, v226 op_sel_hi:[1,1,0]
v_exp_f16_sdwa v171, v171 dst_sel:WORD_0 dst_unused:UNUSED_PRESERVE src0_sel:WORD_0
v_cvt_pkrtz_f16_f32 v165, v164, v165
v_and_b32_e64 v165, s49, v165
v_bfe_u32 v164, v165, 2, 14
v_lshrrev_b32_e64 v165, 18, v165
v_mfma_f32_32x32x16_bf16 v[96:111], v[16:19], v[184:187], v[96:111]
ds_read_u16 v164, v164
ds_read_u16 v165, v165
v_exp_f16_sdwa v173, v173 dst_sel:WORD_0 dst_unused:UNUSED_PRESERVE src0_sel:WORD_0
v_fma_mix_f32 v226, v152, v152, v226 op_sel_hi:[1,1,0]
v_exp_f16_sdwa v175, v175 dst_sel:WORD_0 dst_unused:UNUSED_PRESERVE src0_sel:WORD_0
v_fma_mix_f32 v226, v153, v153, v226 op_sel_hi:[1,1,0]
v_cvt_pkrtz_f16_f32 v167, v166, v167
v_and_b32_e64 v167, s49, v167
v_bfe_u32 v166, v167, 2, 14
v_lshrrev_b32_e64 v167, 18, v167
v_exp_f16_sdwa v171, v171 dst_sel:WORD_1 dst_unused:UNUSED_PRESERVE src0_sel:WORD_1
v_fma_mix_f32 v226, v154, v154, v226 op_sel_hi:[1,1,0]
v_exp_f16_sdwa v173, v173 dst_sel:WORD_1 dst_unused:UNUSED_PRESERVE src0_sel:WORD_1
v_fma_mix_f32 v226, v155, v155, v226 op_sel_hi:[1,1,0]
v_mfma_f32_32x32x16_bf16 v[112:127], v[40:43], v[184:187], v[112:127]
ds_read_u16 v166, v166
ds_read_u16 v167, v167
s_add_u32 s46, s80, 10485760
buffer_store_dwordx4 v[20:23], v250, s[32:35], s46 offen
v_exp_f16_sdwa v175, v175 dst_sel:WORD_1 dst_unused:UNUSED_PRESERVE src0_sel:WORD_1
v_cvt_pkrtz_f16_f32 v169, v168, v169
v_and_b32_e64 v169, s49, v169
v_bfe_u32 v168, v169, 2, 14
v_lshrrev_b32_e64 v169, 18, v169
v_pk_add_f16 v171, v171, 1.0 op_sel_hi:[1,0]
v_pk_add_f16 v173, v173, 1.0 op_sel_hi:[1,0]
ds_read_b128 v[180:183], v250 offset:25600
ds_read_u16 v168, v168
ds_read_u16 v169, v169
v_pk_add_f16 v175, v175, 1.0 op_sel_hi:[1,0]
v_rcp_f16_sdwa v171, v171 dst_sel:WORD_0 dst_unused:UNUSED_PRESERVE src0_sel:WORD_0
v_mfma_f32_32x32x16_bf16 v[96:111], v[20:23], v[188:191], v[96:111]
v_rcp_f16_sdwa v173, v173 dst_sel:WORD_0 dst_unused:UNUSED_PRESERVE src0_sel:WORD_0
v_rcp_f16_sdwa v175, v175 dst_sel:WORD_0 dst_unused:UNUSED_PRESERVE src0_sel:WORD_0
v_rcp_f16_sdwa v171, v171 dst_sel:WORD_1 dst_unused:UNUSED_PRESERVE src0_sel:WORD_1
v_rcp_f16_sdwa v173, v173 dst_sel:WORD_1 dst_unused:UNUSED_PRESERVE src0_sel:WORD_1
v_mfma_f32_32x32x16_bf16 v[112:127], v[44:47], v[188:191], v[112:127]
v_rcp_f16_sdwa v175, v175 dst_sel:WORD_1 dst_unused:UNUSED_PRESERVE src0_sel:WORD_1
v_pk_mul_f16 v170, v170, v171
v_pk_mul_f16 v172, v172, v173
v_pk_mul_f16 v174, v174, v175
v_fma_mix_f32 v226, v170, v170, v226 op_sel_hi:[1,1,0]
s_waitcnt lgkmcnt(4)
v_mfma_f32_32x32x16_bf16 v[128:143], v[0:3], v[176:179], 0
ds_read_b128 v[184:187], v250 offset:26624
v_fma_mix_f32 v226, v172, v172, v226 op_sel_hi:[1,1,0]
v_cvt_pkrtz_f16_f32 v97, v96, v97
v_fma_mix_f32 v226, v174, v174, v226 op_sel_hi:[1,1,0]
v_and_b32 v97, s49, v97
v_fma_mix_f32 v226, v170, v170, v226 op_sel:[1,1,0] op_sel_hi:[1,1,0]
v_bfe_u32 v96, v97, 2, 14
v_fma_mix_f32 v226, v172, v172, v226 op_sel:[1,1,0] op_sel_hi:[1,1,0]
v_lshrrev_b32_e64 v97, 18, v97
v_fma_mix_f32 v226, v174, v174, v226 op_sel:[1,1,0] op_sel_hi:[1,1,0]
v_cvt_pk_f16_f32 v108, v108, v109
v_fma_mix_f32 v226, v160, v160, v226 op_sel_hi:[1,1,0]
v_cvt_pk_f16_f32 v110, v110, v111
v_fma_mix_f32 v226, v161, v161, v226 op_sel_hi:[1,1,0]
v_pk_fma_f16 v109, v108, v108, s48
v_fma_mix_f32 v226, v162, v162, v226 op_sel_hi:[1,1,0]
v_mfma_f32_32x32x16_bf16 v[144:159], v[24:27], v[176:179], 0
ds_read_u16 v96, v96
ds_read_u16 v97, v97
v_fma_mix_f32 v226, v163, v163, v226 op_sel_hi:[1,1,0]
v_cvt_pkrtz_f16_f32 v99, v98, v99
v_and_b32_e64 v99, s49, v99
v_bfe_u32 v98, v99, 2, 14
v_lshrrev_b32_e64 v99, 18, v99
v_pk_fma_f16 v111, v110, v110, s48
v_fma_mix_f32 v226, v164, v164, v226 op_sel_hi:[1,1,0]
v_pk_mul_f16 v109, v108, v109
v_fma_mix_f32 v226, v165, v165, v226 op_sel_hi:[1,1,0]
v_pk_mul_f16 v111, v110, v111
v_cvt_pkrtz_f16_f32 v101, v100, v101
ds_read_u16 v98, v98
ds_read_u16 v99, v99
ds_read_b128 v[188:191], v250 offset:27648
v_and_b32_e64 v101, s49, v101
v_bfe_u32 v100, v101, 2, 14
v_lshrrev_b32 v101, 18, v101
v_exp_f16_sdwa v109, v109 dst_sel:WORD_0 dst_unused:UNUSED_PRESERVE src0_sel:WORD_0
v_fma_mix_f32 v226, v166, v166, v226 op_sel_hi:[1,1,0]
s_waitcnt lgkmcnt(5)
v_mfma_f32_32x32x16_bf16 v[128:143], v[4:7], v[180:183], v[128:143]
ds_read_u16 v100, v100
ds_read_u16 v101, v101
v_fma_mix_f32 v226, v167, v167, v226 op_sel_hi:[1,1,0]
v_exp_f16_sdwa v111, v111 dst_sel:WORD_0 dst_unused:UNUSED_PRESERVE src0_sel:WORD_0
v_cvt_pkrtz_f16_f32 v103, v102, v103
v_and_b32_e64 v103, s49, v103
v_bfe_u32 v102, v103, 2, 14
v_lshrrev_b32_e64 v103, 18, v103
v_exp_f16_sdwa v109, v109 dst_sel:WORD_1 dst_unused:UNUSED_PRESERVE src0_sel:WORD_1
v_fma_mix_f32 v226, v168, v168, v226 op_sel_hi:[1,1,0]
v_cvt_pkrtz_f16_f32 v105, v104, v105
v_fma_mix_f32 v226, v169, v169, v226 op_sel_hi:[1,1,0]
v_and_b32_e64 v105, s49, v105
v_bfe_u32 v104, v105, 2, 14
ds_read_u16 v102, v102
ds_read_u16 v103, v103
v_lshrrev_b32_e64 v105, 18, v105
v_exp_f16_sdwa v111, v111 dst_sel:WORD_1 dst_unused:UNUSED_PRESERVE src0_sel:WORD_1
v_mfma_f32_32x32x16_bf16 v[144:159], v[28:31], v[180:183], v[144:159]
ds_read_u16 v104, v104
ds_read_u16 v105, v105
ds_read_b128 v[176:179], v250 offset:28672
v_cvt_pkrtz_f16_f32 v107, v106, v107
v_and_b32_e64 v107, s49, v107
v_bfe_u32 v106, v107, 2, 14
v_lshrrev_b32_e64 v107, 18, v107
v_pk_add_f16 v109, v109, 1.0 op_sel_hi:[1,0]
v_pk_add_f16 v111, v111, 1.0 op_sel_hi:[1,0]
v_rcp_f16_sdwa v109, v109 dst_sel:WORD_0 dst_unused:UNUSED_PRESERVE src0_sel:WORD_0
v_mfma_f32_32x32x16_bf16 v[128:143], v[8:11], v[184:187], v[128:143]
ds_read_u16 v106, v106
ds_read_u16 v107, v107
v_rcp_f16_sdwa v111, v111 dst_sel:WORD_0 dst_unused:UNUSED_PRESERVE src0_sel:WORD_0
v_rcp_f16_sdwa v109, v109 dst_sel:WORD_1 dst_unused:UNUSED_PRESERVE src0_sel:WORD_1
v_rcp_f16_sdwa v111, v111 dst_sel:WORD_1 dst_unused:UNUSED_PRESERVE src0_sel:WORD_1
v_mfma_f32_32x32x16_bf16 v[144:159], v[32:35], v[184:187], v[144:159]
ds_read_b128 v[180:183], v250 offset:29696
v_pk_mul_f16 v108, v108, v109
v_pk_mul_f16 v110, v110, v111
v_fma_mix_f32 v227, v108, v108, v227 op_sel_hi:[1,1,0]
v_cvt_pkrtz_f16_f32 v113, v112, v113
v_fma_mix_f32 v227, v110, v110, v227 op_sel_hi:[1,1,0]
s_waitcnt lgkmcnt(8)
v_mfma_f32_32x32x16_bf16 v[128:143], v[12:15], v[188:191], v[128:143]
v_fma_mix_f32 v227, v108, v108, v227 op_sel:[1,1,0] op_sel_hi:[1,1,0]
v_and_b32 v113, s49, v113
v_fma_mix_f32 v227, v110, v110, v227 op_sel:[1,1,0] op_sel_hi:[1,1,0]
v_bfe_u32 v112, v113, 2, 14
v_fma_mix_f32 v227, v96, v96, v227 op_sel_hi:[1,1,0]
v_lshrrev_b32_e64 v113, 18, v113
v_fma_mix_f32 v227, v97, v97, v227 op_sel_hi:[1,1,0]
v_cvt_pk_f16_f32 v122, v122, v123
v_fma_mix_f32 v227, v98, v98, v227 op_sel_hi:[1,1,0]
v_cvt_pk_f16_f32 v124, v124, v125
v_fma_mix_f32 v227, v99, v99, v227 op_sel_hi:[1,1,0]
v_cvt_pk_f16_f32 v126, v126, v127
v_pk_fma_f16 v123, v122, v122, s48
v_mfma_f32_32x32x16_bf16 v[144:159], v[36:39], v[188:191], v[144:159]
ds_read_u16 v112, v112
ds_read_u16 v113, v113
v_fma_mix_f32 v227, v100, v100, v227 op_sel_hi:[1,1,0]
v_pk_fma_f16 v125, v124, v124, s48
v_fma_mix_f32 v227, v101, v101, v227 op_sel_hi:[1,1,0]
v_cvt_pkrtz_f16_f32 v115, v114, v115
v_and_b32_e64 v115, s49, v115
v_bfe_u32 v114, v115, 2, 14
v_lshrrev_b32_e64 v115, 18, v115
v_pk_fma_f16 v127, v126, v126, s48
v_pk_mul_f16 v123, v122, v123
ds_read_b128 v[184:187], v250 offset:30720
ds_read_u16 v114, v114
ds_read_u16 v115, v115
v_pk_mul_f16 v125, v124, v125
s_waitcnt lgkmcnt(8)
v_fma_mix_f32 v227, v102, v102, v227 op_sel_hi:[1,1,0]
v_pk_mul_f16 v127, v126, v127
v_fma_mix_f32 v227, v103, v103, v227 op_sel_hi:[1,1,0]
v_exp_f16_sdwa v123, v123 dst_sel:WORD_0 dst_unused:UNUSED_PRESERVE src0_sel:WORD_0
v_cvt_pkrtz_f16_f32 v117, v116, v117
v_and_b32 v117, s49, v117
v_bfe_u32 v116, v117, 2, 14
v_lshrrev_b32_e64 v117, 18, v117
v_mfma_f32_32x32x16_bf16 v[128:143], v[16:19], v[176:179], v[128:143]
ds_read_u16 v116, v116
ds_read_u16 v117, v117
v_exp_f16_sdwa v125, v125 dst_sel:WORD_0 dst_unused:UNUSED_PRESERVE src0_sel:WORD_0
v_fma_mix_f32 v227, v104, v104, v227 op_sel_hi:[1,1,0]
v_exp_f16_sdwa v127, v127 dst_sel:WORD_0 dst_unused:UNUSED_PRESERVE src0_sel:WORD_0
v_fma_mix_f32 v227, v105, v105, v227 op_sel_hi:[1,1,0]
v_cvt_pkrtz_f16_f32 v119, v118, v119
v_and_b32_e64 v119, s49, v119
v_bfe_u32 v118, v119, 2, 14
v_lshrrev_b32 v119, 18, v119
v_exp_f16_sdwa v123, v123 dst_sel:WORD_1 dst_unused:UNUSED_PRESERVE src0_sel:WORD_1
s_waitcnt lgkmcnt(6)
v_fma_mix_f32 v227, v106, v106, v227 op_sel_hi:[1,1,0]
v_exp_f16_sdwa v125, v125 dst_sel:WORD_1 dst_unused:UNUSED_PRESERVE src0_sel:WORD_1
v_fma_mix_f32 v227, v107, v107, v227 op_sel_hi:[1,1,0]
v_mfma_f32_32x32x16_bf16 v[144:159], v[40:43], v[176:179], v[144:159]
ds_read_u16 v118, v118
ds_read_u16 v119, v119
v_exp_f16_sdwa v127, v127 dst_sel:WORD_1 dst_unused:UNUSED_PRESERVE src0_sel:WORD_1
v_cvt_pkrtz_f16_f32 v121, v120, v121
v_and_b32_e64 v121, s49, v121
v_bfe_u32 v120, v121, 2, 14
v_lshrrev_b32_e64 v121, 18, v121
v_pk_add_f16 v123, v123, 1.0 op_sel_hi:[1,0]
v_pk_add_f16 v125, v125, 1.0 op_sel_hi:[1,0]
ds_read_b128 v[188:191], v250 offset:31744
ds_read_u16 v120, v120
ds_read_u16 v121, v121
v_pk_add_f16 v127, v127, 1.0 op_sel_hi:[1,0]
v_rcp_f16_sdwa v123, v123 dst_sel:WORD_0 dst_unused:UNUSED_PRESERVE src0_sel:WORD_0
v_mfma_f32_32x32x16_bf16 v[128:143], v[20:23], v[180:183], v[128:143]
v_rcp_f16_sdwa v125, v125 dst_sel:WORD_0 dst_unused:UNUSED_PRESERVE src0_sel:WORD_0
v_rcp_f16_sdwa v127, v127 dst_sel:WORD_0 dst_unused:UNUSED_PRESERVE src0_sel:WORD_0
v_rcp_f16_sdwa v123, v123 dst_sel:WORD_1 dst_unused:UNUSED_PRESERVE src0_sel:WORD_1
v_rcp_f16_sdwa v125, v125 dst_sel:WORD_1 dst_unused:UNUSED_PRESERVE src0_sel:WORD_1
v_mfma_f32_32x32x16_bf16 v[144:159], v[44:47], v[180:183], v[144:159]
v_rcp_f16_sdwa v127, v127 dst_sel:WORD_1 dst_unused:UNUSED_PRESERVE src0_sel:WORD_1
v_pk_mul_f16 v122, v122, v123
v_pk_mul_f16 v124, v124, v125
v_pk_mul_f16 v126, v126, v127
v_fma_mix_f32 v227, v122, v122, v227 op_sel_hi:[1,1,0]
s_waitcnt lgkmcnt(5)
v_mfma_f32_32x32x16_bf16 v[160:175], v[0:3], v[184:187], 0
ds_read_b128 v[176:179], v250 offset:32768
v_fma_mix_f32 v227, v124, v124, v227 op_sel_hi:[1,1,0]
s_cmp_lg_u32 s40, 7
s_cbranch_scc1 Lnoinit
s_waitcnt vmcnt(0)
v_mov_b32 v222, 1
v_mov_b32 v223, 0
s_nop 6
s_mov_b64 exec, 1
buffer_atomic_add v222, v223, s[36:39], 0 offen
s_mov_b64 exec, -1
s_nop 1
Lnoinit:
v_cvt_pkrtz_f16_f32 v129, v128, v129
v_fma_mix_f32 v227, v126, v126, v227 op_sel_hi:[1,1,0]
v_and_b32_e64 v129, s49, v129
v_fma_mix_f32 v227, v122, v122, v227 op_sel:[1,1,0] op_sel_hi:[1,1,0]
v_bfe_u32 v128, v129, 2, 14
v_fma_mix_f32 v227, v124, v124, v227 op_sel:[1,1,0] op_sel_hi:[1,1,0]
v_lshrrev_b32_e64 v129, 18, v129
v_fma_mix_f32 v227, v126, v126, v227 op_sel:[1,1,0] op_sel_hi:[1,1,0]
v_cvt_pk_f16_f32 v140, v140, v141
v_fma_mix_f32 v227, v112, v112, v227 op_sel_hi:[1,1,0]
v_cvt_pk_f16_f32 v142, v142, v143
v_fma_mix_f32 v227, v113, v113, v227 op_sel_hi:[1,1,0]
v_pk_fma_f16 v141, v140, v140, s48
v_fma_mix_f32 v227, v114, v114, v227 op_sel_hi:[1,1,0]
v_mfma_f32_32x32x16_bf16 v[96:111], v[24:27], v[184:187], 0
ds_read_u16 v128, v128
ds_read_u16 v129, v129
v_fma_mix_f32 v227, v115, v115, v227 op_sel_hi:[1,1,0]
v_cvt_pkrtz_f16_f32 v131, v130, v131
v_and_b32_e64 v131, s49, v131
v_bfe_u32 v130, v131, 2, 14
v_lshrrev_b32_e64 v131, 18, v131
v_pk_fma_f16 v143, v142, v142, s48
v_fma_mix_f32 v227, v116, v116, v227 op_sel_hi:[1,1,0]
v_pk_mul_f16 v141, v140, v141
v_fma_mix_f32 v227, v117, v117, v227 op_sel_hi:[1,1,0]
v_pk_mul_f16 v143, v142, v143
v_cvt_pkrtz_f16_f32 v133, v132, v133
ds_read_u16 v130, v130
ds_read_u16 v131, v131
ds_read_b128 v[180:183], v250 offset:33792
v_and_b32_e64 v133, s49, v133
v_bfe_u32 v132, v133, 2, 14
v_lshrrev_b32 v133, 18, v133
v_exp_f16_sdwa v141, v141 dst_sel:WORD_0 dst_unused:UNUSED_PRESERVE src0_sel:WORD_0
s_waitcnt lgkmcnt(5)
v_fma_mix_f32 v227, v118, v118, v227 op_sel_hi:[1,1,0]
v_mfma_f32_32x32x16_bf16 v[160:175], v[4:7], v[188:191], v[160:175]
ds_read_u16 v132, v132
ds_read_u16 v133, v133
v_fma_mix_f32 v227, v119, v119, v227 op_sel_hi:[1,1,0]
v_exp_f16_sdwa v143, v143 dst_sel:WORD_0 dst_unused:UNUSED_PRESERVE src0_sel:WORD_0
v_cvt_pkrtz_f16_f32 v135, v134, v135
v_and_b32_e64 v135, s49, v135
v_bfe_u32 v134, v135, 2, 14
v_lshrrev_b32_e64 v135, 18, v135
v_exp_f16_sdwa v141, v141 dst_sel:WORD_1 dst_unused:UNUSED_PRESERVE src0_sel:WORD_1
v_fma_mix_f32 v227, v120, v120, v227 op_sel_hi:[1,1,0]
v_cvt_pkrtz_f16_f32 v137, v136, v137
v_fma_mix_f32 v227, v121, v121, v227 op_sel_hi:[1,1,0]
v_and_b32_e64 v137, s49, v137
v_bfe_u32 v136, v137, 2, 14
ds_read_u16 v134, v134
ds_read_u16 v135, v135
v_lshrrev_b32_e64 v137, 18, v137
v_exp_f16_sdwa v143, v143 dst_sel:WORD_1 dst_unused:UNUSED_PRESERVE src0_sel:WORD_1
v_mfma_f32_32x32x16_bf16 v[96:111], v[28:31], v[188:191], v[96:111]
ds_read_u16 v136, v136
ds_read_u16 v137, v137
ds_read_b128 v[184:187], v250 offset:34816
v_cvt_pkrtz_f16_f32 v139, v138, v139
v_and_b32_e64 v139, s49, v139
v_bfe_u32 v138, v139, 2, 14
v_lshrrev_b32_e64 v139, 18, v139
v_pk_add_f16 v141, v141, 1.0 op_sel_hi:[1,0]
v_pk_add_f16 v143, v143, 1.0 op_sel_hi:[1,0]
v_rcp_f16_sdwa v141, v141 dst_sel:WORD_0 dst_unused:UNUSED_PRESERVE src0_sel:WORD_0
v_mfma_f32_32x32x16_bf16 v[160:175], v[8:11], v[176:179], v[160:175]
ds_read_u16 v138, v138
ds_read_u16 v139, v139
v_rcp_f16_sdwa v143, v143 dst_sel:WORD_0 dst_unused:UNUSED_PRESERVE src0_sel:WORD_0
v_rcp_f16_sdwa v141, v141 dst_sel:WORD_1 dst_unused:UNUSED_PRESERVE src0_sel:WORD_1
v_rcp_f16_sdwa v143, v143 dst_sel:WORD_1 dst_unused:UNUSED_PRESERVE src0_sel:WORD_1
v_mfma_f32_32x32x16_bf16 v[96:111], v[32:35], v[176:179], v[96:111]
ds_read_b128 v[188:191], v250 offset:35840
v_pk_mul_f16 v140, v140, v141
v_pk_mul_f16 v142, v142, v143
v_fma_mix_f32 v228, v140, v140, v228 op_sel_hi:[1,1,0]
s_add_u32 s66, s66, 786432
s_sub_u32 s81, s81, 13184
v_bfe_u32 v223, v250, 4, 6
v_and_b32 v222, 15, v223
v_lshlrev_b32 v222, 7, v222
v_lshrrev_b32_e64 v223, 4, v223
v_mul_u32_u24 v223, 98304, v223
s_sub_u32 s43, s67, -8000
s_mul_i32 s44, s41, 192
s_add_u32 s43, s43, s44
v_add3_u32 v222, v222, v223, s43
s_mov_b32 m0, 163840
s_add_u32 s44, s66, 393216
buffer_load_dword v222, s[4:7], s66 offen lds
buffer_load_dword v222, s[4:7], s44 offen lds
v_fma_mix_f32 v228, v142, v142, v228 op_sel_hi:[1,1,0]
s_waitcnt lgkmcnt(7)
v_mfma_f32_32x32x16_bf16 v[160:175], v[12:15], v[180:183], v[160:175]
v_fma_mix_f32 v228, v140, v140, v228 op_sel:[1,1,0] op_sel_hi:[1,1,0]
v_cvt_pkrtz_f16_f32 v145, v144, v145
v_fma_mix_f32 v228, v142, v142, v228 op_sel:[1,1,0] op_sel_hi:[1,1,0]
v_and_b32_e64 v145, s49, v145
v_fma_mix_f32 v228, v128, v128, v228 op_sel_hi:[1,1,0]
v_bfe_u32 v144, v145, 2, 14
v_fma_mix_f32 v228, v129, v129, v228 op_sel_hi:[1,1,0]
v_lshrrev_b32_e64 v145, 18, v145
v_fma_mix_f32 v228, v130, v130, v228 op_sel_hi:[1,1,0]
v_cvt_pk_f16_f32 v154, v154, v155
v_fma_mix_f32 v228, v131, v131, v228 op_sel_hi:[1,1,0]
v_cvt_pk_f16_f32 v156, v156, v157
v_cvt_pk_f16_f32 v158, v158, v159
v_pk_fma_f16 v155, v154, v154, s48
v_mfma_f32_32x32x16_bf16 v[96:111], v[36:39], v[180:183], v[96:111]
ds_read_u16 v144, v144
ds_read_u16 v145, v145
v_fma_mix_f32 v228, v132, v132, v228 op_sel_hi:[1,1,0]
v_pk_fma_f16 v157, v156, v156, s48
v_fma_mix_f32 v228, v133, v133, v228 op_sel_hi:[1,1,0]
v_cvt_pkrtz_f16_f32 v147, v146, v147
v_and_b32_e64 v147, s49, v147
v_bfe_u32 v146, v147, 2, 14
v_lshrrev_b32_e64 v147, 18, v147
v_pk_fma_f16 v159, v158, v158, s48
v_pk_mul_f16 v155, v154, v155
ds_read_b128 v[176:179], v250 offset:36864
ds_read_u16 v146, v146
ds_read_u16 v147, v147
v_pk_mul_f16 v157, v156, v157
v_fma_mix_f32 v228, v134, v134, v228 op_sel_hi:[1,1,0]
v_pk_mul_f16 v159, v158, v159
s_waitcnt lgkmcnt(7)
v_fma_mix_f32 v228, v135, v135, v228 op_sel_hi:[1,1,0]
v_exp_f16_sdwa v155, v155 dst_sel:WORD_0 dst_unused:UNUSED_PRESERVE src0_sel:WORD_0
v_cvt_pkrtz_f16_f32 v149, v148, v149
v_and_b32 v149, s49, v149
v_bfe_u32 v148, v149, 2, 14
v_lshrrev_b32_e64 v149, 18, v149
v_mfma_f32_32x32x16_bf16 v[160:175], v[16:19], v[184:187], v[160:175]
ds_read_u16 v148, v148
ds_read_u16 v149, v149
v_exp_f16_sdwa v157, v157 dst_sel:WORD_0 dst_unused:UNUSED_PRESERVE src0_sel:WORD_0
v_fma_mix_f32 v228, v136, v136, v228 op_sel_hi:[1,1,0]
v_exp_f16_sdwa v159, v159 dst_sel:WORD_0 dst_unused:UNUSED_PRESERVE src0_sel:WORD_0
v_fma_mix_f32 v228, v137, v137, v228 op_sel_hi:[1,1,0]
v_cvt_pkrtz_f16_f32 v151, v150, v151
v_and_b32_e64 v151, s49, v151
v_bfe_u32 v150, v151, 2, 14
v_lshrrev_b32 v151, 18, v151
v_exp_f16_sdwa v155, v155 dst_sel:WORD_1 dst_unused:UNUSED_PRESERVE src0_sel:WORD_1
v_fma_mix_f32 v228, v138, v138, v228 op_sel_hi:[1,1,0]
v_exp_f16_sdwa v157, v157 dst_sel:WORD_1 dst_unused:UNUSED_PRESERVE src0_sel:WORD_1
s_waitcnt lgkmcnt(4)
v_fma_mix_f32 v228, v139, v139, v228 op_sel_hi:[1,1,0]
v_mfma_f32_32x32x16_bf16 v[96:111], v[40:43], v[184:187], v[96:111]
ds_read_u16 v150, v150
ds_read_u16 v151, v151
v_exp_f16_sdwa v159, v159 dst_sel:WORD_1 dst_unused:UNUSED_PRESERVE src0_sel:WORD_1
v_cvt_pkrtz_f16_f32 v153, v152, v153
v_and_b32_e64 v153, s49, v153
v_bfe_u32 v152, v153, 2, 14
v_lshrrev_b32_e64 v153, 18, v153
v_pk_add_f16 v155, v155, 1.0 op_sel_hi:[1,0]
v_pk_add_f16 v157, v157, 1.0 op_sel_hi:[1,0]
ds_read_b128 v[180:183], v250 offset:37888
ds_read_u16 v152, v152
ds_read_u16 v153, v153
v_pk_add_f16 v159, v159, 1.0 op_sel_hi:[1,0]
v_rcp_f16_sdwa v155, v155 dst_sel:WORD_0 dst_unused:UNUSED_PRESERVE src0_sel:WORD_0
v_mfma_f32_32x32x16_bf16 v[160:175], v[20:23], v[188:191], v[160:175]
v_rcp_f16_sdwa v157, v157 dst_sel:WORD_0 dst_unused:UNUSED_PRESERVE src0_sel:WORD_0
v_rcp_f16_sdwa v159, v159 dst_sel:WORD_0 dst_unused:UNUSED_PRESERVE src0_sel:WORD_0
v_rcp_f16_sdwa v155, v155 dst_sel:WORD_1 dst_unused:UNUSED_PRESERVE src0_sel:WORD_1
v_rcp_f16_sdwa v157, v157 dst_sel:WORD_1 dst_unused:UNUSED_PRESERVE src0_sel:WORD_1
v_mfma_f32_32x32x16_bf16 v[96:111], v[44:47], v[188:191], v[96:111]
v_rcp_f16_sdwa v159, v159 dst_sel:WORD_1 dst_unused:UNUSED_PRESERVE src0_sel:WORD_1
v_pk_mul_f16 v154, v154, v155
v_pk_mul_f16 v156, v156, v157
v_pk_mul_f16 v158, v158, v159
v_fma_mix_f32 v228, v154, v154, v228 op_sel_hi:[1,1,0]
v_mfma_f32_32x32x16_bf16 v[112:127], v[0:3], v[176:179], 0
ds_read_b128 v[184:187], v250 offset:38912
v_fma_mix_f32 v228, v156, v156, v228 op_sel_hi:[1,1,0]
v_cvt_pkrtz_f16_f32 v161, v160, v161
v_fma_mix_f32 v228, v158, v158, v228 op_sel_hi:[1,1,0]
v_and_b32_e64 v161, s49, v161
v_fma_mix_f32 v228, v154, v154, v228 op_sel:[1,1,0] op_sel_hi:[1,1,0]
v_bfe_u32 v160, v161, 2, 14
v_fma_mix_f32 v228, v156, v156, v228 op_sel:[1,1,0] op_sel_hi:[1,1,0]
v_lshrrev_b32 v161, 18, v161
v_fma_mix_f32 v228, v158, v158, v228 op_sel:[1,1,0] op_sel_hi:[1,1,0]
v_cvt_pk_f16_f32 v172, v172, v173
v_fma_mix_f32 v228, v144, v144, v228 op_sel_hi:[1,1,0]
v_cvt_pk_f16_f32 v174, v174, v175
v_fma_mix_f32 v228, v145, v145, v228 op_sel_hi:[1,1,0]
v_pk_fma_f16 v173, v172, v172, s48
s_waitcnt lgkmcnt(2)
v_fma_mix_f32 v228, v146, v146, v228 op_sel_hi:[1,1,0]
v_mfma_f32_32x32x16_bf16 v[128:143], v[24:27], v[176:179], 0
ds_read_u16 v160, v160
ds_read_u16 v161, v161
v_fma_mix_f32 v228, v147, v147, v228 op_sel_hi:[1,1,0]
v_cvt_pkrtz_f16_f32 v163, v162, v163
v_and_b32_e64 v163, s49, v163
v_bfe_u32 v162, v163, 2, 14
v_lshrrev_b32_e64 v163, 18, v163
v_pk_fma_f16 v175, v174, v174, s48
v_fma_mix_f32 v228, v148, v148, v228 op_sel_hi:[1,1,0]
v_pk_mul_f16 v173, v172, v173
v_fma_mix_f32 v228, v149, v149, v228 op_sel_hi:[1,1,0]
v_pk_mul_f16 v175, v174, v175
v_cvt_pkrtz_f16_f32 v165, v164, v165
ds_read_u16 v162, v162
ds_read_u16 v163, v163
ds_read_b128 v[188:191], v250 offset:39936
v_and_b32_e64 v165, s49, v165
v_bfe_u32 v164, v165, 2, 14
v_lshrrev_b32_e64 v165, 18, v165
v_exp_f16_sdwa v173, v173 dst_sel:WORD_0 dst_unused:UNUSED_PRESERVE src0_sel:WORD_0
v_fma_mix_f32 v228, v150, v150, v228 op_sel_hi:[1,1,0]
v_mfma_f32_32x32x16_bf16 v[112:127], v[4:7], v[180:183], v[112:127]
ds_read_u16 v164, v164
ds_read_u16 v165, v165
v_fma_mix_f32 v228, v151, v151, v228 op_sel_hi:[1,1,0]
v_exp_f16_sdwa v175, v175 dst_sel:WORD_0 dst_unused:UNUSED_PRESERVE src0_sel:WORD_0
v_cvt_pkrtz_f16_f32 v167, v166, v167
v_and_b32_e64 v167, s49, v167
v_bfe_u32 v166, v167, 2, 14
v_lshrrev_b32_e64 v167, 18, v167
v_exp_f16_sdwa v173, v173 dst_sel:WORD_1 dst_unused:UNUSED_PRESERVE src0_sel:WORD_1
v_fma_mix_f32 v228, v152, v152, v228 op_sel_hi:[1,1,0]
v_cvt_pkrtz_f16_f32 v169, v168, v169
s_waitcnt lgkmcnt(6)
v_fma_mix_f32 v228, v153, v153, v228 op_sel_hi:[1,1,0]
v_and_b32 v169, s49, v169
v_bfe_u32 v168, v169, 2, 14
ds_read_u16 v166, v166
ds_read_u16 v167, v167
v_lshrrev_b32_e64 v169, 18, v169
v_exp_f16_sdwa v175, v175 dst_sel:WORD_1 dst_unused:UNUSED_PRESERVE src0_sel:WORD_1
v_mfma_f32_32x32x16_bf16 v[128:143], v[28:31], v[180:183], v[128:143]
ds_read_u16 v168, v168
ds_read_u16 v169, v169
ds_read_b128 v[176:179], v250 offset:40960
v_cvt_pkrtz_f16_f32 v171, v170, v171
v_and_b32_e64 v171, s49, v171
v_bfe_u32 v170, v171, 2, 14
v_lshrrev_b32_e64 v171, 18, v171
v_pk_add_f16 v173, v173, 1.0 op_sel_hi:[1,0]
v_pk_add_f16 v175, v175, 1.0 op_sel_hi:[1,0]
v_rcp_f16_sdwa v173, v173 dst_sel:WORD_0 dst_unused:UNUSED_PRESERVE src0_sel:WORD_0
v_mfma_f32_32x32x16_bf16 v[112:127], v[8:11], v[184:187], v[112:127]
ds_read_u16 v170, v170
ds_read_u16 v171, v171
v_rcp_f16_sdwa v175, v175 dst_sel:WORD_0 dst_unused:UNUSED_PRESERVE src0_sel:WORD_0
v_rcp_f16_sdwa v173, v173 dst_sel:WORD_1 dst_unused:UNUSED_PRESERVE src0_sel:WORD_1
v_rcp_f16_sdwa v175, v175 dst_sel:WORD_1 dst_unused:UNUSED_PRESERVE src0_sel:WORD_1
v_mfma_f32_32x32x16_bf16 v[128:143], v[32:35], v[184:187], v[128:143]
ds_read_b128 v[180:183], v250 offset:41984
v_pk_mul_f16 v172, v172, v173
v_pk_mul_f16 v174, v174, v175
v_fma_mix_f32 v229, v172, v172, v229 op_sel_hi:[1,1,0]
v_cvt_pkrtz_f16_f32 v97, v96, v97
v_fma_mix_f32 v229, v174, v174, v229 op_sel_hi:[1,1,0]
s_waitcnt lgkmcnt(8)
v_mfma_f32_32x32x16_bf16 v[112:127], v[12:15], v[188:191], v[112:127]
v_fma_mix_f32 v229, v172, v172, v229 op_sel:[1,1,0] op_sel_hi:[1,1,0]
v_and_b32 v97, s49, v97
v_fma_mix_f32 v229, v174, v174, v229 op_sel:[1,1,0] op_sel_hi:[1,1,0]
v_bfe_u32 v96, v97, 2, 14
v_fma_mix_f32 v229, v160, v160, v229 op_sel_hi:[1,1,0]
v_lshrrev_b32_e64 v97, 18, v97
v_fma_mix_f32 v229, v161, v161, v229 op_sel_hi:[1,1,0]
v_cvt_pk_f16_f32 v106, v106, v107
v_fma_mix_f32 v229, v162, v162, v229 op_sel_hi:[1,1,0]
v_cvt_pk_f16_f32 v108, v108, v109
v_fma_mix_f32 v229, v163, v163, v229 op_sel_hi:[1,1,0]
v_cvt_pk_f16_f32 v110, v110, v111
v_pk_fma_f16 v107, v106, v106, s48
v_mfma_f32_32x32x16_bf16 v[128:143], v[36:39], v[188:191], v[128:143]
ds_read_u16 v96, v96
ds_read_u16 v97, v97
v_fma_mix_f32 v229, v164, v164, v229 op_sel_hi:[1,1,0]
v_pk_fma_f16 v109, v108, v108, s48
v_fma_mix_f32 v229, v165, v165, v229 op_sel_hi:[1,1,0]
v_cvt_pkrtz_f16_f32 v99, v98, v99
v_and_b32_e64 v99, s49, v99
v_bfe_u32 v98, v99, 2, 14
v_lshrrev_b32_e64 v99, 18, v99
v_pk_fma_f16 v111, v110, v110, s48
v_pk_mul_f16 v107, v106, v107
ds_read_b128 v[184:187], v250 offset:43008
ds_read_u16 v98, v98
ds_read_u16 v99, v99
v_pk_mul_f16 v109, v108, v109
s_waitcnt lgkmcnt(8)
v_fma_mix_f32 v229, v166, v166, v229 op_sel_hi:[1,1,0]
v_pk_mul_f16 v111, v110, v111
v_fma_mix_f32 v229, v167, v167, v229 op_sel_hi:[1,1,0]
v_exp_f16_sdwa v107, v107 dst_sel:WORD_0 dst_unused:UNUSED_PRESERVE src0_sel:WORD_0
v_cvt_pkrtz_f16_f32 v101, v100, v101
v_and_b32 v101, s49, v101
v_bfe_u32 v100, v101, 2, 14
v_lshrrev_b32_e64 v101, 18, v101
v_mfma_f32_32x32x16_bf16 v[112:127], v[16:19], v[176:179], v[112:127]
ds_read_u16 v100, v100
ds_read_u16 v101, v101
v_exp_f16_sdwa v109, v109 dst_sel:WORD_0 dst_unused:UNUSED_PRESERVE src0_sel:WORD_0
v_fma_mix_f32 v229, v168, v168, v229 op_sel_hi:[1,1,0]
v_exp_f16_sdwa v111, v111 dst_sel:WORD_0 dst_unused:UNUSED_PRESERVE src0_sel:WORD_0
v_fma_mix_f32 v229, v169, v169, v229 op_sel_hi:[1,1,0]
v_cvt_pkrtz_f16_f32 v103, v102, v103
v_and_b32_e64 v103, s49, v103
v_bfe_u32 v102, v103, 2, 14
v_lshrrev_b32 v103, 18, v103
v_exp_f16_sdwa v107, v107 dst_sel:WORD_1 dst_unused:UNUSED_PRESERVE src0_sel:WORD_1
s_waitcnt lgkmcnt(6)
v_fma_mix_f32 v229, v170, v170, v229 op_sel_hi:[1,1,0]
v_exp_f16_sdwa v109, v109 dst_sel:WORD_1 dst_unused:UNUSED_PRESERVE src0_sel:WORD_1
v_fma_mix_f32 v229, v171, v171, v229 op_sel_hi:[1,1,0]
v_mfma_f32_32x32x16_bf16 v[128:143], v[40:43], v[176:179], v[128:143]
ds_read_u16 v102, v102
ds_read_u16 v103, v103
v_exp_f16_sdwa v111, v111 dst_sel:WORD_1 dst_unused:UNUSED_PRESERVE src0_sel:WORD_1
v_cvt_pkrtz_f16_f32 v105, v104, v105
v_and_b32_e64 v105, s49, v105
v_bfe_u32 v104, v105, 2, 14
v_lshrrev_b32_e64 v105, 18, v105
v_pk_add_f16 v107, v107, 1.0 op_sel_hi:[1,0]
v_pk_add_f16 v109, v109, 1.0 op_sel_hi:[1,0]
ds_read_b128 v[188:191], v250 offset:44032
ds_read_u16 v104, v104
ds_read_u16 v105, v105
v_pk_add_f16 v111, v111, 1.0 op_sel_hi:[1,0]
v_rcp_f16_sdwa v107, v107 dst_sel:WORD_0 dst_unused:UNUSED_PRESERVE src0_sel:WORD_0
v_mfma_f32_32x32x16_bf16 v[112:127], v[20:23], v[180:183], v[112:127]
v_rcp_f16_sdwa v109, v109 dst_sel:WORD_0 dst_unused:UNUSED_PRESERVE src0_sel:WORD_0
v_rcp_f16_sdwa v111, v111 dst_sel:WORD_0 dst_unused:UNUSED_PRESERVE src0_sel:WORD_0
v_rcp_f16_sdwa v107, v107 dst_sel:WORD_1 dst_unused:UNUSED_PRESERVE src0_sel:WORD_1
v_rcp_f16_sdwa v109, v109 dst_sel:WORD_1 dst_unused:UNUSED_PRESERVE src0_sel:WORD_1
v_mfma_f32_32x32x16_bf16 v[128:143], v[44:47], v[180:183], v[128:143]
v_rcp_f16_sdwa v111, v111 dst_sel:WORD_1 dst_unused:UNUSED_PRESERVE src0_sel:WORD_1
v_pk_mul_f16 v106, v106, v107
v_pk_mul_f16 v108, v108, v109
v_pk_mul_f16 v110, v110, v111
v_fma_mix_f32 v229, v106, v106, v229 op_sel_hi:[1,1,0]
s_waitcnt lgkmcnt(5)
v_mfma_f32_32x32x16_bf16 v[144:159], v[0:3], v[184:187], 0
ds_read_b128 v[176:179], v250 offset:45056
v_fma_mix_f32 v229, v108, v108, v229 op_sel_hi:[1,1,0]
v_cvt_pkrtz_f16_f32 v113, v112, v113
v_fma_mix_f32 v229, v110, v110, v229 op_sel_hi:[1,1,0]
v_and_b32 v113, s49, v113
v_fma_mix_f32 v229, v106, v106, v229 op_sel:[1,1,0] op_sel_hi:[1,1,0]
v_bfe_u32 v112, v113, 2, 14
v_fma_mix_f32 v229, v108, v108, v229 op_sel:[1,1,0] op_sel_hi:[1,1,0]
v_lshrrev_b32_e64 v113, 18, v113
v_fma_mix_f32 v229, v110, v110, v229 op_sel:[1,1,0] op_sel_hi:[1,1,0]
v_cvt_pk_f16_f32 v124, v124, v125
v_fma_mix_f32 v229, v96, v96, v229 op_sel_hi:[1,1,0]
v_cvt_pk_f16_f32 v126, v126, v127
v_fma_mix_f32 v229, v97, v97, v229 op_sel_hi:[1,1,0]
v_pk_fma_f16 v125, v124, v124, s48
v_fma_mix_f32 v229, v98, v98, v229 op_sel_hi:[1,1,0]
v_mfma_f32_32x32x16_bf16 v[160:175], v[24:27], v[184:187], 0
ds_read_u16 v112, v112
ds_read_u16 v113, v113
v_fma_mix_f32 v229, v99, v99, v229 op_sel_hi:[1,1,0]
v_cvt_pkrtz_f16_f32 v115, v114, v115
v_and_b32_e64 v115, s49, v115
v_bfe_u32 v114, v115, 2, 14
v_lshrrev_b32_e64 v115, 18, v115
v_pk_fma_f16 v127, v126, v126, s48
v_fma_mix_f32 v229, v100, v100, v229 op_sel_hi:[1,1,0]
v_pk_mul_f16 v125, v124, v125
v_fma_mix_f32 v229, v101, v101, v229 op_sel_hi:[1,1,0]
v_pk_mul_f16 v127, v126, v127
v_cvt_pkrtz_f16_f32 v117, v116, v117
ds_read_u16 v114, v114
ds_read_u16 v115, v115
ds_read_b128 v[180:183], v250 offset:46080
v_and_b32_e64 v117, s49, v117
v_bfe_u32 v116, v117, 2, 14
v_lshrrev_b32 v117, 18, v117
v_exp_f16_sdwa v125, v125 dst_sel:WORD_0 dst_unused:UNUSED_PRESERVE src0_sel:WORD_0
s_waitcnt lgkmcnt(5)
v_fma_mix_f32 v229, v102, v102, v229 op_sel_hi:[1,1,0]
v_mfma_f32_32x32x16_bf16 v[144:159], v[4:7], v[188:191], v[144:159]
ds_read_u16 v116, v116
ds_read_u16 v117, v117
v_fma_mix_f32 v229, v103, v103, v229 op_sel_hi:[1,1,0]
v_exp_f16_sdwa v127, v127 dst_sel:WORD_0 dst_unused:UNUSED_PRESERVE src0_sel:WORD_0
v_cvt_pkrtz_f16_f32 v119, v118, v119
v_and_b32_e64 v119, s49, v119
v_bfe_u32 v118, v119, 2, 14
v_lshrrev_b32_e64 v119, 18, v119
v_exp_f16_sdwa v125, v125 dst_sel:WORD_1 dst_unused:UNUSED_PRESERVE src0_sel:WORD_1
v_fma_mix_f32 v229, v104, v104, v229 op_sel_hi:[1,1,0]
v_cvt_pkrtz_f16_f32 v121, v120, v121
v_fma_mix_f32 v229, v105, v105, v229 op_sel_hi:[1,1,0]
v_and_b32_e64 v121, s49, v121
v_bfe_u32 v120, v121, 2, 14
ds_read_u16 v118, v118
ds_read_u16 v119, v119
v_lshrrev_b32_e64 v121, 18, v121
v_exp_f16_sdwa v127, v127 dst_sel:WORD_1 dst_unused:UNUSED_PRESERVE src0_sel:WORD_1
v_mfma_f32_32x32x16_bf16 v[160:175], v[28:31], v[188:191], v[160:175]
ds_read_u16 v120, v120
ds_read_u16 v121, v121
ds_read_b128 v[184:187], v250 offset:47104
v_cvt_pkrtz_f16_f32 v123, v122, v123
v_and_b32_e64 v123, s49, v123
v_bfe_u32 v122, v123, 2, 14
v_lshrrev_b32_e64 v123, 18, v123
v_pk_add_f16 v125, v125, 1.0 op_sel_hi:[1,0]
v_pk_add_f16 v127, v127, 1.0 op_sel_hi:[1,0]
v_rcp_f16_sdwa v125, v125 dst_sel:WORD_0 dst_unused:UNUSED_PRESERVE src0_sel:WORD_0
v_mfma_f32_32x32x16_bf16 v[144:159], v[8:11], v[176:179], v[144:159]
ds_read_u16 v122, v122
ds_read_u16 v123, v123
v_rcp_f16_sdwa v127, v127 dst_sel:WORD_0 dst_unused:UNUSED_PRESERVE src0_sel:WORD_0
v_rcp_f16_sdwa v125, v125 dst_sel:WORD_1 dst_unused:UNUSED_PRESERVE src0_sel:WORD_1
v_rcp_f16_sdwa v127, v127 dst_sel:WORD_1 dst_unused:UNUSED_PRESERVE src0_sel:WORD_1
v_mfma_f32_32x32x16_bf16 v[160:175], v[32:35], v[176:179], v[160:175]
ds_read_b128 v[188:191], v250 offset:48128
v_pk_mul_f16 v124, v124, v125
v_pk_mul_f16 v126, v126, v127
v_fma_mix_f32 v230, v124, v124, v230 op_sel_hi:[1,1,0]
v_cvt_pkrtz_f16_f32 v129, v128, v129
v_fma_mix_f32 v230, v126, v126, v230 op_sel_hi:[1,1,0]
s_waitcnt lgkmcnt(8)
v_mfma_f32_32x32x16_bf16 v[144:159], v[12:15], v[180:183], v[144:159]
v_fma_mix_f32 v230, v124, v124, v230 op_sel:[1,1,0] op_sel_hi:[1,1,0]
v_and_b32 v129, s49, v129
v_fma_mix_f32 v230, v126, v126, v230 op_sel:[1,1,0] op_sel_hi:[1,1,0]
v_bfe_u32 v128, v129, 2, 14
v_fma_mix_f32 v230, v112, v112, v230 op_sel_hi:[1,1,0]
v_lshrrev_b32_e64 v129, 18, v129
v_fma_mix_f32 v230, v113, v113, v230 op_sel_hi:[1,1,0]
v_cvt_pk_f16_f32 v138, v138, v139
v_fma_mix_f32 v230, v114, v114, v230 op_sel_hi:[1,1,0]
v_cvt_pk_f16_f32 v140, v140, v141
v_fma_mix_f32 v230, v115, v115, v230 op_sel_hi:[1,1,0]
v_cvt_pk_f16_f32 v142, v142, v143
v_pk_fma_f16 v139, v138, v138, s48
v_mfma_f32_32x32x16_bf16 v[160:175], v[36:39], v[180:183], v[160:175]
ds_read_u16 v128, v128
ds_read_u16 v129, v129
v_fma_mix_f32 v230, v116, v116, v230 op_sel_hi:[1,1,0]
v_pk_fma_f16 v141, v140, v140, s48
v_fma_mix_f32 v230, v117, v117, v230 op_sel_hi:[1,1,0]
v_cvt_pkrtz_f16_f32 v131, v130, v131
v_and_b32_e64 v131, s49, v131
v_bfe_u32 v130, v131, 2, 14
v_lshrrev_b32_e64 v131, 18, v131
v_pk_fma_f16 v143, v142, v142, s48
v_pk_mul_f16 v139, v138, v139
ds_read_b128 v[176:179], v250 offset:49152
ds_read_u16 v130, v130
ds_read_u16 v131, v131
v_pk_mul_f16 v141, v140, v141
s_waitcnt lgkmcnt(8)
v_fma_mix_f32 v230, v118, v118, v230 op_sel_hi:[1,1,0]
v_pk_mul_f16 v143, v142, v143
v_fma_mix_f32 v230, v119, v119, v230 op_sel_hi:[1,1,0]
v_exp_f16_sdwa v139, v139 dst_sel:WORD_0 dst_unused:UNUSED_PRESERVE src0_sel:WORD_0
v_cvt_pkrtz_f16_f32 v133, v132, v133
v_and_b32 v133, s49, v133
v_bfe_u32 v132, v133, 2, 14
v_lshrrev_b32_e64 v133, 18, v133
v_mfma_f32_32x32x16_bf16 v[144:159], v[16:19], v[184:187], v[144:159]
ds_read_u16 v132, v132
ds_read_u16 v133, v133
v_exp_f16_sdwa v141, v141 dst_sel:WORD_0 dst_unused:UNUSED_PRESERVE src0_sel:WORD_0
v_fma_mix_f32 v230, v120, v120, v230 op_sel_hi:[1,1,0]
v_exp_f16_sdwa v143, v143 dst_sel:WORD_0 dst_unused:UNUSED_PRESERVE src0_sel:WORD_0
v_fma_mix_f32 v230, v121, v121, v230 op_sel_hi:[1,1,0]
v_cvt_pkrtz_f16_f32 v135, v134, v135
v_and_b32_e64 v135, s49, v135
v_bfe_u32 v134, v135, 2, 14
v_lshrrev_b32 v135, 18, v135
v_exp_f16_sdwa v139, v139 dst_sel:WORD_1 dst_unused:UNUSED_PRESERVE src0_sel:WORD_1
s_waitcnt lgkmcnt(6)
v_fma_mix_f32 v230, v122, v122, v230 op_sel_hi:[1,1,0]
v_exp_f16_sdwa v141, v141 dst_sel:WORD_1 dst_unused:UNUSED_PRESERVE src0_sel:WORD_1
v_fma_mix_f32 v230, v123, v123, v230 op_sel_hi:[1,1,0]
v_mfma_f32_32x32x16_bf16 v[160:175], v[40:43], v[184:187], v[160:175]
ds_read_u16 v134, v134
ds_read_u16 v135, v135
v_exp_f16_sdwa v143, v143 dst_sel:WORD_1 dst_unused:UNUSED_PRESERVE src0_sel:WORD_1
v_cvt_pkrtz_f16_f32 v137, v136, v137
v_and_b32_e64 v137, s49, v137
v_bfe_u32 v136, v137, 2, 14
v_lshrrev_b32_e64 v137, 18, v137
v_pk_add_f16 v139, v139, 1.0 op_sel_hi:[1,0]
v_pk_add_f16 v141, v141, 1.0 op_sel_hi:[1,0]
ds_read_b128 v[180:183], v250 offset:50176
ds_read_u16 v136, v136
ds_read_u16 v137, v137
v_pk_add_f16 v143, v143, 1.0 op_sel_hi:[1,0]
v_rcp_f16_sdwa v139, v139 dst_sel:WORD_0 dst_unused:UNUSED_PRESERVE src0_sel:WORD_0
v_mfma_f32_32x32x16_bf16 v[144:159], v[20:23], v[188:191], v[144:159]
v_rcp_f16_sdwa v141, v141 dst_sel:WORD_0 dst_unused:UNUSED_PRESERVE src0_sel:WORD_0
v_rcp_f16_sdwa v143, v143 dst_sel:WORD_0 dst_unused:UNUSED_PRESERVE src0_sel:WORD_0
v_rcp_f16_sdwa v139, v139 dst_sel:WORD_1 dst_unused:UNUSED_PRESERVE src0_sel:WORD_1
v_rcp_f16_sdwa v141, v141 dst_sel:WORD_1 dst_unused:UNUSED_PRESERVE src0_sel:WORD_1
v_mfma_f32_32x32x16_bf16 v[160:175], v[44:47], v[188:191], v[160:175]
v_rcp_f16_sdwa v143, v143 dst_sel:WORD_1 dst_unused:UNUSED_PRESERVE src0_sel:WORD_1
v_pk_mul_f16 v138, v138, v139
v_pk_mul_f16 v140, v140, v141
v_pk_mul_f16 v142, v142, v143
v_fma_mix_f32 v230, v138, v138, v230 op_sel_hi:[1,1,0]
s_waitcnt lgkmcnt(5)
v_mfma_f32_32x32x16_bf16 v[96:111], v[0:3], v[176:179], 0
ds_read_b128 v[184:187], v250 offset:51200
v_fma_mix_f32 v230, v140, v140, v230 op_sel_hi:[1,1,0]
v_cvt_pkrtz_f16_f32 v145, v144, v145
v_fma_mix_f32 v230, v142, v142, v230 op_sel_hi:[1,1,0]
v_and_b32 v145, s49, v145
v_fma_mix_f32 v230, v138, v138, v230 op_sel:[1,1,0] op_sel_hi:[1,1,0]
v_bfe_u32 v144, v145, 2, 14
v_fma_mix_f32 v230, v140, v140, v230 op_sel:[1,1,0] op_sel_hi:[1,1,0]
v_lshrrev_b32_e64 v145, 18, v145
v_fma_mix_f32 v230, v142, v142, v230 op_sel:[1,1,0] op_sel_hi:[1,1,0]
v_cvt_pk_f16_f32 v156, v156, v157
v_fma_mix_f32 v230, v128, v128, v230 op_sel_hi:[1,1,0]
v_cvt_pk_f16_f32 v158, v158, v159
v_fma_mix_f32 v230, v129, v129, v230 op_sel_hi:[1,1,0]
v_pk_fma_f16 v157, v156, v156, s48
v_fma_mix_f32 v230, v130, v130, v230 op_sel_hi:[1,1,0]
v_mfma_f32_32x32x16_bf16 v[112:127], v[24:27], v[176:179], 0
ds_read_u16 v144, v144
ds_read_u16 v145, v145
v_fma_mix_f32 v230, v131, v131, v230 op_sel_hi:[1,1,0]
v_cvt_pkrtz_f16_f32 v147, v146, v147
v_and_b32_e64 v147, s49, v147
v_bfe_u32 v146, v147, 2, 14
v_lshrrev_b32_e64 v147, 18, v147
v_pk_fma_f16 v159, v158, v158, s48
v_fma_mix_f32 v230, v132, v132, v230 op_sel_hi:[1,1,0]
v_pk_mul_f16 v157, v156, v157
v_fma_mix_f32 v230, v133, v133, v230 op_sel_hi:[1,1,0]
v_pk_mul_f16 v159, v158, v159
v_cvt_pkrtz_f16_f32 v149, v148, v149
ds_read_u16 v146, v146
ds_read_u16 v147, v147
ds_read_b128 v[188:191], v250 offset:52224
v_and_b32_e64 v149, s49, v149
v_bfe_u32 v148, v149, 2, 14
v_lshrrev_b32 v149, 18, v149
v_exp_f16_sdwa v157, v157 dst_sel:WORD_0 dst_unused:UNUSED_PRESERVE src0_sel:WORD_0
s_waitcnt lgkmcnt(5)
v_fma_mix_f32 v230, v134, v134, v230 op_sel_hi:[1,1,0]
v_mfma_f32_32x32x16_bf16 v[96:111], v[4:7], v[180:183], v[96:111]
ds_read_u16 v148, v148
ds_read_u16 v149, v149
v_fma_mix_f32 v230, v135, v135, v230 op_sel_hi:[1,1,0]
v_exp_f16_sdwa v159, v159 dst_sel:WORD_0 dst_unused:UNUSED_PRESERVE src0_sel:WORD_0
v_cvt_pkrtz_f16_f32 v151, v150, v151
v_and_b32_e64 v151, s49, v151
v_bfe_u32 v150, v151, 2, 14
v_lshrrev_b32_e64 v151, 18, v151
v_exp_f16_sdwa v157, v157 dst_sel:WORD_1 dst_unused:UNUSED_PRESERVE src0_sel:WORD_1
v_fma_mix_f32 v230, v136, v136, v230 op_sel_hi:[1,1,0]
v_cvt_pkrtz_f16_f32 v153, v152, v153
v_fma_mix_f32 v230, v137, v137, v230 op_sel_hi:[1,1,0]
v_and_b32_e64 v153, s49, v153
v_bfe_u32 v152, v153, 2, 14
ds_read_u16 v150, v150
ds_read_u16 v151, v151
v_lshrrev_b32_e64 v153, 18, v153
v_exp_f16_sdwa v159, v159 dst_sel:WORD_1 dst_unused:UNUSED_PRESERVE src0_sel:WORD_1
v_mfma_f32_32x32x16_bf16 v[112:127], v[28:31], v[180:183], v[112:127]
ds_read_u16 v152, v152
ds_read_u16 v153, v153
ds_read_b128 v[176:179], v250 offset:53248
v_cvt_pkrtz_f16_f32 v155, v154, v155
v_and_b32_e64 v155, s49, v155
v_bfe_u32 v154, v155, 2, 14
v_lshrrev_b32_e64 v155, 18, v155
v_pk_add_f16 v157, v157, 1.0 op_sel_hi:[1,0]
v_pk_add_f16 v159, v159, 1.0 op_sel_hi:[1,0]
v_rcp_f16_sdwa v157, v157 dst_sel:WORD_0 dst_unused:UNUSED_PRESERVE src0_sel:WORD_0
v_mfma_f32_32x32x16_bf16 v[96:111], v[8:11], v[184:187], v[96:111]
ds_read_u16 v154, v154
ds_read_u16 v155, v155
v_rcp_f16_sdwa v159, v159 dst_sel:WORD_0 dst_unused:UNUSED_PRESERVE src0_sel:WORD_0
v_rcp_f16_sdwa v157, v157 dst_sel:WORD_1 dst_unused:UNUSED_PRESERVE src0_sel:WORD_1
v_rcp_f16_sdwa v159, v159 dst_sel:WORD_1 dst_unused:UNUSED_PRESERVE src0_sel:WORD_1
v_mfma_f32_32x32x16_bf16 v[112:127], v[32:35], v[184:187], v[112:127]
ds_read_b128 v[180:183], v250 offset:54272
v_pk_mul_f16 v156, v156, v157
v_pk_mul_f16 v158, v158, v159
v_fma_mix_f32 v231, v156, v156, v231 op_sel_hi:[1,1,0]
v_cvt_pkrtz_f16_f32 v161, v160, v161
v_fma_mix_f32 v231, v158, v158, v231 op_sel_hi:[1,1,0]
s_waitcnt lgkmcnt(8)
v_mfma_f32_32x32x16_bf16 v[96:111], v[12:15], v[188:191], v[96:111]
v_fma_mix_f32 v231, v156, v156, v231 op_sel:[1,1,0] op_sel_hi:[1,1,0]
v_and_b32 v161, s49, v161
v_fma_mix_f32 v231, v158, v158, v231 op_sel:[1,1,0] op_sel_hi:[1,1,0]
v_bfe_u32 v160, v161, 2, 14
v_fma_mix_f32 v231, v144, v144, v231 op_sel_hi:[1,1,0]
v_lshrrev_b32_e64 v161, 18, v161
v_fma_mix_f32 v231, v145, v145, v231 op_sel_hi:[1,1,0]
v_cvt_pk_f16_f32 v170, v170, v171
v_fma_mix_f32 v231, v146, v146, v231 op_sel_hi:[1,1,0]
v_cvt_pk_f16_f32 v172, v172, v173
v_fma_mix_f32 v231, v147, v147, v231 op_sel_hi:[1,1,0]
v_cvt_pk_f16_f32 v174, v174, v175
v_pk_fma_f16 v171, v170, v170, s48
v_mfma_f32_32x32x16_bf16 v[112:127], v[36:39], v[188:191], v[112:127]
ds_read_u16 v160, v160
ds_read_u16 v161, v161
v_fma_mix_f32 v231, v148, v148, v231 op_sel_hi:[1,1,0]
v_pk_fma_f16 v173, v172, v172, s48
v_fma_mix_f32 v231, v149, v149, v231 op_sel_hi:[1,1,0]
v_cvt_pkrtz_f16_f32 v163, v162, v163
v_and_b32_e64 v163, s49, v163
v_bfe_u32 v162, v163, 2, 14
v_lshrrev_b32_e64 v163, 18, v163
v_pk_fma_f16 v175, v174, v174, s48
v_pk_mul_f16 v171, v170, v171
ds_read_b128 v[184:187], v250 offset:55296
ds_read_u16 v162, v162
ds_read_u16 v163, v163
v_pk_mul_f16 v173, v172, v173
s_waitcnt lgkmcnt(8)
v_fma_mix_f32 v231, v150, v150, v231 op_sel_hi:[1,1,0]
v_pk_mul_f16 v175, v174, v175
v_fma_mix_f32 v231, v151, v151, v231 op_sel_hi:[1,1,0]
v_exp_f16_sdwa v171, v171 dst_sel:WORD_0 dst_unused:UNUSED_PRESERVE src0_sel:WORD_0
v_cvt_pkrtz_f16_f32 v165, v164, v165
v_and_b32 v165, s49, v165
v_bfe_u32 v164, v165, 2, 14
v_lshrrev_b32_e64 v165, 18, v165
v_mfma_f32_32x32x16_bf16 v[96:111], v[16:19], v[176:179], v[96:111]
ds_read_u16 v164, v164
ds_read_u16 v165, v165
v_exp_f16_sdwa v173, v173 dst_sel:WORD_0 dst_unused:UNUSED_PRESERVE src0_sel:WORD_0
v_fma_mix_f32 v231, v152, v152, v231 op_sel_hi:[1,1,0]
v_exp_f16_sdwa v175, v175 dst_sel:WORD_0 dst_unused:UNUSED_PRESERVE src0_sel:WORD_0
v_fma_mix_f32 v231, v153, v153, v231 op_sel_hi:[1,1,0]
v_cvt_pkrtz_f16_f32 v167, v166, v167
v_and_b32_e64 v167, s49, v167
v_bfe_u32 v166, v167, 2, 14
v_lshrrev_b32 v167, 18, v167
v_exp_f16_sdwa v171, v171 dst_sel:WORD_1 dst_unused:UNUSED_PRESERVE src0_sel:WORD_1
s_waitcnt lgkmcnt(6)
v_fma_mix_f32 v231, v154, v154, v231 op_sel_hi:[1,1,0]
v_exp_f16_sdwa v173, v173 dst_sel:WORD_1 dst_unused:UNUSED_PRESERVE src0_sel:WORD_1
v_fma_mix_f32 v231, v155, v155, v231 op_sel_hi:[1,1,0]
v_mfma_f32_32x32x16_bf16 v[112:127], v[40:43], v[176:179], v[112:127]
ds_read_u16 v166, v166
ds_read_u16 v167, v167
v_exp_f16_sdwa v175, v175 dst_sel:WORD_1 dst_unused:UNUSED_PRESERVE src0_sel:WORD_1
v_cvt_pkrtz_f16_f32 v169, v168, v169
v_and_b32_e64 v169, s49, v169
v_bfe_u32 v168, v169, 2, 14
v_lshrrev_b32_e64 v169, 18, v169
v_pk_add_f16 v171, v171, 1.0 op_sel_hi:[1,0]
v_pk_add_f16 v173, v173, 1.0 op_sel_hi:[1,0]
ds_read_b128 v[188:191], v250 offset:56320
ds_read_u16 v168, v168
ds_read_u16 v169, v169
v_pk_add_f16 v175, v175, 1.0 op_sel_hi:[1,0]
v_rcp_f16_sdwa v171, v171 dst_sel:WORD_0 dst_unused:UNUSED_PRESERVE src0_sel:WORD_0
v_mfma_f32_32x32x16_bf16 v[96:111], v[20:23], v[180:183], v[96:111]
v_rcp_f16_sdwa v173, v173 dst_sel:WORD_0 dst_unused:UNUSED_PRESERVE src0_sel:WORD_0
v_rcp_f16_sdwa v175, v175 dst_sel:WORD_0 dst_unused:UNUSED_PRESERVE src0_sel:WORD_0
v_rcp_f16_sdwa v171, v171 dst_sel:WORD_1 dst_unused:UNUSED_PRESERVE src0_sel:WORD_1
v_rcp_f16_sdwa v173, v173 dst_sel:WORD_1 dst_unused:UNUSED_PRESERVE src0_sel:WORD_1
v_mfma_f32_32x32x16_bf16 v[112:127], v[44:47], v[180:183], v[112:127]
v_rcp_f16_sdwa v175, v175 dst_sel:WORD_1 dst_unused:UNUSED_PRESERVE src0_sel:WORD_1
v_pk_mul_f16 v170, v170, v171
v_pk_mul_f16 v172, v172, v173
v_pk_mul_f16 v174, v174, v175
v_fma_mix_f32 v231, v170, v170, v231 op_sel_hi:[1,1,0]
s_waitcnt lgkmcnt(5)
v_mfma_f32_32x32x16_bf16 v[128:143], v[0:3], v[184:187], 0
ds_read_b128 v[176:179], v250 offset:57344
v_fma_mix_f32 v231, v172, v172, v231 op_sel_hi:[1,1,0]
v_cvt_pkrtz_f16_f32 v97, v96, v97
v_fma_mix_f32 v231, v174, v174, v231 op_sel_hi:[1,1,0]
v_and_b32 v97, s49, v97
v_fma_mix_f32 v231, v170, v170, v231 op_sel:[1,1,0] op_sel_hi:[1,1,0]
v_bfe_u32 v96, v97, 2, 14
v_fma_mix_f32 v231, v172, v172, v231 op_sel:[1,1,0] op_sel_hi:[1,1,0]
v_lshrrev_b32_e64 v97, 18, v97
v_fma_mix_f32 v231, v174, v174, v231 op_sel:[1,1,0] op_sel_hi:[1,1,0]
v_cvt_pk_f16_f32 v108, v108, v109
v_fma_mix_f32 v231, v160, v160, v231 op_sel_hi:[1,1,0]
v_cvt_pk_f16_f32 v110, v110, v111
v_fma_mix_f32 v231, v161, v161, v231 op_sel_hi:[1,1,0]
v_pk_fma_f16 v109, v108, v108, s48
v_fma_mix_f32 v231, v162, v162, v231 op_sel_hi:[1,1,0]
v_mfma_f32_32x32x16_bf16 v[144:159], v[24:27], v[184:187], 0
ds_read_u16 v96, v96
ds_read_u16 v97, v97
v_fma_mix_f32 v231, v163, v163, v231 op_sel_hi:[1,1,0]
v_cvt_pkrtz_f16_f32 v99, v98, v99
v_and_b32_e64 v99, s49, v99
v_bfe_u32 v98, v99, 2, 14
v_lshrrev_b32_e64 v99, 18, v99
v_pk_fma_f16 v111, v110, v110, s48
v_fma_mix_f32 v231, v164, v164, v231 op_sel_hi:[1,1,0]
v_pk_mul_f16 v109, v108, v109
v_fma_mix_f32 v231, v165, v165, v231 op_sel_hi:[1,1,0]
v_pk_mul_f16 v111, v110, v111
v_cvt_pkrtz_f16_f32 v101, v100, v101
ds_read_u16 v98, v98
ds_read_u16 v99, v99
ds_read_b128 v[180:183], v250 offset:58368
v_and_b32_e64 v101, s49, v101
v_bfe_u32 v100, v101, 2, 14
v_lshrrev_b32 v101, 18, v101
v_exp_f16_sdwa v109, v109 dst_sel:WORD_0 dst_unused:UNUSED_PRESERVE src0_sel:WORD_0
s_waitcnt lgkmcnt(5)
v_fma_mix_f32 v231, v166, v166, v231 op_sel_hi:[1,1,0]
v_mfma_f32_32x32x16_bf16 v[128:143], v[4:7], v[188:191], v[128:143]
ds_read_u16 v100, v100
ds_read_u16 v101, v101
v_fma_mix_f32 v231, v167, v167, v231 op_sel_hi:[1,1,0]
v_exp_f16_sdwa v111, v111 dst_sel:WORD_0 dst_unused:UNUSED_PRESERVE src0_sel:WORD_0
v_cvt_pkrtz_f16_f32 v103, v102, v103
v_and_b32_e64 v103, s49, v103
v_bfe_u32 v102, v103, 2, 14
v_lshrrev_b32_e64 v103, 18, v103
v_exp_f16_sdwa v109, v109 dst_sel:WORD_1 dst_unused:UNUSED_PRESERVE src0_sel:WORD_1
v_fma_mix_f32 v231, v168, v168, v231 op_sel_hi:[1,1,0]
v_cvt_pkrtz_f16_f32 v105, v104, v105
v_fma_mix_f32 v231, v169, v169, v231 op_sel_hi:[1,1,0]
v_and_b32_e64 v105, s49, v105
v_bfe_u32 v104, v105, 2, 14
ds_read_u16 v102, v102
ds_read_u16 v103, v103
v_lshrrev_b32_e64 v105, 18, v105
v_exp_f16_sdwa v111, v111 dst_sel:WORD_1 dst_unused:UNUSED_PRESERVE src0_sel:WORD_1
v_mfma_f32_32x32x16_bf16 v[144:159], v[28:31], v[188:191], v[144:159]
ds_read_u16 v104, v104
ds_read_u16 v105, v105
ds_read_b128 v[184:187], v250 offset:59392
v_cvt_pkrtz_f16_f32 v107, v106, v107
v_and_b32_e64 v107, s49, v107
v_bfe_u32 v106, v107, 2, 14
v_lshrrev_b32_e64 v107, 18, v107
v_pk_add_f16 v109, v109, 1.0 op_sel_hi:[1,0]
v_pk_add_f16 v111, v111, 1.0 op_sel_hi:[1,0]
v_rcp_f16_sdwa v109, v109 dst_sel:WORD_0 dst_unused:UNUSED_PRESERVE src0_sel:WORD_0
v_mfma_f32_32x32x16_bf16 v[128:143], v[8:11], v[176:179], v[128:143]
ds_read_u16 v106, v106
ds_read_u16 v107, v107
v_rcp_f16_sdwa v111, v111 dst_sel:WORD_0 dst_unused:UNUSED_PRESERVE src0_sel:WORD_0
v_rcp_f16_sdwa v109, v109 dst_sel:WORD_1 dst_unused:UNUSED_PRESERVE src0_sel:WORD_1
v_rcp_f16_sdwa v111, v111 dst_sel:WORD_1 dst_unused:UNUSED_PRESERVE src0_sel:WORD_1
v_mfma_f32_32x32x16_bf16 v[144:159], v[32:35], v[176:179], v[144:159]
ds_read_b128 v[188:191], v250 offset:60416
v_pk_mul_f16 v108, v108, v109
v_pk_mul_f16 v110, v110, v111
v_fma_mix_f32 v232, v108, v108, v232 op_sel_hi:[1,1,0]
v_add_u32_e64 v222, s83, v247
v_mov_b32 v223, 0
s_branch Law4
Lax4:
s_sleep 2
Law4:
ds_read_b32 v223, v222 offset:20
s_sub_u32 s76, s76, 1
s_cselect_b32 s44, 4, 0
s_cselect_b32 s76, 0, s76
s_waitcnt lgkmcnt(0)
v_readfirstlane_b32 s43, v223
s_nop 1
s_max_u32 s43, s43, s44
s_cmp_lt_u32 s43, 4
s_cbranch_scc1 Lax4
v_mfma_f32_32x32x16_bf16 v[128:143], v[12:15], v[180:183], v[128:143]
s_add_u32 s81, s81, 6592
s_cmp_eq_u32 s81, 65920
s_cselect_b32 s81, 0, s81
s_add_u32 s43, s81, s67
s_add_u32 m0, s43, 16
s_add_u32 s66, s66, 98304
buffer_load_dwordx4 v236, s[4:7], s66 offen lds
s_add_u32 m0, s43, 912
s_nop 0
buffer_load_dwordx4 v237, s[4:7], s66 offen lds
v_fma_mix_f32 v232, v110, v110, v232 op_sel_hi:[1,1,0]
v_cvt_pkrtz_f16_f32 v113, v112, v113
v_fma_mix_f32 v232, v108, v108, v232 op_sel:[1,1,0] op_sel_hi:[1,1,0]
v_and_b32_e64 v113, s49, v113
v_fma_mix_f32 v232, v110, v110, v232 op_sel:[1,1,0] op_sel_hi:[1,1,0]
v_bfe_u32 v112, v113, 2, 14
v_fma_mix_f32 v232, v96, v96, v232 op_sel_hi:[1,1,0]
v_lshrrev_b32_e64 v113, 18, v113
v_fma_mix_f32 v232, v97, v97, v232 op_sel_hi:[1,1,0]
v_cvt_pk_f16_f32 v122, v122, v123
v_fma_mix_f32 v232, v98, v98, v232 op_sel_hi:[1,1,0]
v_cvt_pk_f16_f32 v124, v124, v125
v_fma_mix_f32 v232, v99, v99, v232 op_sel_hi:[1,1,0]
v_cvt_pk_f16_f32 v126, v126, v127
v_pk_fma_f16 v123, v122, v122, s48
v_mfma_f32_32x32x16_bf16 v[144:159], v[36:39], v[180:183], v[144:159]
ds_read_u16 v112, v112
ds_read_u16 v113, v113
v_fma_mix_f32 v232, v100, v100, v232 op_sel_hi:[1,1,0]
v_pk_fma_f16 v125, v124, v124, s48
v_fma_mix_f32 v232, v101, v101, v232 op_sel_hi:[1,1,0]
v_cvt_pkrtz_f16_f32 v115, v114, v115
v_and_b32_e64 v115, s49, v115
v_bfe_u32 v114, v115, 2, 14
v_lshrrev_b32_e64 v115, 18, v115
v_pk_fma_f16 v127, v126, v126, s48
v_pk_mul_f16 v123, v122, v123
ds_read_b128 v[176:179], v250 offset:61440
ds_read_u16 v114, v114
ds_read_u16 v115, v115
v_pk_mul_f16 v125, v124, v125
v_fma_mix_f32 v232, v102, v102, v232 op_sel_hi:[1,1,0]
v_pk_mul_f16 v127, v126, v127
v_fma_mix_f32 v232, v103, v103, v232 op_sel_hi:[1,1,0]
v_exp_f16_sdwa v123, v123 dst_sel:WORD_0 dst_unused:UNUSED_PRESERVE src0_sel:WORD_0
s_add_u32 s81, s81, 6592
s_cmp_eq_u32 s81, 65920
s_cselect_b32 s81, 0, s81
s_add_u32 s43, s81, s67
s_add_u32 m0, s43, 16
s_add_u32 s66, s66, 98304
buffer_load_dwordx4 v236, s[4:7], s66 offen lds
s_add_u32 m0, s43, 912
s_nop 0
buffer_load_dwordx4 v237, s[4:7], s66 offen lds
v_cvt_pkrtz_f16_f32 v117, v116, v117
v_and_b32_e64 v117, s49, v117
v_bfe_u32 v116, v117, 2, 14
v_lshrrev_b32_e64 v117, 18, v117
v_mfma_f32_32x32x16_bf16 v[128:143], v[16:19], v[184:187], v[128:143]
ds_read_u16 v116, v116
ds_read_u16 v117, v117
v_exp_f16_sdwa v125, v125 dst_sel:WORD_0 dst_unused:UNUSED_PRESERVE src0_sel:WORD_0
v_fma_mix_f32 v232, v104, v104, v232 op_sel_hi:[1,1,0]
v_exp_f16_sdwa v127, v127 dst_sel:WORD_0 dst_unused:UNUSED_PRESERVE src0_sel:WORD_0
v_fma_mix_f32 v232, v105, v105, v232 op_sel_hi:[1,1,0]
v_cvt_pkrtz_f16_f32 v119, v118, v119
v_and_b32_e64 v119, s49, v119
v_bfe_u32 v118, v119, 2, 14
v_lshrrev_b32_e64 v119, 18, v119
v_exp_f16_sdwa v123, v123 dst_sel:WORD_1 dst_unused:UNUSED_PRESERVE src0_sel:WORD_1
v_fma_mix_f32 v232, v106, v106, v232 op_sel_hi:[1,1,0]
v_exp_f16_sdwa v125, v125 dst_sel:WORD_1 dst_unused:UNUSED_PRESERVE src0_sel:WORD_1
v_fma_mix_f32 v232, v107, v107, v232 op_sel_hi:[1,1,0]
v_mfma_f32_32x32x16_bf16 v[144:159], v[40:43], v[184:187], v[144:159]
ds_read_u16 v118, v118
ds_read_u16 v119, v119
v_exp_f16_sdwa v127, v127 dst_sel:WORD_1 dst_unused:UNUSED_PRESERVE src0_sel:WORD_1
v_cvt_pkrtz_f16_f32 v121, v120, v121
v_and_b32_e64 v121, s49, v121
v_bfe_u32 v120, v121, 2, 14
v_lshrrev_b32_e64 v121, 18, v121
v_pk_add_f16 v123, v123, 1.0 op_sel_hi:[1,0]
v_pk_add_f16 v125, v125, 1.0 op_sel_hi:[1,0]
ds_read_b128 v[180:183], v250 offset:62464
ds_read_u16 v120, v120
ds_read_u16 v121, v121
v_pk_add_f16 v127, v127, 1.0 op_sel_hi:[1,0]
s_add_u32 s81, s81, 6592
s_cmp_eq_u32 s81, 65920
s_cselect_b32 s81, 0, s81
s_add_u32 s43, s81, s67
s_add_u32 m0, s43, 32
s_add_u32 s66, s66, 98304
buffer_load_dwordx4 v236, s[4:7], s66 offen lds
s_add_u32 m0, s43, 928
s_nop 0
buffer_load_dwordx4 v237, s[4:7], s66 offen lds
v_rcp_f16_sdwa v123, v123 dst_sel:WORD_0 dst_unused:UNUSED_PRESERVE src0_sel:WORD_0
v_mfma_f32_32x32x16_bf16 v[128:143], v[20:23], v[188:191], v[128:143]
v_rcp_f16_sdwa v125, v125 dst_sel:WORD_0 dst_unused:UNUSED_PRESERVE src0_sel:WORD_0
v_rcp_f16_sdwa v127, v127 dst_sel:WORD_0 dst_unused:UNUSED_PRESERVE src0_sel:WORD_0
v_rcp_f16_sdwa v123, v123 dst_sel:WORD_1 dst_unused:UNUSED_PRESERVE src0_sel:WORD_1
v_rcp_f16_sdwa v125, v125 dst_sel:WORD_1 dst_unused:UNUSED_PRESERVE src0_sel:WORD_1
v_mfma_f32_32x32x16_bf16 v[144:159], v[44:47], v[188:191], v[144:159]
v_rcp_f16_sdwa v127, v127 dst_sel:WORD_1 dst_unused:UNUSED_PRESERVE src0_sel:WORD_1
v_pk_mul_f16 v122, v122, v123
v_pk_mul_f16 v124, v124, v125
v_pk_mul_f16 v126, v126, v127
v_fma_mix_f32 v232, v122, v122, v232 op_sel_hi:[1,1,0]
s_waitcnt lgkmcnt(4)
v_mfma_f32_32x32x16_bf16 v[160:175], v[0:3], v[176:179], 0
ds_read_b128 v[184:187], v250 offset:63488
s_add_u32 s81, s81, 6592
s_cmp_eq_u32 s81, 65920
s_cselect_b32 s81, 0, s81
s_add_u32 s43, s81, s67
s_add_u32 m0, s43, 32
s_add_u32 s66, s66, 98304
buffer_load_dwordx4 v236, s[4:7], s66 offen lds
s_add_u32 m0, s43, 928
s_nop 0
buffer_load_dwordx4 v237, s[4:7], s66 offen lds
v_fma_mix_f32 v232, v124, v124, v232 op_sel_hi:[1,1,0]
v_cvt_pkrtz_f16_f32 v129, v128, v129
v_fma_mix_f32 v232, v126, v126, v232 op_sel_hi:[1,1,0]
v_and_b32 v129, s49, v129
v_fma_mix_f32 v232, v122, v122, v232 op_sel:[1,1,0] op_sel_hi:[1,1,0]
v_bfe_u32 v128, v129, 2, 14
v_fma_mix_f32 v232, v124, v124, v232 op_sel:[1,1,0] op_sel_hi:[1,1,0]
v_lshrrev_b32_e64 v129, 18, v129
v_fma_mix_f32 v232, v126, v126, v232 op_sel:[1,1,0] op_sel_hi:[1,1,0]
v_cvt_pk_f16_f32 v140, v140, v141
v_fma_mix_f32 v232, v112, v112, v232 op_sel_hi:[1,1,0]
v_cvt_pk_f16_f32 v142, v142, v143
v_fma_mix_f32 v232, v113, v113, v232 op_sel_hi:[1,1,0]
v_pk_fma_f16 v141, v140, v140, s48
v_fma_mix_f32 v232, v114, v114, v232 op_sel_hi:[1,1,0]
v_mfma_f32_32x32x16_bf16 v[96:111], v[24:27], v[176:179], 0
ds_read_u16 v128, v128
ds_read_u16 v129, v129
v_fma_mix_f32 v232, v115, v115, v232 op_sel_hi:[1,1,0]
v_cvt_pkrtz_f16_f32 v131, v130, v131
v_and_b32_e64 v131, s49, v131
v_bfe_u32 v130, v131, 2, 14
v_lshrrev_b32_e64 v131, 18, v131
v_pk_fma_f16 v143, v142, v142, s48
v_fma_mix_f32 v232, v116, v116, v232 op_sel_hi:[1,1,0]
v_pk_mul_f16 v141, v140, v141
v_fma_mix_f32 v232, v117, v117, v232 op_sel_hi:[1,1,0]
v_pk_mul_f16 v143, v142, v143
v_cvt_pkrtz_f16_f32 v133, v132, v133
ds_read_u16 v130, v130
ds_read_u16 v131, v131
ds_read_b128 v[188:191], v250 offset:64512
s_add_u32 s81, s81, 6592
s_cmp_eq_u32 s81, 65920
s_cselect_b32 s81, 0, s81
s_add_u32 s43, s81, s67
s_add_u32 m0, s43, 48
s_add_u32 s66, s66, 98304
buffer_load_dwordx4 v236, s[4:7], s66 offen lds
s_add_u32 m0, s43, 944
s_nop 0
buffer_load_dwordx4 v237, s[4:7], s66 offen lds
v_and_b32_e64 v133, s49, v133
v_bfe_u32 v132, v133, 2, 14
v_lshrrev_b32 v133, 18, v133
v_exp_f16_sdwa v141, v141 dst_sel:WORD_0 dst_unused:UNUSED_PRESERVE src0_sel:WORD_0
v_fma_mix_f32 v232, v118, v118, v232 op_sel_hi:[1,1,0]
s_waitcnt lgkmcnt(5)
v_mfma_f32_32x32x16_bf16 v[160:175], v[4:7], v[180:183], v[160:175]
ds_read_u16 v132, v132
ds_read_u16 v133, v133
v_fma_mix_f32 v232, v119, v119, v232 op_sel_hi:[1,1,0]
v_exp_f16_sdwa v143, v143 dst_sel:WORD_0 dst_unused:UNUSED_PRESERVE src0_sel:WORD_0
v_cvt_pkrtz_f16_f32 v135, v134, v135
v_and_b32_e64 v135, s49, v135
v_bfe_u32 v134, v135, 2, 14
v_lshrrev_b32_e64 v135, 18, v135
v_exp_f16_sdwa v141, v141 dst_sel:WORD_1 dst_unused:UNUSED_PRESERVE src0_sel:WORD_1
v_fma_mix_f32 v232, v120, v120, v232 op_sel_hi:[1,1,0]
v_cvt_pkrtz_f16_f32 v137, v136, v137
v_fma_mix_f32 v232, v121, v121, v232 op_sel_hi:[1,1,0]
v_and_b32_e64 v137, s49, v137
v_bfe_u32 v136, v137, 2, 14
ds_read_u16 v134, v134
ds_read_u16 v135, v135
v_lshrrev_b32_e64 v137, 18, v137
v_exp_f16_sdwa v143, v143 dst_sel:WORD_1 dst_unused:UNUSED_PRESERVE src0_sel:WORD_1
v_mfma_f32_32x32x16_bf16 v[96:111], v[28:31], v[180:183], v[96:111]
ds_read_u16 v136, v136
ds_read_u16 v137, v137
ds_read_b128 v[176:179], v251
v_cvt_pkrtz_f16_f32 v139, v138, v139
v_and_b32_e64 v139, s49, v139
v_bfe_u32 v138, v139, 2, 14
v_lshrrev_b32_e64 v139, 18, v139
v_pk_add_f16 v141, v141, 1.0 op_sel_hi:[1,0]
v_pk_add_f16 v143, v143, 1.0 op_sel_hi:[1,0]
v_rcp_f16_sdwa v141, v141 dst_sel:WORD_0 dst_unused:UNUSED_PRESERVE src0_sel:WORD_0
v_mfma_f32_32x32x16_bf16 v[160:175], v[8:11], v[184:187], v[160:175]
ds_read_u16 v138, v138
ds_read_u16 v139, v139
s_add_u32 s81, s81, 6592
s_cmp_eq_u32 s81, 65920
s_cselect_b32 s81, 0, s81
s_add_u32 s43, s81, s67
s_add_u32 m0, s43, 48
s_add_u32 s66, s66, 98304
buffer_load_dwordx4 v236, s[4:7], s66 offen lds
s_add_u32 m0, s43, 944
s_nop 0
buffer_load_dwordx4 v237, s[4:7], s66 offen lds
v_rcp_f16_sdwa v143, v143 dst_sel:WORD_0 dst_unused:UNUSED_PRESERVE src0_sel:WORD_0
v_rcp_f16_sdwa v141, v141 dst_sel:WORD_1 dst_unused:UNUSED_PRESERVE src0_sel:WORD_1
v_rcp_f16_sdwa v143, v143 dst_sel:WORD_1 dst_unused:UNUSED_PRESERVE src0_sel:WORD_1
v_mfma_f32_32x32x16_bf16 v[96:111], v[32:35], v[184:187], v[96:111]
ds_read_b128 v[180:183], v251 offset:1024
s_add_u32 s81, s81, 6592
s_cmp_eq_u32 s81, 65920
s_cselect_b32 s81, 0, s81
s_add_u32 s43, s81, s67
s_add_u32 m0, s43, 0
s_add_u32 s66, s66, 98304
buffer_load_dwordx4 v236, s[4:7], s66 offen lds
s_add_u32 m0, s43, 896
s_nop 0
buffer_load_dwordx4 v237, s[4:7], s66 offen lds
v_pk_mul_f16 v140, v140, v141
v_pk_mul_f16 v142, v142, v143
v_fma_mix_f32 v233, v140, v140, v233 op_sel_hi:[1,1,0]
v_cvt_pkrtz_f16_f32 v145, v144, v145
s_waitcnt lgkmcnt(8)
v_mfma_f32_32x32x16_bf16 v[160:175], v[12:15], v[188:191], v[160:175]
v_fma_mix_f32 v233, v142, v142, v233 op_sel_hi:[1,1,0]
v_and_b32 v145, s49, v145
v_fma_mix_f32 v233, v140, v140, v233 op_sel:[1,1,0] op_sel_hi:[1,1,0]
v_bfe_u32 v144, v145, 2, 14
v_fma_mix_f32 v233, v142, v142, v233 op_sel:[1,1,0] op_sel_hi:[1,1,0]
v_lshrrev_b32_e64 v145, 18, v145
v_fma_mix_f32 v233, v128, v128, v233 op_sel_hi:[1,1,0]
v_cvt_pk_f16_f32 v154, v154, v155
v_fma_mix_f32 v233, v129, v129, v233 op_sel_hi:[1,1,0]
v_cvt_pk_f16_f32 v156, v156, v157
v_fma_mix_f32 v233, v130, v130, v233 op_sel_hi:[1,1,0]
v_cvt_pk_f16_f32 v158, v158, v159
v_fma_mix_f32 v233, v131, v131, v233 op_sel_hi:[1,1,0]
v_pk_fma_f16 v155, v154, v154, s48
v_mfma_f32_32x32x16_bf16 v[96:111], v[36:39], v[188:191], v[96:111]
ds_read_u16 v144, v144
ds_read_u16 v145, v145
v_fma_mix_f32 v233, v132, v132, v233 op_sel_hi:[1,1,0]
v_pk_fma_f16 v157, v156, v156, s48
v_fma_mix_f32 v233, v133, v133, v233 op_sel_hi:[1,1,0]
s_add_u32 s81, s81, 6592
s_cmp_eq_u32 s81, 65920
s_cselect_b32 s81, 0, s81
s_add_u32 s43, s81, s67
s_add_u32 m0, s43, 0
s_add_u32 s66, s66, 98304
buffer_load_dwordx4 v236, s[4:7], s66 offen lds
s_add_u32 m0, s43, 896
s_nop 0
buffer_load_dwordx4 v237, s[4:7], s66 offen lds
ds_read_b128 v[184:187], v251 offset:2048
v_cvt_pkrtz_f16_f32 v147, v146, v147
v_and_b32_e64 v147, s49, v147
v_bfe_u32 v146, v147, 2, 14
v_lshrrev_b32 v147, 18, v147
v_pk_fma_f16 v159, v158, v158, s48
v_pk_mul_f16 v155, v154, v155
v_pk_mul_f16 v157, v156, v157
s_waitcnt lgkmcnt(6)
v_fma_mix_f32 v233, v134, v134, v233 op_sel_hi:[1,1,0]
v_pk_mul_f16 v159, v158, v159
v_fma_mix_f32 v233, v135, v135, v233 op_sel_hi:[1,1,0]
ds_read_u16 v146, v146
ds_read_u16 v147, v147
v_exp_f16_sdwa v155, v155 dst_sel:WORD_0 dst_unused:UNUSED_PRESERVE src0_sel:WORD_0
v_cvt_pkrtz_f16_f32 v149, v148, v149
v_and_b32_e64 v149, s49, v149
v_bfe_u32 v148, v149, 2, 14
v_lshrrev_b32_e64 v149, 18, v149
v_mfma_f32_32x32x16_bf16 v[160:175], v[16:19], v[176:179], v[160:175]
ds_read_u16 v148, v148
ds_read_u16 v149, v149
v_exp_f16_sdwa v157, v157 dst_sel:WORD_0 dst_unused:UNUSED_PRESERVE src0_sel:WORD_0
v_fma_mix_f32 v233, v136, v136, v233 op_sel_hi:[1,1,0]
v_exp_f16_sdwa v159, v159 dst_sel:WORD_0 dst_unused:UNUSED_PRESERVE src0_sel:WORD_0
v_fma_mix_f32 v233, v137, v137, v233 op_sel_hi:[1,1,0]
v_cvt_pkrtz_f16_f32 v151, v150, v151
v_and_b32_e64 v151, s49, v151
v_bfe_u32 v150, v151, 2, 14
v_lshrrev_b32 v151, 18, v151
v_exp_f16_sdwa v155, v155 dst_sel:WORD_1 dst_unused:UNUSED_PRESERVE src0_sel:WORD_1
s_waitcnt lgkmcnt(6)
v_fma_mix_f32 v233, v138, v138, v233 op_sel_hi:[1,1,0]
v_exp_f16_sdwa v157, v157 dst_sel:WORD_1 dst_unused:UNUSED_PRESERVE src0_sel:WORD_1
v_fma_mix_f32 v233, v139, v139, v233 op_sel_hi:[1,1,0]
v_mfma_f32_32x32x16_bf16 v[96:111], v[40:43], v[176:179], v[96:111]
ds_read_u16 v150, v150
ds_read_u16 v151, v151
v_exp_f16_sdwa v159, v159 dst_sel:WORD_1 dst_unused:UNUSED_PRESERVE src0_sel:WORD_1
v_cvt_pkrtz_f16_f32 v153, v152, v153
v_and_b32_e64 v153, s49, v153
v_bfe_u32 v152, v153, 2, 14
v_lshrrev_b32_e64 v153, 18, v153
v_pk_add_f16 v155, v155, 1.0 op_sel_hi:[1,0]
v_pk_add_f16 v157, v157, 1.0 op_sel_hi:[1,0]
ds_read_b128 v[188:191], v251 offset:3072
ds_read_u16 v152, v152
ds_read_u16 v153, v153
v_pk_add_f16 v159, v159, 1.0 op_sel_hi:[1,0]
v_rcp_f16_sdwa v155, v155 dst_sel:WORD_0 dst_unused:UNUSED_PRESERVE src0_sel:WORD_0
v_mfma_f32_32x32x16_bf16 v[160:175], v[20:23], v[180:183], v[160:175]
v_rcp_f16_sdwa v157, v157 dst_sel:WORD_0 dst_unused:UNUSED_PRESERVE src0_sel:WORD_0
v_rcp_f16_sdwa v159, v159 dst_sel:WORD_0 dst_unused:UNUSED_PRESERVE src0_sel:WORD_0
v_rcp_f16_sdwa v155, v155 dst_sel:WORD_1 dst_unused:UNUSED_PRESERVE src0_sel:WORD_1
v_rcp_f16_sdwa v157, v157 dst_sel:WORD_1 dst_unused:UNUSED_PRESERVE src0_sel:WORD_1
v_mfma_f32_32x32x16_bf16 v[96:111], v[44:47], v[180:183], v[96:111]
v_rcp_f16_sdwa v159, v159 dst_sel:WORD_1 dst_unused:UNUSED_PRESERVE src0_sel:WORD_1
v_pk_mul_f16 v154, v154, v155
v_pk_mul_f16 v156, v156, v157
v_pk_mul_f16 v158, v158, v159
v_fma_mix_f32 v233, v154, v154, v233 op_sel_hi:[1,1,0]
s_waitcnt lgkmcnt(4)
v_mfma_f32_32x32x16_bf16 v[112:127], v[0:3], v[184:187], 0
ds_read_b128 v[176:179], v251 offset:4096
v_fma_mix_f32 v233, v156, v156, v233 op_sel_hi:[1,1,0]
v_cvt_pkrtz_f16_f32 v161, v160, v161
v_fma_mix_f32 v233, v158, v158, v233 op_sel_hi:[1,1,0]
v_and_b32 v161, s49, v161
v_fma_mix_f32 v233, v154, v154, v233 op_sel:[1,1,0] op_sel_hi:[1,1,0]
v_bfe_u32 v160, v161, 2, 14
v_fma_mix_f32 v233, v156, v156, v233 op_sel:[1,1,0] op_sel_hi:[1,1,0]
v_lshrrev_b32_e64 v161, 18, v161
v_fma_mix_f32 v233, v158, v158, v233 op_sel:[1,1,0] op_sel_hi:[1,1,0]
v_cvt_pk_f16_f32 v172, v172, v173
v_fma_mix_f32 v233, v144, v144, v233 op_sel_hi:[1,1,0]
v_cvt_pk_f16_f32 v174, v174, v175
v_fma_mix_f32 v233, v145, v145, v233 op_sel_hi:[1,1,0]
v_pk_fma_f16 v173, v172, v172, s48
v_fma_mix_f32 v233, v146, v146, v233 op_sel_hi:[1,1,0]
v_mfma_f32_32x32x16_bf16 v[128:143], v[24:27], v[184:187], 0
ds_read_u16 v160, v160
ds_read_u16 v161, v161
v_fma_mix_f32 v233, v147, v147, v233 op_sel_hi:[1,1,0]
v_cvt_pkrtz_f16_f32 v163, v162, v163
v_and_b32_e64 v163, s49, v163
v_bfe_u32 v162, v163, 2, 14
v_lshrrev_b32_e64 v163, 18, v163
v_pk_fma_f16 v175, v174, v174, s48
v_fma_mix_f32 v233, v148, v148, v233 op_sel_hi:[1,1,0]
v_pk_mul_f16 v173, v172, v173
v_fma_mix_f32 v233, v149, v149, v233 op_sel_hi:[1,1,0]
v_pk_mul_f16 v175, v174, v175
v_cvt_pkrtz_f16_f32 v165, v164, v165
ds_read_u16 v162, v162
ds_read_u16 v163, v163
ds_read_b128 v[180:183], v251 offset:5120
v_and_b32_e64 v165, s49, v165
v_bfe_u32 v164, v165, 2, 14
v_lshrrev_b32 v165, 18, v165
v_exp_f16_sdwa v173, v173 dst_sel:WORD_0 dst_unused:UNUSED_PRESERVE src0_sel:WORD_0
v_fma_mix_f32 v233, v150, v150, v233 op_sel_hi:[1,1,0]
s_waitcnt lgkmcnt(5)
v_mfma_f32_32x32x16_bf16 v[112:127], v[4:7], v[188:191], v[112:127]
ds_read_u16 v164, v164
ds_read_u16 v165, v165
v_fma_mix_f32 v233, v151, v151, v233 op_sel_hi:[1,1,0]
v_exp_f16_sdwa v175, v175 dst_sel:WORD_0 dst_unused:UNUSED_PRESERVE src0_sel:WORD_0
v_cvt_pkrtz_f16_f32 v167, v166, v167
v_and_b32_e64 v167, s49, v167
v_bfe_u32 v166, v167, 2, 14
v_lshrrev_b32_e64 v167, 18, v167
v_exp_f16_sdwa v173, v173 dst_sel:WORD_1 dst_unused:UNUSED_PRESERVE src0_sel:WORD_1
v_fma_mix_f32 v233, v152, v152, v233 op_sel_hi:[1,1,0]
v_cvt_pkrtz_f16_f32 v169, v168, v169
v_fma_mix_f32 v233, v153, v153, v233 op_sel_hi:[1,1,0]
v_and_b32_e64 v169, s49, v169
v_bfe_u32 v168, v169, 2, 14
ds_read_u16 v166, v166
ds_read_u16 v167, v167
v_lshrrev_b32_e64 v169, 18, v169
v_exp_f16_sdwa v175, v175 dst_sel:WORD_1 dst_unused:UNUSED_PRESERVE src0_sel:WORD_1
v_mfma_f32_32x32x16_bf16 v[128:143], v[28:31], v[188:191], v[128:143]
ds_read_u16 v168, v168
ds_read_u16 v169, v169
ds_read_b128 v[184:187], v251 offset:6144
v_cvt_pkrtz_f16_f32 v171, v170, v171
v_and_b32_e64 v171, s49, v171
v_bfe_u32 v170, v171, 2, 14
v_lshrrev_b32_e64 v171, 18, v171
v_pk_add_f16 v173, v173, 1.0 op_sel_hi:[1,0]
v_pk_add_f16 v175, v175, 1.0 op_sel_hi:[1,0]
v_rcp_f16_sdwa v173, v173 dst_sel:WORD_0 dst_unused:UNUSED_PRESERVE src0_sel:WORD_0
v_mfma_f32_32x32x16_bf16 v[112:127], v[8:11], v[176:179], v[112:127]
ds_read_u16 v170, v170
ds_read_u16 v171, v171
v_rcp_f16_sdwa v175, v175 dst_sel:WORD_0 dst_unused:UNUSED_PRESERVE src0_sel:WORD_0
v_rcp_f16_sdwa v173, v173 dst_sel:WORD_1 dst_unused:UNUSED_PRESERVE src0_sel:WORD_1
v_rcp_f16_sdwa v175, v175 dst_sel:WORD_1 dst_unused:UNUSED_PRESERVE src0_sel:WORD_1
v_mfma_f32_32x32x16_bf16 v[128:143], v[32:35], v[176:179], v[128:143]
ds_read_b128 v[188:191], v251 offset:7168
v_pk_mul_f16 v172, v172, v173
v_pk_mul_f16 v174, v174, v175
v_fma_mix_f32 v234, v172, v172, v234 op_sel_hi:[1,1,0]
v_cvt_pkrtz_f16_f32 v97, v96, v97
v_fma_mix_f32 v234, v174, v174, v234 op_sel_hi:[1,1,0]
s_waitcnt lgkmcnt(8)
v_mfma_f32_32x32x16_bf16 v[112:127], v[12:15], v[180:183], v[112:127]
v_fma_mix_f32 v234, v172, v172, v234 op_sel:[1,1,0] op_sel_hi:[1,1,0]
v_and_b32 v97, s49, v97
v_fma_mix_f32 v234, v174, v174, v234 op_sel:[1,1,0] op_sel_hi:[1,1,0]
v_bfe_u32 v96, v97, 2, 14
v_fma_mix_f32 v234, v160, v160, v234 op_sel_hi:[1,1,0]
v_lshrrev_b32_e64 v97, 18, v97
v_fma_mix_f32 v234, v161, v161, v234 op_sel_hi:[1,1,0]
v_cvt_pk_f16_f32 v106, v106, v107
v_fma_mix_f32 v234, v162, v162, v234 op_sel_hi:[1,1,0]
v_cvt_pk_f16_f32 v108, v108, v109
v_fma_mix_f32 v234, v163, v163, v234 op_sel_hi:[1,1,0]
v_cvt_pk_f16_f32 v110, v110, v111
v_pk_fma_f16 v107, v106, v106, s48
v_mfma_f32_32x32x16_bf16 v[128:143], v[36:39], v[180:183], v[128:143]
ds_read_u16 v96, v96
ds_read_u16 v97, v97
v_fma_mix_f32 v234, v164, v164, v234 op_sel_hi:[1,1,0]
v_pk_fma_f16 v109, v108, v108, s48
v_fma_mix_f32 v234, v165, v165, v234 op_sel_hi:[1,1,0]
v_cvt_pkrtz_f16_f32 v99, v98, v99
v_and_b32_e64 v99, s49, v99
v_bfe_u32 v98, v99, 2, 14
v_lshrrev_b32 v99, 18, v99
v_pk_fma_f16 v111, v110, v110, s48
v_pk_mul_f16 v107, v106, v107
v_pk_mul_f16 v109, v108, v109
s_waitcnt lgkmcnt(5)
v_fma_mix_f32 v234, v166, v166, v234 op_sel_hi:[1,1,0]
v_pk_mul_f16 v111, v110, v111
v_fma_mix_f32 v234, v167, v167, v234 op_sel_hi:[1,1,0]
ds_read_u16 v98, v98
ds_read_u16 v99, v99
v_exp_f16_sdwa v107, v107 dst_sel:WORD_0 dst_unused:UNUSED_PRESERVE src0_sel:WORD_0
v_cvt_pkrtz_f16_f32 v101, v100, v101
v_and_b32_e64 v101, s49, v101
v_bfe_u32 v100, v101, 2, 14
v_lshrrev_b32_e64 v101, 18, v101
v_mfma_f32_32x32x16_bf16 v[112:127], v[16:19], v[184:187], v[112:127]
ds_read_u16 v100, v100
ds_read_u16 v101, v101
v_exp_f16_sdwa v109, v109 dst_sel:WORD_0 dst_unused:UNUSED_PRESERVE src0_sel:WORD_0
v_fma_mix_f32 v234, v168, v168, v234 op_sel_hi:[1,1,0]
v_exp_f16_sdwa v111, v111 dst_sel:WORD_0 dst_unused:UNUSED_PRESERVE src0_sel:WORD_0
v_fma_mix_f32 v234, v169, v169, v234 op_sel_hi:[1,1,0]
v_cvt_pkrtz_f16_f32 v103, v102, v103
v_and_b32_e64 v103, s49, v103
v_bfe_u32 v102, v103, 2, 14
v_lshrrev_b32 v103, 18, v103
v_exp_f16_sdwa v107, v107 dst_sel:WORD_1 dst_unused:UNUSED_PRESERVE src0_sel:WORD_1
s_waitcnt lgkmcnt(5)
v_fma_mix_f32 v234, v170, v170, v234 op_sel_hi:[1,1,0]
v_exp_f16_sdwa v109, v109 dst_sel:WORD_1 dst_unused:UNUSED_PRESERVE src0_sel:WORD_1
v_fma_mix_f32 v234, v171, v171, v234 op_sel_hi:[1,1,0]
v_mfma_f32_32x32x16_bf16 v[128:143], v[40:43], v[184:187], v[128:143]
ds_read_u16 v102, v102
ds_read_u16 v103, v103
v_exp_f16_sdwa v111, v111 dst_sel:WORD_1 dst_unused:UNUSED_PRESERVE src0_sel:WORD_1
v_cvt_pkrtz_f16_f32 v105, v104, v105
v_and_b32_e64 v105, s49, v105
v_bfe_u32 v104, v105, 2, 14
v_lshrrev_b32_e64 v105, 18, v105
v_pk_add_f16 v107, v107, 1.0 op_sel_hi:[1,0]
v_pk_add_f16 v109, v109, 1.0 op_sel_hi:[1,0]
v_pk_add_f16 v111, v111, 1.0 op_sel_hi:[1,0]
v_rcp_f16_sdwa v107, v107 dst_sel:WORD_0 dst_unused:UNUSED_PRESERVE src0_sel:WORD_0
v_mfma_f32_32x32x16_bf16 v[112:127], v[20:23], v[188:191], v[112:127]
ds_read_u16 v104, v104
ds_read_u16 v105, v105
v_rcp_f16_sdwa v109, v109 dst_sel:WORD_0 dst_unused:UNUSED_PRESERVE src0_sel:WORD_0
v_rcp_f16_sdwa v111, v111 dst_sel:WORD_0 dst_unused:UNUSED_PRESERVE src0_sel:WORD_0
v_rcp_f16_sdwa v107, v107 dst_sel:WORD_1 dst_unused:UNUSED_PRESERVE src0_sel:WORD_1
v_rcp_f16_sdwa v109, v109 dst_sel:WORD_1 dst_unused:UNUSED_PRESERVE src0_sel:WORD_1
v_mfma_f32_32x32x16_bf16 v[128:143], v[44:47], v[188:191], v[128:143]
v_rcp_f16_sdwa v111, v111 dst_sel:WORD_1 dst_unused:UNUSED_PRESERVE src0_sel:WORD_1
v_pk_mul_f16 v106, v106, v107
v_pk_mul_f16 v108, v108, v109
v_pk_mul_f16 v110, v110, v111
v_fma_mix_f32 v234, v106, v106, v234 op_sel_hi:[1,1,0]
v_cvt_pkrtz_f16_f32 v113, v112, v113
v_fma_mix_f32 v234, v108, v108, v234 op_sel_hi:[1,1,0]
v_and_b32_e64 v113, s49, v113
v_fma_mix_f32 v234, v110, v110, v234 op_sel_hi:[1,1,0]
v_bfe_u32 v112, v113, 2, 14
v_fma_mix_f32 v234, v106, v106, v234 op_sel:[1,1,0] op_sel_hi:[1,1,0]
v_lshrrev_b32_e64 v113, 18, v113
v_fma_mix_f32 v234, v108, v108, v234 op_sel:[1,1,0] op_sel_hi:[1,1,0]
v_cvt_pk_f16_f32 v124, v124, v125
v_fma_mix_f32 v234, v110, v110, v234 op_sel:[1,1,0] op_sel_hi:[1,1,0]
v_cvt_pk_f16_f32 v126, v126, v127
v_fma_mix_f32 v234, v96, v96, v234 op_sel_hi:[1,1,0]
v_pk_fma_f16 v125, v124, v124, s48
s_waitcnt lgkmcnt(1)
v_fma_mix_f32 v234, v97, v97, v234 op_sel_hi:[1,1,0]
v_cvt_pkrtz_f16_f32 v115, v114, v115
v_fma_mix_f32 v234, v98, v98, v234 op_sel_hi:[1,1,0]
v_and_b32 v115, s49, v115
v_fma_mix_f32 v234, v99, v99, v234 op_sel_hi:[1,1,0]
v_bfe_u32 v114, v115, 2, 14
v_lshrrev_b32_e64 v115, 18, v115
ds_read_u16 v112, v112
ds_read_u16 v113, v113
ds_read_u16 v114, v114
ds_read_u16 v115, v115
s_add_u32 s43, s81, 6592
v_add_u32_e64 v212, s43, v246
v_subrev_u32 v222, 65920, v212
v_min_u32_e64 v212, v212, v222
v_add_u32 v212, 90112, v212
v_add_u32_e64 v213, s43, v246
v_add_u32 v213, 6592, v213
v_subrev_u32 v222, 65920, v213
v_min_u32_e64 v213, v213, v222
v_add_u32 v213, 90112, v213
v_add_u32_e64 v214, s43, v246
v_add_u32 v214, 13184, v214
v_add_u32_e64 v222, 16, v214
v_bfi_b32 v214, 48, v222, v214
v_subrev_u32 v222, 65920, v214
v_min_u32_e64 v214, v214, v222
v_add_u32 v214, 90112, v214
v_add_u32_e64 v215, s43, v246
v_add_u32 v215, 19776, v215
v_add_u32_e64 v222, 16, v215
v_bfi_b32 v215, 48, v222, v215
v_subrev_u32 v222, 65920, v215
v_min_u32_e64 v215, v215, v222
v_add_u32 v215, 90112, v215
v_pk_fma_f16 v127, v126, v126, s48
v_fma_mix_f32 v234, v100, v100, v234 op_sel_hi:[1,1,0]
v_pk_mul_f16 v125, v124, v125
v_fma_mix_f32 v234, v101, v101, v234 op_sel_hi:[1,1,0]
v_pk_mul_f16 v127, v126, v127
v_cvt_pkrtz_f16_f32 v117, v116, v117
v_and_b32_e64 v117, s49, v117
v_bfe_u32 v116, v117, 2, 14
v_lshrrev_b32_e64 v117, 18, v117
v_exp_f16_sdwa v125, v125 dst_sel:WORD_0 dst_unused:UNUSED_PRESERVE src0_sel:WORD_0
v_fma_mix_f32 v234, v102, v102, v234 op_sel_hi:[1,1,0]
v_exp_f16_sdwa v127, v127 dst_sel:WORD_0 dst_unused:UNUSED_PRESERVE src0_sel:WORD_0
v_fma_mix_f32 v234, v103, v103, v234 op_sel_hi:[1,1,0]
v_cvt_pkrtz_f16_f32 v119, v118, v119
v_and_b32_e64 v119, s49, v119
ds_read_u16 v116, v116
ds_read_u16 v117, v117
v_bfe_u32 v118, v119, 2, 14
v_lshrrev_b32_e64 v119, 18, v119
v_exp_f16_sdwa v125, v125 dst_sel:WORD_1 dst_unused:UNUSED_PRESERVE src0_sel:WORD_1
v_fma_mix_f32 v234, v104, v104, v234 op_sel_hi:[1,1,0]
v_cvt_pkrtz_f16_f32 v121, v120, v121
s_waitcnt lgkmcnt(3)
v_fma_mix_f32 v234, v105, v105, v234 op_sel_hi:[1,1,0]
v_and_b32 v121, s49, v121
v_bfe_u32 v120, v121, 2, 14
ds_read_u16 v118, v118
ds_read_u16 v119, v119
s_waitcnt vmcnt(0)
ds_read_b128 v[144:147], v212
ds_read_b64 v[196:197], v238
ds_read_b64 v[198:199], v239
v_lshrrev_b32 v121, 18, v121
v_exp_f16_sdwa v127, v127 dst_sel:WORD_1 dst_unused:UNUSED_PRESERVE src0_sel:WORD_1
v_cvt_pkrtz_f16_f32 v123, v122, v123
v_and_b32_e64 v123, s49, v123
v_bfe_u32 v122, v123, 2, 14
v_lshrrev_b32_e64 v123, 18, v123
v_pk_add_f16 v125, v125, 1.0 op_sel_hi:[1,0]
ds_read_u16 v120, v120
ds_read_u16 v121, v121
ds_read_b128 v[148:151], v213
ds_read_b128 v[152:155], v214
ds_read_b64 v[200:201], v238 offset:2400
ds_read_b64 v[202:203], v239 offset:2400
ds_read_b128 v[156:159], v215
s_waitcnt lgkmcnt(14)
ds_read_u16 v122, v122
v_pk_add_f16 v127, v127, 1.0 op_sel_hi:[1,0]
v_rcp_f16_sdwa v125, v125 dst_sel:WORD_0 dst_unused:UNUSED_PRESERVE src0_sel:WORD_0
v_rcp_f16_sdwa v127, v127 dst_sel:WORD_0 dst_unused:UNUSED_PRESERVE src0_sel:WORD_0
v_rcp_f16_sdwa v125, v125 dst_sel:WORD_1 dst_unused:UNUSED_PRESERVE src0_sel:WORD_1
v_rcp_f16_sdwa v127, v127 dst_sel:WORD_1 dst_unused:UNUSED_PRESERVE src0_sel:WORD_1
v_pk_mul_f16 v124, v124, v125
v_pk_mul_f16 v126, v126, v127
s_waitcnt lgkmcnt(13)
ds_read_u16 v123, v123
ds_read_b64 v[204:205], v238 offset:4800
v_fma_mix_f32 v235, v124, v124, v235 op_sel_hi:[1,1,0]
v_cvt_pkrtz_f16_f32 v129, v128, v129
v_fma_mix_f32 v235, v126, v126, v235 op_sel_hi:[1,1,0]
v_and_b32_e64 v129, s49, v129
v_fma_mix_f32 v235, v124, v124, v235 op_sel:[1,1,0] op_sel_hi:[1,1,0]
v_bfe_u32 v128, v129, 2, 14
v_fma_mix_f32 v235, v126, v126, v235 op_sel:[1,1,0] op_sel_hi:[1,1,0]
v_lshrrev_b32 v129, 18, v129
s_waitcnt lgkmcnt(14)
ds_read_b64 v[206:207], v239 offset:4800
s_waitcnt lgkmcnt(14)
ds_read_b128 v[160:163], v212 offset:16
s_waitcnt lgkmcnt(14)
ds_read_b64 v[208:209], v238 offset:200
s_waitcnt lgkmcnt(14)
ds_read_b64 v[210:211], v239 offset:200
s_waitcnt lgkmcnt(14)
v_mfma_f32_16x16x32_bf16 v[48:51], v[196:199], v[144:147], 0
v_fma_mix_f32 v235, v112, v112, v235 op_sel_hi:[1,1,0]
v_cvt_pk_f16_f32 v138, v138, v139
v_fma_mix_f32 v235, v113, v113, v235 op_sel_hi:[1,1,0]
v_cvt_pk_f16_f32 v140, v140, v141
v_fma_mix_f32 v235, v114, v114, v235 op_sel_hi:[1,1,0]
v_cvt_pk_f16_f32 v142, v142, v143
v_fma_mix_f32 v235, v115, v115, v235 op_sel_hi:[1,1,0]
v_pk_fma_f16 v139, v138, v138, s48
v_fma_mix_f32 v235, v116, v116, v235 op_sel_hi:[1,1,0]
v_pk_fma_f16 v141, v140, v140, s48
ds_read_b128 v[164:167], v213 offset:16
s_waitcnt lgkmcnt(14)
ds_read_b128 v[168:171], v214 offset:16
v_fma_mix_f32 v235, v117, v117, v235 op_sel_hi:[1,1,0]
v_cvt_pkrtz_f16_f32 v131, v130, v131
v_and_b32_e64 v131, s49, v131
s_waitcnt lgkmcnt(13)
v_mfma_f32_16x16x32_bf16 v[96:99], v[196:199], v[148:151], 0
ds_read_b64 v[192:193], v238 offset:2600
v_bfe_u32 v130, v131, 2, 14
v_lshrrev_b32 v131, 18, v131
v_pk_fma_f16 v143, v142, v142, s48
v_pk_mul_f16 v139, v138, v139
v_pk_mul_f16 v141, v140, v141
v_fma_mix_f32 v235, v118, v118, v235 op_sel_hi:[1,1,0]
s_waitcnt lgkmcnt(11)
v_mfma_f32_16x16x32_bf16 v[48:51], v[200:203], v[148:151], v[48:51]
ds_read_b64 v[194:195], v239 offset:2600
ds_read_b128 v[172:175], v215 offset:16
ds_read_b64 v[196:197], v238 offset:5000
ds_read_b64 v[198:199], v239 offset:5000
v_mfma_f32_16x16x32_bf16 v[96:99], v[200:203], v[152:155], v[96:99]
v_fma_mix_f32 v235, v119, v119, v235 op_sel_hi:[1,1,0]
v_pk_mul_f16 v143, v142, v143
v_exp_f16_sdwa v139, v139 dst_sel:WORD_0 dst_unused:UNUSED_PRESERVE src0_sel:WORD_0
v_cvt_pkrtz_f16_f32 v133, v132, v133
v_and_b32_e64 v133, s49, v133
v_bfe_u32 v132, v133, 2, 14
v_lshrrev_b32 v133, 18, v133
v_exp_f16_sdwa v141, v141 dst_sel:WORD_0 dst_unused:UNUSED_PRESERVE src0_sel:WORD_0
v_fma_mix_f32 v235, v120, v120, v235 op_sel_hi:[1,1,0]
s_waitcnt lgkmcnt(13)
ds_read_b128 v[144:147], v212 offset:32
ds_read_b64 v[200:201], v238 offset:400
s_waitcnt lgkmcnt(14)
ds_read_b64 v[202:203], v239 offset:400
v_fma_mix_f32 v235, v121, v121, v235 op_sel_hi:[1,1,0]
s_waitcnt lgkmcnt(13)
v_mfma_f32_16x16x32_bf16 v[48:51], v[204:207], v[152:155], v[48:51]
ds_read_b128 v[148:151], v213 offset:32
v_exp_f16_sdwa v143, v143 dst_sel:WORD_0 dst_unused:UNUSED_PRESERVE src0_sel:WORD_0
v_mfma_f32_16x16x32_bf16 v[96:99], v[204:207], v[156:159], v[96:99]
ds_read_b128 v[152:155], v214 offset:32
s_waitcnt lgkmcnt(14)
ds_read_b64 v[204:205], v238 offset:2800
s_waitcnt lgkmcnt(13)
v_mfma_f32_16x16x32_bf16 v[52:55], v[208:211], v[160:163], 0
ds_read_b64 v[206:207], v239 offset:2800
v_cvt_pkrtz_f16_f32 v135, v134, v135
s_waitcnt lgkmcnt(13)
v_mfma_f32_16x16x32_bf16 v[100:103], v[208:211], v[164:167], 0
ds_read_b128 v[156:159], v215 offset:32
v_and_b32 v135, s49, v135
v_bfe_u32 v134, v135, 2, 14
v_lshrrev_b32 v135, 18, v135
v_exp_f16_sdwa v139, v139 dst_sel:WORD_1 dst_unused:UNUSED_PRESERVE src0_sel:WORD_1
s_waitcnt lgkmcnt(11)
v_mfma_f32_16x16x32_bf16 v[52:55], v[192:195], v[164:167], v[52:55]
ds_read_b64 v[208:209], v238 offset:5200
ds_read_b64 v[210:211], v239 offset:5200
v_mfma_f32_16x16x32_bf16 v[100:103], v[192:195], v[168:171], v[100:103]
ds_read_b128 v[160:163], v212 offset:48
ds_read_b64 v[192:193], v238 offset:600
s_waitcnt lgkmcnt(14)
ds_read_b64 v[194:195], v239 offset:600
s_waitcnt lgkmcnt(13)
v_mfma_f32_16x16x32_bf16 v[52:55], v[196:199], v[168:171], v[52:55]
ds_read_u16 v128, v128
v_fma_mix_f32 v235, v122, v122, v235 op_sel_hi:[1,1,0]
v_mfma_f32_16x16x32_bf16 v[100:103], v[196:199], v[172:175], v[100:103]
ds_read_u16 v129, v129
s_waitcnt lgkmcnt(14)
ds_read_b128 v[164:167], v213 offset:48
v_fma_mix_f32 v235, v123, v123, v235 op_sel_hi:[1,1,0]
s_waitcnt lgkmcnt(13)
v_mfma_f32_16x16x32_bf16 v[56:59], v[200:203], v[144:147], 0
ds_read_b128 v[168:171], v214 offset:48
v_exp_f16_sdwa v141, v141 dst_sel:WORD_1 dst_unused:UNUSED_PRESERVE src0_sel:WORD_1
s_waitcnt lgkmcnt(13)
v_mfma_f32_16x16x32_bf16 v[104:107], v[200:203], v[148:151], 0
ds_read_b64 v[196:197], v238 offset:3000
v_exp_f16_sdwa v143, v143 dst_sel:WORD_1 dst_unused:UNUSED_PRESERVE src0_sel:WORD_1
v_cvt_pkrtz_f16_f32 v137, v136, v137
v_and_b32_e64 v137, s49, v137
v_bfe_u32 v136, v137, 2, 14
s_waitcnt lgkmcnt(11)
v_mfma_f32_16x16x32_bf16 v[56:59], v[204:207], v[148:151], v[56:59]
ds_read_b64 v[198:199], v239 offset:3000
ds_read_b128 v[172:175], v215 offset:48
ds_read_u16 v130, v130
ds_read_u16 v131, v131
v_mfma_f32_16x16x32_bf16 v[104:107], v[204:207], v[152:155], v[104:107]
s_waitcnt lgkmcnt(14)
ds_read_b64 v[200:201], v238 offset:5400
s_waitcnt lgkmcnt(14)
ds_read_b64 v[202:203], v239 offset:5400
s_waitcnt lgkmcnt(14)
v_mfma_f32_16x16x32_bf16 v[56:59], v[208:211], v[152:155], v[56:59]
v_lshrrev_b32_e64 v137, 18, v137
v_pk_add_f16 v139, v139, 1.0 op_sel_hi:[1,0]
v_mfma_f32_16x16x32_bf16 v[104:107], v[208:211], v[156:159], v[104:107]
ds_read_b128 v[144:147], v212 offset:64
s_waitcnt lgkmcnt(14)
ds_read_b64 v[204:205], v238 offset:800
s_waitcnt lgkmcnt(14)
ds_read_b64 v[206:207], v239 offset:800
s_waitcnt lgkmcnt(14)
v_mfma_f32_16x16x32_bf16 v[60:63], v[192:195], v[160:163], 0
v_pk_add_f16 v141, v141, 1.0 op_sel_hi:[1,0]
v_pk_add_f16 v143, v143, 1.0 op_sel_hi:[1,0]
v_rcp_f16_sdwa v139, v139 dst_sel:WORD_0 dst_unused:UNUSED_PRESERVE src0_sel:WORD_0
v_rcp_f16_sdwa v141, v141 dst_sel:WORD_0 dst_unused:UNUSED_PRESERVE src0_sel:WORD_0
v_rcp_f16_sdwa v143, v143 dst_sel:WORD_0 dst_unused:UNUSED_PRESERVE src0_sel:WORD_0
v_rcp_f16_sdwa v139, v139 dst_sel:WORD_1 dst_unused:UNUSED_PRESERVE src0_sel:WORD_1
v_rcp_f16_sdwa v141, v141 dst_sel:WORD_1 dst_unused:UNUSED_PRESERVE src0_sel:WORD_1
v_rcp_f16_sdwa v143, v143 dst_sel:WORD_1 dst_unused:UNUSED_PRESERVE src0_sel:WORD_1
s_waitcnt lgkmcnt(11)
v_mfma_f32_16x16x32_bf16 v[108:111], v[192:195], v[164:167], 0
ds_read_u16 v132, v132
ds_read_u16 v133, v133
ds_read_b128 v[148:151], v213 offset:64
ds_read_b128 v[152:155], v214 offset:64
v_pk_mul_f16 v138, v138, v139
v_pk_mul_f16 v140, v140, v141
v_pk_mul_f16 v142, v142, v143
s_waitcnt lgkmcnt(12)
v_mfma_f32_16x16x32_bf16 v[60:63], v[196:199], v[164:167], v[60:63]
ds_read_b64 v[208:209], v238 offset:3200
ds_read_b64 v[210:211], v239 offset:3200
v_mfma_f32_16x16x32_bf16 v[108:111], v[196:199], v[168:171], v[108:111]
ds_read_b128 v[156:159], v215 offset:64
v_fma_mix_f32 v235, v138, v138, v235 op_sel_hi:[1,1,0]
s_nop 0
v_fma_mix_f32 v235, v140, v140, v235 op_sel_hi:[1,1,0]
s_nop 0
v_fma_mix_f32 v235, v142, v142, v235 op_sel_hi:[1,1,0]
s_nop 0
v_fma_mix_f32 v235, v138, v138, v235 op_sel:[1,1,0] op_sel_hi:[1,1,0]
s_waitcnt lgkmcnt(14)
ds_read_u16 v134, v134
v_fma_mix_f32 v235, v140, v140, v235 op_sel:[1,1,0] op_sel_hi:[1,1,0]
s_nop 0
v_fma_mix_f32 v235, v142, v142, v235 op_sel:[1,1,0] op_sel_hi:[1,1,0]
s_nop 0
v_fma_mix_f32 v235, v128, v128, v235 op_sel_hi:[1,1,0]
s_nop 0
v_fma_mix_f32 v235, v129, v129, v235 op_sel_hi:[1,1,0]
s_waitcnt lgkmcnt(14)
ds_read_u16 v135, v135
v_fma_mix_f32 v235, v130, v130, v235 op_sel_hi:[1,1,0]
s_waitcnt lgkmcnt(14)
ds_read_b64 v[192:193], v238 offset:5600
v_fma_mix_f32 v235, v131, v131, v235 op_sel_hi:[1,1,0]
s_waitcnt lgkmcnt(13)
v_mfma_f32_16x16x32_bf16 v[60:63], v[200:203], v[168:171], v[60:63]
ds_read_b64 v[194:195], v239 offset:5600
v_mfma_f32_16x16x32_bf16 v[108:111], v[200:203], v[172:175], v[108:111]
ds_read_b128 v[160:163], v212 offset:80
s_waitcnt lgkmcnt(14)
ds_read_b64 v[196:197], v238 offset:1000
s_waitcnt lgkmcnt(14)
ds_read_b64 v[198:199], v239 offset:1000
s_waitcnt lgkmcnt(14)
v_mfma_f32_16x16x32_bf16 v[64:67], v[204:207], v[144:147], 0
ds_read_u16 v136, v136
s_waitcnt lgkmcnt(14)
v_fma_mix_f32 v235, v132, v132, v235 op_sel_hi:[1,1,0]
s_waitcnt lgkmcnt(13)
v_fma_mix_f32 v235, v133, v133, v235 op_sel_hi:[1,1,0]
ds_read_u16 v137, v137
ds_read_b128 v[164:167], v213 offset:80
s_waitcnt lgkmcnt(14)
v_mfma_f32_16x16x32_bf16 v[112:115], v[204:207], v[148:151], 0
ds_read_b128 v[168:171], v214 offset:80
s_waitcnt lgkmcnt(14)
ds_read_b64 v[200:201], v238 offset:3400
s_waitcnt lgkmcnt(14)
ds_read_b64 v[202:203], v239 offset:3400
s_waitcnt lgkmcnt(14)
v_mfma_f32_16x16x32_bf16 v[64:67], v[208:211], v[148:151], v[64:67]
ds_read_b128 v[172:175], v215 offset:80
v_mfma_f32_16x16x32_bf16 v[112:115], v[208:211], v[152:155], v[112:115]
s_waitcnt lgkmcnt(14)
ds_read_b64 v[204:205], v238 offset:5800
s_waitcnt lgkmcnt(14)
v_fma_mix_f32 v235, v134, v134, v235 op_sel_hi:[1,1,0]
s_waitcnt lgkmcnt(13)
v_fma_mix_f32 v235, v135, v135, v235 op_sel_hi:[1,1,0]
ds_read_b64 v[206:207], v239 offset:5800
ds_read_b128 v[144:147], v212 offset:96
s_waitcnt lgkmcnt(13)
v_mfma_f32_16x16x32_bf16 v[64:67], v[192:195], v[152:155], v[64:67]
ds_read_b64 v[208:209], v238 offset:1200
v_mfma_f32_16x16x32_bf16 v[112:115], v[192:195], v[156:159], v[112:115]
ds_read_b64 v[210:211], v239 offset:1200
s_waitcnt lgkmcnt(14)
ds_read_b128 v[148:151], v213 offset:96
s_waitcnt lgkmcnt(13)
v_mfma_f32_16x16x32_bf16 v[68:71], v[196:199], v[160:163], 0
ds_read_b128 v[152:155], v214 offset:96
ds_read_b64 v[192:193], v238 offset:3600
s_waitcnt lgkmcnt(14)
v_fma_mix_f32 v235, v136, v136, v235 op_sel_hi:[1,1,0]
s_waitcnt lgkmcnt(13)
v_fma_mix_f32 v235, v137, v137, v235 op_sel_hi:[1,1,0]
ds_read_b64 v[194:195], v239 offset:3600
s_waitcnt lgkmcnt(13)
v_mfma_f32_16x16x32_bf16 v[116:119], v[196:199], v[164:167], 0
ds_read_b128 v[156:159], v215 offset:96
ds_read_b64 v[196:197], v238 offset:6000
s_waitcnt lgkmcnt(14)
ds_read_b64 v[198:199], v239 offset:6000
s_waitcnt lgkmcnt(13)
v_mfma_f32_16x16x32_bf16 v[68:71], v[200:203], v[164:167], v[68:71]
ds_read_b128 v[160:163], v212 offset:112
v_mfma_f32_16x16x32_bf16 v[116:119], v[200:203], v[168:171], v[116:119]
ds_read_b64 v[200:201], v238 offset:1400
s_waitcnt lgkmcnt(14)
ds_read_b64 v[202:203], v239 offset:1400
s_waitcnt lgkmcnt(13)
v_mfma_f32_16x16x32_bf16 v[68:71], v[204:207], v[168:171], v[68:71]
ds_read_b128 v[164:167], v213 offset:112
v_mfma_f32_16x16x32_bf16 v[116:119], v[204:207], v[172:175], v[116:119]
ds_read_b128 v[168:171], v214 offset:112
s_waitcnt lgkmcnt(14)
ds_read_b64 v[204:205], v238 offset:3800
s_waitcnt lgkmcnt(13)
v_mfma_f32_16x16x32_bf16 v[72:75], v[208:211], v[144:147], 0
ds_read_b64 v[206:207], v239 offset:3800
s_waitcnt lgkmcnt(13)
v_mfma_f32_16x16x32_bf16 v[120:123], v[208:211], v[148:151], 0
ds_read_b128 v[172:175], v215 offset:112
ds_read_b64 v[208:209], v238 offset:6200
s_waitcnt lgkmcnt(14)
ds_read_b64 v[210:211], v239 offset:6200
s_waitcnt lgkmcnt(13)
v_mfma_f32_16x16x32_bf16 v[72:75], v[192:195], v[148:151], v[72:75]
ds_read_b128 v[144:147], v212 offset:128
v_mfma_f32_16x16x32_bf16 v[120:123], v[192:195], v[152:155], v[120:123]
ds_read_b64 v[192:193], v238 offset:1600
s_waitcnt lgkmcnt(14)
ds_read_b64 v[194:195], v239 offset:1600
s_waitcnt lgkmcnt(13)
v_mfma_f32_16x16x32_bf16 v[72:75], v[196:199], v[152:155], v[72:75]
ds_read_b128 v[148:151], v213 offset:128
v_mfma_f32_16x16x32_bf16 v[120:123], v[196:199], v[156:159], v[120:123]
ds_read_b128 v[152:155], v214 offset:128
s_waitcnt lgkmcnt(14)
ds_read_b64 v[196:197], v238 offset:4000
s_waitcnt lgkmcnt(13)
v_mfma_f32_16x16x32_bf16 v[76:79], v[200:203], v[160:163], 0
ds_read_b64 v[198:199], v239 offset:4000
s_waitcnt lgkmcnt(13)
v_mfma_f32_16x16x32_bf16 v[124:127], v[200:203], v[164:167], 0
ds_read_b128 v[156:159], v215 offset:128
ds_read_b64 v[200:201], v238 offset:6400
s_waitcnt lgkmcnt(14)
ds_read_b64 v[202:203], v239 offset:6400
s_waitcnt lgkmcnt(13)
v_mfma_f32_16x16x32_bf16 v[76:79], v[204:207], v[164:167], v[76:79]
ds_read_b128 v[160:163], v212 offset:144
v_mfma_f32_16x16x32_bf16 v[124:127], v[204:207], v[168:171], v[124:127]
ds_read_b64 v[204:205], v238 offset:1800
s_waitcnt lgkmcnt(14)
ds_read_b64 v[206:207], v239 offset:1800
s_waitcnt lgkmcnt(13)
v_mfma_f32_16x16x32_bf16 v[76:79], v[208:211], v[168:171], v[76:79]
ds_read_b128 v[164:167], v213 offset:144
v_mfma_f32_16x16x32_bf16 v[124:127], v[208:211], v[172:175], v[124:127]
ds_read_b128 v[168:171], v214 offset:144
s_waitcnt lgkmcnt(14)
ds_read_b64 v[208:209], v238 offset:4200
s_waitcnt lgkmcnt(13)
v_mfma_f32_16x16x32_bf16 v[80:83], v[192:195], v[144:147], 0
ds_read_b64 v[210:211], v239 offset:4200
s_waitcnt lgkmcnt(13)
v_mfma_f32_16x16x32_bf16 v[128:131], v[192:195], v[148:151], 0
ds_read_b128 v[172:175], v215 offset:144
ds_read_b64 v[192:193], v238 offset:6600
s_waitcnt lgkmcnt(14)
ds_read_b64 v[194:195], v239 offset:6600
s_waitcnt lgkmcnt(13)
v_mfma_f32_16x16x32_bf16 v[80:83], v[196:199], v[148:151], v[80:83]
ds_read_b128 v[144:147], v212 offset:160
v_mfma_f32_16x16x32_bf16 v[128:131], v[196:199], v[152:155], v[128:131]
ds_read_b64 v[196:197], v238 offset:2000
s_waitcnt lgkmcnt(14)
ds_read_b64 v[198:199], v239 offset:2000
s_waitcnt lgkmcnt(13)
v_mfma_f32_16x16x32_bf16 v[80:83], v[200:203], v[152:155], v[80:83]
ds_read_b128 v[148:151], v213 offset:160
v_mfma_f32_16x16x32_bf16 v[128:131], v[200:203], v[156:159], v[128:131]
ds_read_b128 v[152:155], v214 offset:160
s_waitcnt lgkmcnt(14)
ds_read_b64 v[200:201], v238 offset:4400
s_waitcnt lgkmcnt(13)
v_mfma_f32_16x16x32_bf16 v[84:87], v[204:207], v[160:163], 0
ds_read_b64 v[202:203], v239 offset:4400
s_waitcnt lgkmcnt(13)
v_mfma_f32_16x16x32_bf16 v[132:135], v[204:207], v[164:167], 0
ds_read_b128 v[156:159], v215 offset:160
ds_read_b64 v[204:205], v238 offset:6800
s_waitcnt lgkmcnt(14)
ds_read_b64 v[206:207], v239 offset:6800
s_waitcnt lgkmcnt(13)
v_mfma_f32_16x16x32_bf16 v[84:87], v[208:211], v[164:167], v[84:87]
ds_read_b128 v[160:163], v212 offset:176
v_mfma_f32_16x16x32_bf16 v[132:135], v[208:211], v[168:171], v[132:135]
ds_read_b64 v[208:209], v238 offset:2200
s_waitcnt lgkmcnt(14)
ds_read_b64 v[210:211], v239 offset:2200
s_waitcnt lgkmcnt(13)
v_mfma_f32_16x16x32_bf16 v[84:87], v[192:195], v[168:171], v[84:87]
ds_read_b128 v[164:167], v213 offset:176
v_mfma_f32_16x16x32_bf16 v[132:135], v[192:195], v[172:175], v[132:135]
ds_read_b128 v[168:171], v214 offset:176
s_waitcnt lgkmcnt(14)
ds_read_b64 v[192:193], v238 offset:4600
s_waitcnt lgkmcnt(13)
v_mfma_f32_16x16x32_bf16 v[88:91], v[196:199], v[144:147], 0
ds_read_b64 v[194:195], v239 offset:4600
s_waitcnt lgkmcnt(13)
v_mfma_f32_16x16x32_bf16 v[136:139], v[196:199], v[148:151], 0
ds_read_b128 v[172:175], v215 offset:176
ds_read_b64 v[196:197], v238 offset:7000
s_waitcnt lgkmcnt(14)
ds_read_b64 v[198:199], v239 offset:7000
s_waitcnt lgkmcnt(13)
v_mfma_f32_16x16x32_bf16 v[88:91], v[200:203], v[148:151], v[88:91]
ds_read_b128 v[176:179], v250
v_mfma_f32_16x16x32_bf16 v[136:139], v[200:203], v[152:155], v[136:139]
s_waitcnt lgkmcnt(11)
v_mfma_f32_16x16x32_bf16 v[88:91], v[204:207], v[152:155], v[88:91]
v_mfma_f32_16x16x32_bf16 v[136:139], v[204:207], v[156:159], v[136:139]
s_waitcnt lgkmcnt(8)
v_mfma_f32_16x16x32_bf16 v[92:95], v[208:211], v[160:163], 0
s_waitcnt lgkmcnt(7)
v_mfma_f32_16x16x32_bf16 v[140:143], v[208:211], v[164:167], 0
s_waitcnt lgkmcnt(4)
v_mfma_f32_16x16x32_bf16 v[92:95], v[192:195], v[164:167], v[92:95]
v_mfma_f32_16x16x32_bf16 v[140:143], v[192:195], v[168:171], v[140:143]
s_waitcnt lgkmcnt(1)
v_mfma_f32_16x16x32_bf16 v[92:95], v[196:199], v[168:171], v[92:95]
ds_read_b128 v[180:183], v250 offset:1024
v_mfma_f32_16x16x32_bf16 v[140:143], v[196:199], v[172:175], v[140:143]
v_mov_b32 v223, 1
v_add_u32 v222, s83, v247
s_waitcnt lgkmcnt(0)
s_nop 6
s_mov_b64 exec, 1
ds_add_u32 v222, v223 offset:24
s_mov_b64 exec, -1
v_pk_mul_f32 v[242:243], v[48:49], v[48:49]
v_pk_add_f32 v[240:241], v[48:49], v[50:51]
v_pk_fma_f32 v[242:243], v[50:51], v[50:51], v[242:243]
v_pk_mul_f32 v[218:219], v[96:97], v[96:97]
v_pk_add_f32 v[216:217], v[96:97], v[98:99]
v_pk_fma_f32 v[218:219], v[98:99], v[98:99], v[218:219]
v_pk_fma_f32 v[242:243], v[52:53], v[52:53], v[242:243]
v_pk_add_f32 v[240:241], v[240:241], v[52:53]
v_pk_fma_f32 v[242:243], v[54:55], v[54:55], v[242:243]
v_pk_add_f32 v[240:241], v[240:241], v[54:55]
v_pk_fma_f32 v[218:219], v[100:101], v[100:101], v[218:219]
v_pk_add_f32 v[216:217], v[216:217], v[100:101]
v_pk_fma_f32 v[218:219], v[102:103], v[102:103], v[218:219]
v_pk_add_f32 v[216:217], v[216:217], v[102:103]
v_pk_fma_f32 v[242:243], v[56:57], v[56:57], v[242:243]
v_pk_add_f32 v[240:241], v[240:241], v[56:57]
v_pk_fma_f32 v[242:243], v[58:59], v[58:59], v[242:243]
v_pk_add_f32 v[240:241], v[240:241], v[58:59]
v_pk_fma_f32 v[218:219], v[104:105], v[104:105], v[218:219]
v_pk_add_f32 v[216:217], v[216:217], v[104:105]
v_pk_fma_f32 v[218:219], v[106:107], v[106:107], v[218:219]
v_pk_add_f32 v[216:217], v[216:217], v[106:107]
v_pk_fma_f32 v[242:243], v[60:61], v[60:61], v[242:243]
v_pk_add_f32 v[240:241], v[240:241], v[60:61]
v_pk_fma_f32 v[242:243], v[62:63], v[62:63], v[242:243]
v_pk_add_f32 v[240:241], v[240:241], v[62:63]
v_pk_fma_f32 v[218:219], v[108:109], v[108:109], v[218:219]
v_pk_add_f32 v[216:217], v[216:217], v[108:109]
v_pk_fma_f32 v[218:219], v[110:111], v[110:111], v[218:219]
v_pk_add_f32 v[216:217], v[216:217], v[110:111]
v_pk_fma_f32 v[242:243], v[64:65], v[64:65], v[242:243]
v_pk_add_f32 v[240:241], v[240:241], v[64:65]
v_pk_fma_f32 v[242:243], v[66:67], v[66:67], v[242:243]
v_pk_add_f32 v[240:241], v[240:241], v[66:67]
v_pk_fma_f32 v[218:219], v[112:113], v[112:113], v[218:219]
v_pk_add_f32 v[216:217], v[216:217], v[112:113]
v_pk_fma_f32 v[218:219], v[114:115], v[114:115], v[218:219]
v_pk_add_f32 v[216:217], v[216:217], v[114:115]
v_pk_fma_f32 v[242:243], v[68:69], v[68:69], v[242:243]
v_pk_add_f32 v[240:241], v[240:241], v[68:69]
v_pk_fma_f32 v[242:243], v[70:71], v[70:71], v[242:243]
v_pk_add_f32 v[240:241], v[240:241], v[70:71]
v_pk_fma_f32 v[218:219], v[116:117], v[116:117], v[218:219]
v_pk_add_f32 v[216:217], v[216:217], v[116:117]
v_pk_fma_f32 v[218:219], v[118:119], v[118:119], v[218:219]
v_pk_add_f32 v[216:217], v[216:217], v[118:119]
v_pk_fma_f32 v[242:243], v[72:73], v[72:73], v[242:243]
v_pk_add_f32 v[240:241], v[240:241], v[72:73]
v_pk_fma_f32 v[242:243], v[74:75], v[74:75], v[242:243]
v_pk_add_f32 v[240:241], v[240:241], v[74:75]
v_pk_fma_f32 v[218:219], v[120:121], v[120:121], v[218:219]
v_pk_add_f32 v[216:217], v[216:217], v[120:121]
v_pk_fma_f32 v[218:219], v[122:123], v[122:123], v[218:219]
v_pk_add_f32 v[216:217], v[216:217], v[122:123]
v_pk_fma_f32 v[242:243], v[76:77], v[76:77], v[242:243]
v_pk_add_f32 v[240:241], v[240:241], v[76:77]
v_pk_fma_f32 v[242:243], v[78:79], v[78:79], v[242:243]
v_pk_add_f32 v[240:241], v[240:241], v[78:79]
v_pk_fma_f32 v[218:219], v[124:125], v[124:125], v[218:219]
v_pk_add_f32 v[216:217], v[216:217], v[124:125]
v_pk_fma_f32 v[218:219], v[126:127], v[126:127], v[218:219]
v_pk_add_f32 v[216:217], v[216:217], v[126:127]
v_pk_fma_f32 v[242:243], v[80:81], v[80:81], v[242:243]
v_pk_add_f32 v[240:241], v[240:241], v[80:81]
v_pk_fma_f32 v[242:243], v[82:83], v[82:83], v[242:243]
v_pk_add_f32 v[240:241], v[240:241], v[82:83]
v_pk_fma_f32 v[218:219], v[128:129], v[128:129], v[218:219]
v_pk_add_f32 v[216:217], v[216:217], v[128:129]
v_pk_fma_f32 v[218:219], v[130:131], v[130:131], v[218:219]
v_pk_add_f32 v[216:217], v[216:217], v[130:131]
v_pk_fma_f32 v[242:243], v[84:85], v[84:85], v[242:243]
v_pk_add_f32 v[240:241], v[240:241], v[84:85]
v_pk_fma_f32 v[242:243], v[86:87], v[86:87], v[242:243]
v_pk_add_f32 v[240:241], v[240:241], v[86:87]
v_pk_fma_f32 v[218:219], v[132:133], v[132:133], v[218:219]
v_pk_add_f32 v[216:217], v[216:217], v[132:133]
v_pk_fma_f32 v[218:219], v[134:135], v[134:135], v[218:219]
v_pk_add_f32 v[216:217], v[216:217], v[134:135]
v_pk_fma_f32 v[242:243], v[88:89], v[88:89], v[242:243]
v_pk_add_f32 v[240:241], v[240:241], v[88:89]
v_pk_fma_f32 v[242:243], v[90:91], v[90:91], v[242:243]
v_pk_add_f32 v[240:241], v[240:241], v[90:91]
v_pk_fma_f32 v[218:219], v[136:137], v[136:137], v[218:219]
v_pk_add_f32 v[216:217], v[216:217], v[136:137]
v_pk_fma_f32 v[218:219], v[138:139], v[138:139], v[218:219]
v_pk_add_f32 v[216:217], v[216:217], v[138:139]
v_pk_fma_f32 v[242:243], v[92:93], v[92:93], v[242:243]
v_pk_add_f32 v[240:241], v[240:241], v[92:93]
v_pk_fma_f32 v[242:243], v[94:95], v[94:95], v[242:243]
v_pk_add_f32 v[240:241], v[240:241], v[94:95]
v_pk_fma_f32 v[218:219], v[140:141], v[140:141], v[218:219]
v_pk_add_f32 v[216:217], v[216:217], v[140:141]
v_pk_fma_f32 v[218:219], v[142:143], v[142:143], v[218:219]
v_pk_add_f32 v[216:217], v[216:217], v[142:143]
v_add_f32 v218, v218, v219
v_add_f32 v216, v216, v217
s_nop 1
v_permlane32_swap_b32 v216, v218
v_add_f32_e64 v216, v216, v218
v_mul_f32 v216, 1009429163, v216
v_mov_b32_e64 v218, v216
s_nop 1
v_permlane32_swap_b32 v216, v218
v_fma_f32 v218, -v216, v216, v218
v_max_f32_e64 v218, 0, v218
v_add_f32 v218, 925353388, v218
v_rsq_f32 v218, v218
v_add_f32 v240, v240, v241
v_mul_f32 v220, 3203396952, v218
v_mul_f32 v221, 3203396952, v218
v_mul_f32 v218, v216, v220
v_mul_f32 v219, v216, v220
v_add_f32 v242, v242, v243
s_nop 1
v_permlane32_swap_b32 v240, v242
v_add_f32 v240, v240, v242
v_mul_f32 v240, 1009429163, v240
v_mov_b32_e64 v242, v240
s_nop 1
v_permlane32_swap_b32 v240, v242
v_fma_f32 v242, -v240, v240, v242
v_max_f32_e64 v242, 0, v242
v_add_f32 v242, 925353388, v242
v_rsq_f32_e64 v242, v242
v_pk_fma_f32 v[96:97], v[96:97], v[220:221], v[218:219] neg_lo:[0,0,1] neg_hi:[0,0,1]
v_mul_f32 v244, 3203396952, v242
v_mul_f32 v245, 3203396952, v242
v_mul_f32 v242, v240, v244
v_mul_f32 v243, v240, v244
v_pk_fma_f32 v[48:49], v[48:49], v[244:245], v[242:243] neg_lo:[0,0,1] neg_hi:[0,0,1]
v_pk_fma_f32 v[50:51], v[50:51], v[244:245], v[242:243] neg_lo:[0,0,1] neg_hi:[0,0,1]
v_cvt_pk_bf16_f32 v48, v48, v49
v_cvt_pk_bf16_f32 v49, v50, v51
v_pk_fma_f32 v[52:53], v[52:53], v[244:245], v[242:243] neg_lo:[0,0,1] neg_hi:[0,0,1]
v_pk_fma_f32 v[54:55], v[54:55], v[244:245], v[242:243] neg_lo:[0,0,1] neg_hi:[0,0,1]
v_cvt_pk_bf16_f32 v50, v52, v53
v_cvt_pk_bf16_f32 v51, v54, v55
v_pk_fma_f32 v[56:57], v[56:57], v[244:245], v[242:243] neg_lo:[0,0,1] neg_hi:[0,0,1]
v_pk_fma_f32 v[58:59], v[58:59], v[244:245], v[242:243] neg_lo:[0,0,1] neg_hi:[0,0,1]
v_cvt_pk_bf16_f32 v52, v56, v57
v_cvt_pk_bf16_f32 v53, v58, v59
v_pk_fma_f32 v[60:61], v[60:61], v[244:245], v[242:243] neg_lo:[0,0,1] neg_hi:[0,0,1]
v_pk_fma_f32 v[62:63], v[62:63], v[244:245], v[242:243] neg_lo:[0,0,1] neg_hi:[0,0,1]
v_cvt_pk_bf16_f32 v54, v60, v61
v_cvt_pk_bf16_f32 v55, v62, v63
v_pk_fma_f32 v[64:65], v[64:65], v[244:245], v[242:243] neg_lo:[0,0,1] neg_hi:[0,0,1]
v_pk_fma_f32 v[66:67], v[66:67], v[244:245], v[242:243] neg_lo:[0,0,1] neg_hi:[0,0,1]
v_cvt_pk_bf16_f32 v56, v64, v65
v_cvt_pk_bf16_f32 v57, v66, v67
v_pk_fma_f32 v[68:69], v[68:69], v[244:245], v[242:243] neg_lo:[0,0,1] neg_hi:[0,0,1]
v_pk_fma_f32 v[70:71], v[70:71], v[244:245], v[242:243] neg_lo:[0,0,1] neg_hi:[0,0,1]
v_cvt_pk_bf16_f32 v58, v68, v69
v_cvt_pk_bf16_f32 v59, v70, v71
v_pk_fma_f32 v[72:73], v[72:73], v[244:245], v[242:243] neg_lo:[0,0,1] neg_hi:[0,0,1]
v_pk_fma_f32 v[74:75], v[74:75], v[244:245], v[242:243] neg_lo:[0,0,1] neg_hi:[0,0,1]
v_cvt_pk_bf16_f32 v60, v72, v73
v_cvt_pk_bf16_f32 v61, v74, v75
v_pk_fma_f32 v[76:77], v[76:77], v[244:245], v[242:243] neg_lo:[0,0,1] neg_hi:[0,0,1]
v_pk_fma_f32 v[78:79], v[78:79], v[244:245], v[242:243] neg_lo:[0,0,1] neg_hi:[0,0,1]
v_cvt_pk_bf16_f32 v62, v76, v77
v_cvt_pk_bf16_f32 v63, v78, v79
v_pk_fma_f32 v[80:81], v[80:81], v[244:245], v[242:243] neg_lo:[0,0,1] neg_hi:[0,0,1]
v_pk_fma_f32 v[82:83], v[82:83], v[244:245], v[242:243] neg_lo:[0,0,1] neg_hi:[0,0,1]
v_cvt_pk_bf16_f32 v64, v80, v81
v_cvt_pk_bf16_f32 v65, v82, v83
v_pk_fma_f32 v[84:85], v[84:85], v[244:245], v[242:243] neg_lo:[0,0,1] neg_hi:[0,0,1]
v_pk_fma_f32 v[86:87], v[86:87], v[244:245], v[242:243] neg_lo:[0,0,1] neg_hi:[0,0,1]
v_cvt_pk_bf16_f32 v66, v84, v85
v_cvt_pk_bf16_f32 v67, v86, v87
v_pk_fma_f32 v[88:89], v[88:89], v[244:245], v[242:243] neg_lo:[0,0,1] neg_hi:[0,0,1]
v_pk_fma_f32 v[90:91], v[90:91], v[244:245], v[242:243] neg_lo:[0,0,1] neg_hi:[0,0,1]
v_cvt_pk_bf16_f32 v68, v88, v89
v_cvt_pk_bf16_f32 v69, v90, v91
v_pk_fma_f32 v[92:93], v[92:93], v[244:245], v[242:243] neg_lo:[0,0,1] neg_hi:[0,0,1]
v_pk_fma_f32 v[94:95], v[94:95], v[244:245], v[242:243] neg_lo:[0,0,1] neg_hi:[0,0,1]
v_cvt_pk_bf16_f32 v70, v92, v93
v_cvt_pk_bf16_f32 v71, v94, v95
v_cvt_pk_bf16_f32 v72, v96, v97
v_pk_fma_f32 v[98:99], v[98:99], v[220:221], v[218:219] neg_lo:[0,0,1] neg_hi:[0,0,1]
v_pk_fma_f32 v[100:101], v[100:101], v[220:221], v[218:219] neg_lo:[0,0,1] neg_hi:[0,0,1]
v_cvt_pk_bf16_f32 v73, v98, v99
v_cvt_pk_bf16_f32 v74, v100, v101
v_pk_fma_f32 v[102:103], v[102:103], v[220:221], v[218:219] neg_lo:[0,0,1] neg_hi:[0,0,1]
v_pk_fma_f32 v[104:105], v[104:105], v[220:221], v[218:219] neg_lo:[0,0,1] neg_hi:[0,0,1]
v_cvt_pk_bf16_f32 v75, v102, v103
v_cvt_pk_bf16_f32 v76, v104, v105
v_pk_fma_f32 v[106:107], v[106:107], v[220:221], v[218:219] neg_lo:[0,0,1] neg_hi:[0,0,1]
v_pk_fma_f32 v[108:109], v[108:109], v[220:221], v[218:219] neg_lo:[0,0,1] neg_hi:[0,0,1]
v_cvt_pk_bf16_f32 v77, v106, v107
v_cvt_pk_bf16_f32 v78, v108, v109
v_pk_fma_f32 v[110:111], v[110:111], v[220:221], v[218:219] neg_lo:[0,0,1] neg_hi:[0,0,1]
v_pk_fma_f32 v[112:113], v[112:113], v[220:221], v[218:219] neg_lo:[0,0,1] neg_hi:[0,0,1]
v_cvt_pk_bf16_f32 v79, v110, v111
v_cvt_pk_bf16_f32 v80, v112, v113
v_pk_fma_f32 v[114:115], v[114:115], v[220:221], v[218:219] neg_lo:[0,0,1] neg_hi:[0,0,1]
v_pk_fma_f32 v[116:117], v[116:117], v[220:221], v[218:219] neg_lo:[0,0,1] neg_hi:[0,0,1]
v_cvt_pk_bf16_f32 v81, v114, v115
v_cvt_pk_bf16_f32 v82, v116, v117
v_pk_fma_f32 v[118:119], v[118:119], v[220:221], v[218:219] neg_lo:[0,0,1] neg_hi:[0,0,1]
v_pk_fma_f32 v[120:121], v[120:121], v[220:221], v[218:219] neg_lo:[0,0,1] neg_hi:[0,0,1]
v_cvt_pk_bf16_f32 v83, v118, v119
v_cvt_pk_bf16_f32 v84, v120, v121
v_pk_fma_f32 v[122:123], v[122:123], v[220:221], v[218:219] neg_lo:[0,0,1] neg_hi:[0,0,1]
v_pk_fma_f32 v[124:125], v[124:125], v[220:221], v[218:219] neg_lo:[0,0,1] neg_hi:[0,0,1]
v_cvt_pk_bf16_f32 v85, v122, v123
v_cvt_pk_bf16_f32 v86, v124, v125
v_pk_fma_f32 v[126:127], v[126:127], v[220:221], v[218:219] neg_lo:[0,0,1] neg_hi:[0,0,1]
v_pk_fma_f32 v[128:129], v[128:129], v[220:221], v[218:219] neg_lo:[0,0,1] neg_hi:[0,0,1]
v_cvt_pk_bf16_f32 v87, v126, v127
v_cvt_pk_bf16_f32 v88, v128, v129
v_pk_fma_f32 v[130:131], v[130:131], v[220:221], v[218:219] neg_lo:[0,0,1] neg_hi:[0,0,1]
v_pk_fma_f32 v[132:133], v[132:133], v[220:221], v[218:219] neg_lo:[0,0,1] neg_hi:[0,0,1]
v_cvt_pk_bf16_f32 v89, v130, v131
v_cvt_pk_bf16_f32 v90, v132, v133
v_pk_fma_f32 v[134:135], v[134:135], v[220:221], v[218:219] neg_lo:[0,0,1] neg_hi:[0,0,1]
v_pk_fma_f32 v[136:137], v[136:137], v[220:221], v[218:219] neg_lo:[0,0,1] neg_hi:[0,0,1]
v_cvt_pk_bf16_f32 v91, v134, v135
v_cvt_pk_bf16_f32 v92, v136, v137
v_pk_fma_f32 v[138:139], v[138:139], v[220:221], v[218:219] neg_lo:[0,0,1] neg_hi:[0,0,1]
v_pk_fma_f32 v[140:141], v[140:141], v[220:221], v[218:219] neg_lo:[0,0,1] neg_hi:[0,0,1]
v_cvt_pk_bf16_f32 v93, v138, v139
v_cvt_pk_bf16_f32 v94, v140, v141
v_pk_fma_f32 v[142:143], v[142:143], v[220:221], v[218:219] neg_lo:[0,0,1] neg_hi:[0,0,1]
ds_read_b128 v[184:187], v250 offset:2048
v_cvt_pk_bf16_f32 v95, v142, v143
v_cndmask_b32 v216, 0, v255, s[50:51]
v_and_b32 v216, 1006648320, v216
v_cndmask_b32 v217, 0, v255, s[52:53]
v_and_b32 v217, 1006648320, v217
v_cndmask_b32 v218, 0, v255, s[54:55]
v_and_b32 v218, 1006648320, v218
v_cndmask_b32 v219, 0, v255, s[56:57]
v_and_b32 v219, 1006648320, v219
v_cndmask_b32 v220, 0, v255, s[58:59]
v_and_b32 v220, 1006648320, v220
v_cndmask_b32 v221, 0, v255, s[60:61]
v_and_b32 v221, 1006648320, v221
v_cndmask_b32 v222, 0, v255, s[62:63]
v_and_b32 v222, 1006648320, v222
v_cndmask_b32 v223, 0, v255, s[64:65]
v_and_b32 v223, 1006648320, v223
v_mfma_f32_32x32x16_bf16 v[144:159], v[48:51], v[176:179], 0
s_cmp_lt_u32 s40, 4
s_cbranch_scc0 Lbk
s_setprio 2
Lbk:
ds_read_b128 v[188:191], v250 offset:3072
v_mfma_f32_32x32x16_bf16 v[160:175], v[72:75], v[176:179], 0
ds_read_b128 v[176:179], v250 offset:4096
v_mfma_f32_32x32x16_bf16 v[144:159], v[52:55], v[180:183], v[144:159]
v_mfma_f32_32x32x16_bf16 v[160:175], v[76:79], v[180:183], v[160:175]
ds_read_b128 v[180:183], v250 offset:5120
s_waitcnt lgkmcnt(3)
v_mfma_f32_32x32x16_bf16 v[144:159], v[56:59], v[184:187], v[144:159]
v_mfma_f32_32x32x16_bf16 v[160:175], v[80:83], v[184:187], v[160:175]
ds_read_b128 v[184:187], v250 offset:6144
s_waitcnt lgkmcnt(2)
v_mfma_f32_32x32x16_bf16 v[144:159], v[60:63], v[188:191], v[144:159]
v_mfma_f32_32x32x16_bf16 v[160:175], v[84:87], v[188:191], v[160:175]
ds_read_b128 v[188:191], v250 offset:7168
v_mfma_f32_32x32x16_bf16 v[144:159], v[64:67], v[176:179], v[144:159]
v_mfma_f32_32x32x16_bf16 v[160:175], v[88:91], v[176:179], v[160:175]
ds_read_b128 v[176:179], v250 offset:8192
s_waitcnt lgkmcnt(2)
v_mfma_f32_32x32x16_bf16 v[144:159], v[68:71], v[180:183], v[144:159]
v_mfma_f32_32x32x16_bf16 v[160:175], v[92:95], v[180:183], v[160:175]
ds_read_b128 v[180:183], v250 offset:9216
s_nop 9
v_cvt_pkrtz_f16_f32 v145, v144, v145
v_mfma_f32_32x32x16_bf16 v[112:127], v[48:51], v[184:187], 0
v_and_b32 v145, s49, v145
v_bfe_u32 v144, v145, 2, 14
v_lshrrev_b32_e64 v145, 18, v145
v_cvt_pk_f16_f32 v156, v156, v157
v_cvt_pk_f16_f32 v158, v158, v159
v_mfma_f32_32x32x16_bf16 v[128:143], v[72:75], v[184:187], 0
ds_read_u16 v144, v144
ds_read_u16 v145, v145
v_pk_fma_f16 v157, v156, v156, s48
v_cvt_pkrtz_f16_f32 v147, v146, v147
v_and_b32_e64 v147, s49, v147
v_bfe_u32 v146, v147, 2, 14
v_lshrrev_b32_e64 v147, 18, v147
v_pk_fma_f16 v159, v158, v158, s48
v_pk_mul_f16 v157, v156, v157
v_pk_mul_f16 v159, v158, v159
v_cvt_pkrtz_f16_f32 v149, v148, v149
v_and_b32_e64 v149, s49, v149
v_bfe_u32 v148, v149, 2, 14
ds_read_u16 v146, v146
ds_read_u16 v147, v147
v_lshrrev_b32 v149, 18, v149
v_exp_f16_sdwa v157, v157 dst_sel:WORD_0 dst_unused:UNUSED_PRESERVE src0_sel:WORD_0
s_waitcnt lgkmcnt(4)
v_mfma_f32_32x32x16_bf16 v[112:127], v[52:55], v[188:191], v[112:127]
ds_read_u16 v148, v148
ds_read_u16 v149, v149
v_exp_f16_sdwa v159, v159 dst_sel:WORD_0 dst_unused:UNUSED_PRESERVE src0_sel:WORD_0
v_cvt_pkrtz_f16_f32 v151, v150, v151
v_and_b32_e64 v151, s49, v151
v_bfe_u32 v150, v151, 2, 14
v_lshrrev_b32_e64 v151, 18, v151
v_exp_f16_sdwa v157, v157 dst_sel:WORD_1 dst_unused:UNUSED_PRESERVE src0_sel:WORD_1
v_cvt_pkrtz_f16_f32 v153, v152, v153
v_and_b32_e64 v153, s49, v153
v_bfe_u32 v152, v153, 2, 14
v_lshrrev_b32_e64 v153, 18, v153
v_mfma_f32_32x32x16_bf16 v[128:143], v[76:79], v[188:191], v[128:143]
ds_read_u16 v150, v150
ds_read_u16 v151, v151
ds_read_u16 v152, v152
ds_read_u16 v153, v153
v_exp_f16_sdwa v159, v159 dst_sel:WORD_1 dst_unused:UNUSED_PRESERVE src0_sel:WORD_1
v_cvt_pkrtz_f16_f32 v155, v154, v155
v_and_b32_e64 v155, s49, v155
v_bfe_u32 v154, v155, 2, 14
v_lshrrev_b32_e64 v155, 18, v155
v_pk_add_f16 v157, v157, 1.0 op_sel_hi:[1,0]
v_pk_add_f16 v159, v159, 1.0 op_sel_hi:[1,0]
ds_read_b128 v[184:187], v250 offset:10240
ds_read_u16 v154, v154
ds_read_u16 v155, v155
v_rcp_f16_sdwa v157, v157 dst_sel:WORD_0 dst_unused:UNUSED_PRESERVE src0_sel:WORD_0
v_mfma_f32_32x32x16_bf16 v[112:127], v[56:59], v[176:179], v[112:127]
v_rcp_f16_sdwa v159, v159 dst_sel:WORD_0 dst_unused:UNUSED_PRESERVE src0_sel:WORD_0
v_rcp_f16_sdwa v157, v157 dst_sel:WORD_1 dst_unused:UNUSED_PRESERVE src0_sel:WORD_1
v_rcp_f16_sdwa v159, v159 dst_sel:WORD_1 dst_unused:UNUSED_PRESERVE src0_sel:WORD_1
v_mfma_f32_32x32x16_bf16 v[128:143], v[80:83], v[176:179], v[128:143]
ds_read_b128 v[188:191], v250 offset:11264
v_pk_mul_f16 v156, v156, v157
v_pk_mul_f16 v158, v158, v159
v_fma_mix_f32 v224, v156, v156, v224 op_sel_hi:[1,1,0]
v_cvt_pkrtz_f16_f32 v161, v160, v161
v_fma_mix_f32 v224, v158, v158, v224 op_sel_hi:[1,1,0]
v_mfma_f32_32x32x16_bf16 v[112:127], v[60:63], v[180:183], v[112:127]
v_fma_mix_f32 v224, v156, v156, v224 op_sel:[1,1,0] op_sel_hi:[1,1,0]
v_and_b32_e64 v161, s49, v161
v_fma_mix_f32 v224, v158, v158, v224 op_sel:[1,1,0] op_sel_hi:[1,1,0]
v_bfe_u32 v160, v161, 2, 14
s_waitcnt lgkmcnt(7)
v_fma_mix_f32 v224, v144, v144, v224 op_sel_hi:[1,1,0]
v_lshrrev_b32 v161, 18, v161
v_fma_mix_f32 v224, v145, v145, v224 op_sel_hi:[1,1,0]
v_cvt_pk_f16_f32 v170, v170, v171
v_fma_mix_f32 v224, v146, v146, v224 op_sel_hi:[1,1,0]
v_cvt_pk_f16_f32 v172, v172, v173
v_fma_mix_f32 v224, v147, v147, v224 op_sel_hi:[1,1,0]
v_cvt_pk_f16_f32 v174, v174, v175
v_mfma_f32_32x32x16_bf16 v[128:143], v[84:87], v[180:183], v[128:143]
ds_read_u16 v160, v160
ds_read_u16 v161, v161
v_pk_fma_f16 v171, v170, v170, s48
v_fma_mix_f32 v224, v148, v148, v224 op_sel_hi:[1,1,0]
v_pk_fma_f16 v173, v172, v172, s48
v_fma_mix_f32 v224, v149, v149, v224 op_sel_hi:[1,1,0]
v_cvt_pkrtz_f16_f32 v163, v162, v163
v_and_b32_e64 v163, s49, v163
v_bfe_u32 v162, v163, 2, 14
v_lshrrev_b32_e64 v163, 18, v163
v_pk_fma_f16 v175, v174, v174, s48
v_pk_mul_f16 v171, v170, v171
ds_read_b128 v[176:179], v250 offset:12288
ds_read_u16 v162, v162
ds_read_u16 v163, v163
v_pk_mul_f16 v173, v172, v173
v_fma_mix_f32 v224, v150, v150, v224 op_sel_hi:[1,1,0]
v_pk_mul_f16 v175, v174, v175
s_waitcnt lgkmcnt(8)
v_fma_mix_f32 v224, v151, v151, v224 op_sel_hi:[1,1,0]
v_exp_f16_sdwa v171, v171 dst_sel:WORD_0 dst_unused:UNUSED_PRESERVE src0_sel:WORD_0
v_cvt_pkrtz_f16_f32 v165, v164, v165
v_and_b32 v165, s49, v165
v_bfe_u32 v164, v165, 2, 14
v_lshrrev_b32_e64 v165, 18, v165
v_mfma_f32_32x32x16_bf16 v[112:127], v[64:67], v[184:187], v[112:127]
ds_read_u16 v164, v164
ds_read_u16 v165, v165
v_exp_f16_sdwa v173, v173 dst_sel:WORD_0 dst_unused:UNUSED_PRESERVE src0_sel:WORD_0
v_fma_mix_f32 v224, v152, v152, v224 op_sel_hi:[1,1,0]
v_exp_f16_sdwa v175, v175 dst_sel:WORD_0 dst_unused:UNUSED_PRESERVE src0_sel:WORD_0
v_fma_mix_f32 v224, v153, v153, v224 op_sel_hi:[1,1,0]
v_cvt_pkrtz_f16_f32 v167, v166, v167
v_and_b32_e64 v167, s49, v167
v_bfe_u32 v166, v167, 2, 14
v_lshrrev_b32 v167, 18, v167
v_exp_f16_sdwa v171, v171 dst_sel:WORD_1 dst_unused:UNUSED_PRESERVE src0_sel:WORD_1
s_waitcnt lgkmcnt(6)
v_fma_mix_f32 v224, v154, v154, v224 op_sel_hi:[1,1,0]
v_exp_f16_sdwa v173, v173 dst_sel:WORD_1 dst_unused:UNUSED_PRESERVE src0_sel:WORD_1
v_fma_mix_f32 v224, v155, v155, v224 op_sel_hi:[1,1,0]
v_mfma_f32_32x32x16_bf16 v[128:143], v[88:91], v[184:187], v[128:143]
ds_read_u16 v166, v166
ds_read_u16 v167, v167
v_exp_f16_sdwa v175, v175 dst_sel:WORD_1 dst_unused:UNUSED_PRESERVE src0_sel:WORD_1
v_cvt_pkrtz_f16_f32 v169, v168, v169
v_and_b32_e64 v169, s49, v169
v_bfe_u32 v168, v169, 2, 14
v_lshrrev_b32_e64 v169, 18, v169
v_pk_add_f16 v171, v171, 1.0 op_sel_hi:[1,0]
v_pk_add_f16 v173, v173, 1.0 op_sel_hi:[1,0]
ds_read_b128 v[180:183], v250 offset:13312
ds_read_u16 v168, v168
ds_read_u16 v169, v169
v_pk_add_f16 v175, v175, 1.0 op_sel_hi:[1,0]
v_rcp_f16_sdwa v171, v171 dst_sel:WORD_0 dst_unused:UNUSED_PRESERVE src0_sel:WORD_0
v_mfma_f32_32x32x16_bf16 v[112:127], v[68:71], v[188:191], v[112:127]
v_rcp_f16_sdwa v173, v173 dst_sel:WORD_0 dst_unused:UNUSED_PRESERVE src0_sel:WORD_0
v_rcp_f16_sdwa v175, v175 dst_sel:WORD_0 dst_unused:UNUSED_PRESERVE src0_sel:WORD_0
v_rcp_f16_sdwa v171, v171 dst_sel:WORD_1 dst_unused:UNUSED_PRESERVE src0_sel:WORD_1
v_rcp_f16_sdwa v173, v173 dst_sel:WORD_1 dst_unused:UNUSED_PRESERVE src0_sel:WORD_1
v_mfma_f32_32x32x16_bf16 v[128:143], v[92:95], v[188:191], v[128:143]
v_rcp_f16_sdwa v175, v175 dst_sel:WORD_1 dst_unused:UNUSED_PRESERVE src0_sel:WORD_1
v_pk_mul_f16 v170, v170, v171
v_pk_mul_f16 v172, v172, v173
v_pk_mul_f16 v174, v174, v175
v_fma_mix_f32 v224, v170, v170, v224 op_sel_hi:[1,1,0]
s_waitcnt lgkmcnt(5)
v_mfma_f32_32x32x16_bf16 v[96:111], v[48:51], v[176:179], 0
ds_read_b128 v[184:187], v250 offset:14336
v_fma_mix_f32 v224, v172, v172, v224 op_sel_hi:[1,1,0]
v_cvt_pkrtz_f16_f32 v113, v112, v113
v_fma_mix_f32 v224, v174, v174, v224 op_sel_hi:[1,1,0]
v_and_b32 v113, s49, v113
v_fma_mix_f32 v224, v170, v170, v224 op_sel:[1,1,0] op_sel_hi:[1,1,0]
v_bfe_u32 v112, v113, 2, 14
v_fma_mix_f32 v224, v172, v172, v224 op_sel:[1,1,0] op_sel_hi:[1,1,0]
v_lshrrev_b32_e64 v113, 18, v113
v_fma_mix_f32 v224, v174, v174, v224 op_sel:[1,1,0] op_sel_hi:[1,1,0]
v_cvt_pk_f16_f32 v124, v124, v125
v_fma_mix_f32 v224, v160, v160, v224 op_sel_hi:[1,1,0]
v_cvt_pk_f16_f32 v126, v126, v127
v_fma_mix_f32 v224, v161, v161, v224 op_sel_hi:[1,1,0]
v_mfma_f32_32x32x16_bf16 v[144:159], v[176:179], v[72:75], 0
ds_read_u16 v112, v112
ds_read_u16 v113, v113
v_fma_mix_f32 v224, v162, v162, v224 op_sel_hi:[1,1,0]
v_pk_fma_f16 v125, v124, v124, s48
v_fma_mix_f32 v224, v163, v163, v224 op_sel_hi:[1,1,0]
v_cvt_pkrtz_f16_f32 v115, v114, v115
v_and_b32_e64 v115, s49, v115
v_bfe_u32 v114, v115, 2, 14
v_lshrrev_b32_e64 v115, 18, v115
v_pk_fma_f16 v127, v126, v126, s48
v_fma_mix_f32 v224, v164, v164, v224 op_sel_hi:[1,1,0]
v_pk_mul_f16 v125, v124, v125
v_fma_mix_f32 v224, v165, v165, v224 op_sel_hi:[1,1,0]
v_pk_mul_f16 v127, v126, v127
v_cvt_pkrtz_f16_f32 v117, v116, v117
ds_read_u16 v114, v114
ds_read_u16 v115, v115
ds_read_b128 v[188:191], v250 offset:15360
v_and_b32_e64 v117, s49, v117
v_bfe_u32 v116, v117, 2, 14
v_lshrrev_b32 v117, 18, v117
v_exp_f16_sdwa v125, v125 dst_sel:WORD_0 dst_unused:UNUSED_PRESERVE src0_sel:WORD_0
s_waitcnt lgkmcnt(5)
v_fma_mix_f32 v224, v166, v166, v224 op_sel_hi:[1,1,0]
v_mfma_f32_32x32x16_bf16 v[96:111], v[52:55], v[180:183], v[96:111]
ds_read_u16 v116, v116
ds_read_u16 v117, v117
v_fma_mix_f32 v224, v167, v167, v224 op_sel_hi:[1,1,0]
v_exp_f16_sdwa v127, v127 dst_sel:WORD_0 dst_unused:UNUSED_PRESERVE src0_sel:WORD_0
v_cvt_pkrtz_f16_f32 v119, v118, v119
v_and_b32_e64 v119, s49, v119
v_bfe_u32 v118, v119, 2, 14
v_lshrrev_b32_e64 v119, 18, v119
v_exp_f16_sdwa v125, v125 dst_sel:WORD_1 dst_unused:UNUSED_PRESERVE src0_sel:WORD_1
v_fma_mix_f32 v224, v168, v168, v224 op_sel_hi:[1,1,0]
v_cvt_pkrtz_f16_f32 v121, v120, v121
v_fma_mix_f32 v224, v169, v169, v224 op_sel_hi:[1,1,0]
v_and_b32_e64 v121, s49, v121
v_bfe_u32 v120, v121, 2, 14
ds_read_u16 v118, v118
ds_read_u16 v119, v119
v_lshrrev_b32_e64 v121, 18, v121
v_mfma_f32_32x32x16_bf16 v[144:159], v[180:183], v[76:79], v[144:159]
ds_read_u16 v120, v120
ds_read_u16 v121, v121
v_exp_f16_sdwa v127, v127 dst_sel:WORD_1 dst_unused:UNUSED_PRESERVE src0_sel:WORD_1
v_cvt_pkrtz_f16_f32 v123, v122, v123
v_and_b32_e64 v123, s49, v123
v_bfe_u32 v122, v123, 2, 14
v_lshrrev_b32_e64 v123, 18, v123
v_pk_add_f16 v125, v125, 1.0 op_sel_hi:[1,0]
v_pk_add_f16 v127, v127, 1.0 op_sel_hi:[1,0]
ds_read_b128 v[176:179], v250 offset:16384
ds_read_u16 v122, v122
ds_read_u16 v123, v123
v_rcp_f16_sdwa v125, v125 dst_sel:WORD_0 dst_unused:UNUSED_PRESERVE src0_sel:WORD_0
v_mfma_f32_32x32x16_bf16 v[96:111], v[56:59], v[184:187], v[96:111]
v_rcp_f16_sdwa v127, v127 dst_sel:WORD_0 dst_unused:UNUSED_PRESERVE src0_sel:WORD_0
v_rcp_f16_sdwa v125, v125 dst_sel:WORD_1 dst_unused:UNUSED_PRESERVE src0_sel:WORD_1
v_rcp_f16_sdwa v127, v127 dst_sel:WORD_1 dst_unused:UNUSED_PRESERVE src0_sel:WORD_1
v_mfma_f32_32x32x16_bf16 v[144:159], v[184:187], v[80:83], v[144:159]
ds_read_b128 v[180:183], v250 offset:17408
v_pk_mul_f16 v124, v124, v125
v_pk_mul_f16 v126, v126, v127
v_fma_mix_f32 v225, v124, v124, v225 op_sel_hi:[1,1,0]
v_cvt_pkrtz_f16_f32 v129, v128, v129
v_fma_mix_f32 v225, v126, v126, v225 op_sel_hi:[1,1,0]
s_waitcnt lgkmcnt(8)
v_mfma_f32_32x32x16_bf16 v[96:111], v[60:63], v[188:191], v[96:111]
v_fma_mix_f32 v225, v124, v124, v225 op_sel:[1,1,0] op_sel_hi:[1,1,0]
v_and_b32 v129, s49, v129
v_fma_mix_f32 v225, v126, v126, v225 op_sel:[1,1,0] op_sel_hi:[1,1,0]
v_bfe_u32 v128, v129, 2, 14
v_fma_mix_f32 v225, v112, v112, v225 op_sel_hi:[1,1,0]
v_lshrrev_b32_e64 v129, 18, v129
v_fma_mix_f32 v225, v113, v113, v225 op_sel_hi:[1,1,0]
v_cvt_pk_f16_f32 v138, v138, v139
v_fma_mix_f32 v225, v114, v114, v225 op_sel_hi:[1,1,0]
v_cvt_pk_f16_f32 v140, v140, v141
v_fma_mix_f32 v225, v115, v115, v225 op_sel_hi:[1,1,0]
v_cvt_pk_f16_f32 v142, v142, v143
v_mfma_f32_32x32x16_bf16 v[144:159], v[188:191], v[84:87], v[144:159]
ds_read_u16 v128, v128
ds_read_u16 v129, v129
v_pk_fma_f16 v139, v138, v138, s48
v_fma_mix_f32 v225, v116, v116, v225 op_sel_hi:[1,1,0]
v_pk_fma_f16 v141, v140, v140, s48
v_fma_mix_f32 v225, v117, v117, v225 op_sel_hi:[1,1,0]
v_cvt_pkrtz_f16_f32 v131, v130, v131
v_and_b32_e64 v131, s49, v131
v_bfe_u32 v130, v131, 2, 14
v_lshrrev_b32_e64 v131, 18, v131
v_pk_fma_f16 v143, v142, v142, s48
v_pk_mul_f16 v139, v138, v139
ds_read_b128 v[184:187], v250 offset:18432
ds_read_u16 v130, v130
ds_read_u16 v131, v131
v_pk_mul_f16 v141, v140, v141
s_waitcnt lgkmcnt(8)
v_fma_mix_f32 v225, v118, v118, v225 op_sel_hi:[1,1,0]
v_pk_mul_f16 v143, v142, v143
v_fma_mix_f32 v225, v119, v119, v225 op_sel_hi:[1,1,0]
v_exp_f16_sdwa v139, v139 dst_sel:WORD_0 dst_unused:UNUSED_PRESERVE src0_sel:WORD_0
v_cvt_pkrtz_f16_f32 v133, v132, v133
v_and_b32 v133, s49, v133
v_bfe_u32 v132, v133, 2, 14
v_lshrrev_b32_e64 v133, 18, v133
v_mfma_f32_32x32x16_bf16 v[96:111], v[64:67], v[176:179], v[96:111]
ds_read_u16 v132, v132
ds_read_u16 v133, v133
v_exp_f16_sdwa v141, v141 dst_sel:WORD_0 dst_unused:UNUSED_PRESERVE src0_sel:WORD_0
v_fma_mix_f32 v225, v120, v120, v225 op_sel_hi:[1,1,0]
v_exp_f16_sdwa v143, v143 dst_sel:WORD_0 dst_unused:UNUSED_PRESERVE src0_sel:WORD_0
v_fma_mix_f32 v225, v121, v121, v225 op_sel_hi:[1,1,0]
v_cvt_pkrtz_f16_f32 v135, v134, v135
v_and_b32_e64 v135, s49, v135
v_bfe_u32 v134, v135, 2, 14
v_lshrrev_b32 v135, 18, v135
v_exp_f16_sdwa v139, v139 dst_sel:WORD_1 dst_unused:UNUSED_PRESERVE src0_sel:WORD_1
s_waitcnt lgkmcnt(6)
v_fma_mix_f32 v225, v122, v122, v225 op_sel_hi:[1,1,0]
v_exp_f16_sdwa v141, v141 dst_sel:WORD_1 dst_unused:UNUSED_PRESERVE src0_sel:WORD_1
v_fma_mix_f32 v225, v123, v123, v225 op_sel_hi:[1,1,0]
v_mfma_f32_32x32x16_bf16 v[144:159], v[176:179], v[88:91], v[144:159]
ds_read_u16 v134, v134
ds_read_u16 v135, v135
v_exp_f16_sdwa v143, v143 dst_sel:WORD_1 dst_unused:UNUSED_PRESERVE src0_sel:WORD_1
v_cvt_pkrtz_f16_f32 v137, v136, v137
v_and_b32_e64 v137, s49, v137
v_bfe_u32 v136, v137, 2, 14
v_lshrrev_b32_e64 v137, 18, v137
v_pk_add_f16 v139, v139, 1.0 op_sel_hi:[1,0]
v_pk_add_f16 v141, v141, 1.0 op_sel_hi:[1,0]
ds_read_b128 v[188:191], v250 offset:19456
ds_read_u16 v136, v136
ds_read_u16 v137, v137
v_pk_add_f16 v143, v143, 1.0 op_sel_hi:[1,0]
v_rcp_f16_sdwa v139, v139 dst_sel:WORD_0 dst_unused:UNUSED_PRESERVE src0_sel:WORD_0
v_mfma_f32_32x32x16_bf16 v[96:111], v[68:71], v[180:183], v[96:111]
v_rcp_f16_sdwa v141, v141 dst_sel:WORD_0 dst_unused:UNUSED_PRESERVE src0_sel:WORD_0
v_rcp_f16_sdwa v143, v143 dst_sel:WORD_0 dst_unused:UNUSED_PRESERVE src0_sel:WORD_0
v_rcp_f16_sdwa v139, v139 dst_sel:WORD_1 dst_unused:UNUSED_PRESERVE src0_sel:WORD_1
v_rcp_f16_sdwa v141, v141 dst_sel:WORD_1 dst_unused:UNUSED_PRESERVE src0_sel:WORD_1
v_mfma_f32_32x32x16_bf16 v[144:159], v[180:183], v[92:95], v[144:159]
v_rcp_f16_sdwa v143, v143 dst_sel:WORD_1 dst_unused:UNUSED_PRESERVE src0_sel:WORD_1
v_pk_mul_f16 v138, v138, v139
v_pk_mul_f16 v140, v140, v141
v_pk_mul_f16 v142, v142, v143
v_fma_mix_f32 v225, v138, v138, v225 op_sel_hi:[1,1,0]
s_waitcnt lgkmcnt(5)
v_mfma_f32_32x32x16_bf16 v[160:175], v[48:51], v[184:187], 0
ds_read_b128 v[176:179], v250 offset:20480
v_fma_mix_f32 v225, v140, v140, v225 op_sel_hi:[1,1,0]
v_cvt_pkrtz_f16_f32 v97, v96, v97
v_fma_mix_f32 v225, v142, v142, v225 op_sel_hi:[1,1,0]
v_and_b32 v97, s49, v97
v_fma_mix_f32 v225, v138, v138, v225 op_sel:[1,1,0] op_sel_hi:[1,1,0]
v_bfe_u32 v96, v97, 2, 14
v_fma_mix_f32 v225, v140, v140, v225 op_sel:[1,1,0] op_sel_hi:[1,1,0]
v_lshrrev_b32_e64 v97, 18, v97
v_fma_mix_f32 v225, v142, v142, v225 op_sel:[1,1,0] op_sel_hi:[1,1,0]
v_cvt_pk_f16_f32 v108, v108, v109
v_fma_mix_f32 v225, v128, v128, v225 op_sel_hi:[1,1,0]
v_cvt_pk_f16_f32 v110, v110, v111
v_fma_mix_f32 v225, v129, v129, v225 op_sel_hi:[1,1,0]
v_mfma_f32_32x32x16_bf16 v[112:127], v[184:187], v[72:75], 0
ds_read_u16 v96, v96
ds_read_u16 v97, v97
v_fma_mix_f32 v225, v130, v130, v225 op_sel_hi:[1,1,0]
v_pk_fma_f16 v109, v108, v108, s48
v_fma_mix_f32 v225, v131, v131, v225 op_sel_hi:[1,1,0]
v_cvt_pkrtz_f16_f32 v99, v98, v99
v_and_b32_e64 v99, s49, v99
v_bfe_u32 v98, v99, 2, 14
v_lshrrev_b32_e64 v99, 18, v99
v_pk_fma_f16 v111, v110, v110, s48
v_fma_mix_f32 v225, v132, v132, v225 op_sel_hi:[1,1,0]
v_pk_mul_f16 v109, v108, v109
v_fma_mix_f32 v225, v133, v133, v225 op_sel_hi:[1,1,0]
v_pk_mul_f16 v111, v110, v111
v_cvt_pkrtz_f16_f32 v101, v100, v101
ds_read_u16 v98, v98
ds_read_u16 v99, v99
ds_read_b128 v[180:183], v250 offset:21504
v_and_b32_e64 v101, s49, v101
v_bfe_u32 v100, v101, 2, 14
v_lshrrev_b32 v101, 18, v101
v_exp_f16_sdwa v109, v109 dst_sel:WORD_0 dst_unused:UNUSED_PRESERVE src0_sel:WORD_0
s_waitcnt lgkmcnt(5)
v_fma_mix_f32 v225, v134, v134, v225 op_sel_hi:[1,1,0]
v_mfma_f32_32x32x16_bf16 v[160:175], v[52:55], v[188:191], v[160:175]
ds_read_u16 v100, v100
ds_read_u16 v101, v101
v_fma_mix_f32 v225, v135, v135, v225 op_sel_hi:[1,1,0]
v_exp_f16_sdwa v111, v111 dst_sel:WORD_0 dst_unused:UNUSED_PRESERVE src0_sel:WORD_0
v_cvt_pkrtz_f16_f32 v103, v102, v103
v_and_b32_e64 v103, s49, v103
v_bfe_u32 v102, v103, 2, 14
v_lshrrev_b32_e64 v103, 18, v103
v_exp_f16_sdwa v109, v109 dst_sel:WORD_1 dst_unused:UNUSED_PRESERVE src0_sel:WORD_1
v_fma_mix_f32 v225, v136, v136, v225 op_sel_hi:[1,1,0]
v_cvt_pkrtz_f16_f32 v105, v104, v105
v_fma_mix_f32 v225, v137, v137, v225 op_sel_hi:[1,1,0]
v_and_b32_e64 v105, s49, v105
v_bfe_u32 v104, v105, 2, 14
ds_read_u16 v102, v102
ds_read_u16 v103, v103
v_lshrrev_b32_e64 v105, 18, v105
v_mfma_f32_32x32x16_bf16 v[112:127], v[188:191], v[76:79], v[112:127]
ds_read_u16 v104, v104
ds_read_u16 v105, v105
v_exp_f16_sdwa v111, v111 dst_sel:WORD_1 dst_unused:UNUSED_PRESERVE src0_sel:WORD_1
v_cvt_pkrtz_f16_f32 v107, v106, v107
v_and_b32_e64 v107, s49, v107
v_bfe_u32 v106, v107, 2, 14
v_lshrrev_b32_e64 v107, 18, v107
v_pk_add_f16 v109, v109, 1.0 op_sel_hi:[1,0]
v_pk_add_f16 v111, v111, 1.0 op_sel_hi:[1,0]
ds_read_b128 v[184:187], v250 offset:22528
ds_read_u16 v106, v106
ds_read_u16 v107, v107
v_rcp_f16_sdwa v109, v109 dst_sel:WORD_0 dst_unused:UNUSED_PRESERVE src0_sel:WORD_0
v_mfma_f32_32x32x16_bf16 v[160:175], v[56:59], v[176:179], v[160:175]
v_rcp_f16_sdwa v111, v111 dst_sel:WORD_0 dst_unused:UNUSED_PRESERVE src0_sel:WORD_0
v_rcp_f16_sdwa v109, v109 dst_sel:WORD_1 dst_unused:UNUSED_PRESERVE src0_sel:WORD_1
v_rcp_f16_sdwa v111, v111 dst_sel:WORD_1 dst_unused:UNUSED_PRESERVE src0_sel:WORD_1
v_mfma_f32_32x32x16_bf16 v[112:127], v[176:179], v[80:83], v[112:127]
ds_read_b128 v[188:191], v250 offset:23552
v_pk_mul_f16 v108, v108, v109
v_pk_mul_f16 v110, v110, v111
v_fma_mix_f32 v226, v108, v108, v226 op_sel_hi:[1,1,0]
v_cvt_pkrtz_f16_f32 v145, v144, v145
v_fma_mix_f32 v226, v110, v110, v226 op_sel_hi:[1,1,0]
s_waitcnt lgkmcnt(8)
v_mfma_f32_32x32x16_bf16 v[160:175], v[60:63], v[180:183], v[160:175]
v_fma_mix_f32 v226, v108, v108, v226 op_sel:[1,1,0] op_sel_hi:[1,1,0]
v_and_b32 v145, s49, v145
v_fma_mix_f32 v226, v110, v110, v226 op_sel:[1,1,0] op_sel_hi:[1,1,0]
v_bfe_u32 v144, v145, 2, 14
v_fma_mix_f32 v226, v96, v96, v226 op_sel_hi:[1,1,0]
v_lshrrev_b32_e64 v145, 18, v145
v_fma_mix_f32 v226, v97, v97, v226 op_sel_hi:[1,1,0]
v_cvt_pk_f16_f32 v154, v154, v155
v_fma_mix_f32 v226, v98, v98, v226 op_sel_hi:[1,1,0]
v_cvt_pk_f16_f32 v156, v156, v157
v_fma_mix_f32 v226, v99, v99, v226 op_sel_hi:[1,1,0]
v_cvt_pk_f16_f32 v158, v158, v159
v_mfma_f32_32x32x16_bf16 v[112:127], v[180:183], v[84:87], v[112:127]
ds_read_u16 v144, v144
ds_read_u16_d16_hi v145, v145
v_pk_fma_f16 v155, v154, v154, s48
v_fma_mix_f32 v226, v100, v100, v226 op_sel_hi:[1,1,0]
v_pk_fma_f16 v157, v156, v156, s48
v_fma_mix_f32 v226, v101, v101, v226 op_sel_hi:[1,1,0]
v_cvt_pkrtz_f16_f32 v147, v146, v147
v_and_b32_e64 v147, s49, v147
v_bfe_u32 v146, v147, 2, 14
v_lshrrev_b32 v147, 18, v147
v_pk_fma_f16 v159, v158, v158, s48
v_pk_mul_f16 v155, v154, v155
ds_read_b128 v[176:179], v250 offset:24576
ds_read_u16 v146, v146
ds_read_u16_d16_hi v147, v147
s_waitcnt lgkmcnt(8)
v_fma_mix_f32 v226, v102, v102, v226 op_sel_hi:[1,1,0]
v_pk_mul_f16 v157, v156, v157
v_fma_mix_f32 v226, v103, v103, v226 op_sel_hi:[1,1,0]
v_pk_mul_f16 v159, v158, v159
v_cvt_pkrtz_f16_f32 v149, v148, v149
v_and_b32_e64 v149, s49, v149
v_bfe_u32 v148, v149, 2, 14
v_lshrrev_b32_e64 v149, 18, v149
v_exp_f16_sdwa v155, v155 dst_sel:WORD_0 dst_unused:UNUSED_PRESERVE src0_sel:WORD_0
v_mfma_f32_32x32x16_bf16 v[160:175], v[64:67], v[184:187], v[160:175]
ds_read_u16 v148, v148
ds_read_u16_d16_hi v149, v149
v_fma_mix_f32 v226, v104, v104, v226 op_sel_hi:[1,1,0]
v_exp_f16_sdwa v157, v157 dst_sel:WORD_0 dst_unused:UNUSED_PRESERVE src0_sel:WORD_0
v_fma_mix_f32 v226, v105, v105, v226 op_sel_hi:[1,1,0]
v_cvt_pkrtz_f16_f32 v151, v150, v151
v_and_b32_e64 v151, s49, v151
v_bfe_u32 v150, v151, 2, 14
v_lshrrev_b32 v151, 18, v151
v_exp_f16_sdwa v159, v159 dst_sel:WORD_0 dst_unused:UNUSED_PRESERVE src0_sel:WORD_0
s_waitcnt lgkmcnt(6)
v_fma_mix_f32 v226, v106, v106, v226 op_sel_hi:[1,1,0]
v_exp_f16_sdwa v155, v155 dst_sel:WORD_1 dst_unused:UNUSED_PRESERVE src0_sel:WORD_1
v_fma_mix_f32 v226, v107, v107, v226 op_sel_hi:[1,1,0]
v_mfma_f32_32x32x16_bf16 v[112:127], v[184:187], v[88:91], v[112:127]
ds_read_u16 v150, v150
ds_read_u16_d16_hi v151, v151
ds_read_b128 v[180:183], v250 offset:25600
v_exp_f16_sdwa v157, v157 dst_sel:WORD_1 dst_unused:UNUSED_PRESERVE src0_sel:WORD_1
v_cvt_pkrtz_f16_f32 v153, v152, v153
v_and_b32_e64 v153, s49, v153
v_bfe_u32 v152, v153, 2, 14
v_lshrrev_b32_e64 v153, 18, v153
v_exp_f16_sdwa v159, v159 dst_sel:WORD_1 dst_unused:UNUSED_PRESERVE src0_sel:WORD_1
v_pk_add_f16 v155, v155, 1.0 op_sel_hi:[1,0]
v_pk_add_f16 v157, v157, 1.0 op_sel_hi:[1,0]
v_mfma_f32_32x32x16_bf16 v[160:175], v[68:71], v[188:191], v[160:175]
ds_read_u16 v152, v152
ds_read_u16_d16_hi v153, v153
v_pk_add_f16 v159, v159, 1.0 op_sel_hi:[1,0]
v_rcp_f16_sdwa v155, v155 dst_sel:WORD_0 dst_unused:UNUSED_PRESERVE src0_sel:WORD_0
v_rcp_f16_sdwa v157, v157 dst_sel:WORD_0 dst_unused:UNUSED_PRESERVE src0_sel:WORD_0
v_rcp_f16_sdwa v159, v159 dst_sel:WORD_0 dst_unused:UNUSED_PRESERVE src0_sel:WORD_0
v_mfma_f32_32x32x16_bf16 v[112:127], v[188:191], v[92:95], v[112:127]
ds_read_b128 v[184:187], v250 offset:26624
v_rcp_f16_sdwa v155, v155 dst_sel:WORD_1 dst_unused:UNUSED_PRESERVE src0_sel:WORD_1
v_rcp_f16_sdwa v157, v157 dst_sel:WORD_1 dst_unused:UNUSED_PRESERVE src0_sel:WORD_1
v_rcp_f16_sdwa v159, v159 dst_sel:WORD_1 dst_unused:UNUSED_PRESERVE src0_sel:WORD_1
s_waitcnt lgkmcnt(6)
v_or_b32 v0, v144, v145
v_mfma_f32_32x32x16_bf16 v[128:143], v[48:51], v[176:179], 0
v_pk_mul_f16 v3, v154, v155
v_pk_mul_f16 v6, v156, v157
v_pk_mul_f16 v7, v158, v159
v_cvt_pkrtz_f16_f32 v161, v160, v161
v_and_b32_e64 v161, s49, v161
v_bfe_u32 v160, v161, 2, 14
v_lshrrev_b32_e64 v161, 18, v161
v_cvt_pk_f16_f32 v172, v172, v173
v_or_b32_e64 v1, v146, v147
v_cvt_pk_f16_f32 v174, v174, v175
v_mfma_f32_32x32x16_bf16 v[96:111], v[176:179], v[72:75], 0
ds_read_u16 v160, v160
ds_read_u16 v161, v161
v_pk_fma_f16 v173, v172, v172, s48
v_cvt_pkrtz_f16_f32 v163, v162, v163
v_and_b32_e64 v163, s49, v163
v_bfe_u32 v162, v163, 2, 14
v_lshrrev_b32_e64 v163, 18, v163
v_pk_fma_f16 v175, v174, v174, s48
v_or_b32_e64 v4, v148, v149
v_pk_mul_f16 v173, v172, v173
v_pk_mul_f16 v175, v174, v175
v_cvt_pkrtz_f16_f32 v165, v164, v165
v_and_b32_e64 v165, s49, v165
ds_read_u16 v162, v162
ds_read_u16 v163, v163
ds_read_b128 v[188:191], v250 offset:27648
v_bfe_u32 v164, v165, 2, 14
v_lshrrev_b32_e64 v165, 18, v165
v_exp_f16_sdwa v173, v173 dst_sel:WORD_0 dst_unused:UNUSED_PRESERVE src0_sel:WORD_0
s_waitcnt lgkmcnt(5)
v_or_b32 v5, v150, v151
v_mfma_f32_32x32x16_bf16 v[128:143], v[52:55], v[180:183], v[128:143]
ds_read_u16 v164, v164
ds_read_u16 v165, v165
v_exp_f16_sdwa v175, v175 dst_sel:WORD_0 dst_unused:UNUSED_PRESERVE src0_sel:WORD_0
v_cvt_pkrtz_f16_f32 v167, v166, v167
v_and_b32_e64 v167, s49, v167
v_bfe_u32 v166, v167, 2, 14
v_lshrrev_b32_e64 v167, 18, v167
v_exp_f16_sdwa v173, v173 dst_sel:WORD_1 dst_unused:UNUSED_PRESERVE src0_sel:WORD_1
v_or_b32_e64 v2, v152, v153
v_cvt_pkrtz_f16_f32 v169, v168, v169
v_and_b32_e64 v169, s49, v169
v_bfe_u32 v168, v169, 2, 14
v_lshrrev_b32_e64 v169, 18, v169
ds_read_u16 v166, v166
ds_read_u16 v167, v167
ds_read_u16 v168, v168
ds_read_u16 v169, v169
v_mfma_f32_32x32x16_bf16 v[96:111], v[180:183], v[76:79], v[96:111]
v_exp_f16_sdwa v175, v175 dst_sel:WORD_1 dst_unused:UNUSED_PRESERVE src0_sel:WORD_1
v_cvt_pkrtz_f16_f32 v171, v170, v171
v_and_b32_e64 v171, s49, v171
v_bfe_u32 v170, v171, 2, 14
v_mfma_f32_32x32x16_f16 v[144:159], v[0:3], v[216:219], 0
ds_read_b128 v[176:179], v250 offset:28672
v_lshrrev_b32_e64 v171, 18, v171
v_pk_add_f16 v173, v173, 1.0 op_sel_hi:[1,0]
v_pk_add_f16 v175, v175, 1.0 op_sel_hi:[1,0]
v_rcp_f16_sdwa v173, v173 dst_sel:WORD_0 dst_unused:UNUSED_PRESERVE src0_sel:WORD_0
v_mfma_f32_32x32x16_f16 v[144:159], v[4:7], v[220:223], v[144:159]
ds_read_u16 v170, v170
ds_read_u16 v171, v171
v_permlane16_swap_b32 v0, v4
v_permlane16_swap_b32 v1, v5
v_permlane16_swap_b32 v2, v6
v_permlane16_swap_b32 v3, v7
v_mfma_f32_32x32x16_bf16 v[128:143], v[56:59], v[184:187], v[128:143]
v_rcp_f16_sdwa v175, v175 dst_sel:WORD_0 dst_unused:UNUSED_PRESERVE src0_sel:WORD_0
v_rcp_f16_sdwa v173, v173 dst_sel:WORD_1 dst_unused:UNUSED_PRESERVE src0_sel:WORD_1
v_rcp_f16_sdwa v175, v175 dst_sel:WORD_1 dst_unused:UNUSED_PRESERVE src0_sel:WORD_1
v_mfma_f32_32x32x16_bf16 v[96:111], v[184:187], v[80:83], v[96:111]
ds_read_b128 v[180:183], v250 offset:29696
v_fmac_f32_e64 v226, v144, v144
v_pk_mul_f16 v172, v172, v173
v_fmac_f32_e64 v226, v145, v145
v_pk_mul_f16 v174, v174, v175
v_fmac_f32 v226, v146, v146
v_fmac_f32 v226, v147, v147
v_fma_mix_f32 v227, v172, v172, v227 op_sel_hi:[1,1,0]
v_fmac_f32 v226, v148, v148
v_fmac_f32 v226, v149, v149
v_fma_mix_f32 v227, v174, v174, v227 op_sel_hi:[1,1,0]
s_waitcnt lgkmcnt(6)
v_mfma_f32_32x32x16_bf16 v[128:143], v[60:63], v[188:191], v[128:143]
v_fmac_f32 v226, v150, v150
v_fma_mix_f32 v227, v172, v172, v227 op_sel:[1,1,0] op_sel_hi:[1,1,0]
v_fmac_f32 v226, v151, v151
v_fmac_f32 v226, v152, v152
v_fma_mix_f32 v227, v174, v174, v227 op_sel:[1,1,0] op_sel_hi:[1,1,0]
v_fmac_f32_e64 v226, v153, v153
v_fma_mix_f32 v227, v160, v160, v227 op_sel_hi:[1,1,0]
v_fmac_f32_e64 v226, v154, v154
v_fma_mix_f32 v227, v161, v161, v227 op_sel_hi:[1,1,0]
v_cvt_pkrtz_f16_f32 v113, v112, v113
v_fma_mix_f32 v227, v162, v162, v227 op_sel_hi:[1,1,0]
v_and_b32_e64 v113, s49, v113
v_fma_mix_f32 v227, v163, v163, v227 op_sel_hi:[1,1,0]
v_bfe_u32 v112, v113, 2, 14
v_lshrrev_b32_e64 v113, 18, v113
v_cvt_pk_f16_f32 v122, v122, v123
v_fmac_f32_e64 v226, v155, v155
v_cvt_pk_f16_f32 v124, v124, v125
v_fmac_f32_e64 v226, v156, v156
v_cvt_pk_f16_f32 v126, v126, v127
v_fmac_f32_e64 v226, v157, v157
ds_read_u16 v112, v112
ds_read_u16_d16_hi v113, v113
v_mfma_f32_32x32x16_bf16 v[96:111], v[188:191], v[84:87], v[96:111]
v_pk_fma_f16 v123, v122, v122, s48
v_fmac_f32_e64 v226, v158, v158
v_fma_mix_f32 v227, v164, v164, v227 op_sel_hi:[1,1,0]
v_fmac_f32_e64 v226, v159, v159
v_fma_mix_f32 v227, v165, v165, v227 op_sel_hi:[1,1,0]
v_pk_fma_f16 v125, v124, v124, s48
v_cvt_pkrtz_f16_f32 v115, v114, v115
v_and_b32_e64 v115, s49, v115
v_bfe_u32 v114, v115, 2, 14
v_lshrrev_b32_e64 v115, 18, v115
v_pk_fma_f16 v127, v126, v126, s48
ds_read_b128 v[184:187], v250 offset:30720
ds_read_u16 v114, v114
ds_read_u16_d16_hi v115, v115
v_pk_mul_f16 v123, v122, v123
v_fma_mix_f32 v227, v166, v166, v227 op_sel_hi:[1,1,0]
v_pk_mul_f16 v125, v124, v125
v_fma_mix_f32 v227, v167, v167, v227 op_sel_hi:[1,1,0]
v_pk_mul_f16 v127, v126, v127
v_cvt_pkrtz_f16_f32 v117, v116, v117
v_and_b32_e64 v117, s49, v117
v_bfe_u32 v116, v117, 2, 14
v_lshrrev_b32 v117, 18, v117
v_exp_f16_sdwa v123, v123 dst_sel:WORD_0 dst_unused:UNUSED_PRESERVE src0_sel:WORD_0
s_waitcnt lgkmcnt(5)
v_mfma_f32_32x32x16_bf16 v[128:143], v[64:67], v[176:179], v[128:143]
ds_read_u16 v116, v116
ds_read_u16_d16_hi v117, v117
v_fma_mix_f32 v227, v168, v168, v227 op_sel_hi:[1,1,0]
v_exp_f16_sdwa v125, v125 dst_sel:WORD_0 dst_unused:UNUSED_PRESERVE src0_sel:WORD_0
v_fma_mix_f32 v227, v169, v169, v227 op_sel_hi:[1,1,0]
v_cvt_pkrtz_f16_f32 v119, v118, v119
v_and_b32_e64 v119, s49, v119
v_bfe_u32 v118, v119, 2, 14
v_lshrrev_b32_e64 v119, 18, v119
v_exp_f16_sdwa v127, v127 dst_sel:WORD_0 dst_unused:UNUSED_PRESERVE src0_sel:WORD_0
v_fma_mix_f32 v227, v170, v170, v227 op_sel_hi:[1,1,0]
v_exp_f16_sdwa v123, v123 dst_sel:WORD_1 dst_unused:UNUSED_PRESERVE src0_sel:WORD_1
v_fma_mix_f32 v227, v171, v171, v227 op_sel_hi:[1,1,0]
v_mfma_f32_32x32x16_bf16 v[96:111], v[176:179], v[88:91], v[96:111]
ds_read_u16 v118, v118
ds_read_u16_d16_hi v119, v119
ds_read_b128 v[188:191], v250 offset:31744
v_exp_f16_sdwa v125, v125 dst_sel:WORD_1 dst_unused:UNUSED_PRESERVE src0_sel:WORD_1
v_cvt_pkrtz_f16_f32 v121, v120, v121
v_and_b32_e64 v121, s49, v121
v_bfe_u32 v120, v121, 2, 14
v_lshrrev_b32_e64 v121, 18, v121
v_exp_f16_sdwa v127, v127 dst_sel:WORD_1 dst_unused:UNUSED_PRESERVE src0_sel:WORD_1
v_pk_add_f16 v123, v123, 1.0 op_sel_hi:[1,0]
v_pk_add_f16 v125, v125, 1.0 op_sel_hi:[1,0]
v_mfma_f32_32x32x16_bf16 v[128:143], v[68:71], v[180:183], v[128:143]
ds_read_u16 v120, v120
ds_read_u16_d16_hi v121, v121
v_pk_add_f16 v127, v127, 1.0 op_sel_hi:[1,0]
v_rcp_f16_sdwa v123, v123 dst_sel:WORD_0 dst_unused:UNUSED_PRESERVE src0_sel:WORD_0
v_rcp_f16_sdwa v125, v125 dst_sel:WORD_0 dst_unused:UNUSED_PRESERVE src0_sel:WORD_0
v_rcp_f16_sdwa v127, v127 dst_sel:WORD_0 dst_unused:UNUSED_PRESERVE src0_sel:WORD_0
v_mfma_f32_32x32x16_bf16 v[96:111], v[180:183], v[92:95], v[96:111]
ds_read_b128 v[176:179], v250 offset:32768
v_rcp_f16_sdwa v123, v123 dst_sel:WORD_1 dst_unused:UNUSED_PRESERVE src0_sel:WORD_1
v_rcp_f16_sdwa v125, v125 dst_sel:WORD_1 dst_unused:UNUSED_PRESERVE src0_sel:WORD_1
v_rcp_f16_sdwa v127, v127 dst_sel:WORD_1 dst_unused:UNUSED_PRESERVE src0_sel:WORD_1
s_waitcnt lgkmcnt(5)
v_or_b32 v8, v112, v113
v_mfma_f32_32x32x16_bf16 v[144:159], v[48:51], v[184:187], 0
s_cmp_lg_u32 s40, 0
s_cbranch_scc1 Lpix
v_mov_b32_e64 v244, 0
Lpi:
buffer_load_dword v245, v244, s[36:39], 0 offen sc1
s_waitcnt vmcnt(0)
v_readfirstlane_b32 s43, v245
s_cmp_eq_u32 s76, 0
s_cbranch_scc1 Lpix
s_sub_u32 s76, s76, 1
s_cmp_lt_u32 s43, 256
s_cbranch_scc1 Lpi
Lpix:
v_pk_mul_f16 v11, v122, v123
v_pk_mul_f16 v14, v124, v125
v_pk_mul_f16 v15, v126, v127
v_cvt_pkrtz_f16_f32 v129, v128, v129
v_and_b32_e64 v129, s49, v129
v_bfe_u32 v128, v129, 2, 14
v_lshrrev_b32_e64 v129, 18, v129
v_cvt_pk_f16_f32 v140, v140, v141
v_or_b32_e64 v9, v114, v115
v_cvt_pk_f16_f32 v142, v142, v143
v_mfma_f32_32x32x16_bf16 v[160:175], v[184:187], v[72:75], 0
ds_read_u16 v128, v128
ds_read_u16 v129, v129
v_pk_fma_f16 v141, v140, v140, s48
v_cvt_pkrtz_f16_f32 v131, v130, v131
v_and_b32_e64 v131, s49, v131
v_bfe_u32 v130, v131, 2, 14
v_lshrrev_b32_e64 v131, 18, v131
v_pk_fma_f16 v143, v142, v142, s48
v_or_b32_e64 v12, v116, v117
v_pk_mul_f16 v141, v140, v141
v_pk_mul_f16 v143, v142, v143
v_cvt_pkrtz_f16_f32 v133, v132, v133
v_and_b32_e64 v133, s49, v133
ds_read_u16 v130, v130
ds_read_u16 v131, v131
ds_read_b128 v[180:183], v250 offset:33792
v_bfe_u32 v132, v133, 2, 14
v_lshrrev_b32_e64 v133, 18, v133
v_exp_f16_sdwa v141, v141 dst_sel:WORD_0 dst_unused:UNUSED_PRESERVE src0_sel:WORD_0
s_waitcnt lgkmcnt(5)
v_or_b32 v13, v118, v119
v_mfma_f32_32x32x16_bf16 v[144:159], v[52:55], v[188:191], v[144:159]
ds_read_u16 v132, v132
ds_read_u16 v133, v133
v_exp_f16_sdwa v143, v143 dst_sel:WORD_0 dst_unused:UNUSED_PRESERVE src0_sel:WORD_0
v_cvt_pkrtz_f16_f32 v135, v134, v135
v_and_b32_e64 v135, s49, v135
v_bfe_u32 v134, v135, 2, 14
v_lshrrev_b32_e64 v135, 18, v135
v_exp_f16_sdwa v141, v141 dst_sel:WORD_1 dst_unused:UNUSED_PRESERVE src0_sel:WORD_1
v_or_b32_e64 v10, v120, v121
v_cvt_pkrtz_f16_f32 v137, v136, v137
v_and_b32_e64 v137, s49, v137
v_bfe_u32 v136, v137, 2, 14
v_lshrrev_b32_e64 v137, 18, v137
ds_read_u16 v134, v134
ds_read_u16 v135, v135
ds_read_u16 v136, v136
ds_read_u16 v137, v137
v_mfma_f32_32x32x16_bf16 v[160:175], v[188:191], v[76:79], v[160:175]
v_exp_f16_sdwa v143, v143 dst_sel:WORD_1 dst_unused:UNUSED_PRESERVE src0_sel:WORD_1
v_cvt_pkrtz_f16_f32 v139, v138, v139
v_and_b32_e64 v139, s49, v139
v_bfe_u32 v138, v139, 2, 14
v_mfma_f32_32x32x16_f16 v[112:127], v[8:11], v[216:219], 0
ds_read_b128 v[184:187], v250 offset:34816
v_lshrrev_b32_e64 v139, 18, v139
v_pk_add_f16 v141, v141, 1.0 op_sel_hi:[1,0]
v_pk_add_f16 v143, v143, 1.0 op_sel_hi:[1,0]
v_rcp_f16_sdwa v141, v141 dst_sel:WORD_0 dst_unused:UNUSED_PRESERVE src0_sel:WORD_0
v_mfma_f32_32x32x16_f16 v[112:127], v[12:15], v[220:223], v[112:127]
ds_read_u16 v138, v138
ds_read_u16 v139, v139
v_permlane16_swap_b32 v8, v12
v_permlane16_swap_b32 v9, v13
v_permlane16_swap_b32 v10, v14
v_permlane16_swap_b32 v11, v15
v_mfma_f32_32x32x16_bf16 v[144:159], v[56:59], v[176:179], v[144:159]
v_rcp_f16_sdwa v143, v143 dst_sel:WORD_0 dst_unused:UNUSED_PRESERVE src0_sel:WORD_0
v_rcp_f16_sdwa v141, v141 dst_sel:WORD_1 dst_unused:UNUSED_PRESERVE src0_sel:WORD_1
v_rcp_f16_sdwa v143, v143 dst_sel:WORD_1 dst_unused:UNUSED_PRESERVE src0_sel:WORD_1
v_mfma_f32_32x32x16_bf16 v[160:175], v[176:179], v[80:83], v[160:175]
ds_read_b128 v[188:191], v250 offset:35840
v_fmac_f32_e64 v227, v112, v112
v_pk_mul_f16 v140, v140, v141
v_fmac_f32_e64 v227, v113, v113
v_pk_mul_f16 v142, v142, v143
v_fmac_f32 v227, v114, v114
v_fmac_f32 v227, v115, v115
v_fma_mix_f32 v228, v140, v140, v228 op_sel_hi:[1,1,0]
v_fmac_f32 v227, v116, v116
v_fmac_f32 v227, v117, v117
v_fma_mix_f32 v228, v142, v142, v228 op_sel_hi:[1,1,0]
s_waitcnt lgkmcnt(6)
v_mfma_f32_32x32x16_bf16 v[144:159], v[60:63], v[180:183], v[144:159]
v_fmac_f32 v227, v118, v118
v_fma_mix_f32 v228, v140, v140, v228 op_sel:[1,1,0] op_sel_hi:[1,1,0]
v_fmac_f32 v227, v119, v119
v_fmac_f32 v227, v120, v120
v_fma_mix_f32 v228, v142, v142, v228 op_sel:[1,1,0] op_sel_hi:[1,1,0]
v_fmac_f32_e64 v227, v121, v121
v_fma_mix_f32 v228, v128, v128, v228 op_sel_hi:[1,1,0]
v_fmac_f32_e64 v227, v122, v122
v_fma_mix_f32 v228, v129, v129, v228 op_sel_hi:[1,1,0]
v_cvt_pkrtz_f16_f32 v97, v96, v97
v_fma_mix_f32 v228, v130, v130, v228 op_sel_hi:[1,1,0]
v_and_b32_e64 v97, s49, v97
v_fma_mix_f32 v228, v131, v131, v228 op_sel_hi:[1,1,0]
v_bfe_u32 v96, v97, 2, 14
v_lshrrev_b32_e64 v97, 18, v97
v_cvt_pk_f16_f32 v106, v106, v107
v_fmac_f32_e64 v227, v123, v123
v_cvt_pk_f16_f32 v108, v108, v109
v_fmac_f32_e64 v227, v124, v124
v_cvt_pk_f16_f32 v110, v110, v111
v_fmac_f32_e64 v227, v125, v125
ds_read_u16 v96, v96
ds_read_u16_d16_hi v97, v97
v_mfma_f32_32x32x16_bf16 v[160:175], v[180:183], v[84:87], v[160:175]
v_pk_fma_f16 v107, v106, v106, s48
v_fmac_f32_e64 v227, v126, v126
v_fma_mix_f32 v228, v132, v132, v228 op_sel_hi:[1,1,0]
v_fmac_f32_e64 v227, v127, v127
v_fma_mix_f32 v228, v133, v133, v228 op_sel_hi:[1,1,0]
v_pk_fma_f16 v109, v108, v108, s48
v_cvt_pkrtz_f16_f32 v99, v98, v99
v_and_b32_e64 v99, s49, v99
v_bfe_u32 v98, v99, 2, 14
v_lshrrev_b32_e64 v99, 18, v99
v_pk_fma_f16 v111, v110, v110, s48
ds_read_b128 v[176:179], v250 offset:36864
ds_read_u16 v98, v98
ds_read_u16_d16_hi v99, v99
v_pk_mul_f16 v107, v106, v107
v_fma_mix_f32 v228, v134, v134, v228 op_sel_hi:[1,1,0]
v_pk_mul_f16 v109, v108, v109
v_fma_mix_f32 v228, v135, v135, v228 op_sel_hi:[1,1,0]
v_pk_mul_f16 v111, v110, v111
v_cvt_pkrtz_f16_f32 v101, v100, v101
v_and_b32_e64 v101, s49, v101
v_bfe_u32 v100, v101, 2, 14
v_lshrrev_b32 v101, 18, v101
v_exp_f16_sdwa v107, v107 dst_sel:WORD_0 dst_unused:UNUSED_PRESERVE src0_sel:WORD_0
s_waitcnt lgkmcnt(5)
v_mfma_f32_32x32x16_bf16 v[144:159], v[64:67], v[184:187], v[144:159]
ds_read_u16 v100, v100
ds_read_u16_d16_hi v101, v101
v_fma_mix_f32 v228, v136, v136, v228 op_sel_hi:[1,1,0]
v_exp_f16_sdwa v109, v109 dst_sel:WORD_0 dst_unused:UNUSED_PRESERVE src0_sel:WORD_0
v_fma_mix_f32 v228, v137, v137, v228 op_sel_hi:[1,1,0]
v_cvt_pkrtz_f16_f32 v103, v102, v103
v_and_b32_e64 v103, s49, v103
v_bfe_u32 v102, v103, 2, 14
v_lshrrev_b32_e64 v103, 18, v103
v_exp_f16_sdwa v111, v111 dst_sel:WORD_0 dst_unused:UNUSED_PRESERVE src0_sel:WORD_0
v_fma_mix_f32 v228, v138, v138, v228 op_sel_hi:[1,1,0]
v_exp_f16_sdwa v107, v107 dst_sel:WORD_1 dst_unused:UNUSED_PRESERVE src0_sel:WORD_1
v_fma_mix_f32 v228, v139, v139, v228 op_sel_hi:[1,1,0]
v_mfma_f32_32x32x16_bf16 v[160:175], v[184:187], v[88:91], v[160:175]
ds_read_u16 v102, v102
ds_read_u16_d16_hi v103, v103
ds_read_b128 v[180:183], v250 offset:37888
v_exp_f16_sdwa v109, v109 dst_sel:WORD_1 dst_unused:UNUSED_PRESERVE src0_sel:WORD_1
v_cvt_pkrtz_f16_f32 v105, v104, v105
v_and_b32_e64 v105, s49, v105
v_bfe_u32 v104, v105, 2, 14
v_lshrrev_b32_e64 v105, 18, v105
v_exp_f16_sdwa v111, v111 dst_sel:WORD_1 dst_unused:UNUSED_PRESERVE src0_sel:WORD_1
v_pk_add_f16 v107, v107, 1.0 op_sel_hi:[1,0]
v_pk_add_f16 v109, v109, 1.0 op_sel_hi:[1,0]
v_mfma_f32_32x32x16_bf16 v[144:159], v[68:71], v[188:191], v[144:159]
ds_read_u16 v104, v104
ds_read_u16_d16_hi v105, v105
v_pk_add_f16 v111, v111, 1.0 op_sel_hi:[1,0]
v_rcp_f16_sdwa v107, v107 dst_sel:WORD_0 dst_unused:UNUSED_PRESERVE src0_sel:WORD_0
v_rcp_f16_sdwa v109, v109 dst_sel:WORD_0 dst_unused:UNUSED_PRESERVE src0_sel:WORD_0
v_rcp_f16_sdwa v111, v111 dst_sel:WORD_0 dst_unused:UNUSED_PRESERVE src0_sel:WORD_0
v_mfma_f32_32x32x16_bf16 v[160:175], v[188:191], v[92:95], v[160:175]
ds_read_b128 v[184:187], v250 offset:38912
v_rcp_f16_sdwa v107, v107 dst_sel:WORD_1 dst_unused:UNUSED_PRESERVE src0_sel:WORD_1
v_rcp_f16_sdwa v109, v109 dst_sel:WORD_1 dst_unused:UNUSED_PRESERVE src0_sel:WORD_1
v_rcp_f16_sdwa v111, v111 dst_sel:WORD_1 dst_unused:UNUSED_PRESERVE src0_sel:WORD_1
s_waitcnt lgkmcnt(5)
v_or_b32 v16, v96, v97
v_mfma_f32_32x32x16_bf16 v[112:127], v[48:51], v[176:179], 0
v_pk_mul_f16 v19, v106, v107
v_pk_mul_f16 v22, v108, v109
v_pk_mul_f16 v23, v110, v111
v_cvt_pkrtz_f16_f32 v145, v144, v145
v_and_b32_e64 v145, s49, v145
v_bfe_u32 v144, v145, 2, 14
v_lshrrev_b32_e64 v145, 18, v145
v_cvt_pk_f16_f32 v156, v156, v157
v_or_b32_e64 v17, v98, v99
v_cvt_pk_f16_f32 v158, v158, v159
v_mfma_f32_32x32x16_bf16 v[128:143], v[176:179], v[72:75], 0
ds_read_u16 v144, v144
ds_read_u16 v145, v145
v_pk_fma_f16 v157, v156, v156, s48
v_cvt_pkrtz_f16_f32 v147, v146, v147
v_and_b32_e64 v147, s49, v147
v_bfe_u32 v146, v147, 2, 14
v_lshrrev_b32_e64 v147, 18, v147
v_pk_fma_f16 v159, v158, v158, s48
v_or_b32_e64 v20, v100, v101
v_pk_mul_f16 v157, v156, v157
v_pk_mul_f16 v159, v158, v159
v_cvt_pkrtz_f16_f32 v149, v148, v149
v_and_b32_e64 v149, s49, v149
ds_read_u16 v146, v146
ds_read_u16 v147, v147
ds_read_b128 v[188:191], v250 offset:39936
v_bfe_u32 v148, v149, 2, 14
v_lshrrev_b32_e64 v149, 18, v149
v_exp_f16_sdwa v157, v157 dst_sel:WORD_0 dst_unused:UNUSED_PRESERVE src0_sel:WORD_0
s_waitcnt lgkmcnt(5)
v_or_b32 v21, v102, v103
v_mfma_f32_32x32x16_bf16 v[112:127], v[52:55], v[180:183], v[112:127]
ds_read_u16 v148, v148
ds_read_u16 v149, v149
v_exp_f16_sdwa v159, v159 dst_sel:WORD_0 dst_unused:UNUSED_PRESERVE src0_sel:WORD_0
v_cvt_pkrtz_f16_f32 v151, v150, v151
v_and_b32_e64 v151, s49, v151
v_bfe_u32 v150, v151, 2, 14
v_lshrrev_b32_e64 v151, 18, v151
v_exp_f16_sdwa v157, v157 dst_sel:WORD_1 dst_unused:UNUSED_PRESERVE src0_sel:WORD_1
v_or_b32_e64 v18, v104, v105
v_cvt_pkrtz_f16_f32 v153, v152, v153
v_and_b32_e64 v153, s49, v153
v_bfe_u32 v152, v153, 2, 14
v_lshrrev_b32_e64 v153, 18, v153
ds_read_u16 v150, v150
ds_read_u16 v151, v151
ds_read_u16 v152, v152
ds_read_u16 v153, v153
v_mfma_f32_32x32x16_bf16 v[128:143], v[180:183], v[76:79], v[128:143]
v_exp_f16_sdwa v159, v159 dst_sel:WORD_1 dst_unused:UNUSED_PRESERVE src0_sel:WORD_1
v_cvt_pkrtz_f16_f32 v155, v154, v155
v_and_b32_e64 v155, s49, v155
v_bfe_u32 v154, v155, 2, 14
v_mfma_f32_32x32x16_f16 v[96:111], v[16:19], v[216:219], 0
ds_read_b128 v[176:179], v250 offset:40960
v_lshrrev_b32_e64 v155, 18, v155
v_pk_add_f16 v157, v157, 1.0 op_sel_hi:[1,0]
v_pk_add_f16 v159, v159, 1.0 op_sel_hi:[1,0]
v_rcp_f16_sdwa v157, v157 dst_sel:WORD_0 dst_unused:UNUSED_PRESERVE src0_sel:WORD_0
v_mfma_f32_32x32x16_f16 v[96:111], v[20:23], v[220:223], v[96:111]
ds_read_u16 v154, v154
ds_read_u16 v155, v155
v_permlane16_swap_b32 v16, v20
v_permlane16_swap_b32 v17, v21
v_permlane16_swap_b32 v18, v22
v_permlane16_swap_b32 v19, v23
v_mfma_f32_32x32x16_bf16 v[112:127], v[56:59], v[184:187], v[112:127]
v_rcp_f16_sdwa v159, v159 dst_sel:WORD_0 dst_unused:UNUSED_PRESERVE src0_sel:WORD_0
v_rcp_f16_sdwa v157, v157 dst_sel:WORD_1 dst_unused:UNUSED_PRESERVE src0_sel:WORD_1
v_rcp_f16_sdwa v159, v159 dst_sel:WORD_1 dst_unused:UNUSED_PRESERVE src0_sel:WORD_1
v_mfma_f32_32x32x16_bf16 v[128:143], v[184:187], v[80:83], v[128:143]
ds_read_b128 v[180:183], v250 offset:41984
v_fmac_f32_e64 v228, v96, v96
v_pk_mul_f16 v156, v156, v157
v_fmac_f32_e64 v228, v97, v97
v_pk_mul_f16 v158, v158, v159
v_fmac_f32 v228, v98, v98
v_fmac_f32 v228, v99, v99
v_fma_mix_f32 v229, v156, v156, v229 op_sel_hi:[1,1,0]
v_fmac_f32 v228, v100, v100
v_fmac_f32 v228, v101, v101
v_fma_mix_f32 v229, v158, v158, v229 op_sel_hi:[1,1,0]
s_waitcnt lgkmcnt(6)
v_mfma_f32_32x32x16_bf16 v[112:127], v[60:63], v[188:191], v[112:127]
v_fmac_f32 v228, v102, v102
v_fma_mix_f32 v229, v156, v156, v229 op_sel:[1,1,0] op_sel_hi:[1,1,0]
v_fmac_f32 v228, v103, v103
v_fmac_f32 v228, v104, v104
v_fma_mix_f32 v229, v158, v158, v229 op_sel:[1,1,0] op_sel_hi:[1,1,0]
v_fmac_f32_e64 v228, v105, v105
v_fma_mix_f32 v229, v144, v144, v229 op_sel_hi:[1,1,0]
v_fmac_f32_e64 v228, v106, v106
v_fma_mix_f32 v229, v145, v145, v229 op_sel_hi:[1,1,0]
v_cvt_pkrtz_f16_f32 v161, v160, v161
v_fma_mix_f32 v229, v146, v146, v229 op_sel_hi:[1,1,0]
v_and_b32_e64 v161, s49, v161
v_fma_mix_f32 v229, v147, v147, v229 op_sel_hi:[1,1,0]
v_bfe_u32 v160, v161, 2, 14
v_lshrrev_b32_e64 v161, 18, v161
v_cvt_pk_f16_f32 v170, v170, v171
v_fmac_f32_e64 v228, v107, v107
v_cvt_pk_f16_f32 v172, v172, v173
v_fmac_f32_e64 v228, v108, v108
v_cvt_pk_f16_f32 v174, v174, v175
v_fmac_f32_e64 v228, v109, v109
ds_read_u16 v160, v160
ds_read_u16_d16_hi v161, v161
v_mfma_f32_32x32x16_bf16 v[128:143], v[188:191], v[84:87], v[128:143]
v_pk_fma_f16 v171, v170, v170, s48
v_fmac_f32_e64 v228, v110, v110
v_fma_mix_f32 v229, v148, v148, v229 op_sel_hi:[1,1,0]
v_fmac_f32_e64 v228, v111, v111
v_fma_mix_f32 v229, v149, v149, v229 op_sel_hi:[1,1,0]
v_pk_fma_f16 v173, v172, v172, s48
v_cvt_pkrtz_f16_f32 v163, v162, v163
v_and_b32_e64 v163, s49, v163
v_bfe_u32 v162, v163, 2, 14
v_lshrrev_b32_e64 v163, 18, v163
v_pk_fma_f16 v175, v174, v174, s48
ds_read_b128 v[184:187], v250 offset:43008
ds_read_u16 v162, v162
ds_read_u16_d16_hi v163, v163
v_pk_mul_f16 v171, v170, v171
v_fma_mix_f32 v229, v150, v150, v229 op_sel_hi:[1,1,0]
v_pk_mul_f16 v173, v172, v173
v_fma_mix_f32 v229, v151, v151, v229 op_sel_hi:[1,1,0]
v_pk_mul_f16 v175, v174, v175
v_cvt_pkrtz_f16_f32 v165, v164, v165
v_and_b32_e64 v165, s49, v165
v_bfe_u32 v164, v165, 2, 14
v_lshrrev_b32 v165, 18, v165
v_exp_f16_sdwa v171, v171 dst_sel:WORD_0 dst_unused:UNUSED_PRESERVE src0_sel:WORD_0
s_waitcnt lgkmcnt(5)
v_mfma_f32_32x32x16_bf16 v[112:127], v[64:67], v[176:179], v[112:127]
ds_read_u16 v164, v164
ds_read_u16_d16_hi v165, v165
v_fma_mix_f32 v229, v152, v152, v229 op_sel_hi:[1,1,0]
v_exp_f16_sdwa v173, v173 dst_sel:WORD_0 dst_unused:UNUSED_PRESERVE src0_sel:WORD_0
v_fma_mix_f32 v229, v153, v153, v229 op_sel_hi:[1,1,0]
v_cvt_pkrtz_f16_f32 v167, v166, v167
v_and_b32_e64 v167, s49, v167
v_bfe_u32 v166, v167, 2, 14
v_lshrrev_b32_e64 v167, 18, v167
v_exp_f16_sdwa v175, v175 dst_sel:WORD_0 dst_unused:UNUSED_PRESERVE src0_sel:WORD_0
v_fma_mix_f32 v229, v154, v154, v229 op_sel_hi:[1,1,0]
v_exp_f16_sdwa v171, v171 dst_sel:WORD_1 dst_unused:UNUSED_PRESERVE src0_sel:WORD_1
v_fma_mix_f32 v229, v155, v155, v229 op_sel_hi:[1,1,0]
v_mfma_f32_32x32x16_bf16 v[128:143], v[176:179], v[88:91], v[128:143]
ds_read_u16 v166, v166
ds_read_u16_d16_hi v167, v167
ds_read_b128 v[188:191], v250 offset:44032
v_exp_f16_sdwa v173, v173 dst_sel:WORD_1 dst_unused:UNUSED_PRESERVE src0_sel:WORD_1
v_cvt_pkrtz_f16_f32 v169, v168, v169
v_and_b32_e64 v169, s49, v169
v_bfe_u32 v168, v169, 2, 14
v_lshrrev_b32_e64 v169, 18, v169
v_exp_f16_sdwa v175, v175 dst_sel:WORD_1 dst_unused:UNUSED_PRESERVE src0_sel:WORD_1
v_pk_add_f16 v171, v171, 1.0 op_sel_hi:[1,0]
v_pk_add_f16 v173, v173, 1.0 op_sel_hi:[1,0]
v_mfma_f32_32x32x16_bf16 v[112:127], v[68:71], v[180:183], v[112:127]
ds_read_u16 v168, v168
ds_read_u16_d16_hi v169, v169
v_pk_add_f16 v175, v175, 1.0 op_sel_hi:[1,0]
v_rcp_f16_sdwa v171, v171 dst_sel:WORD_0 dst_unused:UNUSED_PRESERVE src0_sel:WORD_0
v_rcp_f16_sdwa v173, v173 dst_sel:WORD_0 dst_unused:UNUSED_PRESERVE src0_sel:WORD_0
v_rcp_f16_sdwa v175, v175 dst_sel:WORD_0 dst_unused:UNUSED_PRESERVE src0_sel:WORD_0
v_mfma_f32_32x32x16_bf16 v[128:143], v[180:183], v[92:95], v[128:143]
ds_read_b128 v[176:179], v250 offset:45056
v_rcp_f16_sdwa v171, v171 dst_sel:WORD_1 dst_unused:UNUSED_PRESERVE src0_sel:WORD_1
v_rcp_f16_sdwa v173, v173 dst_sel:WORD_1 dst_unused:UNUSED_PRESERVE src0_sel:WORD_1
v_rcp_f16_sdwa v175, v175 dst_sel:WORD_1 dst_unused:UNUSED_PRESERVE src0_sel:WORD_1
s_waitcnt lgkmcnt(5)
v_or_b32 v192, v160, v161
v_mfma_f32_32x32x16_bf16 v[96:111], v[48:51], v[184:187], 0
v_pk_mul_f16 v195, v170, v171
v_pk_mul_f16 v198, v172, v173
v_pk_mul_f16 v199, v174, v175
v_cvt_pkrtz_f16_f32 v113, v112, v113
v_and_b32_e64 v113, s49, v113
v_bfe_u32 v112, v113, 2, 14
v_lshrrev_b32_e64 v113, 18, v113
v_cvt_pk_f16_f32 v124, v124, v125
v_or_b32_e64 v193, v162, v163
v_cvt_pk_f16_f32 v126, v126, v127
v_mfma_f32_32x32x16_bf16 v[144:159], v[184:187], v[72:75], 0
ds_read_u16 v112, v112
ds_read_u16 v113, v113
v_pk_fma_f16 v125, v124, v124, s48
v_cvt_pkrtz_f16_f32 v115, v114, v115
v_and_b32_e64 v115, s49, v115
v_bfe_u32 v114, v115, 2, 14
v_lshrrev_b32_e64 v115, 18, v115
v_pk_fma_f16 v127, v126, v126, s48
v_or_b32_e64 v196, v164, v165
v_pk_mul_f16 v125, v124, v125
v_pk_mul_f16 v127, v126, v127
v_cvt_pkrtz_f16_f32 v117, v116, v117
v_and_b32_e64 v117, s49, v117
ds_read_u16 v114, v114
ds_read_u16 v115, v115
ds_read_b128 v[180:183], v250 offset:46080
v_bfe_u32 v116, v117, 2, 14
v_lshrrev_b32_e64 v117, 18, v117
v_exp_f16_sdwa v125, v125 dst_sel:WORD_0 dst_unused:UNUSED_PRESERVE src0_sel:WORD_0
s_waitcnt lgkmcnt(5)
v_or_b32 v197, v166, v167
v_mfma_f32_32x32x16_bf16 v[96:111], v[52:55], v[188:191], v[96:111]
ds_read_u16 v116, v116
ds_read_u16 v117, v117
v_exp_f16_sdwa v127, v127 dst_sel:WORD_0 dst_unused:UNUSED_PRESERVE src0_sel:WORD_0
v_cvt_pkrtz_f16_f32 v119, v118, v119
v_and_b32_e64 v119, s49, v119
v_bfe_u32 v118, v119, 2, 14
v_lshrrev_b32_e64 v119, 18, v119
v_exp_f16_sdwa v125, v125 dst_sel:WORD_1 dst_unused:UNUSED_PRESERVE src0_sel:WORD_1
v_or_b32_e64 v194, v168, v169
v_cvt_pkrtz_f16_f32 v121, v120, v121
v_and_b32_e64 v121, s49, v121
v_bfe_u32 v120, v121, 2, 14
v_lshrrev_b32_e64 v121, 18, v121
ds_read_u16 v118, v118
ds_read_u16 v119, v119
ds_read_u16 v120, v120
ds_read_u16 v121, v121
v_mfma_f32_32x32x16_bf16 v[144:159], v[188:191], v[76:79], v[144:159]
v_exp_f16_sdwa v127, v127 dst_sel:WORD_1 dst_unused:UNUSED_PRESERVE src0_sel:WORD_1
v_cvt_pkrtz_f16_f32 v123, v122, v123
v_and_b32_e64 v123, s49, v123
v_bfe_u32 v122, v123, 2, 14
v_mfma_f32_32x32x16_f16 v[160:175], v[192:195], v[216:219], 0
ds_read_b128 v[184:187], v250 offset:47104
v_lshrrev_b32_e64 v123, 18, v123
v_pk_add_f16 v125, v125, 1.0 op_sel_hi:[1,0]
v_pk_add_f16 v127, v127, 1.0 op_sel_hi:[1,0]
v_rcp_f16_sdwa v125, v125 dst_sel:WORD_0 dst_unused:UNUSED_PRESERVE src0_sel:WORD_0
v_mfma_f32_32x32x16_f16 v[160:175], v[196:199], v[220:223], v[160:175]
ds_read_u16 v122, v122
ds_read_u16 v123, v123
v_permlane16_swap_b32 v192, v196
v_permlane16_swap_b32 v193, v197
v_permlane16_swap_b32 v194, v198
v_permlane16_swap_b32 v195, v199
v_mfma_f32_32x32x16_bf16 v[96:111], v[56:59], v[176:179], v[96:111]
v_rcp_f16_sdwa v127, v127 dst_sel:WORD_0 dst_unused:UNUSED_PRESERVE src0_sel:WORD_0
v_rcp_f16_sdwa v125, v125 dst_sel:WORD_1 dst_unused:UNUSED_PRESERVE src0_sel:WORD_1
v_rcp_f16_sdwa v127, v127 dst_sel:WORD_1 dst_unused:UNUSED_PRESERVE src0_sel:WORD_1
v_mfma_f32_32x32x16_bf16 v[144:159], v[176:179], v[80:83], v[144:159]
ds_read_b128 v[188:191], v250 offset:48128
v_fmac_f32_e64 v229, v160, v160
v_pk_mul_f16 v124, v124, v125
v_fmac_f32_e64 v229, v161, v161
v_pk_mul_f16 v126, v126, v127
v_fmac_f32 v229, v162, v162
v_fmac_f32 v229, v163, v163
v_fma_mix_f32 v230, v124, v124, v230 op_sel_hi:[1,1,0]
v_fmac_f32 v229, v164, v164
v_fmac_f32 v229, v165, v165
v_fma_mix_f32 v230, v126, v126, v230 op_sel_hi:[1,1,0]
s_waitcnt lgkmcnt(6)
v_mfma_f32_32x32x16_bf16 v[96:111], v[60:63], v[180:183], v[96:111]
v_fmac_f32 v229, v166, v166
v_fma_mix_f32 v230, v124, v124, v230 op_sel:[1,1,0] op_sel_hi:[1,1,0]
v_fmac_f32 v229, v167, v167
v_fmac_f32 v229, v168, v168
v_fma_mix_f32 v230, v126, v126, v230 op_sel:[1,1,0] op_sel_hi:[1,1,0]
v_fmac_f32_e64 v229, v169, v169
v_fma_mix_f32 v230, v112, v112, v230 op_sel_hi:[1,1,0]
v_fmac_f32_e64 v229, v170, v170
v_fma_mix_f32 v230, v113, v113, v230 op_sel_hi:[1,1,0]
v_cvt_pkrtz_f16_f32 v129, v128, v129
v_fma_mix_f32 v230, v114, v114, v230 op_sel_hi:[1,1,0]
v_and_b32_e64 v129, s49, v129
v_fma_mix_f32 v230, v115, v115, v230 op_sel_hi:[1,1,0]
v_bfe_u32 v128, v129, 2, 14
v_lshrrev_b32_e64 v129, 18, v129
v_cvt_pk_f16_f32 v138, v138, v139
v_fmac_f32_e64 v229, v171, v171
v_cvt_pk_f16_f32 v140, v140, v141
v_fmac_f32_e64 v229, v172, v172
v_cvt_pk_f16_f32 v142, v142, v143
v_fmac_f32_e64 v229, v173, v173
ds_read_u16 v128, v128
ds_read_u16_d16_hi v129, v129
v_mfma_f32_32x32x16_bf16 v[144:159], v[180:183], v[84:87], v[144:159]
v_pk_fma_f16 v139, v138, v138, s48
v_fmac_f32_e64 v229, v174, v174
v_fma_mix_f32 v230, v116, v116, v230 op_sel_hi:[1,1,0]
v_fmac_f32_e64 v229, v175, v175
v_fma_mix_f32 v230, v117, v117, v230 op_sel_hi:[1,1,0]
v_pk_fma_f16 v141, v140, v140, s48
v_cvt_pkrtz_f16_f32 v131, v130, v131
v_and_b32_e64 v131, s49, v131
v_bfe_u32 v130, v131, 2, 14
v_lshrrev_b32_e64 v131, 18, v131
v_pk_fma_f16 v143, v142, v142, s48
ds_read_b128 v[176:179], v250 offset:49152
ds_read_u16 v130, v130
ds_read_u16_d16_hi v131, v131
v_pk_mul_f16 v139, v138, v139
v_fma_mix_f32 v230, v118, v118, v230 op_sel_hi:[1,1,0]
v_pk_mul_f16 v141, v140, v141
v_fma_mix_f32 v230, v119, v119, v230 op_sel_hi:[1,1,0]
v_pk_mul_f16 v143, v142, v143
v_cvt_pkrtz_f16_f32 v133, v132, v133
v_and_b32_e64 v133, s49, v133
v_bfe_u32 v132, v133, 2, 14
v_lshrrev_b32 v133, 18, v133
v_exp_f16_sdwa v139, v139 dst_sel:WORD_0 dst_unused:UNUSED_PRESERVE src0_sel:WORD_0
s_waitcnt lgkmcnt(5)
v_mfma_f32_32x32x16_bf16 v[96:111], v[64:67], v[184:187], v[96:111]
ds_read_u16 v132, v132
ds_read_u16_d16_hi v133, v133
v_fma_mix_f32 v230, v120, v120, v230 op_sel_hi:[1,1,0]
v_exp_f16_sdwa v141, v141 dst_sel:WORD_0 dst_unused:UNUSED_PRESERVE src0_sel:WORD_0
v_fma_mix_f32 v230, v121, v121, v230 op_sel_hi:[1,1,0]
v_cvt_pkrtz_f16_f32 v135, v134, v135
v_and_b32_e64 v135, s49, v135
v_bfe_u32 v134, v135, 2, 14
v_lshrrev_b32_e64 v135, 18, v135
v_exp_f16_sdwa v143, v143 dst_sel:WORD_0 dst_unused:UNUSED_PRESERVE src0_sel:WORD_0
v_fma_mix_f32 v230, v122, v122, v230 op_sel_hi:[1,1,0]
v_exp_f16_sdwa v139, v139 dst_sel:WORD_1 dst_unused:UNUSED_PRESERVE src0_sel:WORD_1
v_fma_mix_f32 v230, v123, v123, v230 op_sel_hi:[1,1,0]
v_mfma_f32_32x32x16_bf16 v[144:159], v[184:187], v[88:91], v[144:159]
ds_read_u16 v134, v134
ds_read_u16_d16_hi v135, v135
ds_read_b128 v[180:183], v250 offset:50176
v_exp_f16_sdwa v141, v141 dst_sel:WORD_1 dst_unused:UNUSED_PRESERVE src0_sel:WORD_1
v_cvt_pkrtz_f16_f32 v137, v136, v137
v_and_b32_e64 v137, s49, v137
v_bfe_u32 v136, v137, 2, 14
v_lshrrev_b32_e64 v137, 18, v137
v_exp_f16_sdwa v143, v143 dst_sel:WORD_1 dst_unused:UNUSED_PRESERVE src0_sel:WORD_1
v_pk_add_f16 v139, v139, 1.0 op_sel_hi:[1,0]
v_pk_add_f16 v141, v141, 1.0 op_sel_hi:[1,0]
v_mfma_f32_32x32x16_bf16 v[96:111], v[68:71], v[188:191], v[96:111]
ds_read_u16 v136, v136
ds_read_u16_d16_hi v137, v137
v_pk_add_f16 v143, v143, 1.0 op_sel_hi:[1,0]
v_rcp_f16_sdwa v139, v139 dst_sel:WORD_0 dst_unused:UNUSED_PRESERVE src0_sel:WORD_0
v_rcp_f16_sdwa v141, v141 dst_sel:WORD_0 dst_unused:UNUSED_PRESERVE src0_sel:WORD_0
v_rcp_f16_sdwa v143, v143 dst_sel:WORD_0 dst_unused:UNUSED_PRESERVE src0_sel:WORD_0
v_mfma_f32_32x32x16_bf16 v[144:159], v[188:191], v[92:95], v[144:159]
ds_read_b128 v[184:187], v250 offset:51200
v_rcp_f16_sdwa v139, v139 dst_sel:WORD_1 dst_unused:UNUSED_PRESERVE src0_sel:WORD_1
v_rcp_f16_sdwa v141, v141 dst_sel:WORD_1 dst_unused:UNUSED_PRESERVE src0_sel:WORD_1
v_rcp_f16_sdwa v143, v143 dst_sel:WORD_1 dst_unused:UNUSED_PRESERVE src0_sel:WORD_1
s_waitcnt lgkmcnt(5)
v_or_b32 v200, v128, v129
v_mfma_f32_32x32x16_bf16 v[160:175], v[48:51], v[176:179], 0
v_mov_b32 v239, 0
s_branch Law5
Lax5:
s_sleep 2
Law5:
ds_read_b32 v239, v247 offset:28
s_sub_u32 s76, s76, 1
s_cselect_b32 s44, 4, 0
s_cselect_b32 s76, 0, s76
s_waitcnt lgkmcnt(0)
v_readfirstlane_b32 s43, v239
s_nop 1
s_max_u32 s43, s43, s44
s_cmp_lt_u32 s43, 4
s_cbranch_scc1 Lax5
v_bfe_u32 v237, v250, 4, 6
v_lshrrev_b32_e64 v246, 2, v237
v_mul_u32_u24 v246, 192, v246
v_and_b32_e64 v237, 3, v237
v_lshl_add_u32 v246, v237, 4, v246
v_permlane32_swap_b32 v224, v225
v_add_f32 v224, v224, v225
v_permlane32_swap_b32 v226, v227
v_add_f32 v226, v226, v227
v_permlane32_swap_b32 v228, v229
v_add_f32 v228, v228, v229
v_pk_mul_f16 v203, v138, v139
v_pk_mul_f16 v206, v140, v141
ds_write_b32 v248, v224 offset:5120
ds_write_b32 v248, v226 offset:5376
ds_write_b32 v248, v228 offset:5632
v_pk_mul_f16 v207, v142, v143
v_cvt_pkrtz_f16_f32 v97, v96, v97
v_and_b32_e64 v97, s49, v97
v_bfe_u32 v96, v97, 2, 14
v_lshrrev_b32_e64 v97, 18, v97
v_cvt_pk_f16_f32 v108, v108, v109
v_or_b32_e64 v201, v130, v131
v_cvt_pk_f16_f32 v110, v110, v111
v_mfma_f32_32x32x16_bf16 v[112:127], v[176:179], v[72:75], 0
ds_read_u16 v96, v96
ds_read_u16 v97, v97
v_pk_fma_f16 v109, v108, v108, s48
v_cvt_pkrtz_f16_f32 v99, v98, v99
v_and_b32_e64 v99, s49, v99
v_bfe_u32 v98, v99, 2, 14
v_lshrrev_b32_e64 v99, 18, v99
v_pk_fma_f16 v111, v110, v110, s48
v_or_b32_e64 v204, v132, v133
v_pk_mul_f16 v109, v108, v109
v_pk_mul_f16 v111, v110, v111
v_cvt_pkrtz_f16_f32 v101, v100, v101
v_and_b32_e64 v101, s49, v101
ds_read_u16 v98, v98
ds_read_u16 v99, v99
ds_read_b128 v[188:191], v250 offset:52224
v_bfe_u32 v100, v101, 2, 14
v_lshrrev_b32_e64 v101, 18, v101
v_exp_f16_sdwa v109, v109 dst_sel:WORD_0 dst_unused:UNUSED_PRESERVE src0_sel:WORD_0
v_or_b32_e64 v205, v134, v135
v_mfma_f32_32x32x16_bf16 v[160:175], v[52:55], v[180:183], v[160:175]
ds_read_u16 v100, v100
ds_read_u16 v101, v101
s_add_u32 m0, s72, 0
s_add_u32 s43, s82, 0
buffer_load_dwordx4 v246, s[16:19], s43 offen lds
v_exp_f16_sdwa v111, v111 dst_sel:WORD_0 dst_unused:UNUSED_PRESERVE src0_sel:WORD_0
v_cvt_pkrtz_f16_f32 v103, v102, v103
v_and_b32_e64 v103, s49, v103
v_bfe_u32 v102, v103, 2, 14
v_lshrrev_b32_e64 v103, 18, v103
v_exp_f16_sdwa v109, v109 dst_sel:WORD_1 dst_unused:UNUSED_PRESERVE src0_sel:WORD_1
v_or_b32_e64 v202, v136, v137
v_cvt_pkrtz_f16_f32 v105, v104, v105
v_and_b32_e64 v105, s49, v105
v_bfe_u32 v104, v105, 2, 14
v_lshrrev_b32_e64 v105, 18, v105
ds_read_u16 v102, v102
ds_read_u16 v103, v103
ds_read_u16 v104, v104
ds_read_u16 v105, v105
v_mfma_f32_32x32x16_bf16 v[112:127], v[180:183], v[76:79], v[112:127]
v_exp_f16_sdwa v111, v111 dst_sel:WORD_1 dst_unused:UNUSED_PRESERVE src0_sel:WORD_1
v_cvt_pkrtz_f16_f32 v107, v106, v107
v_and_b32_e64 v107, s49, v107
v_bfe_u32 v106, v107, 2, 14
v_mfma_f32_32x32x16_f16 v[128:143], v[200:203], v[216:219], 0
ds_read_b128 v[176:179], v250 offset:53248
v_lshrrev_b32_e64 v107, 18, v107
v_pk_add_f16 v109, v109, 1.0 op_sel_hi:[1,0]
v_pk_add_f16 v111, v111, 1.0 op_sel_hi:[1,0]
v_rcp_f16_sdwa v109, v109 dst_sel:WORD_0 dst_unused:UNUSED_PRESERVE src0_sel:WORD_0
v_mfma_f32_32x32x16_f16 v[128:143], v[204:207], v[220:223], v[128:143]
s_waitcnt lgkmcnt(7)
ds_read_u16 v106, v106
ds_read_u16 v107, v107
v_permlane16_swap_b32 v200, v204
v_permlane16_swap_b32 v201, v205
v_permlane16_swap_b32 v202, v206
v_permlane16_swap_b32 v203, v207
v_mfma_f32_32x32x16_bf16 v[160:175], v[56:59], v[184:187], v[160:175]
v_rcp_f16_sdwa v111, v111 dst_sel:WORD_0 dst_unused:UNUSED_PRESERVE src0_sel:WORD_0
v_rcp_f16_sdwa v109, v109 dst_sel:WORD_1 dst_unused:UNUSED_PRESERVE src0_sel:WORD_1
s_add_u32 m0, s72, 1024
s_add_u32 s43, s82, 64
buffer_load_dwordx4 v246, s[16:19], s43 offen lds
v_rcp_f16_sdwa v111, v111 dst_sel:WORD_1 dst_unused:UNUSED_PRESERVE src0_sel:WORD_1
v_mfma_f32_32x32x16_bf16 v[112:127], v[184:187], v[80:83], v[112:127]
ds_read_b128 v[180:183], v250 offset:54272
v_fmac_f32_e64 v230, v128, v128
v_pk_mul_f16 v108, v108, v109
v_fmac_f32_e64 v230, v129, v129
v_pk_mul_f16 v110, v110, v111
v_fmac_f32 v230, v130, v130
v_fmac_f32 v230, v131, v131
v_fma_mix_f32 v231, v108, v108, v231 op_sel_hi:[1,1,0]
v_fmac_f32 v230, v132, v132
v_fmac_f32 v230, v133, v133
v_fma_mix_f32 v231, v110, v110, v231 op_sel_hi:[1,1,0]
v_mfma_f32_32x32x16_bf16 v[160:175], v[60:63], v[188:191], v[160:175]
v_fmac_f32_e64 v230, v134, v134
v_fma_mix_f32 v231, v108, v108, v231 op_sel:[1,1,0] op_sel_hi:[1,1,0]
v_fmac_f32 v230, v135, v135
v_fmac_f32 v230, v136, v136
v_fma_mix_f32 v231, v110, v110, v231 op_sel:[1,1,0] op_sel_hi:[1,1,0]
v_fmac_f32_e64 v230, v137, v137
v_fma_mix_f32 v231, v96, v96, v231 op_sel_hi:[1,1,0]
v_fmac_f32_e64 v230, v138, v138
v_fma_mix_f32 v231, v97, v97, v231 op_sel_hi:[1,1,0]
v_cvt_pkrtz_f16_f32 v145, v144, v145
v_fma_mix_f32 v231, v98, v98, v231 op_sel_hi:[1,1,0]
v_and_b32_e64 v145, s49, v145
v_fma_mix_f32 v231, v99, v99, v231 op_sel_hi:[1,1,0]
v_bfe_u32 v144, v145, 2, 14
v_lshrrev_b32_e64 v145, 18, v145
v_cvt_pk_f16_f32 v154, v154, v155
v_fmac_f32_e64 v230, v139, v139
v_cvt_pk_f16_f32 v156, v156, v157
v_fmac_f32_e64 v230, v140, v140
v_cvt_pk_f16_f32 v158, v158, v159
v_fmac_f32_e64 v230, v141, v141
ds_read_u16 v144, v144
ds_read_u16_d16_hi v145, v145
v_mfma_f32_32x32x16_bf16 v[112:127], v[188:191], v[84:87], v[112:127]
v_pk_fma_f16 v155, v154, v154, s48
v_fmac_f32 v230, v142, v142
s_waitcnt lgkmcnt(4)
v_fma_mix_f32 v231, v100, v100, v231 op_sel_hi:[1,1,0]
v_fmac_f32_e64 v230, v143, v143
v_fma_mix_f32 v231, v101, v101, v231 op_sel_hi:[1,1,0]
v_pk_fma_f16 v157, v156, v156, s48
v_cvt_pkrtz_f16_f32 v147, v146, v147
v_and_b32_e64 v147, s49, v147
v_bfe_u32 v146, v147, 2, 14
v_lshrrev_b32_e64 v147, 18, v147
v_pk_fma_f16 v159, v158, v158, s48
ds_read_b128 v[184:187], v250 offset:55296
ds_read_u16 v146, v146
ds_read_u16_d16_hi v147, v147
v_pk_mul_f16 v155, v154, v155
v_fma_mix_f32 v231, v102, v102, v231 op_sel_hi:[1,1,0]
v_pk_mul_f16 v157, v156, v157
v_fma_mix_f32 v231, v103, v103, v231 op_sel_hi:[1,1,0]
s_add_u32 m0, s72, 2048
s_add_u32 s43, s82, 128
buffer_load_dwordx4 v246, s[16:19], s43 offen lds
v_pk_mul_f16 v159, v158, v159
v_cvt_pkrtz_f16_f32 v149, v148, v149
v_and_b32_e64 v149, s49, v149
v_bfe_u32 v148, v149, 2, 14
v_lshrrev_b32_e64 v149, 18, v149
v_exp_f16_sdwa v155, v155 dst_sel:WORD_0 dst_unused:UNUSED_PRESERVE src0_sel:WORD_0
v_mfma_f32_32x32x16_bf16 v[160:175], v[64:67], v[176:179], v[160:175]
ds_read_u16 v148, v148
ds_read_u16_d16_hi v149, v149
v_fma_mix_f32 v231, v104, v104, v231 op_sel_hi:[1,1,0]
v_exp_f16_sdwa v157, v157 dst_sel:WORD_0 dst_unused:UNUSED_PRESERVE src0_sel:WORD_0
v_fma_mix_f32 v231, v105, v105, v231 op_sel_hi:[1,1,0]
v_cvt_pkrtz_f16_f32 v151, v150, v151
v_and_b32_e64 v151, s49, v151
v_bfe_u32 v150, v151, 2, 14
v_lshrrev_b32 v151, 18, v151
v_exp_f16_sdwa v159, v159 dst_sel:WORD_0 dst_unused:UNUSED_PRESERVE src0_sel:WORD_0
v_fma_mix_f32 v231, v106, v106, v231 op_sel_hi:[1,1,0]
v_exp_f16_sdwa v155, v155 dst_sel:WORD_1 dst_unused:UNUSED_PRESERVE src0_sel:WORD_1
s_waitcnt lgkmcnt(4)
v_fma_mix_f32 v231, v107, v107, v231 op_sel_hi:[1,1,0]
v_mfma_f32_32x32x16_bf16 v[112:127], v[176:179], v[88:91], v[112:127]
ds_read_u16 v150, v150
ds_read_u16_d16_hi v151, v151
ds_read_b128 v[188:191], v250 offset:56320
v_exp_f16_sdwa v157, v157 dst_sel:WORD_1 dst_unused:UNUSED_PRESERVE src0_sel:WORD_1
v_cvt_pkrtz_f16_f32 v153, v152, v153
v_and_b32_e64 v153, s49, v153
v_bfe_u32 v152, v153, 2, 14
v_lshrrev_b32_e64 v153, 18, v153
v_exp_f16_sdwa v159, v159 dst_sel:WORD_1 dst_unused:UNUSED_PRESERVE src0_sel:WORD_1
v_pk_add_f16 v155, v155, 1.0 op_sel_hi:[1,0]
v_pk_add_f16 v157, v157, 1.0 op_sel_hi:[1,0]
v_mfma_f32_32x32x16_bf16 v[160:175], v[68:71], v[180:183], v[160:175]
ds_read_u16 v152, v152
ds_read_u16_d16_hi v153, v153
v_pk_add_f16 v159, v159, 1.0 op_sel_hi:[1,0]
v_rcp_f16_sdwa v155, v155 dst_sel:WORD_0 dst_unused:UNUSED_PRESERVE src0_sel:WORD_0
v_rcp_f16_sdwa v157, v157 dst_sel:WORD_0 dst_unused:UNUSED_PRESERVE src0_sel:WORD_0
s_add_u32 m0, s72, 3072
s_add_u32 s43, s82, 3072
buffer_load_dwordx4 v246, s[16:19], s43 offen lds
v_rcp_f16_sdwa v159, v159 dst_sel:WORD_0 dst_unused:UNUSED_PRESERVE src0_sel:WORD_0
v_mfma_f32_32x32x16_bf16 v[112:127], v[180:183], v[92:95], v[112:127]
ds_read_b128 v[176:179], v250 offset:57344
v_rcp_f16_sdwa v155, v155 dst_sel:WORD_1 dst_unused:UNUSED_PRESERVE src0_sel:WORD_1
v_rcp_f16_sdwa v157, v157 dst_sel:WORD_1 dst_unused:UNUSED_PRESERVE src0_sel:WORD_1
v_rcp_f16_sdwa v159, v159 dst_sel:WORD_1 dst_unused:UNUSED_PRESERVE src0_sel:WORD_1
v_or_b32_e64 v208, v144, v145
v_mfma_f32_32x32x16_bf16 v[128:143], v[48:51], v[184:187], 0
v_pk_mul_f16 v211, v154, v155
v_pk_mul_f16 v214, v156, v157
v_pk_mul_f16 v215, v158, v159
v_cvt_pkrtz_f16_f32 v161, v160, v161
v_and_b32_e64 v161, s49, v161
v_bfe_u32 v160, v161, 2, 14
v_lshrrev_b32_e64 v161, 18, v161
v_cvt_pk_f16_f32 v172, v172, v173
s_waitcnt lgkmcnt(3)
v_or_b32 v209, v146, v147
v_cvt_pk_f16_f32 v174, v174, v175
v_mfma_f32_32x32x16_bf16 v[96:111], v[72:75], v[184:187], 0
ds_read_u16 v160, v160
ds_read_u16 v161, v161
v_pk_fma_f16 v173, v172, v172, s48
v_cvt_pkrtz_f16_f32 v163, v162, v163
v_and_b32_e64 v163, s49, v163
v_bfe_u32 v162, v163, 2, 14
v_lshrrev_b32_e64 v163, 18, v163
v_pk_fma_f16 v175, v174, v174, s48
v_or_b32_e64 v212, v148, v149
v_pk_mul_f16 v173, v172, v173
v_pk_mul_f16 v175, v174, v175
v_cvt_pkrtz_f16_f32 v165, v164, v165
v_and_b32_e64 v165, s49, v165
ds_read_u16 v162, v162
ds_read_u16 v163, v163
ds_read_b128 v[180:183], v250 offset:58368
v_bfe_u32 v164, v165, 2, 14
v_lshrrev_b32_e64 v165, 18, v165
v_exp_f16_sdwa v173, v173 dst_sel:WORD_0 dst_unused:UNUSED_PRESERVE src0_sel:WORD_0
v_or_b32_e64 v213, v150, v151
v_mfma_f32_32x32x16_bf16 v[128:143], v[52:55], v[188:191], v[128:143]
ds_read_u16 v164, v164
ds_read_u16 v165, v165
s_add_u32 m0, s72, 4096
s_add_u32 s43, s82, 3136
buffer_load_dwordx4 v246, s[16:19], s43 offen lds
v_exp_f16_sdwa v175, v175 dst_sel:WORD_0 dst_unused:UNUSED_PRESERVE src0_sel:WORD_0
v_cvt_pkrtz_f16_f32 v167, v166, v167
v_and_b32_e64 v167, s49, v167
v_bfe_u32 v166, v167, 2, 14
v_lshrrev_b32_e64 v167, 18, v167
v_exp_f16_sdwa v173, v173 dst_sel:WORD_1 dst_unused:UNUSED_PRESERVE src0_sel:WORD_1
s_waitcnt lgkmcnt(6)
v_or_b32 v210, v152, v153
v_cvt_pkrtz_f16_f32 v169, v168, v169
v_and_b32_e64 v169, s49, v169
v_bfe_u32 v168, v169, 2, 14
v_lshrrev_b32_e64 v169, 18, v169
ds_read_u16 v166, v166
ds_read_u16 v167, v167
ds_read_u16 v168, v168
ds_read_u16 v169, v169
v_mfma_f32_32x32x16_bf16 v[96:111], v[76:79], v[188:191], v[96:111]
v_exp_f16_sdwa v175, v175 dst_sel:WORD_1 dst_unused:UNUSED_PRESERVE src0_sel:WORD_1
v_cvt_pkrtz_f16_f32 v171, v170, v171
v_and_b32_e64 v171, s49, v171
v_bfe_u32 v170, v171, 2, 14
v_mfma_f32_32x32x16_f16 v[144:159], v[208:211], v[216:219], 0
ds_read_b128 v[184:187], v250 offset:59392
v_lshrrev_b32_e64 v171, 18, v171
v_pk_add_f16 v173, v173, 1.0 op_sel_hi:[1,0]
v_pk_add_f16 v175, v175, 1.0 op_sel_hi:[1,0]
v_rcp_f16_sdwa v173, v173 dst_sel:WORD_0 dst_unused:UNUSED_PRESERVE src0_sel:WORD_0
v_mfma_f32_32x32x16_f16 v[144:159], v[212:215], v[220:223], v[144:159]
ds_read_u16 v170, v170
ds_read_u16 v171, v171
v_permlane16_swap_b32 v208, v212
v_permlane16_swap_b32 v209, v213
v_permlane16_swap_b32 v210, v214
v_permlane16_swap_b32 v211, v215
v_mfma_f32_32x32x16_bf16 v[128:143], v[56:59], v[176:179], v[128:143]
v_rcp_f16_sdwa v175, v175 dst_sel:WORD_0 dst_unused:UNUSED_PRESERVE src0_sel:WORD_0
v_rcp_f16_sdwa v173, v173 dst_sel:WORD_1 dst_unused:UNUSED_PRESERVE src0_sel:WORD_1
s_add_u32 m0, s72, 6144
s_add_u32 s43, s82, 6144
buffer_load_dwordx4 v246, s[16:19], s43 offen lds
v_rcp_f16_sdwa v175, v175 dst_sel:WORD_1 dst_unused:UNUSED_PRESERVE src0_sel:WORD_1
v_mfma_f32_32x32x16_bf16 v[96:111], v[80:83], v[176:179], v[96:111]
ds_read_b128 v[188:191], v250 offset:60416
v_fmac_f32_e64 v231, v144, v144
v_pk_mul_f16 v172, v172, v173
v_fmac_f32_e64 v231, v145, v145
v_pk_mul_f16 v174, v174, v175
v_fmac_f32 v231, v146, v146
v_fmac_f32 v231, v147, v147
v_fma_mix_f32 v232, v172, v172, v232 op_sel_hi:[1,1,0]
v_fmac_f32 v231, v148, v148
v_fmac_f32 v231, v149, v149
v_fma_mix_f32 v232, v174, v174, v232 op_sel_hi:[1,1,0]
s_waitcnt lgkmcnt(6)
v_mfma_f32_32x32x16_bf16 v[128:143], v[60:63], v[180:183], v[128:143]
v_fmac_f32 v231, v150, v150
v_fma_mix_f32 v232, v172, v172, v232 op_sel:[1,1,0] op_sel_hi:[1,1,0]
v_fmac_f32 v231, v151, v151
v_fmac_f32 v231, v152, v152
v_fma_mix_f32 v232, v174, v174, v232 op_sel:[1,1,0] op_sel_hi:[1,1,0]
v_fmac_f32_e64 v231, v153, v153
v_fma_mix_f32 v232, v160, v160, v232 op_sel_hi:[1,1,0]
v_fmac_f32_e64 v231, v154, v154
v_fma_mix_f32 v232, v161, v161, v232 op_sel_hi:[1,1,0]
v_cvt_pkrtz_f16_f32 v113, v112, v113
v_fma_mix_f32 v232, v162, v162, v232 op_sel_hi:[1,1,0]
v_and_b32_e64 v113, s49, v113
v_fma_mix_f32 v232, v163, v163, v232 op_sel_hi:[1,1,0]
v_bfe_u32 v112, v113, 2, 14
v_lshrrev_b32_e64 v113, 18, v113
v_cvt_pk_f16_f32 v122, v122, v123
v_fmac_f32_e64 v231, v155, v155
v_cvt_pk_f16_f32 v124, v124, v125
v_fmac_f32_e64 v231, v156, v156
v_cvt_pk_f16_f32 v126, v126, v127
v_fmac_f32_e64 v231, v157, v157
ds_read_u16 v112, v112
ds_read_u16_d16_hi v113, v113
v_mfma_f32_32x32x16_bf16 v[96:111], v[84:87], v[180:183], v[96:111]
v_pk_fma_f16 v123, v122, v122, s48
v_fmac_f32_e64 v231, v158, v158
v_fma_mix_f32 v232, v164, v164, v232 op_sel_hi:[1,1,0]
v_fmac_f32_e64 v231, v159, v159
v_fma_mix_f32 v232, v165, v165, v232 op_sel_hi:[1,1,0]
s_nop 0
v_permlane32_swap_b32 v230, v231
v_add_f32_e64 v230, v230, v231
v_pk_fma_f16 v125, v124, v124, s48
v_cvt_pkrtz_f16_f32 v115, v114, v115
v_and_b32_e64 v115, s49, v115
v_bfe_u32 v114, v115, 2, 14
v_lshrrev_b32_e64 v115, 18, v115
v_pk_fma_f16 v127, v126, v126, s48
ds_write_b32 v248, v230 offset:8192
ds_read_b128 v[176:179], v250 offset:61440
ds_read_u16 v114, v114
ds_read_u16_d16_hi v115, v115
v_pk_mul_f16 v123, v122, v123
v_fma_mix_f32 v232, v166, v166, v232 op_sel_hi:[1,1,0]
v_pk_mul_f16 v125, v124, v125
v_fma_mix_f32 v232, v167, v167, v232 op_sel_hi:[1,1,0]
s_add_u32 m0, s72, 7168
s_add_u32 s43, s82, 6208
buffer_load_dwordx4 v246, s[16:19], s43 offen lds
v_pk_mul_f16 v127, v126, v127
v_cvt_pkrtz_f16_f32 v117, v116, v117
v_and_b32_e64 v117, s49, v117
v_bfe_u32 v116, v117, 2, 14
v_lshrrev_b32 v117, 18, v117
v_exp_f16_sdwa v123, v123 dst_sel:WORD_0 dst_unused:UNUSED_PRESERVE src0_sel:WORD_0
s_waitcnt lgkmcnt(5)
v_mfma_f32_32x32x16_bf16 v[128:143], v[64:67], v[184:187], v[128:143]
ds_read_u16 v116, v116
ds_read_u16_d16_hi v117, v117
v_fma_mix_f32 v232, v168, v168, v232 op_sel_hi:[1,1,0]
v_exp_f16_sdwa v125, v125 dst_sel:WORD_0 dst_unused:UNUSED_PRESERVE src0_sel:WORD_0
v_fma_mix_f32 v232, v169, v169, v232 op_sel_hi:[1,1,0]
v_cvt_pkrtz_f16_f32 v119, v118, v119
v_and_b32_e64 v119, s49, v119
v_bfe_u32 v118, v119, 2, 14
v_lshrrev_b32_e64 v119, 18, v119
v_exp_f16_sdwa v127, v127 dst_sel:WORD_0 dst_unused:UNUSED_PRESERVE src0_sel:WORD_0
v_fma_mix_f32 v232, v170, v170, v232 op_sel_hi:[1,1,0]
v_exp_f16_sdwa v123, v123 dst_sel:WORD_1 dst_unused:UNUSED_PRESERVE src0_sel:WORD_1
v_fma_mix_f32 v232, v171, v171, v232 op_sel_hi:[1,1,0]
v_mfma_f32_32x32x16_bf16 v[96:111], v[88:91], v[184:187], v[96:111]
ds_read_u16 v118, v118
ds_read_u16_d16_hi v119, v119
ds_read_b128 v[180:183], v250 offset:62464
v_exp_f16_sdwa v125, v125 dst_sel:WORD_1 dst_unused:UNUSED_PRESERVE src0_sel:WORD_1
v_cvt_pkrtz_f16_f32 v121, v120, v121
v_and_b32_e64 v121, s49, v121
v_bfe_u32 v120, v121, 2, 14
v_lshrrev_b32_e64 v121, 18, v121
v_exp_f16_sdwa v127, v127 dst_sel:WORD_1 dst_unused:UNUSED_PRESERVE src0_sel:WORD_1
v_pk_add_f16 v123, v123, 1.0 op_sel_hi:[1,0]
v_pk_add_f16 v125, v125, 1.0 op_sel_hi:[1,0]
v_mfma_f32_32x32x16_bf16 v[128:143], v[68:71], v[188:191], v[128:143]
ds_read_u16 v120, v120
ds_read_u16_d16_hi v121, v121
v_pk_add_f16 v127, v127, 1.0 op_sel_hi:[1,0]
v_rcp_f16_sdwa v123, v123 dst_sel:WORD_0 dst_unused:UNUSED_PRESERVE src0_sel:WORD_0
v_rcp_f16_sdwa v125, v125 dst_sel:WORD_0 dst_unused:UNUSED_PRESERVE src0_sel:WORD_0
v_rcp_f16_sdwa v127, v127 dst_sel:WORD_0 dst_unused:UNUSED_PRESERVE src0_sel:WORD_0
v_mfma_f32_32x32x16_bf16 v[96:111], v[92:95], v[188:191], v[96:111]
ds_read_b128 v[184:187], v250 offset:63488
v_rcp_f16_sdwa v123, v123 dst_sel:WORD_1 dst_unused:UNUSED_PRESERVE src0_sel:WORD_1
v_rcp_f16_sdwa v125, v125 dst_sel:WORD_1 dst_unused:UNUSED_PRESERVE src0_sel:WORD_1
v_rcp_f16_sdwa v127, v127 dst_sel:WORD_1 dst_unused:UNUSED_PRESERVE src0_sel:WORD_1
s_waitcnt lgkmcnt(5)
v_or_b32 v224, v112, v113
v_mfma_f32_32x32x16_bf16 v[144:159], v[48:51], v[176:179], 0
v_pk_mul_f16 v227, v122, v123
v_pk_mul_f16 v230, v124, v125
v_pk_mul_f16 v231, v126, v127
v_cvt_pkrtz_f16_f32 v129, v128, v129
v_and_b32_e64 v129, s49, v129
v_bfe_u32 v128, v129, 2, 14
v_lshrrev_b32_e64 v129, 18, v129
v_cvt_pk_f16_f32 v140, v140, v141
v_or_b32_e64 v225, v114, v115
v_cvt_pk_f16_f32 v142, v142, v143
v_mfma_f32_32x32x16_bf16 v[160:175], v[176:179], v[72:75], 0
ds_read_u16 v128, v128
ds_read_u16 v129, v129
v_pk_fma_f16 v141, v140, v140, s48
v_cvt_pkrtz_f16_f32 v131, v130, v131
v_and_b32_e64 v131, s49, v131
v_bfe_u32 v130, v131, 2, 14
v_lshrrev_b32_e64 v131, 18, v131
v_pk_fma_f16 v143, v142, v142, s48
v_or_b32_e64 v228, v116, v117
v_pk_mul_f16 v141, v140, v141
v_pk_mul_f16 v143, v142, v143
v_cvt_pkrtz_f16_f32 v133, v132, v133
v_and_b32_e64 v133, s49, v133
ds_read_u16 v130, v130
ds_read_u16 v131, v131
ds_read_b128 v[188:191], v250 offset:64512
v_bfe_u32 v132, v133, 2, 14
v_lshrrev_b32_e64 v133, 18, v133
v_exp_f16_sdwa v141, v141 dst_sel:WORD_0 dst_unused:UNUSED_PRESERVE src0_sel:WORD_0
s_waitcnt lgkmcnt(5)
v_or_b32 v229, v118, v119
v_mfma_f32_32x32x16_bf16 v[144:159], v[52:55], v[180:183], v[144:159]
ds_read_u16 v132, v132
ds_read_u16 v133, v133
v_exp_f16_sdwa v143, v143 dst_sel:WORD_0 dst_unused:UNUSED_PRESERVE src0_sel:WORD_0
v_cvt_pkrtz_f16_f32 v135, v134, v135
v_and_b32_e64 v135, s49, v135
v_bfe_u32 v134, v135, 2, 14
v_lshrrev_b32_e64 v135, 18, v135
v_exp_f16_sdwa v141, v141 dst_sel:WORD_1 dst_unused:UNUSED_PRESERVE src0_sel:WORD_1
v_or_b32_e64 v226, v120, v121
v_cvt_pkrtz_f16_f32 v137, v136, v137
v_and_b32_e64 v137, s49, v137
v_bfe_u32 v136, v137, 2, 14
v_lshrrev_b32_e64 v137, 18, v137
ds_read_u16 v134, v134
ds_read_u16 v135, v135
ds_read_u16 v136, v136
ds_read_u16 v137, v137
v_mfma_f32_32x32x16_bf16 v[160:175], v[180:183], v[76:79], v[160:175]
v_exp_f16_sdwa v143, v143 dst_sel:WORD_1 dst_unused:UNUSED_PRESERVE src0_sel:WORD_1
v_cvt_pkrtz_f16_f32 v139, v138, v139
v_and_b32_e64 v139, s49, v139
v_bfe_u32 v138, v139, 2, 14
v_mfma_f32_32x32x16_f16 v[112:127], v[224:227], v[216:219], 0
ds_read_b128 v[176:179], v251
v_lshrrev_b32_e64 v139, 18, v139
v_pk_add_f16 v141, v141, 1.0 op_sel_hi:[1,0]
v_pk_add_f16 v143, v143, 1.0 op_sel_hi:[1,0]
v_rcp_f16_sdwa v141, v141 dst_sel:WORD_0 dst_unused:UNUSED_PRESERVE src0_sel:WORD_0
v_mfma_f32_32x32x16_f16 v[112:127], v[228:231], v[220:223], v[112:127]
ds_read_u16 v138, v138
ds_read_u16 v139, v139
v_permlane16_swap_b32 v224, v228
v_permlane16_swap_b32 v225, v229
v_permlane16_swap_b32 v226, v230
v_permlane16_swap_b32 v227, v231
v_mfma_f32_32x32x16_bf16 v[144:159], v[56:59], v[184:187], v[144:159]
v_rcp_f16_sdwa v143, v143 dst_sel:WORD_0 dst_unused:UNUSED_PRESERVE src0_sel:WORD_0
v_rcp_f16_sdwa v141, v141 dst_sel:WORD_1 dst_unused:UNUSED_PRESERVE src0_sel:WORD_1
v_rcp_f16_sdwa v143, v143 dst_sel:WORD_1 dst_unused:UNUSED_PRESERVE src0_sel:WORD_1
v_mfma_f32_32x32x16_bf16 v[160:175], v[184:187], v[80:83], v[160:175]
ds_read_b128 v[180:183], v251 offset:1024
v_fmac_f32_e64 v232, v112, v112
v_pk_mul_f16 v140, v140, v141
v_fmac_f32_e64 v232, v113, v113
v_pk_mul_f16 v142, v142, v143
v_fmac_f32 v232, v114, v114
v_fmac_f32 v232, v115, v115
v_fma_mix_f32 v233, v140, v140, v233 op_sel_hi:[1,1,0]
v_fmac_f32 v232, v116, v116
v_fmac_f32 v232, v117, v117
v_fma_mix_f32 v233, v142, v142, v233 op_sel_hi:[1,1,0]
s_waitcnt lgkmcnt(6)
v_mfma_f32_32x32x16_bf16 v[144:159], v[60:63], v[188:191], v[144:159]
v_fmac_f32 v232, v118, v118
v_fma_mix_f32 v233, v140, v140, v233 op_sel:[1,1,0] op_sel_hi:[1,1,0]
v_fmac_f32 v232, v119, v119
v_fmac_f32 v232, v120, v120
v_fma_mix_f32 v233, v142, v142, v233 op_sel:[1,1,0] op_sel_hi:[1,1,0]
v_fmac_f32_e64 v232, v121, v121
v_fma_mix_f32 v233, v128, v128, v233 op_sel_hi:[1,1,0]
v_fmac_f32_e64 v232, v122, v122
v_fma_mix_f32 v233, v129, v129, v233 op_sel_hi:[1,1,0]
v_cvt_pkrtz_f16_f32 v97, v96, v97
v_fma_mix_f32 v233, v130, v130, v233 op_sel_hi:[1,1,0]
v_and_b32_e64 v97, s49, v97
v_fma_mix_f32 v233, v131, v131, v233 op_sel_hi:[1,1,0]
v_bfe_u32 v96, v97, 2, 14
v_lshrrev_b32_e64 v97, 18, v97
v_cvt_pk_f16_f32 v106, v106, v107
v_fmac_f32_e64 v232, v123, v123
v_cvt_pk_f16_f32 v108, v108, v109
v_fmac_f32_e64 v232, v124, v124
v_cvt_pk_f16_f32 v110, v110, v111
v_fmac_f32_e64 v232, v125, v125
ds_read_u16 v96, v96
ds_read_u16 v97, v97
v_mfma_f32_32x32x16_bf16 v[160:175], v[188:191], v[84:87], v[160:175]
v_pk_fma_f16 v107, v106, v106, s48
v_fmac_f32_e64 v232, v126, v126
v_fma_mix_f32 v233, v132, v132, v233 op_sel_hi:[1,1,0]
v_pk_fma_f16 v109, v108, v108, s48
v_fma_mix_f32 v233, v133, v133, v233 op_sel_hi:[1,1,0]
v_fmac_f32_e64 v232, v127, v127
v_cvt_pkrtz_f16_f32 v99, v98, v99
v_and_b32_e64 v99, s49, v99
v_bfe_u32 v98, v99, 2, 14
v_lshrrev_b32_e64 v99, 18, v99
v_pk_fma_f16 v111, v110, v110, s48
v_pk_mul_f16 v107, v106, v107
ds_read_b128 v[184:187], v251 offset:2048
ds_read_u16 v98, v98
ds_read_u16 v99, v99
v_pk_mul_f16 v109, v108, v109
v_fma_mix_f32 v233, v134, v134, v233 op_sel_hi:[1,1,0]
v_pk_mul_f16 v111, v110, v111
v_fma_mix_f32 v233, v135, v135, v233 op_sel_hi:[1,1,0]
v_exp_f16_sdwa v107, v107 dst_sel:WORD_0 dst_unused:UNUSED_PRESERVE src0_sel:WORD_0
v_cvt_pkrtz_f16_f32 v101, v100, v101
v_and_b32_e64 v101, s49, v101
v_bfe_u32 v100, v101, 2, 14
v_lshrrev_b32 v101, 18, v101
s_waitcnt lgkmcnt(5)
v_mfma_f32_32x32x16_bf16 v[144:159], v[64:67], v[176:179], v[144:159]
ds_read_u16 v100, v100
ds_read_u16 v101, v101
v_exp_f16_sdwa v109, v109 dst_sel:WORD_0 dst_unused:UNUSED_PRESERVE src0_sel:WORD_0
v_fma_mix_f32 v233, v136, v136, v233 op_sel_hi:[1,1,0]
v_exp_f16_sdwa v111, v111 dst_sel:WORD_0 dst_unused:UNUSED_PRESERVE src0_sel:WORD_0
v_fma_mix_f32 v233, v137, v137, v233 op_sel_hi:[1,1,0]
v_cvt_pkrtz_f16_f32 v103, v102, v103
v_and_b32_e64 v103, s49, v103
v_bfe_u32 v102, v103, 2, 14
v_lshrrev_b32_e64 v103, 18, v103
v_exp_f16_sdwa v107, v107 dst_sel:WORD_1 dst_unused:UNUSED_PRESERVE src0_sel:WORD_1
v_fma_mix_f32 v233, v138, v138, v233 op_sel_hi:[1,1,0]
v_exp_f16_sdwa v109, v109 dst_sel:WORD_1 dst_unused:UNUSED_PRESERVE src0_sel:WORD_1
v_fma_mix_f32 v233, v139, v139, v233 op_sel_hi:[1,1,0]
v_mfma_f32_32x32x16_bf16 v[160:175], v[176:179], v[88:91], v[160:175]
ds_read_u16 v102, v102
ds_read_u16 v103, v103
v_exp_f16_sdwa v111, v111 dst_sel:WORD_1 dst_unused:UNUSED_PRESERVE src0_sel:WORD_1
v_cvt_pkrtz_f16_f32 v105, v104, v105
v_and_b32_e64 v105, s49, v105
v_bfe_u32 v104, v105, 2, 14
v_lshrrev_b32_e64 v105, 18, v105
v_pk_add_f16 v107, v107, 1.0 op_sel_hi:[1,0]
v_pk_add_f16 v109, v109, 1.0 op_sel_hi:[1,0]
ds_read_b128 v[188:191], v251 offset:3072
ds_read_u16 v104, v104
ds_read_u16 v105, v105
v_pk_add_f16 v111, v111, 1.0 op_sel_hi:[1,0]
v_rcp_f16_sdwa v107, v107 dst_sel:WORD_0 dst_unused:UNUSED_PRESERVE src0_sel:WORD_0
v_mfma_f32_32x32x16_bf16 v[144:159], v[68:71], v[180:183], v[144:159]
v_rcp_f16_sdwa v109, v109 dst_sel:WORD_0 dst_unused:UNUSED_PRESERVE src0_sel:WORD_0
v_rcp_f16_sdwa v111, v111 dst_sel:WORD_0 dst_unused:UNUSED_PRESERVE src0_sel:WORD_0
v_rcp_f16_sdwa v107, v107 dst_sel:WORD_1 dst_unused:UNUSED_PRESERVE src0_sel:WORD_1
v_rcp_f16_sdwa v109, v109 dst_sel:WORD_1 dst_unused:UNUSED_PRESERVE src0_sel:WORD_1
v_mfma_f32_32x32x16_bf16 v[160:175], v[180:183], v[92:95], v[160:175]
v_rcp_f16_sdwa v111, v111 dst_sel:WORD_1 dst_unused:UNUSED_PRESERVE src0_sel:WORD_1
v_pk_mul_f16 v106, v106, v107
v_pk_mul_f16 v108, v108, v109
v_pk_mul_f16 v110, v110, v111
v_fma_mix_f32 v233, v106, v106, v233 op_sel_hi:[1,1,0]
s_waitcnt lgkmcnt(4)
v_mfma_f32_32x32x16_bf16 v[112:127], v[48:51], v[184:187], 0
ds_read_b128 v[176:179], v251 offset:4096
v_fma_mix_f32 v233, v108, v108, v233 op_sel_hi:[1,1,0]
v_bfe_u32 v237, v250, 4, 6
v_min_u32 v237, 47, v237
v_lshlrev_b32_e64 v244, 5, v237
v_add_u32 v244, 95232, v244
v_add_u32 v245, 2304, v244
v_cmp_gt_u32 vcc, 24, v237
s_nop 1
v_cndmask_b32 v244, v245, v244, vcc
v_lshlrev_b32 v237, 13, v237
v_add_u32 v245, 4096, v237
v_fma_mix_f32 v233, v110, v110, v233 op_sel_hi:[1,1,0]
v_cvt_pkrtz_f16_f32 v145, v144, v145
v_fma_mix_f32 v233, v106, v106, v233 op_sel:[1,1,0] op_sel_hi:[1,1,0]
v_and_b32_e64 v145, s49, v145
v_fma_mix_f32 v233, v108, v108, v233 op_sel:[1,1,0] op_sel_hi:[1,1,0]
v_bfe_u32 v144, v145, 2, 14
v_fma_mix_f32 v233, v110, v110, v233 op_sel:[1,1,0] op_sel_hi:[1,1,0]
v_lshrrev_b32_e64 v145, 18, v145
v_fma_mix_f32 v233, v96, v96, v233 op_sel_hi:[1,1,0]
v_cvt_pk_f16_f32 v156, v156, v157
v_fma_mix_f32 v233, v97, v97, v233 op_sel_hi:[1,1,0]
v_cvt_pk_f16_f32 v158, v158, v159
v_fma_mix_f32 v233, v98, v98, v233 op_sel_hi:[1,1,0]
v_mfma_f32_32x32x16_bf16 v[128:143], v[184:187], v[72:75], 0
ds_read_u16 v144, v144
ds_read_u16 v145, v145
v_fma_mix_f32 v233, v99, v99, v233 op_sel_hi:[1,1,0]
v_pk_fma_f16 v157, v156, v156, s48
v_cvt_pkrtz_f16_f32 v147, v146, v147
v_and_b32_e64 v147, s49, v147
v_bfe_u32 v146, v147, 2, 14
v_lshrrev_b32_e64 v147, 18, v147
v_pk_fma_f16 v159, v158, v158, s48
v_fma_mix_f32 v233, v100, v100, v233 op_sel_hi:[1,1,0]
v_pk_mul_f16 v157, v156, v157
v_fma_mix_f32 v233, v101, v101, v233 op_sel_hi:[1,1,0]
v_pk_mul_f16 v159, v158, v159
v_cvt_pkrtz_f16_f32 v149, v148, v149
ds_read_u16 v146, v146
ds_read_u16 v147, v147
ds_read_b128 v[180:183], v251 offset:5120
v_and_b32_e64 v149, s49, v149
v_bfe_u32 v148, v149, 2, 14
v_lshrrev_b32 v149, 18, v149
v_exp_f16_sdwa v157, v157 dst_sel:WORD_0 dst_unused:UNUSED_PRESERVE src0_sel:WORD_0
v_fma_mix_f32 v233, v102, v102, v233 op_sel_hi:[1,1,0]
s_waitcnt lgkmcnt(5)
v_mfma_f32_32x32x16_bf16 v[112:127], v[52:55], v[188:191], v[112:127]
ds_read_u16 v148, v148
ds_read_u16 v149, v149
v_fma_mix_f32 v233, v103, v103, v233 op_sel_hi:[1,1,0]
v_exp_f16_sdwa v159, v159 dst_sel:WORD_0 dst_unused:UNUSED_PRESERVE src0_sel:WORD_0
v_cvt_pkrtz_f16_f32 v151, v150, v151
v_and_b32_e64 v151, s49, v151
v_bfe_u32 v150, v151, 2, 14
v_lshrrev_b32_e64 v151, 18, v151
v_exp_f16_sdwa v157, v157 dst_sel:WORD_1 dst_unused:UNUSED_PRESERVE src0_sel:WORD_1
v_fma_mix_f32 v233, v104, v104, v233 op_sel_hi:[1,1,0]
v_cvt_pkrtz_f16_f32 v153, v152, v153
v_fma_mix_f32 v233, v105, v105, v233 op_sel_hi:[1,1,0]
v_and_b32_e64 v153, s49, v153
v_bfe_u32 v152, v153, 2, 14
ds_read_u16 v150, v150
ds_read_u16 v151, v151
v_lshrrev_b32_e64 v153, 18, v153
v_mfma_f32_32x32x16_bf16 v[128:143], v[188:191], v[76:79], v[128:143]
ds_read_u16 v152, v152
ds_read_u16 v153, v153
v_exp_f16_sdwa v159, v159 dst_sel:WORD_1 dst_unused:UNUSED_PRESERVE src0_sel:WORD_1
v_cvt_pkrtz_f16_f32 v155, v154, v155
v_and_b32_e64 v155, s49, v155
v_bfe_u32 v154, v155, 2, 14
v_lshrrev_b32_e64 v155, 18, v155
v_pk_add_f16 v157, v157, 1.0 op_sel_hi:[1,0]
v_pk_add_f16 v159, v159, 1.0 op_sel_hi:[1,0]
ds_read_b128 v[184:187], v251 offset:6144
ds_read_u16 v154, v154
ds_read_u16 v155, v155
v_rcp_f16_sdwa v157, v157 dst_sel:WORD_0 dst_unused:UNUSED_PRESERVE src0_sel:WORD_0
v_mfma_f32_32x32x16_bf16 v[112:127], v[56:59], v[176:179], v[112:127]
v_rcp_f16_sdwa v159, v159 dst_sel:WORD_0 dst_unused:UNUSED_PRESERVE src0_sel:WORD_0
v_rcp_f16_sdwa v157, v157 dst_sel:WORD_1 dst_unused:UNUSED_PRESERVE src0_sel:WORD_1
v_rcp_f16_sdwa v159, v159 dst_sel:WORD_1 dst_unused:UNUSED_PRESERVE src0_sel:WORD_1
v_mfma_f32_32x32x16_bf16 v[128:143], v[176:179], v[80:83], v[128:143]
ds_read_b128 v[188:191], v251 offset:7168
v_pk_mul_f16 v156, v156, v157
v_pk_mul_f16 v158, v158, v159
v_fma_mix_f32 v234, v156, v156, v234 op_sel_hi:[1,1,0]
v_permlane32_swap_b32 v232, v233
v_fma_mix_f32 v234, v158, v158, v234 op_sel_hi:[1,1,0]
s_waitcnt lgkmcnt(8)
v_mfma_f32_32x32x16_bf16 v[112:127], v[60:63], v[180:183], v[112:127]
v_add_f32 v232, v232, v233
s_setprio 1
ds_write_b32 v248, v232 offset:8448
v_fma_mix_f32 v234, v156, v156, v234 op_sel:[1,1,0] op_sel_hi:[1,1,0]
v_cvt_pkrtz_f16_f32 v161, v160, v161
v_fma_mix_f32 v234, v158, v158, v234 op_sel:[1,1,0] op_sel_hi:[1,1,0]
v_and_b32_e64 v161, s49, v161
v_fma_mix_f32 v234, v144, v144, v234 op_sel_hi:[1,1,0]
v_bfe_u32 v160, v161, 2, 14
v_fma_mix_f32 v234, v145, v145, v234 op_sel_hi:[1,1,0]
v_lshrrev_b32_e64 v161, 18, v161
v_fma_mix_f32 v234, v146, v146, v234 op_sel_hi:[1,1,0]
v_cvt_pk_f16_f32 v170, v170, v171
v_fma_mix_f32 v234, v147, v147, v234 op_sel_hi:[1,1,0]
v_cvt_pk_f16_f32 v172, v172, v173
v_cvt_pk_f16_f32 v174, v174, v175
v_mfma_f32_32x32x16_bf16 v[128:143], v[180:183], v[84:87], v[128:143]
ds_read_u16 v160, v160
ds_read_u16_d16_hi v161, v161
v_pk_fma_f16 v171, v170, v170, s48
v_fma_mix_f32 v234, v148, v148, v234 op_sel_hi:[1,1,0]
v_pk_fma_f16 v173, v172, v172, s48
v_fma_mix_f32 v234, v149, v149, v234 op_sel_hi:[1,1,0]
v_cvt_pkrtz_f16_f32 v163, v162, v163
v_and_b32_e64 v163, s49, v163
v_bfe_u32 v162, v163, 2, 14
v_lshrrev_b32 v163, 18, v163
v_pk_fma_f16 v175, v174, v174, s48
v_pk_mul_f16 v171, v170, v171
s_waitcnt lgkmcnt(6)
v_fma_mix_f32 v234, v150, v150, v234 op_sel_hi:[1,1,0]
v_pk_mul_f16 v173, v172, v173
v_fma_mix_f32 v234, v151, v151, v234 op_sel_hi:[1,1,0]
v_pk_mul_f16 v175, v174, v175
ds_read_u16 v162, v162
ds_read_u16_d16_hi v163, v163
v_cvt_pkrtz_f16_f32 v165, v164, v165
v_and_b32_e64 v165, s49, v165
v_bfe_u32 v164, v165, 2, 14
v_lshrrev_b32_e64 v165, 18, v165
v_exp_f16_sdwa v171, v171 dst_sel:WORD_0 dst_unused:UNUSED_PRESERVE src0_sel:WORD_0
v_mfma_f32_32x32x16_bf16 v[112:127], v[64:67], v[184:187], v[112:127]
ds_read_u16 v164, v164
ds_read_u16_d16_hi v165, v165
v_fma_mix_f32 v234, v152, v152, v234 op_sel_hi:[1,1,0]
v_exp_f16_sdwa v173, v173 dst_sel:WORD_0 dst_unused:UNUSED_PRESERVE src0_sel:WORD_0
v_fma_mix_f32 v234, v153, v153, v234 op_sel_hi:[1,1,0]
v_cvt_pkrtz_f16_f32 v167, v166, v167
v_and_b32_e64 v167, s49, v167
v_bfe_u32 v166, v167, 2, 14
v_lshrrev_b32 v167, 18, v167
v_exp_f16_sdwa v175, v175 dst_sel:WORD_0 dst_unused:UNUSED_PRESERVE src0_sel:WORD_0
s_waitcnt lgkmcnt(5)
v_fma_mix_f32 v234, v154, v154, v234 op_sel_hi:[1,1,0]
v_exp_f16_sdwa v171, v171 dst_sel:WORD_1 dst_unused:UNUSED_PRESERVE src0_sel:WORD_1
v_fma_mix_f32 v234, v155, v155, v234 op_sel_hi:[1,1,0]
v_mfma_f32_32x32x16_bf16 v[128:143], v[184:187], v[88:91], v[128:143]
ds_read_u16 v166, v166
ds_read_u16_d16_hi v167, v167
v_exp_f16_sdwa v173, v173 dst_sel:WORD_1 dst_unused:UNUSED_PRESERVE src0_sel:WORD_1
v_cvt_pkrtz_f16_f32 v169, v168, v169
v_and_b32_e64 v169, s49, v169
v_bfe_u32 v168, v169, 2, 14
v_lshrrev_b32_e64 v169, 18, v169
v_exp_f16_sdwa v175, v175 dst_sel:WORD_1 dst_unused:UNUSED_PRESERVE src0_sel:WORD_1
v_pk_add_f16 v171, v171, 1.0 op_sel_hi:[1,0]
v_pk_add_f16 v173, v173, 1.0 op_sel_hi:[1,0]
v_mfma_f32_32x32x16_bf16 v[112:127], v[68:71], v[188:191], v[112:127]
ds_read_u16 v168, v168
ds_read_u16_d16_hi v169, v169
v_pk_add_f16 v175, v175, 1.0 op_sel_hi:[1,0]
v_rcp_f16_sdwa v171, v171 dst_sel:WORD_0 dst_unused:UNUSED_PRESERVE src0_sel:WORD_0
v_rcp_f16_sdwa v173, v173 dst_sel:WORD_0 dst_unused:UNUSED_PRESERVE src0_sel:WORD_0
v_rcp_f16_sdwa v175, v175 dst_sel:WORD_0 dst_unused:UNUSED_PRESERVE src0_sel:WORD_0
v_mfma_f32_32x32x16_bf16 v[128:143], v[188:191], v[92:95], v[128:143]
v_rcp_f16_sdwa v171, v171 dst_sel:WORD_1 dst_unused:UNUSED_PRESERVE src0_sel:WORD_1
v_rcp_f16_sdwa v173, v173 dst_sel:WORD_1 dst_unused:UNUSED_PRESERVE src0_sel:WORD_1
v_rcp_f16_sdwa v175, v175 dst_sel:WORD_1 dst_unused:UNUSED_PRESERVE src0_sel:WORD_1
s_waitcnt lgkmcnt(4)
v_or_b32 v96, v160, v161
v_pk_mul_f16 v99, v170, v171
v_pk_mul_f16 v102, v172, v173
v_pk_mul_f16 v103, v174, v175
v_or_b32_e64 v97, v162, v163
v_or_b32 v100, v164, v165
s_nop 1
v_cvt_pkrtz_f16_f32 v129, v128, v129
v_and_b32_e64 v129, s49, v129
v_bfe_u32 v128, v129, 2, 14
v_lshrrev_b32_e64 v129, 18, v129
v_cvt_pk_f16_f32 v138, v138, v139
v_cvt_pk_f16_f32 v140, v140, v141
v_cvt_pk_f16_f32 v142, v142, v143
v_pk_fma_f16 v139, v138, v138, s48
v_pk_fma_f16 v141, v140, v140, s48
v_cvt_pkrtz_f16_f32 v131, v130, v131
ds_read_u16 v128, v128
ds_read_u16_d16_hi v129, v129
ds_read_b128 v[176:179], v250
v_and_b32_e64 v131, s49, v131
v_bfe_u32 v130, v131, 2, 14
v_lshrrev_b32_e64 v131, 18, v131
v_pk_fma_f16 v143, v142, v142, s48
v_pk_mul_f16 v139, v138, v139
v_pk_mul_f16 v141, v140, v141
v_pk_mul_f16 v143, v142, v143
v_cvt_pkrtz_f16_f32 v133, v132, v133
v_and_b32_e64 v133, s49, v133
ds_read_u16 v130, v130
ds_read_u16_d16_hi v131, v131
v_bfe_u32 v132, v133, 2, 14
v_lshrrev_b32 v133, 18, v133
s_waitcnt lgkmcnt(5)
v_or_b32_e64 v101, v166, v167
v_exp_f16_sdwa v139, v139 dst_sel:WORD_0 dst_unused:UNUSED_PRESERVE src0_sel:WORD_0
v_exp_f16_sdwa v141, v141 dst_sel:WORD_0 dst_unused:UNUSED_PRESERVE src0_sel:WORD_0
v_cvt_pkrtz_f16_f32 v135, v134, v135
v_and_b32_e64 v135, s49, v135
v_bfe_u32 v134, v135, 2, 14
ds_read_u16 v132, v132
ds_read_u16_d16_hi v133, v133
ds_read_b128 v[180:183], v250 offset:1024
v_lshrrev_b32_e64 v135, 18, v135
v_exp_f16_sdwa v143, v143 dst_sel:WORD_0 dst_unused:UNUSED_PRESERVE src0_sel:WORD_0
v_or_b32_e64 v98, v168, v169
v_exp_f16_sdwa v139, v139 dst_sel:WORD_1 dst_unused:UNUSED_PRESERVE src0_sel:WORD_1
v_exp_f16_sdwa v141, v141 dst_sel:WORD_1 dst_unused:UNUSED_PRESERVE src0_sel:WORD_1
v_cvt_pkrtz_f16_f32 v137, v136, v137
v_and_b32_e64 v137, s49, v137
ds_read_u16 v134, v134
ds_read_u16_d16_hi v135, v135
ds_read_b128 v[184:187], v250 offset:2048
v_bfe_u32 v136, v137, 2, 14
v_lshrrev_b32_e64 v137, 18, v137
v_mfma_f32_32x32x16_f16 v[160:175], v[96:99], v[216:219], 0
ds_read_u16 v136, v136
ds_read_u16_d16_hi v137, v137
v_exp_f16_sdwa v143, v143 dst_sel:WORD_1 dst_unused:UNUSED_PRESERVE src0_sel:WORD_1
v_pk_add_f16 v139, v139, 1.0 op_sel_hi:[1,0]
v_pk_add_f16 v141, v141, 1.0 op_sel_hi:[1,0]
v_mfma_f32_32x32x16_f16 v[160:175], v[100:103], v[220:223], v[160:175]
v_pk_add_f16 v143, v143, 1.0 op_sel_hi:[1,0]
v_permlane16_swap_b32 v96, v100
v_permlane16_swap_b32 v97, v101
v_permlane16_swap_b32 v98, v102
v_permlane16_swap_b32 v99, v103
v_rcp_f16_sdwa v139, v139 dst_sel:WORD_0 dst_unused:UNUSED_PRESERVE src0_sel:WORD_0
v_rcp_f16_sdwa v141, v141 dst_sel:WORD_0 dst_unused:UNUSED_PRESERVE src0_sel:WORD_0
v_rcp_f16_sdwa v143, v143 dst_sel:WORD_0 dst_unused:UNUSED_PRESERVE src0_sel:WORD_0
v_rcp_f16_sdwa v139, v139 dst_sel:WORD_1 dst_unused:UNUSED_PRESERVE src0_sel:WORD_1
s_nop 2
v_fmac_f32 v234, v160, v160
v_fmac_f32_e64 v234, v161, v161
ds_read_b128 v[188:191], v250 offset:3072
v_rcp_f16_sdwa v141, v141 dst_sel:WORD_1 dst_unused:UNUSED_PRESERVE src0_sel:WORD_1
v_fmac_f32 v234, v162, v162
v_fmac_f32 v234, v163, v163
v_rcp_f16_sdwa v143, v143 dst_sel:WORD_1 dst_unused:UNUSED_PRESERVE src0_sel:WORD_1
v_fmac_f32 v234, v164, v164
v_fmac_f32 v234, v165, v165
s_waitcnt lgkmcnt(6)
v_or_b32 v104, v128, v129
v_mfma_f32_32x32x16_bf16 v[144:159], v[176:179], v[72:75], 0
ds_read_b128 v[176:179], v250 offset:4096
v_fmac_f32_e64 v234, v166, v166
v_pk_mul_f16 v107, v138, v139
v_fmac_f32_e64 v234, v167, v167
v_pk_mul_f16 v110, v140, v141
v_fmac_f32_e64 v234, v168, v168
v_pk_mul_f16 v111, v142, v143
v_fmac_f32 v234, v169, v169
v_fmac_f32 v234, v170, v170
v_cvt_pkrtz_f16_f32 v113, v112, v113
v_and_b32_e64 v113, s49, v113
v_bfe_u32 v112, v113, 2, 14
v_lshrrev_b32_e64 v113, 18, v113
v_cvt_pk_f16_f32 v124, v124, v125
v_or_b32 v105, v130, v131
v_fmac_f32 v234, v171, v171
v_cvt_pk_f16_f32 v126, v126, v127
v_fmac_f32 v234, v172, v172
v_fmac_f32 v234, v173, v173
ds_read_u16 v112, v112
ds_read_u16 v113, v113
v_mfma_f32_32x32x16_bf16 v[144:159], v[180:183], v[76:79], v[144:159]
ds_read_b128 v[180:183], v250 offset:5120
v_pk_fma_f16 v125, v124, v124, s48
v_fmac_f32_e64 v234, v174, v174
v_cvt_pkrtz_f16_f32 v115, v114, v115
v_and_b32_e64 v115, s49, v115
v_bfe_u32 v114, v115, 2, 14
v_lshrrev_b32 v115, 18, v115
v_fmac_f32 v234, v175, v175
v_pk_fma_f16 v127, v126, v126, s48
v_or_b32_e64 v108, v132, v133
v_pk_mul_f16 v125, v124, v125
v_pk_mul_f16 v127, v126, v127
v_cvt_pkrtz_f16_f32 v117, v116, v117
ds_read_u16 v114, v114
ds_read_u16 v115, v115
v_and_b32_e64 v117, s49, v117
v_bfe_u32 v116, v117, 2, 14
v_lshrrev_b32_e64 v117, 18, v117
v_exp_f16_sdwa v125, v125 dst_sel:WORD_0 dst_unused:UNUSED_PRESERVE src0_sel:WORD_0
s_waitcnt lgkmcnt(5)
v_or_b32 v109, v134, v135
v_mfma_f32_32x32x16_bf16 v[144:159], v[184:187], v[80:83], v[144:159]
ds_read_u16 v116, v116
ds_read_u16 v117, v117
ds_read_b128 v[184:187], v250 offset:6144
v_exp_f16_sdwa v127, v127 dst_sel:WORD_0 dst_unused:UNUSED_PRESERVE src0_sel:WORD_0
v_cvt_pkrtz_f16_f32 v119, v118, v119
v_and_b32_e64 v119, s49, v119
v_bfe_u32 v118, v119, 2, 14
v_lshrrev_b32_e64 v119, 18, v119
v_exp_f16_sdwa v125, v125 dst_sel:WORD_1 dst_unused:UNUSED_PRESERVE src0_sel:WORD_1
v_or_b32_e64 v106, v136, v137
v_cvt_pkrtz_f16_f32 v121, v120, v121
v_and_b32_e64 v121, s49, v121
v_bfe_u32 v120, v121, 2, 14
v_lshrrev_b32_e64 v121, 18, v121
ds_read_u16 v118, v118
ds_read_u16 v119, v119
ds_read_u16 v120, v120
ds_read_u16 v121, v121
v_mfma_f32_32x32x16_bf16 v[144:159], v[188:191], v[84:87], v[144:159]
ds_read_b128 v[188:191], v250 offset:7168
s_waitcnt vmcnt(0)
v_exp_f16_sdwa v127, v127 dst_sel:WORD_1 dst_unused:UNUSED_PRESERVE src0_sel:WORD_1
v_cvt_pkrtz_f16_f32 v123, v122, v123
v_and_b32 v123, s49, v123
v_mfma_f32_32x32x16_f16 v[128:143], v[104:107], v[216:219], 0
v_bfe_u32 v122, v123, 2, 14
v_lshrrev_b32_e64 v123, 18, v123
v_pk_add_f16 v125, v125, 1.0 op_sel_hi:[1,0]
v_pk_add_f16 v127, v127, 1.0 op_sel_hi:[1,0]
v_rcp_f16_sdwa v125, v125 dst_sel:WORD_0 dst_unused:UNUSED_PRESERVE src0_sel:WORD_0
v_mfma_f32_32x32x16_f16 v[128:143], v[108:111], v[220:223], v[128:143]
ds_read_u16 v122, v122
ds_read_u16 v123, v123
v_permlane16_swap_b32 v104, v108
v_permlane16_swap_b32 v105, v109
v_permlane16_swap_b32 v106, v110
v_permlane16_swap_b32 v107, v111
v_mfma_f32_32x32x16_bf16 v[144:159], v[176:179], v[88:91], v[144:159]
s_waitcnt lgkmcnt(8)
ds_read_b128 v[176:179], v250 offset:8192
v_rcp_f16_sdwa v127, v127 dst_sel:WORD_0 dst_unused:UNUSED_PRESERVE src0_sel:WORD_0
v_rcp_f16_sdwa v125, v125 dst_sel:WORD_1 dst_unused:UNUSED_PRESERVE src0_sel:WORD_1
v_rcp_f16_sdwa v127, v127 dst_sel:WORD_1 dst_unused:UNUSED_PRESERVE src0_sel:WORD_1
v_mfma_f32_32x32x16_bf16 v[144:159], v[180:183], v[92:95], v[144:159]
ds_read_b128 v[180:183], v250 offset:9216
v_fmac_f32 v235, v128, v128
v_pk_mul_f16 v124, v124, v125
v_fmac_f32_e64 v235, v129, v129
v_pk_mul_f16 v126, v126, v127
v_fmac_f32 v235, v130, v130
v_fmac_f32 v235, v131, v131
v_fmac_f32_e64 v235, v132, v132
v_fmac_f32 v235, v133, v133
s_waitcnt lgkmcnt(7)
v_mfma_f32_32x32x16_bf16 v[160:175], v[184:187], v[72:75], 0
ds_read_b128 v[184:187], v250 offset:10240
v_permlane16_swap_b32 v48, v52
v_permlane16_swap_b32 v49, v53
v_permlane16_swap_b32 v50, v54
v_permlane16_swap_b32 v51, v55
v_permlane16_swap_b32 v56, v60
v_permlane16_swap_b32 v57, v61
v_permlane16_swap_b32 v58, v62
v_permlane16_swap_b32 v59, v63
v_permlane16_swap_b32 v64, v68
v_permlane16_swap_b32 v65, v69
v_permlane16_swap_b32 v66, v70
v_permlane16_swap_b32 v67, v71
v_permlane16_swap_b32 v24, v28
v_permlane16_swap_b32 v25, v29
v_permlane16_swap_b32 v26, v30
v_permlane16_swap_b32 v27, v31
v_permlane16_swap_b32 v32, v36
v_permlane16_swap_b32 v33, v37
v_permlane16_swap_b32 v34, v38
v_permlane16_swap_b32 v35, v39
v_permlane16_swap_b32 v40, v44
v_permlane16_swap_b32 v41, v45
v_permlane16_swap_b32 v42, v46
v_permlane16_swap_b32 v43, v47
v_fmac_f32 v235, v134, v134
v_fmac_f32 v235, v135, v135
v_fmac_f32 v235, v136, v136
v_fmac_f32 v235, v137, v137
v_fmac_f32_e64 v235, v138, v138
v_cvt_pkrtz_f16_f32 v145, v144, v145
v_and_b32_e64 v145, s49, v145
v_bfe_u32 v144, v145, 2, 14
v_lshrrev_b32_e64 v145, 18, v145
v_cvt_pk_f16_f32 v154, v154, v155
v_fmac_f32_e64 v235, v139, v139
v_cvt_pk_f16_f32 v156, v156, v157
v_fmac_f32_e64 v235, v140, v140
v_cvt_pk_f16_f32 v158, v158, v159
v_fmac_f32 v235, v141, v141
ds_read_u16 v144, v144
ds_read_u16_d16_hi v145, v145
s_waitcnt lgkmcnt(2)
v_mfma_f32_32x32x16_bf16 v[160:175], v[188:191], v[76:79], v[160:175]
ds_read_b128 v[188:191], v250 offset:11264
v_pk_fma_f16 v155, v154, v154, s48
v_fmac_f32 v235, v142, v142
v_fmac_f32 v235, v143, v143
v_fma_mix_f32 v235, v124, v124, v235 op_sel_hi:[1,1,0]
v_pk_fma_f16 v157, v156, v156, s48
v_fma_mix_f32 v235, v126, v126, v235 op_sel_hi:[1,1,0]
v_cvt_pkrtz_f16_f32 v147, v146, v147
v_fma_mix_f32 v235, v124, v124, v235 op_sel:[1,1,0] op_sel_hi:[1,1,0]
v_and_b32_e64 v147, s49, v147
v_fma_mix_f32 v235, v126, v126, v235 op_sel:[1,1,0] op_sel_hi:[1,1,0]
v_bfe_u32 v146, v147, 2, 14
v_fma_mix_f32 v235, v112, v112, v235 op_sel_hi:[1,1,0]
v_lshrrev_b32_e64 v147, 18, v147
v_fma_mix_f32 v235, v113, v113, v235 op_sel_hi:[1,1,0]
v_pk_fma_f16 v159, v158, v158, s48
v_fma_mix_f32 v235, v114, v114, v235 op_sel_hi:[1,1,0]
v_pk_mul_f16 v155, v154, v155
v_fma_mix_f32 v235, v115, v115, v235 op_sel_hi:[1,1,0]
v_pk_mul_f16 v157, v156, v157
v_fma_mix_f32 v235, v116, v116, v235 op_sel_hi:[1,1,0]
v_pk_mul_f16 v159, v158, v159
v_fma_mix_f32 v235, v117, v117, v235 op_sel_hi:[1,1,0]
v_cvt_pkrtz_f16_f32 v149, v148, v149
v_fma_mix_f32 v235, v118, v118, v235 op_sel_hi:[1,1,0]
v_and_b32_e64 v149, s49, v149
v_fma_mix_f32 v235, v119, v119, v235 op_sel_hi:[1,1,0]
v_bfe_u32 v148, v149, 2, 14
v_lshrrev_b32_e64 v149, 18, v149
ds_read_u16 v146, v146
ds_read_u16_d16_hi v147, v147
ds_read_u16 v148, v148
ds_read_u16_d16_hi v149, v149
v_exp_f16_sdwa v155, v155 dst_sel:WORD_0 dst_unused:UNUSED_PRESERVE src0_sel:WORD_0
v_mfma_f32_32x32x16_bf16 v[160:175], v[176:179], v[80:83], v[160:175]
v_fma_mix_f32 v235, v120, v120, v235 op_sel_hi:[1,1,0]
v_exp_f16_sdwa v157, v157 dst_sel:WORD_0 dst_unused:UNUSED_PRESERVE src0_sel:WORD_0
v_fma_mix_f32 v235, v121, v121, v235 op_sel_hi:[1,1,0]
v_cvt_pkrtz_f16_f32 v151, v150, v151
v_and_b32_e64 v151, s49, v151
v_bfe_u32 v150, v151, 2, 14
v_lshrrev_b32_e64 v151, 18, v151
v_exp_f16_sdwa v159, v159 dst_sel:WORD_0 dst_unused:UNUSED_PRESERVE src0_sel:WORD_0
v_fma_mix_f32 v235, v122, v122, v235 op_sel_hi:[1,1,0]
v_exp_f16_sdwa v155, v155 dst_sel:WORD_1 dst_unused:UNUSED_PRESERVE src0_sel:WORD_1
v_fma_mix_f32 v235, v123, v123, v235 op_sel_hi:[1,1,0]
v_mfma_f32_32x32x16_bf16 v[160:175], v[180:183], v[84:87], v[160:175]
ds_read_u16 v150, v150
ds_read_u16_d16_hi v151, v151
v_permlane32_swap_b32 v234, v235
v_add_f32 v234, v234, v235
v_exp_f16_sdwa v157, v157 dst_sel:WORD_1 dst_unused:UNUSED_PRESERVE src0_sel:WORD_1
v_cvt_pkrtz_f16_f32 v153, v152, v153
v_and_b32_e64 v153, s49, v153
v_bfe_u32 v152, v153, 2, 14
v_lshrrev_b32_e64 v153, 18, v153
v_exp_f16_sdwa v159, v159 dst_sel:WORD_1 dst_unused:UNUSED_PRESERVE src0_sel:WORD_1
ds_write_b32 v248, v234 offset:8704
s_setprio 3
v_mov_b32 v238, 1
s_waitcnt lgkmcnt(0)
s_mov_b64 exec, 1
ds_add_rtn_u32 v239, v247, v238 offset:0
s_mov_b64 exec, -1
s_waitcnt lgkmcnt(0)
v_readfirstlane_b32 s43, v239
s_nop 1
s_cmp_lg_u32 s43, 7
s_cbranch_scc1 Lnopub
ds_read_b128 v[128:131], v244
ds_read_b128 v[132:135], v244 offset:16
ds_read_b128 v[136:139], v244 offset:9216
ds_read_b128 v[140:143], v244 offset:9232
ds_read_b128 v[112:115], v244 offset:18432
ds_read_b128 v[116:119], v244 offset:18448
ds_read_b128 v[120:123], v244 offset:27648
ds_read_b128 v[124:127], v244 offset:27664
ds_read_b128 v[216:219], v244 offset:36864
ds_read_b128 v[220:223], v244 offset:36880
s_waitcnt lgkmcnt(7)
v_add_f32 v128, v128, v136
v_add_f32 v129, v129, v137
v_add_f32 v130, v130, v138
v_add_f32 v131, v131, v139
s_waitcnt lgkmcnt(6)
v_add_f32 v132, v132, v140
v_add_f32 v133, v133, v141
v_add_f32 v134, v134, v142
v_add_f32 v135, v135, v143
ds_read_b128 v[136:139], v244 offset:46080
ds_read_b128 v[140:143], v244 offset:46096
s_waitcnt lgkmcnt(7)
v_add_f32 v128, v128, v112
v_add_f32 v129, v129, v113
v_add_f32 v130, v130, v114
v_add_f32 v131, v131, v115
s_waitcnt lgkmcnt(6)
v_add_f32 v132, v132, v116
v_add_f32 v133, v133, v117
v_add_f32 v134, v134, v118
v_add_f32 v135, v135, v119
ds_read_b128 v[112:115], v244 offset:55296
ds_read_b128 v[116:119], v244 offset:55312
s_waitcnt lgkmcnt(7)
v_add_f32 v128, v128, v120
v_add_f32 v129, v129, v121
v_add_f32 v130, v130, v122
v_add_f32 v131, v131, v123
s_waitcnt lgkmcnt(6)
v_add_f32 v132, v132, v124
v_add_f32 v133, v133, v125
v_add_f32 v134, v134, v126
v_add_f32 v135, v135, v127
ds_read_b128 v[120:123], v244 offset:64512
ds_read_b128 v[124:127], v244 offset:64528
s_waitcnt lgkmcnt(7)
v_add_f32 v128, v128, v216
v_add_f32 v129, v129, v217
v_add_f32 v130, v130, v218
v_add_f32 v131, v131, v219
s_waitcnt lgkmcnt(6)
v_add_f32 v132, v132, v220
v_add_f32 v133, v133, v221
v_add_f32 v134, v134, v222
v_add_f32 v135, v135, v223
s_waitcnt lgkmcnt(5)
v_add_f32 v128, v128, v136
v_add_f32 v129, v129, v137
v_add_f32 v130, v130, v138
v_add_f32 v131, v131, v139
s_waitcnt lgkmcnt(4)
v_add_f32 v132, v132, v140
v_add_f32 v133, v133, v141
v_add_f32 v134, v134, v142
v_add_f32 v135, v135, v143
s_waitcnt lgkmcnt(3)
v_add_f32 v128, v128, v112
v_add_f32 v129, v129, v113
v_add_f32 v130, v130, v114
v_add_f32 v131, v131, v115
s_waitcnt lgkmcnt(2)
v_add_f32 v132, v132, v116
v_add_f32 v133, v133, v117
v_add_f32 v134, v134, v118
v_add_f32 v135, v135, v119
s_waitcnt lgkmcnt(1)
v_add_f32 v128, v128, v120
v_add_f32 v129, v129, v121
v_add_f32 v130, v130, v122
v_add_f32 v131, v131, v123
s_waitcnt lgkmcnt(0)
v_add_f32 v132, v132, v124
v_add_f32 v133, v133, v125
v_add_f32 v134, v134, v126
v_add_f32 v135, v135, v127
v_min_u32 v216, -2, v128
v_min_u32 v217, -2, v129
v_min_u32 v218, -2, v130
v_min_u32 v219, -2, v131
v_min_u32 v220, -2, v132
v_min_u32 v221, -2, v133
v_min_u32_e64 v222, -2, v134
v_min_u32 v223, -2, v135
s_lshl_b32 s43, s2, 4
buffer_store_dwordx4 v[216:219], v237, s[32:35], s43 offen sc1
buffer_store_dwordx4 v[220:223], v245, s[32:35], s43 offen sc1
ds_write_b32 v247, v238 offset:4
s_waitcnt lgkmcnt(0)
s_nop 1
Lnopub:
s_mov_b32 s77, 0
v_bfe_u32 v244, v250, 8, 2
v_lshlrev_b32 v244, 3, v244
s_cmp_lg_u32 s40, 0
s_cbranch_scc1 Lnorole
v_subrev_u32 v245, 16384, v250
v_lshrrev_b32 v240, 2, v245
s_cmp_lt_u32 s2, 96
s_cselect_b32 s77, 1, 2
s_cbranch_scc1 Lred
s_and_b32 s44, s2, 7
s_lshl_b32 s44, s44, 11
s_add_u32 s44, s44, 393216
s_waitcnt lgkmcnt(0)
buffer_load_dword v128, v240, s[32:35], s44 offen sc1
buffer_load_dword v129, v240, s[32:35], s44 offen offset:256 sc1
buffer_load_dword v130, v240, s[32:35], s44 offen offset:512 sc1
buffer_load_dword v131, v240, s[32:35], s44 offen offset:768 sc1
buffer_load_dword v132, v240, s[32:35], s44 offen offset:1024 sc1
buffer_load_dword v133, v240, s[32:35], s44 offen offset:1280 sc1
v_lshrrev_b32_e64 v241, 1, v240
buffer_load_ushort v134, v241, s[24:27], 0 offen
buffer_load_ushort v135, v241, s[24:27], 0 offen offset:128
buffer_load_ushort v136, v241, s[24:27], 0 offen offset:256
buffer_load_ushort v137, v241, s[24:27], 0 offen offset:384
buffer_load_ushort v138, v241, s[24:27], 0 offen offset:512
buffer_load_ushort v139, v241, s[24:27], 0 offen offset:640
s_branch Lnorole
Lred:
s_lshl_b32 s44, s2, 12
s_waitcnt vmcnt(8)
buffer_load_dwordx4 v[128:131], v245, s[32:35], s44 offen sc1
s_waitcnt vmcnt(5)
buffer_load_dwordx4 v[132:135], v245, s[32:35], s44 offen offset:1024 sc1
s_waitcnt vmcnt(2)
buffer_load_dwordx4 v[136:139], v245, s[32:35], s44 offen offset:2048 sc1
buffer_load_dwordx4 v[140:143], v245, s[32:35], s44 offen offset:3072 sc1
Lnorole:
s_setprio 0
ds_read_u16 v152, v152
ds_read_u16_d16_hi v153, v153
v_pk_add_f16 v155, v155, 1.0 op_sel_hi:[1,0]
v_pk_add_f16 v157, v157, 1.0 op_sel_hi:[1,0]
v_mfma_f32_32x32x16_bf16 v[160:175], v[184:187], v[88:91], v[160:175]
v_pk_add_f16 v159, v159, 1.0 op_sel_hi:[1,0]
v_rcp_f16_sdwa v155, v155 dst_sel:WORD_0 dst_unused:UNUSED_PRESERVE src0_sel:WORD_0
v_rcp_f16_sdwa v157, v157 dst_sel:WORD_0 dst_unused:UNUSED_PRESERVE src0_sel:WORD_0
v_rcp_f16_sdwa v159, v159 dst_sel:WORD_0 dst_unused:UNUSED_PRESERVE src0_sel:WORD_0
v_mfma_f32_32x32x16_bf16 v[160:175], v[188:191], v[92:95], v[160:175]
ds_read_b128 v[176:179], v250 offset:55296
ds_read_b128 v[180:183], v250 offset:56320
ds_read_b128 v[184:187], v250 offset:57344
v_rcp_f16_sdwa v155, v155 dst_sel:WORD_1 dst_unused:UNUSED_PRESERVE src0_sel:WORD_1
v_rcp_f16_sdwa v157, v157 dst_sel:WORD_1 dst_unused:UNUSED_PRESERVE src0_sel:WORD_1
v_rcp_f16_sdwa v159, v159 dst_sel:WORD_1 dst_unused:UNUSED_PRESERVE src0_sel:WORD_1
s_waitcnt lgkmcnt(5)
v_or_b32 v112, v144, v145
v_pk_mul_f16 v115, v154, v155
v_pk_mul_f16 v118, v156, v157
v_pk_mul_f16 v119, v158, v159
s_nop 0
v_cvt_pkrtz_f16_f32 v161, v160, v161
ds_read_b128 v[188:191], v250 offset:58368
v_and_b32 v161, s49, v161
v_bfe_u32 v160, v161, 2, 14
v_lshrrev_b32_e64 v161, 18, v161
v_cvt_pk_f16_f32 v170, v170, v171
v_or_b32_e64 v113, v146, v147
v_cvt_pk_f16_f32 v172, v172, v173
v_cvt_pk_f16_f32 v174, v174, v175
v_pk_fma_f16 v171, v170, v170, s48
v_pk_fma_f16 v173, v172, v172, s48
ds_read_u16 v160, v160
ds_read_u16_d16_hi v161, v161
v_cvt_pkrtz_f16_f32 v163, v162, v163
v_and_b32_e64 v163, s49, v163
v_bfe_u32 v162, v163, 2, 14
v_lshrrev_b32 v163, 18, v163
v_or_b32 v116, v148, v149
v_pk_fma_f16 v175, v174, v174, s48
v_pk_mul_f16 v171, v170, v171
v_pk_mul_f16 v173, v172, v173
v_pk_mul_f16 v175, v174, v175
v_cvt_pkrtz_f16_f32 v165, v164, v165
ds_read_u16 v162, v162
ds_read_u16_d16_hi v163, v163
s_cmp_eq_u32 s77, 0
s_cbranch_scc1 Lpp1
s_call_b64 s[78:79], Lpolln
Lpp1:
v_and_b32 v165, s49, v165
v_bfe_u32 v164, v165, 2, 14
v_lshrrev_b32 v165, 18, v165
v_or_b32 v117, v150, v151
v_exp_f16_sdwa v171, v171 dst_sel:WORD_0 dst_unused:UNUSED_PRESERVE src0_sel:WORD_0
v_exp_f16_sdwa v173, v173 dst_sel:WORD_0 dst_unused:UNUSED_PRESERVE src0_sel:WORD_0
v_cvt_pkrtz_f16_f32 v167, v166, v167
v_and_b32_e64 v167, s49, v167
v_bfe_u32 v166, v167, 2, 14
ds_read_u16 v164, v164
ds_read_u16_d16_hi v165, v165
v_lshrrev_b32_e64 v167, 18, v167
v_exp_f16_sdwa v175, v175 dst_sel:WORD_0 dst_unused:UNUSED_PRESERVE src0_sel:WORD_0
s_waitcnt lgkmcnt(6)
v_or_b32 v114, v152, v153
v_exp_f16_sdwa v171, v171 dst_sel:WORD_1 dst_unused:UNUSED_PRESERVE src0_sel:WORD_1
v_mfma_f32_32x32x16_bf16 v[144:159], v[176:179], v[72:75], 0
ds_read_u16 v166, v166
ds_read_u16_d16_hi v167, v167
ds_read_b128 v[176:179], v250 offset:59392
v_exp_f16_sdwa v173, v173 dst_sel:WORD_1 dst_unused:UNUSED_PRESERVE src0_sel:WORD_1
v_cvt_pkrtz_f16_f32 v169, v168, v169
v_and_b32_e64 v169, s49, v169
v_bfe_u32 v168, v169, 2, 14
v_lshrrev_b32_e64 v169, 18, v169
v_permlane16_swap_b32 v112, v116
v_permlane16_swap_b32 v113, v117
v_permlane16_swap_b32 v114, v118
v_permlane16_swap_b32 v115, v119
v_mfma_f32_32x32x16_bf16 v[144:159], v[180:183], v[76:79], v[144:159]
ds_read_u16 v168, v168
ds_read_u16_d16_hi v169, v169
s_cmp_eq_u32 s77, 0
s_cbranch_scc1 Lpp2
s_nop 9
s_call_b64 s[78:79], Lpolln
Lpp2:
ds_read_b128 v[180:183], v250 offset:60416
v_exp_f16_sdwa v175, v175 dst_sel:WORD_1 dst_unused:UNUSED_PRESERVE src0_sel:WORD_1
v_pk_add_f16 v171, v171, 1.0 op_sel_hi:[1,0]
v_pk_add_f16 v173, v173, 1.0 op_sel_hi:[1,0]
v_mfma_f32_32x32x16_bf16 v[144:159], v[184:187], v[80:83], v[144:159]
v_pk_add_f16 v175, v175, 1.0 op_sel_hi:[1,0]
v_rcp_f16_sdwa v171, v171 dst_sel:WORD_0 dst_unused:UNUSED_PRESERVE src0_sel:WORD_0
v_rcp_f16_sdwa v173, v173 dst_sel:WORD_0 dst_unused:UNUSED_PRESERVE src0_sel:WORD_0
v_mfma_f32_32x32x16_bf16 v[144:159], v[188:191], v[84:87], v[144:159]
v_rcp_f16_sdwa v175, v175 dst_sel:WORD_0 dst_unused:UNUSED_PRESERVE src0_sel:WORD_0
v_rcp_f16_sdwa v171, v171 dst_sel:WORD_1 dst_unused:UNUSED_PRESERVE src0_sel:WORD_1
v_rcp_f16_sdwa v173, v173 dst_sel:WORD_1 dst_unused:UNUSED_PRESERVE src0_sel:WORD_1
v_rcp_f16_sdwa v175, v175 dst_sel:WORD_1 dst_unused:UNUSED_PRESERVE src0_sel:WORD_1
s_waitcnt lgkmcnt(5)
v_or_b32 v216, v160, v161
v_pk_mul_f16 v219, v170, v171
v_pk_mul_f16 v222, v172, v173
s_waitcnt lgkmcnt(3)
v_mfma_f32_32x32x16_bf16 v[144:159], v[176:179], v[88:91], v[144:159]
s_cmp_eq_u32 s77, 0
s_cbranch_scc1 Lpp3
s_nop 11
s_call_b64 s[78:79], Lpolln
Lpp3:
v_pk_mul_f16 v223, v174, v175
v_or_b32 v217, v162, v163
v_or_b32_e64 v220, v164, v165
v_or_b32 v221, v166, v167
s_nop 0
v_permlane16_swap_b32 v216, v220
v_permlane16_swap_b32 v217, v221
v_permlane16_swap_b32 v219, v223
s_waitcnt lgkmcnt(1)
v_or_b32 v218, v168, v169
s_nop 1
v_permlane16_swap_b32 v218, v222
s_waitcnt lgkmcnt(0)
v_mfma_f32_32x32x16_bf16 v[144:159], v[180:183], v[92:95], v[144:159]
v_mov_b32 v249, 0
s_branch Law6
Lax6:
s_sleep 2
Law6:
ds_read_b32 v249, v247 offset:4
s_sub_u32 s76, s76, 1
s_cselect_b32 s44, 1, 0
s_cselect_b32 s76, 0, s76
s_waitcnt lgkmcnt(0)
v_readfirstlane_b32 s43, v249
s_nop 1
s_max_u32 s43, s43, s44
s_cmp_lt_u32 s43, 1
s_cbranch_scc1 Lax6
s_add_u32 m0, s72, 5120
s_add_u32 s43, s82, 3200
buffer_load_dwordx4 v246, s[16:19], s43 offen lds
v_cvt_pkrtz_f16_f32 v145, v144, v145
v_and_b32_e64 v145, s49, v145
v_bfe_u32 v144, v145, 2, 14
v_lshrrev_b32_e64 v145, 18, v145
v_cvt_pk_f16_f32 v154, v154, v155
v_cvt_pk_f16_f32 v156, v156, v157
v_cvt_pk_f16_f32 v158, v158, v159
v_pk_fma_f16 v155, v154, v154, s48
v_pk_fma_f16 v157, v156, v156, s48
v_cvt_pkrtz_f16_f32 v147, v146, v147
ds_read_u16 v144, v144
ds_read_u16_d16_hi v145, v145
v_and_b32_e64 v147, s49, v147
v_bfe_u32 v146, v147, 2, 14
v_lshrrev_b32_e64 v147, 18, v147
v_pk_fma_f16 v159, v158, v158, s48
v_pk_mul_f16 v155, v154, v155
v_pk_mul_f16 v157, v156, v157
v_pk_mul_f16 v159, v158, v159
v_cvt_pkrtz_f16_f32 v149, v148, v149
v_and_b32_e64 v149, s49, v149
ds_read_u16 v146, v146
ds_read_u16_d16_hi v147, v147
v_bfe_u32 v148, v149, 2, 14
v_lshrrev_b32_e64 v149, 18, v149
v_exp_f16_sdwa v155, v155 dst_sel:WORD_0 dst_unused:UNUSED_PRESERVE src0_sel:WORD_0
v_exp_f16_sdwa v157, v157 dst_sel:WORD_0 dst_unused:UNUSED_PRESERVE src0_sel:WORD_0
v_cvt_pkrtz_f16_f32 v151, v150, v151
v_and_b32_e64 v151, s49, v151
v_bfe_u32 v150, v151, 2, 14
v_lshrrev_b32_e64 v151, 18, v151
ds_read_u16 v148, v148
ds_read_u16_d16_hi v149, v149
ds_read_u16 v150, v150
ds_read_u16_d16_hi v151, v151
v_exp_f16_sdwa v159, v159 dst_sel:WORD_0 dst_unused:UNUSED_PRESERVE src0_sel:WORD_0
v_exp_f16_sdwa v155, v155 dst_sel:WORD_1 dst_unused:UNUSED_PRESERVE src0_sel:WORD_1
v_exp_f16_sdwa v157, v157 dst_sel:WORD_1 dst_unused:UNUSED_PRESERVE src0_sel:WORD_1
v_cvt_pkrtz_f16_f32 v153, v152, v153
v_and_b32_e64 v153, s49, v153
v_bfe_u32 v152, v153, 2, 14
v_lshrrev_b32_e64 v153, 18, v153
v_exp_f16_sdwa v159, v159 dst_sel:WORD_1 dst_unused:UNUSED_PRESERVE src0_sel:WORD_1
v_pk_add_f16 v155, v155, 1.0 op_sel_hi:[1,0]
v_pk_add_f16 v157, v157, 1.0 op_sel_hi:[1,0]
v_pk_add_f16 v159, v159, 1.0 op_sel_hi:[1,0]
v_rcp_f16_sdwa v155, v155 dst_sel:WORD_0 dst_unused:UNUSED_PRESERVE src0_sel:WORD_0
v_rcp_f16_sdwa v157, v157 dst_sel:WORD_0 dst_unused:UNUSED_PRESERVE src0_sel:WORD_0
ds_read_u16 v152, v152
ds_read_u16_d16_hi v153, v153
v_rcp_f16_sdwa v159, v159 dst_sel:WORD_0 dst_unused:UNUSED_PRESERVE src0_sel:WORD_0
v_rcp_f16_sdwa v155, v155 dst_sel:WORD_1 dst_unused:UNUSED_PRESERVE src0_sel:WORD_1
v_rcp_f16_sdwa v157, v157 dst_sel:WORD_1 dst_unused:UNUSED_PRESERVE src0_sel:WORD_1
s_add_u32 m0, s72, 8192
s_add_u32 s43, s82, 6272
buffer_load_dwordx4 v246, s[16:19], s43 offen lds
s_cmp_eq_u32 s77, 0
s_cbranch_scc1 Lpp4
s_call_b64 s[78:79], Lpolln
Lpp4:
s_cmp_eq_u32 s77, 0
s_cbranch_scc1 Lpp5
s_call_b64 s[78:79], Lpolln
Lpp5:
s_setprio 3
s_mul_i32 s43, s40, 96
buffer_load_dwordx2 v[176:177], v244, s[28:31], s43 offen
buffer_load_dwordx2 v[178:179], v244, s[28:31], s43 offen offset:32
buffer_load_dwordx2 v[180:181], v244, s[28:31], s43 offen offset:64
v_bfe_u32 v190, v250, 4, 6
v_lshl_add_u32 v186, v190, 4, s72
s_mul_i32 s43, s40, 3
s_add_u32 s43, s43, 0
s_and_b32 s44, s43, 1
s_mul_i32 s44, s44, 3064
s_mul_i32 s43, s43, 3072
s_sub_u32 s43, s43, s44
s_add_u32 s43, s43, 90112
v_lshl_add_u32 v173, v190, 4, s43
s_mul_i32 s43, s40, 3
s_add_u32 s43, s43, 1
s_and_b32 s44, s43, 1
s_mul_i32 s44, s44, 3064
s_mul_i32 s43, s43, 3072
s_sub_u32 s43, s43, s44
s_add_u32 s43, s43, 90112
v_lshl_add_u32 v174, v190, 4, s43
s_mul_i32 s43, s40, 3
s_add_u32 s43, s43, 2
s_and_b32 s44, s43, 1
s_mul_i32 s44, s44, 3064
s_mul_i32 s43, s43, 3072
s_sub_u32 s43, s43, s44
s_add_u32 s43, s43, 90112
v_lshl_add_u32 v175, v190, 4, s43
v_lshl_add_u32 v187, v244, 2, s72
v_and_b32 v189, 3, v190
v_bfe_u32 v191, v190, 2, 1
v_lshl_add_u32 v189, v191, 3, v189
v_bfe_u32 v191, v190, 3, 1
v_lshl_add_u32 v189, v191, 2, v189
v_bfe_u32 v191, v190, 4, 1
v_lshl_add_u32 v189, v191, 6, v189
v_bfe_u32 v191, v190, 5, 1
v_lshl_add_u32 v189, v191, 5, v189
v_lshlrev_b32_e64 v189, 4, v189
v_add_u32 v248, 16384, v189
v_add_u32 v249, 53248, v189
v_min_u32 v189, 11, v190
s_mul_i32 s43, s40, 12
v_add_u32 v189, s43, v189
v_cmp_gt_u32 vcc, 64, v189
v_lshlrev_b32_e64 v189, 2, v189
v_add_u32 v172, 93312, v189
v_add_u32 v191, 16128, v189
v_add_u32 v189, 7680, v189
v_cndmask_b32 v189, v189, v191, vcc
v_add_u32 v188, s72, v244
ds_read_b64_tr_b16 v[72:73], v186
ds_read_b64_tr_b16 v[74:75], v186 offset:8
ds_read_b64_tr_b16 v[84:85], v186 offset:3072
ds_read_b64_tr_b16 v[86:87], v186 offset:3080
ds_read_b64_tr_b16 v[160:161], v186 offset:6144
s_waitcnt lgkmcnt(5)
ds_read_b64_tr_b16 v[162:163], v186 offset:6152
s_cmp_eq_u32 s77, 0
s_cbranch_scc1 Lpp6
s_call_b64 s[78:79], Lpolln
Lpp6:
ds_read_b64_tr_b16 v[76:77], v186 offset:1024
ds_read_b64_tr_b16 v[78:79], v186 offset:1032
ds_read_b64_tr_b16 v[88:89], v186 offset:4096
ds_read_b64_tr_b16 v[90:91], v186 offset:4104
ds_read_b64_tr_b16 v[164:165], v186 offset:7168
ds_read_b64_tr_b16 v[166:167], v186 offset:7176
v_rcp_f16_sdwa v159, v159 dst_sel:WORD_1 dst_unused:UNUSED_PRESERVE src0_sel:WORD_1
v_or_b32_e64 v232, v144, v145
v_pk_mul_f16 v235, v154, v155
v_pk_mul_f16 v238, v156, v157
v_pk_mul_f16 v239, v158, v159
v_or_b32 v233, v146, v147
v_or_b32 v236, v148, v149
v_or_b32 v237, v150, v151
s_waitcnt lgkmcnt(11)
v_lshlrev_b32_e64 v182, 16, v72
v_and_b32 v183, 4294901760, v72
v_lshlrev_b32_e64 v184, 16, v73
v_and_b32 v185, 4294901760, v73
v_or_b32_e64 v234, v152, v153
v_permlane16_swap_b32 v232, v236
v_permlane16_swap_b32 v233, v237
v_permlane16_swap_b32 v234, v238
v_permlane16_swap_b32 v235, v239
ds_read_b64_tr_b16 v[80:81], v186 offset:2048
ds_read_b64_tr_b16 v[82:83], v186 offset:2056
s_waitcnt vmcnt(2)
v_mfma_f32_16x16x16_bf16 v[120:123], v[72:73], v[176:177], 0
v_cvt_pk_f16_f32 v72, v182, v183
v_cvt_pk_f16_f32 v73, v184, v185
s_waitcnt lgkmcnt(0)
v_mfma_f32_16x16x16_bf16 v[124:127], v[74:75], v[176:177], 0
v_lshlrev_b32 v182, 16, v74
v_and_b32 v183, 4294901760, v74
s_waitcnt vmcnt(1)
v_mfma_f32_16x16x16_bf16 v[120:123], v[84:85], v[178:179], v[120:123]
v_cvt_pk_f16_f32 v74, v182, v183
v_lshlrev_b32_e64 v184, 16, v75
v_mfma_f32_16x16x16_bf16 v[124:127], v[86:87], v[178:179], v[124:127]
v_and_b32 v185, 4294901760, v75
v_cvt_pk_f16_f32 v75, v184, v185
s_waitcnt vmcnt(0)
v_mfma_f32_16x16x16_bf16 v[120:123], v[160:161], v[180:181], v[120:123]
v_lshlrev_b32 v182, 16, v84
v_and_b32 v183, 4294901760, v84
v_mfma_f32_16x16x16_bf16 v[124:127], v[162:163], v[180:181], v[124:127]
s_setprio 2
s_cmp_eq_u32 s77, 0
s_cbranch_scc1 Lpp7
s_nop 6
s_call_b64 s[78:79], Lpolln
Lpp7:
v_lshlrev_b32 v184, 16, v85
v_and_b32 v185, 4294901760, v85
s_nop 2
s_nop 1
s_mov_b32 exec_lo, 65537
s_mov_b32 exec_hi, 65537
ds_write_b128 v187, v[120:123] offset:3200
ds_write_b128 v187, v[124:127] offset:3216
s_mov_b64 exec, -1
v_cvt_pk_f16_f32 v84, v182, v183
v_cvt_pk_f16_f32 v85, v184, v185
v_lshlrev_b32 v182, 16, v86
v_and_b32 v183, 4294901760, v86
v_cvt_pk_f16_f32 v86, v182, v183
v_lshlrev_b32_e64 v184, 16, v87
v_and_b32 v185, 4294901760, v87
v_cvt_pk_f16_f32 v87, v184, v185
v_lshlrev_b32_e64 v182, 16, v160
v_and_b32 v183, 4294901760, v160
v_cvt_pk_f16_f32 v160, v182, v183
v_lshlrev_b32_e64 v184, 16, v161
v_and_b32 v185, 4294901760, v161
v_cvt_pk_f16_f32 v161, v184, v185
v_lshlrev_b32_e64 v182, 16, v162
v_and_b32 v183, 4294901760, v162
v_cvt_pk_f16_f32 v162, v182, v183
s_cmp_eq_u32 s77, 0
s_cbranch_scc1 Lpp8
s_call_b64 s[78:79], Lpolln
Lpp8:
v_lshlrev_b32 v184, 16, v163
v_and_b32 v185, 4294901760, v163
v_cvt_pk_f16_f32 v163, v184, v185
v_mfma_f32_16x16x16_bf16 v[120:123], v[76:77], v[176:177], 0
v_lshlrev_b32_e64 v182, 16, v76
v_and_b32 v183, 4294901760, v76
v_mfma_f32_16x16x16_bf16 v[124:127], v[78:79], v[176:177], 0
v_cvt_pk_f16_f32 v76, v182, v183
v_lshlrev_b32_e64 v184, 16, v77
v_mfma_f32_16x16x16_bf16 v[120:123], v[88:89], v[178:179], v[120:123]
v_and_b32 v185, 4294901760, v77
v_cvt_pk_f16_f32 v77, v184, v185
v_mfma_f32_16x16x16_bf16 v[124:127], v[90:91], v[178:179], v[124:127]
v_lshlrev_b32_e64 v182, 16, v78
v_and_b32 v183, 4294901760, v78
v_mfma_f32_16x16x16_bf16 v[120:123], v[164:165], v[180:181], v[120:123]
v_cvt_pk_f16_f32 v78, v182, v183
v_lshlrev_b32 v184, 16, v79
v_mfma_f32_16x16x16_bf16 v[124:127], v[166:167], v[180:181], v[124:127]
s_setprio 1
v_and_b32 v185, 4294901760, v79
v_cvt_pk_f16_f32 v79, v184, v185
v_lshlrev_b32_e64 v182, 16, v88
v_and_b32 v183, 4294901760, v88
v_cvt_pk_f16_f32 v88, v182, v183
v_lshlrev_b32 v184, 16, v89
v_and_b32 v185, 4294901760, v89
v_cvt_pk_f16_f32 v89, v184, v185
s_nop 0
s_mov_b32 exec_lo, 65537
s_mov_b32 exec_hi, 65537
ds_write_b128 v187, v[120:123] offset:3328
ds_write_b128 v187, v[124:127] offset:3344
s_mov_b64 exec, -1
s_cmp_eq_u32 s77, 0
s_cbranch_scc1 Lpp9
s_call_b64 s[78:79], Lpolln
Lpp9:
v_lshlrev_b32_e64 v182, 16, v90
v_and_b32 v183, 4294901760, v90
v_cvt_pk_f16_f32 v90, v182, v183
ds_read_b64_tr_b16 v[92:93], v186 offset:5120
ds_read_b64_tr_b16 v[94:95], v186 offset:5128
ds_read_b64_tr_b16 v[168:169], v186 offset:8192
ds_read_b64_tr_b16 v[170:171], v186 offset:8200
v_lshlrev_b32_e64 v184, 16, v91
v_and_b32 v185, 4294901760, v91
v_cvt_pk_f16_f32 v91, v184, v185
v_lshlrev_b32_e64 v182, 16, v164
v_and_b32 v183, 4294901760, v164
v_cvt_pk_f16_f32 v164, v182, v183
v_lshlrev_b32_e64 v184, 16, v165
v_and_b32 v185, 4294901760, v165
v_cvt_pk_f16_f32 v165, v184, v185
v_lshlrev_b32_e64 v182, 16, v166
v_and_b32 v183, 4294901760, v166
v_cvt_pk_f16_f32 v166, v182, v183
v_lshlrev_b32_e64 v184, 16, v167
v_and_b32 v185, 4294901760, v167
v_cvt_pk_f16_f32 v167, v184, v185
v_mfma_f32_16x16x16_bf16 v[120:123], v[80:81], v[176:177], 0
v_lshlrev_b32_e64 v182, 16, v80
v_and_b32 v183, 4294901760, v80
v_mfma_f32_16x16x16_bf16 v[124:127], v[82:83], v[176:177], 0
v_cvt_pk_f16_f32 v80, v182, v183
v_lshlrev_b32 v184, 16, v81
s_waitcnt lgkmcnt(3)
v_mfma_f32_16x16x16_bf16 v[120:123], v[92:93], v[178:179], v[120:123]
v_and_b32 v185, 4294901760, v81
v_cvt_pk_f16_f32 v81, v184, v185
s_waitcnt lgkmcnt(1)
v_mfma_f32_16x16x16_bf16 v[124:127], v[94:95], v[178:179], v[124:127]
v_lshlrev_b32 v182, 16, v82
v_and_b32 v183, 4294901760, v82
v_mfma_f32_16x16x16_bf16 v[120:123], v[168:169], v[180:181], v[120:123]
v_cvt_pk_f16_f32 v82, v182, v183
v_lshlrev_b32_e64 v184, 16, v83
s_waitcnt lgkmcnt(0)
v_mfma_f32_16x16x16_bf16 v[124:127], v[170:171], v[180:181], v[124:127]
s_cmp_eq_u32 s77, 0
s_cbranch_scc1 Lpp10
s_nop 7
s_call_b64 s[78:79], Lpolln
Lpp10:
s_setprio 0
v_and_b32 v185, 4294901760, v83
v_cvt_pk_f16_f32 v83, v184, v185
v_lshlrev_b32_e64 v182, 16, v92
v_and_b32 v183, 4294901760, v92
v_cvt_pk_f16_f32 v92, v182, v183
v_lshlrev_b32_e64 v184, 16, v93
v_and_b32 v185, 4294901760, v93
v_cvt_pk_f16_f32 v93, v184, v185
s_mov_b32 exec_lo, 65537
s_mov_b32 exec_hi, 65537
ds_write_b128 v187, v[120:123] offset:3456
ds_write_b128 v187, v[124:127] offset:3472
s_mov_b64 exec, -1
ds_read_b128 v[120:123], v248
ds_read_b128 v[124:127], v248 offset:2048
v_lshlrev_b32 v182, 16, v94
v_and_b32 v183, 4294901760, v94
v_cvt_pk_f16_f32 v94, v182, v183
v_lshlrev_b32_e64 v184, 16, v95
v_and_b32 v185, 4294901760, v95
v_cvt_pk_f16_f32 v95, v184, v185
s_cmp_eq_u32 s77, 0
s_cbranch_scc1 Lpp11
s_call_b64 s[78:79], Lpolln
Lpp11:
v_lshlrev_b32 v182, 16, v168
v_and_b32 v183, 4294901760, v168
v_cvt_pk_f16_f32 v168, v182, v183
v_lshlrev_b32_e64 v184, 16, v169
v_and_b32 v185, 4294901760, v169
v_cvt_pk_f16_f32 v169, v184, v185
v_lshlrev_b32_e64 v182, 16, v170
v_and_b32 v183, 4294901760, v170
v_cvt_pk_f16_f32 v170, v182, v183
v_lshlrev_b32_e64 v184, 16, v171
v_and_b32 v185, 4294901760, v171
v_cvt_pk_f16_f32 v171, v184, v185
s_cmp_eq_u32 s77, 0
s_cbranch_scc1 Lpp12
s_call_b64 s[78:79], Lpolln
Lpp12:
s_waitcnt lgkmcnt(0)
s_barrier
s_setprio 2
ds_read_b32 v176, v172
ds_read_b32 v177, v172 offset:9216
ds_read_b32 v178, v172 offset:18432
ds_read_b32 v179, v172 offset:27648
ds_read_b32 v180, v172 offset:36864
ds_read_b32 v181, v172 offset:46080
ds_read_b32 v182, v172 offset:55296
ds_read_b32 v183, v172 offset:64512
v_mfma_f32_16x16x32_bf16 v[144:147], v[120:123], v[48:51], 0
s_cmp_eq_u32 s77, 0
s_cbranch_scc1 Lpp13
s_nop 7
s_call_b64 s[78:79], Lpolln
Lpp13:
v_mfma_f32_16x16x32_bf16 v[152:155], v[120:123], v[52:55], 0
ds_read_b128 v[120:123], v248 offset:4096
v_mfma_f32_16x16x32_bf16 v[144:147], v[124:127], v[56:59], v[144:147]
v_mfma_f32_16x16x32_bf16 v[152:155], v[124:127], v[60:63], v[152:155]
ds_read_b128 v[124:127], v248 offset:256
s_waitcnt lgkmcnt(8)
v_add_f32 v176, v176, v177
s_waitcnt lgkmcnt(7)
v_add_f32 v176, v176, v178
s_waitcnt lgkmcnt(6)
v_add_f32 v176, v176, v179
s_waitcnt lgkmcnt(5)
v_add_f32 v176, v176, v180
s_waitcnt lgkmcnt(4)
v_add_f32 v176, v176, v181
s_waitcnt lgkmcnt(3)
v_add_f32 v176, v176, v182
s_waitcnt lgkmcnt(2)
v_add_f32 v176, v176, v183
ds_write_b32 v189, v176
s_cmp_eq_u32 s77, 0
s_cbranch_scc1 Lpp14
s_call_b64 s[78:79], Lpolln
Lpp14:
s_waitcnt lgkmcnt(2)
v_mfma_f32_16x16x32_bf16 v[144:147], v[120:123], v[64:67], v[144:147]
v_mfma_f32_16x16x32_bf16 v[152:155], v[120:123], v[68:71], v[152:155]
ds_read_b128 v[120:123], v248 offset:2304
s_waitcnt lgkmcnt(2)
v_mfma_f32_16x16x32_bf16 v[148:151], v[124:127], v[48:51], 0
s_nop 3
v_cvt_pkrtz_f16_f32 v145, v144, v145
v_mfma_f32_16x16x32_bf16 v[156:159], v[124:127], v[52:55], 0
ds_read_b128 v[124:127], v248 offset:4352
s_cmp_eq_u32 s77, 0
s_cbranch_scc1 Lpp15
s_nop 6
s_call_b64 s[78:79], Lpolln
Lpp15:
v_and_b32_e64 v145, s49, v145
v_bfe_u32 v144, v145, 2, 14
v_lshrrev_b32_e64 v145, 18, v145
v_cvt_pk_f16_f32 v154, v154, v155
v_pk_fma_f16 v155, v154, v154, s48
v_cvt_pkrtz_f16_f32 v147, v146, v147
v_and_b32_e64 v147, s49, v147
v_bfe_u32 v146, v147, 2, 14
v_lshrrev_b32_e64 v147, 18, v147
ds_read_u16 v144, v144
ds_read_u16_d16_hi v145, v145
ds_read_u16 v146, v146
ds_read_u16_d16_hi v147, v147
s_waitcnt lgkmcnt(5)
v_mfma_f32_16x16x32_bf16 v[148:151], v[120:123], v[56:59], v[148:151]
v_pk_mul_f16 v155, v154, v155
v_cvt_pkrtz_f16_f32 v153, v152, v153
v_mfma_f32_16x16x32_bf16 v[156:159], v[120:123], v[60:63], v[156:159]
v_exp_f16_sdwa v155, v155 dst_sel:WORD_0 dst_unused:UNUSED_PRESERVE src0_sel:WORD_0
s_waitcnt lgkmcnt(4)
v_mfma_f32_16x16x32_bf16 v[148:151], v[124:127], v[64:67], v[148:151]
s_cmp_eq_u32 s77, 0
s_cbranch_scc1 Lpp16
s_nop 7
s_call_b64 s[78:79], Lpolln
Lpp16:
v_exp_f16_sdwa v155, v155 dst_sel:WORD_1 dst_unused:UNUSED_PRESERVE src0_sel:WORD_1
v_mfma_f32_16x16x32_bf16 v[156:159], v[124:127], v[68:71], v[156:159]
v_and_b32_e64 v153, s49, v153
v_bfe_u32 v152, v153, 2, 14
v_lshrrev_b32_e64 v153, 18, v153
v_pk_add_f16 v155, v155, 1.0 op_sel_hi:[1,0]
v_cvt_pkrtz_f16_f32 v149, v148, v149
v_and_b32_e64 v149, s49, v149
v_bfe_u32 v148, v149, 2, 14
v_lshrrev_b32 v149, 18, v149
v_cvt_pk_f16_f32 v156, v156, v157
s_cmp_eq_u32 s77, 0
s_cbranch_scc1 Lpp17
s_call_b64 s[78:79], Lpolln
Lpp17:
v_cvt_pk_f16_f32 v158, v158, v159
v_pk_fma_f16 v157, v156, v156, s48
v_pk_fma_f16 v159, v158, v158, s48
v_pk_mul_f16 v157, v156, v157
v_pk_mul_f16 v159, v158, v159
v_exp_f16_sdwa v157, v157 dst_sel:WORD_0 dst_unused:UNUSED_PRESERVE src0_sel:WORD_0
v_cvt_pkrtz_f16_f32 v151, v150, v151
v_and_b32_e64 v151, s49, v151
v_bfe_u32 v150, v151, 2, 14
v_lshrrev_b32 v151, 18, v151
v_exp_f16_sdwa v159, v159 dst_sel:WORD_0 dst_unused:UNUSED_PRESERVE src0_sel:WORD_0
ds_read_u16 v148, v148
ds_read_u16_d16_hi v149, v149
ds_read_u16 v150, v150
ds_read_u16_d16_hi v151, v151
s_cmp_eq_u32 s77, 0
s_cbranch_scc1 Lpp18
s_call_b64 s[78:79], Lpolln
Lpp18:
v_exp_f16_sdwa v157, v157 dst_sel:WORD_1 dst_unused:UNUSED_PRESERVE src0_sel:WORD_1
v_exp_f16_sdwa v159, v159 dst_sel:WORD_1 dst_unused:UNUSED_PRESERVE src0_sel:WORD_1
v_pk_add_f16 v157, v157, 1.0 op_sel_hi:[1,0]
v_pk_add_f16 v159, v159, 1.0 op_sel_hi:[1,0]
v_rcp_f16_sdwa v155, v155 dst_sel:WORD_0 dst_unused:UNUSED_PRESERVE src0_sel:WORD_0
v_rcp_f16_sdwa v157, v157 dst_sel:WORD_0 dst_unused:UNUSED_PRESERVE src0_sel:WORD_0
v_rcp_f16_sdwa v159, v159 dst_sel:WORD_0 dst_unused:UNUSED_PRESERVE src0_sel:WORD_0
ds_read_u16 v152, v152
ds_read_u16_d16_hi v153, v153
s_cmp_eq_u32 s77, 0
s_cbranch_scc1 Lpp19
s_call_b64 s[78:79], Lpolln
Lpp19:
v_rcp_f16_sdwa v155, v155 dst_sel:WORD_1 dst_unused:UNUSED_PRESERVE src0_sel:WORD_1
v_rcp_f16_sdwa v157, v157 dst_sel:WORD_1 dst_unused:UNUSED_PRESERVE src0_sel:WORD_1
v_rcp_f16_sdwa v159, v159 dst_sel:WORD_1 dst_unused:UNUSED_PRESERVE src0_sel:WORD_1
ds_read_b128 v[120:123], v248 offset:8192
s_cmp_lg_u32 s40, 0
s_cbranch_scc1 Lspinx
s_setprio 3
v_add_u32_e64 v176, 0, v190
v_mul_u32_u24 v191, 1366, v176
v_lshrrev_b32_e64 v191, 16, v191
v_mul_u32_u24 v191, 9120, v191
v_lshl_add_u32 v176, v176, 1, v191
v_add_u32 v176, 93184, v176
v_add_u32_e64 v177, 64, v190
v_mul_u32_u24 v191, 1366, v177
v_lshrrev_b32_e64 v191, 16, v191
v_mul_u32_u24 v191, 9120, v191
v_lshl_add_u32 v177, v177, 1, v191
v_add_u32 v177, 93184, v177
v_add_u32 v178, 128, v190
v_mul_u32_u24 v191, 1366, v178
v_lshrrev_b32_e64 v191, 16, v191
v_mul_u32_u24 v191, 9120, v191
v_lshl_add_u32 v178, v178, 1, v191
v_add_u32 v178, 93184, v178
v_add_u32 v179, 192, v190
v_mul_u32_u24 v191, 1366, v179
v_lshrrev_b32_e64 v191, 16, v191
v_mul_u32_u24 v191, 9120, v191
v_lshl_add_u32 v179, v179, 1, v191
v_add_u32 v179, 93184, v179
v_add_u32 v180, 256, v190
v_mul_u32_u24 v191, 1366, v180
v_lshrrev_b32_e64 v191, 16, v191
v_mul_u32_u24 v191, 9120, v191
v_lshl_add_u32 v180, v180, 1, v191
v_add_u32 v180, 93184, v180
v_add_u32 v181, 320, v190
v_mul_u32_u24 v191, 1366, v181
v_lshrrev_b32_e64 v191, 16, v191
v_mul_u32_u24 v191, 9120, v191
v_lshl_add_u32 v181, v181, 1, v191
v_add_u32 v181, 93184, v181
Lspin:
s_cmp_eq_u32 s77, 0
s_cbranch_scc1 Lspiny
s_cmp_eq_u32 s76, 0
s_cbranch_scc1 Lspiny
s_sub_u32 s76, s76, 1
s_call_b64 s[78:79], Lpoll
s_branch Lspin
Lspiny:
v_cvt_f16_f32 v128, v128
ds_write_b16 v176, v128
v_cvt_f16_f32_e64 v129, v129
ds_write_b16 v177, v129
v_cvt_f16_f32_e64 v130, v130
ds_write_b16 v178, v130
v_cvt_f16_f32_e64 v131, v131
ds_write_b16 v179, v131
v_cvt_f16_f32 v132, v132
s_waitcnt lgkmcnt(11)
ds_write_b16 v180, v132
v_cvt_f16_f32 v133, v133
ds_write_b16 v181, v133
s_waitcnt lgkmcnt(0)
Lspinx:
s_waitcnt lgkmcnt(0)
s_barrier
ds_read_b64 v[176:177], v188 offset:3072
ds_read_b64 v[178:179], v188 offset:3104
ds_read_b64 v[180:181], v188 offset:3136
ds_read_b128 v[128:131], v254 offset:8192
ds_read_b128 v[132:135], v254 offset:8208
ds_read_b128 v[136:139], v254 offset:8320
ds_read_b128 v[140:143], v254 offset:8336
ds_read_b128 v[240:243], v254
ds_read_b128 v[244:247], v254 offset:16
s_waitcnt lgkmcnt(8)
v_pk_mul_f16 v72, v72, v176
v_pk_mul_f16 v73, v73, v177
v_add_u32 v72, 262148, v72
v_and_b32 v72, s49, v72
s_waitcnt lgkmcnt(6)
v_add_u32 v73, 262148, v73
v_and_b32 v73, s49, v73
v_pk_mul_f16 v74, v74, v176
v_pk_mul_f16 v75, v75, v177
v_add_u32 v74, 262148, v74
v_and_b32_e64 v74, s49, v74
v_add_u32 v75, 262148, v75
v_and_b32_e64 v75, s49, v75
v_pk_mul_f16 v76, v76, v176
v_pk_mul_f16 v77, v77, v177
v_add_u32 v76, 262148, v76
v_and_b32_e64 v76, s49, v76
v_add_u32 v77, 262148, v77
v_and_b32_e64 v77, s49, v77
ds_write_b64 v173, v[72:73]
ds_write_b64 v173, v[74:75] offset:3072
v_pk_mul_f16 v78, v78, v176
v_pk_mul_f16 v79, v79, v177
v_add_u32 v78, 262148, v78
v_and_b32_e64 v78, s49, v78
v_add_u32 v79, 262148, v79
v_and_b32_e64 v79, s49, v79
v_pk_mul_f16 v80, v80, v176
v_pk_mul_f16 v81, v81, v177
v_add_u32 v80, 262148, v80
v_and_b32_e64 v80, s49, v80
v_add_u32 v81, 262148, v81
v_and_b32_e64 v81, s49, v81
ds_write_b64 v173, v[76:77] offset:1024
ds_write_b64 v173, v[78:79] offset:4096
v_pk_mul_f16 v82, v82, v176
v_pk_mul_f16 v83, v83, v177
v_add_u32 v82, 262148, v82
v_and_b32_e64 v82, s49, v82
v_add_u32 v83, 262148, v83
v_and_b32_e64 v83, s49, v83
v_pk_mul_f16 v84, v84, v178
v_pk_mul_f16 v85, v85, v179
v_add_u32 v84, 262148, v84
v_and_b32_e64 v84, s49, v84
v_add_u32 v85, 262148, v85
v_and_b32_e64 v85, s49, v85
ds_write_b64 v173, v[80:81] offset:2048
ds_write_b64 v173, v[82:83] offset:5120
v_pk_mul_f16 v86, v86, v178
v_pk_mul_f16 v87, v87, v179
v_add_u32 v86, 262148, v86
v_and_b32_e64 v86, s49, v86
v_add_u32 v87, 262148, v87
v_and_b32_e64 v87, s49, v87
v_pk_mul_f16 v88, v88, v178
v_pk_mul_f16 v89, v89, v179
v_add_u32 v88, 262148, v88
v_and_b32_e64 v88, s49, v88
v_add_u32 v89, 262148, v89
v_and_b32_e64 v89, s49, v89
ds_write_b64 v174, v[84:85]
ds_write_b64 v174, v[86:87] offset:3072
v_pk_mul_f16 v90, v90, v178
v_pk_mul_f16 v91, v91, v179
v_add_u32 v90, 262148, v90
v_and_b32_e64 v90, s49, v90
v_add_u32 v91, 262148, v91
v_and_b32_e64 v91, s49, v91
v_pk_mul_f16 v92, v92, v178
v_pk_mul_f16 v93, v93, v179
v_add_u32 v92, 262148, v92
v_and_b32_e64 v92, s49, v92
v_add_u32 v93, 262148, v93
v_and_b32 v93, s49, v93
ds_write_b64 v174, v[88:89] offset:1024
s_waitcnt lgkmcnt(4)
ds_write_b64 v174, v[90:91] offset:4096
v_pk_mul_f16 v94, v94, v178
v_pk_mul_f16 v95, v95, v179
v_add_u32 v94, 262148, v94
v_and_b32_e64 v94, s49, v94
v_add_u32 v95, 262148, v95
v_and_b32_e64 v95, s49, v95
v_pk_mul_f16 v160, v160, v180
v_pk_mul_f16 v161, v161, v181
v_add_u32 v160, 262148, v160
v_and_b32_e64 v160, s49, v160
v_add_u32 v161, 262148, v161
v_and_b32_e64 v161, s49, v161
ds_write_b64 v174, v[92:93] offset:2048
ds_write_b64 v174, v[94:95] offset:5120
v_pk_mul_f16 v162, v162, v180
v_pk_mul_f16 v163, v163, v181
v_add_u32 v162, 262148, v162
v_and_b32_e64 v162, s49, v162
v_add_u32 v163, 262148, v163
v_and_b32_e64 v163, s49, v163
v_pk_mul_f16 v164, v164, v180
v_pk_mul_f16 v165, v165, v181
v_add_u32 v164, 262148, v164
v_and_b32_e64 v164, s49, v164
v_add_u32 v165, 262148, v165
v_and_b32_e64 v165, s49, v165
ds_write_b64 v175, v[160:161]
ds_write_b64 v175, v[162:163] offset:3072
v_pk_mul_f16 v166, v166, v180
v_pk_mul_f16 v167, v167, v181
v_add_u32 v166, 262148, v166
v_and_b32_e64 v166, s49, v166
v_add_u32 v167, 262148, v167
v_and_b32_e64 v167, s49, v167
v_pk_mul_f16 v168, v168, v180
v_pk_mul_f16 v169, v169, v181
v_add_u32 v168, 262148, v168
v_and_b32_e64 v168, s49, v168
v_add_u32 v169, 262148, v169
v_and_b32_e64 v169, s49, v169
ds_write_b64 v175, v[164:165] offset:1024
ds_write_b64 v175, v[166:167] offset:4096
v_pk_mul_f16 v170, v170, v180
v_pk_mul_f16 v171, v171, v181
v_add_u32 v170, 262148, v170
v_and_b32_e64 v170, s49, v170
v_add_u32 v171, 262148, v171
v_and_b32_e64 v171, s49, v171
ds_write_b64 v175, v[168:169] offset:2048
ds_write_b64 v175, v[170:171] offset:5120
ds_read_b128 v[176:179], v248 offset:6144
s_waitcnt lgkmcnt(0)
s_barrier
ds_read_b128 v[180:183], v251 offset:20480
ds_read_b128 v[184:187], v251 offset:23552
ds_read_b128 v[188:191], v251 offset:21504
ds_read_b128 v[124:127], v251 offset:24576
s_setprio 3
v_mfma_f32_16x16x32_bf16 v[160:163], v[176:179], v[48:51], 0
v_mfma_f32_16x16x32_bf16 v[168:171], v[176:179], v[52:55], 0
ds_read_b128 v[176:179], v251 offset:22528
s_waitcnt lgkmcnt(4)
v_mfma_f32_16x16x32_f16 v[72:75], v[180:183], v[4:7], v[128:131]
v_mfma_f32_16x16x32_f16 v[128:131], v[180:183], v[0:3], v[128:131]
ds_read_b128 v[180:183], v251 offset:25600
s_waitcnt lgkmcnt(4)
v_mfma_f32_16x16x32_f16 v[76:79], v[184:187], v[4:7], v[132:135]
v_mfma_f32_16x16x32_f16 v[132:135], v[184:187], v[0:3], v[132:135]
ds_read_b128 v[184:187], v248 offset:10240
s_waitcnt lgkmcnt(4)
v_mfma_f32_16x16x32_f16 v[80:83], v[188:191], v[4:7], v[136:139]
v_mfma_f32_16x16x32_f16 v[136:139], v[188:191], v[0:3], v[136:139]
ds_read_b128 v[188:191], v251 offset:26624
v_mfma_f32_16x16x32_bf16 v[160:163], v[120:123], v[56:59], v[160:163]
s_waitcnt lgkmcnt(4)
v_mfma_f32_16x16x32_f16 v[84:87], v[124:127], v[4:7], v[140:143]
v_mfma_f32_16x16x32_f16 v[140:143], v[124:127], v[0:3], v[140:143]
ds_read_b128 v[124:127], v251 offset:27648
s_waitcnt lgkmcnt(4)
v_mfma_f32_16x16x32_f16 v[88:91], v[176:179], v[4:7], v[240:243]
v_mfma_f32_16x16x32_bf16 v[168:171], v[120:123], v[60:63], v[168:171]
ds_read_b128 v[120:123], v251 offset:29696
v_mfma_f32_16x16x32_f16 v[240:243], v[176:179], v[0:3], v[240:243]
ds_read_b128 v[176:179], v248 offset:6400
s_waitcnt lgkmcnt(4)
v_mfma_f32_16x16x32_f16 v[92:95], v[180:183], v[4:7], v[244:247]
v_mfma_f32_16x16x32_f16 v[244:247], v[180:183], v[0:3], v[244:247]
ds_read_b128 v[180:183], v251 offset:30720
v_mfma_f32_16x16x32_bf16 v[160:163], v[184:187], v[64:67], v[160:163]
s_waitcnt lgkmcnt(4)
v_mfma_f32_16x16x32_f16 v[72:75], v[188:191], v[12:15], v[72:75]
v_mfma_f32_16x16x32_f16 v[128:131], v[188:191], v[8:11], v[128:131]
ds_read_b128 v[188:191], v251 offset:31744
s_nop 3
v_cvt_pkrtz_f16_f32 v161, v160, v161
s_waitcnt lgkmcnt(3)
v_mfma_f32_16x16x32_f16 v[76:79], v[120:123], v[12:15], v[76:79]
v_and_b32_e64 v161, s49, v161
v_bfe_u32 v160, v161, 2, 14
v_mfma_f32_16x16x32_bf16 v[168:171], v[184:187], v[68:71], v[168:171]
ds_read_b128 v[184:187], v251 offset:28672
v_lshrrev_b32_e64 v161, 18, v161
v_mfma_f32_16x16x32_f16 v[132:135], v[120:123], v[8:11], v[132:135]
ds_read_b128 v[120:123], v248 offset:8448
ds_read_u16 v160, v160
v_mfma_f32_16x16x32_f16 v[80:83], v[124:127], v[12:15], v[80:83]
ds_read_u16_d16_hi v161, v161
v_cvt_pkrtz_f16_f32 v163, v162, v163
v_mfma_f32_16x16x32_f16 v[136:139], v[124:127], v[8:11], v[136:139]
ds_read_b128 v[124:127], v251 offset:32768
s_setprio 2
v_and_b32_e64 v163, s49, v163
s_waitcnt lgkmcnt(6)
v_mfma_f32_16x16x32_bf16 v[164:167], v[176:179], v[48:51], 0
v_bfe_u32 v162, v163, 2, 14
v_lshrrev_b32_e64 v163, 18, v163
v_mfma_f32_16x16x32_f16 v[84:87], v[180:183], v[12:15], v[84:87]
ds_read_u16 v162, v162
ds_read_u16_d16_hi v163, v163
v_mfma_f32_16x16x32_f16 v[140:143], v[180:183], v[8:11], v[140:143]
ds_read_b128 v[180:183], v251 offset:33792
v_cvt_pkrtz_f16_f32 v169, v168, v169
s_waitcnt lgkmcnt(7)
v_mfma_f32_16x16x32_f16 v[88:91], v[184:187], v[12:15], v[88:91]
v_and_b32 v169, s49, v169
v_bfe_u32 v168, v169, 2, 14
v_mfma_f32_16x16x32_bf16 v[172:175], v[176:179], v[52:55], 0
ds_read_b128 v[176:179], v251 offset:35840
v_lshrrev_b32_e64 v169, 18, v169
v_mfma_f32_16x16x32_f16 v[240:243], v[184:187], v[8:11], v[240:243]
ds_read_b128 v[184:187], v248 offset:10496
ds_read_u16 v168, v168
v_mfma_f32_16x16x32_f16 v[92:95], v[188:191], v[12:15], v[92:95]
ds_read_u16_d16_hi v169, v169
v_cvt_pkrtz_f16_f32 v171, v170, v171
v_mfma_f32_16x16x32_f16 v[244:247], v[188:191], v[8:11], v[244:247]
ds_read_b128 v[188:191], v251 offset:36864
v_and_b32 v171, s49, v171
s_waitcnt lgkmcnt(10)
v_mfma_f32_16x16x32_bf16 v[164:167], v[120:123], v[56:59], v[164:167]
v_bfe_u32 v170, v171, 2, 14
v_lshrrev_b32 v171, 18, v171
s_waitcnt lgkmcnt(8)
v_mfma_f32_16x16x32_f16 v[72:75], v[124:127], v[20:23], v[72:75]
ds_read_u16 v170, v170
ds_read_u16_d16_hi v171, v171
v_mfma_f32_16x16x32_f16 v[128:131], v[124:127], v[16:19], v[128:131]
ds_read_b128 v[124:127], v251 offset:37888
v_mfma_f32_16x16x32_bf16 v[172:175], v[120:123], v[60:63], v[172:175]
ds_read_b128 v[120:123], v251 offset:34816
s_waitcnt lgkmcnt(9)
v_mfma_f32_16x16x32_f16 v[80:83], v[180:183], v[20:23], v[80:83]
v_mfma_f32_16x16x32_f16 v[136:139], v[180:183], v[16:19], v[136:139]
ds_read_b128 v[180:183], v252 offset:4096
s_waitcnt lgkmcnt(9)
v_mfma_f32_16x16x32_f16 v[76:79], v[176:179], v[20:23], v[76:79]
v_mfma_f32_16x16x32_f16 v[132:135], v[176:179], v[16:19], v[132:135]
ds_read_b128 v[176:179], v248 offset:12288
s_waitcnt lgkmcnt(9)
v_mfma_f32_16x16x32_bf16 v[164:167], v[184:187], v[64:67], v[164:167]
v_mfma_f32_16x16x32_bf16 v[172:175], v[184:187], v[68:71], v[172:175]
ds_read_b128 v[184:187], v252 offset:7168
s_nop 5
v_cvt_pkrtz_f16_f32 v165, v164, v165
v_and_b32 v165, s49, v165
s_waitcnt lgkmcnt(7)
v_mfma_f32_16x16x32_f16 v[84:87], v[188:191], v[20:23], v[84:87]
v_cvt_pk_f16_f32 v172, v172, v173
v_cvt_pk_f16_f32 v174, v174, v175
v_mfma_f32_16x16x32_f16 v[140:143], v[188:191], v[16:19], v[140:143]
ds_read_b128 v[188:191], v252 offset:5120
v_pk_fma_f16 v173, v172, v172, s48
v_pk_fma_f16 v175, v174, v174, s48
v_pk_mul_f16 v173, v172, v173
v_bfe_u32 v164, v165, 2, 14
v_lshrrev_b32_e64 v165, 18, v165
v_pk_mul_f16 v175, v174, v175
v_exp_f16_sdwa v173, v173 dst_sel:WORD_0 dst_unused:UNUSED_PRESERVE src0_sel:WORD_0
v_cvt_pkrtz_f16_f32 v167, v166, v167
v_and_b32_e64 v167, s49, v167
v_bfe_u32 v166, v167, 2, 14
s_waitcnt lgkmcnt(5)
v_mfma_f32_16x16x32_f16 v[92:95], v[124:127], v[20:23], v[92:95]
ds_read_u16 v164, v164
ds_read_u16_d16_hi v165, v165
s_waitcnt lgkmcnt(6)
v_mfma_f32_16x16x32_f16 v[88:91], v[120:123], v[20:23], v[88:91]
v_lshrrev_b32 v167, 18, v167
v_exp_f16_sdwa v175, v175 dst_sel:WORD_0 dst_unused:UNUSED_PRESERVE src0_sel:WORD_0
v_mfma_f32_16x16x32_f16 v[240:243], v[120:123], v[16:19], v[240:243]
ds_read_b128 v[120:123], v248 offset:14336
s_setprio 1
ds_read_u16 v166, v166
v_mfma_f32_16x16x32_f16 v[244:247], v[124:127], v[16:19], v[244:247]
ds_read_b128 v[124:127], v252 offset:8192
ds_read_u16_d16_hi v167, v167
s_waitcnt lgkmcnt(8)
v_mfma_f32_16x16x32_bf16 v[0:3], v[176:179], v[48:51], 0
v_exp_f16_sdwa v173, v173 dst_sel:WORD_1 dst_unused:UNUSED_PRESERVE src0_sel:WORD_1
v_mfma_f32_16x16x32_f16 v[72:75], v[180:183], v[100:103], v[72:75]
v_exp_f16_sdwa v175, v175 dst_sel:WORD_1 dst_unused:UNUSED_PRESERVE src0_sel:WORD_1
v_mfma_f32_16x16x32_f16 v[128:131], v[180:183], v[96:99], v[128:131]
ds_read_b128 v[180:183], v252 offset:9216
v_pk_add_f16 v173, v173, 1.0 op_sel_hi:[1,0]
v_mfma_f32_16x16x32_bf16 v[8:11], v[176:179], v[52:55], 0
ds_read_b128 v[176:179], v252 offset:6144
v_pk_add_f16 v175, v175, 1.0 op_sel_hi:[1,0]
s_waitcnt lgkmcnt(8)
v_mfma_f32_16x16x32_f16 v[76:79], v[184:187], v[100:103], v[76:79]
v_rcp_f16_sdwa v173, v173 dst_sel:WORD_0 dst_unused:UNUSED_PRESERVE src0_sel:WORD_0
v_mfma_f32_16x16x32_f16 v[132:135], v[184:187], v[96:99], v[132:135]
ds_read_b128 v[184:187], v248 offset:16384
v_rcp_f16_sdwa v175, v175 dst_sel:WORD_0 dst_unused:UNUSED_PRESERVE src0_sel:WORD_0
v_mfma_f32_16x16x32_f16 v[80:83], v[188:191], v[100:103], v[80:83]
v_rcp_f16_sdwa v173, v173 dst_sel:WORD_1 dst_unused:UNUSED_PRESERVE src0_sel:WORD_1
s_waitcnt lgkmcnt(6)
v_mfma_f32_16x16x32_bf16 v[0:3], v[120:123], v[56:59], v[0:3]
v_rcp_f16_sdwa v175, v175 dst_sel:WORD_1 dst_unused:UNUSED_PRESERVE src0_sel:WORD_1
v_mfma_f32_16x16x32_f16 v[136:139], v[188:191], v[96:99], v[136:139]
ds_read_b128 v[188:191], v252 offset:10240
s_waitcnt lgkmcnt(5)
v_mfma_f32_16x16x32_f16 v[84:87], v[124:127], v[100:103], v[84:87]
v_mfma_f32_16x16x32_f16 v[140:143], v[124:127], v[96:99], v[140:143]
ds_read_b128 v[124:127], v252 offset:11264
v_mfma_f32_16x16x32_bf16 v[8:11], v[120:123], v[60:63], v[8:11]
ds_read_b128 v[120:123], v252 offset:13312
s_waitcnt lgkmcnt(5)
v_mfma_f32_16x16x32_f16 v[92:95], v[180:183], v[100:103], v[92:95]
s_waitcnt lgkmcnt(4)
v_mfma_f32_16x16x32_f16 v[88:91], v[176:179], v[100:103], v[88:91]
v_pk_mul_f16 v101, v154, v155
v_pk_mul_f16 v102, v156, v157
v_mfma_f32_16x16x32_f16 v[240:243], v[176:179], v[96:99], v[240:243]
ds_read_b128 v[176:179], v248 offset:12544
v_pk_mul_f16 v103, v158, v159
v_or_b32 v100, v152, v153
s_waitcnt lgkmcnt(4)
v_mfma_f32_16x16x32_bf16 v[0:3], v[184:187], v[64:67], v[0:3]
v_mfma_f32_16x16x32_f16 v[244:247], v[180:183], v[96:99], v[244:247]
v_or_b32 v96, v144, v145
v_or_b32 v97, v146, v147
v_or_b32_e64 v98, v148, v149
v_or_b32 v99, v150, v151
s_waitcnt lgkmcnt(3)
v_mfma_f32_16x16x32_f16 v[72:75], v[188:191], v[108:111], v[72:75]
ds_read_b128 v[180:183], v252 offset:14336
v_cvt_pkrtz_f16_f32 v1, v0, v1
v_mfma_f32_16x16x32_f16 v[128:131], v[188:191], v[104:107], v[128:131]
ds_read_b128 v[188:191], v252 offset:15360
v_and_b32_e64 v1, s49, v1
v_mfma_f32_16x16x32_bf16 v[8:11], v[184:187], v[68:71], v[8:11]
ds_read_b128 v[184:187], v252 offset:12288
v_bfe_u32 v0, v1, 2, 14
s_waitcnt lgkmcnt(4)
v_mfma_f32_16x16x32_f16 v[76:79], v[120:123], v[108:111], v[76:79]
v_lshrrev_b32_e64 v1, 18, v1
v_cvt_pkrtz_f16_f32 v3, v2, v3
v_mfma_f32_16x16x32_f16 v[132:135], v[120:123], v[104:107], v[132:135]
ds_read_b128 v[120:123], v248 offset:14592
s_setprio 0
ds_read_u16 v0, v0
v_mfma_f32_16x16x32_f16 v[80:83], v[124:127], v[108:111], v[80:83]
ds_read_u16_d16_hi v1, v1
v_and_b32 v3, s49, v3
s_waitcnt lgkmcnt(6)
v_mfma_f32_16x16x32_bf16 v[4:7], v[176:179], v[48:51], 0
v_bfe_u32 v2, v3, 2, 14
v_lshrrev_b32 v3, 18, v3
v_mfma_f32_16x16x32_f16 v[136:139], v[124:127], v[104:107], v[136:139]
ds_read_b128 v[124:127], v251 offset:38912
ds_read_u16 v2, v2
s_waitcnt lgkmcnt(7)
v_mfma_f32_16x16x32_f16 v[84:87], v[180:183], v[108:111], v[84:87]
ds_read_u16_d16_hi v3, v3
v_cvt_pkrtz_f16_f32 v9, v8, v9
v_mfma_f32_16x16x32_f16 v[140:143], v[180:183], v[104:107], v[140:143]
ds_read_b128 v[180:183], v251 offset:39936
v_and_b32_e64 v9, s49, v9
v_mfma_f32_16x16x32_bf16 v[12:15], v[176:179], v[52:55], 0
ds_read_b128 v[176:179], v251 offset:41984
v_bfe_u32 v8, v9, 2, 14
s_waitcnt lgkmcnt(8)
v_mfma_f32_16x16x32_f16 v[88:91], v[184:187], v[108:111], v[88:91]
v_lshrrev_b32 v9, 18, v9
v_cvt_pkrtz_f16_f32 v11, v10, v11
v_mfma_f32_16x16x32_f16 v[240:243], v[184:187], v[104:107], v[240:243]
ds_read_b128 v[184:187], v248 offset:16640
ds_read_u16 v8, v8
v_mfma_f32_16x16x32_f16 v[92:95], v[188:191], v[108:111], v[92:95]
v_pk_mul_f16 v110, v172, v173
v_pk_mul_f16 v111, v174, v175
s_waitcnt lgkmcnt(8)
v_mfma_f32_16x16x32_bf16 v[4:7], v[120:123], v[56:59], v[4:7]
v_or_b32 v108, v168, v169
v_or_b32_e64 v109, v170, v171
v_mfma_f32_16x16x32_f16 v[244:247], v[188:191], v[104:107], v[244:247]
ds_read_b128 v[188:191], v251 offset:43008
v_or_b32 v104, v160, v161
s_waitcnt lgkmcnt(7)
v_mfma_f32_16x16x32_f16 v[72:75], v[124:127], v[196:199], v[72:75]
v_or_b32 v105, v162, v163
v_or_b32 v106, v164, v165
v_mfma_f32_16x16x32_f16 v[128:131], v[124:127], v[192:195], v[128:131]
ds_read_b128 v[124:127], v248 offset:18432
v_or_b32_e64 v107, v166, v167
v_mfma_f32_16x16x32_bf16 v[12:15], v[120:123], v[60:63], v[12:15]
ds_read_b128 v[120:123], v251 offset:40960
ds_read_u16_d16_hi v9, v9
v_and_b32 v11, s49, v11
s_waitcnt lgkmcnt(7)
v_mfma_f32_16x16x32_f16 v[80:83], v[180:183], v[196:199], v[80:83]
v_bfe_u32 v10, v11, 2, 14
v_lshrrev_b32 v11, 18, v11
s_waitcnt lgkmcnt(6)
v_mfma_f32_16x16x32_f16 v[76:79], v[176:179], v[196:199], v[76:79]
ds_read_u16 v10, v10
ds_read_u16_d16_hi v11, v11
v_mfma_f32_16x16x32_f16 v[132:135], v[176:179], v[192:195], v[132:135]
ds_read_b128 v[176:179], v251 offset:44032
s_waitcnt lgkmcnt(8)
v_mfma_f32_16x16x32_bf16 v[4:7], v[184:187], v[64:67], v[4:7]
v_mfma_f32_16x16x32_f16 v[136:139], v[180:183], v[192:195], v[136:139]
ds_read_b128 v[180:183], v251 offset:45056
s_waitcnt lgkmcnt(7)
v_mfma_f32_16x16x32_f16 v[84:87], v[188:191], v[196:199], v[84:87]
s_nop 3
v_cvt_pkrtz_f16_f32 v5, v4, v5
v_mfma_f32_16x16x32_f16 v[140:143], v[188:191], v[192:195], v[140:143]
ds_read_b128 v[188:191], v248 offset:20480
v_and_b32 v5, s49, v5
v_mfma_f32_16x16x32_bf16 v[12:15], v[184:187], v[68:71], v[12:15]
ds_read_b128 v[184:187], v251 offset:48128
v_bfe_u32 v4, v5, 2, 14
s_waitcnt lgkmcnt(7)
v_mfma_f32_16x16x32_f16 v[88:91], v[120:123], v[196:199], v[88:91]
v_lshrrev_b32_e64 v5, 18, v5
v_cvt_pkrtz_f16_f32 v7, v6, v7
v_mfma_f32_16x16x32_f16 v[240:243], v[120:123], v[192:195], v[240:243]
ds_read_b128 v[120:123], v251 offset:46080
s_setprio 3
v_cvt_pk_f16_f32 v12, v12, v13
v_mfma_f32_16x16x32_bf16 v[144:147], v[124:127], v[48:51], 0
v_cvt_pk_f16_f32 v14, v14, v15
v_pk_fma_f16 v13, v12, v12, s48
v_mfma_f32_16x16x32_bf16 v[152:155], v[124:127], v[52:55], 0
ds_read_b128 v[124:127], v251 offset:49152
v_pk_fma_f16 v15, v14, v14, s48
v_pk_mul_f16 v13, v12, v13
v_pk_mul_f16 v15, v14, v15
v_exp_f16_sdwa v13, v13 dst_sel:WORD_0 dst_unused:UNUSED_PRESERVE src0_sel:WORD_0
v_and_b32 v7, s49, v7
s_waitcnt lgkmcnt(5)
v_mfma_f32_16x16x32_f16 v[92:95], v[176:179], v[196:199], v[92:95]
ds_read_u16 v4, v4
ds_read_u16_d16_hi v5, v5
v_mfma_f32_16x16x32_f16 v[244:247], v[176:179], v[192:195], v[244:247]
ds_read_b128 v[176:179], v251 offset:47104
v_bfe_u32 v6, v7, 2, 14
s_waitcnt lgkmcnt(7)
v_mfma_f32_16x16x32_f16 v[72:75], v[180:183], v[204:207], v[72:75]
v_lshrrev_b32 v7, 18, v7
v_exp_f16_sdwa v15, v15 dst_sel:WORD_0 dst_unused:UNUSED_PRESERVE src0_sel:WORD_0
v_mfma_f32_16x16x32_f16 v[128:131], v[180:183], v[200:203], v[128:131]
ds_read_b128 v[180:183], v248 offset:22528
ds_read_u16 v6, v6
s_waitcnt lgkmcnt(7)
v_mfma_f32_16x16x32_f16 v[76:79], v[184:187], v[204:207], v[76:79]
ds_read_u16_d16_hi v7, v7
v_exp_f16_sdwa v13, v13 dst_sel:WORD_1 dst_unused:UNUSED_PRESERVE src0_sel:WORD_1
v_mfma_f32_16x16x32_f16 v[132:135], v[184:187], v[200:203], v[132:135]
ds_read_b128 v[184:187], v251 offset:50176
v_exp_f16_sdwa v15, v15 dst_sel:WORD_1 dst_unused:UNUSED_PRESERVE src0_sel:WORD_1
v_mfma_f32_16x16x32_bf16 v[144:147], v[188:191], v[56:59], v[144:147]
v_pk_add_f16 v13, v13, 1.0 op_sel_hi:[1,0]
v_pk_add_f16 v15, v15, 1.0 op_sel_hi:[1,0]
s_waitcnt lgkmcnt(7)
v_mfma_f32_16x16x32_f16 v[80:83], v[120:123], v[204:207], v[80:83]
v_rcp_f16_sdwa v13, v13 dst_sel:WORD_0 dst_unused:UNUSED_PRESERVE src0_sel:WORD_0
v_mfma_f32_16x16x32_f16 v[136:139], v[120:123], v[200:203], v[136:139]
ds_read_b128 v[120:123], v248 offset:18688
v_rcp_f16_sdwa v15, v15 dst_sel:WORD_0 dst_unused:UNUSED_PRESERVE src0_sel:WORD_0
v_mfma_f32_16x16x32_f16 v[84:87], v[124:127], v[204:207], v[84:87]
v_rcp_f16_sdwa v13, v13 dst_sel:WORD_1 dst_unused:UNUSED_PRESERVE src0_sel:WORD_1
v_mfma_f32_16x16x32_bf16 v[152:155], v[188:191], v[60:63], v[152:155]
ds_read_b128 v[188:191], v251 offset:51200
v_rcp_f16_sdwa v15, v15 dst_sel:WORD_1 dst_unused:UNUSED_PRESERVE src0_sel:WORD_1
v_mfma_f32_16x16x32_f16 v[140:143], v[124:127], v[200:203], v[140:143]
ds_read_b128 v[124:127], v251 offset:54272
s_waitcnt lgkmcnt(6)
v_mfma_f32_16x16x32_f16 v[88:91], v[176:179], v[204:207], v[88:91]
v_mfma_f32_16x16x32_f16 v[240:243], v[176:179], v[200:203], v[240:243]
ds_read_b128 v[176:179], v248 offset:20736
v_mfma_f32_16x16x32_bf16 v[144:147], v[180:183], v[64:67], v[144:147]
s_waitcnt lgkmcnt(4)
v_mfma_f32_16x16x32_f16 v[92:95], v[184:187], v[204:207], v[92:95]
v_pk_mul_f16 v206, v12, v13
v_pk_mul_f16 v207, v14, v15
v_mfma_f32_16x16x32_f16 v[244:247], v[184:187], v[200:203], v[244:247]
ds_read_b128 v[184:187], v251 offset:55296
buffer_load_dwordx4 v[192:195], v253, s[4:7], s71 offen
buffer_load_dwordx4 v[196:199], v253, s[4:7], s71 offen offset:64
s_waitcnt lgkmcnt(3)
v_mfma_f32_16x16x32_f16 v[72:75], v[188:191], v[212:215], v[72:75]
v_or_b32 v200, v0, v1
v_or_b32_e64 v201, v2, v3
v_mfma_f32_16x16x32_bf16 v[152:155], v[180:183], v[68:71], v[152:155]
ds_read_b128 v[180:183], v251 offset:52224
v_cvt_pkrtz_f16_f32 v145, v144, v145
v_mfma_f32_16x16x32_f16 v[128:131], v[188:191], v[208:211], v[128:131]
ds_read_b128 v[188:191], v248 offset:22784
s_setprio 2
v_and_b32 v145, s49, v145
v_mfma_f32_16x16x32_bf16 v[148:151], v[120:123], v[48:51], 0
v_bfe_u32 v144, v145, 2, 14
v_lshrrev_b32 v145, 18, v145
s_waitcnt lgkmcnt(3)
v_mfma_f32_16x16x32_f16 v[76:79], v[124:127], v[212:215], v[76:79]
ds_read_u16 v144, v144
ds_read_u16_d16_hi v145, v145
v_mfma_f32_16x16x32_bf16 v[156:159], v[120:123], v[52:55], 0
ds_read_b128 v[120:123], v251 offset:53248
v_or_b32_e64 v202, v4, v5
v_mfma_f32_16x16x32_f16 v[132:135], v[124:127], v[208:211], v[132:135]
ds_read_b128 v[124:127], v248 offset:24576
v_cvt_pkrtz_f16_f32 v147, v146, v147
v_mfma_f32_16x16x32_bf16 v[148:151], v[176:179], v[56:59], v[148:151]
v_and_b32 v147, s49, v147
v_bfe_u32 v146, v147, 2, 14
s_waitcnt lgkmcnt(5)
v_mfma_f32_16x16x32_f16 v[80:83], v[180:183], v[212:215], v[80:83]
v_lshrrev_b32 v147, 18, v147
v_or_b32 v203, v6, v7
v_mfma_f32_16x16x32_bf16 v[156:159], v[176:179], v[60:63], v[156:159]
ds_read_b128 v[176:179], v251 offset:56320
ds_read_u16 v146, v146
v_mfma_f32_16x16x32_f16 v[136:139], v[180:183], v[208:211], v[136:139]
ds_read_b128 v[180:183], v248 offset:26624
ds_read_u16_d16_hi v147, v147
v_mfma_f32_16x16x32_f16 v[84:87], v[184:187], v[212:215], v[84:87]
v_or_b32_e64 v204, v8, v9
v_or_b32 v205, v10, v11
s_waitcnt lgkmcnt(8)
v_mfma_f32_16x16x32_bf16 v[148:151], v[188:191], v[64:67], v[148:151]
v_cvt_pkrtz_f16_f32 v153, v152, v153
v_and_b32_e64 v153, s49, v153
v_mfma_f32_16x16x32_f16 v[140:143], v[184:187], v[208:211], v[140:143]
ds_read_b128 v[184:187], v251 offset:57344
v_bfe_u32 v152, v153, 2, 14
v_mfma_f32_16x16x32_bf16 v[156:159], v[188:191], v[68:71], v[156:159]
ds_read_b128 v[188:191], v248 offset:28672
s_setprio 1
v_cvt_pkrtz_f16_f32 v149, v148, v149
s_waitcnt lgkmcnt(7)
v_mfma_f32_16x16x32_f16 v[88:91], v[120:123], v[212:215], v[88:91]
v_and_b32 v149, s49, v149
v_bfe_u32 v148, v149, 2, 14
s_waitcnt lgkmcnt(6)
v_mfma_f32_16x16x32_bf16 v[160:163], v[124:127], v[48:51], 0
v_cvt_pk_f16_f32 v156, v156, v157
v_cvt_pk_f16_f32 v158, v158, v159
v_mfma_f32_16x16x32_f16 v[240:243], v[120:123], v[208:211], v[240:243]
ds_read_b128 v[120:123], v251 offset:60416
v_pk_fma_f16 v157, v156, v156, s48
v_mfma_f32_16x16x32_bf16 v[168:171], v[124:127], v[52:55], 0
ds_read_b128 v[124:127], v248 offset:24832
v_pk_fma_f16 v159, v158, v158, s48
s_waitcnt lgkmcnt(7)
v_mfma_f32_16x16x32_f16 v[92:95], v[176:179], v[212:215], v[92:95]
v_pk_mul_f16 v157, v156, v157
v_lshrrev_b32_e64 v149, 18, v149
s_waitcnt lgkmcnt(5)
v_mfma_f32_16x16x32_bf16 v[160:163], v[180:183], v[56:59], v[160:163]
ds_read_u16 v148, v148
ds_read_u16_d16_hi v149, v149
v_mfma_f32_16x16x32_f16 v[244:247], v[176:179], v[208:211], v[244:247]
ds_read_b128 v[176:179], v251 offset:58368
v_pk_mul_f16 v159, v158, v159
v_mfma_f32_16x16x32_bf16 v[168:171], v[180:183], v[60:63], v[168:171]
ds_read_b128 v[180:183], v248 offset:26880
v_exp_f16_sdwa v157, v157 dst_sel:WORD_0 dst_unused:UNUSED_PRESERVE src0_sel:WORD_0
s_waitcnt lgkmcnt(7)
v_mfma_f32_16x16x32_f16 v[72:75], v[184:187], v[228:231], v[72:75]
v_cvt_pkrtz_f16_f32 v151, v150, v151
v_and_b32 v151, s49, v151
v_mfma_f32_16x16x32_f16 v[128:131], v[184:187], v[224:227], v[128:131]
ds_read_b128 v[184:187], v251 offset:61440
v_bfe_u32 v150, v151, 2, 14
s_waitcnt lgkmcnt(6)
v_mfma_f32_16x16x32_bf16 v[160:163], v[188:191], v[64:67], v[160:163]
v_lshrrev_b32 v151, 18, v151
v_exp_f16_sdwa v159, v159 dst_sel:WORD_0 dst_unused:UNUSED_PRESERVE src0_sel:WORD_0
v_mfma_f32_16x16x32_f16 v[76:79], v[120:123], v[228:231], v[76:79]
ds_read_u16 v150, v150
ds_read_u16_d16_hi v151, v151
v_mfma_f32_16x16x32_bf16 v[168:171], v[188:191], v[68:71], v[168:171]
ds_read_b128 v[188:191], v251 offset:59392
s_setprio 0
v_lshrrev_b32 v153, 18, v153
v_mfma_f32_16x16x32_f16 v[132:135], v[120:123], v[224:227], v[132:135]
ds_read_b128 v[120:123], v248 offset:28928
ds_read_u16 v152, v152
s_waitcnt lgkmcnt(9)
v_mfma_f32_16x16x32_bf16 v[164:167], v[124:127], v[48:51], 0
ds_read_u16_d16_hi v153, v153
v_exp_f16_sdwa v157, v157 dst_sel:WORD_1 dst_unused:UNUSED_PRESERVE src0_sel:WORD_1
s_waitcnt lgkmcnt(8)
v_mfma_f32_16x16x32_f16 v[80:83], v[176:179], v[228:231], v[80:83]
v_cvt_pkrtz_f16_f32 v155, v154, v155
v_and_b32_e64 v155, s49, v155
v_mfma_f32_16x16x32_bf16 v[172:175], v[124:127], v[52:55], 0
ds_read_b128 v[124:127], v251 offset:62464
v_bfe_u32 v154, v155, 2, 14
v_lshrrev_b32 v155, 18, v155
v_mfma_f32_16x16x32_f16 v[136:139], v[176:179], v[224:227], v[136:139]
ds_read_u16 v154, v154
ds_read_u16_d16_hi v155, v155
ds_read_b128 v[176:179], v248 offset:30720
v_exp_f16_sdwa v159, v159 dst_sel:WORD_1 dst_unused:UNUSED_PRESERVE src0_sel:WORD_1
s_waitcnt lgkmcnt(10)
v_mfma_f32_16x16x32_bf16 v[164:167], v[180:183], v[56:59], v[164:167]
v_pk_add_f16 v157, v157, 1.0 op_sel_hi:[1,0]
v_pk_add_f16 v159, v159, 1.0 op_sel_hi:[1,0]
v_mfma_f32_16x16x32_f16 v[84:87], v[184:187], v[228:231], v[84:87]
v_rcp_f16_sdwa v157, v157 dst_sel:WORD_0 dst_unused:UNUSED_PRESERVE src0_sel:WORD_0
v_mfma_f32_16x16x32_bf16 v[172:175], v[180:183], v[60:63], v[172:175]
ds_read_b128 v[180:183], v251 offset:8192
v_rcp_f16_sdwa v159, v159 dst_sel:WORD_0 dst_unused:UNUSED_PRESERVE src0_sel:WORD_0
v_mfma_f32_16x16x32_f16 v[140:143], v[184:187], v[224:227], v[140:143]
ds_read_b128 v[184:187], v248 offset:32768
v_rcp_f16_sdwa v157, v157 dst_sel:WORD_1 dst_unused:UNUSED_PRESERVE src0_sel:WORD_1
s_waitcnt lgkmcnt(8)
v_mfma_f32_16x16x32_f16 v[88:91], v[188:191], v[228:231], v[88:91]
v_rcp_f16_sdwa v159, v159 dst_sel:WORD_1 dst_unused:UNUSED_PRESERVE src0_sel:WORD_1
v_mfma_f32_16x16x32_bf16 v[164:167], v[120:123], v[64:67], v[164:167]
v_or_b32 v208, v144, v145
v_pk_mul_f16 v214, v156, v157
v_mfma_f32_16x16x32_f16 v[240:243], v[188:191], v[224:227], v[240:243]
ds_read_b128 v[188:191], v251 offset:11264
v_pk_mul_f16 v215, v158, v159
v_mfma_f32_16x16x32_bf16 v[172:175], v[120:123], v[68:71], v[172:175]
ds_read_b128 v[120:123], v248 offset:34816
s_setprio 3
v_or_b32_e64 v209, v146, v147
s_waitcnt lgkmcnt(7)
v_mfma_f32_16x16x32_f16 v[92:95], v[124:127], v[228:231], v[92:95]
v_cvt_pkrtz_f16_f32 v161, v160, v161
v_and_b32_e64 v161, s49, v161
v_mfma_f32_16x16x32_f16 v[244:247], v[124:127], v[224:227], v[244:247]
ds_read_b128 v[124:127], v251 offset:9216
v_bfe_u32 v160, v161, 2, 14
v_lshrrev_b32 v161, 18, v161
v_cvt_pk_f16_f32 v172, v172, v173
v_cvt_pk_f16_f32 v174, v174, v175
v_pk_fma_f16 v173, v172, v172, s48
s_waitcnt lgkmcnt(5)
v_mfma_f32_16x16x32_bf16 v[0:3], v[176:179], v[48:51], 0
ds_read_u16 v160, v160
ds_read_u16_d16_hi v161, v161
v_mfma_f32_16x16x32_bf16 v[8:11], v[176:179], v[52:55], 0
ds_read_b128 v[176:179], v248 offset:30976
v_or_b32 v210, v148, v149
s_waitcnt lgkmcnt(7)
v_mfma_f32_16x16x32_f16 v[72:75], v[180:183], v[116:119], v[72:75]
v_cvt_pkrtz_f16_f32 v163, v162, v163
v_and_b32 v163, s49, v163
s_waitcnt lgkmcnt(6)
v_mfma_f32_16x16x32_bf16 v[0:3], v[184:187], v[56:59], v[0:3]
v_bfe_u32 v162, v163, 2, 14
v_lshrrev_b32_e64 v163, 18, v163
v_mfma_f32_16x16x32_f16 v[128:131], v[180:183], v[112:115], v[128:131]
ds_read_b128 v[180:183], v251 offset:12288
ds_read_u16 v162, v162
ds_read_u16_d16_hi v163, v163
v_mfma_f32_16x16x32_bf16 v[8:11], v[184:187], v[60:63], v[8:11]
ds_read_b128 v[184:187], v248 offset:33024
v_pk_fma_f16 v175, v174, v174, s48
s_waitcnt lgkmcnt(8)
v_mfma_f32_16x16x32_f16 v[76:79], v[188:191], v[116:119], v[76:79]
v_pk_mul_f16 v173, v172, v173
v_or_b32 v211, v150, v151
v_mfma_f32_16x16x32_f16 v[132:135], v[188:191], v[112:115], v[132:135]
ds_read_b128 v[188:191], v251 offset:10240
v_cvt_pkrtz_f16_f32 v165, v164, v165
v_mfma_f32_16x16x32_bf16 v[0:3], v[120:123], v[64:67], v[0:3]
v_and_b32_e64 v165, s49, v165
v_bfe_u32 v164, v165, 2, 14
v_lshrrev_b32 v165, 18, v165
v_pk_mul_f16 v175, v174, v175
v_exp_f16_sdwa v173, v173 dst_sel:WORD_0 dst_unused:UNUSED_PRESERVE src0_sel:WORD_0
s_waitcnt lgkmcnt(7)
v_mfma_f32_16x16x32_f16 v[80:83], v[124:127], v[116:119], v[80:83]
ds_read_u16 v164, v164
ds_read_u16_d16_hi v165, v165
v_mfma_f32_16x16x32_bf16 v[8:11], v[120:123], v[68:71], v[8:11]
ds_read_b128 v[120:123], v251 offset:13312
v_or_b32_e64 v212, v152, v153
v_cvt_pkrtz_f16_f32 v167, v166, v167
v_and_b32_e64 v167, s49, v167
v_bfe_u32 v166, v167, 2, 14
v_lshrrev_b32 v167, 18, v167
v_mov_b32 v16, 0
v_mov_b32_e64 v17, 0
v_cndmask_b32 v18, 0, v255, s[88:89]
v_cndmask_b32 v19, 0, v255, s[90:91]
v_mov_b32_e64 v20, 0
v_mov_b32 v21, 0
ds_read_u16 v166, v166
ds_read_u16_d16_hi v167, v167
s_setprio 2
v_exp_f16_sdwa v175, v175 dst_sel:WORD_0 dst_unused:UNUSED_PRESERVE src0_sel:WORD_0
v_mfma_f32_16x16x32_f16 v[136:139], v[124:127], v[112:115], v[136:139]
ds_read_b128 v[124:127], v248 offset:35072
v_or_b32 v213, v154, v155
s_waitcnt lgkmcnt(8)
v_mfma_f32_16x16x32_bf16 v[4:7], v[176:179], v[48:51], 0
v_cvt_pkrtz_f16_f32 v169, v168, v169
v_and_b32_e64 v169, s49, v169
v_bfe_u32 v168, v169, 2, 14
v_lshrrev_b32_e64 v169, 18, v169
v_exp_f16_sdwa v173, v173 dst_sel:WORD_1 dst_unused:UNUSED_PRESERVE src0_sel:WORD_1
v_mfma_f32_16x16x32_f16 v[84:87], v[180:183], v[116:119], v[84:87]
ds_read_u16 v168, v168
ds_read_u16_d16_hi v169, v169
v_mfma_f32_16x16x32_bf16 v[12:15], v[176:179], v[52:55], 0
ds_read_b128 v[176:179], v251 offset:14336
v_cvt_pkrtz_f16_f32 v171, v170, v171
v_and_b32_e64 v171, s49, v171
v_bfe_u32 v170, v171, 2, 14
v_lshrrev_b32 v171, 18, v171
v_mfma_f32_16x16x32_f16 v[140:143], v[180:183], v[112:115], v[140:143]
ds_read_u16 v170, v170
ds_read_u16_d16_hi v171, v171
ds_read_b128 v[180:183], v249
v_exp_f16_sdwa v175, v175 dst_sel:WORD_1 dst_unused:UNUSED_PRESERVE src0_sel:WORD_1
s_waitcnt lgkmcnt(9)
v_mfma_f32_16x16x32_bf16 v[4:7], v[184:187], v[56:59], v[4:7]
v_pk_add_f16 v173, v173, 1.0 op_sel_hi:[1,0]
v_pk_add_f16 v175, v175, 1.0 op_sel_hi:[1,0]
v_mfma_f32_16x16x32_f16 v[88:91], v[188:191], v[116:119], v[88:91]
v_rcp_f16_sdwa v173, v173 dst_sel:WORD_0 dst_unused:UNUSED_PRESERVE src0_sel:WORD_0
v_mfma_f32_16x16x32_bf16 v[12:15], v[184:187], v[60:63], v[12:15]
ds_read_b128 v[184:187], v251 offset:17408
v_rcp_f16_sdwa v175, v175 dst_sel:WORD_0 dst_unused:UNUSED_PRESERVE src0_sel:WORD_0
v_mfma_f32_16x16x32_f16 v[240:243], v[188:191], v[112:115], v[240:243]
ds_read_b128 v[188:191], v249 offset:2048
v_rcp_f16_sdwa v173, v173 dst_sel:WORD_1 dst_unused:UNUSED_PRESERVE src0_sel:WORD_1
v_mfma_f32_16x16x32_f16 v[92:95], v[120:123], v[116:119], v[92:95]
v_rcp_f16_sdwa v175, v175 dst_sel:WORD_1 dst_unused:UNUSED_PRESERVE src0_sel:WORD_1
s_waitcnt lgkmcnt(8)
v_mfma_f32_16x16x32_bf16 v[4:7], v[124:127], v[64:67], v[4:7]
v_cvt_pkrtz_f16_f32 v1, v0, v1
v_and_b32 v1, s49, v1
v_mfma_f32_16x16x32_f16 v[244:247], v[120:123], v[112:115], v[244:247]
ds_read_b128 v[120:123], v251 offset:15360
v_bfe_u32 v0, v1, 2, 14
v_mfma_f32_16x16x32_bf16 v[12:15], v[124:127], v[68:71], v[12:15]
ds_read_b128 v[124:127], v249 offset:4096
s_setprio 1
v_lshrrev_b32_e64 v1, 18, v1
s_waitcnt vmcnt(1)
v_mfma_f32_16x16x32_bf16 v[128:131], v[18:21], v[192:195], v[128:131]
ds_read_u16 v0, v0
ds_read_u16_d16_hi v1, v1
v_mfma_f32_16x16x32_bf16 v[132:135], v[16:19], v[192:195], v[132:135]
v_or_b32_e64 v192, v160, v161
v_or_b32 v193, v162, v163
s_waitcnt vmcnt(0)
v_mfma_f32_16x16x32_bf16 v[136:139], v[18:21], v[196:199], v[136:139]
v_cvt_pk_f16_f32 v12, v12, v13
v_cvt_pk_f16_f32 v14, v14, v15
v_mfma_f32_16x16x32_bf16 v[140:143], v[16:19], v[196:199], v[140:143]
buffer_load_dwordx4 v[224:227], v253, s[4:7], s71 offen offset:128
buffer_load_dwordx4 v[228:231], v253, s[4:7], s71 offen offset:192
buffer_load_dwordx4 v[112:115], v253, s[4:7], s71 offen offset:256
buffer_load_dwordx4 v[116:119], v253, s[4:7], s71 offen offset:320
s_waitcnt lgkmcnt(7)
v_mfma_f32_16x16x32_f16 v[72:75], v[176:179], v[220:223], v[72:75]
v_pk_mul_f16 v198, v172, v173
v_pk_mul_f16 v199, v174, v175
s_waitcnt lgkmcnt(6)
v_mfma_f32_16x16x32_bf16 v[144:147], v[180:183], v[48:51], 0
v_pk_fma_f16 v13, v12, v12, s48
v_or_b32_e64 v194, v164, v165
v_mfma_f32_16x16x32_f16 v[128:131], v[176:179], v[216:219], v[128:131]
ds_read_b128 v[176:179], v251 offset:18432
v_cvt_pkrtz_f16_f32 v3, v2, v3
v_mfma_f32_16x16x32_bf16 v[152:155], v[180:183], v[52:55], 0
ds_read_b128 v[180:183], v249 offset:256
v_and_b32 v3, s49, v3
s_waitcnt lgkmcnt(5)
v_mfma_f32_16x16x32_f16 v[76:79], v[184:187], v[220:223], v[76:79]
v_bfe_u32 v2, v3, 2, 14
v_lshrrev_b32_e64 v3, 18, v3
v_mfma_f32_16x16x32_bf16 v[144:147], v[188:191], v[56:59], v[144:147]
ds_read_u16 v2, v2
ds_read_u16_d16_hi v3, v3
v_mfma_f32_16x16x32_f16 v[132:135], v[184:187], v[216:219], v[132:135]
ds_read_b128 v[184:187], v251 offset:16384
v_pk_fma_f16 v15, v14, v14, s48
v_mfma_f32_16x16x32_bf16 v[152:155], v[188:191], v[60:63], v[152:155]
ds_read_b128 v[188:191], v249 offset:2304
v_pk_mul_f16 v13, v12, v13
v_mfma_f32_16x16x32_f16 v[80:83], v[120:123], v[220:223], v[80:83]
v_or_b32_e64 v195, v166, v167
v_cvt_pkrtz_f16_f32 v5, v4, v5
v_mfma_f32_16x16x32_f16 v[136:139], v[120:123], v[216:219], v[136:139]
ds_read_b128 v[120:123], v251 offset:19456
v_and_b32 v5, s49, v5
s_waitcnt lgkmcnt(6)
v_mfma_f32_16x16x32_bf16 v[144:147], v[124:127], v[64:67], v[144:147]
v_bfe_u32 v4, v5, 2, 14
v_lshrrev_b32_e64 v5, 18, v5
v_pk_mul_f16 v15, v14, v15
v_exp_f16_sdwa v13, v13 dst_sel:WORD_0 dst_unused:UNUSED_PRESERVE src0_sel:WORD_0
v_mfma_f32_16x16x32_f16 v[84:87], v[176:179], v[220:223], v[84:87]
ds_read_u16 v4, v4
ds_read_u16_d16_hi v5, v5
v_mfma_f32_16x16x32_bf16 v[152:155], v[124:127], v[68:71], v[152:155]
ds_read_b128 v[124:127], v251 offset:63488
v_or_b32_e64 v196, v168, v169
v_cvt_pkrtz_f16_f32 v7, v6, v7
v_and_b32_e64 v7, s49, v7
v_bfe_u32 v6, v7, 2, 14
v_lshrrev_b32_e64 v7, 18, v7
v_exp_f16_sdwa v15, v15 dst_sel:WORD_0 dst_unused:UNUSED_PRESERVE src0_sel:WORD_0
v_mfma_f32_16x16x32_f16 v[140:143], v[176:179], v[216:219], v[140:143]
ds_read_u16 v6, v6
ds_read_u16_d16_hi v7, v7
s_setprio 0
ds_read_b128 v[176:179], v249 offset:4352
s_waitcnt lgkmcnt(8)
v_mfma_f32_16x16x32_bf16 v[148:151], v[180:183], v[48:51], 0
v_or_b32_e64 v197, v170, v171
v_cvt_pkrtz_f16_f32 v9, v8, v9
v_and_b32_e64 v9, s49, v9
v_bfe_u32 v8, v9, 2, 14
v_lshrrev_b32_e64 v9, 18, v9
v_exp_f16_sdwa v13, v13 dst_sel:WORD_1 dst_unused:UNUSED_PRESERVE src0_sel:WORD_1
v_mfma_f32_16x16x32_f16 v[88:91], v[184:187], v[220:223], v[88:91]
ds_read_u16 v8, v8
ds_read_u16_d16_hi v9, v9
v_mfma_f32_16x16x32_bf16 v[156:159], v[180:183], v[52:55], 0
ds_read_b128 v[180:183], v252 offset:1024
v_cvt_pkrtz_f16_f32 v11, v10, v11
v_mfma_f32_16x16x32_f16 v[240:243], v[184:187], v[216:219], v[240:243]
ds_read_b128 v[184:187], v249 offset:6144
v_and_b32_e64 v11, s49, v11
v_bfe_u32 v10, v11, 2, 14
v_lshrrev_b32 v11, 18, v11
v_exp_f16_sdwa v15, v15 dst_sel:WORD_1 dst_unused:UNUSED_PRESERVE src0_sel:WORD_1
s_waitcnt lgkmcnt(8)
v_mfma_f32_16x16x32_bf16 v[148:151], v[188:191], v[56:59], v[148:151]
ds_read_u16 v10, v10
ds_read_u16_d16_hi v11, v11
v_mfma_f32_16x16x32_f16 v[92:95], v[120:123], v[220:223], v[92:95]
v_pk_add_f16 v13, v13, 1.0 op_sel_hi:[1,0]
v_pk_add_f16 v15, v15, 1.0 op_sel_hi:[1,0]
v_mfma_f32_16x16x32_f16 v[244:247], v[120:123], v[216:219], v[244:247]
ds_read_b128 v[120:123], v249 offset:8192
v_rcp_f16_sdwa v13, v13 dst_sel:WORD_0 dst_unused:UNUSED_PRESERVE src0_sel:WORD_0
v_mfma_f32_16x16x32_bf16 v[156:159], v[188:191], v[60:63], v[156:159]
ds_read_b128 v[188:191], v251 offset:64512
v_rcp_f16_sdwa v15, v15 dst_sel:WORD_0 dst_unused:UNUSED_PRESERVE src0_sel:WORD_0
s_waitcnt lgkmcnt(8)
v_mfma_f32_16x16x32_bf16 v[148:151], v[176:179], v[64:67], v[148:151]
v_rcp_f16_sdwa v13, v13 dst_sel:WORD_1 dst_unused:UNUSED_PRESERVE src0_sel:WORD_1
v_mfma_f32_16x16x32_f16 v[128:131], v[124:127], v[232:235], v[128:131]
v_rcp_f16_sdwa v15, v15 dst_sel:WORD_1 dst_unused:UNUSED_PRESERVE src0_sel:WORD_1
v_mfma_f32_16x16x32_bf16 v[156:159], v[176:179], v[68:71], v[156:159]
ds_read_b128 v[176:179], v249 offset:10240
v_or_b32 v216, v0, v1
s_waitcnt lgkmcnt(6)
v_mfma_f32_16x16x32_f16 v[132:135], v[180:183], v[232:235], v[132:135]
s_setprio 3
v_pk_mul_f16 v222, v12, v13
v_pk_mul_f16 v223, v14, v15
s_waitcnt lgkmcnt(5)
v_mfma_f32_16x16x32_bf16 v[160:163], v[184:187], v[48:51], 0
v_or_b32 v217, v2, v3
v_cvt_pkrtz_f16_f32 v145, v144, v145
v_mfma_f32_16x16x32_bf16 v[168:171], v[184:187], v[52:55], 0
ds_read_b128 v[184:187], v249 offset:6400
v_and_b32_e64 v145, s49, v145
v_bfe_u32 v144, v145, 2, 14
v_lshrrev_b32_e64 v145, 18, v145
v_cvt_pk_f16_f32 v156, v156, v157
v_cvt_pk_f16_f32 v158, v158, v159
v_pk_fma_f16 v157, v156, v156, s48
v_or_b32_e64 v218, v4, v5
v_cvt_pkrtz_f16_f32 v147, v146, v147
v_and_b32 v147, s49, v147
ds_read_u16 v144, v144
ds_read_u16_d16_hi v145, v145
s_waitcnt lgkmcnt(5)
v_mfma_f32_16x16x32_bf16 v[160:163], v[120:123], v[56:59], v[160:163]
v_bfe_u32 v146, v147, 2, 14
v_lshrrev_b32 v147, 18, v147
s_waitcnt lgkmcnt(4)
v_mfma_f32_16x16x32_f16 v[80:83], v[188:191], v[236:239], v[80:83]
ds_read_u16 v146, v146
ds_read_u16_d16_hi v147, v147
v_mfma_f32_16x16x32_f16 v[136:139], v[188:191], v[232:235], v[136:139]
ds_read_b128 v[188:191], v252 offset:3072
v_pk_fma_f16 v159, v158, v158, s48
v_mfma_f32_16x16x32_bf16 v[168:171], v[120:123], v[60:63], v[168:171]
ds_read_b128 v[120:123], v249 offset:8448
v_pk_mul_f16 v157, v156, v157
v_or_b32 v219, v6, v7
s_waitcnt lgkmcnt(7)
v_mfma_f32_16x16x32_bf16 v[160:163], v[176:179], v[64:67], v[160:163]
v_cvt_pkrtz_f16_f32 v149, v148, v149
v_and_b32_e64 v149, s49, v149
v_bfe_u32 v148, v149, 2, 14
v_lshrrev_b32_e64 v149, 18, v149
v_pk_mul_f16 v159, v158, v159
v_exp_f16_sdwa v157, v157 dst_sel:WORD_0 dst_unused:UNUSED_PRESERVE src0_sel:WORD_0
v_mfma_f32_16x16x32_bf16 v[168:171], v[176:179], v[68:71], v[168:171]
ds_read_u16 v148, v148
ds_read_u16_d16_hi v149, v149
ds_read_b128 v[176:179], v251 offset:11264
v_or_b32_e64 v220, v8, v9
v_cvt_pkrtz_f16_f32 v151, v150, v151
v_and_b32_e64 v151, s49, v151
v_bfe_u32 v150, v151, 2, 14
v_lshrrev_b32 v151, 18, v151
v_exp_f16_sdwa v159, v159 dst_sel:WORD_0 dst_unused:UNUSED_PRESERVE src0_sel:WORD_0
s_waitcnt lgkmcnt(7)
v_mfma_f32_16x16x32_bf16 v[164:167], v[184:187], v[48:51], 0
ds_read_u16 v150, v150
ds_read_u16_d16_hi v151, v151
s_setprio 2
v_or_b32 v221, v10, v11
v_cvt_pkrtz_f16_f32 v153, v152, v153
v_and_b32_e64 v153, s49, v153
v_bfe_u32 v152, v153, 2, 14
v_lshrrev_b32 v153, 18, v153
v_exp_f16_sdwa v157, v157 dst_sel:WORD_1 dst_unused:UNUSED_PRESERVE src0_sel:WORD_1
s_waitcnt lgkmcnt(6)
v_mfma_f32_16x16x32_f16 v[92:95], v[188:191], v[236:239], v[92:95]
ds_read_u16 v152, v152
ds_read_u16_d16_hi v153, v153
v_mfma_f32_16x16x32_bf16 v[172:175], v[184:187], v[52:55], 0
ds_read_b128 v[184:187], v251 offset:9216
v_cvt_pkrtz_f16_f32 v155, v154, v155
v_and_b32_e64 v155, s49, v155
v_bfe_u32 v154, v155, 2, 14
v_lshrrev_b32 v155, 18, v155
v_exp_f16_sdwa v159, v159 dst_sel:WORD_1 dst_unused:UNUSED_PRESERVE src0_sel:WORD_1
s_waitcnt lgkmcnt(8)
v_mfma_f32_16x16x32_bf16 v[164:167], v[120:123], v[56:59], v[164:167]
ds_read_u16 v154, v154
ds_read_u16_d16_hi v155, v155
v_pk_add_f16 v157, v157, 1.0 op_sel_hi:[1,0]
v_pk_add_f16 v159, v159, 1.0 op_sel_hi:[1,0]
v_mfma_f32_16x16x32_bf16 v[172:175], v[120:123], v[60:63], v[172:175]
ds_read_b128 v[120:123], v251 offset:12288
v_rcp_f16_sdwa v157, v157 dst_sel:WORD_0 dst_unused:UNUSED_PRESERVE src0_sel:WORD_0
s_waitcnt vmcnt(3)
v_mfma_f32_16x16x32_bf16 v[240:243], v[18:21], v[224:227], v[240:243]
v_mfma_f32_16x16x32_bf16 v[244:247], v[16:19], v[224:227], v[244:247]
v_cvt_pk_bf16_f32 v224, v128, v129
v_cvt_pk_bf16_f32 v225, v130, v131
s_waitcnt vmcnt(2)
v_mfma_f32_16x16x32_bf16 v[72:75], v[18:21], v[228:231], v[72:75]
v_cvt_pk_bf16_f32 v226, v132, v133
v_cvt_pk_bf16_f32 v227, v134, v135
v_mfma_f32_16x16x32_bf16 v[76:79], v[16:19], v[228:231], v[76:79]
ds_read_b128 v[128:131], v254 offset:8192
ds_read_b128 v[132:135], v254 offset:8208
v_mfma_f32_16x16x32_f16 v[72:75], v[124:127], v[236:239], v[72:75]
ds_read_b128 v[124:127], v252 offset:2048
v_cvt_pk_bf16_f32 v228, v136, v137
v_mfma_f32_16x16x32_f16 v[76:79], v[180:183], v[236:239], v[76:79]
ds_read_b128 v[180:183], v252
v_cvt_pk_bf16_f32 v229, v138, v139
v_mfma_f32_16x16x32_f16 v[244:247], v[188:191], v[232:235], v[244:247]
s_waitcnt lgkmcnt(4)
ds_read_b128 v[136:139], v254 offset:8320
ds_read_b128 v[188:191], v249 offset:12288
s_waitcnt vmcnt(1)
v_mfma_f32_16x16x32_bf16 v[80:83], v[18:21], v[112:115], v[80:83]
v_rcp_f16_sdwa v159, v159 dst_sel:WORD_0 dst_unused:UNUSED_PRESERVE src0_sel:WORD_0
s_waitcnt vmcnt(0)
v_mfma_f32_16x16x32_bf16 v[92:95], v[16:19], v[116:119], v[92:95]
v_rcp_f16_sdwa v157, v157 dst_sel:WORD_1 dst_unused:UNUSED_PRESERVE src0_sel:WORD_1
v_rcp_f16_sdwa v159, v159 dst_sel:WORD_1 dst_unused:UNUSED_PRESERVE src0_sel:WORD_1
v_cvt_pkrtz_f16_f32 v161, v160, v161
v_and_b32 v161, s49, v161
v_bfe_u32 v160, v161, 2, 14
v_lshrrev_b32 v161, 18, v161
s_nop 1
v_cvt_pk_bf16_f32 v22, v92, v93
v_cvt_pk_bf16_f32 v23, v94, v95
s_waitcnt lgkmcnt(3)
v_mfma_f32_16x16x32_f16 v[84:87], v[124:127], v[236:239], v[84:87]
ds_read_u16 v160, v160
ds_read_u16_d16_hi v161, v161
v_mfma_f32_16x16x32_f16 v[140:143], v[124:127], v[232:235], v[140:143]
ds_read_b128 v[124:127], v251 offset:8192
v_cvt_pkrtz_f16_f32 v163, v162, v163
s_waitcnt lgkmcnt(5)
v_mfma_f32_16x16x32_f16 v[88:91], v[180:183], v[236:239], v[88:91]
v_cvt_pk_bf16_f32 v236, v72, v73
v_cvt_pk_bf16_f32 v237, v74, v75
v_mfma_f32_16x16x32_f16 v[240:243], v[180:183], v[232:235], v[240:243]
ds_read_b128 v[180:183], v249 offset:10496
v_cvt_pk_bf16_f32 v230, v140, v141
v_cvt_pk_bf16_f32 v231, v142, v143
v_cvt_pk_bf16_f32 v238, v76, v77
v_cvt_pk_bf16_f32 v239, v78, v79
v_cvt_pk_bf16_f32 v234, v244, v245
v_cvt_pk_bf16_f32 v235, v246, v247
v_mfma_f32_16x16x32_bf16 v[84:87], v[16:19], v[112:115], v[84:87]
ds_read_b128 v[140:143], v254 offset:8336
v_cvt_pk_bf16_f32 v232, v240, v241
v_cvt_pk_bf16_f32 v233, v242, v243
v_mfma_f32_16x16x32_bf16 v[88:91], v[18:21], v[116:119], v[88:91]
ds_read_b128 v[240:243], v254
ds_read_b128 v[244:247], v254 offset:16
v_cvt_pk_bf16_f32 v16, v80, v81
v_cvt_pk_bf16_f32 v17, v82, v83
v_cvt_pk_bf16_f32 v18, v84, v85
v_cvt_pk_bf16_f32 v19, v86, v87
v_mfma_f32_16x16x32_f16 v[76:79], v[176:179], v[100:103], v[132:135]
buffer_store_dwordx4 v[224:227], v253, s[8:11], s71 offen sc1
v_cvt_pk_bf16_f32 v20, v88, v89
v_cvt_pk_bf16_f32 v21, v90, v91
s_waitcnt lgkmcnt(4)
v_mfma_f32_16x16x32_f16 v[72:75], v[124:127], v[100:103], v[128:131]
buffer_store_dwordx4 v[228:231], v253, s[8:11], s71 offen offset:64 sc1
v_or_b32 v112, v144, v145
v_mfma_f32_16x16x32_f16 v[128:131], v[124:127], v[96:99], v[128:131]
ds_read_b128 v[124:127], v249 offset:14336
v_pk_mul_f16 v118, v156, v157
s_waitcnt lgkmcnt(4)
v_mfma_f32_16x16x32_bf16 v[164:167], v[180:183], v[64:67], v[164:167]
v_pk_mul_f16 v119, v158, v159
v_or_b32 v113, v146, v147
v_mfma_f32_16x16x32_f16 v[132:135], v[176:179], v[96:99], v[132:135]
ds_read_b128 v[176:179], v251 offset:10240
v_or_b32_e64 v114, v148, v149
v_mfma_f32_16x16x32_bf16 v[172:175], v[180:183], v[68:71], v[172:175]
ds_read_b128 v[180:183], v249 offset:16384
s_setprio 1
v_and_b32 v163, s49, v163
v_mfma_f32_16x16x32_f16 v[80:83], v[184:187], v[100:103], v[136:139]
v_bfe_u32 v162, v163, 2, 14
v_lshrrev_b32 v163, 18, v163
v_mfma_f32_16x16x32_bf16 v[0:3], v[188:191], v[48:51], 0
s_nop 0
v_cvt_pk_f16_f32 v172, v172, v173
v_cvt_pk_f16_f32 v174, v174, v175
v_mfma_f32_16x16x32_f16 v[136:139], v[184:187], v[96:99], v[136:139]
ds_read_b128 v[184:187], v251 offset:13312
v_pk_fma_f16 v173, v172, v172, s48
v_mfma_f32_16x16x32_bf16 v[8:11], v[188:191], v[52:55], 0
ds_read_b128 v[188:191], v249 offset:12544
ds_read_u16 v162, v162
s_waitcnt lgkmcnt(5)
v_mfma_f32_16x16x32_f16 v[84:87], v[120:123], v[100:103], v[140:143]
ds_read_u16_d16_hi v163, v163
v_pk_fma_f16 v175, v174, v174, s48
v_mfma_f32_16x16x32_bf16 v[0:3], v[124:127], v[56:59], v[0:3]
v_pk_mul_f16 v173, v172, v173
v_or_b32 v115, v150, v151
v_mfma_f32_16x16x32_f16 v[140:143], v[120:123], v[96:99], v[140:143]
ds_read_b128 v[120:123], v251 offset:14336
v_cvt_pkrtz_f16_f32 v165, v164, v165
s_waitcnt lgkmcnt(5)
v_mfma_f32_16x16x32_f16 v[88:91], v[176:179], v[100:103], v[240:243]
v_and_b32 v165, s49, v165
v_bfe_u32 v164, v165, 2, 14
v_mfma_f32_16x16x32_bf16 v[8:11], v[124:127], v[60:63], v[8:11]
ds_read_b128 v[124:127], v249 offset:14592
v_lshrrev_b32_e64 v165, 18, v165
v_mfma_f32_16x16x32_f16 v[240:243], v[176:179], v[96:99], v[240:243]
ds_read_b128 v[176:179], v251 offset:17408
ds_read_u16 v164, v164
v_mfma_f32_16x16x32_bf16 v[0:3], v[180:183], v[64:67], v[0:3]
ds_read_u16_d16_hi v165, v165
v_pk_mul_f16 v175, v174, v175
v_exp_f16_sdwa v173, v173 dst_sel:WORD_0 dst_unused:UNUSED_PRESERVE src0_sel:WORD_0
s_waitcnt lgkmcnt(7)
v_mfma_f32_16x16x32_f16 v[92:95], v[184:187], v[100:103], v[244:247]
v_or_b32 v116, v152, v153
v_cvt_pkrtz_f16_f32 v167, v166, v167
v_mfma_f32_16x16x32_bf16 v[8:11], v[180:183], v[68:71], v[8:11]
ds_read_b128 v[180:183], v251 offset:15360
s_setprio 0
v_and_b32 v167, s49, v167
v_bfe_u32 v166, v167, 2, 14
v_lshrrev_b32_e64 v167, 18, v167
v_exp_f16_sdwa v175, v175 dst_sel:WORD_0 dst_unused:UNUSED_PRESERVE src0_sel:WORD_0
v_mfma_f32_16x16x32_f16 v[244:247], v[184:187], v[96:99], v[244:247]
ds_read_u16 v166, v166
ds_read_u16_d16_hi v167, v167
ds_read_b128 v[184:187], v249 offset:16640
v_mfma_f32_16x16x32_bf16 v[4:7], v[188:191], v[48:51], 0
v_or_b32_e64 v117, v154, v155
v_cvt_pkrtz_f16_f32 v169, v168, v169
v_and_b32_e64 v169, s49, v169
v_bfe_u32 v168, v169, 2, 14
v_lshrrev_b32 v169, 18, v169
s_waitcnt lgkmcnt(6)
v_mfma_f32_16x16x32_f16 v[72:75], v[120:123], v[108:111], v[72:75]
ds_read_u16 v168, v168
ds_read_u16_d16_hi v169, v169
v_exp_f16_sdwa v173, v173 dst_sel:WORD_1 dst_unused:UNUSED_PRESERVE src0_sel:WORD_1
v_mfma_f32_16x16x32_bf16 v[12:15], v[188:191], v[52:55], 0
ds_read_b128 v[188:191], v251 offset:18432
v_cvt_pkrtz_f16_f32 v171, v170, v171
v_mfma_f32_16x16x32_f16 v[128:131], v[120:123], v[104:107], v[128:131]
ds_read_b128 v[120:123], v249 offset:18432
v_and_b32_e64 v171, s49, v171
v_bfe_u32 v170, v171, 2, 14
v_lshrrev_b32_e64 v171, 18, v171
v_exp_f16_sdwa v175, v175 dst_sel:WORD_1 dst_unused:UNUSED_PRESERVE src0_sel:WORD_1
v_mfma_f32_16x16x32_bf16 v[4:7], v[124:127], v[56:59], v[4:7]
ds_read_u16 v170, v170
ds_read_u16_d16_hi v171, v171
v_mfma_f32_16x16x32_f16 v[76:79], v[176:179], v[108:111], v[76:79]
v_pk_add_f16 v173, v173, 1.0 op_sel_hi:[1,0]
v_pk_add_f16 v175, v175, 1.0 op_sel_hi:[1,0]
v_mfma_f32_16x16x32_f16 v[132:135], v[176:179], v[104:107], v[132:135]
ds_read_b128 v[176:179], v249 offset:20480
v_rcp_f16_sdwa v173, v173 dst_sel:WORD_0 dst_unused:UNUSED_PRESERVE src0_sel:WORD_0
v_mfma_f32_16x16x32_bf16 v[12:15], v[124:127], v[60:63], v[12:15]
ds_read_b128 v[124:127], v251 offset:16384
v_rcp_f16_sdwa v175, v175 dst_sel:WORD_0 dst_unused:UNUSED_PRESERVE src0_sel:WORD_0
s_waitcnt lgkmcnt(9)
v_mfma_f32_16x16x32_f16 v[80:83], v[180:183], v[108:111], v[80:83]
v_rcp_f16_sdwa v173, v173 dst_sel:WORD_1 dst_unused:UNUSED_PRESERVE src0_sel:WORD_1
s_waitcnt lgkmcnt(8)
v_mfma_f32_16x16x32_bf16 v[4:7], v[184:187], v[64:67], v[4:7]
v_rcp_f16_sdwa v175, v175 dst_sel:WORD_1 dst_unused:UNUSED_PRESERVE src0_sel:WORD_1
v_mfma_f32_16x16x32_f16 v[136:139], v[180:183], v[104:107], v[136:139]
ds_read_b128 v[180:183], v251 offset:19456
s_setprio 3
v_or_b32 v224, v160, v161
v_mfma_f32_16x16x32_bf16 v[12:15], v[184:187], v[68:71], v[12:15]
ds_read_b128 v[184:187], v249 offset:22528
v_pk_mul_f16 v230, v172, v173
s_waitcnt lgkmcnt(7)
v_mfma_f32_16x16x32_f16 v[84:87], v[188:191], v[108:111], v[84:87]
v_pk_mul_f16 v231, v174, v175
v_or_b32_e64 v225, v162, v163
s_waitcnt lgkmcnt(6)
v_mfma_f32_16x16x32_bf16 v[144:147], v[120:123], v[48:51], 0
v_cvt_pkrtz_f16_f32 v1, v0, v1
v_and_b32_e64 v1, s49, v1
v_mfma_f32_16x16x32_f16 v[140:143], v[188:191], v[104:107], v[140:143]
ds_read_b128 v[188:191], v251 offset:20480
v_bfe_u32 v0, v1, 2, 14
v_mfma_f32_16x16x32_bf16 v[152:155], v[120:123], v[52:55], 0
ds_read_b128 v[120:123], v249 offset:18688
v_lshrrev_b32_e64 v1, 18, v1
v_cvt_pk_f16_f32 v12, v12, v13
v_cvt_pk_f16_f32 v14, v14, v15
s_waitcnt lgkmcnt(5)
v_mfma_f32_16x16x32_bf16 v[144:147], v[176:179], v[56:59], v[144:147]
ds_read_u16 v0, v0
ds_read_u16_d16_hi v1, v1
s_waitcnt lgkmcnt(6)
v_mfma_f32_16x16x32_f16 v[88:91], v[124:127], v[108:111], v[88:91]
v_pk_fma_f16 v13, v12, v12, s48
v_or_b32_e64 v226, v164, v165
v_mfma_f32_16x16x32_f16 v[240:243], v[124:127], v[104:107], v[240:243]
ds_read_b128 v[124:127], v251 offset:23552
v_cvt_pkrtz_f16_f32 v3, v2, v3
v_and_b32_e64 v3, s49, v3
v_bfe_u32 v2, v3, 2, 14
v_lshrrev_b32 v3, 18, v3
s_waitcnt lgkmcnt(6)
v_mfma_f32_16x16x32_f16 v[92:95], v[180:183], v[108:111], v[92:95]
ds_read_u16 v2, v2
ds_read_u16_d16_hi v3, v3
v_mfma_f32_16x16x32_bf16 v[152:155], v[176:179], v[60:63], v[152:155]
ds_read_b128 v[176:179], v249 offset:20736
v_pk_fma_f16 v15, v14, v14, s48
v_pk_mul_f16 v13, v12, v13
v_mfma_f32_16x16x32_f16 v[244:247], v[180:183], v[104:107], v[244:247]
ds_read_b128 v[180:183], v251 offset:21504
v_or_b32 v227, v166, v167
s_waitcnt lgkmcnt(8)
v_mfma_f32_16x16x32_bf16 v[144:147], v[184:187], v[64:67], v[144:147]
v_cvt_pkrtz_f16_f32 v5, v4, v5
v_and_b32_e64 v5, s49, v5
v_bfe_u32 v4, v5, 2, 14
v_lshrrev_b32_e64 v5, 18, v5
v_pk_mul_f16 v15, v14, v15
v_exp_f16_sdwa v13, v13 dst_sel:WORD_0 dst_unused:UNUSED_PRESERVE src0_sel:WORD_0
v_mfma_f32_16x16x32_f16 v[72:75], v[188:191], v[204:207], v[72:75]
ds_read_u16 v4, v4
ds_read_u16_d16_hi v5, v5
buffer_store_dwordx4 v[232:235], v253, s[8:11], s71 offen offset:128 sc1
buffer_store_dwordx4 v[236:239], v253, s[8:11], s71 offen offset:192 sc1
s_setprio 2
v_mfma_f32_16x16x32_bf16 v[152:155], v[184:187], v[68:71], v[152:155]
ds_read_b128 v[184:187], v251 offset:24576
v_or_b32 v228, v168, v169
v_cvt_pkrtz_f16_f32 v7, v6, v7
v_and_b32_e64 v7, s49, v7
v_bfe_u32 v6, v7, 2, 14
v_lshrrev_b32_e64 v7, 18, v7
v_mfma_f32_16x16x32_f16 v[128:131], v[188:191], v[200:203], v[128:131]
ds_read_u16 v6, v6
ds_read_u16_d16_hi v7, v7
ds_read_b128 v[188:191], v249 offset:22784
v_exp_f16_sdwa v15, v15 dst_sel:WORD_0 dst_unused:UNUSED_PRESERVE src0_sel:WORD_0
s_waitcnt lgkmcnt(9)
v_mfma_f32_16x16x32_bf16 v[148:151], v[120:123], v[48:51], 0
v_or_b32 v229, v170, v171
v_cvt_pkrtz_f16_f32 v9, v8, v9
v_and_b32_e64 v9, s49, v9
v_bfe_u32 v8, v9, 2, 14
v_lshrrev_b32_e64 v9, 18, v9
v_mfma_f32_16x16x32_f16 v[76:79], v[124:127], v[204:207], v[76:79]
ds_read_u16 v8, v8
ds_read_u16_d16_hi v9, v9
v_exp_f16_sdwa v13, v13 dst_sel:WORD_1 dst_unused:UNUSED_PRESERVE src0_sel:WORD_1
v_mfma_f32_16x16x32_bf16 v[156:159], v[120:123], v[52:55], 0
ds_read_b128 v[120:123], v251 offset:22528
v_cvt_pkrtz_f16_f32 v11, v10, v11
v_mfma_f32_16x16x32_f16 v[132:135], v[124:127], v[200:203], v[132:135]
ds_read_b128 v[124:127], v249 offset:24576
v_and_b32_e64 v11, s49, v11
v_bfe_u32 v10, v11, 2, 14
v_lshrrev_b32 v11, 18, v11
v_exp_f16_sdwa v15, v15 dst_sel:WORD_1 dst_unused:UNUSED_PRESERVE src0_sel:WORD_1
s_waitcnt lgkmcnt(9)
v_mfma_f32_16x16x32_bf16 v[148:151], v[176:179], v[56:59], v[148:151]
ds_read_u16 v10, v10
ds_read_u16_d16_hi v11, v11
v_mfma_f32_16x16x32_f16 v[80:83], v[180:183], v[204:207], v[80:83]
v_pk_add_f16 v13, v13, 1.0 op_sel_hi:[1,0]
v_pk_add_f16 v15, v15, 1.0 op_sel_hi:[1,0]
v_mfma_f32_16x16x32_f16 v[136:139], v[180:183], v[200:203], v[136:139]
ds_read_b128 v[180:183], v249 offset:26624
v_rcp_f16_sdwa v13, v13 dst_sel:WORD_0 dst_unused:UNUSED_PRESERVE src0_sel:WORD_0
v_mfma_f32_16x16x32_bf16 v[156:159], v[176:179], v[60:63], v[156:159]
ds_read_b128 v[176:179], v251 offset:25600
v_rcp_f16_sdwa v15, v15 dst_sel:WORD_0 dst_unused:UNUSED_PRESERVE src0_sel:WORD_0
s_waitcnt lgkmcnt(10)
v_mfma_f32_16x16x32_f16 v[84:87], v[184:187], v[204:207], v[84:87]
v_rcp_f16_sdwa v13, v13 dst_sel:WORD_1 dst_unused:UNUSED_PRESERVE src0_sel:WORD_1
s_waitcnt lgkmcnt(8)
v_mfma_f32_16x16x32_bf16 v[148:151], v[188:191], v[64:67], v[148:151]
v_rcp_f16_sdwa v15, v15 dst_sel:WORD_1 dst_unused:UNUSED_PRESERVE src0_sel:WORD_1
v_mfma_f32_16x16x32_f16 v[140:143], v[184:187], v[200:203], v[140:143]
ds_read_b128 v[184:187], v251 offset:26624
s_setprio 1
v_or_b32 v96, v0, v1
v_mfma_f32_16x16x32_bf16 v[156:159], v[188:191], v[68:71], v[156:159]
ds_read_b128 v[188:191], v249 offset:28672
v_pk_mul_f16 v102, v12, v13
s_waitcnt lgkmcnt(7)
v_mfma_f32_16x16x32_f16 v[88:91], v[120:123], v[204:207], v[88:91]
v_pk_mul_f16 v103, v14, v15
v_or_b32_e64 v97, v2, v3
s_waitcnt lgkmcnt(6)
v_mfma_f32_16x16x32_bf16 v[160:163], v[124:127], v[48:51], 0
v_cvt_pkrtz_f16_f32 v145, v144, v145
v_and_b32_e64 v145, s49, v145
v_mfma_f32_16x16x32_f16 v[240:243], v[120:123], v[200:203], v[240:243]
ds_read_b128 v[120:123], v251 offset:29696
v_bfe_u32 v144, v145, 2, 14
v_mfma_f32_16x16x32_bf16 v[168:171], v[124:127], v[52:55], 0
ds_read_b128 v[124:127], v249 offset:24832
v_lshrrev_b32_e64 v145, 18, v145
v_cvt_pk_f16_f32 v156, v156, v157
v_cvt_pk_f16_f32 v158, v158, v159
v_pk_fma_f16 v157, v156, v156, s48
v_or_b32_e64 v98, v4, v5
v_cvt_pkrtz_f16_f32 v147, v146, v147
v_and_b32 v147, s49, v147
ds_read_u16 v144, v144
ds_read_u16_d16_hi v145, v145
s_waitcnt lgkmcnt(7)
v_mfma_f32_16x16x32_bf16 v[160:163], v[180:183], v[56:59], v[160:163]
v_bfe_u32 v146, v147, 2, 14
v_lshrrev_b32 v147, 18, v147
s_waitcnt lgkmcnt(6)
v_mfma_f32_16x16x32_f16 v[92:95], v[176:179], v[204:207], v[92:95]
ds_read_u16 v146, v146
ds_read_u16_d16_hi v147, v147
v_mfma_f32_16x16x32_f16 v[244:247], v[176:179], v[200:203], v[244:247]
ds_read_b128 v[176:179], v251 offset:27648
v_pk_fma_f16 v159, v158, v158, s48
s_waitcnt lgkmcnt(8)
v_mfma_f32_16x16x32_f16 v[72:75], v[184:187], v[212:215], v[72:75]
v_pk_mul_f16 v157, v156, v157
v_or_b32 v99, v6, v7
v_mfma_f32_16x16x32_bf16 v[168:171], v[180:183], v[60:63], v[168:171]
ds_read_b128 v[180:183], v249 offset:26880
v_cvt_pkrtz_f16_f32 v149, v148, v149
v_mfma_f32_16x16x32_f16 v[128:131], v[184:187], v[208:211], v[128:131]
ds_read_b128 v[184:187], v251 offset:30720
v_and_b32 v149, s49, v149
s_waitcnt lgkmcnt(8)
v_mfma_f32_16x16x32_bf16 v[160:163], v[188:191], v[64:67], v[160:163]
v_bfe_u32 v148, v149, 2, 14
v_lshrrev_b32_e64 v149, 18, v149
v_pk_mul_f16 v159, v158, v159
v_exp_f16_sdwa v157, v157 dst_sel:WORD_0 dst_unused:UNUSED_PRESERVE src0_sel:WORD_0
v_mfma_f32_16x16x32_f16 v[76:79], v[120:123], v[212:215], v[76:79]
ds_read_u16 v148, v148
ds_read_u16_d16_hi v149, v149
buffer_load_dwordx4 v[232:235], v253, s[4:7], s70 offen
buffer_load_dwordx4 v[236:239], v253, s[4:7], s70 offen offset:64
s_setprio 0
v_mfma_f32_16x16x32_bf16 v[168:171], v[188:191], v[68:71], v[168:171]
ds_read_b128 v[188:191], v251 offset:28672
v_or_b32 v100, v8, v9
v_cvt_pkrtz_f16_f32 v151, v150, v151
v_and_b32_e64 v151, s49, v151
v_bfe_u32 v150, v151, 2, 14
v_lshrrev_b32_e64 v151, 18, v151
v_mfma_f32_16x16x32_f16 v[132:135], v[120:123], v[208:211], v[132:135]
ds_read_u16 v150, v150
ds_read_u16_d16_hi v151, v151
ds_read_b128 v[120:123], v249 offset:28928
v_exp_f16_sdwa v159, v159 dst_sel:WORD_0 dst_unused:UNUSED_PRESERVE src0_sel:WORD_0
s_waitcnt lgkmcnt(10)
v_mfma_f32_16x16x32_bf16 v[164:167], v[124:127], v[48:51], 0
v_or_b32 v101, v10, v11
v_cvt_pkrtz_f16_f32 v153, v152, v153
v_and_b32_e64 v153, s49, v153
v_bfe_u32 v152, v153, 2, 14
v_lshrrev_b32 v153, 18, v153
s_waitcnt lgkmcnt(8)
v_mfma_f32_16x16x32_f16 v[80:83], v[176:179], v[212:215], v[80:83]
ds_read_u16 v152, v152
ds_read_u16_d16_hi v153, v153
v_exp_f16_sdwa v157, v157 dst_sel:WORD_1 dst_unused:UNUSED_PRESERVE src0_sel:WORD_1
v_mfma_f32_16x16x32_bf16 v[172:175], v[124:127], v[52:55], 0
ds_read_b128 v[124:127], v251 offset:31744
v_cvt_pkrtz_f16_f32 v155, v154, v155
v_mfma_f32_16x16x32_f16 v[136:139], v[176:179], v[208:211], v[136:139]
ds_read_b128 v[176:179], v249 offset:30720
v_and_b32_e64 v155, s49, v155
v_bfe_u32 v154, v155, 2, 14
v_lshrrev_b32 v155, 18, v155
v_exp_f16_sdwa v159, v159 dst_sel:WORD_1 dst_unused:UNUSED_PRESERVE src0_sel:WORD_1
s_waitcnt lgkmcnt(9)
v_mfma_f32_16x16x32_bf16 v[164:167], v[180:183], v[56:59], v[164:167]
ds_read_u16 v154, v154
ds_read_u16_d16_hi v155, v155
v_mfma_f32_16x16x32_f16 v[84:87], v[184:187], v[212:215], v[84:87]
v_pk_add_f16 v157, v157, 1.0 op_sel_hi:[1,0]
v_pk_add_f16 v159, v159, 1.0 op_sel_hi:[1,0]
v_mfma_f32_16x16x32_f16 v[140:143], v[184:187], v[208:211], v[140:143]
ds_read_b128 v[184:187], v249 offset:32768
v_rcp_f16_sdwa v157, v157 dst_sel:WORD_0 dst_unused:UNUSED_PRESERVE src0_sel:WORD_0
v_mfma_f32_16x16x32_bf16 v[172:175], v[180:183], v[60:63], v[172:175]
ds_read_b128 v[180:183], v251 offset:32768
v_rcp_f16_sdwa v159, v159 dst_sel:WORD_0 dst_unused:UNUSED_PRESERVE src0_sel:WORD_0
s_waitcnt lgkmcnt(10)
v_mfma_f32_16x16x32_f16 v[88:91], v[188:191], v[212:215], v[88:91]
v_rcp_f16_sdwa v157, v157 dst_sel:WORD_1 dst_unused:UNUSED_PRESERVE src0_sel:WORD_1
s_waitcnt lgkmcnt(8)
v_mfma_f32_16x16x32_bf16 v[164:167], v[120:123], v[64:67], v[164:167]
v_rcp_f16_sdwa v159, v159 dst_sel:WORD_1 dst_unused:UNUSED_PRESERVE src0_sel:WORD_1
v_mfma_f32_16x16x32_f16 v[240:243], v[188:191], v[208:211], v[240:243]
ds_read_b128 v[188:191], v251 offset:35840
s_setprio 3
v_or_b32 v104, v144, v145
v_mfma_f32_16x16x32_bf16 v[172:175], v[120:123], v[68:71], v[172:175]
ds_read_b128 v[120:123], v249 offset:34816
v_pk_mul_f16 v110, v156, v157
v_pk_mul_f16 v111, v158, v159
v_or_b32_e64 v105, v146, v147
v_cvt_pkrtz_f16_f32 v161, v160, v161
v_and_b32 v161, s49, v161
v_bfe_u32 v160, v161, 2, 14
s_waitcnt lgkmcnt(7)
v_mfma_f32_16x16x32_f16 v[92:95], v[124:127], v[212:215], v[92:95]
buffer_store_dwordx4 v[16:19], v253, s[8:11], s71 offen offset:256 sc1
buffer_store_dwordx4 v[20:23], v253, s[8:11], s71 offen offset:320 sc1
v_lshrrev_b32 v161, 18, v161
s_waitcnt lgkmcnt(6)
v_mfma_f32_16x16x32_bf16 v[0:3], v[176:179], v[48:51], 0
ds_read_u16 v160, v160
ds_read_u16_d16_hi v161, v161
v_mfma_f32_16x16x32_f16 v[244:247], v[124:127], v[208:211], v[244:247]
ds_read_b128 v[124:127], v251 offset:33792
v_cvt_pk_f16_f32 v172, v172, v173
v_mfma_f32_16x16x32_bf16 v[8:11], v[176:179], v[52:55], 0
ds_read_b128 v[176:179], v249 offset:30976
v_cvt_pk_f16_f32 v174, v174, v175
v_pk_fma_f16 v173, v172, v172, s48
v_or_b32_e64 v106, v148, v149
v_cvt_pkrtz_f16_f32 v163, v162, v163
v_and_b32_e64 v163, s49, v163
v_bfe_u32 v162, v163, 2, 14
v_lshrrev_b32 v163, 18, v163
v_pk_fma_f16 v175, v174, v174, s48
s_waitcnt lgkmcnt(7)
v_mfma_f32_16x16x32_bf16 v[0:3], v[184:187], v[56:59], v[0:3]
ds_read_u16 v162, v162
ds_read_u16_d16_hi v163, v163
s_waitcnt lgkmcnt(8)
v_mfma_f32_16x16x32_f16 v[72:75], v[180:183], v[196:199], v[72:75]
v_pk_mul_f16 v173, v172, v173
v_or_b32 v107, v150, v151
v_mfma_f32_16x16x32_f16 v[128:131], v[180:183], v[192:195], v[128:131]
ds_read_b128 v[180:183], v251 offset:36864
buffer_load_dwordx4 v[200:203], v253, s[4:7], s70 offen offset:128
buffer_load_dwordx4 v[204:207], v253, s[4:7], s70 offen offset:192
s_waitcnt lgkmcnt(8)
v_mfma_f32_16x16x32_f16 v[76:79], v[188:191], v[196:199], v[76:79]
v_cvt_pkrtz_f16_f32 v165, v164, v165
v_and_b32 v165, s49, v165
v_mfma_f32_16x16x32_bf16 v[8:11], v[184:187], v[60:63], v[8:11]
ds_read_b128 v[184:187], v251 offset:34816
v_bfe_u32 v164, v165, 2, 14
v_mfma_f32_16x16x32_f16 v[132:135], v[188:191], v[192:195], v[132:135]
ds_read_b128 v[188:191], v249 offset:33024
v_lshrrev_b32 v165, 18, v165
s_waitcnt lgkmcnt(9)
v_mfma_f32_16x16x32_bf16 v[0:3], v[120:123], v[64:67], v[0:3]
ds_read_u16 v164, v164
ds_read_u16_d16_hi v165, v165
v_pk_mul_f16 v175, v174, v175
v_exp_f16_sdwa v173, v173 dst_sel:WORD_0 dst_unused:UNUSED_PRESERVE src0_sel:WORD_0
s_waitcnt lgkmcnt(8)
v_mfma_f32_16x16x32_f16 v[80:83], v[124:127], v[196:199], v[80:83]
s_setprio 2
v_or_b32_e64 v108, v152, v153
v_cvt_pkrtz_f16_f32 v167, v166, v167
v_mfma_f32_16x16x32_bf16 v[8:11], v[120:123], v[68:71], v[8:11]
ds_read_b128 v[120:123], v251 offset:37888
v_and_b32_e64 v167, s49, v167
v_bfe_u32 v166, v167, 2, 14
v_lshrrev_b32_e64 v167, 18, v167
v_mfma_f32_16x16x32_f16 v[136:139], v[124:127], v[192:195], v[136:139]
ds_read_u16 v166, v166
ds_read_u16_d16_hi v167, v167
ds_read_b128 v[124:127], v249 offset:35072
v_exp_f16_sdwa v175, v175 dst_sel:WORD_0 dst_unused:UNUSED_PRESERVE src0_sel:WORD_0
s_waitcnt lgkmcnt(11)
v_mfma_f32_16x16x32_bf16 v[4:7], v[176:179], v[48:51], 0
v_or_b32 v109, v154, v155
v_cvt_pkrtz_f16_f32 v169, v168, v169
v_and_b32_e64 v169, s49, v169
v_bfe_u32 v168, v169, 2, 14
v_lshrrev_b32 v169, 18, v169
s_waitcnt lgkmcnt(8)
v_mfma_f32_16x16x32_f16 v[84:87], v[180:183], v[196:199], v[84:87]
ds_read_u16 v168, v168
ds_read_u16_d16_hi v169, v169
v_exp_f16_sdwa v173, v173 dst_sel:WORD_1 dst_unused:UNUSED_PRESERVE src0_sel:WORD_1
v_mfma_f32_16x16x32_bf16 v[12:15], v[176:179], v[52:55], 0
ds_read_b128 v[176:179], v251 offset:38912
v_cvt_pkrtz_f16_f32 v171, v170, v171
v_mfma_f32_16x16x32_f16 v[140:143], v[180:183], v[192:195], v[140:143]
ds_read_b128 v[180:183], v248
v_and_b32_e64 v171, s49, v171
v_bfe_u32 v170, v171, 2, 14
v_lshrrev_b32 v171, 18, v171
v_exp_f16_sdwa v175, v175 dst_sel:WORD_1 dst_unused:UNUSED_PRESERVE src0_sel:WORD_1
s_waitcnt lgkmcnt(10)
v_mfma_f32_16x16x32_f16 v[88:91], v[184:187], v[196:199], v[88:91]
ds_read_u16 v170, v170
ds_read_u16_d16_hi v171, v171
v_mfma_f32_16x16x32_bf16 v[4:7], v[188:191], v[56:59], v[4:7]
v_pk_add_f16 v173, v173, 1.0 op_sel_hi:[1,0]
v_pk_add_f16 v175, v175, 1.0 op_sel_hi:[1,0]
v_mfma_f32_16x16x32_f16 v[240:243], v[184:187], v[192:195], v[240:243]
ds_read_b128 v[184:187], v251 offset:41984
v_rcp_f16_sdwa v173, v173 dst_sel:WORD_0 dst_unused:UNUSED_PRESERVE src0_sel:WORD_0
v_mfma_f32_16x16x32_bf16 v[12:15], v[188:191], v[60:63], v[12:15]
ds_read_b128 v[188:191], v248 offset:2048
v_rcp_f16_sdwa v175, v175 dst_sel:WORD_0 dst_unused:UNUSED_PRESERVE src0_sel:WORD_0
s_waitcnt lgkmcnt(11)
v_mfma_f32_16x16x32_f16 v[92:95], v[120:123], v[196:199], v[92:95]
v_rcp_f16_sdwa v173, v173 dst_sel:WORD_1 dst_unused:UNUSED_PRESERVE src0_sel:WORD_1
v_mfma_f32_16x16x32_f16 v[244:247], v[120:123], v[192:195], v[244:247]
ds_read_b128 v[120:123], v251 offset:39936
v_rcp_f16_sdwa v175, v175 dst_sel:WORD_1 dst_unused:UNUSED_PRESERVE src0_sel:WORD_1
s_waitcnt lgkmcnt(9)
v_mfma_f32_16x16x32_bf16 v[4:7], v[124:127], v[64:67], v[4:7]
s_setprio 1
v_or_b32 v208, v160, v161
v_pk_mul_f16 v214, v172, v173
v_mfma_f32_16x16x32_bf16 v[12:15], v[124:127], v[68:71], v[12:15]
ds_read_b128 v[124:127], v248 offset:4096
v_pk_mul_f16 v215, v174, v175
v_or_b32_e64 v209, v162, v163
v_cvt_pkrtz_f16_f32 v1, v0, v1
v_and_b32_e64 v1, s49, v1
v_bfe_u32 v0, v1, 2, 14
v_lshrrev_b32 v1, 18, v1
v_or_b32 v210, v164, v165
v_cvt_pkrtz_f16_f32 v3, v2, v3
v_cvt_pk_f16_f32 v12, v12, v13
s_waitcnt lgkmcnt(7)
v_mfma_f32_16x16x32_f16 v[72:75], v[176:179], v[220:223], v[72:75]
ds_read_u16 v0, v0
ds_read_u16_d16_hi v1, v1
s_waitcnt lgkmcnt(8)
v_mfma_f32_16x16x32_bf16 v[144:147], v[180:183], v[24:27], 0
v_cvt_pk_f16_f32 v14, v14, v15
v_pk_fma_f16 v13, v12, v12, s48
v_mfma_f32_16x16x32_f16 v[128:131], v[176:179], v[216:219], v[128:131]
ds_read_b128 v[176:179], v251 offset:43008
v_and_b32_e64 v3, s49, v3
v_mfma_f32_16x16x32_bf16 v[152:155], v[180:183], v[28:31], 0
ds_read_b128 v[180:183], v248 offset:256
v_bfe_u32 v2, v3, 2, 14
v_lshrrev_b32_e64 v3, 18, v3
v_pk_fma_f16 v15, v14, v14, s48
v_pk_mul_f16 v13, v12, v13
v_or_b32_e64 v211, v166, v167
v_cvt_pkrtz_f16_f32 v5, v4, v5
v_and_b32 v5, s49, v5
s_waitcnt lgkmcnt(7)
v_mfma_f32_16x16x32_f16 v[76:79], v[184:187], v[220:223], v[76:79]
ds_read_u16 v2, v2
ds_read_u16_d16_hi v3, v3
v_mfma_f32_16x16x32_f16 v[132:135], v[184:187], v[216:219], v[132:135]
ds_read_b128 v[184:187], v251 offset:40960
v_bfe_u32 v4, v5, 2, 14
s_waitcnt lgkmcnt(9)
v_mfma_f32_16x16x32_bf16 v[144:147], v[188:191], v[32:35], v[144:147]
v_lshrrev_b32_e64 v5, 18, v5
v_pk_mul_f16 v15, v14, v15
s_waitcnt lgkmcnt(8)
v_mfma_f32_16x16x32_f16 v[80:83], v[120:123], v[220:223], v[80:83]
ds_read_u16 v4, v4
ds_read_u16_d16_hi v5, v5
v_mfma_f32_16x16x32_bf16 v[152:155], v[188:191], v[36:39], v[152:155]
ds_read_b128 v[188:191], v251 offset:44032
v_exp_f16_sdwa v13, v13 dst_sel:WORD_0 dst_unused:UNUSED_PRESERVE src0_sel:WORD_0
v_mfma_f32_16x16x32_f16 v[136:139], v[120:123], v[216:219], v[136:139]
ds_read_b128 v[120:123], v248 offset:2304
v_or_b32 v212, v168, v169
s_waitcnt lgkmcnt(11)
v_mfma_f32_16x16x32_bf16 v[144:147], v[124:127], v[40:43], v[144:147]
v_cvt_pkrtz_f16_f32 v7, v6, v7
v_and_b32 v7, s49, v7
v_mfma_f32_16x16x32_bf16 v[152:155], v[124:127], v[44:47], v[152:155]
s_setprio 0
ds_read_b128 v[124:127], v251 offset:45056
v_bfe_u32 v6, v7, 2, 14
s_waitcnt lgkmcnt(9)
v_mfma_f32_16x16x32_f16 v[84:87], v[176:179], v[220:223], v[84:87]
v_lshrrev_b32 v7, 18, v7
v_exp_f16_sdwa v15, v15 dst_sel:WORD_0 dst_unused:UNUSED_PRESERVE src0_sel:WORD_0
v_mfma_f32_16x16x32_f16 v[140:143], v[176:179], v[216:219], v[140:143]
ds_read_u16 v6, v6
ds_read_u16_d16_hi v7, v7
ds_read_b128 v[176:179], v248 offset:4352
s_waitcnt lgkmcnt(11)
v_mfma_f32_16x16x32_bf16 v[148:151], v[180:183], v[24:27], 0
buffer_load_dwordx4 v[48:51], v250, s[32:35], s80 offen
v_or_b32 v213, v170, v171
v_cvt_pkrtz_f16_f32 v9, v8, v9
v_and_b32_e64 v9, s49, v9
v_bfe_u32 v8, v9, 2, 14
v_lshrrev_b32 v9, 18, v9
v_exp_f16_sdwa v13, v13 dst_sel:WORD_1 dst_unused:UNUSED_PRESERVE src0_sel:WORD_1
v_mfma_f32_16x16x32_bf16 v[156:159], v[180:183], v[28:31], 0
ds_read_u16 v8, v8
ds_read_u16_d16_hi v9, v9
s_waitcnt lgkmcnt(10)
v_mfma_f32_16x16x32_f16 v[88:91], v[184:187], v[220:223], v[88:91]
ds_read_b128 v[180:183], v251 offset:48128
v_cvt_pkrtz_f16_f32 v11, v10, v11
v_mfma_f32_16x16x32_f16 v[240:243], v[184:187], v[216:219], v[240:243]
ds_read_b128 v[184:187], v248 offset:6144
v_and_b32_e64 v11, s49, v11
v_bfe_u32 v10, v11, 2, 14
v_lshrrev_b32_e64 v11, 18, v11
v_exp_f16_sdwa v15, v15 dst_sel:WORD_1 dst_unused:UNUSED_PRESERVE src0_sel:WORD_1
v_pk_add_f16 v13, v13, 1.0 op_sel_hi:[1,0]
v_pk_add_f16 v15, v15, 1.0 op_sel_hi:[1,0]
v_rcp_f16_sdwa v13, v13 dst_sel:WORD_0 dst_unused:UNUSED_PRESERVE src0_sel:WORD_0
s_waitcnt lgkmcnt(9)
v_mfma_f32_16x16x32_f16 v[92:95], v[188:191], v[220:223], v[92:95]
ds_read_u16 v10, v10
ds_read_u16_d16_hi v11, v11
s_waitcnt lgkmcnt(10)
v_mfma_f32_16x16x32_bf16 v[148:151], v[120:123], v[32:35], v[148:151]
v_rcp_f16_sdwa v15, v15 dst_sel:WORD_0 dst_unused:UNUSED_PRESERVE src0_sel:WORD_0
v_mfma_f32_16x16x32_f16 v[244:247], v[188:191], v[216:219], v[244:247]
ds_read_b128 v[188:191], v251 offset:46080
v_rcp_f16_sdwa v13, v13 dst_sel:WORD_1 dst_unused:UNUSED_PRESERVE src0_sel:WORD_1
v_mfma_f32_16x16x32_bf16 v[156:159], v[120:123], v[36:39], v[156:159]
ds_read_b128 v[120:123], v248 offset:8192
buffer_load_dwordx4 v[192:195], v253, s[4:7], s70 offen offset:256
buffer_load_dwordx4 v[196:199], v253, s[4:7], s70 offen offset:320
s_waitcnt lgkmcnt(11)
v_mfma_f32_16x16x32_f16 v[72:75], v[124:127], v[116:119], v[72:75]
v_rcp_f16_sdwa v15, v15 dst_sel:WORD_1 dst_unused:UNUSED_PRESERVE src0_sel:WORD_1
v_mfma_f32_16x16x32_f16 v[128:131], v[124:127], v[112:115], v[128:131]
s_setprio 3
ds_read_b128 v[124:127], v251 offset:49152
v_or_b32 v216, v0, v1
v_pk_mul_f16 v222, v12, v13
s_waitcnt lgkmcnt(9)
v_mfma_f32_16x16x32_bf16 v[148:151], v[176:179], v[40:43], v[148:151]
v_pk_mul_f16 v223, v14, v15
v_or_b32_e64 v217, v2, v3
v_mfma_f32_16x16x32_bf16 v[156:159], v[176:179], v[44:47], v[156:159]
ds_read_b128 v[176:179], v248 offset:10240
v_cvt_pkrtz_f16_f32 v145, v144, v145
v_and_b32_e64 v145, s49, v145
v_bfe_u32 v144, v145, 2, 14
v_lshrrev_b32 v145, 18, v145
v_or_b32 v218, v4, v5
v_cvt_pkrtz_f16_f32 v147, v146, v147
v_and_b32 v147, s49, v147
v_bfe_u32 v146, v147, 2, 14
v_cvt_pk_f16_f32 v156, v156, v157
v_cvt_pk_f16_f32 v158, v158, v159
ds_read_u16 v144, v144
s_waitcnt lgkmcnt(8)
v_mfma_f32_16x16x32_f16 v[76:79], v[180:183], v[116:119], v[76:79]
ds_read_u16_d16_hi v145, v145
v_pk_fma_f16 v157, v156, v156, s48
v_mfma_f32_16x16x32_f16 v[132:135], v[180:183], v[112:115], v[132:135]
ds_read_b128 v[180:183], v251 offset:47104
v_lshrrev_b32 v147, 18, v147
s_waitcnt lgkmcnt(9)
v_mfma_f32_16x16x32_bf16 v[160:163], v[184:187], v[24:27], 0
ds_read_u16 v146, v146
ds_read_u16_d16_hi v147, v147
v_mfma_f32_16x16x32_bf16 v[168:171], v[184:187], v[28:31], 0
ds_read_b128 v[184:187], v248 offset:6400
v_pk_fma_f16 v159, v158, v158, s48
v_pk_mul_f16 v157, v156, v157
v_or_b32_e64 v219, v6, v7
v_cvt_pkrtz_f16_f32 v149, v148, v149
v_and_b32_e64 v149, s49, v149
v_bfe_u32 v148, v149, 2, 14
v_lshrrev_b32 v149, 18, v149
v_pk_mul_f16 v159, v158, v159
s_waitcnt lgkmcnt(9)
v_mfma_f32_16x16x32_f16 v[80:83], v[188:191], v[116:119], v[80:83]
ds_read_u16 v148, v148
ds_read_u16_d16_hi v149, v149
v_mfma_f32_16x16x32_f16 v[136:139], v[188:191], v[112:115], v[136:139]
ds_read_b128 v[188:191], v251 offset:50176
v_exp_f16_sdwa v157, v157 dst_sel:WORD_0 dst_unused:UNUSED_PRESERVE src0_sel:WORD_0
s_waitcnt lgkmcnt(11)
v_mfma_f32_16x16x32_bf16 v[160:163], v[120:123], v[32:35], v[160:163]
s_add_u32 s46, s80, 2097152
buffer_load_dwordx4 v[52:55], v250, s[32:35], s46 offen
v_or_b32_e64 v220, v8, v9
s_waitcnt lgkmcnt(10)
v_mfma_f32_16x16x32_f16 v[84:87], v[124:127], v[116:119], v[84:87]
v_cvt_pkrtz_f16_f32 v151, v150, v151
v_and_b32_e64 v151, s49, v151
v_mfma_f32_16x16x32_bf16 v[168:171], v[120:123], v[36:39], v[168:171]
ds_read_b128 v[120:123], v251 offset:51200
v_bfe_u32 v150, v151, 2, 14
v_mfma_f32_16x16x32_f16 v[140:143], v[124:127], v[112:115], v[140:143]
ds_read_b128 v[124:127], v248 offset:8448
v_lshrrev_b32_e64 v151, 18, v151
s_waitcnt lgkmcnt(11)
v_mfma_f32_16x16x32_bf16 v[160:163], v[176:179], v[40:43], v[160:163]
s_setprio 2
ds_read_u16 v150, v150
ds_read_u16_d16_hi v151, v151
v_mfma_f32_16x16x32_bf16 v[168:171], v[176:179], v[44:47], v[168:171]
ds_read_b128 v[176:179], v251 offset:54272
v_exp_f16_sdwa v159, v159 dst_sel:WORD_0 dst_unused:UNUSED_PRESERVE src0_sel:WORD_0
s_waitcnt lgkmcnt(11)
v_mfma_f32_16x16x32_f16 v[88:91], v[180:183], v[116:119], v[88:91]
v_or_b32 v221, v10, v11
v_cvt_pkrtz_f16_f32 v153, v152, v153
v_mfma_f32_16x16x32_f16 v[240:243], v[180:183], v[112:115], v[240:243]
ds_read_b128 v[180:183], v248 offset:10496
v_and_b32_e64 v153, s49, v153
v_bfe_u32 v152, v153, 2, 14
v_lshrrev_b32_e64 v153, 18, v153
v_exp_f16_sdwa v157, v157 dst_sel:WORD_1 dst_unused:UNUSED_PRESERVE src0_sel:WORD_1
v_cvt_pkrtz_f16_f32 v155, v154, v155
v_and_b32_e64 v155, s49, v155
v_bfe_u32 v154, v155, 2, 14
v_lshrrev_b32 v155, 18, v155
s_waitcnt lgkmcnt(9)
v_mfma_f32_16x16x32_bf16 v[164:167], v[184:187], v[24:27], 0
ds_read_u16 v152, v152
ds_read_u16_d16_hi v153, v153
v_mfma_f32_16x16x32_bf16 v[172:175], v[184:187], v[28:31], 0
ds_read_b128 v[184:187], v251 offset:52224
ds_read_u16 v154, v154
ds_read_u16_d16_hi v155, v155
v_exp_f16_sdwa v159, v159 dst_sel:WORD_1 dst_unused:UNUSED_PRESERVE src0_sel:WORD_1
v_pk_add_f16 v157, v157, 1.0 op_sel_hi:[1,0]
v_pk_add_f16 v159, v159, 1.0 op_sel_hi:[1,0]
v_rcp_f16_sdwa v157, v157 dst_sel:WORD_0 dst_unused:UNUSED_PRESERVE src0_sel:WORD_0
v_rcp_f16_sdwa v159, v159 dst_sel:WORD_0 dst_unused:UNUSED_PRESERVE src0_sel:WORD_0
v_rcp_f16_sdwa v157, v157 dst_sel:WORD_1 dst_unused:UNUSED_PRESERVE src0_sel:WORD_1
s_waitcnt lgkmcnt(11)
v_mfma_f32_16x16x32_f16 v[92:95], v[188:191], v[116:119], v[92:95]
v_rcp_f16_sdwa v159, v159 dst_sel:WORD_1 dst_unused:UNUSED_PRESERVE src0_sel:WORD_1
v_mfma_f32_16x16x32_f16 v[244:247], v[188:191], v[112:115], v[244:247]
ds_read_b128 v[188:191], v248 offset:12288
v_or_b32_e64 v112, v144, v145
s_waitcnt lgkmcnt(11)
v_mfma_f32_16x16x32_f16 v[72:75], v[120:123], v[228:231], v[72:75]
v_pk_mul_f16 v118, v156, v157
v_pk_mul_f16 v119, v158, v159
s_waitcnt lgkmcnt(10)
v_mfma_f32_16x16x32_bf16 v[164:167], v[124:127], v[32:35], v[164:167]
v_or_b32 v113, v146, v147
v_cvt_pkrtz_f16_f32 v161, v160, v161
v_mfma_f32_16x16x32_f16 v[128:131], v[120:123], v[224:227], v[128:131]
ds_read_b128 v[120:123], v251 offset:55296
v_and_b32_e64 v161, s49, v161
v_mfma_f32_16x16x32_bf16 v[172:175], v[124:127], v[36:39], v[172:175]
ds_read_b128 v[124:127], v248 offset:14336
v_bfe_u32 v160, v161, 2, 14
v_lshrrev_b32_e64 v161, 18, v161
v_or_b32 v114, v148, v149
s_waitcnt lgkmcnt(9)
v_mfma_f32_16x16x32_f16 v[76:79], v[176:179], v[228:231], v[76:79]
ds_read_u16 v160, v160
ds_read_u16_d16_hi v161, v161
s_waitcnt lgkmcnt(10)
v_mfma_f32_16x16x32_bf16 v[164:167], v[180:183], v[40:43], v[164:167]
s_setprio 1
v_cvt_pkrtz_f16_f32 v163, v162, v163
v_and_b32_e64 v163, s49, v163
v_mfma_f32_16x16x32_f16 v[132:135], v[176:179], v[224:227], v[132:135]
ds_read_b128 v[176:179], v251 offset:53248
s_add_u32 s46, s80, 4194304
buffer_load_dwordx4 v[56:59], v250, s[32:35], s46 offen
v_bfe_u32 v162, v163, 2, 14
v_mfma_f32_16x16x32_bf16 v[172:175], v[180:183], v[44:47], v[172:175]
ds_read_b128 v[180:183], v248 offset:16384
v_lshrrev_b32 v163, 18, v163
v_or_b32 v115, v150, v151
v_cvt_pkrtz_f16_f32 v165, v164, v165
v_and_b32_e64 v165, s49, v165
v_bfe_u32 v164, v165, 2, 14
v_lshrrev_b32 v165, 18, v165
s_waitcnt lgkmcnt(9)
v_mfma_f32_16x16x32_f16 v[80:83], v[184:187], v[228:231], v[80:83]
v_cvt_pk_f16_f32 v172, v172, v173
v_cvt_pk_f16_f32 v174, v174, v175
v_mfma_f32_16x16x32_f16 v[136:139], v[184:187], v[224:227], v[136:139]
ds_read_b128 v[184:187], v251 offset:56320
v_pk_fma_f16 v173, v172, v172, s48
v_pk_fma_f16 v175, v174, v174, s48
v_pk_mul_f16 v173, v172, v173
v_pk_mul_f16 v175, v174, v175
v_exp_f16_sdwa v173, v173 dst_sel:WORD_0 dst_unused:UNUSED_PRESERVE src0_sel:WORD_0
v_or_b32_e64 v116, v152, v153
v_cvt_pkrtz_f16_f32 v167, v166, v167
ds_read_u16 v162, v162
ds_read_u16_d16_hi v163, v163
ds_read_u16 v164, v164
ds_read_u16_d16_hi v165, v165
s_waitcnt lgkmcnt(11)
v_mfma_f32_16x16x32_bf16 v[0:3], v[188:191], v[24:27], 0
v_and_b32 v167, s49, v167
v_bfe_u32 v166, v167, 2, 14
v_mfma_f32_16x16x32_bf16 v[8:11], v[188:191], v[28:31], 0
ds_read_b128 v[188:191], v248 offset:12544
v_lshrrev_b32 v167, 18, v167
s_waitcnt lgkmcnt(11)
v_mfma_f32_16x16x32_f16 v[84:87], v[120:123], v[228:231], v[84:87]
ds_read_u16 v166, v166
ds_read_u16_d16_hi v167, v167
v_mfma_f32_16x16x32_f16 v[140:143], v[120:123], v[224:227], v[140:143]
ds_read_b128 v[120:123], v251 offset:57344
v_exp_f16_sdwa v175, v175 dst_sel:WORD_0 dst_unused:UNUSED_PRESERVE src0_sel:WORD_0
s_waitcnt lgkmcnt(13)
v_mfma_f32_16x16x32_bf16 v[0:3], v[124:127], v[32:35], v[0:3]
v_or_b32 v117, v154, v155
v_cvt_pkrtz_f16_f32 v169, v168, v169
v_mfma_f32_16x16x32_bf16 v[8:11], v[124:127], v[36:39], v[8:11]
ds_read_b128 v[124:127], v251 offset:60416
v_and_b32_e64 v169, s49, v169
v_bfe_u32 v168, v169, 2, 14
v_lshrrev_b32 v169, 18, v169
s_waitcnt lgkmcnt(11)
v_mfma_f32_16x16x32_f16 v[88:91], v[176:179], v[228:231], v[88:91]
ds_read_u16 v168, v168
ds_read_u16_d16_hi v169, v169
v_mfma_f32_16x16x32_f16 v[240:243], v[176:179], v[224:227], v[240:243]
ds_read_b128 v[176:179], v248 offset:14592
v_exp_f16_sdwa v173, v173 dst_sel:WORD_1 dst_unused:UNUSED_PRESERVE src0_sel:WORD_1
s_waitcnt lgkmcnt(13)
v_mfma_f32_16x16x32_bf16 v[0:3], v[180:183], v[40:43], v[0:3]
s_setprio 0
v_cvt_pkrtz_f16_f32 v171, v170, v171
v_and_b32 v171, s49, v171
s_waitcnt lgkmcnt(12)
v_mfma_f32_16x16x32_f16 v[92:95], v[184:187], v[228:231], v[92:95]
v_bfe_u32 v170, v171, 2, 14
v_lshrrev_b32 v171, 18, v171
v_mfma_f32_16x16x32_bf16 v[8:11], v[180:183], v[44:47], v[8:11]
ds_read_b128 v[180:183], v251 offset:58368
ds_read_u16 v170, v170
v_mfma_f32_16x16x32_f16 v[244:247], v[184:187], v[224:227], v[244:247]
ds_read_b128 v[184:187], v248 offset:16640
s_waitcnt lgkmcnt(14)
ds_read_u16_d16_hi v171, v171
v_exp_f16_sdwa v175, v175 dst_sel:WORD_1 dst_unused:UNUSED_PRESERVE src0_sel:WORD_1
v_pk_add_f16 v173, v173, 1.0 op_sel_hi:[1,0]
v_pk_add_f16 v175, v175, 1.0 op_sel_hi:[1,0]
v_rcp_f16_sdwa v173, v173 dst_sel:WORD_0 dst_unused:UNUSED_PRESERVE src0_sel:WORD_0
v_rcp_f16_sdwa v175, v175 dst_sel:WORD_0 dst_unused:UNUSED_PRESERVE src0_sel:WORD_0
v_rcp_f16_sdwa v173, v173 dst_sel:WORD_1 dst_unused:UNUSED_PRESERVE src0_sel:WORD_1
v_rcp_f16_sdwa v175, v175 dst_sel:WORD_1 dst_unused:UNUSED_PRESERVE src0_sel:WORD_1
v_or_b32_e64 v224, v160, v161
v_pk_mul_f16 v230, v172, v173
v_pk_mul_f16 v231, v174, v175
s_waitcnt lgkmcnt(11)
v_mfma_f32_16x16x32_bf16 v[4:7], v[188:191], v[24:27], 0
v_or_b32 v225, v162, v163
v_cvt_pkrtz_f16_f32 v1, v0, v1
v_mfma_f32_16x16x32_bf16 v[12:15], v[188:191], v[28:31], 0
ds_read_b128 v[188:191], v251 offset:61440
v_and_b32_e64 v1, s49, v1
v_bfe_u32 v0, v1, 2, 14
v_lshrrev_b32 v1, 18, v1
v_or_b32 v226, v164, v165
v_cvt_pkrtz_f16_f32 v3, v2, v3
v_and_b32_e64 v3, s49, v3
v_bfe_u32 v2, v3, 2, 14
v_lshrrev_b32 v3, 18, v3
s_waitcnt lgkmcnt(10)
v_or_b32 v227, v166, v167
ds_read_u16 v0, v0
ds_read_u16_d16_hi v1, v1
ds_read_u16 v2, v2
s_waitcnt lgkmcnt(12)
v_mfma_f32_16x16x32_f16 v[72:75], v[120:123], v[100:103], v[72:75]
ds_read_u16_d16_hi v3, v3
v_cvt_pkrtz_f16_f32 v9, v8, v9
v_mfma_f32_16x16x32_f16 v[128:131], v[120:123], v[96:99], v[128:131]
ds_read_b128 v[120:123], v248 offset:18432
s_add_u32 s46, s80, 6291456
buffer_load_dwordx4 v[60:63], v250, s[32:35], s46 offen
v_and_b32 v9, s49, v9
s_waitcnt lgkmcnt(13)
v_mfma_f32_16x16x32_f16 v[76:79], v[124:127], v[100:103], v[76:79]
v_bfe_u32 v8, v9, 2, 14
v_lshrrev_b32_e64 v9, 18, v9
v_mfma_f32_16x16x32_f16 v[132:135], v[124:127], v[96:99], v[132:135]
ds_read_b128 v[124:127], v251 offset:59392
ds_read_u16 v8, v8
v_cvt_pkrtz_f16_f32 v11, v10, v11
v_and_b32 v11, s49, v11
s_waitcnt lgkmcnt(13)
v_or_b32_e64 v228, v168, v169
v_bfe_u32 v10, v11, 2, 14
v_lshrrev_b32 v11, 18, v11
ds_read_u16_d16_hi v9, v9
s_waitcnt lgkmcnt(13)
v_mfma_f32_16x16x32_bf16 v[4:7], v[176:179], v[32:35], v[4:7]
ds_read_u16 v10, v10
v_mov_b32_e64 v16, 0
v_mfma_f32_16x16x32_bf16 v[12:15], v[176:179], v[36:39], v[12:15]
ds_read_b128 v[176:179], v248 offset:20480
v_mov_b32 v17, 0
s_waitcnt lgkmcnt(14)
v_mfma_f32_16x16x32_f16 v[80:83], v[180:183], v[100:103], v[80:83]
v_cndmask_b32 v18, 0, v255, s[88:89]
v_cndmask_b32 v19, 0, v255, s[90:91]
v_mfma_f32_16x16x32_f16 v[136:139], v[180:183], v[96:99], v[136:139]
s_setprio 3
ds_read_b128 v[180:183], v251 offset:62464
s_waitcnt lgkmcnt(14)
ds_read_u16_d16_hi v11, v11
s_waitcnt lgkmcnt(14)
v_mfma_f32_16x16x32_bf16 v[4:7], v[184:187], v[40:43], v[4:7]
v_mov_b32 v20, 0
v_mov_b32_e64 v21, 0
v_mfma_f32_16x16x32_bf16 v[12:15], v[184:187], v[44:47], v[12:15]
ds_read_b128 v[184:187], v248 offset:22528
s_waitcnt lgkmcnt(14)
v_or_b32_e64 v229, v170, v171
s_waitcnt lgkmcnt(13)
v_mfma_f32_16x16x32_f16 v[84:87], v[188:191], v[100:103], v[84:87]
v_cvt_pkrtz_f16_f32 v5, v4, v5
v_and_b32_e64 v5, s49, v5
v_mfma_f32_16x16x32_f16 v[140:143], v[188:191], v[96:99], v[140:143]
ds_read_b128 v[188:191], v251 offset:63488
v_cvt_pk_f16_f32 v12, v12, v13
v_cvt_pk_f16_f32 v14, v14, v15
v_pk_fma_f16 v13, v12, v12, s48
v_pk_fma_f16 v15, v14, v14, s48
v_pk_mul_f16 v13, v12, v13
v_bfe_u32 v4, v5, 2, 14
v_lshrrev_b32_e64 v5, 18, v5
v_pk_mul_f16 v15, v14, v15
v_exp_f16_sdwa v13, v13 dst_sel:WORD_0 dst_unused:UNUSED_PRESERVE src0_sel:WORD_0
v_cvt_pkrtz_f16_f32 v7, v6, v7
v_and_b32_e64 v7, s49, v7
v_bfe_u32 v6, v7, 2, 14
v_lshrrev_b32 v7, 18, v7
ds_read_u16 v4, v4
s_waitcnt lgkmcnt(13)
ds_read_u16_d16_hi v5, v5
ds_read_u16 v6, v6
v_exp_f16_sdwa v15, v15 dst_sel:WORD_0 dst_unused:UNUSED_PRESERVE src0_sel:WORD_0
v_exp_f16_sdwa v13, v13 dst_sel:WORD_1 dst_unused:UNUSED_PRESERVE src0_sel:WORD_1
v_exp_f16_sdwa v15, v15 dst_sel:WORD_1 dst_unused:UNUSED_PRESERVE src0_sel:WORD_1
v_pk_add_f16 v13, v13, 1.0 op_sel_hi:[1,0]
v_pk_add_f16 v15, v15, 1.0 op_sel_hi:[1,0]
s_waitcnt lgkmcnt(12)
v_mfma_f32_16x16x32_bf16 v[144:147], v[120:123], v[24:27], 0
ds_read_u16_d16_hi v7, v7
v_rcp_f16_sdwa v13, v13 dst_sel:WORD_0 dst_unused:UNUSED_PRESERVE src0_sel:WORD_0
v_mfma_f32_16x16x32_bf16 v[152:155], v[120:123], v[28:31], 0
ds_read_b128 v[120:123], v248 offset:18688
v_rcp_f16_sdwa v15, v15 dst_sel:WORD_0 dst_unused:UNUSED_PRESERVE src0_sel:WORD_0
s_waitcnt lgkmcnt(13)
v_mfma_f32_16x16x32_f16 v[88:91], v[124:127], v[100:103], v[88:91]
v_rcp_f16_sdwa v13, v13 dst_sel:WORD_1 dst_unused:UNUSED_PRESERVE src0_sel:WORD_1
v_mfma_f32_16x16x32_f16 v[240:243], v[124:127], v[96:99], v[240:243]
ds_read_b128 v[124:127], v252 offset:1024
v_rcp_f16_sdwa v15, v15 dst_sel:WORD_1 dst_unused:UNUSED_PRESERVE src0_sel:WORD_1
s_waitcnt lgkmcnt(10)
v_mfma_f32_16x16x32_bf16 v[144:147], v[176:179], v[32:35], v[144:147]
v_mfma_f32_16x16x32_bf16 v[152:155], v[176:179], v[36:39], v[152:155]
ds_read_b128 v[176:179], v251 offset:64512
s_waitcnt lgkmcnt(10)
v_mfma_f32_16x16x32_f16 v[92:95], v[180:183], v[100:103], v[92:95]
v_pk_mul_f16 v102, v12, v13
v_pk_mul_f16 v103, v14, v15
v_mfma_f32_16x16x32_f16 v[244:247], v[180:183], v[96:99], v[244:247]
ds_read_b128 v[180:183], v248 offset:20736
s_add_u32 s46, s80, 8388608
buffer_load_dwordx4 v[64:67], v250, s[32:35], s46 offen
v_or_b32_e64 v96, v0, v1
s_waitcnt lgkmcnt(9)
v_mfma_f32_16x16x32_bf16 v[144:147], v[184:187], v[40:43], v[144:147]
s_setprio 2
v_or_b32 v97, v2, v3
s_waitcnt lgkmcnt(8)
v_mfma_f32_16x16x32_f16 v[72:75], v[188:191], v[108:111], v[72:75]
v_mfma_f32_16x16x32_bf16 v[152:155], v[184:187], v[44:47], v[152:155]
ds_read_b128 v[184:187], v252 offset:2048
v_or_b32_e64 v100, v8, v9
v_mfma_f32_16x16x32_f16 v[128:131], v[188:191], v[104:107], v[128:131]
ds_read_b128 v[188:191], v248 offset:22784
v_cvt_pkrtz_f16_f32 v145, v144, v145
v_and_b32_e64 v145, s49, v145
v_bfe_u32 v144, v145, 2, 14
v_lshrrev_b32_e64 v145, 18, v145
s_waitcnt vmcnt(12)
v_mfma_f32_16x16x32_bf16 v[128:131], v[18:21], v[232:235], v[128:131]
s_setprio 1
s_add_u32 s46, s80, 10485760
buffer_load_dwordx4 v[68:71], v250, s[32:35], s46 offen
ds_read_u16 v144, v144
ds_read_u16_d16_hi v145, v145
s_waitcnt lgkmcnt(10)
v_or_b32 v98, v4, v5
v_cvt_pkrtz_f16_f32 v147, v146, v147
v_and_b32_e64 v147, s49, v147
v_bfe_u32 v146, v147, 2, 14
v_lshrrev_b32_e64 v147, 18, v147
ds_read_u16 v146, v146
ds_read_u16_d16_hi v147, v147
s_waitcnt lgkmcnt(10)
v_or_b32 v99, v6, v7
s_waitcnt lgkmcnt(9)
v_mfma_f32_16x16x32_bf16 v[148:151], v[120:123], v[24:27], 0
v_or_b32 v101, v10, v11
v_mfma_f32_16x16x32_bf16 v[156:159], v[120:123], v[28:31], 0
ds_read_b128 v[120:123], v252
s_waitcnt lgkmcnt(9)
v_mfma_f32_16x16x32_f16 v[76:79], v[124:127], v[108:111], v[76:79]
v_cvt_pkrtz_f16_f32 v153, v152, v153
v_and_b32 v153, s49, v153
v_mfma_f32_16x16x32_f16 v[132:135], v[124:127], v[104:107], v[132:135]
ds_read_b128 v[124:127], v248 offset:24576
v_bfe_u32 v152, v153, 2, 14
s_waitcnt lgkmcnt(9)
v_mfma_f32_16x16x32_f16 v[80:83], v[176:179], v[108:111], v[80:83]
v_lshrrev_b32_e64 v153, 18, v153
v_cvt_pkrtz_f16_f32 v155, v154, v155
s_waitcnt lgkmcnt(8)
v_mfma_f32_16x16x32_bf16 v[148:151], v[180:183], v[32:35], v[148:151]
ds_read_u16 v152, v152
ds_read_u16_d16_hi v153, v153
v_mfma_f32_16x16x32_f16 v[136:139], v[176:179], v[104:107], v[136:139]
ds_read_b128 v[176:179], v252 offset:3072
v_and_b32_e64 v155, s49, v155
v_mfma_f32_16x16x32_bf16 v[156:159], v[180:183], v[36:39], v[156:159]
ds_read_b128 v[180:183], v248 offset:26624
v_bfe_u32 v154, v155, 2, 14
s_waitcnt lgkmcnt(10)
v_mfma_f32_16x16x32_f16 v[84:87], v[184:187], v[108:111], v[84:87]
v_lshrrev_b32 v155, 18, v155
ds_read_u16 v154, v154
v_mfma_f32_16x16x32_bf16 v[148:151], v[188:191], v[40:43], v[148:151]
ds_read_u16_d16_hi v155, v155
v_mfma_f32_16x16x32_f16 v[140:143], v[184:187], v[104:107], v[140:143]
ds_read_b128 v[184:187], v252 offset:4096
v_mfma_f32_16x16x32_bf16 v[156:159], v[188:191], v[44:47], v[156:159]
ds_read_b128 v[188:191], v248 offset:28672
s_nop 2
v_cvt_pkrtz_f16_f32 v149, v148, v149
v_mfma_f32_16x16x32_bf16 v[132:135], v[16:19], v[232:235], v[132:135]
v_and_b32 v149, s49, v149
v_bfe_u32 v148, v149, 2, 14
s_waitcnt vmcnt(12)
v_mfma_f32_16x16x32_bf16 v[136:139], v[18:21], v[236:239], v[136:139]
v_cvt_pk_f16_f32 v156, v156, v157
v_cvt_pk_f16_f32 v158, v158, v159
s_waitcnt lgkmcnt(9)
v_mfma_f32_16x16x32_f16 v[88:91], v[120:123], v[108:111], v[88:91]
v_pk_fma_f16 v157, v156, v156, s48
v_pk_fma_f16 v159, v158, v158, s48
s_waitcnt lgkmcnt(8)
v_mfma_f32_16x16x32_bf16 v[160:163], v[124:127], v[24:27], 0
v_pk_mul_f16 v157, v156, v157
v_lshrrev_b32 v149, 18, v149
v_mfma_f32_16x16x32_f16 v[240:243], v[120:123], v[104:107], v[240:243]
ds_read_b128 v[120:123], v252 offset:7168
ds_read_u16 v148, v148
v_mfma_f32_16x16x32_bf16 v[168:171], v[124:127], v[28:31], 0
ds_read_b128 v[124:127], v248 offset:24832
ds_read_u16_d16_hi v149, v149
v_mfma_f32_16x16x32_bf16 v[140:143], v[16:19], v[236:239], v[140:143]
v_pk_mul_f16 v159, v158, v159
v_exp_f16_sdwa v157, v157 dst_sel:WORD_0 dst_unused:UNUSED_PRESERVE src0_sel:WORD_0
s_waitcnt lgkmcnt(9)
v_mfma_f32_16x16x32_f16 v[92:95], v[176:179], v[108:111], v[92:95]
v_cvt_pkrtz_f16_f32 v151, v150, v151
v_and_b32 v151, s49, v151
v_mfma_f32_16x16x32_f16 v[244:247], v[176:179], v[104:107], v[244:247]
ds_read_b128 v[176:179], v252 offset:5120
v_bfe_u32 v150, v151, 2, 14
s_waitcnt lgkmcnt(9)
v_mfma_f32_16x16x32_bf16 v[160:163], v[180:183], v[32:35], v[160:163]
v_lshrrev_b32 v151, 18, v151
v_exp_f16_sdwa v159, v159 dst_sel:WORD_0 dst_unused:UNUSED_PRESERVE src0_sel:WORD_0
v_mfma_f32_16x16x32_bf16 v[168:171], v[180:183], v[36:39], v[168:171]
ds_read_b128 v[180:183], v252 offset:8192
ds_read_u16 v150, v150
ds_read_u16_d16_hi v151, v151
v_exp_f16_sdwa v157, v157 dst_sel:WORD_1 dst_unused:UNUSED_PRESERVE src0_sel:WORD_1
v_exp_f16_sdwa v159, v159 dst_sel:WORD_1 dst_unused:UNUSED_PRESERVE src0_sel:WORD_1
v_pk_add_f16 v157, v157, 1.0 op_sel_hi:[1,0]
s_waitcnt lgkmcnt(9)
v_mfma_f32_16x16x32_f16 v[72:75], v[184:187], v[212:215], v[72:75]
v_pk_add_f16 v159, v159, 1.0 op_sel_hi:[1,0]
v_rcp_f16_sdwa v157, v157 dst_sel:WORD_0 dst_unused:UNUSED_PRESERVE src0_sel:WORD_0
v_mfma_f32_16x16x32_f16 v[128:131], v[184:187], v[208:211], v[128:131]
ds_read_b128 v[184:187], v248 offset:26880
v_rcp_f16_sdwa v159, v159 dst_sel:WORD_0 dst_unused:UNUSED_PRESERVE src0_sel:WORD_0
s_waitcnt lgkmcnt(9)
v_mfma_f32_16x16x32_bf16 v[160:163], v[188:191], v[40:43], v[160:163]
s_setprio 0
v_rcp_f16_sdwa v157, v157 dst_sel:WORD_1 dst_unused:UNUSED_PRESERVE src0_sel:WORD_1
s_waitcnt lgkmcnt(8)
v_mfma_f32_16x16x32_f16 v[76:79], v[120:123], v[212:215], v[76:79]
v_rcp_f16_sdwa v159, v159 dst_sel:WORD_1 dst_unused:UNUSED_PRESERVE src0_sel:WORD_1
v_mfma_f32_16x16x32_bf16 v[168:171], v[188:191], v[44:47], v[168:171]
ds_read_b128 v[188:191], v252 offset:6144
v_or_b32 v104, v144, v145
v_mfma_f32_16x16x32_f16 v[132:135], v[120:123], v[208:211], v[132:135]
ds_read_b128 v[120:123], v248 offset:28928
v_pk_mul_f16 v110, v156, v157
s_waitcnt lgkmcnt(8)
v_mfma_f32_16x16x32_bf16 v[164:167], v[124:127], v[24:27], 0
v_pk_mul_f16 v111, v158, v159
v_or_b32 v105, v146, v147
s_waitcnt lgkmcnt(6)
v_mfma_f32_16x16x32_f16 v[80:83], v[176:179], v[212:215], v[80:83]
v_cvt_pkrtz_f16_f32 v161, v160, v161
v_and_b32_e64 v161, s49, v161
v_mfma_f32_16x16x32_f16 v[136:139], v[176:179], v[208:211], v[136:139]
ds_read_b128 v[176:179], v248 offset:30720
v_bfe_u32 v160, v161, 2, 14
v_mfma_f32_16x16x32_bf16 v[172:175], v[124:127], v[28:31], 0
ds_read_b128 v[124:127], v252 offset:9216
v_lshrrev_b32 v161, 18, v161
s_waitcnt lgkmcnt(7)
v_mfma_f32_16x16x32_f16 v[84:87], v[180:183], v[212:215], v[84:87]
ds_read_u16 v160, v160
ds_read_u16_d16_hi v161, v161
v_mfma_f32_16x16x32_f16 v[140:143], v[180:183], v[208:211], v[140:143]
ds_read_b128 v[180:183], v252 offset:10240
v_or_b32_e64 v106, v148, v149
s_waitcnt vmcnt(8)
v_mfma_f32_16x16x32_bf16 v[72:75], v[18:21], v[204:207], v[72:75]
s_setprio 3
v_cvt_pkrtz_f16_f32 v163, v162, v163
v_and_b32 v163, s49, v163
s_waitcnt lgkmcnt(7)
v_mfma_f32_16x16x32_bf16 v[164:167], v[184:187], v[32:35], v[164:167]
v_bfe_u32 v162, v163, 2, 14
v_lshrrev_b32 v163, 18, v163
v_mfma_f32_16x16x32_bf16 v[172:175], v[184:187], v[36:39], v[172:175]
ds_read_b128 v[184:187], v248 offset:32768
ds_read_u16 v162, v162
s_waitcnt lgkmcnt(8)
v_mfma_f32_16x16x32_f16 v[88:91], v[188:191], v[212:215], v[88:91]
ds_read_u16_d16_hi v163, v163
v_or_b32 v107, v150, v151
s_waitcnt lgkmcnt(8)
v_mfma_f32_16x16x32_bf16 v[164:167], v[120:123], v[40:43], v[164:167]
v_or_b32 v108, v152, v153
v_or_b32 v109, v154, v155
v_mfma_f32_16x16x32_f16 v[240:243], v[188:191], v[208:211], v[240:243]
ds_read_b128 v[188:191], v252 offset:13312
v_cvt_pkrtz_f16_f32 v169, v168, v169
v_mfma_f32_16x16x32_bf16 v[172:175], v[120:123], v[44:47], v[172:175]
ds_read_b128 v[120:123], v248 offset:34816
s_nop 0
v_cvt_pkrtz_f16_f32 v165, v164, v165
s_waitcnt lgkmcnt(8)
v_mfma_f32_16x16x32_f16 v[92:95], v[124:127], v[212:215], v[92:95]
v_and_b32_e64 v165, s49, v165
v_bfe_u32 v164, v165, 2, 14
v_mfma_f32_16x16x32_bf16 v[0:3], v[176:179], v[24:27], 0
v_lshrrev_b32_e64 v165, 18, v165
v_cvt_pk_f16_f32 v172, v172, v173
v_mfma_f32_16x16x32_f16 v[244:247], v[124:127], v[208:211], v[244:247]
ds_read_b128 v[124:127], v252 offset:11264
v_cvt_pk_f16_f32 v174, v174, v175
v_mfma_f32_16x16x32_bf16 v[240:243], v[18:21], v[200:203], v[240:243]
v_pk_fma_f16 v173, v172, v172, s48
v_pk_fma_f16 v175, v174, v174, s48
v_mfma_f32_16x16x32_bf16 v[244:247], v[16:19], v[200:203], v[244:247]
v_pk_mul_f16 v173, v172, v173
v_pk_mul_f16 v175, v174, v175
v_mfma_f32_16x16x32_bf16 v[76:79], v[16:19], v[204:207], v[76:79]
ds_read_u16 v164, v164
ds_read_u16_d16_hi v165, v165
s_waitcnt lgkmcnt(7)
v_mfma_f32_16x16x32_f16 v[72:75], v[180:183], v[220:223], v[72:75]
v_exp_f16_sdwa v173, v173 dst_sel:WORD_0 dst_unused:UNUSED_PRESERVE src0_sel:WORD_0
v_mfma_f32_16x16x32_bf16 v[8:11], v[176:179], v[28:31], 0
ds_read_b128 v[176:179], v248 offset:30976
v_cvt_pkrtz_f16_f32 v167, v166, v167
v_mfma_f32_16x16x32_f16 v[128:131], v[180:183], v[216:219], v[128:131]
ds_read_b128 v[180:183], v252 offset:14336
v_and_b32 v167, s49, v167
v_mfma_f32_16x16x32_bf16 v[0:3], v[184:187], v[32:35], v[0:3]
v_bfe_u32 v166, v167, 2, 14
v_lshrrev_b32 v167, 18, v167
s_waitcnt lgkmcnt(6)
v_mfma_f32_16x16x32_f16 v[76:79], v[188:191], v[220:223], v[76:79]
ds_read_u16 v166, v166
ds_read_u16_d16_hi v167, v167
v_mfma_f32_16x16x32_bf16 v[8:11], v[184:187], v[36:39], v[8:11]
ds_read_b128 v[184:187], v252 offset:12288
v_exp_f16_sdwa v175, v175 dst_sel:WORD_0 dst_unused:UNUSED_PRESERVE src0_sel:WORD_0
v_mfma_f32_16x16x32_f16 v[132:135], v[188:191], v[216:219], v[132:135]
ds_read_b128 v[188:191], v248 offset:33024
s_setprio 2
v_and_b32_e64 v169, s49, v169
s_waitcnt lgkmcnt(8)
v_mfma_f32_16x16x32_bf16 v[0:3], v[120:123], v[40:43], v[0:3]
v_bfe_u32 v168, v169, 2, 14
v_lshrrev_b32_e64 v169, 18, v169
v_mfma_f32_16x16x32_f16 v[80:83], v[124:127], v[220:223], v[80:83]
ds_read_u16 v168, v168
ds_read_u16_d16_hi v169, v169
v_mfma_f32_16x16x32_bf16 v[8:11], v[120:123], v[44:47], v[8:11]
ds_read_b128 v[120:123], v252 offset:15360
v_exp_f16_sdwa v173, v173 dst_sel:WORD_1 dst_unused:UNUSED_PRESERVE src0_sel:WORD_1
v_mfma_f32_16x16x32_f16 v[136:139], v[124:127], v[216:219], v[136:139]
ds_read_b128 v[124:127], v248 offset:35072
v_cvt_pkrtz_f16_f32 v171, v170, v171
s_waitcnt lgkmcnt(9)
v_mfma_f32_16x16x32_bf16 v[4:7], v[176:179], v[24:27], 0
v_and_b32 v171, s49, v171
v_bfe_u32 v170, v171, 2, 14
s_waitcnt lgkmcnt(8)
v_mfma_f32_16x16x32_f16 v[84:87], v[180:183], v[220:223], v[84:87]
v_lshrrev_b32 v171, 18, v171
v_exp_f16_sdwa v175, v175 dst_sel:WORD_1 dst_unused:UNUSED_PRESERVE src0_sel:WORD_1
v_mfma_f32_16x16x32_f16 v[140:143], v[180:183], v[216:219], v[140:143]
ds_read_b128 v[180:183], v249
ds_read_u16 v170, v170
v_mfma_f32_16x16x32_bf16 v[12:15], v[176:179], v[28:31], 0
ds_read_b128 v[176:179], v251 offset:8192
ds_read_u16_d16_hi v171, v171
v_cvt_pk_bf16_f32 v232, v128, v129
v_cvt_pk_bf16_f32 v233, v130, v131
v_cvt_pk_bf16_f32 v234, v132, v133
v_cvt_pk_bf16_f32 v235, v134, v135
v_cvt_pk_bf16_f32 v212, v72, v73
v_cvt_pk_bf16_f32 v213, v74, v75
v_cvt_pk_bf16_f32 v214, v76, v77
v_cvt_pk_bf16_f32 v215, v78, v79
s_waitcnt lgkmcnt(8)
v_mfma_f32_16x16x32_f16 v[88:91], v[184:187], v[220:223], v[88:91]
ds_read_b128 v[128:131], v254 offset:8192
ds_read_b128 v[132:135], v254 offset:8208
v_mfma_f32_16x16x32_bf16 v[4:7], v[188:191], v[32:35], v[4:7]
v_cvt_pk_bf16_f32 v236, v136, v137
v_cvt_pk_bf16_f32 v237, v138, v139
v_cvt_pk_bf16_f32 v238, v140, v141
v_cvt_pk_bf16_f32 v239, v142, v143
v_pk_add_f16 v173, v173, 1.0 op_sel_hi:[1,0]
v_mfma_f32_16x16x32_f16 v[240:243], v[184:187], v[216:219], v[240:243]
ds_read_b128 v[136:139], v254 offset:8320
ds_read_b128 v[140:143], v254 offset:8336
ds_read_b128 v[184:187], v251 offset:11264
v_pk_add_f16 v175, v175, 1.0 op_sel_hi:[1,0]
v_mfma_f32_16x16x32_bf16 v[12:15], v[188:191], v[36:39], v[12:15]
ds_read_b128 v[188:191], v249 offset:2048
v_rcp_f16_sdwa v173, v173 dst_sel:WORD_0 dst_unused:UNUSED_PRESERVE src0_sel:WORD_0
s_nop 0
v_cvt_pk_bf16_f32 v208, v240, v241
v_cvt_pk_bf16_f32 v209, v242, v243
s_waitcnt lgkmcnt(10)
v_mfma_f32_16x16x32_f16 v[92:95], v[120:123], v[220:223], v[92:95]
ds_read_b128 v[240:243], v254
s_setprio 1
v_rcp_f16_sdwa v175, v175 dst_sel:WORD_0 dst_unused:UNUSED_PRESERVE src0_sel:WORD_0
v_mfma_f32_16x16x32_bf16 v[4:7], v[124:127], v[40:43], v[4:7]
v_rcp_f16_sdwa v173, v173 dst_sel:WORD_1 dst_unused:UNUSED_PRESERVE src0_sel:WORD_1
v_mfma_f32_16x16x32_f16 v[244:247], v[120:123], v[216:219], v[244:247]
ds_read_b128 v[120:123], v251 offset:9216
v_rcp_f16_sdwa v175, v175 dst_sel:WORD_1 dst_unused:UNUSED_PRESERVE src0_sel:WORD_1
v_mfma_f32_16x16x32_bf16 v[12:15], v[124:127], v[44:47], v[12:15]
ds_read_b128 v[124:127], v249 offset:4096
v_or_b32_e64 v200, v160, v161
s_waitcnt vmcnt(6)
v_mfma_f32_16x16x32_bf16 v[80:83], v[18:21], v[192:195], v[80:83]
s_nop 0
v_cvt_pk_bf16_f32 v210, v244, v245
v_cvt_pk_bf16_f32 v211, v246, v247
v_mfma_f32_16x16x32_bf16 v[84:87], v[16:19], v[192:195], v[84:87]
ds_read_b128 v[244:247], v254 offset:16
v_pk_mul_f16 v206, v172, v173
s_waitcnt vmcnt(5)
v_mfma_f32_16x16x32_bf16 v[88:91], v[18:21], v[196:199], v[88:91]
v_pk_mul_f16 v207, v174, v175
v_or_b32 v201, v162, v163
v_mfma_f32_16x16x32_bf16 v[92:95], v[16:19], v[196:199], v[92:95]
v_cvt_pk_bf16_f32 v16, v80, v81
v_cvt_pk_bf16_f32 v17, v82, v83
v_cvt_pk_bf16_f32 v18, v84, v85
v_cvt_pk_bf16_f32 v19, v86, v87
s_nop 0
v_cvt_pk_bf16_f32 v20, v88, v89
v_cvt_pk_bf16_f32 v21, v90, v91
s_waitcnt lgkmcnt(6)
v_mfma_f32_16x16x32_f16 v[72:75], v[176:179], v[116:119], v[128:131]
v_cvt_pk_bf16_f32 v22, v92, v93
v_cvt_pk_bf16_f32 v23, v94, v95
v_mfma_f32_16x16x32_bf16 v[144:147], v[180:183], v[24:27], 0
v_cvt_pkrtz_f16_f32 v1, v0, v1
v_and_b32_e64 v1, s49, v1
v_mfma_f32_16x16x32_f16 v[128:131], v[176:179], v[112:115], v[128:131]
ds_read_b128 v[176:179], v251 offset:12288
buffer_store_dwordx4 v[232:235], v253, s[8:11], s70 offen sc1
buffer_store_dwordx4 v[236:239], v253, s[8:11], s70 offen offset:64 sc1
s_waitcnt lgkmcnt(4)
v_mfma_f32_16x16x32_f16 v[76:79], v[184:187], v[116:119], v[132:135]
v_bfe_u32 v0, v1, 2, 14
v_lshrrev_b32 v1, 18, v1
v_mfma_f32_16x16x32_bf16 v[152:155], v[180:183], v[28:31], 0
ds_read_b128 v[180:183], v249 offset:256
ds_read_u16 v0, v0
v_mfma_f32_16x16x32_f16 v[132:135], v[184:187], v[112:115], v[132:135]
ds_read_b128 v[184:187], v251 offset:10240
ds_read_u16_d16_hi v1, v1
v_cvt_pk_f16_f32 v12, v12, v13
v_mfma_f32_16x16x32_bf16 v[144:147], v[188:191], v[32:35], v[144:147]
v_cvt_pk_f16_f32 v14, v14, v15
v_pk_fma_f16 v13, v12, v12, s48
s_waitcnt lgkmcnt(5)
v_mfma_f32_16x16x32_f16 v[80:83], v[120:123], v[116:119], v[136:139]
v_or_b32 v202, v164, v165
v_cvt_pkrtz_f16_f32 v3, v2, v3
v_and_b32_e64 v3, s49, v3
v_bfe_u32 v2, v3, 2, 14
v_lshrrev_b32_e64 v3, 18, v3
v_mfma_f32_16x16x32_bf16 v[152:155], v[188:191], v[36:39], v[152:155]
ds_read_u16 v2, v2
ds_read_u16_d16_hi v3, v3
ds_read_b128 v[188:191], v251 offset:13312
v_pk_fma_f16 v15, v14, v14, s48
v_mfma_f32_16x16x32_f16 v[136:139], v[120:123], v[112:115], v[136:139]
ds_read_b128 v[120:123], v249 offset:2304
v_pk_mul_f16 v13, v12, v13
s_setprio 0
v_or_b32 v203, v166, v167
v_mfma_f32_16x16x32_bf16 v[144:147], v[124:127], v[40:43], v[144:147]
v_cvt_pkrtz_f16_f32 v5, v4, v5
v_and_b32_e64 v5, s49, v5
v_bfe_u32 v4, v5, 2, 14
v_lshrrev_b32 v5, 18, v5
v_pk_mul_f16 v15, v14, v15
s_waitcnt lgkmcnt(6)
v_mfma_f32_16x16x32_f16 v[84:87], v[176:179], v[116:119], v[140:143]
ds_read_u16 v4, v4
ds_read_u16_d16_hi v5, v5
v_exp_f16_sdwa v13, v13 dst_sel:WORD_0 dst_unused:UNUSED_PRESERVE src0_sel:WORD_0
v_mfma_f32_16x16x32_bf16 v[152:155], v[124:127], v[44:47], v[152:155]
ds_read_b128 v[124:127], v251 offset:14336
v_or_b32_e64 v204, v168, v169
v_cvt_pkrtz_f16_f32 v7, v6, v7
v_and_b32_e64 v7, s49, v7
v_bfe_u32 v6, v7, 2, 14
v_lshrrev_b32_e64 v7, 18, v7
v_mfma_f32_16x16x32_f16 v[140:143], v[176:179], v[112:115], v[140:143]
ds_read_u16 v6, v6
ds_read_u16_d16_hi v7, v7
ds_read_b128 v[176:179], v249 offset:4352
v_exp_f16_sdwa v15, v15 dst_sel:WORD_0 dst_unused:UNUSED_PRESERVE src0_sel:WORD_0
v_mfma_f32_16x16x32_bf16 v[148:151], v[180:183], v[24:27], 0
v_or_b32 v205, v170, v171
v_cvt_pkrtz_f16_f32 v9, v8, v9
s_waitcnt lgkmcnt(9)
v_mfma_f32_16x16x32_f16 v[88:91], v[184:187], v[116:119], v[240:243]
v_and_b32_e64 v9, s49, v9
v_bfe_u32 v8, v9, 2, 14
v_lshrrev_b32_e64 v9, 18, v9
v_exp_f16_sdwa v13, v13 dst_sel:WORD_1 dst_unused:UNUSED_PRESERVE src0_sel:WORD_1
v_mfma_f32_16x16x32_f16 v[240:243], v[184:187], v[112:115], v[240:243]
ds_read_u16 v8, v8
ds_read_u16_d16_hi v9, v9
ds_read_b128 v[184:187], v249 offset:6144
v_mfma_f32_16x16x32_bf16 v[156:159], v[180:183], v[28:31], 0
ds_read_b128 v[180:183], v251 offset:17408
v_cvt_pkrtz_f16_f32 v11, v10, v11
v_and_b32_e64 v11, s49, v11
v_bfe_u32 v10, v11, 2, 14
v_lshrrev_b32 v11, 18, v11
v_exp_f16_sdwa v15, v15 dst_sel:WORD_1 dst_unused:UNUSED_PRESERVE src0_sel:WORD_1
s_waitcnt lgkmcnt(9)
v_mfma_f32_16x16x32_f16 v[92:95], v[188:191], v[116:119], v[244:247]
ds_read_u16 v10, v10
ds_read_u16_d16_hi v11, v11
v_mfma_f32_16x16x32_bf16 v[148:151], v[120:123], v[32:35], v[148:151]
v_pk_add_f16 v13, v13, 1.0 op_sel_hi:[1,0]
v_pk_add_f16 v15, v15, 1.0 op_sel_hi:[1,0]
v_mfma_f32_16x16x32_f16 v[244:247], v[188:191], v[112:115], v[244:247]
ds_read_b128 v[188:191], v251 offset:15360
v_rcp_f16_sdwa v13, v13 dst_sel:WORD_0 dst_unused:UNUSED_PRESERVE src0_sel:WORD_0
v_mfma_f32_16x16x32_bf16 v[156:159], v[120:123], v[36:39], v[156:159]
ds_read_b128 v[120:123], v249 offset:8192
v_rcp_f16_sdwa v15, v15 dst_sel:WORD_0 dst_unused:UNUSED_PRESERVE src0_sel:WORD_0
s_waitcnt lgkmcnt(10)
v_mfma_f32_16x16x32_f16 v[72:75], v[124:127], v[228:231], v[72:75]
s_setprio 3
v_rcp_f16_sdwa v13, v13 dst_sel:WORD_1 dst_unused:UNUSED_PRESERVE src0_sel:WORD_1
s_waitcnt lgkmcnt(8)
v_mfma_f32_16x16x32_bf16 v[148:151], v[176:179], v[40:43], v[148:151]
v_rcp_f16_sdwa v15, v15 dst_sel:WORD_1 dst_unused:UNUSED_PRESERVE src0_sel:WORD_1
v_mfma_f32_16x16x32_f16 v[128:131], v[124:127], v[224:227], v[128:131]
ds_read_b128 v[124:127], v251 offset:18432
v_or_b32 v216, v0, v1
v_mfma_f32_16x16x32_bf16 v[156:159], v[176:179], v[44:47], v[156:159]
ds_read_b128 v[176:179], v249 offset:10240
v_pk_mul_f16 v222, v12, v13
v_pk_mul_f16 v223, v14, v15
s_waitcnt lgkmcnt(7)
v_mfma_f32_16x16x32_bf16 v[160:163], v[184:187], v[24:27], 0
v_or_b32 v217, v2, v3
v_cvt_pkrtz_f16_f32 v145, v144, v145
s_waitcnt lgkmcnt(6)
v_mfma_f32_16x16x32_f16 v[76:79], v[180:183], v[228:231], v[76:79]
v_and_b32 v145, s49, v145
v_bfe_u32 v144, v145, 2, 14
v_mfma_f32_16x16x32_f16 v[132:135], v[180:183], v[224:227], v[132:135]
ds_read_b128 v[180:183], v251 offset:16384
v_lshrrev_b32_e64 v145, 18, v145
v_mfma_f32_16x16x32_bf16 v[168:171], v[184:187], v[28:31], 0
ds_read_b128 v[184:187], v249 offset:6400
ds_read_u16 v144, v144
ds_read_u16_d16_hi v145, v145
v_cvt_pk_f16_f32 v156, v156, v157
v_cvt_pk_f16_f32 v158, v158, v159
v_pk_fma_f16 v157, v156, v156, s48
v_or_b32_e64 v218, v4, v5
v_cvt_pkrtz_f16_f32 v147, v146, v147
v_and_b32 v147, s49, v147
s_waitcnt lgkmcnt(7)
v_mfma_f32_16x16x32_f16 v[80:83], v[188:191], v[228:231], v[80:83]
v_bfe_u32 v146, v147, 2, 14
v_lshrrev_b32_e64 v147, 18, v147
v_mfma_f32_16x16x32_f16 v[136:139], v[188:191], v[224:227], v[136:139]
ds_read_b128 v[188:191], v251 offset:19456
ds_read_u16 v146, v146
s_waitcnt lgkmcnt(8)
v_mfma_f32_16x16x32_bf16 v[160:163], v[120:123], v[32:35], v[160:163]
ds_read_u16_d16_hi v147, v147
v_pk_fma_f16 v159, v158, v158, s48
s_waitcnt lgkmcnt(8)
v_mfma_f32_16x16x32_f16 v[84:87], v[124:127], v[228:231], v[84:87]
v_pk_mul_f16 v157, v156, v157
v_or_b32_e64 v219, v6, v7
v_mfma_f32_16x16x32_bf16 v[168:171], v[120:123], v[36:39], v[168:171]
ds_read_b128 v[120:123], v251 offset:20480
v_cvt_pkrtz_f16_f32 v149, v148, v149
v_mfma_f32_16x16x32_f16 v[140:143], v[124:127], v[224:227], v[140:143]
ds_read_b128 v[124:127], v249 offset:8448
s_setprio 2
v_and_b32_e64 v149, s49, v149
s_waitcnt lgkmcnt(8)
v_mfma_f32_16x16x32_bf16 v[160:163], v[176:179], v[40:43], v[160:163]
v_bfe_u32 v148, v149, 2, 14
v_lshrrev_b32_e64 v149, 18, v149
v_pk_mul_f16 v159, v158, v159
v_mfma_f32_16x16x32_f16 v[88:91], v[180:183], v[228:231], v[88:91]
ds_read_u16 v148, v148
ds_read_u16_d16_hi v149, v149
v_exp_f16_sdwa v157, v157 dst_sel:WORD_0 dst_unused:UNUSED_PRESERVE src0_sel:WORD_0
v_mfma_f32_16x16x32_bf16 v[168:171], v[176:179], v[44:47], v[168:171]
ds_read_b128 v[176:179], v251 offset:23552
v_or_b32_e64 v220, v8, v9
v_cvt_pkrtz_f16_f32 v151, v150, v151
v_and_b32_e64 v151, s49, v151
v_bfe_u32 v150, v151, 2, 14
v_lshrrev_b32_e64 v151, 18, v151
v_mfma_f32_16x16x32_f16 v[240:243], v[180:183], v[224:227], v[240:243]
ds_read_u16 v150, v150
ds_read_u16_d16_hi v151, v151
ds_read_b128 v[180:183], v249 offset:10496
v_exp_f16_sdwa v159, v159 dst_sel:WORD_0 dst_unused:UNUSED_PRESERVE src0_sel:WORD_0
s_waitcnt lgkmcnt(10)
v_mfma_f32_16x16x32_bf16 v[164:167], v[184:187], v[24:27], 0
v_or_b32 v221, v10, v11
v_cvt_pkrtz_f16_f32 v153, v152, v153
v_mfma_f32_16x16x32_f16 v[92:95], v[188:191], v[228:231], v[92:95]
v_and_b32_e64 v153, s49, v153
v_bfe_u32 v152, v153, 2, 14
v_lshrrev_b32_e64 v153, 18, v153
v_exp_f16_sdwa v157, v157 dst_sel:WORD_1 dst_unused:UNUSED_PRESERVE src0_sel:WORD_1
v_mfma_f32_16x16x32_f16 v[244:247], v[188:191], v[224:227], v[244:247]
ds_read_u16 v152, v152
ds_read_u16_d16_hi v153, v153
ds_read_b128 v[188:191], v249 offset:12288
v_mfma_f32_16x16x32_bf16 v[172:175], v[184:187], v[28:31], 0
ds_read_b128 v[184:187], v251 offset:21504
v_cvt_pkrtz_f16_f32 v155, v154, v155
v_and_b32_e64 v155, s49, v155
v_bfe_u32 v154, v155, 2, 14
v_lshrrev_b32 v155, 18, v155
v_exp_f16_sdwa v159, v159 dst_sel:WORD_1 dst_unused:UNUSED_PRESERVE src0_sel:WORD_1
s_waitcnt lgkmcnt(10)
v_mfma_f32_16x16x32_f16 v[72:75], v[120:123], v[100:103], v[72:75]
ds_read_u16 v154, v154
ds_read_u16_d16_hi v155, v155
buffer_store_dwordx4 v[208:211], v253, s[8:11], s70 offen offset:128 sc1
buffer_store_dwordx4 v[212:215], v253, s[8:11], s70 offen offset:192 sc1
v_mfma_f32_16x16x32_bf16 v[164:167], v[124:127], v[32:35], v[164:167]
v_pk_add_f16 v157, v157, 1.0 op_sel_hi:[1,0]
v_pk_add_f16 v159, v159, 1.0 op_sel_hi:[1,0]
v_mfma_f32_16x16x32_f16 v[128:131], v[120:123], v[96:99], v[128:131]
ds_read_b128 v[120:123], v251 offset:24576
v_rcp_f16_sdwa v157, v157 dst_sel:WORD_0 dst_unused:UNUSED_PRESERVE src0_sel:WORD_0
v_mfma_f32_16x16x32_bf16 v[172:175], v[124:127], v[36:39], v[172:175]
ds_read_b128 v[124:127], v249 offset:14336
v_rcp_f16_sdwa v159, v159 dst_sel:WORD_0 dst_unused:UNUSED_PRESERVE src0_sel:WORD_0
s_waitcnt lgkmcnt(11)
v_mfma_f32_16x16x32_f16 v[76:79], v[176:179], v[100:103], v[76:79]
s_setprio 1
v_rcp_f16_sdwa v157, v157 dst_sel:WORD_1 dst_unused:UNUSED_PRESERVE src0_sel:WORD_1
s_waitcnt lgkmcnt(8)
v_mfma_f32_16x16x32_bf16 v[164:167], v[180:183], v[40:43], v[164:167]
v_rcp_f16_sdwa v159, v159 dst_sel:WORD_1 dst_unused:UNUSED_PRESERVE src0_sel:WORD_1
v_mfma_f32_16x16x32_f16 v[132:135], v[176:179], v[96:99], v[132:135]
ds_read_b128 v[176:179], v251 offset:22528
v_or_b32 v192, v144, v145
v_mfma_f32_16x16x32_bf16 v[172:175], v[180:183], v[44:47], v[172:175]
ds_read_b128 v[180:183], v249 offset:16384
v_pk_mul_f16 v198, v156, v157
v_pk_mul_f16 v199, v158, v159
v_or_b32_e64 v193, v146, v147
v_cvt_pkrtz_f16_f32 v161, v160, v161
v_and_b32_e64 v161, s49, v161
v_bfe_u32 v160, v161, 2, 14
v_lshrrev_b32 v161, 18, v161
s_waitcnt lgkmcnt(7)
v_mfma_f32_16x16x32_bf16 v[0:3], v[188:191], v[24:27], 0
ds_read_u16 v160, v160
ds_read_u16_d16_hi v161, v161
v_mfma_f32_16x16x32_bf16 v[8:11], v[188:191], v[28:31], 0
ds_read_b128 v[188:191], v249 offset:12544
v_cvt_pk_f16_f32 v172, v172, v173
s_waitcnt lgkmcnt(9)
v_mfma_f32_16x16x32_f16 v[80:83], v[184:187], v[100:103], v[80:83]
v_cvt_pk_f16_f32 v174, v174, v175
v_pk_fma_f16 v173, v172, v172, s48
v_mfma_f32_16x16x32_f16 v[136:139], v[184:187], v[96:99], v[136:139]
ds_read_b128 v[184:187], v251 offset:25600
v_or_b32 v194, v148, v149
v_cvt_pkrtz_f16_f32 v163, v162, v163
v_and_b32_e64 v163, s49, v163
v_bfe_u32 v162, v163, 2, 14
v_lshrrev_b32_e64 v163, 18, v163
v_pk_fma_f16 v175, v174, v174, s48
v_pk_mul_f16 v173, v172, v173
v_or_b32 v195, v150, v151
s_waitcnt lgkmcnt(7)
v_mfma_f32_16x16x32_f16 v[84:87], v[120:123], v[100:103], v[84:87]
ds_read_u16 v162, v162
ds_read_u16_d16_hi v163, v163
v_mfma_f32_16x16x32_f16 v[140:143], v[120:123], v[96:99], v[140:143]
ds_read_b128 v[120:123], v251 offset:26624
v_cvt_pkrtz_f16_f32 v165, v164, v165
s_waitcnt lgkmcnt(9)
v_mfma_f32_16x16x32_bf16 v[0:3], v[124:127], v[32:35], v[0:3]
v_and_b32 v165, s49, v165
v_bfe_u32 v164, v165, 2, 14
s_waitcnt lgkmcnt(8)
v_mfma_f32_16x16x32_f16 v[88:91], v[176:179], v[100:103], v[88:91]
v_lshrrev_b32 v165, 18, v165
v_pk_mul_f16 v175, v174, v175
v_mfma_f32_16x16x32_bf16 v[8:11], v[124:127], v[36:39], v[8:11]
ds_read_b128 v[124:127], v251 offset:29696
ds_read_u16 v164, v164
v_mfma_f32_16x16x32_f16 v[240:243], v[176:179], v[96:99], v[240:243]
ds_read_b128 v[176:179], v249 offset:14592
s_setprio 0
ds_read_u16_d16_hi v165, v165
s_waitcnt lgkmcnt(11)
v_mfma_f32_16x16x32_bf16 v[0:3], v[180:183], v[40:43], v[0:3]
v_exp_f16_sdwa v173, v173 dst_sel:WORD_0 dst_unused:UNUSED_PRESERVE src0_sel:WORD_0
v_mfma_f32_16x16x32_bf16 v[8:11], v[180:183], v[44:47], v[8:11]
ds_read_b128 v[180:183], v251 offset:27648
v_or_b32_e64 v196, v152, v153
v_cvt_pkrtz_f16_f32 v167, v166, v167
v_and_b32 v167, s49, v167
v_bfe_u32 v166, v167, 2, 14
s_waitcnt lgkmcnt(8)
v_mfma_f32_16x16x32_f16 v[92:95], v[184:187], v[100:103], v[92:95]
v_lshrrev_b32_e64 v167, 18, v167
v_exp_f16_sdwa v175, v175 dst_sel:WORD_0 dst_unused:UNUSED_PRESERVE src0_sel:WORD_0
v_mfma_f32_16x16x32_f16 v[244:247], v[184:187], v[96:99], v[244:247]
ds_read_u16 v166, v166
ds_read_u16_d16_hi v167, v167
ds_read_b128 v[184:187], v249 offset:16640
v_mfma_f32_16x16x32_bf16 v[4:7], v[188:191], v[24:27], 0
v_or_b32_e64 v197, v154, v155
v_cvt_pkrtz_f16_f32 v169, v168, v169
v_and_b32_e64 v169, s49, v169
v_bfe_u32 v168, v169, 2, 14
v_lshrrev_b32 v169, 18, v169
v_exp_f16_sdwa v173, v173 dst_sel:WORD_1 dst_unused:UNUSED_PRESERVE src0_sel:WORD_1
s_waitcnt lgkmcnt(8)
v_mfma_f32_16x16x32_f16 v[72:75], v[120:123], v[108:111], v[72:75]
ds_read_u16 v168, v168
ds_read_u16_d16_hi v169, v169
v_mfma_f32_16x16x32_f16 v[128:131], v[120:123], v[104:107], v[128:131]
ds_read_b128 v[120:123], v249 offset:18432
v_cvt_pkrtz_f16_f32 v171, v170, v171
v_mfma_f32_16x16x32_bf16 v[12:15], v[188:191], v[28:31], 0
ds_read_b128 v[188:191], v251 offset:30720
v_and_b32_e64 v171, s49, v171
v_bfe_u32 v170, v171, 2, 14
v_lshrrev_b32_e64 v171, 18, v171
v_exp_f16_sdwa v175, v175 dst_sel:WORD_1 dst_unused:UNUSED_PRESERVE src0_sel:WORD_1
s_waitcnt lgkmcnt(11)
v_mfma_f32_16x16x32_f16 v[76:79], v[124:127], v[108:111], v[76:79]
ds_read_u16 v170, v170
ds_read_u16_d16_hi v171, v171
buffer_load_dwordx4 v[232:235], v253, s[4:7], s69 offen
buffer_load_dwordx4 v[236:239], v253, s[4:7], s69 offen offset:64
s_waitcnt lgkmcnt(11)
v_mfma_f32_16x16x32_bf16 v[4:7], v[176:179], v[32:35], v[4:7]
v_pk_add_f16 v173, v173, 1.0 op_sel_hi:[1,0]
v_pk_add_f16 v175, v175, 1.0 op_sel_hi:[1,0]
v_mfma_f32_16x16x32_f16 v[132:135], v[124:127], v[104:107], v[132:135]
ds_read_b128 v[124:127], v251 offset:28672
v_rcp_f16_sdwa v173, v173 dst_sel:WORD_0 dst_unused:UNUSED_PRESERVE src0_sel:WORD_0
v_mfma_f32_16x16x32_bf16 v[12:15], v[176:179], v[36:39], v[12:15]
ds_read_b128 v[176:179], v249 offset:20480
v_rcp_f16_sdwa v175, v175 dst_sel:WORD_0 dst_unused:UNUSED_PRESERVE src0_sel:WORD_0
s_waitcnt lgkmcnt(11)
v_mfma_f32_16x16x32_f16 v[80:83], v[180:183], v[108:111], v[80:83]
s_setprio 3
v_rcp_f16_sdwa v173, v173 dst_sel:WORD_1 dst_unused:UNUSED_PRESERVE src0_sel:WORD_1
v_mfma_f32_16x16x32_f16 v[136:139], v[180:183], v[104:107], v[136:139]
ds_read_b128 v[180:183], v251 offset:31744
v_rcp_f16_sdwa v175, v175 dst_sel:WORD_1 dst_unused:UNUSED_PRESERVE src0_sel:WORD_1
s_waitcnt lgkmcnt(9)
v_mfma_f32_16x16x32_bf16 v[4:7], v[184:187], v[40:43], v[4:7]
v_or_b32 v112, v160, v161
v_pk_mul_f16 v118, v172, v173
v_mfma_f32_16x16x32_bf16 v[12:15], v[184:187], v[44:47], v[12:15]
ds_read_b128 v[184:187], v249 offset:22528
v_pk_mul_f16 v119, v174, v175
v_or_b32_e64 v113, v162, v163
v_cvt_pkrtz_f16_f32 v1, v0, v1
v_and_b32_e64 v1, s49, v1
v_bfe_u32 v0, v1, 2, 14
v_lshrrev_b32 v1, 18, v1
v_or_b32 v114, v164, v165
v_cvt_pkrtz_f16_f32 v3, v2, v3
v_cvt_pk_f16_f32 v12, v12, v13
v_cvt_pk_f16_f32 v14, v14, v15
v_pk_fma_f16 v13, v12, v12, s48
s_waitcnt lgkmcnt(7)
v_mfma_f32_16x16x32_bf16 v[144:147], v[120:123], v[24:27], 0
ds_read_u16 v0, v0
ds_read_u16_d16_hi v1, v1
s_waitcnt lgkmcnt(8)
v_mfma_f32_16x16x32_f16 v[84:87], v[188:191], v[108:111], v[84:87]
v_and_b32_e64 v3, s49, v3
v_bfe_u32 v2, v3, 2, 14
v_mfma_f32_16x16x32_f16 v[140:143], v[188:191], v[104:107], v[140:143]
ds_read_b128 v[188:191], v251 offset:32768
v_lshrrev_b32_e64 v3, 18, v3
v_mfma_f32_16x16x32_bf16 v[152:155], v[120:123], v[28:31], 0
ds_read_b128 v[120:123], v251 offset:35840
ds_read_u16 v2, v2
ds_read_u16_d16_hi v3, v3
v_pk_fma_f16 v15, v14, v14, s48
v_pk_mul_f16 v13, v12, v13
v_or_b32_e64 v115, v166, v167
v_cvt_pkrtz_f16_f32 v5, v4, v5
v_and_b32 v5, s49, v5
v_bfe_u32 v4, v5, 2, 14
s_waitcnt lgkmcnt(9)
v_mfma_f32_16x16x32_f16 v[88:91], v[124:127], v[108:111], v[88:91]
v_lshrrev_b32_e64 v5, 18, v5
v_pk_mul_f16 v15, v14, v15
v_mfma_f32_16x16x32_f16 v[240:243], v[124:127], v[104:107], v[240:243]
ds_read_b128 v[124:127], v249 offset:18688
ds_read_u16 v4, v4
s_waitcnt lgkmcnt(10)
v_mfma_f32_16x16x32_bf16 v[144:147], v[176:179], v[32:35], v[144:147]
ds_read_u16_d16_hi v5, v5
v_exp_f16_sdwa v13, v13 dst_sel:WORD_0 dst_unused:UNUSED_PRESERVE src0_sel:WORD_0
s_waitcnt lgkmcnt(10)
v_mfma_f32_16x16x32_f16 v[92:95], v[180:183], v[108:111], v[92:95]
buffer_store_dwordx4 v[16:19], v253, s[8:11], s70 offen offset:256 sc1
buffer_store_dwordx4 v[20:23], v253, s[8:11], s70 offen offset:320 sc1
v_or_b32_e64 v116, v168, v169
v_mfma_f32_16x16x32_bf16 v[152:155], v[176:179], v[36:39], v[152:155]
ds_read_b128 v[176:179], v251 offset:33792
v_cvt_pkrtz_f16_f32 v7, v6, v7
v_mfma_f32_16x16x32_f16 v[244:247], v[180:183], v[104:107], v[244:247]
ds_read_b128 v[180:183], v249 offset:20736
s_setprio 2
v_and_b32_e64 v7, s49, v7
s_waitcnt lgkmcnt(11)
v_mfma_f32_16x16x32_bf16 v[144:147], v[184:187], v[40:43], v[144:147]
v_bfe_u32 v6, v7, 2, 14
v_lshrrev_b32 v7, 18, v7
v_mfma_f32_16x16x32_bf16 v[152:155], v[184:187], v[44:47], v[152:155]
ds_read_b128 v[184:187], v251 offset:36864
ds_read_u16 v6, v6
s_waitcnt lgkmcnt(10)
v_mfma_f32_16x16x32_f16 v[72:75], v[188:191], v[204:207], v[72:75]
ds_read_u16_d16_hi v7, v7
v_exp_f16_sdwa v15, v15 dst_sel:WORD_0 dst_unused:UNUSED_PRESERVE src0_sel:WORD_0
v_mfma_f32_16x16x32_f16 v[128:131], v[188:191], v[200:203], v[128:131]
ds_read_b128 v[188:191], v249 offset:22784
buffer_load_dwordx4 v[208:211], v253, s[4:7], s69 offen offset:128
buffer_load_dwordx4 v[212:215], v253, s[4:7], s69 offen offset:192
s_waitcnt lgkmcnt(11)
v_mfma_f32_16x16x32_f16 v[76:79], v[120:123], v[204:207], v[76:79]
v_or_b32 v117, v170, v171
v_cvt_pkrtz_f16_f32 v9, v8, v9
v_and_b32_e64 v9, s49, v9
v_bfe_u32 v8, v9, 2, 14
v_lshrrev_b32 v9, 18, v9
v_exp_f16_sdwa v13, v13 dst_sel:WORD_1 dst_unused:UNUSED_PRESERVE src0_sel:WORD_1
v_mfma_f32_16x16x32_f16 v[132:135], v[120:123], v[200:203], v[132:135]
ds_read_u16 v8, v8
ds_read_u16_d16_hi v9, v9
s_waitcnt lgkmcnt(10)
v_mfma_f32_16x16x32_bf16 v[148:151], v[124:127], v[24:27], 0
ds_read_b128 v[120:123], v251 offset:34816
v_cvt_pkrtz_f16_f32 v11, v10, v11
v_mfma_f32_16x16x32_bf16 v[156:159], v[124:127], v[28:31], 0
ds_read_b128 v[124:127], v249 offset:24576
v_and_b32_e64 v11, s49, v11
v_bfe_u32 v10, v11, 2, 14
v_lshrrev_b32_e64 v11, 18, v11
v_exp_f16_sdwa v15, v15 dst_sel:WORD_1 dst_unused:UNUSED_PRESERVE src0_sel:WORD_1
v_pk_add_f16 v13, v13, 1.0 op_sel_hi:[1,0]
v_pk_add_f16 v15, v15, 1.0 op_sel_hi:[1,0]
v_rcp_f16_sdwa v13, v13 dst_sel:WORD_0 dst_unused:UNUSED_PRESERVE src0_sel:WORD_0
s_waitcnt lgkmcnt(9)
v_mfma_f32_16x16x32_f16 v[80:83], v[176:179], v[204:207], v[80:83]
ds_read_u16 v10, v10
ds_read_u16_d16_hi v11, v11
v_mfma_f32_16x16x32_f16 v[136:139], v[176:179], v[200:203], v[136:139]
ds_read_b128 v[176:179], v251 offset:37888
v_rcp_f16_sdwa v15, v15 dst_sel:WORD_0 dst_unused:UNUSED_PRESERVE src0_sel:WORD_0
s_waitcnt lgkmcnt(11)
v_mfma_f32_16x16x32_bf16 v[148:151], v[180:183], v[32:35], v[148:151]
v_rcp_f16_sdwa v13, v13 dst_sel:WORD_1 dst_unused:UNUSED_PRESERVE src0_sel:WORD_1
v_mfma_f32_16x16x32_bf16 v[156:159], v[180:183], v[36:39], v[156:159]
ds_read_b128 v[180:183], v249 offset:26624
s_setprio 1
v_rcp_f16_sdwa v15, v15 dst_sel:WORD_1 dst_unused:UNUSED_PRESERVE src0_sel:WORD_1
s_waitcnt lgkmcnt(11)
v_mfma_f32_16x16x32_f16 v[84:87], v[184:187], v[204:207], v[84:87]
v_or_b32_e64 v224, v0, v1
v_pk_mul_f16 v230, v12, v13
v_mfma_f32_16x16x32_f16 v[140:143], v[184:187], v[200:203], v[140:143]
ds_read_b128 v[184:187], v251 offset:38912
v_pk_mul_f16 v231, v14, v15
v_or_b32 v225, v2, v3
s_waitcnt lgkmcnt(9)
v_mfma_f32_16x16x32_bf16 v[148:151], v[188:191], v[40:43], v[148:151]
v_cvt_pkrtz_f16_f32 v145, v144, v145
v_and_b32_e64 v145, s49, v145
v_mfma_f32_16x16x32_bf16 v[156:159], v[188:191], v[44:47], v[156:159]
ds_read_b128 v[188:191], v249 offset:28672
v_bfe_u32 v144, v145, 2, 14
v_lshrrev_b32 v145, 18, v145
v_or_b32 v226, v4, v5
v_cvt_pkrtz_f16_f32 v147, v146, v147
v_and_b32_e64 v147, s49, v147
v_bfe_u32 v146, v147, 2, 14
v_lshrrev_b32 v147, 18, v147
v_or_b32 v227, v6, v7
ds_read_u16 v144, v144
ds_read_u16_d16_hi v145, v145
v_cvt_pk_f16_f32 v156, v156, v157
s_waitcnt lgkmcnt(9)
v_mfma_f32_16x16x32_f16 v[88:91], v[120:123], v[204:207], v[88:91]
v_cvt_pk_f16_f32 v158, v158, v159
v_pk_fma_f16 v157, v156, v156, s48
v_mfma_f32_16x16x32_f16 v[240:243], v[120:123], v[200:203], v[240:243]
ds_read_b128 v[120:123], v251 offset:41984
ds_read_u16 v146, v146
s_waitcnt lgkmcnt(10)
v_mfma_f32_16x16x32_bf16 v[160:163], v[124:127], v[24:27], 0
ds_read_u16_d16_hi v147, v147
v_pk_fma_f16 v159, v158, v158, s48
v_mfma_f32_16x16x32_bf16 v[168:171], v[124:127], v[28:31], 0
ds_read_b128 v[124:127], v251 offset:39936
v_pk_mul_f16 v157, v156, v157
v_cvt_pkrtz_f16_f32 v149, v148, v149
v_and_b32_e64 v149, s49, v149
v_bfe_u32 v148, v149, 2, 14
v_lshrrev_b32 v149, 18, v149
v_pk_mul_f16 v159, v158, v159
v_exp_f16_sdwa v157, v157 dst_sel:WORD_0 dst_unused:UNUSED_PRESERVE src0_sel:WORD_0
s_waitcnt lgkmcnt(9)
v_mfma_f32_16x16x32_f16 v[92:95], v[176:179], v[204:207], v[92:95]
ds_read_u16 v148, v148
ds_read_u16_d16_hi v149, v149
v_mfma_f32_16x16x32_f16 v[244:247], v[176:179], v[200:203], v[244:247]
ds_read_b128 v[176:179], v249 offset:24832
v_or_b32 v228, v8, v9
s_waitcnt lgkmcnt(11)
v_mfma_f32_16x16x32_bf16 v[160:163], v[180:183], v[32:35], v[160:163]
v_cvt_pkrtz_f16_f32 v151, v150, v151
v_and_b32 v151, s49, v151
s_waitcnt lgkmcnt(10)
v_mfma_f32_16x16x32_f16 v[72:75], v[184:187], v[220:223], v[72:75]
v_bfe_u32 v150, v151, 2, 14
v_lshrrev_b32_e64 v151, 18, v151
v_mfma_f32_16x16x32_bf16 v[168:171], v[180:183], v[36:39], v[168:171]
ds_read_b128 v[180:183], v251 offset:43008
s_setprio 0
ds_read_u16 v150, v150
v_mfma_f32_16x16x32_f16 v[128:131], v[184:187], v[216:219], v[128:131]
ds_read_b128 v[184:187], v249 offset:26880
ds_read_u16_d16_hi v151, v151
s_waitcnt lgkmcnt(13)
v_mfma_f32_16x16x32_bf16 v[160:163], v[188:191], v[40:43], v[160:163]
buffer_load_dwordx4 v[96:99], v253, s[4:7], s69 offen offset:256
buffer_load_dwordx4 v[100:103], v253, s[4:7], s69 offen offset:320
v_exp_f16_sdwa v159, v159 dst_sel:WORD_0 dst_unused:UNUSED_PRESERVE src0_sel:WORD_0
v_mfma_f32_16x16x32_bf16 v[168:171], v[188:191], v[44:47], v[168:171]
ds_read_b128 v[188:191], v251 offset:40960
v_or_b32 v229, v10, v11
s_waitcnt lgkmcnt(11)
v_mfma_f32_16x16x32_f16 v[76:79], v[120:123], v[220:223], v[76:79]
v_cvt_pkrtz_f16_f32 v153, v152, v153
v_and_b32_e64 v153, s49, v153
v_mfma_f32_16x16x32_f16 v[132:135], v[120:123], v[216:219], v[132:135]
ds_read_b128 v[120:123], v249 offset:28928
v_bfe_u32 v152, v153, 2, 14
v_lshrrev_b32_e64 v153, 18, v153
v_exp_f16_sdwa v157, v157 dst_sel:WORD_1 dst_unused:UNUSED_PRESERVE src0_sel:WORD_1
v_cvt_pkrtz_f16_f32 v155, v154, v155
v_and_b32_e64 v155, s49, v155
v_bfe_u32 v154, v155, 2, 14
v_lshrrev_b32 v155, 18, v155
v_exp_f16_sdwa v159, v159 dst_sel:WORD_1 dst_unused:UNUSED_PRESERVE src0_sel:WORD_1
s_waitcnt lgkmcnt(9)
v_mfma_f32_16x16x32_f16 v[80:83], v[124:127], v[220:223], v[80:83]
ds_read_u16 v152, v152
ds_read_u16_d16_hi v153, v153
v_mfma_f32_16x16x32_f16 v[136:139], v[124:127], v[216:219], v[136:139]
ds_read_b128 v[124:127], v251 offset:44032
ds_read_u16 v154, v154
ds_read_u16_d16_hi v155, v155
v_pk_add_f16 v157, v157, 1.0 op_sel_hi:[1,0]
v_pk_add_f16 v159, v159, 1.0 op_sel_hi:[1,0]
v_rcp_f16_sdwa v157, v157 dst_sel:WORD_0 dst_unused:UNUSED_PRESERVE src0_sel:WORD_0
v_rcp_f16_sdwa v159, v159 dst_sel:WORD_0 dst_unused:UNUSED_PRESERVE src0_sel:WORD_0
v_rcp_f16_sdwa v157, v157 dst_sel:WORD_1 dst_unused:UNUSED_PRESERVE src0_sel:WORD_1
s_waitcnt lgkmcnt(11)
v_mfma_f32_16x16x32_bf16 v[164:167], v[176:179], v[24:27], 0
v_rcp_f16_sdwa v159, v159 dst_sel:WORD_1 dst_unused:UNUSED_PRESERVE src0_sel:WORD_1
v_mfma_f32_16x16x32_bf16 v[172:175], v[176:179], v[28:31], 0
ds_read_b128 v[176:179], v249 offset:30720
s_waitcnt vmcnt(16)
v_permlane16_swap_b32 v48, v52
s_waitcnt lgkmcnt(11)
v_mfma_f32_16x16x32_f16 v[84:87], v[180:183], v[220:223], v[84:87]
v_permlane16_swap_b32 v49, v53
v_permlane16_swap_b32 v50, v54
v_mfma_f32_16x16x32_f16 v[140:143], v[180:183], v[216:219], v[140:143]
ds_read_b128 v[180:183], v251 offset:45056
v_permlane16_swap_b32 v51, v55
s_waitcnt lgkmcnt(10)
v_mfma_f32_16x16x32_bf16 v[164:167], v[184:187], v[32:35], v[164:167]
s_waitcnt vmcnt(14)
v_permlane16_swap_b32 v56, v60
v_permlane16_swap_b32 v57, v61
v_mfma_f32_16x16x32_bf16 v[172:175], v[184:187], v[36:39], v[172:175]
ds_read_b128 v[184:187], v249 offset:32768
s_setprio 3
v_permlane16_swap_b32 v58, v62
v_permlane16_swap_b32 v59, v63
s_waitcnt vmcnt(12)
v_permlane16_swap_b32 v64, v68
s_waitcnt lgkmcnt(9)
v_mfma_f32_16x16x32_f16 v[88:91], v[188:191], v[220:223], v[88:91]
v_permlane16_swap_b32 v65, v69
v_permlane16_swap_b32 v66, v70
s_waitcnt lgkmcnt(8)
v_mfma_f32_16x16x32_bf16 v[164:167], v[120:123], v[40:43], v[164:167]
v_permlane16_swap_b32 v67, v71
v_or_b32 v104, v144, v145
v_mfma_f32_16x16x32_f16 v[240:243], v[188:191], v[216:219], v[240:243]
ds_read_b128 v[188:191], v251 offset:48128
v_pk_mul_f16 v110, v156, v157
v_mfma_f32_16x16x32_bf16 v[172:175], v[120:123], v[44:47], v[172:175]
ds_read_b128 v[120:123], v249 offset:34816
v_pk_mul_f16 v111, v158, v159
v_or_b32_e64 v105, v146, v147
v_cvt_pkrtz_f16_f32 v161, v160, v161
v_and_b32_e64 v161, s49, v161
v_bfe_u32 v160, v161, 2, 14
v_lshrrev_b32_e64 v161, 18, v161
v_or_b32 v106, v148, v149
s_waitcnt lgkmcnt(7)
v_mfma_f32_16x16x32_f16 v[92:95], v[124:127], v[220:223], v[92:95]
ds_read_u16 v160, v160
ds_read_u16_d16_hi v161, v161
v_mfma_f32_16x16x32_f16 v[244:247], v[124:127], v[216:219], v[244:247]
ds_read_b128 v[124:127], v251 offset:46080
v_cvt_pk_f16_f32 v172, v172, v173
v_cvt_pk_f16_f32 v174, v174, v175
v_pk_fma_f16 v173, v172, v172, s48
v_cvt_pkrtz_f16_f32 v163, v162, v163
v_and_b32_e64 v163, s49, v163
v_bfe_u32 v162, v163, 2, 14
v_lshrrev_b32_e64 v163, 18, v163
v_pk_fma_f16 v175, v174, v174, s48
v_pk_mul_f16 v173, v172, v173
v_or_b32_e64 v107, v150, v151
v_cvt_pkrtz_f16_f32 v165, v164, v165
v_and_b32 v165, s49, v165
s_waitcnt lgkmcnt(7)
v_mfma_f32_16x16x32_bf16 v[0:3], v[176:179], v[24:27], 0
ds_read_u16 v162, v162
ds_read_u16_d16_hi v163, v163
s_waitcnt lgkmcnt(8)
v_mfma_f32_16x16x32_f16 v[72:75], v[180:183], v[196:199], v[72:75]
v_bfe_u32 v164, v165, 2, 14
v_lshrrev_b32 v165, 18, v165
v_mfma_f32_16x16x32_bf16 v[8:11], v[176:179], v[28:31], 0
ds_read_b128 v[176:179], v251 offset:49152
ds_read_u16 v164, v164
v_mfma_f32_16x16x32_f16 v[128:131], v[180:183], v[192:195], v[128:131]
ds_read_b128 v[180:183], v249 offset:30976
ds_read_u16_d16_hi v165, v165
s_waitcnt lgkmcnt(11)
v_mfma_f32_16x16x32_bf16 v[0:3], v[184:187], v[32:35], v[0:3]
v_pk_mul_f16 v175, v174, v175
v_exp_f16_sdwa v173, v173 dst_sel:WORD_0 dst_unused:UNUSED_PRESERVE src0_sel:WORD_0
s_waitcnt lgkmcnt(10)
v_mfma_f32_16x16x32_f16 v[76:79], v[188:191], v[196:199], v[76:79]
v_or_b32_e64 v108, v152, v153
v_cvt_pkrtz_f16_f32 v167, v166, v167
v_mfma_f32_16x16x32_bf16 v[8:11], v[184:187], v[36:39], v[8:11]
ds_read_b128 v[184:187], v251 offset:47104
s_setprio 2
v_and_b32 v167, s49, v167
v_mfma_f32_16x16x32_f16 v[132:135], v[188:191], v[192:195], v[132:135]
ds_read_b128 v[188:191], v249 offset:33024
v_bfe_u32 v166, v167, 2, 14
s_waitcnt lgkmcnt(10)
v_mfma_f32_16x16x32_bf16 v[0:3], v[120:123], v[40:43], v[0:3]
v_lshrrev_b32_e64 v167, 18, v167
v_exp_f16_sdwa v175, v175 dst_sel:WORD_0 dst_unused:UNUSED_PRESERVE src0_sel:WORD_0
s_waitcnt lgkmcnt(8)
v_mfma_f32_16x16x32_f16 v[80:83], v[124:127], v[196:199], v[80:83]
ds_read_u16 v166, v166
ds_read_u16_d16_hi v167, v167
v_mfma_f32_16x16x32_bf16 v[8:11], v[120:123], v[44:47], v[8:11]
ds_read_b128 v[120:123], v251 offset:50176
v_or_b32_e64 v109, v154, v155
v_mfma_f32_16x16x32_f16 v[136:139], v[124:127], v[192:195], v[136:139]
ds_read_b128 v[124:127], v249 offset:35072
v_cvt_pkrtz_f16_f32 v169, v168, v169
v_and_b32_e64 v169, s49, v169
v_bfe_u32 v168, v169, 2, 14
v_lshrrev_b32 v169, 18, v169
s_waitcnt lgkmcnt(9)
v_mfma_f32_16x16x32_f16 v[84:87], v[176:179], v[196:199], v[84:87]
ds_read_u16 v168, v168
ds_read_u16_d16_hi v169, v169
v_exp_f16_sdwa v173, v173 dst_sel:WORD_1 dst_unused:UNUSED_PRESERVE src0_sel:WORD_1
v_mfma_f32_16x16x32_f16 v[140:143], v[176:179], v[192:195], v[140:143]
ds_read_b128 v[176:179], v251 offset:51200
v_cvt_pkrtz_f16_f32 v171, v170, v171
v_and_b32 v171, s49, v171
v_bfe_u32 v170, v171, 2, 14
s_waitcnt lgkmcnt(10)
v_mfma_f32_16x16x32_bf16 v[4:7], v[180:183], v[24:27], 0
v_lshrrev_b32_e64 v171, 18, v171
v_exp_f16_sdwa v175, v175 dst_sel:WORD_1 dst_unused:UNUSED_PRESERVE src0_sel:WORD_1
v_mfma_f32_16x16x32_bf16 v[12:15], v[180:183], v[28:31], 0
ds_read_b128 v[180:183], v248
ds_read_u16 v170, v170
ds_read_u16_d16_hi v171, v171
v_pk_add_f16 v173, v173, 1.0 op_sel_hi:[1,0]
s_waitcnt lgkmcnt(11)
v_mfma_f32_16x16x32_f16 v[88:91], v[184:187], v[196:199], v[88:91]
v_pk_add_f16 v175, v175, 1.0 op_sel_hi:[1,0]
v_rcp_f16_sdwa v173, v173 dst_sel:WORD_0 dst_unused:UNUSED_PRESERVE src0_sel:WORD_0
s_waitcnt lgkmcnt(10)
v_mfma_f32_16x16x32_bf16 v[4:7], v[188:191], v[32:35], v[4:7]
v_rcp_f16_sdwa v175, v175 dst_sel:WORD_0 dst_unused:UNUSED_PRESERVE src0_sel:WORD_0
v_mfma_f32_16x16x32_f16 v[240:243], v[184:187], v[192:195], v[240:243]
ds_read_b128 v[184:187], v251 offset:54272
v_rcp_f16_sdwa v173, v173 dst_sel:WORD_1 dst_unused:UNUSED_PRESERVE src0_sel:WORD_1
v_mfma_f32_16x16x32_bf16 v[12:15], v[188:191], v[36:39], v[12:15]
ds_read_b128 v[188:191], v248 offset:2048
s_setprio 1
v_rcp_f16_sdwa v175, v175 dst_sel:WORD_1 dst_unused:UNUSED_PRESERVE src0_sel:WORD_1
v_or_b32 v200, v160, v161
v_pk_mul_f16 v206, v172, v173
v_pk_mul_f16 v207, v174, v175
s_waitcnt lgkmcnt(9)
v_mfma_f32_16x16x32_f16 v[92:95], v[120:123], v[196:199], v[92:95]
v_or_b32 v201, v162, v163
v_cvt_pkrtz_f16_f32 v1, v0, v1
s_waitcnt lgkmcnt(8)
v_mfma_f32_16x16x32_bf16 v[4:7], v[124:127], v[40:43], v[4:7]
v_and_b32 v1, s49, v1
v_bfe_u32 v0, v1, 2, 14
v_mfma_f32_16x16x32_f16 v[244:247], v[120:123], v[192:195], v[244:247]
ds_read_b128 v[120:123], v251 offset:52224
v_lshrrev_b32_e64 v1, 18, v1
v_mfma_f32_16x16x32_bf16 v[12:15], v[124:127], v[44:47], v[12:15]
ds_read_b128 v[124:127], v248 offset:4096
ds_read_u16 v0, v0
ds_read_u16_d16_hi v1, v1
v_or_b32_e64 v202, v164, v165
v_cvt_pkrtz_f16_f32 v3, v2, v3
v_and_b32_e64 v3, s49, v3
v_bfe_u32 v2, v3, 2, 14
v_lshrrev_b32 v3, 18, v3
v_or_b32 v203, v166, v167
s_waitcnt lgkmcnt(9)
v_mfma_f32_16x16x32_f16 v[72:75], v[176:179], v[116:119], v[72:75]
v_cvt_pk_f16_f32 v12, v12, v13
v_cvt_pk_f16_f32 v14, v14, v15
v_mfma_f32_16x16x32_f16 v[128:131], v[176:179], v[112:115], v[128:131]
ds_read_b128 v[176:179], v251 offset:55296
v_pk_fma_f16 v13, v12, v12, s48
s_waitcnt lgkmcnt(9)
v_mfma_f32_16x16x32_bf16 v[144:147], v[180:183], v[48:51], 0
ds_read_u16 v2, v2
ds_read_u16_d16_hi v3, v3
v_mfma_f32_16x16x32_bf16 v[152:155], v[180:183], v[52:55], 0
ds_read_b128 v[180:183], v251 offset:53248
v_pk_fma_f16 v15, v14, v14, s48
v_pk_mul_f16 v13, v12, v13
v_cvt_pkrtz_f16_f32 v5, v4, v5
v_and_b32_e64 v5, s49, v5
v_bfe_u32 v4, v5, 2, 14
v_lshrrev_b32 v5, 18, v5
v_pk_mul_f16 v15, v14, v15
s_waitcnt lgkmcnt(9)
v_mfma_f32_16x16x32_f16 v[76:79], v[184:187], v[116:119], v[76:79]
ds_read_u16 v4, v4
ds_read_u16_d16_hi v5, v5
v_mfma_f32_16x16x32_f16 v[132:135], v[184:187], v[112:115], v[132:135]
ds_read_b128 v[184:187], v248 offset:256
v_exp_f16_sdwa v13, v13 dst_sel:WORD_0 dst_unused:UNUSED_PRESERVE src0_sel:WORD_0
s_waitcnt lgkmcnt(11)
v_mfma_f32_16x16x32_bf16 v[144:147], v[188:191], v[56:59], v[144:147]
v_or_b32 v204, v168, v169
v_cvt_pkrtz_f16_f32 v7, v6, v7
s_waitcnt lgkmcnt(10)
v_mfma_f32_16x16x32_f16 v[80:83], v[120:123], v[116:119], v[80:83]
v_and_b32 v7, s49, v7
v_bfe_u32 v6, v7, 2, 14
v_mfma_f32_16x16x32_bf16 v[152:155], v[188:191], v[60:63], v[152:155]
ds_read_b128 v[188:191], v251 offset:56320
s_setprio 0
v_lshrrev_b32_e64 v7, 18, v7
v_mfma_f32_16x16x32_f16 v[136:139], v[120:123], v[112:115], v[136:139]
ds_read_b128 v[120:123], v248 offset:2304
ds_read_u16 v6, v6
s_waitcnt lgkmcnt(12)
v_mfma_f32_16x16x32_bf16 v[144:147], v[124:127], v[64:67], v[144:147]
ds_read_u16_d16_hi v7, v7
v_exp_f16_sdwa v15, v15 dst_sel:WORD_0 dst_unused:UNUSED_PRESERVE src0_sel:WORD_0
v_mfma_f32_16x16x32_bf16 v[152:155], v[124:127], v[68:71], v[152:155]
ds_read_b128 v[124:127], v251 offset:57344
v_or_b32 v205, v170, v171
s_waitcnt lgkmcnt(11)
v_mfma_f32_16x16x32_f16 v[84:87], v[176:179], v[116:119], v[84:87]
v_cvt_pkrtz_f16_f32 v9, v8, v9
v_and_b32_e64 v9, s49, v9
v_mfma_f32_16x16x32_f16 v[140:143], v[176:179], v[112:115], v[140:143]
ds_read_b128 v[176:179], v248 offset:4352
v_bfe_u32 v8, v9, 2, 14
v_lshrrev_b32_e64 v9, 18, v9
v_exp_f16_sdwa v13, v13 dst_sel:WORD_1 dst_unused:UNUSED_PRESERVE src0_sel:WORD_1
v_cvt_pkrtz_f16_f32 v11, v10, v11
v_and_b32_e64 v11, s49, v11
v_bfe_u32 v10, v11, 2, 14
v_lshrrev_b32 v11, 18, v11
s_waitcnt lgkmcnt(9)
v_mfma_f32_16x16x32_f16 v[88:91], v[180:183], v[116:119], v[88:91]
ds_read_u16 v8, v8
ds_read_u16_d16_hi v9, v9
v_mfma_f32_16x16x32_f16 v[240:243], v[180:183], v[112:115], v[240:243]
ds_read_b128 v[180:183], v251 offset:60416
ds_read_u16 v10, v10
ds_read_u16_d16_hi v11, v11
v_exp_f16_sdwa v15, v15 dst_sel:WORD_1 dst_unused:UNUSED_PRESERVE src0_sel:WORD_1
v_pk_add_f16 v13, v13, 1.0 op_sel_hi:[1,0]
v_pk_add_f16 v15, v15, 1.0 op_sel_hi:[1,0]
v_rcp_f16_sdwa v13, v13 dst_sel:WORD_0 dst_unused:UNUSED_PRESERVE src0_sel:WORD_0
v_rcp_f16_sdwa v15, v15 dst_sel:WORD_0 dst_unused:UNUSED_PRESERVE src0_sel:WORD_0
v_rcp_f16_sdwa v13, v13 dst_sel:WORD_1 dst_unused:UNUSED_PRESERVE src0_sel:WORD_1
s_waitcnt lgkmcnt(11)
v_mfma_f32_16x16x32_bf16 v[148:151], v[184:187], v[48:51], 0
v_rcp_f16_sdwa v15, v15 dst_sel:WORD_1 dst_unused:UNUSED_PRESERVE src0_sel:WORD_1
v_mfma_f32_16x16x32_bf16 v[156:159], v[184:187], v[52:55], 0
ds_read_b128 v[184:187], v248 offset:6144
v_or_b32_e64 v216, v0, v1
s_waitcnt lgkmcnt(11)
v_mfma_f32_16x16x32_f16 v[92:95], v[188:191], v[116:119], v[92:95]
v_pk_mul_f16 v222, v12, v13
v_pk_mul_f16 v223, v14, v15
s_waitcnt lgkmcnt(10)
v_mfma_f32_16x16x32_bf16 v[148:151], v[120:123], v[56:59], v[148:151]
v_or_b32 v217, v2, v3
v_cvt_pkrtz_f16_f32 v145, v144, v145
v_mfma_f32_16x16x32_f16 v[244:247], v[188:191], v[112:115], v[244:247]
ds_read_b128 v[188:191], v251 offset:58368
s_setprio 3
v_and_b32 v145, s49, v145
v_mfma_f32_16x16x32_bf16 v[156:159], v[120:123], v[60:63], v[156:159]
ds_read_b128 v[120:123], v248 offset:8192
v_bfe_u32 v144, v145, 2, 14
v_lshrrev_b32_e64 v145, 18, v145
v_or_b32 v218, v4, v5
s_waitcnt lgkmcnt(9)
v_mfma_f32_16x16x32_f16 v[72:75], v[124:127], v[228:231], v[72:75]
ds_read_u16 v144, v144
ds_read_u16_d16_hi v145, v145
s_waitcnt lgkmcnt(10)
v_mfma_f32_16x16x32_bf16 v[148:151], v[176:179], v[64:67], v[148:151]
v_cvt_pkrtz_f16_f32 v147, v146, v147
v_and_b32 v147, s49, v147
v_mfma_f32_16x16x32_f16 v[128:131], v[124:127], v[224:227], v[128:131]
ds_read_b128 v[124:127], v251 offset:61440
v_bfe_u32 v146, v147, 2, 14
v_mfma_f32_16x16x32_bf16 v[156:159], v[176:179], v[68:71], v[156:159]
ds_read_b128 v[176:179], v248 offset:10240
v_lshrrev_b32 v147, 18, v147
v_or_b32 v219, v6, v7
v_cvt_pkrtz_f16_f32 v149, v148, v149
v_and_b32_e64 v149, s49, v149
v_bfe_u32 v148, v149, 2, 14
v_lshrrev_b32 v149, 18, v149
s_waitcnt lgkmcnt(10)
v_or_b32 v220, v8, v9
s_waitcnt lgkmcnt(9)
v_mfma_f32_16x16x32_f16 v[76:79], v[180:183], v[228:231], v[76:79]
v_cvt_pk_f16_f32 v156, v156, v157
v_cvt_pk_f16_f32 v158, v158, v159
v_mfma_f32_16x16x32_f16 v[132:135], v[180:183], v[224:227], v[132:135]
ds_read_b128 v[180:183], v251 offset:59392
v_pk_fma_f16 v157, v156, v156, s48
v_pk_fma_f16 v159, v158, v158, s48
v_pk_mul_f16 v157, v156, v157
v_pk_mul_f16 v159, v158, v159
v_exp_f16_sdwa v157, v157 dst_sel:WORD_0 dst_unused:UNUSED_PRESERVE src0_sel:WORD_0
v_cvt_pkrtz_f16_f32 v151, v150, v151
v_and_b32_e64 v151, s49, v151
ds_read_u16 v146, v146
ds_read_u16_d16_hi v147, v147
ds_read_u16 v148, v148
ds_read_u16_d16_hi v149, v149
s_waitcnt lgkmcnt(11)
v_mfma_f32_16x16x32_bf16 v[160:163], v[184:187], v[48:51], 0
v_bfe_u32 v150, v151, 2, 14
v_lshrrev_b32_e64 v151, 18, v151
s_waitcnt lgkmcnt(10)
v_mfma_f32_16x16x32_f16 v[80:83], v[188:191], v[228:231], v[80:83]
ds_read_u16 v150, v150
ds_read_u16_d16_hi v151, v151
v_mfma_f32_16x16x32_bf16 v[168:171], v[184:187], v[52:55], 0
ds_read_b128 v[184:187], v251 offset:62464
v_exp_f16_sdwa v159, v159 dst_sel:WORD_0 dst_unused:UNUSED_PRESERVE src0_sel:WORD_0
v_mfma_f32_16x16x32_f16 v[136:139], v[188:191], v[224:227], v[136:139]
ds_read_b128 v[188:191], v248 offset:6400
v_or_b32 v221, v10, v11
s_waitcnt lgkmcnt(13)
v_mfma_f32_16x16x32_bf16 v[160:163], v[120:123], v[56:59], v[160:163]
v_cvt_pkrtz_f16_f32 v153, v152, v153
v_and_b32 v153, s49, v153
v_mfma_f32_16x16x32_bf16 v[168:171], v[120:123], v[60:63], v[168:171]
s_setprio 2
ds_read_b128 v[120:123], v251 offset:63488
v_bfe_u32 v152, v153, 2, 14
v_lshrrev_b32 v153, 18, v153
v_exp_f16_sdwa v157, v157 dst_sel:WORD_1 dst_unused:UNUSED_PRESERVE src0_sel:WORD_1
s_waitcnt lgkmcnt(11)
v_mfma_f32_16x16x32_f16 v[84:87], v[124:127], v[228:231], v[84:87]
ds_read_u16 v152, v152
ds_read_u16_d16_hi v153, v153
v_mfma_f32_16x16x32_f16 v[140:143], v[124:127], v[224:227], v[140:143]
ds_read_b128 v[124:127], v248 offset:8448
v_cvt_pkrtz_f16_f32 v155, v154, v155
s_waitcnt lgkmcnt(13)
v_mfma_f32_16x16x32_bf16 v[160:163], v[176:179], v[64:67], v[160:163]
v_and_b32 v155, s49, v155
v_bfe_u32 v154, v155, 2, 14
s_waitcnt lgkmcnt(12)
v_mfma_f32_16x16x32_f16 v[88:91], v[180:183], v[228:231], v[88:91]
v_lshrrev_b32 v155, 18, v155
v_exp_f16_sdwa v159, v159 dst_sel:WORD_1 dst_unused:UNUSED_PRESERVE src0_sel:WORD_1
v_mfma_f32_16x16x32_f16 v[240:243], v[180:183], v[224:227], v[240:243]
ds_read_b128 v[180:183], v248 offset:10496
ds_read_u16 v154, v154
v_mfma_f32_16x16x32_bf16 v[168:171], v[176:179], v[68:71], v[168:171]
ds_read_b128 v[176:179], v252 offset:1024
s_waitcnt lgkmcnt(14)
ds_read_u16_d16_hi v155, v155
v_pk_add_f16 v157, v157, 1.0 op_sel_hi:[1,0]
v_pk_add_f16 v159, v159, 1.0 op_sel_hi:[1,0]
v_rcp_f16_sdwa v157, v157 dst_sel:WORD_0 dst_unused:UNUSED_PRESERVE src0_sel:WORD_0
v_rcp_f16_sdwa v159, v159 dst_sel:WORD_0 dst_unused:UNUSED_PRESERVE src0_sel:WORD_0
v_rcp_f16_sdwa v157, v157 dst_sel:WORD_1 dst_unused:UNUSED_PRESERVE src0_sel:WORD_1
v_mov_b32 v16, 0
v_mov_b32_e64 v17, 0
v_cndmask_b32 v18, 0, v255, s[88:89]
v_cndmask_b32 v19, 0, v255, s[90:91]
v_mov_b32 v20, 0
v_mov_b32 v21, 0
v_rcp_f16_sdwa v159, v159 dst_sel:WORD_1 dst_unused:UNUSED_PRESERVE src0_sel:WORD_1
v_or_b32_e64 v192, v144, v145
v_pk_mul_f16 v198, v156, v157
v_pk_mul_f16 v199, v158, v159
s_waitcnt lgkmcnt(12)
v_or_b32 v193, v146, v147
v_cvt_pkrtz_f16_f32 v161, v160, v161
v_and_b32_e64 v161, s49, v161
v_bfe_u32 v160, v161, 2, 14
v_lshrrev_b32 v161, 18, v161
v_or_b32 v194, v148, v149
v_cvt_pkrtz_f16_f32 v163, v162, v163
v_and_b32 v163, s49, v163
v_bfe_u32 v162, v163, 2, 14
s_waitcnt lgkmcnt(9)
v_mfma_f32_16x16x32_f16 v[92:95], v[184:187], v[228:231], v[92:95]
ds_read_u16 v160, v160
ds_read_u16_d16_hi v161, v161
s_waitcnt lgkmcnt(10)
v_mfma_f32_16x16x32_bf16 v[164:167], v[188:191], v[48:51], 0
v_lshrrev_b32 v163, 18, v163
v_or_b32_e64 v195, v150, v151
v_mfma_f32_16x16x32_f16 v[244:247], v[184:187], v[224:227], v[244:247]
ds_read_b128 v[184:187], v251 offset:64512
ds_read_u16 v162, v162
v_mfma_f32_16x16x32_bf16 v[172:175], v[188:191], v[52:55], 0
ds_read_b128 v[188:191], v248 offset:12288
ds_read_u16_d16_hi v163, v163
s_waitcnt lgkmcnt(13)
v_mfma_f32_16x16x32_f16 v[72:75], v[120:123], v[108:111], v[72:75]
v_cvt_pkrtz_f16_f32 v169, v168, v169
v_and_b32 v169, s49, v169
v_mfma_f32_16x16x32_f16 v[128:131], v[120:123], v[104:107], v[128:131]
ds_read_b128 v[120:123], v252 offset:2048
s_waitcnt lgkmcnt(12)
v_or_b32 v196, v152, v153
s_waitcnt vmcnt(7)
v_mfma_f32_16x16x32_bf16 v[128:131], v[18:21], v[232:235], v[128:131]
s_setprio 1
s_setprio 0
v_bfe_u32 v168, v169, 2, 14
s_waitcnt lgkmcnt(11)
v_mfma_f32_16x16x32_bf16 v[164:167], v[124:127], v[56:59], v[164:167]
v_lshrrev_b32_e64 v169, 18, v169
v_cvt_pkrtz_f16_f32 v171, v170, v171
v_mfma_f32_16x16x32_bf16 v[172:175], v[124:127], v[60:63], v[172:175]
ds_read_b128 v[124:127], v248 offset:14336
ds_read_u16 v168, v168
s_waitcnt lgkmcnt(12)
v_mfma_f32_16x16x32_bf16 v[164:167], v[180:183], v[64:67], v[164:167]
ds_read_u16_d16_hi v169, v169
v_and_b32 v171, s49, v171
v_mfma_f32_16x16x32_bf16 v[172:175], v[180:183], v[68:71], v[172:175]
ds_read_b128 v[180:183], v248 offset:16384
v_bfe_u32 v170, v171, 2, 14
s_waitcnt lgkmcnt(12)
v_mfma_f32_16x16x32_f16 v[76:79], v[176:179], v[108:111], v[76:79]
v_lshrrev_b32 v171, 18, v171
v_cvt_pkrtz_f16_f32 v165, v164, v165
v_mfma_f32_16x16x32_f16 v[132:135], v[176:179], v[104:107], v[132:135]
ds_read_b128 v[176:179], v252
v_cvt_pk_f16_f32 v172, v172, v173
v_cvt_pk_f16_f32 v174, v174, v175
v_pk_fma_f16 v173, v172, v172, s48
v_pk_fma_f16 v175, v174, v174, s48
v_pk_mul_f16 v173, v172, v173
v_and_b32_e64 v165, s49, v165
v_bfe_u32 v164, v165, 2, 14
v_lshrrev_b32_e64 v165, 18, v165
v_pk_mul_f16 v175, v174, v175
v_exp_f16_sdwa v173, v173 dst_sel:WORD_0 dst_unused:UNUSED_PRESERVE src0_sel:WORD_0
v_cvt_pkrtz_f16_f32 v167, v166, v167
v_and_b32_e64 v167, s49, v167
v_bfe_u32 v166, v167, 2, 14
v_lshrrev_b32 v167, 18, v167
ds_read_u16 v164, v164
ds_read_u16_d16_hi v165, v165
s_waitcnt lgkmcnt(11)
v_mfma_f32_16x16x32_f16 v[80:83], v[184:187], v[108:111], v[80:83]
ds_read_u16 v166, v166
ds_read_u16_d16_hi v167, v167
v_mfma_f32_16x16x32_f16 v[136:139], v[184:187], v[104:107], v[136:139]
ds_read_b128 v[184:187], v252 offset:3072
v_exp_f16_sdwa v175, v175 dst_sel:WORD_0 dst_unused:UNUSED_PRESERVE src0_sel:WORD_0
v_mfma_f32_16x16x32_bf16 v[132:135], v[16:19], v[232:235], v[132:135]
v_or_b32 v197, v154, v155
v_exp_f16_sdwa v173, v173 dst_sel:WORD_1 dst_unused:UNUSED_PRESERVE src0_sel:WORD_1
s_waitcnt lgkmcnt(12)
v_mfma_f32_16x16x32_bf16 v[0:3], v[188:191], v[48:51], 0
ds_read_u16 v170, v170
ds_read_u16_d16_hi v171, v171
v_mfma_f32_16x16x32_bf16 v[8:11], v[188:191], v[52:55], 0
ds_read_b128 v[188:191], v252 offset:4096
v_exp_f16_sdwa v175, v175 dst_sel:WORD_1 dst_unused:UNUSED_PRESERVE src0_sel:WORD_1
s_waitcnt lgkmcnt(13)
v_mfma_f32_16x16x32_f16 v[84:87], v[120:123], v[108:111], v[84:87]
v_pk_add_f16 v173, v173, 1.0 op_sel_hi:[1,0]
v_pk_add_f16 v175, v175, 1.0 op_sel_hi:[1,0]
v_mfma_f32_16x16x32_f16 v[140:143], v[120:123], v[104:107], v[140:143]
ds_read_b128 v[120:123], v248 offset:12544
v_rcp_f16_sdwa v173, v173 dst_sel:WORD_0 dst_unused:UNUSED_PRESERVE src0_sel:WORD_0
s_waitcnt lgkmcnt(13)
v_mfma_f32_16x16x32_bf16 v[0:3], v[124:127], v[56:59], v[0:3]
v_rcp_f16_sdwa v175, v175 dst_sel:WORD_0 dst_unused:UNUSED_PRESERVE src0_sel:WORD_0
v_mfma_f32_16x16x32_bf16 v[8:11], v[124:127], v[60:63], v[8:11]
ds_read_b128 v[124:127], v252 offset:7168
v_rcp_f16_sdwa v173, v173 dst_sel:WORD_1 dst_unused:UNUSED_PRESERVE src0_sel:WORD_1
s_waitcnt vmcnt(6)
v_mfma_f32_16x16x32_bf16 v[136:139], v[18:21], v[236:239], v[136:139]
v_rcp_f16_sdwa v175, v175 dst_sel:WORD_1 dst_unused:UNUSED_PRESERVE src0_sel:WORD_1
s_waitcnt lgkmcnt(11)
v_mfma_f32_16x16x32_bf16 v[0:3], v[180:183], v[64:67], v[0:3]
v_or_b32 v24, v160, v161
v_pk_mul_f16 v30, v172, v173
s_waitcnt lgkmcnt(10)
v_mfma_f32_16x16x32_f16 v[88:91], v[176:179], v[108:111], v[88:91]
v_pk_mul_f16 v31, v174, v175
v_or_b32_e64 v25, v162, v163
v_mfma_f32_16x16x32_f16 v[240:243], v[176:179], v[104:107], v[240:243]
ds_read_b128 v[176:179], v248 offset:14592
v_cvt_pkrtz_f16_f32 v1, v0, v1
v_mfma_f32_16x16x32_bf16 v[8:11], v[180:183], v[68:71], v[8:11]
ds_read_b128 v[180:183], v252 offset:5120
v_and_b32_e64 v1, s49, v1
v_mfma_f32_16x16x32_bf16 v[140:143], v[16:19], v[236:239], v[140:143]
v_bfe_u32 v0, v1, 2, 14
v_lshrrev_b32 v1, 18, v1
s_waitcnt lgkmcnt(10)
v_or_b32_e64 v26, v164, v165
v_cvt_pkrtz_f16_f32 v3, v2, v3
v_and_b32_e64 v3, s49, v3
v_bfe_u32 v2, v3, 2, 14
v_lshrrev_b32_e64 v3, 18, v3
ds_read_u16 v0, v0
ds_read_u16_d16_hi v1, v1
ds_read_u16 v2, v2
ds_read_u16_d16_hi v3, v3
s_waitcnt lgkmcnt(12)
v_or_b32_e64 v27, v166, v167
s_waitcnt lgkmcnt(11)
v_mfma_f32_16x16x32_f16 v[92:95], v[184:187], v[108:111], v[92:95]
v_mfma_f32_16x16x32_f16 v[244:247], v[184:187], v[104:107], v[244:247]
ds_read_b128 v[184:187], v248 offset:16640
v_or_b32 v28, v168, v169
s_waitcnt lgkmcnt(9)
v_mfma_f32_16x16x32_f16 v[72:75], v[188:191], v[204:207], v[72:75]
v_mfma_f32_16x16x32_f16 v[128:131], v[188:191], v[200:203], v[128:131]
ds_read_b128 v[188:191], v252 offset:8192
s_waitcnt lgkmcnt(9)
v_mfma_f32_16x16x32_bf16 v[4:7], v[120:123], v[48:51], 0
v_or_b32 v29, v170, v171
v_cvt_pkrtz_f16_f32 v9, v8, v9
v_mfma_f32_16x16x32_bf16 v[12:15], v[120:123], v[52:55], 0
ds_read_b128 v[120:123], v248 offset:18432
v_and_b32 v9, s49, v9
s_waitcnt lgkmcnt(9)
v_mfma_f32_16x16x32_f16 v[76:79], v[124:127], v[204:207], v[76:79]
v_bfe_u32 v8, v9, 2, 14
v_lshrrev_b32 v9, 18, v9
s_waitcnt lgkmcnt(8)
v_mfma_f32_16x16x32_bf16 v[4:7], v[176:179], v[56:59], v[4:7]
ds_read_u16 v8, v8
ds_read_u16_d16_hi v9, v9
v_mfma_f32_16x16x32_f16 v[132:135], v[124:127], v[200:203], v[132:135]
ds_read_b128 v[124:127], v252 offset:6144
s_setprio 3
v_cvt_pkrtz_f16_f32 v11, v10, v11
v_mfma_f32_16x16x32_bf16 v[12:15], v[176:179], v[60:63], v[12:15]
ds_read_b128 v[176:179], v248 offset:20480
v_and_b32_e64 v11, s49, v11
s_waitcnt lgkmcnt(11)
v_mfma_f32_16x16x32_f16 v[80:83], v[180:183], v[204:207], v[80:83]
v_bfe_u32 v10, v11, 2, 14
v_lshrrev_b32_e64 v11, 18, v11
v_mfma_f32_16x16x32_f16 v[136:139], v[180:183], v[200:203], v[136:139]
ds_read_b128 v[180:183], v252 offset:9216
ds_read_u16 v10, v10
s_waitcnt vmcnt(2)
v_mfma_f32_16x16x32_bf16 v[72:75], v[18:21], v[212:215], v[72:75]
s_setprio 2
ds_read_u16_d16_hi v11, v11
v_mfma_f32_16x16x32_bf16 v[76:79], v[16:19], v[212:215], v[76:79]
s_waitcnt lgkmcnt(9)
v_mfma_f32_16x16x32_bf16 v[4:7], v[184:187], v[64:67], v[4:7]
v_mfma_f32_16x16x32_bf16 v[12:15], v[184:187], v[68:71], v[12:15]
ds_read_b128 v[184:187], v248 offset:22528
s_waitcnt lgkmcnt(9)
v_mfma_f32_16x16x32_f16 v[84:87], v[188:191], v[204:207], v[84:87]
s_nop 3
v_cvt_pkrtz_f16_f32 v5, v4, v5
v_mfma_f32_16x16x32_f16 v[140:143], v[188:191], v[200:203], v[140:143]
ds_read_b128 v[188:191], v252 offset:10240
v_cvt_pk_f16_f32 v12, v12, v13
s_waitcnt lgkmcnt(9)
v_mfma_f32_16x16x32_bf16 v[144:147], v[120:123], v[48:51], 0
v_cvt_pk_f16_f32 v14, v14, v15
v_pk_fma_f16 v13, v12, v12, s48
v_mfma_f32_16x16x32_bf16 v[152:155], v[120:123], v[52:55], 0
ds_read_b128 v[120:123], v252 offset:13312
v_pk_fma_f16 v15, v14, v14, s48
v_pk_mul_f16 v13, v12, v13
v_and_b32 v5, s49, v5
v_bfe_u32 v4, v5, 2, 14
s_waitcnt lgkmcnt(7)
v_mfma_f32_16x16x32_f16 v[88:91], v[124:127], v[204:207], v[88:91]
v_lshrrev_b32_e64 v5, 18, v5
v_pk_mul_f16 v15, v14, v15
v_mfma_f32_16x16x32_f16 v[240:243], v[124:127], v[200:203], v[240:243]
ds_read_b128 v[124:127], v248 offset:18688
ds_read_u16 v4, v4
s_waitcnt lgkmcnt(8)
v_mfma_f32_16x16x32_bf16 v[144:147], v[176:179], v[56:59], v[144:147]
ds_read_u16_d16_hi v5, v5
v_exp_f16_sdwa v13, v13 dst_sel:WORD_0 dst_unused:UNUSED_PRESERVE src0_sel:WORD_0
s_waitcnt lgkmcnt(8)
v_mfma_f32_16x16x32_f16 v[92:95], v[180:183], v[204:207], v[92:95]
v_cvt_pkrtz_f16_f32 v7, v6, v7
v_and_b32_e64 v7, s49, v7
v_mfma_f32_16x16x32_bf16 v[152:155], v[176:179], v[60:63], v[152:155]
ds_read_b128 v[176:179], v252 offset:11264
v_bfe_u32 v6, v7, 2, 14
v_mfma_f32_16x16x32_f16 v[244:247], v[180:183], v[200:203], v[244:247]
ds_read_b128 v[180:183], v248 offset:20736
v_lshrrev_b32 v7, 18, v7
v_mfma_f32_16x16x32_bf16 v[240:243], v[18:21], v[208:211], v[240:243]
ds_read_u16 v6, v6
ds_read_u16_d16_hi v7, v7
v_mfma_f32_16x16x32_bf16 v[244:247], v[16:19], v[208:211], v[244:247]
v_exp_f16_sdwa v15, v15 dst_sel:WORD_0 dst_unused:UNUSED_PRESERVE src0_sel:WORD_0
s_waitcnt lgkmcnt(9)
v_mfma_f32_16x16x32_bf16 v[144:147], v[184:187], v[64:67], v[144:147]
v_exp_f16_sdwa v13, v13 dst_sel:WORD_1 dst_unused:UNUSED_PRESERVE src0_sel:WORD_1
s_waitcnt lgkmcnt(8)
v_mfma_f32_16x16x32_f16 v[72:75], v[188:191], v[220:223], v[72:75]
v_exp_f16_sdwa v15, v15 dst_sel:WORD_1 dst_unused:UNUSED_PRESERVE src0_sel:WORD_1
v_mfma_f32_16x16x32_f16 v[128:131], v[188:191], v[216:219], v[128:131]
ds_read_b128 v[188:191], v248 offset:22784
v_pk_add_f16 v13, v13, 1.0 op_sel_hi:[1,0]
v_mfma_f32_16x16x32_bf16 v[152:155], v[184:187], v[68:71], v[152:155]
ds_read_b128 v[184:187], v252 offset:14336
v_pk_add_f16 v15, v15, 1.0 op_sel_hi:[1,0]
s_waitcnt lgkmcnt(8)
v_mfma_f32_16x16x32_f16 v[76:79], v[120:123], v[220:223], v[76:79]
v_rcp_f16_sdwa v13, v13 dst_sel:WORD_0 dst_unused:UNUSED_PRESERVE src0_sel:WORD_0
v_mfma_f32_16x16x32_bf16 v[148:151], v[124:127], v[48:51], 0
v_rcp_f16_sdwa v15, v15 dst_sel:WORD_0 dst_unused:UNUSED_PRESERVE src0_sel:WORD_0
v_mfma_f32_16x16x32_f16 v[132:135], v[120:123], v[216:219], v[132:135]
ds_read_b128 v[120:123], v252 offset:12288
v_cvt_pk_bf16_f32 v40, v128, v129
v_mfma_f32_16x16x32_bf16 v[156:159], v[124:127], v[52:55], 0
ds_read_b128 v[124:127], v248 offset:24576
v_cvt_pk_bf16_f32 v41, v130, v131
s_waitcnt lgkmcnt(7)
v_mfma_f32_16x16x32_f16 v[80:83], v[176:179], v[220:223], v[80:83]
v_cvt_pk_bf16_f32 v116, v72, v73
v_cvt_pk_bf16_f32 v42, v132, v133
s_waitcnt lgkmcnt(6)
v_mfma_f32_16x16x32_bf16 v[148:151], v[180:183], v[56:59], v[148:151]
v_cvt_pk_bf16_f32 v43, v134, v135
v_cvt_pk_bf16_f32 v117, v74, v75
v_mfma_f32_16x16x32_f16 v[136:139], v[176:179], v[216:219], v[136:139]
ds_read_b128 v[176:179], v252 offset:15360
s_setprio 1
v_cvt_pk_bf16_f32 v118, v76, v77
v_mfma_f32_16x16x32_bf16 v[156:159], v[180:183], v[60:63], v[156:159]
ds_read_b128 v[180:183], v248 offset:26624
v_cvt_pk_bf16_f32 v119, v78, v79
s_waitcnt lgkmcnt(5)
v_mfma_f32_16x16x32_bf16 v[148:151], v[188:191], v[64:67], v[148:151]
ds_read_b128 v[128:131], v254 offset:8192
ds_read_b128 v[132:135], v254 offset:8208
s_waitcnt lgkmcnt(6)
v_mfma_f32_16x16x32_f16 v[84:87], v[184:187], v[220:223], v[84:87]
v_rcp_f16_sdwa v13, v13 dst_sel:WORD_1 dst_unused:UNUSED_PRESERVE src0_sel:WORD_1
v_mfma_f32_16x16x32_f16 v[140:143], v[184:187], v[216:219], v[140:143]
ds_read_b128 v[184:187], v251 offset:8192
v_cvt_pk_bf16_f32 v44, v136, v137
s_waitcnt lgkmcnt(6)
v_mfma_f32_16x16x32_f16 v[88:91], v[120:123], v[220:223], v[88:91]
v_cvt_pk_bf16_f32 v45, v138, v139
v_rcp_f16_sdwa v15, v15 dst_sel:WORD_1 dst_unused:UNUSED_PRESERVE src0_sel:WORD_1
v_mfma_f32_16x16x32_bf16 v[156:159], v[188:191], v[68:71], v[156:159]
ds_read_b128 v[188:191], v248 offset:28672
v_cvt_pk_bf16_f32 v46, v140, v141
v_cvt_pk_bf16_f32 v47, v142, v143
v_mfma_f32_16x16x32_f16 v[240:243], v[120:123], v[216:219], v[240:243]
ds_read_b128 v[136:139], v254 offset:8320
ds_read_b128 v[140:143], v254 offset:8336
ds_read_b128 v[120:123], v251 offset:11264
s_waitcnt lgkmcnt(8)
v_mfma_f32_16x16x32_bf16 v[160:163], v[124:127], v[48:51], 0
v_or_b32 v32, v0, v1
v_pk_mul_f16 v38, v12, v13
v_mfma_f32_16x16x32_f16 v[92:95], v[176:179], v[220:223], v[92:95]
v_cvt_pk_bf16_f32 v112, v240, v241
v_cvt_pk_bf16_f32 v113, v242, v243
v_mfma_f32_16x16x32_bf16 v[168:171], v[124:127], v[52:55], 0
ds_read_b128 v[240:243], v254
ds_read_b128 v[124:127], v251 offset:9216
v_pk_mul_f16 v39, v14, v15
v_mfma_f32_16x16x32_f16 v[244:247], v[176:179], v[216:219], v[244:247]
ds_read_b128 v[176:179], v248 offset:24832
v_or_b32_e64 v33, v2, v3
v_cvt_pkrtz_f16_f32 v145, v144, v145
v_and_b32_e64 v145, s49, v145
v_bfe_u32 v144, v145, 2, 14
v_lshrrev_b32_e64 v145, 18, v145
v_cvt_pk_f16_f32 v156, v156, v157
s_waitcnt lgkmcnt(6)
v_mfma_f32_16x16x32_bf16 v[160:163], v[180:183], v[56:59], v[160:163]
v_cvt_pk_bf16_f32 v114, v244, v245
v_cvt_pk_bf16_f32 v115, v246, v247
s_waitcnt vmcnt(1)
v_mfma_f32_16x16x32_bf16 v[80:83], v[18:21], v[96:99], v[80:83]
ds_read_b128 v[244:247], v254 offset:16
ds_read_u16 v144, v144
ds_read_u16_d16_hi v145, v145
v_mfma_f32_16x16x32_bf16 v[84:87], v[16:19], v[96:99], v[84:87]
v_cvt_pk_f16_f32 v158, v158, v159
v_pk_fma_f16 v157, v156, v156, s48
s_waitcnt vmcnt(0)
v_mfma_f32_16x16x32_bf16 v[88:91], v[18:21], v[100:103], v[88:91]
v_or_b32 v34, v4, v5
v_cvt_pkrtz_f16_f32 v147, v146, v147
v_mfma_f32_16x16x32_bf16 v[92:95], v[16:19], v[100:103], v[92:95]
v_cvt_pk_bf16_f32 v16, v80, v81
v_cvt_pk_bf16_f32 v17, v82, v83
v_cvt_pk_bf16_f32 v18, v84, v85
v_cvt_pk_bf16_f32 v19, v86, v87
s_nop 0
v_cvt_pk_bf16_f32 v20, v88, v89
v_cvt_pk_bf16_f32 v21, v90, v91
v_mfma_f32_16x16x32_f16 v[72:75], v[184:187], v[196:199], v[128:131]
v_cvt_pk_bf16_f32 v22, v92, v93
v_cvt_pk_bf16_f32 v23, v94, v95
s_setprio 0
v_and_b32_e64 v147, s49, v147
v_bfe_u32 v146, v147, 2, 14
v_lshrrev_b32_e64 v147, 18, v147
v_mfma_f32_16x16x32_bf16 v[168:171], v[180:183], v[60:63], v[168:171]
ds_read_u16 v146, v146
ds_read_u16_d16_hi v147, v147
ds_read_b128 v[180:183], v251 offset:12288
v_pk_fma_f16 v159, v158, v158, s48
v_mfma_f32_16x16x32_f16 v[128:131], v[184:187], v[192:195], v[128:131]
ds_read_b128 v[184:187], v248 offset:26880
buffer_store_dwordx4 v[40:43], v253, s[8:11], s69 offen sc1
buffer_store_dwordx4 v[44:47], v253, s[8:11], s69 offen offset:64 sc1
v_pk_mul_f16 v157, v156, v157
v_or_b32_e64 v35, v6, v7
v_mfma_f32_16x16x32_bf16 v[160:163], v[188:191], v[64:67], v[160:163]
v_cvt_pkrtz_f16_f32 v149, v148, v149
v_and_b32_e64 v149, s49, v149
v_bfe_u32 v148, v149, 2, 14
v_lshrrev_b32 v149, 18, v149
s_waitcnt lgkmcnt(4)
v_mfma_f32_16x16x32_f16 v[76:79], v[120:123], v[196:199], v[132:135]
ds_read_u16 v148, v148
ds_read_u16_d16_hi v149, v149
v_pk_mul_f16 v159, v158, v159
v_exp_f16_sdwa v157, v157 dst_sel:WORD_0 dst_unused:UNUSED_PRESERVE src0_sel:WORD_0
v_mfma_f32_16x16x32_f16 v[132:135], v[120:123], v[192:195], v[132:135]
ds_read_b128 v[120:123], v248 offset:28928
v_or_b32_e64 v36, v8, v9
v_mfma_f32_16x16x32_bf16 v[168:171], v[188:191], v[68:71], v[168:171]
ds_read_b128 v[188:191], v251 offset:10240
v_cvt_pkrtz_f16_f32 v151, v150, v151
v_and_b32_e64 v151, s49, v151
v_bfe_u32 v150, v151, 2, 14
v_lshrrev_b32_e64 v151, 18, v151
v_exp_f16_sdwa v159, v159 dst_sel:WORD_0 dst_unused:UNUSED_PRESERVE src0_sel:WORD_0
v_mfma_f32_16x16x32_f16 v[80:83], v[124:127], v[196:199], v[136:139]
ds_read_u16 v150, v150
ds_read_u16_d16_hi v151, v151
v_mfma_f32_16x16x32_bf16 v[164:167], v[176:179], v[48:51], 0
v_or_b32_e64 v37, v10, v11
v_cvt_pkrtz_f16_f32 v153, v152, v153
v_and_b32_e64 v153, s49, v153
v_bfe_u32 v152, v153, 2, 14
v_lshrrev_b32_e64 v153, 18, v153
v_exp_f16_sdwa v157, v157 dst_sel:WORD_1 dst_unused:UNUSED_PRESERVE src0_sel:WORD_1
v_mfma_f32_16x16x32_f16 v[136:139], v[124:127], v[192:195], v[136:139]
ds_read_u16 v152, v152
ds_read_u16_d16_hi v153, v153
ds_read_b128 v[124:127], v251 offset:13312
v_mfma_f32_16x16x32_bf16 v[172:175], v[176:179], v[52:55], 0
ds_read_b128 v[176:179], v248 offset:30720
v_cvt_pkrtz_f16_f32 v155, v154, v155
v_and_b32_e64 v155, s49, v155
v_bfe_u32 v154, v155, 2, 14
v_lshrrev_b32 v155, 18, v155
v_exp_f16_sdwa v159, v159 dst_sel:WORD_1 dst_unused:UNUSED_PRESERVE src0_sel:WORD_1
s_waitcnt lgkmcnt(8)
v_mfma_f32_16x16x32_f16 v[84:87], v[180:183], v[196:199], v[140:143]
ds_read_u16 v154, v154
ds_read_u16_d16_hi v155, v155
v_mfma_f32_16x16x32_bf16 v[164:167], v[184:187], v[56:59], v[164:167]
v_pk_add_f16 v157, v157, 1.0 op_sel_hi:[1,0]
v_pk_add_f16 v159, v159, 1.0 op_sel_hi:[1,0]
v_mfma_f32_16x16x32_f16 v[140:143], v[180:183], v[192:195], v[140:143]
ds_read_b128 v[180:183], v251 offset:14336
s_setprio 3
v_rcp_f16_sdwa v157, v157 dst_sel:WORD_0 dst_unused:UNUSED_PRESERVE src0_sel:WORD_0
v_mfma_f32_16x16x32_bf16 v[172:175], v[184:187], v[60:63], v[172:175]
ds_read_b128 v[184:187], v248 offset:32768
v_rcp_f16_sdwa v159, v159 dst_sel:WORD_0 dst_unused:UNUSED_PRESERVE src0_sel:WORD_0
s_waitcnt lgkmcnt(9)
v_mfma_f32_16x16x32_f16 v[88:91], v[188:191], v[196:199], v[240:243]
v_rcp_f16_sdwa v157, v157 dst_sel:WORD_1 dst_unused:UNUSED_PRESERVE src0_sel:WORD_1
v_mfma_f32_16x16x32_bf16 v[164:167], v[120:123], v[64:67], v[164:167]
v_rcp_f16_sdwa v159, v159 dst_sel:WORD_1 dst_unused:UNUSED_PRESERVE src0_sel:WORD_1
v_mfma_f32_16x16x32_f16 v[240:243], v[188:191], v[192:195], v[240:243]
ds_read_b128 v[188:191], v251 offset:17408
v_or_b32_e64 v224, v144, v145
v_mfma_f32_16x16x32_bf16 v[172:175], v[120:123], v[68:71], v[172:175]
ds_read_b128 v[120:123], v248 offset:34816
v_pk_mul_f16 v230, v156, v157
s_waitcnt lgkmcnt(7)
v_mfma_f32_16x16x32_f16 v[92:95], v[124:127], v[196:199], v[244:247]
v_pk_mul_f16 v231, v158, v159
v_or_b32 v225, v146, v147
v_mfma_f32_16x16x32_f16 v[244:247], v[124:127], v[192:195], v[244:247]
ds_read_b128 v[124:127], v251 offset:15360
v_cvt_pkrtz_f16_f32 v161, v160, v161
s_waitcnt lgkmcnt(7)
v_mfma_f32_16x16x32_bf16 v[0:3], v[176:179], v[48:51], 0
v_and_b32 v161, s49, v161
v_bfe_u32 v160, v161, 2, 14
v_mfma_f32_16x16x32_bf16 v[8:11], v[176:179], v[52:55], 0
ds_read_b128 v[176:179], v251 offset:18432
v_lshrrev_b32_e64 v161, 18, v161
v_cvt_pk_f16_f32 v172, v172, v173
v_cvt_pk_f16_f32 v174, v174, v175
v_pk_fma_f16 v173, v172, v172, s48
v_or_b32 v226, v148, v149
s_waitcnt lgkmcnt(5)
v_mfma_f32_16x16x32_f16 v[72:75], v[180:183], v[28:31], v[72:75]
ds_read_u16 v160, v160
ds_read_u16_d16_hi v161, v161
v_mfma_f32_16x16x32_f16 v[128:131], v[180:183], v[24:27], v[128:131]
ds_read_b128 v[180:183], v248 offset:30976
v_cvt_pkrtz_f16_f32 v163, v162, v163
s_waitcnt lgkmcnt(7)
v_mfma_f32_16x16x32_bf16 v[0:3], v[184:187], v[56:59], v[0:3]
v_and_b32 v163, s49, v163
v_bfe_u32 v162, v163, 2, 14
s_waitcnt lgkmcnt(6)
v_mfma_f32_16x16x32_f16 v[76:79], v[188:191], v[28:31], v[76:79]
s_setprio 2
v_lshrrev_b32_e64 v163, 18, v163
v_pk_fma_f16 v175, v174, v174, s48
v_mfma_f32_16x16x32_bf16 v[8:11], v[184:187], v[60:63], v[8:11]
ds_read_u16 v162, v162
ds_read_u16_d16_hi v163, v163
ds_read_b128 v[184:187], v251 offset:16384
v_mfma_f32_16x16x32_f16 v[132:135], v[188:191], v[24:27], v[132:135]
ds_read_b128 v[188:191], v248 offset:33024
v_pk_mul_f16 v173, v172, v173
v_or_b32 v227, v150, v151
s_waitcnt lgkmcnt(8)
v_mfma_f32_16x16x32_bf16 v[0:3], v[120:123], v[64:67], v[0:3]
v_cvt_pkrtz_f16_f32 v165, v164, v165
v_and_b32_e64 v165, s49, v165
v_bfe_u32 v164, v165, 2, 14
v_lshrrev_b32_e64 v165, 18, v165
v_mfma_f32_16x16x32_f16 v[80:83], v[124:127], v[28:31], v[80:83]
ds_read_u16 v164, v164
ds_read_u16_d16_hi v165, v165
v_pk_mul_f16 v175, v174, v175
v_exp_f16_sdwa v173, v173 dst_sel:WORD_0 dst_unused:UNUSED_PRESERVE src0_sel:WORD_0
v_mfma_f32_16x16x32_f16 v[136:139], v[124:127], v[24:27], v[136:139]
ds_read_b128 v[124:127], v248 offset:35072
v_or_b32_e64 v228, v152, v153
v_mfma_f32_16x16x32_bf16 v[8:11], v[120:123], v[68:71], v[8:11]
ds_read_b128 v[120:123], v251 offset:19456
v_cvt_pkrtz_f16_f32 v167, v166, v167
v_and_b32_e64 v167, s49, v167
v_bfe_u32 v166, v167, 2, 14
v_lshrrev_b32 v167, 18, v167
v_exp_f16_sdwa v175, v175 dst_sel:WORD_0 dst_unused:UNUSED_PRESERVE src0_sel:WORD_0
s_waitcnt lgkmcnt(8)
v_mfma_f32_16x16x32_f16 v[84:87], v[176:179], v[28:31], v[84:87]
ds_read_u16 v166, v166
ds_read_u16_d16_hi v167, v167
v_mfma_f32_16x16x32_bf16 v[4:7], v[180:183], v[48:51], 0
v_or_b32_e64 v229, v154, v155
v_cvt_pkrtz_f16_f32 v169, v168, v169
v_and_b32_e64 v169, s49, v169
v_bfe_u32 v168, v169, 2, 14
v_lshrrev_b32_e64 v169, 18, v169
v_exp_f16_sdwa v173, v173 dst_sel:WORD_1 dst_unused:UNUSED_PRESERVE src0_sel:WORD_1
v_mfma_f32_16x16x32_f16 v[140:143], v[176:179], v[24:27], v[140:143]
ds_read_u16 v168, v168
ds_read_u16_d16_hi v169, v169
ds_read_b128 v[176:179], v251 offset:20480
v_mfma_f32_16x16x32_bf16 v[12:15], v[180:183], v[52:55], 0
ds_read_b128 v[180:183], v249
v_cvt_pkrtz_f16_f32 v171, v170, v171
v_and_b32_e64 v171, s49, v171
v_bfe_u32 v170, v171, 2, 14
v_lshrrev_b32 v171, 18, v171
v_exp_f16_sdwa v175, v175 dst_sel:WORD_1 dst_unused:UNUSED_PRESERVE src0_sel:WORD_1
s_waitcnt lgkmcnt(9)
v_mfma_f32_16x16x32_f16 v[88:91], v[184:187], v[28:31], v[88:91]
ds_read_u16 v170, v170
ds_read_u16_d16_hi v171, v171
v_mfma_f32_16x16x32_bf16 v[4:7], v[188:191], v[56:59], v[4:7]
v_pk_add_f16 v173, v173, 1.0 op_sel_hi:[1,0]
v_pk_add_f16 v175, v175, 1.0 op_sel_hi:[1,0]
v_mfma_f32_16x16x32_f16 v[240:243], v[184:187], v[24:27], v[240:243]
ds_read_b128 v[184:187], v251 offset:23552
s_setprio 1
v_rcp_f16_sdwa v173, v173 dst_sel:WORD_0 dst_unused:UNUSED_PRESERVE src0_sel:WORD_0
v_mfma_f32_16x16x32_bf16 v[12:15], v[188:191], v[60:63], v[12:15]
ds_read_b128 v[188:191], v249 offset:2048
v_rcp_f16_sdwa v175, v175 dst_sel:WORD_0 dst_unused:UNUSED_PRESERVE src0_sel:WORD_0
s_waitcnt lgkmcnt(10)
v_mfma_f32_16x16x32_f16 v[92:95], v[120:123], v[28:31], v[92:95]
v_rcp_f16_sdwa v173, v173 dst_sel:WORD_1 dst_unused:UNUSED_PRESERVE src0_sel:WORD_1
v_mfma_f32_16x16x32_bf16 v[4:7], v[124:127], v[64:67], v[4:7]
v_rcp_f16_sdwa v175, v175 dst_sel:WORD_1 dst_unused:UNUSED_PRESERVE src0_sel:WORD_1
v_mfma_f32_16x16x32_f16 v[244:247], v[120:123], v[24:27], v[244:247]
ds_read_b128 v[120:123], v251 offset:21504
buffer_store_dwordx4 v[112:115], v253, s[8:11], s69 offen offset:128 sc1
buffer_store_dwordx4 v[116:119], v253, s[8:11], s69 offen offset:192 sc1
v_mfma_f32_16x16x32_bf16 v[12:15], v[124:127], v[68:71], v[12:15]
ds_read_b128 v[124:127], v251 offset:24576
v_or_b32_e64 v104, v160, v161
v_pk_mul_f16 v110, v172, v173
v_pk_mul_f16 v111, v174, v175
v_or_b32 v105, v162, v163
v_cvt_pkrtz_f16_f32 v1, v0, v1
s_waitcnt lgkmcnt(7)
v_mfma_f32_16x16x32_f16 v[72:75], v[176:179], v[36:39], v[72:75]
v_and_b32_e64 v1, s49, v1
v_bfe_u32 v0, v1, 2, 14
v_mfma_f32_16x16x32_f16 v[128:131], v[176:179], v[32:35], v[128:131]
ds_read_b128 v[176:179], v249 offset:4096
v_lshrrev_b32 v1, 18, v1
s_waitcnt lgkmcnt(7)
v_mfma_f32_16x16x32_bf16 v[144:147], v[180:183], v[48:51], 0
ds_read_u16 v0, v0
ds_read_u16_d16_hi v1, v1
v_mfma_f32_16x16x32_bf16 v[152:155], v[180:183], v[52:55], 0
ds_read_b128 v[180:183], v251 offset:22528
v_cvt_pk_f16_f32 v12, v12, v13
v_cvt_pk_f16_f32 v14, v14, v15
v_pk_fma_f16 v13, v12, v12, s48
v_or_b32_e64 v106, v164, v165
v_cvt_pkrtz_f16_f32 v3, v2, v3
v_and_b32 v3, s49, v3
v_bfe_u32 v2, v3, 2, 14
s_waitcnt lgkmcnt(7)
v_mfma_f32_16x16x32_f16 v[76:79], v[184:187], v[36:39], v[76:79]
v_lshrrev_b32_e64 v3, 18, v3
v_pk_fma_f16 v15, v14, v14, s48
v_mfma_f32_16x16x32_f16 v[132:135], v[184:187], v[32:35], v[132:135]
ds_read_b128 v[184:187], v249 offset:256
ds_read_u16 v2, v2
s_waitcnt lgkmcnt(8)
v_mfma_f32_16x16x32_bf16 v[144:147], v[188:191], v[56:59], v[144:147]
s_setprio 0
ds_read_u16_d16_hi v3, v3
v_pk_mul_f16 v13, v12, v13
s_waitcnt lgkmcnt(8)
v_mfma_f32_16x16x32_f16 v[80:83], v[120:123], v[36:39], v[80:83]
v_or_b32 v107, v166, v167
v_cvt_pkrtz_f16_f32 v5, v4, v5
v_mfma_f32_16x16x32_bf16 v[152:155], v[188:191], v[60:63], v[152:155]
ds_read_b128 v[188:191], v251 offset:25600
v_and_b32_e64 v5, s49, v5
v_mfma_f32_16x16x32_f16 v[136:139], v[120:123], v[32:35], v[136:139]
ds_read_b128 v[120:123], v249 offset:2304
v_bfe_u32 v4, v5, 2, 14
s_waitcnt lgkmcnt(9)
v_mfma_f32_16x16x32_f16 v[84:87], v[124:127], v[36:39], v[84:87]
v_lshrrev_b32_e64 v5, 18, v5
v_pk_mul_f16 v15, v14, v15
s_waitcnt lgkmcnt(8)
v_mfma_f32_16x16x32_bf16 v[144:147], v[176:179], v[64:67], v[144:147]
ds_read_u16 v4, v4
ds_read_u16_d16_hi v5, v5
v_exp_f16_sdwa v13, v13 dst_sel:WORD_0 dst_unused:UNUSED_PRESERVE src0_sel:WORD_0
v_mfma_f32_16x16x32_f16 v[140:143], v[124:127], v[32:35], v[140:143]
ds_read_b128 v[124:127], v251 offset:26624
v_or_b32_e64 v108, v168, v169
v_mfma_f32_16x16x32_bf16 v[152:155], v[176:179], v[68:71], v[152:155]
ds_read_b128 v[176:179], v249 offset:4352
v_cvt_pkrtz_f16_f32 v7, v6, v7
v_and_b32_e64 v7, s49, v7
v_bfe_u32 v6, v7, 2, 14
v_lshrrev_b32 v7, 18, v7
v_exp_f16_sdwa v15, v15 dst_sel:WORD_0 dst_unused:UNUSED_PRESERVE src0_sel:WORD_0
s_waitcnt lgkmcnt(8)
v_mfma_f32_16x16x32_f16 v[88:91], v[180:183], v[36:39], v[88:91]
ds_read_u16 v6, v6
ds_read_u16_d16_hi v7, v7
v_mfma_f32_16x16x32_bf16 v[148:151], v[184:187], v[48:51], 0
v_or_b32_e64 v109, v170, v171
v_cvt_pkrtz_f16_f32 v9, v8, v9
v_and_b32_e64 v9, s49, v9
v_bfe_u32 v8, v9, 2, 14
v_lshrrev_b32_e64 v9, 18, v9
v_exp_f16_sdwa v13, v13 dst_sel:WORD_1 dst_unused:UNUSED_PRESERVE src0_sel:WORD_1
v_mfma_f32_16x16x32_f16 v[240:243], v[180:183], v[32:35], v[240:243]
ds_read_u16 v8, v8
ds_read_u16_d16_hi v9, v9
ds_read_b128 v[180:183], v251 offset:29696
v_mfma_f32_16x16x32_bf16 v[156:159], v[184:187], v[52:55], 0
ds_read_b128 v[184:187], v249 offset:6144
v_cvt_pkrtz_f16_f32 v11, v10, v11
v_and_b32_e64 v11, s49, v11
v_bfe_u32 v10, v11, 2, 14
v_lshrrev_b32_e64 v11, 18, v11
v_exp_f16_sdwa v15, v15 dst_sel:WORD_1 dst_unused:UNUSED_PRESERVE src0_sel:WORD_1
s_waitcnt lgkmcnt(10)
v_mfma_f32_16x16x32_f16 v[92:95], v[188:191], v[36:39], v[92:95]
ds_read_u16 v10, v10
ds_read_u16_d16_hi v11, v11
v_mfma_f32_16x16x32_bf16 v[148:151], v[120:123], v[56:59], v[148:151]
s_setprio 3
v_pk_add_f16 v13, v13, 1.0 op_sel_hi:[1,0]
v_pk_add_f16 v15, v15, 1.0 op_sel_hi:[1,0]
v_mfma_f32_16x16x32_f16 v[244:247], v[188:191], v[32:35], v[244:247]
ds_read_b128 v[188:191], v251 offset:27648
v_rcp_f16_sdwa v13, v13 dst_sel:WORD_0 dst_unused:UNUSED_PRESERVE src0_sel:WORD_0
v_mfma_f32_16x16x32_bf16 v[156:159], v[120:123], v[60:63], v[156:159]
ds_read_b128 v[120:123], v249 offset:8192
v_rcp_f16_sdwa v15, v15 dst_sel:WORD_0 dst_unused:UNUSED_PRESERVE src0_sel:WORD_0
s_waitcnt lgkmcnt(11)
v_mfma_f32_16x16x32_f16 v[72:75], v[124:127], v[228:231], v[72:75]
v_rcp_f16_sdwa v13, v13 dst_sel:WORD_1 dst_unused:UNUSED_PRESERVE src0_sel:WORD_1
v_mfma_f32_16x16x32_f16 v[128:131], v[124:127], v[224:227], v[128:131]
ds_read_b128 v[124:127], v251 offset:30720
v_rcp_f16_sdwa v15, v15 dst_sel:WORD_1 dst_unused:UNUSED_PRESERVE src0_sel:WORD_1
s_waitcnt lgkmcnt(10)
v_mfma_f32_16x16x32_bf16 v[148:151], v[176:179], v[64:67], v[148:151]
buffer_load_dwordx4 v[232:235], v253, s[4:7], s68 offen
buffer_load_dwordx4 v[236:239], v253, s[4:7], s68 offen offset:64
v_or_b32_e64 v200, v0, v1
v_mfma_f32_16x16x32_bf16 v[156:159], v[176:179], v[68:71], v[156:159]
ds_read_b128 v[176:179], v251 offset:28672
v_pk_mul_f16 v206, v12, v13
v_pk_mul_f16 v207, v14, v15
v_or_b32_e64 v201, v2, v3
v_cvt_pkrtz_f16_f32 v145, v144, v145
v_and_b32_e64 v145, s49, v145
v_bfe_u32 v144, v145, 2, 14
v_lshrrev_b32 v145, 18, v145
v_or_b32 v202, v4, v5
v_cvt_pk_f16_f32 v156, v156, v157
s_waitcnt lgkmcnt(7)
v_mfma_f32_16x16x32_f16 v[76:79], v[180:183], v[228:231], v[76:79]
ds_read_u16 v144, v144
ds_read_u16_d16_hi v145, v145
v_mfma_f32_16x16x32_f16 v[132:135], v[180:183], v[224:227], v[132:135]
ds_read_b128 v[180:183], v249 offset:10240
v_cvt_pk_f16_f32 v158, v158, v159
s_waitcnt lgkmcnt(9)
v_mfma_f32_16x16x32_bf16 v[160:163], v[184:187], v[48:51], 0
v_pk_fma_f16 v157, v156, v156, s48
v_cvt_pkrtz_f16_f32 v147, v146, v147
v_mfma_f32_16x16x32_bf16 v[168:171], v[184:187], v[52:55], 0
ds_read_b128 v[184:187], v251 offset:31744
v_and_b32_e64 v147, s49, v147
v_bfe_u32 v146, v147, 2, 14
v_lshrrev_b32_e64 v147, 18, v147
v_pk_fma_f16 v159, v158, v158, s48
v_pk_mul_f16 v157, v156, v157
v_or_b32 v203, v6, v7
v_cvt_pkrtz_f16_f32 v149, v148, v149
s_waitcnt lgkmcnt(7)
v_mfma_f32_16x16x32_f16 v[80:83], v[188:191], v[228:231], v[80:83]
ds_read_u16 v146, v146
ds_read_u16_d16_hi v147, v147
v_mfma_f32_16x16x32_f16 v[136:139], v[188:191], v[224:227], v[136:139]
ds_read_b128 v[188:191], v249 offset:6400
v_and_b32_e64 v149, s49, v149
s_waitcnt lgkmcnt(9)
v_mfma_f32_16x16x32_bf16 v[160:163], v[120:123], v[56:59], v[160:163]
s_setprio 2
v_bfe_u32 v148, v149, 2, 14
v_lshrrev_b32 v149, 18, v149
s_waitcnt lgkmcnt(8)
v_mfma_f32_16x16x32_f16 v[84:87], v[124:127], v[228:231], v[84:87]
ds_read_u16 v148, v148
ds_read_u16_d16_hi v149, v149
v_mfma_f32_16x16x32_bf16 v[168:171], v[120:123], v[60:63], v[168:171]
ds_read_b128 v[120:123], v251 offset:32768
v_pk_mul_f16 v159, v158, v159
v_mfma_f32_16x16x32_f16 v[140:143], v[124:127], v[224:227], v[140:143]
ds_read_b128 v[124:127], v249 offset:8448
v_exp_f16_sdwa v157, v157 dst_sel:WORD_0 dst_unused:UNUSED_PRESERVE src0_sel:WORD_0
s_waitcnt lgkmcnt(11)
v_mfma_f32_16x16x32_f16 v[88:91], v[176:179], v[228:231], v[88:91]
v_or_b32 v204, v8, v9
v_cvt_pkrtz_f16_f32 v151, v150, v151
v_mfma_f32_16x16x32_f16 v[240:243], v[176:179], v[224:227], v[240:243]
ds_read_b128 v[176:179], v251 offset:35840
v_and_b32 v151, s49, v151
s_waitcnt lgkmcnt(9)
v_mfma_f32_16x16x32_bf16 v[160:163], v[180:183], v[64:67], v[160:163]
v_bfe_u32 v150, v151, 2, 14
v_lshrrev_b32_e64 v151, 18, v151
v_mfma_f32_16x16x32_bf16 v[168:171], v[180:183], v[68:71], v[168:171]
ds_read_b128 v[180:183], v249 offset:10496
ds_read_u16 v150, v150
ds_read_u16_d16_hi v151, v151
v_exp_f16_sdwa v159, v159 dst_sel:WORD_0 dst_unused:UNUSED_PRESERVE src0_sel:WORD_0
s_waitcnt lgkmcnt(11)
v_mfma_f32_16x16x32_f16 v[92:95], v[184:187], v[228:231], v[92:95]
buffer_store_dwordx4 v[16:19], v253, s[8:11], s69 offen offset:256 sc1
buffer_store_dwordx4 v[20:23], v253, s[8:11], s69 offen offset:320 sc1
v_or_b32 v205, v10, v11
v_cvt_pkrtz_f16_f32 v153, v152, v153
v_and_b32_e64 v153, s49, v153
v_bfe_u32 v152, v153, 2, 14
v_lshrrev_b32 v153, 18, v153
v_exp_f16_sdwa v157, v157 dst_sel:WORD_1 dst_unused:UNUSED_PRESERVE src0_sel:WORD_1
s_waitcnt lgkmcnt(8)
v_mfma_f32_16x16x32_bf16 v[164:167], v[188:191], v[48:51], 0
ds_read_u16 v152, v152
ds_read_u16_d16_hi v153, v153
v_mfma_f32_16x16x32_f16 v[244:247], v[184:187], v[224:227], v[244:247]
ds_read_b128 v[184:187], v251 offset:33792
v_cvt_pkrtz_f16_f32 v155, v154, v155
v_mfma_f32_16x16x32_bf16 v[172:175], v[188:191], v[52:55], 0
ds_read_b128 v[188:191], v249 offset:12288
v_and_b32_e64 v155, s49, v155
v_bfe_u32 v154, v155, 2, 14
v_lshrrev_b32 v155, 18, v155
v_exp_f16_sdwa v159, v159 dst_sel:WORD_1 dst_unused:UNUSED_PRESERVE src0_sel:WORD_1
v_pk_add_f16 v157, v157, 1.0 op_sel_hi:[1,0]
v_pk_add_f16 v159, v159, 1.0 op_sel_hi:[1,0]
s_waitcnt lgkmcnt(9)
v_mfma_f32_16x16x32_f16 v[72:75], v[120:123], v[108:111], v[72:75]
ds_read_u16 v154, v154
ds_read_u16_d16_hi v155, v155
v_mfma_f32_16x16x32_f16 v[128:131], v[120:123], v[104:107], v[128:131]
s_setprio 1
ds_read_b128 v[120:123], v251 offset:36864
v_rcp_f16_sdwa v157, v157 dst_sel:WORD_0 dst_unused:UNUSED_PRESERVE src0_sel:WORD_0
s_waitcnt lgkmcnt(11)
v_mfma_f32_16x16x32_bf16 v[164:167], v[124:127], v[56:59], v[164:167]
v_rcp_f16_sdwa v159, v159 dst_sel:WORD_0 dst_unused:UNUSED_PRESERVE src0_sel:WORD_0
v_mfma_f32_16x16x32_bf16 v[172:175], v[124:127], v[60:63], v[172:175]
ds_read_b128 v[124:127], v249 offset:14336
buffer_load_dwordx4 v[208:211], v253, s[4:7], s68 offen offset:128
buffer_load_dwordx4 v[212:215], v253, s[4:7], s68 offen offset:192
s_waitcnt lgkmcnt(11)
v_mfma_f32_16x16x32_f16 v[76:79], v[176:179], v[108:111], v[76:79]
v_rcp_f16_sdwa v157, v157 dst_sel:WORD_1 dst_unused:UNUSED_PRESERVE src0_sel:WORD_1
v_mfma_f32_16x16x32_f16 v[132:135], v[176:179], v[104:107], v[132:135]
ds_read_b128 v[176:179], v251 offset:34816
v_rcp_f16_sdwa v159, v159 dst_sel:WORD_1 dst_unused:UNUSED_PRESERVE src0_sel:WORD_1
s_waitcnt lgkmcnt(11)
v_mfma_f32_16x16x32_bf16 v[164:167], v[180:183], v[64:67], v[164:167]
v_or_b32_e64 v216, v144, v145
v_pk_mul_f16 v222, v156, v157
v_mfma_f32_16x16x32_bf16 v[172:175], v[180:183], v[68:71], v[172:175]
ds_read_b128 v[180:183], v251 offset:37888
v_pk_mul_f16 v223, v158, v159
v_or_b32_e64 v217, v146, v147
v_cvt_pkrtz_f16_f32 v161, v160, v161
v_and_b32_e64 v161, s49, v161
v_bfe_u32 v160, v161, 2, 14
v_lshrrev_b32_e64 v161, 18, v161
v_or_b32 v218, v148, v149
v_cvt_pkrtz_f16_f32 v163, v162, v163
v_cvt_pk_f16_f32 v172, v172, v173
v_cvt_pk_f16_f32 v174, v174, v175
v_pk_fma_f16 v173, v172, v172, s48
s_waitcnt lgkmcnt(7)
v_mfma_f32_16x16x32_f16 v[80:83], v[184:187], v[108:111], v[80:83]
ds_read_u16 v160, v160
ds_read_u16_d16_hi v161, v161
v_mfma_f32_16x16x32_f16 v[136:139], v[184:187], v[104:107], v[136:139]
ds_read_b128 v[184:187], v249 offset:16384
v_and_b32 v163, s49, v163
s_waitcnt lgkmcnt(9)
v_mfma_f32_16x16x32_bf16 v[0:3], v[188:191], v[48:51], 0
v_bfe_u32 v162, v163, 2, 14
v_lshrrev_b32_e64 v163, 18, v163
v_mfma_f32_16x16x32_bf16 v[8:11], v[188:191], v[52:55], 0
ds_read_b128 v[188:191], v251 offset:38912
ds_read_u16 v162, v162
ds_read_u16_d16_hi v163, v163
v_pk_fma_f16 v175, v174, v174, s48
v_pk_mul_f16 v173, v172, v173
v_or_b32_e64 v219, v150, v151
v_cvt_pkrtz_f16_f32 v165, v164, v165
v_and_b32 v165, s49, v165
v_bfe_u32 v164, v165, 2, 14
s_waitcnt lgkmcnt(9)
v_mfma_f32_16x16x32_f16 v[84:87], v[120:123], v[108:111], v[84:87]
v_lshrrev_b32_e64 v165, 18, v165
v_pk_mul_f16 v175, v174, v175
v_mfma_f32_16x16x32_f16 v[140:143], v[120:123], v[104:107], v[140:143]
ds_read_b128 v[120:123], v249 offset:12544
ds_read_u16 v164, v164
s_waitcnt lgkmcnt(10)
v_mfma_f32_16x16x32_bf16 v[0:3], v[124:127], v[56:59], v[0:3]
s_setprio 0
ds_read_u16_d16_hi v165, v165
v_exp_f16_sdwa v173, v173 dst_sel:WORD_0 dst_unused:UNUSED_PRESERVE src0_sel:WORD_0
s_waitcnt lgkmcnt(10)
v_mfma_f32_16x16x32_f16 v[88:91], v[176:179], v[108:111], v[88:91]
v_or_b32 v220, v152, v153
v_cvt_pkrtz_f16_f32 v167, v166, v167
v_mfma_f32_16x16x32_bf16 v[8:11], v[124:127], v[60:63], v[8:11]
ds_read_b128 v[124:127], v251 offset:41984
v_and_b32_e64 v167, s49, v167
v_mfma_f32_16x16x32_f16 v[240:243], v[176:179], v[104:107], v[240:243]
ds_read_b128 v[176:179], v249 offset:14592
v_bfe_u32 v166, v167, 2, 14
s_waitcnt lgkmcnt(11)
v_mfma_f32_16x16x32_f16 v[92:95], v[180:183], v[108:111], v[92:95]
v_lshrrev_b32 v167, 18, v167
v_exp_f16_sdwa v175, v175 dst_sel:WORD_0 dst_unused:UNUSED_PRESERVE src0_sel:WORD_0
v_mfma_f32_16x16x32_f16 v[244:247], v[180:183], v[104:107], v[244:247]
ds_read_b128 v[180:183], v251 offset:39936
ds_read_u16 v166, v166
s_waitcnt lgkmcnt(10)
v_mfma_f32_16x16x32_bf16 v[0:3], v[184:187], v[64:67], v[0:3]
ds_read_u16_d16_hi v167, v167
v_or_b32 v221, v154, v155
v_mfma_f32_16x16x32_bf16 v[8:11], v[184:187], v[68:71], v[8:11]
ds_read_b128 v[184:187], v249 offset:16640
v_cvt_pkrtz_f16_f32 v169, v168, v169
s_waitcnt lgkmcnt(11)
v_mfma_f32_16x16x32_f16 v[72:75], v[188:191], v[204:207], v[72:75]
v_and_b32 v169, s49, v169
v_bfe_u32 v168, v169, 2, 14
v_lshrrev_b32_e64 v169, 18, v169
v_exp_f16_sdwa v173, v173 dst_sel:WORD_1 dst_unused:UNUSED_PRESERVE src0_sel:WORD_1
v_mfma_f32_16x16x32_f16 v[128:131], v[188:191], v[200:203], v[128:131]
ds_read_u16 v168, v168
ds_read_u16_d16_hi v169, v169
ds_read_b128 v[188:191], v251 offset:43008
s_waitcnt lgkmcnt(11)
v_mfma_f32_16x16x32_bf16 v[4:7], v[120:123], v[48:51], 0
v_cvt_pkrtz_f16_f32 v171, v170, v171
v_and_b32 v171, s49, v171
v_mfma_f32_16x16x32_bf16 v[12:15], v[120:123], v[52:55], 0
ds_read_b128 v[120:123], v249 offset:18432
v_bfe_u32 v170, v171, 2, 14
v_lshrrev_b32_e64 v171, 18, v171
v_exp_f16_sdwa v175, v175 dst_sel:WORD_1 dst_unused:UNUSED_PRESERVE src0_sel:WORD_1
v_pk_add_f16 v173, v173, 1.0 op_sel_hi:[1,0]
v_pk_add_f16 v175, v175, 1.0 op_sel_hi:[1,0]
v_rcp_f16_sdwa v173, v173 dst_sel:WORD_0 dst_unused:UNUSED_PRESERVE src0_sel:WORD_0
v_rcp_f16_sdwa v175, v175 dst_sel:WORD_0 dst_unused:UNUSED_PRESERVE src0_sel:WORD_0
v_rcp_f16_sdwa v173, v173 dst_sel:WORD_1 dst_unused:UNUSED_PRESERVE src0_sel:WORD_1
ds_read_u16 v170, v170
ds_read_u16_d16_hi v171, v171
buffer_load_dwordx4 v[96:99], v253, s[4:7], s68 offen offset:256
buffer_load_dwordx4 v[100:103], v253, s[4:7], s68 offen offset:320
s_waitcnt lgkmcnt(11)
v_mfma_f32_16x16x32_f16 v[76:79], v[124:127], v[204:207], v[76:79]
s_setprio 3
v_rcp_f16_sdwa v175, v175 dst_sel:WORD_1 dst_unused:UNUSED_PRESERVE src0_sel:WORD_1
s_waitcnt lgkmcnt(10)
v_mfma_f32_16x16x32_bf16 v[4:7], v[176:179], v[56:59], v[4:7]
v_or_b32 v40, v160, v161
v_pk_mul_f16 v46, v172, v173
v_mfma_f32_16x16x32_f16 v[132:135], v[124:127], v[200:203], v[132:135]
ds_read_b128 v[124:127], v251 offset:40960
v_pk_mul_f16 v47, v174, v175
v_mfma_f32_16x16x32_bf16 v[12:15], v[176:179], v[60:63], v[12:15]
ds_read_b128 v[176:179], v249 offset:20480
v_or_b32 v41, v162, v163
s_waitcnt lgkmcnt(11)
v_mfma_f32_16x16x32_f16 v[80:83], v[180:183], v[204:207], v[80:83]
v_cvt_pkrtz_f16_f32 v1, v0, v1
v_and_b32_e64 v1, s49, v1
v_mfma_f32_16x16x32_f16 v[136:139], v[180:183], v[200:203], v[136:139]
ds_read_b128 v[180:183], v251 offset:44032
v_bfe_u32 v0, v1, 2, 14
s_waitcnt lgkmcnt(9)
v_mfma_f32_16x16x32_bf16 v[4:7], v[184:187], v[64:67], v[4:7]
v_lshrrev_b32 v1, 18, v1
v_or_b32_e64 v42, v164, v165
v_mfma_f32_16x16x32_bf16 v[12:15], v[184:187], v[68:71], v[12:15]
ds_read_b128 v[184:187], v251 offset:45056
ds_read_u16 v0, v0
ds_read_u16_d16_hi v1, v1
v_cvt_pkrtz_f16_f32 v3, v2, v3
v_and_b32_e64 v3, s49, v3
v_bfe_u32 v2, v3, 2, 14
v_lshrrev_b32 v3, 18, v3
v_or_b32 v43, v166, v167
v_cvt_pkrtz_f16_f32 v5, v4, v5
v_cvt_pk_f16_f32 v12, v12, v13
v_cvt_pk_f16_f32 v14, v14, v15
s_waitcnt lgkmcnt(9)
v_mfma_f32_16x16x32_f16 v[84:87], v[188:191], v[204:207], v[84:87]
v_pk_fma_f16 v13, v12, v12, s48
v_pk_fma_f16 v15, v14, v14, s48
v_mfma_f32_16x16x32_f16 v[140:143], v[188:191], v[200:203], v[140:143]
ds_read_b128 v[188:191], v249 offset:22528
ds_read_u16 v2, v2
s_waitcnt lgkmcnt(10)
v_mfma_f32_16x16x32_bf16 v[144:147], v[120:123], v[48:51], 0
ds_read_u16_d16_hi v3, v3
v_pk_mul_f16 v13, v12, v13
v_mfma_f32_16x16x32_bf16 v[152:155], v[120:123], v[52:55], 0
ds_read_b128 v[120:123], v251 offset:48128
v_and_b32_e64 v5, s49, v5
v_bfe_u32 v4, v5, 2, 14
v_lshrrev_b32_e64 v5, 18, v5
v_pk_mul_f16 v15, v14, v15
v_exp_f16_sdwa v13, v13 dst_sel:WORD_0 dst_unused:UNUSED_PRESERVE src0_sel:WORD_0
v_or_b32 v44, v168, v169
s_waitcnt lgkmcnt(9)
v_mfma_f32_16x16x32_f16 v[88:91], v[124:127], v[204:207], v[88:91]
ds_read_u16 v4, v4
ds_read_u16_d16_hi v5, v5
v_mfma_f32_16x16x32_f16 v[240:243], v[124:127], v[200:203], v[240:243]
ds_read_b128 v[124:127], v249 offset:18688
s_setprio 2
v_cvt_pkrtz_f16_f32 v7, v6, v7
s_waitcnt lgkmcnt(11)
v_mfma_f32_16x16x32_bf16 v[144:147], v[176:179], v[56:59], v[144:147]
v_and_b32 v7, s49, v7
v_bfe_u32 v6, v7, 2, 14
s_waitcnt lgkmcnt(10)
v_mfma_f32_16x16x32_f16 v[92:95], v[180:183], v[204:207], v[92:95]
v_lshrrev_b32_e64 v7, 18, v7
v_exp_f16_sdwa v15, v15 dst_sel:WORD_0 dst_unused:UNUSED_PRESERVE src0_sel:WORD_0
v_mfma_f32_16x16x32_bf16 v[152:155], v[176:179], v[60:63], v[152:155]
ds_read_b128 v[176:179], v251 offset:46080
ds_read_u16 v6, v6
v_mfma_f32_16x16x32_f16 v[244:247], v[180:183], v[200:203], v[244:247]
ds_read_b128 v[180:183], v249 offset:20736
ds_read_u16_d16_hi v7, v7
s_waitcnt lgkmcnt(13)
v_mfma_f32_16x16x32_f16 v[72:75], v[184:187], v[220:223], v[72:75]
v_or_b32 v45, v170, v171
v_cvt_pkrtz_f16_f32 v9, v8, v9
v_mfma_f32_16x16x32_f16 v[128:131], v[184:187], v[216:219], v[128:131]
ds_read_b128 v[184:187], v251 offset:49152
v_and_b32 v9, s49, v9
s_waitcnt lgkmcnt(11)
v_mfma_f32_16x16x32_bf16 v[144:147], v[188:191], v[64:67], v[144:147]
v_bfe_u32 v8, v9, 2, 14
v_lshrrev_b32_e64 v9, 18, v9
v_mfma_f32_16x16x32_bf16 v[152:155], v[188:191], v[68:71], v[152:155]
ds_read_b128 v[188:191], v249 offset:22784
ds_read_u16 v8, v8
ds_read_u16_d16_hi v9, v9
v_exp_f16_sdwa v13, v13 dst_sel:WORD_1 dst_unused:UNUSED_PRESERVE src0_sel:WORD_1
v_cvt_pkrtz_f16_f32 v11, v10, v11
v_and_b32_e64 v11, s49, v11
v_bfe_u32 v10, v11, 2, 14
v_lshrrev_b32 v11, 18, v11
v_exp_f16_sdwa v15, v15 dst_sel:WORD_1 dst_unused:UNUSED_PRESERVE src0_sel:WORD_1
s_waitcnt lgkmcnt(11)
v_mfma_f32_16x16x32_f16 v[76:79], v[120:123], v[220:223], v[76:79]
ds_read_u16 v10, v10
ds_read_u16_d16_hi v11, v11
v_mfma_f32_16x16x32_f16 v[132:135], v[120:123], v[216:219], v[132:135]
ds_read_b128 v[120:123], v251 offset:47104
v_pk_add_f16 v13, v13, 1.0 op_sel_hi:[1,0]
v_pk_add_f16 v15, v15, 1.0 op_sel_hi:[1,0]
v_rcp_f16_sdwa v13, v13 dst_sel:WORD_0 dst_unused:UNUSED_PRESERVE src0_sel:WORD_0
v_rcp_f16_sdwa v15, v15 dst_sel:WORD_0 dst_unused:UNUSED_PRESERVE src0_sel:WORD_0
v_rcp_f16_sdwa v13, v13 dst_sel:WORD_1 dst_unused:UNUSED_PRESERVE src0_sel:WORD_1
v_rcp_f16_sdwa v15, v15 dst_sel:WORD_1 dst_unused:UNUSED_PRESERVE src0_sel:WORD_1
v_or_b32 v192, v0, v1
s_waitcnt lgkmcnt(11)
v_mfma_f32_16x16x32_bf16 v[148:151], v[124:127], v[48:51], 0
v_pk_mul_f16 v198, v12, v13
v_pk_mul_f16 v199, v14, v15
v_mfma_f32_16x16x32_bf16 v[156:159], v[124:127], v[52:55], 0
ds_read_b128 v[124:127], v249 offset:24576
v_or_b32 v193, v2, v3
s_waitcnt lgkmcnt(11)
v_mfma_f32_16x16x32_f16 v[80:83], v[176:179], v[220:223], v[80:83]
s_setprio 1
v_cvt_pkrtz_f16_f32 v145, v144, v145
v_and_b32 v145, s49, v145
v_mfma_f32_16x16x32_f16 v[136:139], v[176:179], v[216:219], v[136:139]
ds_read_b128 v[176:179], v251 offset:50176
v_bfe_u32 v144, v145, 2, 14
s_waitcnt lgkmcnt(10)
v_mfma_f32_16x16x32_bf16 v[148:151], v[180:183], v[56:59], v[148:151]
v_lshrrev_b32 v145, 18, v145
v_or_b32_e64 v194, v4, v5
v_mfma_f32_16x16x32_bf16 v[156:159], v[180:183], v[60:63], v[156:159]
ds_read_b128 v[180:183], v249 offset:26624
ds_read_u16 v144, v144
ds_read_u16_d16_hi v145, v145
v_cvt_pkrtz_f16_f32 v147, v146, v147
s_waitcnt lgkmcnt(11)
v_mfma_f32_16x16x32_f16 v[84:87], v[184:187], v[220:223], v[84:87]
v_and_b32 v147, s49, v147
v_bfe_u32 v146, v147, 2, 14
v_mfma_f32_16x16x32_f16 v[140:143], v[184:187], v[216:219], v[140:143]
ds_read_b128 v[184:187], v251 offset:51200
v_lshrrev_b32 v147, 18, v147
s_waitcnt lgkmcnt(11)
v_mfma_f32_16x16x32_bf16 v[148:151], v[188:191], v[64:67], v[148:151]
ds_read_u16 v146, v146
ds_read_u16_d16_hi v147, v147
v_mfma_f32_16x16x32_bf16 v[156:159], v[188:191], v[68:71], v[156:159]
ds_read_b128 v[188:191], v251 offset:54272
v_or_b32_e64 v195, v6, v7
v_cvt_pkrtz_f16_f32 v153, v152, v153
v_and_b32_e64 v153, s49, v153
v_bfe_u32 v152, v153, 2, 14
v_cvt_pkrtz_f16_f32 v149, v148, v149
v_and_b32_e64 v149, s49, v149
v_bfe_u32 v148, v149, 2, 14
v_lshrrev_b32_e64 v149, 18, v149
v_cvt_pk_f16_f32 v156, v156, v157
v_cvt_pk_f16_f32 v158, v158, v159
v_pk_fma_f16 v157, v156, v156, s48
v_pk_fma_f16 v159, v158, v158, s48
v_pk_mul_f16 v157, v156, v157
v_pk_mul_f16 v159, v158, v159
v_exp_f16_sdwa v157, v157 dst_sel:WORD_0 dst_unused:UNUSED_PRESERVE src0_sel:WORD_0
s_waitcnt lgkmcnt(12)
v_or_b32 v196, v8, v9
v_cvt_pkrtz_f16_f32 v151, v150, v151
v_and_b32_e64 v151, s49, v151
v_bfe_u32 v150, v151, 2, 14
ds_read_u16 v148, v148
ds_read_u16_d16_hi v149, v149
s_waitcnt lgkmcnt(11)
v_mfma_f32_16x16x32_f16 v[88:91], v[120:123], v[220:223], v[88:91]
v_lshrrev_b32 v151, 18, v151
v_exp_f16_sdwa v159, v159 dst_sel:WORD_0 dst_unused:UNUSED_PRESERVE src0_sel:WORD_0
v_mfma_f32_16x16x32_f16 v[240:243], v[120:123], v[216:219], v[240:243]
ds_read_b128 v[120:123], v249 offset:28672
ds_read_u16 v150, v150
s_waitcnt lgkmcnt(12)
v_mfma_f32_16x16x32_bf16 v[160:163], v[124:127], v[48:51], 0
ds_read_u16_d16_hi v151, v151
v_or_b32 v197, v10, v11
s_waitcnt lgkmcnt(12)
v_mfma_f32_16x16x32_f16 v[92:95], v[176:179], v[220:223], v[92:95]
v_lshrrev_b32 v153, 18, v153
v_exp_f16_sdwa v157, v157 dst_sel:WORD_1 dst_unused:UNUSED_PRESERVE src0_sel:WORD_1
v_mfma_f32_16x16x32_bf16 v[168:171], v[124:127], v[52:55], 0
ds_read_b128 v[124:127], v251 offset:52224
ds_read_u16 v152, v152
v_mfma_f32_16x16x32_f16 v[244:247], v[176:179], v[216:219], v[244:247]
ds_read_b128 v[176:179], v249 offset:24832
s_setprio 0
s_waitcnt lgkmcnt(14)
ds_read_u16_d16_hi v153, v153
v_mfma_f32_16x16x32_bf16 v[160:163], v[180:183], v[56:59], v[160:163]
v_cvt_pkrtz_f16_f32 v155, v154, v155
v_and_b32 v155, s49, v155
v_mfma_f32_16x16x32_bf16 v[168:171], v[180:183], v[60:63], v[168:171]
s_waitcnt lgkmcnt(14)
ds_read_b128 v[180:183], v251 offset:55296
v_bfe_u32 v154, v155, 2, 14
s_waitcnt lgkmcnt(13)
v_mfma_f32_16x16x32_f16 v[72:75], v[184:187], v[44:47], v[72:75]
v_lshrrev_b32 v155, 18, v155
v_exp_f16_sdwa v159, v159 dst_sel:WORD_1 dst_unused:UNUSED_PRESERVE src0_sel:WORD_1
v_mfma_f32_16x16x32_f16 v[128:131], v[184:187], v[40:43], v[128:131]
ds_read_b128 v[184:187], v249 offset:26880
ds_read_u16 v154, v154
v_pk_add_f16 v157, v157, 1.0 op_sel_hi:[1,0]
v_pk_add_f16 v159, v159, 1.0 op_sel_hi:[1,0]
v_rcp_f16_sdwa v157, v157 dst_sel:WORD_0 dst_unused:UNUSED_PRESERVE src0_sel:WORD_0
v_rcp_f16_sdwa v159, v159 dst_sel:WORD_0 dst_unused:UNUSED_PRESERVE src0_sel:WORD_0
s_waitcnt lgkmcnt(12)
v_mfma_f32_16x16x32_f16 v[76:79], v[188:191], v[44:47], v[76:79]
ds_read_u16_d16_hi v155, v155
v_rcp_f16_sdwa v157, v157 dst_sel:WORD_1 dst_unused:UNUSED_PRESERVE src0_sel:WORD_1
v_mfma_f32_16x16x32_f16 v[132:135], v[188:191], v[40:43], v[132:135]
ds_read_b128 v[188:191], v251 offset:53248
v_rcp_f16_sdwa v159, v159 dst_sel:WORD_1 dst_unused:UNUSED_PRESERVE src0_sel:WORD_1
v_or_b32 v112, v144, v145
v_pk_mul_f16 v118, v156, v157
v_pk_mul_f16 v119, v158, v159
v_or_b32 v113, v146, v147
s_waitcnt lgkmcnt(12)
v_or_b32 v114, v148, v149
s_waitcnt lgkmcnt(11)
v_mfma_f32_16x16x32_bf16 v[160:163], v[120:123], v[64:67], v[160:163]
v_mfma_f32_16x16x32_bf16 v[168:171], v[120:123], v[68:71], v[168:171]
ds_read_b128 v[120:123], v249 offset:28928
s_nop 5
v_cvt_pkrtz_f16_f32 v161, v160, v161
v_and_b32 v161, s49, v161
v_bfe_u32 v160, v161, 2, 14
v_lshrrev_b32_e64 v161, 18, v161
v_cvt_pkrtz_f16_f32 v163, v162, v163
v_and_b32_e64 v163, s49, v163
v_bfe_u32 v162, v163, 2, 14
v_lshrrev_b32 v163, 18, v163
s_waitcnt lgkmcnt(9)
v_mfma_f32_16x16x32_f16 v[80:83], v[124:127], v[44:47], v[80:83]
ds_read_u16 v160, v160
ds_read_u16_d16_hi v161, v161
v_mfma_f32_16x16x32_f16 v[136:139], v[124:127], v[40:43], v[136:139]
ds_read_b128 v[124:127], v251 offset:56320
ds_read_u16 v162, v162
ds_read_u16_d16_hi v163, v163
v_or_b32 v115, v150, v151
s_waitcnt lgkmcnt(12)
v_mfma_f32_16x16x32_bf16 v[164:167], v[176:179], v[48:51], 0
v_cvt_pkrtz_f16_f32 v169, v168, v169
v_and_b32_e64 v169, s49, v169
v_mfma_f32_16x16x32_bf16 v[172:175], v[176:179], v[52:55], 0
ds_read_b128 v[176:179], v249 offset:30720
s_waitcnt lgkmcnt(12)
v_or_b32 v116, v152, v153
v_bfe_u32 v168, v169, 2, 14
v_lshrrev_b32_e64 v169, 18, v169
ds_read_u16 v168, v168
ds_read_u16_d16_hi v169, v169
s_waitcnt lgkmcnt(13)
v_mfma_f32_16x16x32_f16 v[84:87], v[180:183], v[44:47], v[84:87]
s_setprio 3
v_cvt_pkrtz_f16_f32 v171, v170, v171
v_and_b32 v171, s49, v171
s_waitcnt lgkmcnt(12)
v_mfma_f32_16x16x32_bf16 v[164:167], v[184:187], v[56:59], v[164:167]
v_bfe_u32 v170, v171, 2, 14
v_lshrrev_b32_e64 v171, 18, v171
v_mfma_f32_16x16x32_f16 v[140:143], v[180:183], v[40:43], v[140:143]
ds_read_b128 v[180:183], v251 offset:57344
ds_read_u16 v170, v170
v_mfma_f32_16x16x32_bf16 v[172:175], v[184:187], v[60:63], v[172:175]
ds_read_b128 v[184:187], v249 offset:32768
s_waitcnt lgkmcnt(13)
v_or_b32 v117, v154, v155
ds_read_u16_d16_hi v171, v171
s_waitcnt lgkmcnt(13)
v_mfma_f32_16x16x32_f16 v[88:91], v[188:191], v[44:47], v[88:91]
v_mfma_f32_16x16x32_f16 v[240:243], v[188:191], v[40:43], v[240:243]
ds_read_b128 v[188:191], v251 offset:60416
s_waitcnt lgkmcnt(13)
v_mfma_f32_16x16x32_bf16 v[164:167], v[120:123], v[64:67], v[164:167]
v_mfma_f32_16x16x32_bf16 v[172:175], v[120:123], v[68:71], v[172:175]
ds_read_b128 v[120:123], v251 offset:58368
s_nop 5
v_cvt_pkrtz_f16_f32 v165, v164, v165
v_and_b32 v165, s49, v165
v_bfe_u32 v164, v165, 2, 14
v_lshrrev_b32 v165, 18, v165
v_cvt_pk_f16_f32 v172, v172, v173
s_waitcnt lgkmcnt(11)
v_mfma_f32_16x16x32_f16 v[92:95], v[124:127], v[44:47], v[92:95]
v_cvt_pk_f16_f32 v174, v174, v175
v_pk_fma_f16 v173, v172, v172, s48
v_mfma_f32_16x16x32_f16 v[244:247], v[124:127], v[40:43], v[244:247]
ds_read_b128 v[124:127], v249 offset:34816
v_pk_fma_f16 v175, v174, v174, s48
v_pk_mul_f16 v173, v172, v173
v_pk_mul_f16 v175, v174, v175
v_exp_f16_sdwa v173, v173 dst_sel:WORD_0 dst_unused:UNUSED_PRESERVE src0_sel:WORD_0
v_cvt_pkrtz_f16_f32 v167, v166, v167
v_and_b32_e64 v167, s49, v167
v_bfe_u32 v166, v167, 2, 14
v_lshrrev_b32 v167, 18, v167
ds_read_u16 v164, v164
ds_read_u16_d16_hi v165, v165
s_waitcnt lgkmcnt(11)
v_mfma_f32_16x16x32_bf16 v[0:3], v[176:179], v[48:51], 0
ds_read_u16 v166, v166
ds_read_u16_d16_hi v167, v167
v_mfma_f32_16x16x32_bf16 v[8:11], v[176:179], v[52:55], 0
ds_read_b128 v[176:179], v251 offset:61440
v_exp_f16_sdwa v175, v175 dst_sel:WORD_0 dst_unused:UNUSED_PRESERVE src0_sel:WORD_0
v_exp_f16_sdwa v173, v173 dst_sel:WORD_1 dst_unused:UNUSED_PRESERVE src0_sel:WORD_1
v_exp_f16_sdwa v175, v175 dst_sel:WORD_1 dst_unused:UNUSED_PRESERVE src0_sel:WORD_1
v_pk_add_f16 v173, v173, 1.0 op_sel_hi:[1,0]
v_pk_add_f16 v175, v175, 1.0 op_sel_hi:[1,0]
v_rcp_f16_sdwa v173, v173 dst_sel:WORD_0 dst_unused:UNUSED_PRESERVE src0_sel:WORD_0
v_rcp_f16_sdwa v175, v175 dst_sel:WORD_0 dst_unused:UNUSED_PRESERVE src0_sel:WORD_0
s_waitcnt lgkmcnt(11)
v_mfma_f32_16x16x32_f16 v[72:75], v[180:183], v[196:199], v[72:75]
v_rcp_f16_sdwa v173, v173 dst_sel:WORD_1 dst_unused:UNUSED_PRESERVE src0_sel:WORD_1
v_mfma_f32_16x16x32_f16 v[128:131], v[180:183], v[192:195], v[128:131]
ds_read_b128 v[180:183], v249 offset:30976
s_setprio 2
v_rcp_f16_sdwa v175, v175 dst_sel:WORD_1 dst_unused:UNUSED_PRESERVE src0_sel:WORD_1
v_or_b32 v24, v160, v161
s_waitcnt lgkmcnt(10)
v_mfma_f32_16x16x32_bf16 v[0:3], v[184:187], v[56:59], v[0:3]
v_pk_mul_f16 v30, v172, v173
v_pk_mul_f16 v31, v174, v175
v_mfma_f32_16x16x32_bf16 v[8:11], v[184:187], v[60:63], v[8:11]
ds_read_b128 v[184:187], v251 offset:59392
v_or_b32 v25, v162, v163
s_waitcnt lgkmcnt(9)
v_mfma_f32_16x16x32_f16 v[76:79], v[188:191], v[196:199], v[76:79]
v_mov_b32 v16, 0
v_mov_b32 v17, 0
v_mfma_f32_16x16x32_f16 v[132:135], v[188:191], v[192:195], v[132:135]
ds_read_b128 v[188:191], v249 offset:33024
v_cndmask_b32 v18, 0, v255, s[88:89]
s_waitcnt lgkmcnt(9)
v_mfma_f32_16x16x32_f16 v[80:83], v[120:123], v[196:199], v[80:83]
v_cndmask_b32 v19, 0, v255, s[90:91]
v_mov_b32 v20, 0
s_waitcnt lgkmcnt(8)
v_mfma_f32_16x16x32_bf16 v[0:3], v[124:127], v[64:67], v[0:3]
v_mov_b32 v21, 0
v_mfma_f32_16x16x32_f16 v[136:139], v[120:123], v[192:195], v[136:139]
ds_read_b128 v[120:123], v251 offset:62464
v_mfma_f32_16x16x32_bf16 v[8:11], v[124:127], v[68:71], v[8:11]
ds_read_b128 v[124:127], v249 offset:35072
s_waitcnt lgkmcnt(8)
v_or_b32 v26, v164, v165
s_nop 0
v_cvt_pkrtz_f16_f32 v1, v0, v1
v_and_b32 v1, s49, v1
v_bfe_u32 v0, v1, 2, 14
v_lshrrev_b32_e64 v1, 18, v1
v_cvt_pkrtz_f16_f32 v3, v2, v3
v_and_b32_e64 v3, s49, v3
v_bfe_u32 v2, v3, 2, 14
v_lshrrev_b32 v3, 18, v3
v_or_b32 v28, v168, v169
ds_read_u16 v0, v0
ds_read_u16_d16_hi v1, v1
ds_read_u16 v2, v2
ds_read_u16_d16_hi v3, v3
s_waitcnt lgkmcnt(10)
v_or_b32_e64 v27, v166, v167
s_waitcnt lgkmcnt(9)
v_mfma_f32_16x16x32_f16 v[84:87], v[176:179], v[196:199], v[84:87]
v_mfma_f32_16x16x32_f16 v[140:143], v[176:179], v[192:195], v[140:143]
ds_read_b128 v[176:179], v251 offset:63488
s_waitcnt lgkmcnt(9)
v_mfma_f32_16x16x32_bf16 v[4:7], v[180:183], v[48:51], 0
v_or_b32 v29, v170, v171
v_cvt_pkrtz_f16_f32 v9, v8, v9
v_mfma_f32_16x16x32_bf16 v[12:15], v[180:183], v[52:55], 0
ds_read_b128 v[180:183], v252 offset:1024
v_and_b32_e64 v9, s49, v9
s_waitcnt lgkmcnt(9)
v_mfma_f32_16x16x32_f16 v[88:91], v[184:187], v[196:199], v[88:91]
s_setprio 1
v_bfe_u32 v8, v9, 2, 14
v_lshrrev_b32 v9, 18, v9
s_waitcnt lgkmcnt(8)
v_mfma_f32_16x16x32_bf16 v[4:7], v[188:191], v[56:59], v[4:7]
ds_read_u16 v8, v8
ds_read_u16_d16_hi v9, v9
v_mfma_f32_16x16x32_f16 v[240:243], v[184:187], v[192:195], v[240:243]
ds_read_b128 v[184:187], v251 offset:64512
v_cvt_pkrtz_f16_f32 v11, v10, v11
s_waitcnt lgkmcnt(10)
v_mfma_f32_16x16x32_f16 v[92:95], v[120:123], v[196:199], v[92:95]
v_and_b32 v11, s49, v11
v_bfe_u32 v10, v11, 2, 14
v_mfma_f32_16x16x32_bf16 v[12:15], v[188:191], v[60:63], v[12:15]
ds_read_b128 v[188:191], v252 offset:2048
v_lshrrev_b32 v11, 18, v11
v_mfma_f32_16x16x32_f16 v[244:247], v[120:123], v[192:195], v[244:247]
ds_read_b128 v[120:123], v252
ds_read_u16 v10, v10
s_waitcnt lgkmcnt(11)
v_mfma_f32_16x16x32_bf16 v[4:7], v[124:127], v[64:67], v[4:7]
ds_read_u16_d16_hi v11, v11
v_mfma_f32_16x16x32_bf16 v[12:15], v[124:127], v[68:71], v[12:15]
ds_read_b128 v[124:127], v252 offset:3072
s_nop 4
v_cvt_pkrtz_f16_f32 v5, v4, v5
v_and_b32 v5, s49, v5
v_bfe_u32 v4, v5, 2, 14
v_lshrrev_b32 v5, 18, v5
s_waitcnt lgkmcnt(9)
v_mfma_f32_16x16x32_f16 v[72:75], v[176:179], v[116:119], v[72:75]
v_cvt_pk_f16_f32 v12, v12, v13
v_cvt_pk_f16_f32 v14, v14, v15
v_mfma_f32_16x16x32_f16 v[128:131], v[176:179], v[112:115], v[128:131]
ds_read_b128 v[176:179], v252 offset:4096
v_pk_fma_f16 v13, v12, v12, s48
s_waitcnt lgkmcnt(9)
v_mfma_f32_16x16x32_f16 v[76:79], v[180:183], v[116:119], v[76:79]
v_pk_fma_f16 v15, v14, v14, s48
v_pk_mul_f16 v13, v12, v13
v_mfma_f32_16x16x32_f16 v[132:135], v[180:183], v[112:115], v[132:135]
ds_read_b128 v[180:183], v252 offset:7168
s_setprio 0
ds_read_u16 v4, v4
ds_read_u16_d16_hi v5, v5
v_pk_mul_f16 v15, v14, v15
v_exp_f16_sdwa v13, v13 dst_sel:WORD_0 dst_unused:UNUSED_PRESERVE src0_sel:WORD_0
v_cvt_pkrtz_f16_f32 v7, v6, v7
v_and_b32 v7, s49, v7
s_waitcnt lgkmcnt(9)
v_mfma_f32_16x16x32_f16 v[80:83], v[184:187], v[116:119], v[80:83]
v_bfe_u32 v6, v7, 2, 14
v_lshrrev_b32_e64 v7, 18, v7
v_mfma_f32_16x16x32_f16 v[136:139], v[184:187], v[112:115], v[136:139]
ds_read_b128 v[184:187], v252 offset:5120
ds_read_u16 v6, v6
s_waitcnt lgkmcnt(10)
v_mfma_f32_16x16x32_f16 v[84:87], v[188:191], v[116:119], v[84:87]
ds_read_u16_d16_hi v7, v7
v_exp_f16_sdwa v15, v15 dst_sel:WORD_0 dst_unused:UNUSED_PRESERVE src0_sel:WORD_0
v_mfma_f32_16x16x32_f16 v[140:143], v[188:191], v[112:115], v[140:143]
ds_read_b128 v[188:191], v252 offset:8192
v_exp_f16_sdwa v13, v13 dst_sel:WORD_1 dst_unused:UNUSED_PRESERVE src0_sel:WORD_1
s_waitcnt lgkmcnt(11)
v_mfma_f32_16x16x32_f16 v[88:91], v[120:123], v[116:119], v[88:91]
v_exp_f16_sdwa v15, v15 dst_sel:WORD_1 dst_unused:UNUSED_PRESERVE src0_sel:WORD_1
v_mfma_f32_16x16x32_f16 v[240:243], v[120:123], v[112:115], v[240:243]
ds_read_b128 v[120:123], v252 offset:6144
v_pk_add_f16 v13, v13, 1.0 op_sel_hi:[1,0]
v_pk_add_f16 v15, v15, 1.0 op_sel_hi:[1,0]
s_waitcnt lgkmcnt(9)
v_mfma_f32_16x16x32_f16 v[92:95], v[124:127], v[116:119], v[92:95]
s_setprio 3
v_rcp_f16_sdwa v13, v13 dst_sel:WORD_0 dst_unused:UNUSED_PRESERVE src0_sel:WORD_0
v_mfma_f32_16x16x32_f16 v[244:247], v[124:127], v[112:115], v[244:247]
ds_read_b128 v[124:127], v252 offset:9216
v_rcp_f16_sdwa v15, v15 dst_sel:WORD_0 dst_unused:UNUSED_PRESERVE src0_sel:WORD_0
s_waitcnt vmcnt(7)
v_mfma_f32_16x16x32_bf16 v[128:131], v[18:21], v[232:235], v[128:131]
v_rcp_f16_sdwa v13, v13 dst_sel:WORD_1 dst_unused:UNUSED_PRESERVE src0_sel:WORD_1
v_mfma_f32_16x16x32_bf16 v[132:135], v[16:19], v[232:235], v[132:135]
v_rcp_f16_sdwa v15, v15 dst_sel:WORD_1 dst_unused:UNUSED_PRESERVE src0_sel:WORD_1
s_waitcnt vmcnt(6)
v_mfma_f32_16x16x32_bf16 v[136:139], v[18:21], v[236:239], v[136:139]
v_or_b32_e64 v32, v0, v1
v_pk_mul_f16 v38, v12, v13
v_mfma_f32_16x16x32_bf16 v[140:143], v[16:19], v[236:239], v[140:143]
v_pk_mul_f16 v39, v14, v15
v_or_b32 v33, v2, v3
s_waitcnt lgkmcnt(7)
v_mfma_f32_16x16x32_f16 v[72:75], v[176:179], v[28:31], v[72:75]
s_waitcnt lgkmcnt(6)
v_or_b32 v34, v4, v5
v_or_b32_e64 v36, v8, v9
v_mfma_f32_16x16x32_f16 v[128:131], v[176:179], v[24:27], v[128:131]
ds_read_b128 v[176:179], v252 offset:10240
v_or_b32_e64 v37, v10, v11
v_mfma_f32_16x16x32_f16 v[76:79], v[180:183], v[28:31], v[76:79]
v_mfma_f32_16x16x32_f16 v[132:135], v[180:183], v[24:27], v[132:135]
ds_read_b128 v[180:183], v252 offset:13312
s_waitcnt lgkmcnt(5)
v_or_b32 v35, v6, v7
v_mfma_f32_16x16x32_f16 v[80:83], v[184:187], v[28:31], v[80:83]
v_mfma_f32_16x16x32_f16 v[136:139], v[184:187], v[24:27], v[136:139]
ds_read_b128 v[184:187], v252 offset:11264
s_setprio 2
s_waitcnt lgkmcnt(5)
v_mfma_f32_16x16x32_f16 v[84:87], v[188:191], v[28:31], v[84:87]
v_mfma_f32_16x16x32_f16 v[140:143], v[188:191], v[24:27], v[140:143]
ds_read_b128 v[188:191], v252 offset:14336
s_waitcnt lgkmcnt(5)
v_mfma_f32_16x16x32_f16 v[88:91], v[120:123], v[28:31], v[88:91]
v_mfma_f32_16x16x32_f16 v[240:243], v[120:123], v[24:27], v[240:243]
ds_read_b128 v[120:123], v252 offset:12288
s_waitcnt lgkmcnt(5)
v_mfma_f32_16x16x32_f16 v[92:95], v[124:127], v[28:31], v[92:95]
v_mfma_f32_16x16x32_f16 v[244:247], v[124:127], v[24:27], v[244:247]
ds_read_b128 v[124:127], v252 offset:15360
s_waitcnt vmcnt(3)
v_mfma_f32_16x16x32_bf16 v[240:243], v[18:21], v[208:211], v[240:243]
v_mfma_f32_16x16x32_bf16 v[244:247], v[16:19], v[208:211], v[244:247]
s_waitcnt vmcnt(2)
v_mfma_f32_16x16x32_bf16 v[72:75], v[18:21], v[212:215], v[72:75]
v_mfma_f32_16x16x32_bf16 v[76:79], v[16:19], v[212:215], v[76:79]
s_waitcnt lgkmcnt(2)
v_mfma_f32_16x16x32_f16 v[72:75], v[176:179], v[36:39], v[72:75]
s_setprio 1
v_mfma_f32_16x16x32_f16 v[128:131], v[176:179], v[32:35], v[128:131]
v_mfma_f32_16x16x32_f16 v[76:79], v[180:183], v[36:39], v[76:79]
s_nop 4
v_cvt_pk_bf16_f32 v108, v72, v73
v_mfma_f32_16x16x32_f16 v[132:135], v[180:183], v[32:35], v[132:135]
v_cvt_pk_bf16_f32 v109, v74, v75
v_cvt_pk_bf16_f32 v224, v128, v129
v_mfma_f32_16x16x32_f16 v[80:83], v[184:187], v[36:39], v[80:83]
v_cvt_pk_bf16_f32 v225, v130, v131
v_cvt_pk_bf16_f32 v110, v76, v77
v_mfma_f32_16x16x32_f16 v[136:139], v[184:187], v[32:35], v[136:139]
s_nop 1
v_cvt_pk_bf16_f32 v226, v132, v133
v_cvt_pk_bf16_f32 v227, v134, v135
v_cvt_pk_bf16_f32 v111, v78, v79
v_mfma_f32_16x16x32_f16 v[84:87], v[188:191], v[36:39], v[84:87]
v_mfma_f32_16x16x32_f16 v[140:143], v[188:191], v[32:35], v[140:143]
s_nop 0
v_cvt_pk_bf16_f32 v228, v136, v137
v_cvt_pk_bf16_f32 v229, v138, v139
s_waitcnt lgkmcnt(0)
v_mfma_f32_16x16x32_f16 v[88:91], v[120:123], v[36:39], v[88:91]
v_mfma_f32_16x16x32_f16 v[240:243], v[120:123], v[32:35], v[240:243]
s_nop 1
v_cvt_pk_bf16_f32 v230, v140, v141
v_cvt_pk_bf16_f32 v231, v142, v143
v_mfma_f32_16x16x32_f16 v[92:95], v[124:127], v[36:39], v[92:95]
v_mfma_f32_16x16x32_f16 v[244:247], v[124:127], v[32:35], v[244:247]
s_nop 1
v_cvt_pk_bf16_f32 v104, v240, v241
v_cvt_pk_bf16_f32 v105, v242, v243
s_setprio 0
s_waitcnt vmcnt(1)
v_mfma_f32_16x16x32_bf16 v[80:83], v[18:21], v[96:99], v[80:83]
v_mfma_f32_16x16x32_bf16 v[84:87], v[16:19], v[96:99], v[84:87]
v_cvt_pk_bf16_f32 v106, v244, v245
v_cvt_pk_bf16_f32 v107, v246, v247
s_waitcnt vmcnt(0)
v_mfma_f32_16x16x32_bf16 v[88:91], v[18:21], v[100:103], v[88:91]
v_mfma_f32_16x16x32_bf16 v[92:95], v[16:19], v[100:103], v[92:95]
s_nop 1
v_cvt_pk_bf16_f32 v16, v80, v81
v_cvt_pk_bf16_f32 v17, v82, v83
v_cvt_pk_bf16_f32 v18, v84, v85
v_cvt_pk_bf16_f32 v19, v86, v87
s_nop 0
v_cvt_pk_bf16_f32 v20, v88, v89
v_cvt_pk_bf16_f32 v21, v90, v91
v_cvt_pk_bf16_f32 v22, v92, v93
v_cvt_pk_bf16_f32 v23, v94, v95
buffer_store_dwordx4 v[224:227], v253, s[8:11], s68 offen sc1
buffer_store_dwordx4 v[228:231], v253, s[8:11], s68 offen offset:64 sc1
buffer_store_dwordx4 v[104:107], v253, s[8:11], s68 offen offset:128 sc1
buffer_store_dwordx4 v[108:111], v253, s[8:11], s68 offen offset:192 sc1
buffer_store_dwordx4 v[16:19], v253, s[8:11], s68 offen offset:256 sc1
buffer_store_dwordx4 v[20:23], v253, s[8:11], s68 offen offset:320 sc1
s_endpgm
Lpolln:
s_getreg_b32 s43, hwreg(HW_REG_IB_STS, 0, 4)
s_cmp_eq_u32 s43, 0
s_cbranch_scc1 Lpoll
s_setpc_b64 s[78:79]
Lpoll:
s_waitcnt vmcnt(0)
s_cmp_eq_u32 s77, 2
s_cbranch_scc1 LpollC
v_max_u32 v241, v128, v129
v_max3_u32 v241, v241, v130, v131
v_max3_u32 v241, v241, v132, v133
v_max3_u32 v241, v241, v134, v135
v_max3_u32 v241, v241, v136, v137
v_max3_u32 v241, v241, v138, v139
v_max3_u32 v241, v241, v140, v141
v_max3_u32 v241, v241, v142, v143
v_cmp_eq_u32 vcc, -1, v241
s_nop 4
s_cbranch_vccz LpollR
s_lshl_b32 s44, s2, 12
buffer_load_dwordx4 v[128:131], v245, s[32:35], s44 offen sc1
buffer_load_dwordx4 v[132:135], v245, s[32:35], s44 offen offset:1024 sc1
buffer_load_dwordx4 v[136:139], v245, s[32:35], s44 offen offset:2048 sc1
buffer_load_dwordx4 v[140:143], v245, s[32:35], s44 offen offset:3072 sc1
s_setpc_b64 s[78:79]
LpollR:
v_add_f32 v128, v128, v132
v_add_f32 v140, v136, v140
v_add_f32 v140, v128, v140
v_add_f32 v129, v129, v133
v_add_f32 v141, v137, v141
v_add_f32 v141, v129, v141
v_add_f32 v130, v130, v134
v_add_f32 v142, v138, v142
v_add_f32 v142, v130, v142
v_add_f32 v131, v131, v135
v_add_f32 v143, v139, v143
v_add_f32 v143, v131, v143
v_add_f32_dpp v140, v140, v140 row_ror:8 row_mask:0xf bank_mask:0xf
s_nop 1
v_add_f32_dpp v140, v140, v140 row_ror:4 row_mask:0xf bank_mask:0xf
s_nop 1
v_add_f32_dpp v140, v140, v140 row_ror:2 row_mask:0xf bank_mask:0xf
s_nop 1
v_add_f32_dpp v140, v140, v140 row_ror:1 row_mask:0xf bank_mask:0xf
v_mov_b32 v241, v140
s_nop 1
v_permlane16_swap_b32 v140, v241
v_add_f32 v140, v140, v241
v_mov_b32 v241, v140
s_nop 1
v_permlane32_swap_b32 v140, v241
v_add_f32 v140, v140, v241
v_min_u32 v140, -2, v140
v_add_f32_dpp v141, v141, v141 row_ror:8 row_mask:0xf bank_mask:0xf
s_nop 1
v_add_f32_dpp v141, v141, v141 row_ror:4 row_mask:0xf bank_mask:0xf
s_nop 1
v_add_f32_dpp v141, v141, v141 row_ror:2 row_mask:0xf bank_mask:0xf
s_nop 1
v_add_f32_dpp v141, v141, v141 row_ror:1 row_mask:0xf bank_mask:0xf
v_mov_b32 v241, v141
s_nop 1
v_permlane16_swap_b32 v141, v241
v_add_f32 v141, v141, v241
v_mov_b32 v241, v141
s_nop 1
v_permlane32_swap_b32 v141, v241
v_add_f32 v141, v141, v241
v_min_u32 v141, -2, v141
v_add_f32_dpp v142, v142, v142 row_ror:8 row_mask:0xf bank_mask:0xf
s_nop 1
v_add_f32_dpp v142, v142, v142 row_ror:4 row_mask:0xf bank_mask:0xf
s_nop 1
v_add_f32_dpp v142, v142, v142 row_ror:2 row_mask:0xf bank_mask:0xf
s_nop 1
v_add_f32_dpp v142, v142, v142 row_ror:1 row_mask:0xf bank_mask:0xf
v_mov_b32 v241, v142
s_nop 1
v_permlane16_swap_b32 v142, v241
v_add_f32 v142, v142, v241
v_mov_b32 v241, v142
s_nop 1
v_permlane32_swap_b32 v142, v241
v_add_f32 v142, v142, v241
v_min_u32 v142, -2, v142
v_add_f32_dpp v143, v143, v143 row_ror:8 row_mask:0xf bank_mask:0xf
s_nop 1
v_add_f32_dpp v143, v143, v143 row_ror:4 row_mask:0xf bank_mask:0xf
s_nop 1
v_add_f32_dpp v143, v143, v143 row_ror:2 row_mask:0xf bank_mask:0xf
s_nop 1
v_add_f32_dpp v143, v143, v143 row_ror:1 row_mask:0xf bank_mask:0xf
v_mov_b32 v241, v143
s_nop 1
v_permlane16_swap_b32 v143, v241
v_add_f32 v143, v143, v241
v_mov_b32 v241, v143
s_nop 1
v_permlane32_swap_b32 v143, v241
v_add_f32 v143, v143, v241
v_min_u32 v143, -2, v143
s_lshl_b32 s44, s2, 4
s_add_u32 s44, s44, 393216
v_lshlrev_b32_e64 v241, 9, v240
s_mov_b64 exec, 0xff
buffer_store_dwordx4 v[140:143], v241, s[32:35], s44 offen sc1
s_mov_b64 exec, -1
s_mov_b32 s77, 2
s_and_b32 s44, s2, 7
s_lshl_b32 s44, s44, 11
s_add_u32 s44, s44, 393216
buffer_load_dword v128, v240, s[32:35], s44 offen sc1
buffer_load_dword v129, v240, s[32:35], s44 offen offset:256 sc1
buffer_load_dword v130, v240, s[32:35], s44 offen offset:512 sc1
buffer_load_dword v131, v240, s[32:35], s44 offen offset:768 sc1
buffer_load_dword v132, v240, s[32:35], s44 offen offset:1024 sc1
buffer_load_dword v133, v240, s[32:35], s44 offen offset:1280 sc1
v_lshrrev_b32 v241, 1, v240
buffer_load_ushort v134, v241, s[24:27], 0 offen
buffer_load_ushort v135, v241, s[24:27], 0 offen offset:128
buffer_load_ushort v136, v241, s[24:27], 0 offen offset:256
buffer_load_ushort v137, v241, s[24:27], 0 offen offset:384
buffer_load_ushort v138, v241, s[24:27], 0 offen offset:512
buffer_load_ushort v139, v241, s[24:27], 0 offen offset:640
s_setpc_b64 s[78:79]
LpollC:
v_max3_u32 v241, v128, v129, v130
v_max3_u32 v241, v241, v131, v132
v_max_u32 v241, v241, v133
v_cmp_eq_u32 vcc, -1, v241
s_nop 4
s_cbranch_vccz LpollS
s_and_b32 s44, s2, 7
s_lshl_b32 s44, s44, 11
s_add_u32 s44, s44, 393216
buffer_load_dword v128, v240, s[32:35], s44 offen sc1
buffer_load_dword v129, v240, s[32:35], s44 offen offset:256 sc1
buffer_load_dword v130, v240, s[32:35], s44 offen offset:512 sc1
buffer_load_dword v131, v240, s[32:35], s44 offen offset:768 sc1
buffer_load_dword v132, v240, s[32:35], s44 offen offset:1024 sc1
buffer_load_dword v133, v240, s[32:35], s44 offen offset:1280 sc1
s_setpc_b64 s[78:79]
LpollS:
s_mov_b32 s43, 1083289508
v_mov_b32 v242, 897988541
v_fma_f32 v128, v128, s43, v242
v_sqrt_f32 v128, v128
v_lshlrev_b32_e64 v134, 16, v134
v_fma_f32 v129, v129, s43, v242
v_sqrt_f32 v129, v129
v_lshlrev_b32 v135, 16, v135
v_fma_f32 v130, v130, s43, v242
v_sqrt_f32 v130, v130
v_lshlrev_b32 v136, 16, v136
v_fma_f32 v131, v131, s43, v242
v_sqrt_f32 v131, v131
v_lshlrev_b32 v137, 16, v137
v_fma_f32 v132, v132, s43, v242
v_sqrt_f32 v132, v132
v_lshlrev_b32 v138, 16, v138
v_fma_f32 v133, v133, s43, v242
v_sqrt_f32 v133, v133
v_lshlrev_b32 v139, 16, v139
v_add_f32 v243, v128, v129
v_add_f32 v243, v243, v130
v_add_f32 v243, v243, v131
v_add_f32 v243, v243, v132
v_add_f32 v243, v243, v133
s_nop 1
v_add_f32_dpp v243, v243, v243 row_ror:8 row_mask:0xf bank_mask:0xf
s_nop 1
v_add_f32_dpp v243, v243, v243 row_ror:4 row_mask:0xf bank_mask:0xf
s_nop 1
v_add_f32_dpp v243, v243, v243 row_ror:2 row_mask:0xf bank_mask:0xf
s_nop 1
v_add_f32_dpp v243, v243, v243 row_ror:1 row_mask:0xf bank_mask:0xf
v_mov_b32 v241, v243
s_nop 1
v_permlane16_swap_b32 v243, v241
v_add_f32 v243, v243, v241
v_mov_b32 v241, v243
s_nop 1
v_permlane32_swap_b32 v243, v241
v_add_f32_e64 v243, v243, v241
s_mov_b32 s43, 992651947
v_fma_f32 v243, v243, s43, v242
v_rcp_f32 v243, v243
s_nop 0
v_mul_f32_e64 v128, v128, v243
v_fma_f32 v128, v128, v134, 1.0
v_mul_f32 v128, 3221786265, v128
v_mul_f32_e64 v129, v129, v243
v_fma_f32 v129, v129, v135, 1.0
v_mul_f32 v129, 3221786265, v129
v_mul_f32_e64 v130, v130, v243
v_fma_f32 v130, v130, v136, 1.0
v_mul_f32 v130, 3221786265, v130
v_mul_f32_e64 v131, v131, v243
v_fma_f32 v131, v131, v137, 1.0
v_mul_f32 v131, 3221786265, v131
v_mul_f32_e64 v132, v132, v243
v_fma_f32 v132, v132, v138, 1.0
v_mul_f32 v132, 3221786265, v132
v_mul_f32_e64 v133, v133, v243
v_fma_f32 v133, v133, v139, 1.0
v_mul_f32 v133, 3221786265, v133
s_mov_b32 s77, 0
s_nop 1
s_setpc_b64 s[78:79]
Lend:
s_endpgm

.section .rodata,"a"
.p2align 6
.amdhsa_kernel standalone__modern_conv_block_convnext_v2__vision_kernel
  .amdhsa_next_free_vgpr 256
  .amdhsa_next_free_sgpr 102
  .amdhsa_accum_offset 256
  .amdhsa_group_segment_fixed_size 0
  .amdhsa_kernarg_size 72
  .amdhsa_user_sgpr_count 2
  .amdhsa_user_sgpr_kernarg_segment_ptr 1
  .amdhsa_system_sgpr_workgroup_id_x 1
.end_amdhsa_kernel
```

```asm
; @launch grid=(256,1,1) block=(512,1,1) lds=163840
.amdgcn_target "amdgcn-amd-amdhsa--gfx950"
.text
.globl standalone__modern_conv_block_convnext_v2__vision_kernel
.p2align 8
.type standalone__modern_conv_block_convnext_v2__vision_kernel,@function
standalone__modern_conv_block_convnext_v2__vision_kernel:
s_cmp_ge_u32 s2, 256
s_cbranch_scc1 Lend
s_load_dwordx16 s[80:95], s[0:1], 0
s_load_dwordx2 s[96:97], s[0:1], 64
v_mov_b32 v119, v0
v_and_b32 v118, 63, v0
v_lshrrev_b32 v120, 6, v0
s_nop 0
v_readfirstlane_b32 s40, v120
s_getpc_b64 s[74:75]
Lpc:
s_lshr_b32 s43, s2, 3
s_and_b32 s43, s43, 15
s_lshl_b32 s43, s43, 13
v_lshrrev_b32_e64 v122, 3, v0
v_lshl_add_u32 v122, v122, 7, s43
v_min_u32 v122, Lend-Lpc, v122
global_load_dword v112, v122, s[74:75]
s_and_b32 s43, s2, 7
s_lshr_b32 s44, s2, 3
s_and_b32 s41, s43, 3
s_lshl_b32 s41, s41, 2
s_and_b32 s45, s44, 3
s_add_u32 s41, s41, s45
s_lshr_b32 s42, s43, 2
s_lshl_b32 s42, s42, 3
s_lshr_b32 s45, s44, 2
s_add_u32 s42, s42, s45
s_lshl_b32 s41, s41, 5
s_lshl_b32 s42, s42, 5
s_and_b32 s43, s40, 3
s_mul_i32 s43, s43, 1536
s_add_u32 s67, s43, 90112
s_mul_i32 s44, s41, 192
s_add_u32 s43, s43, s44
s_sub_u32 s43, s43, 192
v_lshl_add_u32 v121, v118, 4, s43
v_add_u32 v123, 896, v121
v_mov_b32 v122, 2147483648
s_mov_b32 s44, 98304
v_cmp_gt_u32 vcc, s44, v121
s_nop 1
v_cndmask_b32 v236, v122, v121, vcc
v_cmp_gt_u32 vcc, s44, v123
s_nop 1
v_cndmask_b32 v237, v122, v123, vcc
s_mul_i32 s66, s42, 98304
v_min_u32 v128, 215, v119
v_lshlrev_b32_e64 v130, 3, v128
v_lshlrev_b32 v250, 4, v118
s_waitcnt lgkmcnt(0)
s_mov_b32 s4, s80
s_and_b32 s5, s81, 65535
s_mov_b32 s6, 50331648
s_mov_b32 s7, 131072
s_cmp_ge_u32 s40, 4
s_cbranch_scc1 Lrowb
s_mov_b32 s20, s82
s_and_b32 s21, s83, 65535
s_mov_b32 s22, 1728
s_mov_b32 s23, 131072
buffer_load_dwordx2 v[126:127], v130, s[20:23], 0 offen
s_add_u32 m0, s67, 0
s_sub_u32 s45, s66, 98304
s_cmp_eq_u32 s42, 0
s_cselect_b32 s45, 1073741824, s45
buffer_load_dwordx4 v236, s[4:7], s45 offen lds
s_add_u32 m0, s67, 6592
s_nop 0
buffer_load_dwordx4 v236, s[4:7], s66 offen lds
s_add_u32 m0, s67, 13200
s_add_u32 s66, s66, 98304
buffer_load_dwordx4 v236, s[4:7], s66 offen lds
s_add_u32 m0, s67, 19792
s_add_u32 s66, s66, 98304
buffer_load_dwordx4 v236, s[4:7], s66 offen lds
s_add_u32 m0, s67, 26400
s_add_u32 s66, s66, 98304
buffer_load_dwordx4 v236, s[4:7], s66 offen lds
s_add_u32 m0, s67, 32992
s_add_u32 s66, s66, 98304
buffer_load_dwordx4 v236, s[4:7], s66 offen lds
s_add_u32 m0, s67, 39600
s_add_u32 s66, s66, 98304
buffer_load_dwordx4 v236, s[4:7], s66 offen lds
s_add_u32 m0, s67, 46192
s_add_u32 s66, s66, 98304
buffer_load_dwordx4 v236, s[4:7], s66 offen lds
s_add_u32 m0, s67, 52736
s_add_u32 s66, s66, 98304
buffer_load_dwordx4 v236, s[4:7], s66 offen lds
s_add_u32 m0, s67, 59328
s_add_u32 s66, s66, 98304
buffer_load_dwordx4 v236, s[4:7], s66 offen lds
s_branch Lsetup
Lrowb:
s_add_u32 m0, s67, 896
s_sub_u32 s45, s66, 98304
s_cmp_eq_u32 s42, 0
s_cselect_b32 s45, 1073741824, s45
buffer_load_dwordx4 v237, s[4:7], s45 offen lds
s_add_u32 m0, s67, 7488
s_nop 0
buffer_load_dwordx4 v237, s[4:7], s66 offen lds
s_add_u32 m0, s67, 14096
s_add_u32 s66, s66, 98304
buffer_load_dwordx4 v237, s[4:7], s66 offen lds
s_add_u32 m0, s67, 20688
s_add_u32 s66, s66, 98304
buffer_load_dwordx4 v237, s[4:7], s66 offen lds
s_add_u32 m0, s67, 27296
s_add_u32 s66, s66, 98304
buffer_load_dwordx4 v237, s[4:7], s66 offen lds
s_add_u32 m0, s67, 33888
s_add_u32 s66, s66, 98304
buffer_load_dwordx4 v237, s[4:7], s66 offen lds
s_add_u32 m0, s67, 40496
s_add_u32 s66, s66, 98304
buffer_load_dwordx4 v237, s[4:7], s66 offen lds
s_add_u32 m0, s67, 47088
s_add_u32 s66, s66, 98304
buffer_load_dwordx4 v237, s[4:7], s66 offen lds
s_add_u32 m0, s67, 53632
s_add_u32 s66, s66, 98304
buffer_load_dwordx4 v237, s[4:7], s66 offen lds
s_add_u32 m0, s67, 60224
s_add_u32 s66, s66, 98304
buffer_load_dwordx4 v237, s[4:7], s66 offen lds
s_mov_b32 s12, s84
s_and_b32 s13, s85, 65535
s_mov_b32 s14, 73728
s_mov_b32 s15, 131072
v_lshrrev_b32 v115, 2, v118
v_mul_u32_u24 v115, 768, v115
v_and_b32_e64 v125, 3, v118
v_lshl_add_u32 v115, v125, 4, v115
s_and_b32 s43, s40, 3
s_add_u32 s43, s43, 0
s_mul_i32 s44, s43, 43
s_lshr_b32 s44, s44, 8
s_lshl_b32 s46, s43, 10
s_add_u32 m0, s46, 16384
s_mul_i32 s46, s44, 6
s_sub_u32 s43, s43, s46
s_mul_i32 s43, s43, 12288
s_lshl_b32 s44, s44, 6
s_add_u32 s43, s43, s44
buffer_load_dwordx4 v115, s[12:15], s43 offen lds
s_and_b32 s43, s40, 3
s_add_u32 s43, s43, 4
s_mul_i32 s44, s43, 43
s_lshr_b32 s44, s44, 8
s_lshl_b32 s46, s43, 10
s_add_u32 m0, s46, 16384
s_mul_i32 s46, s44, 6
s_sub_u32 s43, s43, s46
s_mul_i32 s43, s43, 12288
s_lshl_b32 s44, s44, 6
s_add_u32 s43, s43, s44
buffer_load_dwordx4 v115, s[12:15], s43 offen lds
s_and_b32 s43, s40, 3
s_add_u32 s43, s43, 8
s_mul_i32 s44, s43, 43
s_lshr_b32 s44, s44, 8
s_lshl_b32 s46, s43, 10
s_add_u32 m0, s46, 16384
s_mul_i32 s46, s44, 6
s_sub_u32 s43, s43, s46
s_mul_i32 s43, s43, 12288
s_lshl_b32 s44, s44, 6
s_add_u32 s43, s43, s44
buffer_load_dwordx4 v115, s[12:15], s43 offen lds
s_and_b32 s43, s40, 3
s_add_u32 s43, s43, 12
s_mul_i32 s44, s43, 43
s_lshr_b32 s44, s44, 8
s_lshl_b32 s46, s43, 10
s_add_u32 m0, s46, 16384
s_mul_i32 s46, s44, 6
s_sub_u32 s43, s43, s46
s_mul_i32 s43, s43, 12288
s_lshl_b32 s44, s44, 6
s_add_u32 s43, s43, s44
buffer_load_dwordx4 v115, s[12:15], s43 offen lds
s_and_b32 s43, s40, 3
s_add_u32 s43, s43, 16
s_mul_i32 s44, s43, 43
s_lshr_b32 s44, s44, 8
s_lshl_b32 s46, s43, 10
s_add_u32 m0, s46, 16384
s_mul_i32 s46, s44, 6
s_sub_u32 s43, s43, s46
s_mul_i32 s43, s43, 12288
s_lshl_b32 s44, s44, 6
s_add_u32 s43, s43, s44
buffer_load_dwordx4 v115, s[12:15], s43 offen lds
s_and_b32 s43, s40, 3
s_add_u32 s43, s43, 20
s_mul_i32 s44, s43, 43
s_lshr_b32 s44, s44, 8
s_lshl_b32 s46, s43, 10
s_add_u32 m0, s46, 16384
s_mul_i32 s46, s44, 6
s_sub_u32 s43, s43, s46
s_mul_i32 s43, s43, 12288
s_lshl_b32 s44, s44, 6
s_add_u32 s43, s43, s44
buffer_load_dwordx4 v115, s[12:15], s43 offen lds
v_bfe_u32 v141, v250, 4, 6
v_and_b32 v140, 15, v141
v_lshlrev_b32 v140, 7, v140
v_lshrrev_b32 v141, 4, v141
v_mul_u32_u24 v141, 98304, v141
s_sub_u32 s43, s67, -8000
s_mul_i32 s44, s41, 192
s_add_u32 s43, s43, s44
v_add3_u32 v140, v140, v141, s43
s_mov_b32 m0, 163840
s_add_u32 s44, s66, 393216
buffer_load_dword v140, s[4:7], s66 offen lds
buffer_load_dword v140, s[4:7], s44 offen lds
s_waitcnt vmcnt(8)
s_barrier
s_setprio 0
s_and_b32 s43, s40, 3
s_add_u32 s43, s43, 24
s_mul_i32 s44, s43, 43
s_lshr_b32 s44, s44, 8
s_lshl_b32 s46, s43, 10
s_add_u32 m0, s46, 16384
s_mul_i32 s46, s44, 6
s_sub_u32 s43, s43, s46
s_mul_i32 s43, s43, 12288
s_lshl_b32 s44, s44, 6
s_add_u32 s43, s43, s44
buffer_load_dwordx4 v115, s[12:15], s43 offen lds
s_and_b32 s43, s40, 3
s_add_u32 s43, s43, 28
s_mul_i32 s44, s43, 43
s_lshr_b32 s44, s44, 8
s_lshl_b32 s46, s43, 10
s_add_u32 m0, s46, 16384
s_mul_i32 s46, s44, 6
s_sub_u32 s43, s43, s46
s_mul_i32 s43, s43, 12288
s_lshl_b32 s44, s44, 6
s_add_u32 s43, s43, s44
buffer_load_dwordx4 v115, s[12:15], s43 offen lds
s_and_b32 s43, s40, 3
s_add_u32 s43, s43, 32
s_mul_i32 s44, s43, 43
s_lshr_b32 s44, s44, 8
s_lshl_b32 s46, s43, 10
s_add_u32 m0, s46, 16384
s_mul_i32 s46, s44, 6
s_sub_u32 s43, s43, s46
s_mul_i32 s43, s43, 12288
s_lshl_b32 s44, s44, 6
s_add_u32 s43, s43, s44
buffer_load_dwordx4 v115, s[12:15], s43 offen lds
s_and_b32 s43, s40, 3
s_add_u32 s43, s43, 36
s_mul_i32 s44, s43, 43
s_lshr_b32 s44, s44, 8
s_lshl_b32 s46, s43, 10
s_add_u32 m0, s46, 16384
s_mul_i32 s46, s44, 6
s_sub_u32 s43, s43, s46
s_mul_i32 s43, s43, 12288
s_lshl_b32 s44, s44, 6
s_add_u32 s43, s43, s44
buffer_load_dwordx4 v115, s[12:15], s43 offen lds
s_and_b32 s43, s40, 3
s_add_u32 s43, s43, 40
s_mul_i32 s44, s43, 43
s_lshr_b32 s44, s44, 8
s_lshl_b32 s46, s43, 10
s_add_u32 m0, s46, 16384
s_mul_i32 s46, s44, 6
s_sub_u32 s43, s43, s46
s_mul_i32 s43, s43, 12288
s_lshl_b32 s44, s44, 6
s_add_u32 s43, s43, s44
buffer_load_dwordx4 v115, s[12:15], s43 offen lds
s_and_b32 s43, s40, 3
s_add_u32 s43, s43, 44
s_mul_i32 s44, s43, 43
s_lshr_b32 s44, s44, 8
s_lshl_b32 s46, s43, 10
s_add_u32 m0, s46, 16384
s_mul_i32 s46, s44, 6
s_sub_u32 s43, s43, s46
s_mul_i32 s43, s43, 12288
s_lshl_b32 s44, s44, 6
s_add_u32 s43, s43, s44
buffer_load_dwordx4 v115, s[12:15], s43 offen lds
s_and_b32 s43, s40, 3
s_add_u32 s43, s43, 48
s_mul_i32 s44, s43, 43
s_lshr_b32 s44, s44, 8
s_lshl_b32 s46, s43, 10
s_add_u32 m0, s46, 16384
s_mul_i32 s46, s44, 6
s_sub_u32 s43, s43, s46
s_mul_i32 s43, s43, 12288
s_lshl_b32 s44, s44, 6
s_add_u32 s43, s43, s44
buffer_load_dwordx4 v115, s[12:15], s43 offen lds
s_and_b32 s43, s40, 3
s_add_u32 s43, s43, 52
s_mul_i32 s44, s43, 43
s_lshr_b32 s44, s44, 8
s_lshl_b32 s46, s43, 10
s_add_u32 m0, s46, 16384
s_mul_i32 s46, s44, 6
s_sub_u32 s43, s43, s46
s_mul_i32 s43, s43, 12288
s_lshl_b32 s44, s44, 6
s_add_u32 s43, s43, s44
buffer_load_dwordx4 v115, s[12:15], s43 offen lds
s_and_b32 s43, s40, 3
s_add_u32 s43, s43, 56
s_mul_i32 s44, s43, 43
s_lshr_b32 s44, s44, 8
s_lshl_b32 s46, s43, 10
s_add_u32 m0, s46, 16384
s_mul_i32 s46, s44, 6
s_sub_u32 s43, s43, s46
s_mul_i32 s43, s43, 12288
s_lshl_b32 s44, s44, 6
s_add_u32 s43, s43, s44
buffer_load_dwordx4 v115, s[12:15], s43 offen lds
s_and_b32 s43, s40, 3
s_add_u32 s43, s43, 60
s_mul_i32 s44, s43, 43
s_lshr_b32 s44, s44, 8
s_lshl_b32 s46, s43, 10
s_add_u32 m0, s46, 16384
s_mul_i32 s46, s44, 6
s_sub_u32 s43, s43, s46
s_mul_i32 s43, s43, 12288
s_lshl_b32 s44, s44, 6
s_add_u32 s43, s43, s44
buffer_load_dwordx4 v115, s[12:15], s43 offen lds
s_and_b32 s43, s40, 3
s_add_u32 s43, s43, 64
s_mul_i32 s44, s43, 43
s_lshr_b32 s44, s44, 8
s_lshl_b32 s46, s43, 10
s_add_u32 m0, s46, 16384
s_mul_i32 s46, s44, 6
s_sub_u32 s43, s43, s46
s_mul_i32 s43, s43, 12288
s_lshl_b32 s44, s44, 6
s_add_u32 s43, s43, s44
buffer_load_dwordx4 v115, s[12:15], s43 offen lds
s_and_b32 s43, s40, 3
s_add_u32 s43, s43, 68
s_mul_i32 s44, s43, 43
s_lshr_b32 s44, s44, 8
s_lshl_b32 s46, s43, 10
s_add_u32 m0, s46, 16384
s_mul_i32 s46, s44, 6
s_sub_u32 s43, s43, s46
s_mul_i32 s43, s43, 12288
s_lshl_b32 s44, s44, 6
s_add_u32 s43, s43, s44
buffer_load_dwordx4 v115, s[12:15], s43 offen lds
Lsetup:
s_mov_b32 s16, s86
s_and_b32 s17, s87, 65535
s_mov_b32 s18, 73728
s_mov_b32 s19, 131072
s_mov_b32 s24, s88
s_and_b32 s25, s89, 65535
s_mov_b32 s26, 768
s_mov_b32 s27, 131072
s_mov_b32 s28, s90
s_and_b32 s29, s91, 65535
s_mov_b32 s30, 768
s_mov_b32 s31, 131072
s_mov_b32 s8, s92
s_and_b32 s9, s93, 65535
s_mov_b32 s10, 50331648
s_mov_b32 s11, 131072
s_mov_b32 s36, s94
s_and_b32 s37, s95, 65535
s_mov_b32 s38, 256
s_mov_b32 s39, 131072
s_mov_b32 s32, s96
s_and_b32 s33, s97, 65535
s_mov_b32 s34, 83886080
s_mov_b32 s35, 131072
v_lshlrev_b32_e64 v250, 4, v118
v_add_u32 v250, 16384, v250
v_lshlrev_b32_e64 v251, 4, v118
v_add_u32 v251, 81920, v251
v_lshlrev_b32_e64 v252, 4, v118
v_add_u32 v252, 147456, v252
s_lshl_b32 s73, s2, 3
s_add_u32 s73, s73, s40
s_lshl_b32 s80, s73, 10
s_add_u32 s80, s80, 4177920
s_mul_i32 s73, s73, 16
s_add_u32 s73, s73, 1048576
s_mov_b32 s48, 1156203754
s_mov_b32 s49, 4294508536
v_and_b32 v131, 15, v118
v_lshrrev_b32 v132, 4, v118
v_and_b32_e64 v133, 3, v131
v_mul_u32_u24 v134, 13200, v133
v_lshrrev_b32_e64 v133, 2, v131
v_lshl_add_u32 v133, v133, 1, v132
v_mul_u32_u24 v133, 192, v133
s_sub_u32 s43, s67, 90112
v_add3_u32 v246, v133, v134, s43
v_bfe_u32 v133, v131, 2, 1
v_sub_u32 v133, v132, v133
v_lshrrev_b32 v134, 3, v131
v_and_b32_e64 v135, 3, v131
v_lshl_add_u32 v135, v134, 2, v135
v_lshlrev_b32_e64 v136, 6, v133
v_lshl_add_u32 v136, v135, 3, v136
v_add_u32 v136, 156040, v136
v_mov_b32 v137, 156032
v_cmp_gt_u32 vcc, 3, v133
s_nop 1
v_cndmask_b32 v136, v137, v136, vcc
v_cmp_eq_u32 vcc, 0, v134
s_nop 1
v_cndmask_b32 v238, v137, v136, vcc
v_cndmask_b32 v239, v136, v137, vcc
v_lshrrev_b32 v133, 2, v131
v_bfe_u32 v135, v131, 1, 1
v_cmp_eq_u32 vcc, v133, v132
s_nop 1
v_cndmask_b32 v135, 8, v135, vcc
v_cmp_eq_u32 s[88:89], 0, v135
v_cmp_eq_u32 s[90:91], 1, v135
v_lshlrev_b32 v254, 5, v132
v_add_u32 v254, 7936, v254
v_lshlrev_b32 v253, 4, v132
v_and_b32 v131, 31, v118
v_lshrrev_b32_e64 v132, 5, v118
v_bfe_u32 v133, v131, 2, 1
v_bfe_u32 v134, v131, 3, 1
v_bfe_u32 v135, v131, 1, 1
v_lshrrev_b32 v136, 4, v131
v_lshl_add_u32 v135, v136, 1, v135
v_lshl_add_u32 v135, v134, 2, v135
v_cmp_eq_u32 vcc, v133, v132
s_nop 1
v_cndmask_b32 v135, 8, v135, vcc
v_cmp_eq_u32 s[50:51], 0, v135
v_cmp_eq_u32 s[52:53], 1, v135
v_cmp_eq_u32 s[54:55], 2, v135
v_cmp_eq_u32 s[56:57], 3, v135
v_cmp_eq_u32 s[58:59], 4, v135
v_cmp_eq_u32 s[60:61], 5, v135
v_cmp_eq_u32 s[62:63], 6, v135
v_cmp_eq_u32 s[64:65], 7, v135
v_and_b32 v136, 1, v131
v_lshlrev_b32 v136, 4, v136
v_mov_b32 v255, 16256
v_lshlrev_b32 v255, v136, v255
v_and_b32 v137, 19, v131
v_lshl_add_u32 v137, v133, 3, v137
v_lshl_add_u32 v137, v134, 2, v137
v_lshlrev_b32_e64 v137, 2, v137
v_lshl_add_u32 v137, v132, 7, v137
s_mul_i32 s82, s40, 9216
s_add_u32 s72, s82, 90112
v_add_u32 v248, s72, v137
v_and_b32 v133, 3, v118
v_mul_u32_u24 v134, 196608, v133
v_bfe_u32 v133, v118, 2, 2
v_mul_u32_u24 v133, 384, v133
v_add3_u32 v253, v253, v133, v134
s_mul_i32 s46, s41, 192
s_add_u32 s46, s46, s67
s_sub_u32 s46, s46, 90112
s_and_b32 s83, s40, 4
s_lshl_b32 s44, s83, 1
s_add_u32 s44, s44, s42
s_add_u32 s43, s44, 0
s_mul_i32 s43, s43, 98304
s_add_u32 s68, s43, s46
s_add_u32 s43, s44, 1
s_mul_i32 s43, s43, 98304
s_add_u32 s69, s43, s46
s_add_u32 s43, s44, 16
s_mul_i32 s43, s43, 98304
s_add_u32 s70, s43, s46
s_add_u32 s43, s44, 17
s_mul_i32 s43, s43, 98304
s_add_u32 s71, s43, s46
s_mov_b32 s92, 2863311530
s_mov_b32 s94, 3435973836
s_mov_b32 s93, 2863311530
s_mov_b32 s95, 3435973836
s_mov_b32 s81, 59328
s_mov_b32 s76, 200000
v_mov_b32 v247, 8128
v_lshrrev_b32 v148, 5, v118
v_lshlrev_b32 v116, 8, v148
v_bfe_u32 v148, v118, 2, 2
v_lshl_add_u32 v116, v148, 6, v116
v_bfe_u32 v148, v118, 4, 1
v_lshl_add_u32 v116, v148, 5, v116
v_and_b32_e64 v148, 1, v118
v_lshl_add_u32 v116, v148, 4, v116
v_bfe_u32 v148, v118, 1, 1
v_lshl_add_u32 v116, v148, 3, v116
s_and_b32 s43, s40, 3
s_lshl_b32 s43, s43, 10
v_add_u32_e64 v117, s43, v250
s_add_u32 s43, s43, 16384
v_add_u32 v116, s43, v116
v_mov_b32 v224, 0
v_mov_b32 v225, 0
v_mov_b32 v226, 0
v_mov_b32 v227, 0
v_mov_b32 v228, 0
v_mov_b32 v229, 0
v_mov_b32 v230, 0
v_mov_b32 v231, 0
v_mov_b32 v232, 0
v_mov_b32 v233, 0
v_mov_b32 v234, 0
v_mov_b32 v235, 0
s_cmp_ge_u32 s40, 4
s_cbranch_scc1 Lwa
v_mov_b32 v65, 0
v_mov_b32 v67, 0
v_mov_b32 v68, 0
v_mov_b32 v70, 0
v_mov_b32 v72, 0
v_mov_b32 v73, 0
v_min_u32 v140, 35, v119
v_mul_u32_u24 v140, 200, v140
v_add_u32 v140, 156032, v140
v_and_b32 v141, 31, v119
v_lshlrev_b32 v141, 3, v141
v_bfe_u32 v142, v119, 5, 1
v_lshl_add_u32 v141, v142, 13, v141
v_add_u32 v141, 7936, v141
v_cmp_gt_u32 vcc, 64, v119
s_nop 1
v_cndmask_b32 v140, v141, v140, vcc
ds_write_b64 v140, v[72:73]
v_lshrrev_b32 v140, 1, v128
v_mul_u32_u24 v141, 57, v140
v_lshrrev_b32 v141, 11, v141
v_mul_u32_u24 v142, 171, v140
v_lshrrev_b32_e64 v142, 11, v142
v_mul_u32_u24 v140, 200, v140
v_mul_u32_u24 v142, 2336, v142
v_mul_u32_u24 v141, 2208, v141
v_sub_u32 v140, v140, v142
v_add_u32 v140, v140, v141
v_and_b32_e64 v141, 1, v128
v_lshl_add_u32 v140, v141, 5, v140
v_add_u32 v140, 156040, v140
v_and_b32 v120, 255, v119
v_lshlrev_b32 v121, 8, v120
v_add_u32 v0, 4, v121
v_cvt_f32_f16 v0, v0
v_add_u32 v1, 12, v121
v_cvt_f32_f16 v1, v1
v_add_u32 v2, 20, v121
v_cvt_f32_f16 v2, v2
v_add_u32 v3, 28, v121
v_cvt_f32_f16 v3, v3
v_add_u32 v4, 36, v121
v_cvt_f32_f16 v4, v4
v_add_u32 v5, 44, v121
v_cvt_f32_f16 v5, v5
v_add_u32 v6, 52, v121
v_cvt_f32_f16 v6, v6
v_add_u32 v7, 60, v121
v_cvt_f32_f16_e64 v7, v7
v_add_u32 v8, 68, v121
v_cvt_f32_f16_e64 v8, v8
v_add_u32 v9, 76, v121
v_cvt_f32_f16_e64 v9, v9
v_add_u32 v10, 84, v121
v_cvt_f32_f16_e64 v10, v10
v_add_u32 v11, 92, v121
v_cvt_f32_f16_e64 v11, v11
v_add_u32 v12, 100, v121
v_cvt_f32_f16_e64 v12, v12
v_add_u32 v13, 108, v121
v_cvt_f32_f16_e64 v13, v13
v_add_u32 v14, 116, v121
v_cvt_f32_f16_e64 v14, v14
v_add_u32 v15, 124, v121
v_cvt_f32_f16_e64 v15, v15
v_add_u32 v16, 132, v121
v_cvt_f32_f16_e64 v16, v16
v_add_u32 v17, 140, v121
v_cvt_f32_f16_e64 v17, v17
v_add_u32 v18, 148, v121
v_cvt_f32_f16_e64 v18, v18
v_add_u32 v19, 156, v121
v_cvt_f32_f16_e64 v19, v19
v_add_u32 v20, 164, v121
v_cvt_f32_f16_e64 v20, v20
v_add_u32 v21, 172, v121
v_cvt_f32_f16_e64 v21, v21
v_add_u32 v22, 180, v121
v_cvt_f32_f16_e64 v22, v22
v_add_u32 v23, 188, v121
v_cvt_f32_f16_e64 v23, v23
v_add_u32 v24, 196, v121
v_cvt_f32_f16_e64 v24, v24
v_add_u32 v25, 204, v121
v_cvt_f32_f16_e64 v25, v25
v_add_u32 v26, 212, v121
v_cvt_f32_f16_e64 v26, v26
v_add_u32 v27, 220, v121
v_cvt_f32_f16_e64 v27, v27
v_add_u32 v28, 228, v121
v_cvt_f32_f16_e64 v28, v28
v_add_u32 v29, 236, v121
v_cvt_f32_f16_e64 v29, v29
v_add_u32 v30, 244, v121
v_cvt_f32_f16_e64 v30, v30
v_add_u32 v31, 252, v121
v_cvt_f32_f16_e64 v31, v31
v_fmaak_f32 v32, v0, v0, 0x409d30fc
v_mul_f32_e64 v32, v0, v32
v_fmaak_f32 v33, v1, v1, 0x409d30fc
v_mul_f32_e64 v33, v1, v33
v_fmaak_f32 v34, v2, v2, 0x409d30fc
v_mul_f32_e64 v34, v2, v34
v_fmaak_f32 v35, v3, v3, 0x409d30fc
v_mul_f32_e64 v35, v3, v35
v_fmaak_f32 v36, v4, v4, 0x409d30fc
v_mul_f32_e64 v36, v4, v36
v_fmaak_f32 v37, v5, v5, 0x409d30fc
v_mul_f32_e64 v37, v5, v37
v_fmaak_f32 v38, v6, v6, 0x409d30fc
v_mul_f32_e64 v38, v6, v38
v_fmaak_f32 v39, v7, v7, 0x409d30fc
v_mul_f32_e64 v39, v7, v39
v_fmaak_f32 v40, v8, v8, 0x409d30fc
v_mul_f32_e64 v40, v8, v40
v_fmaak_f32 v41, v9, v9, 0x409d30fc
v_mul_f32_e64 v41, v9, v41
v_fmaak_f32 v42, v10, v10, 0x409d30fc
v_mul_f32_e64 v42, v10, v42
v_fmaak_f32 v43, v11, v11, 0x409d30fc
v_mul_f32_e64 v43, v11, v43
v_fmaak_f32 v44, v12, v12, 0x409d30fc
v_mul_f32_e64 v44, v12, v44
v_fmaak_f32 v45, v13, v13, 0x409d30fc
v_mul_f32_e64 v45, v13, v45
v_fmaak_f32 v46, v14, v14, 0x409d30fc
v_mul_f32_e64 v46, v14, v46
v_fmaak_f32 v47, v15, v15, 0x409d30fc
v_mul_f32_e64 v47, v15, v47
v_fmaak_f32 v48, v16, v16, 0x409d30fc
v_mul_f32_e64 v48, v16, v48
v_fmaak_f32 v49, v17, v17, 0x409d30fc
v_mul_f32_e64 v49, v17, v49
v_fmaak_f32 v50, v18, v18, 0x409d30fc
v_mul_f32_e64 v50, v18, v50
v_fmaak_f32 v51, v19, v19, 0x409d30fc
v_mul_f32_e64 v51, v19, v51
v_fmaak_f32 v52, v20, v20, 0x409d30fc
v_mul_f32_e64 v52, v20, v52
v_fmaak_f32 v53, v21, v21, 0x409d30fc
v_mul_f32_e64 v53, v21, v53
v_fmaak_f32 v54, v22, v22, 0x409d30fc
v_mul_f32_e64 v54, v22, v54
v_fmaak_f32 v55, v23, v23, 0x409d30fc
v_mul_f32_e64 v55, v23, v55
v_fmaak_f32 v56, v24, v24, 0x409d30fc
v_mul_f32_e64 v56, v24, v56
v_fmaak_f32 v57, v25, v25, 0x409d30fc
v_mul_f32_e64 v57, v25, v57
v_fmaak_f32 v58, v26, v26, 0x409d30fc
v_mul_f32_e64 v58, v26, v58
v_fmaak_f32 v59, v27, v27, 0x409d30fc
v_mul_f32_e64 v59, v27, v59
v_fmaak_f32 v60, v28, v28, 0x409d30fc
v_mul_f32_e64 v60, v28, v60
v_fmaak_f32 v61, v29, v29, 0x409d30fc
v_mul_f32_e64 v61, v29, v61
v_fmaak_f32 v62, v30, v30, 0x409d30fc
v_mul_f32_e64 v62, v30, v62
v_fmaak_f32 v63, v31, v31, 0x409d30fc
v_mul_f32 v63, v31, v63
v_exp_f32 v32, v32
v_exp_f32 v33, v33
v_exp_f32 v34, v34
v_exp_f32 v35, v35
v_exp_f32 v36, v36
v_exp_f32 v37, v37
v_exp_f32 v38, v38
v_exp_f32 v39, v39
v_exp_f32 v40, v40
v_exp_f32 v41, v41
v_exp_f32 v42, v42
v_exp_f32 v43, v43
v_exp_f32 v44, v44
v_exp_f32 v45, v45
v_exp_f32 v46, v46
v_exp_f32 v47, v47
v_exp_f32 v48, v48
v_exp_f32 v49, v49
v_exp_f32 v50, v50
v_exp_f32 v51, v51
v_exp_f32 v52, v52
v_exp_f32 v53, v53
v_exp_f32 v54, v54
v_exp_f32 v55, v55
v_exp_f32 v56, v56
v_exp_f32 v57, v57
v_exp_f32 v58, v58
v_exp_f32 v59, v59
v_exp_f32 v60, v60
v_exp_f32 v61, v61
v_exp_f32 v62, v62
v_exp_f32 v63, v63
v_add_f32 v32, 1.0, v32
v_add_f32 v33, 1.0, v33
v_add_f32 v34, 1.0, v34
v_add_f32 v35, 1.0, v35
v_add_f32 v36, 1.0, v36
v_add_f32 v37, 1.0, v37
v_add_f32 v38, 1.0, v38
v_add_f32 v39, 1.0, v39
v_add_f32 v40, 1.0, v40
v_add_f32 v41, 1.0, v41
v_add_f32 v42, 1.0, v42
v_add_f32 v43, 1.0, v43
v_add_f32 v44, 1.0, v44
v_add_f32 v45, 1.0, v45
v_add_f32 v46, 1.0, v46
v_add_f32 v47, 1.0, v47
v_add_f32 v48, 1.0, v48
v_add_f32 v49, 1.0, v49
v_add_f32 v50, 1.0, v50
v_add_f32 v51, 1.0, v51
v_add_f32 v52, 1.0, v52
v_add_f32 v53, 1.0, v53
v_add_f32 v54, 1.0, v54
v_add_f32 v55, 1.0, v55
v_add_f32 v56, 1.0, v56
v_add_f32 v57, 1.0, v57
v_add_f32 v58, 1.0, v58
v_add_f32 v59, 1.0, v59
v_add_f32 v60, 1.0, v60
v_add_f32 v61, 1.0, v61
v_add_f32 v62, 1.0, v62
v_add_f32 v63, 1.0, v63
v_rcp_f32 v32, v32
v_rcp_f32 v33, v33
v_rcp_f32 v34, v34
v_rcp_f32 v35, v35
v_rcp_f32 v36, v36
v_rcp_f32 v37, v37
v_rcp_f32 v38, v38
v_rcp_f32 v39, v39
v_rcp_f32 v40, v40
v_rcp_f32 v41, v41
v_rcp_f32 v42, v42
v_rcp_f32 v43, v43
v_rcp_f32 v44, v44
v_rcp_f32 v45, v45
v_rcp_f32 v46, v46
v_rcp_f32 v47, v47
v_rcp_f32 v48, v48
v_rcp_f32 v49, v49
v_rcp_f32 v50, v50
v_rcp_f32 v51, v51
v_rcp_f32 v52, v52
v_rcp_f32 v53, v53
v_rcp_f32 v54, v54
v_rcp_f32 v55, v55
v_rcp_f32 v56, v56
v_rcp_f32 v57, v57
v_rcp_f32 v58, v58
v_rcp_f32 v59, v59
v_rcp_f32 v60, v60
v_rcp_f32 v61, v61
v_rcp_f32 v62, v62
v_rcp_f32 v63, v63
v_mul_f32 v0, v0, v32
v_mul_f32 v1, v1, v33
v_mul_f32 v2, v2, v34
v_mul_f32 v3, v3, v35
v_mul_f32 v4, v4, v36
v_mul_f32 v5, v5, v37
v_mul_f32 v6, v6, v38
v_mul_f32 v7, v7, v39
v_mul_f32 v8, v8, v40
v_mul_f32 v9, v9, v41
v_mul_f32 v10, v10, v42
v_mul_f32 v11, v11, v43
v_mul_f32 v12, v12, v44
v_mul_f32 v13, v13, v45
v_mul_f32 v14, v14, v46
v_mul_f32 v15, v15, v47
v_mul_f32 v16, v16, v48
v_mul_f32 v17, v17, v49
v_mul_f32 v18, v18, v50
v_mul_f32 v19, v19, v51
v_mul_f32 v20, v20, v52
v_mul_f32 v21, v21, v53
v_mul_f32 v22, v22, v54
v_mul_f32 v23, v23, v55
v_mul_f32 v24, v24, v56
v_mul_f32 v25, v25, v57
v_mul_f32 v26, v26, v58
v_mul_f32 v27, v27, v59
v_mul_f32 v28, v28, v60
v_mul_f32 v29, v29, v61
v_mul_f32 v30, v30, v62
v_mul_f32_e64 v31, v31, v63
v_cvt_pk_f16_f32 v32, v0, v1
v_cvt_pk_f16_f32 v33, v2, v3
v_cvt_pk_f16_f32 v34, v4, v5
v_cvt_pk_f16_f32 v35, v6, v7
v_cvt_pk_f16_f32 v36, v8, v9
v_cvt_pk_f16_f32 v37, v10, v11
v_cvt_pk_f16_f32 v38, v12, v13
v_cvt_pk_f16_f32 v39, v14, v15
v_cvt_pk_f16_f32 v40, v16, v17
v_cvt_pk_f16_f32 v41, v18, v19
v_cvt_pk_f16_f32 v42, v20, v21
v_cvt_pk_f16_f32 v43, v22, v23
v_cvt_pk_f16_f32 v44, v24, v25
v_cvt_pk_f16_f32 v45, v26, v27
v_cvt_pk_f16_f32 v46, v28, v29
v_cvt_pk_f16_f32 v47, v30, v31
v_add_u32 v32, 131074, v32
v_and_b32 v32, 4294770684, v32
v_add_u32 v33, 131074, v33
v_and_b32 v33, 4294770684, v33
v_add_u32 v34, 131074, v34
v_and_b32 v34, 4294770684, v34
v_add_u32 v35, 131074, v35
v_and_b32 v35, 4294770684, v35
v_add_u32 v36, 131074, v36
v_and_b32 v36, 4294770684, v36
v_add_u32 v37, 131074, v37
v_and_b32 v37, 4294770684, v37
v_add_u32 v38, 131074, v38
v_and_b32 v38, 4294770684, v38
v_add_u32 v39, 131074, v39
v_and_b32 v39, 4294770684, v39
v_add_u32 v40, 131074, v40
v_and_b32 v40, 4294770684, v40
v_add_u32 v41, 131074, v41
v_and_b32 v41, 4294770684, v41
v_add_u32 v42, 131074, v42
v_and_b32 v42, 4294770684, v42
v_add_u32 v43, 131074, v43
v_and_b32 v43, 4294770684, v43
v_add_u32 v44, 131074, v44
v_and_b32 v44, 4294770684, v44
v_add_u32 v45, 131074, v45
v_and_b32 v45, 4294770684, v45
v_add_u32 v46, 131074, v46
v_and_b32 v46, 4294770684, v46
v_add_u32 v47, 131074, v47
v_and_b32 v47, 4294770684, v47
v_lshlrev_b32 v121, 6, v120
v_bfe_u32 v120, v120, 2, 5
v_cmp_ne_u32 vcc, 31, v120
s_and_saveexec_b64 s[74:75], vcc
ds_write_b128 v121, v[32:35]
ds_write_b128 v121, v[36:39] offset:16
ds_write_b128 v121, v[40:43] offset:32
ds_write_b128 v121, v[44:47] offset:48
s_mov_b64 exec, s[74:75]
s_waitcnt vmcnt(10)
v_and_b32 v64, 65535, v126
ds_write_b64 v140, v[64:65]
v_and_b32 v66, 4294901760, v126
ds_write_b64 v140, v[66:67] offset:8
v_and_b32 v69, 65535, v127
ds_write_b64 v140, v[68:69] offset:16
v_and_b32 v71, 4294901760, v127
ds_write_b64 v140, v[70:71] offset:24
s_waitcnt vmcnt(0) lgkmcnt(0)
s_barrier
Lwa:
s_cmp_lt_u32 s40, 4
s_cbranch_scc1 Lsu1
s_waitcnt vmcnt(14)
v_add_u32 v113, 65536, v116
v_add_u32 v114, 65536, v117
ds_read_b64_tr_b16 v[0:1], v116
ds_read_b64_tr_b16 v[2:3], v116 offset:512
ds_read_b64_tr_b16 v[4:5], v116 offset:4096
ds_read_b64_tr_b16 v[6:7], v116 offset:4608
ds_read_b64_tr_b16 v[8:9], v116 offset:8192
ds_read_b64_tr_b16 v[10:11], v116 offset:8704
ds_read_b64_tr_b16 v[12:13], v116 offset:12288
ds_read_b64_tr_b16 v[14:15], v116 offset:12800
ds_read_b64_tr_b16 v[16:17], v116 offset:16384
ds_read_b64_tr_b16 v[18:19], v116 offset:16896
ds_read_b64_tr_b16 v[20:21], v116 offset:20480
ds_read_b64_tr_b16 v[22:23], v116 offset:20992
s_waitcnt lgkmcnt(10)
ds_write_b128 v117, v[0:3]
s_waitcnt lgkmcnt(9)
ds_write_b128 v117, v[4:7] offset:4096
s_waitcnt lgkmcnt(8)
ds_write_b128 v117, v[8:11] offset:8192
s_waitcnt lgkmcnt(7)
ds_write_b128 v117, v[12:15] offset:12288
s_waitcnt lgkmcnt(6)
ds_write_b128 v117, v[16:19] offset:16384
s_waitcnt lgkmcnt(5)
ds_write_b128 v117, v[20:23] offset:20480
v_mov_b32_e64 v223, 1
s_waitcnt lgkmcnt(0)
s_mov_b64 exec, 1
ds_add_u32 v247, v223 offset:8
s_mov_b64 exec, -1
s_nop 0
v_mov_b32_e64 v223, 0
s_branch Law1
Lax1:
s_sleep 2
Law1:
ds_read_b32 v223, v247 offset:16
s_sub_u32 s76, s76, 1
s_cselect_b32 s44, 4, 0
s_cselect_b32 s76, 0, s76
s_waitcnt lgkmcnt(0)
v_readfirstlane_b32 s43, v223
s_nop 1
s_max_u32 s43, s43, s44
s_cmp_lt_u32 s43, 4
s_cbranch_scc1 Lax1
s_add_u32 s81, s81, 6592
s_cmp_eq_u32 s81, 65920
s_cselect_b32 s81, 0, s81
s_add_u32 s43, s81, s67
s_add_u32 m0, s43, 16
s_add_u32 s66, s66, 98304
buffer_load_dwordx4 v236, s[4:7], s66 offen lds
s_add_u32 m0, s43, 912
s_nop 0
buffer_load_dwordx4 v237, s[4:7], s66 offen lds
s_add_u32 s81, s81, 6592
s_cmp_eq_u32 s81, 65920
s_cselect_b32 s81, 0, s81
s_add_u32 s43, s81, s67
s_add_u32 m0, s43, 16
s_add_u32 s66, s66, 98304
buffer_load_dwordx4 v236, s[4:7], s66 offen lds
s_add_u32 m0, s43, 912
s_nop 0
buffer_load_dwordx4 v237, s[4:7], s66 offen lds
s_add_u32 s81, s81, 6592
s_cmp_eq_u32 s81, 65920
s_cselect_b32 s81, 0, s81
s_add_u32 s43, s81, s67
s_add_u32 m0, s43, 32
s_add_u32 s66, s66, 98304
buffer_load_dwordx4 v236, s[4:7], s66 offen lds
s_add_u32 m0, s43, 928
s_nop 0
buffer_load_dwordx4 v237, s[4:7], s66 offen lds
s_add_u32 s81, s81, 6592
s_cmp_eq_u32 s81, 65920
s_cselect_b32 s81, 0, s81
s_add_u32 s43, s81, s67
s_add_u32 m0, s43, 32
s_add_u32 s66, s66, 98304
buffer_load_dwordx4 v236, s[4:7], s66 offen lds
s_add_u32 m0, s43, 928
s_nop 0
buffer_load_dwordx4 v237, s[4:7], s66 offen lds
s_add_u32 s81, s81, 6592
s_cmp_eq_u32 s81, 65920
s_cselect_b32 s81, 0, s81
s_add_u32 s43, s81, s67
s_add_u32 m0, s43, 48
s_add_u32 s66, s66, 98304
buffer_load_dwordx4 v236, s[4:7], s66 offen lds
s_add_u32 m0, s43, 944
s_nop 0
buffer_load_dwordx4 v237, s[4:7], s66 offen lds
s_add_u32 s81, s81, 6592
s_cmp_eq_u32 s81, 65920
s_cselect_b32 s81, 0, s81
s_add_u32 s43, s81, s67
s_add_u32 m0, s43, 48
s_add_u32 s66, s66, 98304
buffer_load_dwordx4 v236, s[4:7], s66 offen lds
s_add_u32 m0, s43, 944
s_nop 0
buffer_load_dwordx4 v237, s[4:7], s66 offen lds
s_add_u32 s81, s81, 6592
s_cmp_eq_u32 s81, 65920
s_cselect_b32 s81, 0, s81
s_add_u32 s43, s81, s67
s_add_u32 m0, s43, 0
s_add_u32 s66, s66, 98304
buffer_load_dwordx4 v236, s[4:7], s66 offen lds
s_add_u32 m0, s43, 896
s_nop 0
buffer_load_dwordx4 v237, s[4:7], s66 offen lds
s_add_u32 s81, s81, 6592
s_cmp_eq_u32 s81, 65920
s_cselect_b32 s81, 0, s81
s_add_u32 s43, s81, s67
s_add_u32 m0, s43, 0
s_add_u32 s66, s66, 98304
buffer_load_dwordx4 v236, s[4:7], s66 offen lds
s_add_u32 m0, s43, 896
s_nop 0
buffer_load_dwordx4 v237, s[4:7], s66 offen lds
s_waitcnt vmcnt(16)
v_add_u32 v113, 65536, v116
v_add_u32 v114, 65536, v117
ds_read_b64_tr_b16 v[0:1], v116 offset:24576
ds_read_b64_tr_b16 v[2:3], v116 offset:25088
ds_read_b64_tr_b16 v[4:5], v116 offset:28672
ds_read_b64_tr_b16 v[6:7], v116 offset:29184
ds_read_b64_tr_b16 v[8:9], v116 offset:32768
ds_read_b64_tr_b16 v[10:11], v116 offset:33280
ds_read_b64_tr_b16 v[12:13], v116 offset:36864
ds_read_b64_tr_b16 v[14:15], v116 offset:37376
ds_read_b64_tr_b16 v[16:17], v116 offset:40960
ds_read_b64_tr_b16 v[18:19], v116 offset:41472
ds_read_b64_tr_b16 v[20:21], v116 offset:45056
ds_read_b64_tr_b16 v[22:23], v116 offset:45568
ds_read_b64_tr_b16 v[24:25], v116 offset:49152
ds_read_b64_tr_b16 v[26:27], v116 offset:49664
ds_read_b64_tr_b16 v[28:29], v116 offset:53248
s_waitcnt lgkmcnt(14)
ds_read_b64_tr_b16 v[30:31], v116 offset:53760
s_waitcnt lgkmcnt(14)
ds_read_b64_tr_b16 v[32:33], v116 offset:57344
s_waitcnt lgkmcnt(14)
ds_read_b64_tr_b16 v[34:35], v116 offset:57856
s_waitcnt lgkmcnt(14)
ds_read_b64_tr_b16 v[36:37], v116 offset:61440
s_waitcnt lgkmcnt(14)
ds_read_b64_tr_b16 v[38:39], v116 offset:61952
s_waitcnt lgkmcnt(14)
ds_read_b64_tr_b16 v[40:41], v113
s_waitcnt lgkmcnt(14)
ds_read_b64_tr_b16 v[42:43], v113 offset:512
s_waitcnt lgkmcnt(14)
ds_read_b64_tr_b16 v[44:45], v113 offset:4096
s_waitcnt lgkmcnt(14)
ds_read_b64_tr_b16 v[46:47], v113 offset:4608
s_waitcnt lgkmcnt(14)
ds_write_b128 v117, v[0:3] offset:24576
s_waitcnt lgkmcnt(14)
ds_write_b128 v117, v[4:7] offset:28672
s_waitcnt lgkmcnt(14)
ds_write_b128 v117, v[8:11] offset:32768
s_waitcnt lgkmcnt(14)
ds_write_b128 v117, v[12:15] offset:36864
s_waitcnt lgkmcnt(14)
ds_write_b128 v117, v[16:19] offset:40960
s_waitcnt lgkmcnt(14)
ds_write_b128 v117, v[20:23] offset:45056
s_waitcnt lgkmcnt(14)
ds_write_b128 v117, v[24:27] offset:49152
s_waitcnt lgkmcnt(14)
ds_write_b128 v117, v[28:31] offset:53248
s_waitcnt lgkmcnt(14)
ds_write_b128 v117, v[32:35] offset:57344
s_waitcnt lgkmcnt(14)
s_waitcnt lgkmcnt(13)
ds_write_b128 v117, v[36:39] offset:61440
s_waitcnt lgkmcnt(12)
ds_write_b128 v114, v[40:43]
s_waitcnt lgkmcnt(11)
ds_write_b128 v114, v[44:47] offset:4096
v_mov_b32 v223, 1
s_waitcnt lgkmcnt(0)
s_mov_b64 exec, 1
ds_add_u32 v247, v223 offset:12
s_mov_b64 exec, -1
s_cmp_lg_u32 s40, 7
s_cbranch_scc1 Lnosent
v_bfe_u32 v104, v250, 4, 6
v_mov_b32 v108, -1
v_mov_b32 v109, -1
v_mov_b32 v110, -1
v_mov_b32 v111, -1
v_lshlrev_b32_e64 v100, 12, v104
v_add_u32 v101, 262144, v100
v_cmp_gt_u32 vcc, 32, v104
v_mov_b32 v105, 2147483648
s_nop 0
v_cndmask_b32 v101, v105, v101, vcc
s_lshl_b32 s43, s2, 4
buffer_store_dwordx4 v[108:111], v100, s[32:35], s43 offen sc1
buffer_store_dwordx4 v[108:111], v101, s[32:35], s43 offen sc1
s_add_u32 s43, s43, 393216
s_cmp_lt_u32 s2, 96
s_cselect_b32 s43, s43, 1073741824
v_lshlrev_b32 v103, 11, v104
s_mov_b64 exec, 0xff
buffer_store_dwordx4 v[108:111], v103, s[32:35], s43 offen sc1
s_mov_b64 exec, -1
s_nop 1
Lnosent:
s_setprio 3
s_waitcnt vmcnt(0)
Lsu1:
s_add_u32 s43, s81, 6592
v_add_u32_e64 v212, s43, v246
v_subrev_u32 v222, 65920, v212
v_min_u32_e64 v212, v212, v222
v_add_u32 v212, 90112, v212
v_add_u32_e64 v213, s43, v246
v_add_u32 v213, 6592, v213
v_subrev_u32 v222, 65920, v213
v_min_u32_e64 v213, v213, v222
v_add_u32 v213, 90112, v213
v_add_u32_e64 v214, s43, v246
v_add_u32 v214, 13184, v214
v_add_u32_e64 v222, 16, v214
v_bfi_b32 v214, 48, v222, v214
v_subrev_u32 v222, 65920, v214
v_min_u32_e64 v214, v214, v222
v_add_u32 v214, 90112, v214
v_add_u32_e64 v215, s43, v246
v_add_u32 v215, 19776, v215
v_add_u32_e64 v222, 16, v215
v_bfi_b32 v215, 48, v222, v215
v_subrev_u32 v222, 65920, v215
v_min_u32 v215, v215, v222
v_add_u32 v215, 90112, v215
ds_read_b128 v[144:147], v212
ds_read_b64 v[192:193], v238
ds_read_b64 v[194:195], v239
ds_read_b128 v[148:151], v213
ds_read_b128 v[152:155], v214
ds_read_b64 v[196:197], v238 offset:2400
ds_read_b64 v[198:199], v239 offset:2400
ds_read_b128 v[156:159], v215
ds_read_b64 v[200:201], v238 offset:4800
ds_read_b64 v[202:203], v239 offset:4800
ds_read_b128 v[160:163], v212 offset:16
ds_read_b64 v[204:205], v238 offset:200
ds_read_b64 v[206:207], v239 offset:200
ds_read_b128 v[164:167], v213 offset:16
ds_read_b128 v[168:171], v214 offset:16
s_waitcnt lgkmcnt(14)
ds_read_b64 v[208:209], v238 offset:2600
s_waitcnt lgkmcnt(13)
v_mfma_f32_16x16x32_bf16 v[0:3], v[192:195], v[144:147], 0
ds_read_b64 v[210:211], v239 offset:2600
ds_read_b128 v[172:175], v215 offset:16
s_waitcnt lgkmcnt(14)
v_mfma_f32_16x16x32_bf16 v[48:51], v[192:195], v[148:151], 0
ds_read_b64 v[192:193], v238 offset:5000
s_waitcnt lgkmcnt(14)
ds_read_b64 v[194:195], v239 offset:5000
s_waitcnt lgkmcnt(13)
v_mfma_f32_16x16x32_bf16 v[0:3], v[196:199], v[148:151], v[0:3]
ds_read_b128 v[144:147], v212 offset:32
ds_read_b128 v[148:151], v213 offset:32
v_mfma_f32_16x16x32_bf16 v[48:51], v[196:199], v[152:155], v[48:51]
s_waitcnt lgkmcnt(14)
ds_read_b64 v[196:197], v238 offset:400
s_waitcnt lgkmcnt(14)
ds_read_b64 v[198:199], v239 offset:400
s_waitcnt lgkmcnt(14)
v_mfma_f32_16x16x32_bf16 v[0:3], v[200:203], v[152:155], v[0:3]
ds_read_b128 v[152:155], v214 offset:32
v_mfma_f32_16x16x32_bf16 v[48:51], v[200:203], v[156:159], v[48:51]
s_waitcnt lgkmcnt(14)
ds_read_b64 v[200:201], v238 offset:2800
s_waitcnt lgkmcnt(14)
ds_read_b64 v[202:203], v239 offset:2800
s_waitcnt lgkmcnt(14)
v_mfma_f32_16x16x32_bf16 v[4:7], v[204:207], v[160:163], 0
ds_read_b128 v[156:159], v215 offset:32
s_waitcnt lgkmcnt(14)
v_mfma_f32_16x16x32_bf16 v[52:55], v[204:207], v[164:167], 0
ds_read_b64 v[204:205], v238 offset:5200
s_waitcnt lgkmcnt(14)
ds_read_b64 v[206:207], v239 offset:5200
s_waitcnt lgkmcnt(13)
v_mfma_f32_16x16x32_bf16 v[4:7], v[208:211], v[164:167], v[4:7]
ds_read_b128 v[160:163], v212 offset:48
ds_read_b128 v[164:167], v213 offset:48
v_mfma_f32_16x16x32_bf16 v[52:55], v[208:211], v[168:171], v[52:55]
s_waitcnt lgkmcnt(14)
ds_read_b64 v[208:209], v238 offset:600
s_waitcnt lgkmcnt(14)
ds_read_b64 v[210:211], v239 offset:600
s_waitcnt lgkmcnt(14)
v_mfma_f32_16x16x32_bf16 v[4:7], v[192:195], v[168:171], v[4:7]
ds_read_b128 v[168:171], v214 offset:48
v_mfma_f32_16x16x32_bf16 v[52:55], v[192:195], v[172:175], v[52:55]
s_waitcnt lgkmcnt(14)
ds_read_b64 v[192:193], v238 offset:3000
s_waitcnt lgkmcnt(14)
ds_read_b64 v[194:195], v239 offset:3000
s_waitcnt lgkmcnt(13)
v_mfma_f32_16x16x32_bf16 v[8:11], v[196:199], v[144:147], 0
ds_read_b128 v[172:175], v215 offset:48
ds_read_b128 v[144:147], v212 offset:64
v_mfma_f32_16x16x32_bf16 v[56:59], v[196:199], v[148:151], 0
s_waitcnt lgkmcnt(14)
ds_read_b64 v[196:197], v238 offset:5400
s_waitcnt lgkmcnt(14)
ds_read_b64 v[198:199], v239 offset:5400
s_waitcnt lgkmcnt(14)
v_mfma_f32_16x16x32_bf16 v[8:11], v[200:203], v[148:151], v[8:11]
ds_read_b128 v[148:151], v213 offset:64
v_mfma_f32_16x16x32_bf16 v[56:59], v[200:203], v[152:155], v[56:59]
s_waitcnt lgkmcnt(14)
ds_read_b64 v[200:201], v238 offset:800
s_waitcnt lgkmcnt(14)
ds_read_b64 v[202:203], v239 offset:800
s_waitcnt lgkmcnt(14)
v_mfma_f32_16x16x32_bf16 v[8:11], v[204:207], v[152:155], v[8:11]
ds_read_b128 v[152:155], v214 offset:64
v_mfma_f32_16x16x32_bf16 v[56:59], v[204:207], v[156:159], v[56:59]
s_waitcnt lgkmcnt(14)
ds_read_b64 v[204:205], v238 offset:3200
s_waitcnt lgkmcnt(14)
ds_read_b64 v[206:207], v239 offset:3200
s_waitcnt lgkmcnt(13)
v_mfma_f32_16x16x32_bf16 v[12:15], v[208:211], v[160:163], 0
ds_read_b128 v[156:159], v215 offset:64
ds_read_b128 v[160:163], v212 offset:80
v_mfma_f32_16x16x32_bf16 v[60:63], v[208:211], v[164:167], 0
s_waitcnt lgkmcnt(14)
ds_read_b64 v[208:209], v238 offset:5600
s_waitcnt lgkmcnt(14)
ds_read_b64 v[210:211], v239 offset:5600
s_waitcnt lgkmcnt(14)
v_mfma_f32_16x16x32_bf16 v[12:15], v[192:195], v[164:167], v[12:15]
ds_read_b128 v[164:167], v213 offset:80
v_mfma_f32_16x16x32_bf16 v[60:63], v[192:195], v[168:171], v[60:63]
s_waitcnt lgkmcnt(14)
ds_read_b64 v[192:193], v238 offset:1000
s_waitcnt lgkmcnt(14)
ds_read_b64 v[194:195], v239 offset:1000
s_waitcnt lgkmcnt(13)
v_mfma_f32_16x16x32_bf16 v[12:15], v[196:199], v[168:171], v[12:15]
ds_read_b128 v[168:171], v214 offset:80
v_mfma_f32_16x16x32_bf16 v[60:63], v[196:199], v[172:175], v[60:63]
ds_read_b64 v[196:197], v238 offset:3400
s_waitcnt lgkmcnt(14)
ds_read_b64 v[198:199], v239 offset:3400
s_waitcnt lgkmcnt(13)
v_mfma_f32_16x16x32_bf16 v[16:19], v[200:203], v[144:147], 0
ds_read_b128 v[172:175], v215 offset:80
ds_read_b128 v[144:147], v212 offset:96
v_mfma_f32_16x16x32_bf16 v[64:67], v[200:203], v[148:151], 0
s_waitcnt lgkmcnt(14)
ds_read_b64 v[200:201], v238 offset:5800
s_waitcnt lgkmcnt(14)
ds_read_b64 v[202:203], v239 offset:5800
s_waitcnt lgkmcnt(14)
v_mfma_f32_16x16x32_bf16 v[16:19], v[204:207], v[148:151], v[16:19]
ds_read_b128 v[148:151], v213 offset:96
v_mfma_f32_16x16x32_bf16 v[64:67], v[204:207], v[152:155], v[64:67]
s_waitcnt lgkmcnt(14)
ds_read_b64 v[204:205], v238 offset:1200
s_waitcnt lgkmcnt(14)
ds_read_b64 v[206:207], v239 offset:1200
s_waitcnt lgkmcnt(13)
v_mfma_f32_16x16x32_bf16 v[16:19], v[208:211], v[152:155], v[16:19]
ds_read_b128 v[152:155], v214 offset:96
v_mfma_f32_16x16x32_bf16 v[64:67], v[208:211], v[156:159], v[64:67]
ds_read_b64 v[208:209], v238 offset:3600
s_waitcnt lgkmcnt(14)
ds_read_b64 v[210:211], v239 offset:3600
s_waitcnt lgkmcnt(13)
v_mfma_f32_16x16x32_bf16 v[20:23], v[192:195], v[160:163], 0
ds_read_b128 v[156:159], v215 offset:96
ds_read_b128 v[160:163], v212 offset:112
v_mfma_f32_16x16x32_bf16 v[68:71], v[192:195], v[164:167], 0
s_waitcnt lgkmcnt(14)
ds_read_b64 v[192:193], v238 offset:6000
s_waitcnt lgkmcnt(14)
ds_read_b64 v[194:195], v239 offset:6000
s_waitcnt lgkmcnt(14)
v_mfma_f32_16x16x32_bf16 v[20:23], v[196:199], v[164:167], v[20:23]
ds_read_b128 v[164:167], v213 offset:112
v_mfma_f32_16x16x32_bf16 v[68:71], v[196:199], v[168:171], v[68:71]
s_waitcnt lgkmcnt(14)
ds_read_b64 v[196:197], v238 offset:1400
s_waitcnt lgkmcnt(14)
ds_read_b64 v[198:199], v239 offset:1400
s_waitcnt lgkmcnt(13)
v_mfma_f32_16x16x32_bf16 v[20:23], v[200:203], v[168:171], v[20:23]
ds_read_b128 v[168:171], v214 offset:112
v_mfma_f32_16x16x32_bf16 v[68:71], v[200:203], v[172:175], v[68:71]
ds_read_b64 v[200:201], v238 offset:3800
s_waitcnt lgkmcnt(14)
ds_read_b64 v[202:203], v239 offset:3800
s_waitcnt lgkmcnt(13)
v_mfma_f32_16x16x32_bf16 v[24:27], v[204:207], v[144:147], 0
ds_read_b128 v[172:175], v215 offset:112
ds_read_b128 v[144:147], v212 offset:128
v_mfma_f32_16x16x32_bf16 v[72:75], v[204:207], v[148:151], 0
s_waitcnt lgkmcnt(14)
ds_read_b64 v[204:205], v238 offset:6200
s_waitcnt lgkmcnt(14)
ds_read_b64 v[206:207], v239 offset:6200
s_waitcnt lgkmcnt(14)
v_mfma_f32_16x16x32_bf16 v[24:27], v[208:211], v[148:151], v[24:27]
ds_read_b128 v[148:151], v213 offset:128
v_mfma_f32_16x16x32_bf16 v[72:75], v[208:211], v[152:155], v[72:75]
s_waitcnt lgkmcnt(14)
ds_read_b64 v[208:209], v238 offset:1600
s_waitcnt lgkmcnt(14)
ds_read_b64 v[210:211], v239 offset:1600
s_waitcnt lgkmcnt(13)
v_mfma_f32_16x16x32_bf16 v[24:27], v[192:195], v[152:155], v[24:27]
ds_read_b128 v[152:155], v214 offset:128
v_mfma_f32_16x16x32_bf16 v[72:75], v[192:195], v[156:159], v[72:75]
ds_read_b64 v[192:193], v238 offset:4000
s_waitcnt lgkmcnt(14)
ds_read_b64 v[194:195], v239 offset:4000
s_waitcnt lgkmcnt(13)
v_mfma_f32_16x16x32_bf16 v[28:31], v[196:199], v[160:163], 0
ds_read_b128 v[156:159], v215 offset:128
ds_read_b128 v[160:163], v212 offset:144
v_mfma_f32_16x16x32_bf16 v[76:79], v[196:199], v[164:167], 0
s_waitcnt lgkmcnt(14)
ds_read_b64 v[196:197], v238 offset:6400
s_waitcnt lgkmcnt(14)
ds_read_b64 v[198:199], v239 offset:6400
s_waitcnt lgkmcnt(14)
v_mfma_f32_16x16x32_bf16 v[28:31], v[200:203], v[164:167], v[28:31]
ds_read_b128 v[164:167], v213 offset:144
v_mfma_f32_16x16x32_bf16 v[76:79], v[200:203], v[168:171], v[76:79]
s_waitcnt lgkmcnt(14)
ds_read_b64 v[200:201], v238 offset:1800
s_waitcnt lgkmcnt(14)
ds_read_b64 v[202:203], v239 offset:1800
s_waitcnt lgkmcnt(13)
v_mfma_f32_16x16x32_bf16 v[28:31], v[204:207], v[168:171], v[28:31]
ds_read_b128 v[168:171], v214 offset:144
v_mfma_f32_16x16x32_bf16 v[76:79], v[204:207], v[172:175], v[76:79]
ds_read_b64 v[204:205], v238 offset:4200
s_waitcnt lgkmcnt(14)
ds_read_b64 v[206:207], v239 offset:4200
s_waitcnt lgkmcnt(13)
v_mfma_f32_16x16x32_bf16 v[32:35], v[208:211], v[144:147], 0
ds_read_b128 v[172:175], v215 offset:144
ds_read_b128 v[144:147], v212 offset:160
v_mfma_f32_16x16x32_bf16 v[80:83], v[208:211], v[148:151], 0
s_waitcnt lgkmcnt(14)
ds_read_b64 v[208:209], v238 offset:6600
s_waitcnt lgkmcnt(14)
ds_read_b64 v[210:211], v239 offset:6600
s_waitcnt lgkmcnt(14)
v_mfma_f32_16x16x32_bf16 v[32:35], v[192:195], v[148:151], v[32:35]
ds_read_b128 v[148:151], v213 offset:160
v_mfma_f32_16x16x32_bf16 v[80:83], v[192:195], v[152:155], v[80:83]
s_waitcnt lgkmcnt(14)
ds_read_b64 v[192:193], v238 offset:2000
s_waitcnt lgkmcnt(14)
ds_read_b64 v[194:195], v239 offset:2000
s_waitcnt lgkmcnt(13)
v_mfma_f32_16x16x32_bf16 v[32:35], v[196:199], v[152:155], v[32:35]
ds_read_b128 v[152:155], v214 offset:160
v_mfma_f32_16x16x32_bf16 v[80:83], v[196:199], v[156:159], v[80:83]
ds_read_b64 v[196:197], v238 offset:4400
s_waitcnt lgkmcnt(14)
ds_read_b64 v[198:199], v239 offset:4400
s_waitcnt lgkmcnt(13)
v_mfma_f32_16x16x32_bf16 v[36:39], v[200:203], v[160:163], 0
ds_read_b128 v[156:159], v215 offset:160
ds_read_b128 v[160:163], v212 offset:176
v_mfma_f32_16x16x32_bf16 v[84:87], v[200:203], v[164:167], 0
s_waitcnt lgkmcnt(14)
ds_read_b64 v[200:201], v238 offset:6800
s_waitcnt lgkmcnt(14)
ds_read_b64 v[202:203], v239 offset:6800
s_waitcnt lgkmcnt(14)
v_mfma_f32_16x16x32_bf16 v[36:39], v[204:207], v[164:167], v[36:39]
ds_read_b128 v[164:167], v213 offset:176
v_mfma_f32_16x16x32_bf16 v[84:87], v[204:207], v[168:171], v[84:87]
s_waitcnt lgkmcnt(14)
ds_read_b64 v[204:205], v238 offset:2200
s_waitcnt lgkmcnt(14)
ds_read_b64 v[206:207], v239 offset:2200
s_waitcnt lgkmcnt(13)
v_mfma_f32_16x16x32_bf16 v[36:39], v[208:211], v[168:171], v[36:39]
ds_read_b128 v[168:171], v214 offset:176
v_mfma_f32_16x16x32_bf16 v[84:87], v[208:211], v[172:175], v[84:87]
ds_read_b64 v[208:209], v238 offset:4600
s_waitcnt lgkmcnt(14)
ds_read_b64 v[210:211], v239 offset:4600
s_waitcnt lgkmcnt(13)
v_mfma_f32_16x16x32_bf16 v[40:43], v[192:195], v[144:147], 0
ds_read_b128 v[172:175], v215 offset:176
v_mfma_f32_16x16x32_bf16 v[88:91], v[192:195], v[148:151], 0
ds_read_b64 v[192:193], v238 offset:7000
s_waitcnt lgkmcnt(14)
ds_read_b64 v[194:195], v239 offset:7000
s_waitcnt lgkmcnt(13)
v_mfma_f32_16x16x32_bf16 v[40:43], v[196:199], v[148:151], v[40:43]
v_mfma_f32_16x16x32_bf16 v[88:91], v[196:199], v[152:155], v[88:91]
s_waitcnt lgkmcnt(9)
v_mfma_f32_16x16x32_bf16 v[40:43], v[200:203], v[152:155], v[40:43]
v_mfma_f32_16x16x32_bf16 v[88:91], v[200:203], v[156:159], v[88:91]
s_waitcnt lgkmcnt(6)
v_mfma_f32_16x16x32_bf16 v[44:47], v[204:207], v[160:163], 0
v_mfma_f32_16x16x32_bf16 v[92:95], v[204:207], v[164:167], 0
s_waitcnt lgkmcnt(3)
v_mfma_f32_16x16x32_bf16 v[44:47], v[208:211], v[164:167], v[44:47]
v_mfma_f32_16x16x32_bf16 v[92:95], v[208:211], v[168:171], v[92:95]
s_waitcnt lgkmcnt(0)
v_mfma_f32_16x16x32_bf16 v[44:47], v[192:195], v[168:171], v[44:47]
v_mfma_f32_16x16x32_bf16 v[92:95], v[192:195], v[172:175], v[92:95]
v_mov_b32_e64 v223, 1
v_add_u32 v222, s83, v247
s_nop 7
s_mov_b64 exec, 1
ds_add_u32 v222, v223 offset:16
s_mov_b64 exec, -1
v_pk_mul_f32 v[242:243], v[0:1], v[0:1]
v_pk_add_f32 v[240:241], v[0:1], v[2:3]
v_pk_fma_f32 v[242:243], v[2:3], v[2:3], v[242:243]
v_pk_mul_f32 v[218:219], v[48:49], v[48:49]
v_pk_add_f32 v[216:217], v[48:49], v[50:51]
v_pk_fma_f32 v[218:219], v[50:51], v[50:51], v[218:219]
v_pk_fma_f32 v[242:243], v[4:5], v[4:5], v[242:243]
v_pk_add_f32 v[240:241], v[240:241], v[4:5]
v_pk_fma_f32 v[242:243], v[6:7], v[6:7], v[242:243]
v_pk_add_f32 v[240:241], v[240:241], v[6:7]
v_pk_fma_f32 v[218:219], v[52:53], v[52:53], v[218:219]
v_pk_add_f32 v[216:217], v[216:217], v[52:53]
v_pk_fma_f32 v[218:219], v[54:55], v[54:55], v[218:219]
v_pk_add_f32 v[216:217], v[216:217], v[54:55]
v_pk_fma_f32 v[242:243], v[8:9], v[8:9], v[242:243]
v_pk_add_f32 v[240:241], v[240:241], v[8:9]
v_pk_fma_f32 v[242:243], v[10:11], v[10:11], v[242:243]
v_pk_add_f32 v[240:241], v[240:241], v[10:11]
v_pk_fma_f32 v[218:219], v[56:57], v[56:57], v[218:219]
v_pk_add_f32 v[216:217], v[216:217], v[56:57]
v_pk_fma_f32 v[218:219], v[58:59], v[58:59], v[218:219]
v_pk_add_f32 v[216:217], v[216:217], v[58:59]
v_pk_fma_f32 v[242:243], v[12:13], v[12:13], v[242:243]
v_pk_add_f32 v[240:241], v[240:241], v[12:13]
v_pk_fma_f32 v[242:243], v[14:15], v[14:15], v[242:243]
v_pk_add_f32 v[240:241], v[240:241], v[14:15]
v_pk_fma_f32 v[218:219], v[60:61], v[60:61], v[218:219]
v_pk_add_f32 v[216:217], v[216:217], v[60:61]
v_pk_fma_f32 v[218:219], v[62:63], v[62:63], v[218:219]
v_pk_add_f32 v[216:217], v[216:217], v[62:63]
v_pk_fma_f32 v[242:243], v[16:17], v[16:17], v[242:243]
v_pk_add_f32 v[240:241], v[240:241], v[16:17]
v_pk_fma_f32 v[242:243], v[18:19], v[18:19], v[242:243]
v_pk_add_f32 v[240:241], v[240:241], v[18:19]
v_pk_fma_f32 v[218:219], v[64:65], v[64:65], v[218:219]
v_pk_add_f32 v[216:217], v[216:217], v[64:65]
v_pk_fma_f32 v[218:219], v[66:67], v[66:67], v[218:219]
v_pk_add_f32 v[216:217], v[216:217], v[66:67]
v_pk_fma_f32 v[242:243], v[20:21], v[20:21], v[242:243]
v_pk_add_f32 v[240:241], v[240:241], v[20:21]
v_pk_fma_f32 v[242:243], v[22:23], v[22:23], v[242:243]
v_pk_add_f32 v[240:241], v[240:241], v[22:23]
v_pk_fma_f32 v[218:219], v[68:69], v[68:69], v[218:219]
v_pk_add_f32 v[216:217], v[216:217], v[68:69]
v_pk_fma_f32 v[218:219], v[70:71], v[70:71], v[218:219]
v_pk_add_f32 v[216:217], v[216:217], v[70:71]
v_pk_fma_f32 v[242:243], v[24:25], v[24:25], v[242:243]
v_pk_add_f32 v[240:241], v[240:241], v[24:25]
v_pk_fma_f32 v[242:243], v[26:27], v[26:27], v[242:243]
v_pk_add_f32 v[240:241], v[240:241], v[26:27]
v_pk_fma_f32 v[218:219], v[72:73], v[72:73], v[218:219]
v_pk_add_f32 v[216:217], v[216:217], v[72:73]
v_pk_fma_f32 v[218:219], v[74:75], v[74:75], v[218:219]
v_pk_add_f32 v[216:217], v[216:217], v[74:75]
v_pk_fma_f32 v[242:243], v[28:29], v[28:29], v[242:243]
v_pk_add_f32 v[240:241], v[240:241], v[28:29]
v_pk_fma_f32 v[242:243], v[30:31], v[30:31], v[242:243]
v_pk_add_f32 v[240:241], v[240:241], v[30:31]
v_pk_fma_f32 v[218:219], v[76:77], v[76:77], v[218:219]
v_pk_add_f32 v[216:217], v[216:217], v[76:77]
v_pk_fma_f32 v[218:219], v[78:79], v[78:79], v[218:219]
v_pk_add_f32 v[216:217], v[216:217], v[78:79]
v_pk_fma_f32 v[242:243], v[32:33], v[32:33], v[242:243]
v_pk_add_f32 v[240:241], v[240:241], v[32:33]
v_pk_fma_f32 v[242:243], v[34:35], v[34:35], v[242:243]
v_pk_add_f32 v[240:241], v[240:241], v[34:35]
v_pk_fma_f32 v[218:219], v[80:81], v[80:81], v[218:219]
v_pk_add_f32 v[216:217], v[216:217], v[80:81]
v_pk_fma_f32 v[218:219], v[82:83], v[82:83], v[218:219]
v_pk_add_f32 v[216:217], v[216:217], v[82:83]
v_pk_fma_f32 v[242:243], v[36:37], v[36:37], v[242:243]
v_pk_add_f32 v[240:241], v[240:241], v[36:37]
v_pk_fma_f32 v[242:243], v[38:39], v[38:39], v[242:243]
v_pk_add_f32 v[240:241], v[240:241], v[38:39]
v_pk_fma_f32 v[218:219], v[84:85], v[84:85], v[218:219]
v_pk_add_f32 v[216:217], v[216:217], v[84:85]
v_pk_fma_f32 v[218:219], v[86:87], v[86:87], v[218:219]
v_pk_add_f32 v[216:217], v[216:217], v[86:87]
v_pk_fma_f32 v[242:243], v[40:41], v[40:41], v[242:243]
v_pk_add_f32 v[240:241], v[240:241], v[40:41]
v_pk_fma_f32 v[242:243], v[42:43], v[42:43], v[242:243]
v_pk_add_f32 v[240:241], v[240:241], v[42:43]
v_pk_fma_f32 v[218:219], v[88:89], v[88:89], v[218:219]
v_pk_add_f32 v[216:217], v[216:217], v[88:89]
v_pk_fma_f32 v[218:219], v[90:91], v[90:91], v[218:219]
v_pk_add_f32 v[216:217], v[216:217], v[90:91]
v_pk_fma_f32 v[242:243], v[44:45], v[44:45], v[242:243]
v_pk_add_f32 v[240:241], v[240:241], v[44:45]
v_pk_fma_f32 v[242:243], v[46:47], v[46:47], v[242:243]
v_pk_add_f32 v[240:241], v[240:241], v[46:47]
v_pk_fma_f32 v[218:219], v[92:93], v[92:93], v[218:219]
v_pk_add_f32 v[216:217], v[216:217], v[92:93]
v_pk_fma_f32 v[218:219], v[94:95], v[94:95], v[218:219]
v_pk_add_f32 v[216:217], v[216:217], v[94:95]
v_add_f32 v218, v218, v219
v_add_f32 v216, v216, v217
s_nop 1
v_permlane32_swap_b32 v216, v218
v_add_f32_e64 v216, v216, v218
v_mul_f32 v216, 1009429163, v216
v_mov_b32_e64 v218, v216
s_nop 1
v_permlane32_swap_b32 v216, v218
v_fma_f32 v218, -v216, v216, v218
v_max_f32_e64 v218, 0, v218
v_add_f32 v218, 925353388, v218
v_rsq_f32 v218, v218
v_add_f32 v240, v240, v241
v_mul_f32 v220, 3203396952, v218
v_mul_f32 v221, 3203396952, v218
v_mul_f32 v218, v216, v220
v_mul_f32 v219, v216, v220
v_add_f32 v242, v242, v243
s_nop 1
v_permlane32_swap_b32 v240, v242
v_add_f32 v240, v240, v242
v_mul_f32 v240, 1009429163, v240
v_mov_b32_e64 v242, v240
s_nop 1
v_permlane32_swap_b32 v240, v242
v_fma_f32 v242, -v240, v240, v242
v_max_f32_e64 v242, 0, v242
v_add_f32 v242, 925353388, v242
v_rsq_f32 v242, v242
s_nop 0
v_mul_f32 v244, 3203396952, v242
v_mul_f32 v245, 3203396952, v242
v_mul_f32 v242, v240, v244
v_mul_f32 v243, v240, v244
v_pk_fma_f32 v[0:1], v[0:1], v[244:245], v[242:243] neg_lo:[0,0,1] neg_hi:[0,0,1]
v_pk_fma_f32 v[2:3], v[2:3], v[244:245], v[242:243] neg_lo:[0,0,1] neg_hi:[0,0,1]
v_cvt_pk_bf16_f32 v0, v0, v1
v_cvt_pk_bf16_f32 v1, v2, v3
v_pk_fma_f32 v[4:5], v[4:5], v[244:245], v[242:243] neg_lo:[0,0,1] neg_hi:[0,0,1]
v_pk_fma_f32 v[6:7], v[6:7], v[244:245], v[242:243] neg_lo:[0,0,1] neg_hi:[0,0,1]
v_cvt_pk_bf16_f32 v2, v4, v5
v_cvt_pk_bf16_f32 v3, v6, v7
v_pk_fma_f32 v[8:9], v[8:9], v[244:245], v[242:243] neg_lo:[0,0,1] neg_hi:[0,0,1]
v_pk_fma_f32 v[10:11], v[10:11], v[244:245], v[242:243] neg_lo:[0,0,1] neg_hi:[0,0,1]
v_cvt_pk_bf16_f32 v4, v8, v9
v_cvt_pk_bf16_f32 v5, v10, v11
v_pk_fma_f32 v[12:13], v[12:13], v[244:245], v[242:243] neg_lo:[0,0,1] neg_hi:[0,0,1]
v_pk_fma_f32 v[14:15], v[14:15], v[244:245], v[242:243] neg_lo:[0,0,1] neg_hi:[0,0,1]
v_cvt_pk_bf16_f32 v6, v12, v13
v_cvt_pk_bf16_f32 v7, v14, v15
v_pk_fma_f32 v[16:17], v[16:17], v[244:245], v[242:243] neg_lo:[0,0,1] neg_hi:[0,0,1]
v_pk_fma_f32 v[18:19], v[18:19], v[244:245], v[242:243] neg_lo:[0,0,1] neg_hi:[0,0,1]
v_cvt_pk_bf16_f32 v8, v16, v17
v_cvt_pk_bf16_f32 v9, v18, v19
v_pk_fma_f32 v[20:21], v[20:21], v[244:245], v[242:243] neg_lo:[0,0,1] neg_hi:[0,0,1]
v_pk_fma_f32 v[22:23], v[22:23], v[244:245], v[242:243] neg_lo:[0,0,1] neg_hi:[0,0,1]
v_cvt_pk_bf16_f32 v10, v20, v21
v_cvt_pk_bf16_f32 v11, v22, v23
v_pk_fma_f32 v[24:25], v[24:25], v[244:245], v[242:243] neg_lo:[0,0,1] neg_hi:[0,0,1]
v_pk_fma_f32 v[26:27], v[26:27], v[244:245], v[242:243] neg_lo:[0,0,1] neg_hi:[0,0,1]
v_cvt_pk_bf16_f32 v12, v24, v25
v_cvt_pk_bf16_f32 v13, v26, v27
v_mov_b32 v223, 0
s_branch Law2
Lax2:
s_sleep 2
Law2:
ds_read_b32 v223, v247 offset:8
s_sub_u32 s76, s76, 1
s_cselect_b32 s44, 4, 0
s_cselect_b32 s76, 0, s76
s_waitcnt lgkmcnt(0)
v_readfirstlane_b32 s43, v223
s_nop 1
s_max_u32 s43, s43, s44
s_cmp_lt_u32 s43, 4
s_cbranch_scc1 Lax2
v_pk_fma_f32 v[28:29], v[28:29], v[244:245], v[242:243] neg_lo:[0,0,1] neg_hi:[0,0,1]
v_pk_fma_f32 v[30:31], v[30:31], v[244:245], v[242:243] neg_lo:[0,0,1] neg_hi:[0,0,1]
v_cvt_pk_bf16_f32 v14, v28, v29
v_cvt_pk_bf16_f32 v15, v30, v31
v_pk_fma_f32 v[32:33], v[32:33], v[244:245], v[242:243] neg_lo:[0,0,1] neg_hi:[0,0,1]
v_pk_fma_f32 v[34:35], v[34:35], v[244:245], v[242:243] neg_lo:[0,0,1] neg_hi:[0,0,1]
v_cvt_pk_bf16_f32 v16, v32, v33
v_cvt_pk_bf16_f32 v17, v34, v35
v_pk_fma_f32 v[36:37], v[36:37], v[244:245], v[242:243] neg_lo:[0,0,1] neg_hi:[0,0,1]
v_pk_fma_f32 v[38:39], v[38:39], v[244:245], v[242:243] neg_lo:[0,0,1] neg_hi:[0,0,1]
v_cvt_pk_bf16_f32 v18, v36, v37
v_cvt_pk_bf16_f32 v19, v38, v39
v_pk_fma_f32 v[40:41], v[40:41], v[244:245], v[242:243] neg_lo:[0,0,1] neg_hi:[0,0,1]
v_pk_fma_f32 v[42:43], v[42:43], v[244:245], v[242:243] neg_lo:[0,0,1] neg_hi:[0,0,1]
v_cvt_pk_bf16_f32 v20, v40, v41
v_cvt_pk_bf16_f32 v21, v42, v43
v_pk_fma_f32 v[44:45], v[44:45], v[244:245], v[242:243] neg_lo:[0,0,1] neg_hi:[0,0,1]
v_pk_fma_f32 v[46:47], v[46:47], v[244:245], v[242:243] neg_lo:[0,0,1] neg_hi:[0,0,1]
v_cvt_pk_bf16_f32 v22, v44, v45
v_cvt_pk_bf16_f32 v23, v46, v47
v_pk_fma_f32 v[48:49], v[48:49], v[220:221], v[218:219] neg_lo:[0,0,1] neg_hi:[0,0,1]
ds_read_b128 v[176:179], v250
v_cvt_pk_bf16_f32 v24, v48, v49
v_pk_fma_f32 v[50:51], v[50:51], v[220:221], v[218:219] neg_lo:[0,0,1] neg_hi:[0,0,1]
v_pk_fma_f32 v[52:53], v[52:53], v[220:221], v[218:219] neg_lo:[0,0,1] neg_hi:[0,0,1]
v_cvt_pk_bf16_f32 v25, v50, v51
v_cvt_pk_bf16_f32 v26, v52, v53
v_pk_fma_f32 v[54:55], v[54:55], v[220:221], v[218:219] neg_lo:[0,0,1] neg_hi:[0,0,1]
v_pk_fma_f32 v[56:57], v[56:57], v[220:221], v[218:219] neg_lo:[0,0,1] neg_hi:[0,0,1]
v_cvt_pk_bf16_f32 v27, v54, v55
v_cvt_pk_bf16_f32 v28, v56, v57
v_pk_fma_f32 v[58:59], v[58:59], v[220:221], v[218:219] neg_lo:[0,0,1] neg_hi:[0,0,1]
v_pk_fma_f32 v[60:61], v[60:61], v[220:221], v[218:219] neg_lo:[0,0,1] neg_hi:[0,0,1]
v_cvt_pk_bf16_f32 v29, v58, v59
v_cvt_pk_bf16_f32 v30, v60, v61
v_pk_fma_f32 v[62:63], v[62:63], v[220:221], v[218:219] neg_lo:[0,0,1] neg_hi:[0,0,1]
v_pk_fma_f32 v[64:65], v[64:65], v[220:221], v[218:219] neg_lo:[0,0,1] neg_hi:[0,0,1]
v_cvt_pk_bf16_f32 v31, v62, v63
v_cvt_pk_bf16_f32 v32, v64, v65
v_pk_fma_f32 v[66:67], v[66:67], v[220:221], v[218:219] neg_lo:[0,0,1] neg_hi:[0,0,1]
v_pk_fma_f32 v[68:69], v[68:69], v[220:221], v[218:219] neg_lo:[0,0,1] neg_hi:[0,0,1]
v_cvt_pk_bf16_f32 v33, v66, v67
v_cvt_pk_bf16_f32 v34, v68, v69
v_pk_fma_f32 v[70:71], v[70:71], v[220:221], v[218:219] neg_lo:[0,0,1] neg_hi:[0,0,1]
v_pk_fma_f32 v[72:73], v[72:73], v[220:221], v[218:219] neg_lo:[0,0,1] neg_hi:[0,0,1]
ds_read_b128 v[180:183], v250 offset:1024
v_cvt_pk_bf16_f32 v35, v70, v71
v_cvt_pk_bf16_f32 v36, v72, v73
v_pk_fma_f32 v[74:75], v[74:75], v[220:221], v[218:219] neg_lo:[0,0,1] neg_hi:[0,0,1]
v_pk_fma_f32 v[76:77], v[76:77], v[220:221], v[218:219] neg_lo:[0,0,1] neg_hi:[0,0,1]
v_cvt_pk_bf16_f32 v37, v74, v75
v_cvt_pk_bf16_f32 v38, v76, v77
v_pk_fma_f32 v[78:79], v[78:79], v[220:221], v[218:219] neg_lo:[0,0,1] neg_hi:[0,0,1]
v_pk_fma_f32 v[80:81], v[80:81], v[220:221], v[218:219] neg_lo:[0,0,1] neg_hi:[0,0,1]
v_cvt_pk_bf16_f32 v39, v78, v79
v_cvt_pk_bf16_f32 v40, v80, v81
v_pk_fma_f32 v[82:83], v[82:83], v[220:221], v[218:219] neg_lo:[0,0,1] neg_hi:[0,0,1]
v_pk_fma_f32 v[84:85], v[84:85], v[220:221], v[218:219] neg_lo:[0,0,1] neg_hi:[0,0,1]
v_cvt_pk_bf16_f32 v41, v82, v83
v_cvt_pk_bf16_f32 v42, v84, v85
v_pk_fma_f32 v[86:87], v[86:87], v[220:221], v[218:219] neg_lo:[0,0,1] neg_hi:[0,0,1]
v_pk_fma_f32 v[88:89], v[88:89], v[220:221], v[218:219] neg_lo:[0,0,1] neg_hi:[0,0,1]
v_cvt_pk_bf16_f32 v43, v86, v87
v_cvt_pk_bf16_f32 v44, v88, v89
v_pk_fma_f32 v[90:91], v[90:91], v[220:221], v[218:219] neg_lo:[0,0,1] neg_hi:[0,0,1]
v_pk_fma_f32 v[92:93], v[92:93], v[220:221], v[218:219] neg_lo:[0,0,1] neg_hi:[0,0,1]
v_cvt_pk_bf16_f32 v45, v90, v91
v_cvt_pk_bf16_f32 v46, v92, v93
v_pk_fma_f32 v[94:95], v[94:95], v[220:221], v[218:219] neg_lo:[0,0,1] neg_hi:[0,0,1]
ds_read_b128 v[184:187], v250 offset:2048
v_cvt_pk_bf16_f32 v47, v94, v95
s_waitcnt lgkmcnt(2)
v_mfma_f32_32x32x16_bf16 v[160:175], v[0:3], v[176:179], 0
ds_read_b128 v[188:191], v250 offset:3072
v_mfma_f32_32x32x16_bf16 v[96:111], v[24:27], v[176:179], 0
ds_read_b128 v[176:179], v250 offset:4096
s_waitcnt lgkmcnt(3)
v_mfma_f32_32x32x16_bf16 v[160:175], v[4:7], v[180:183], v[160:175]
v_mfma_f32_32x32x16_bf16 v[96:111], v[28:31], v[180:183], v[96:111]
ds_read_b128 v[180:183], v250 offset:5120
s_waitcnt lgkmcnt(3)
v_mfma_f32_32x32x16_bf16 v[160:175], v[8:11], v[184:187], v[160:175]
v_mfma_f32_32x32x16_bf16 v[96:111], v[32:35], v[184:187], v[96:111]
ds_read_b128 v[184:187], v250 offset:6144
s_waitcnt lgkmcnt(2)
v_mfma_f32_32x32x16_bf16 v[160:175], v[12:15], v[188:191], v[160:175]
v_mfma_f32_32x32x16_bf16 v[96:111], v[36:39], v[188:191], v[96:111]
ds_read_b128 v[188:191], v250 offset:7168
v_mfma_f32_32x32x16_bf16 v[160:175], v[16:19], v[176:179], v[160:175]
v_mfma_f32_32x32x16_bf16 v[96:111], v[40:43], v[176:179], v[96:111]
ds_read_b128 v[176:179], v250 offset:8192
s_waitcnt lgkmcnt(2)
v_mfma_f32_32x32x16_bf16 v[160:175], v[20:23], v[180:183], v[160:175]
v_mfma_f32_32x32x16_bf16 v[96:111], v[44:47], v[180:183], v[96:111]
ds_read_b128 v[180:183], v250 offset:9216
s_nop 9
v_cvt_pkrtz_f16_f32 v161, v160, v161
v_mfma_f32_32x32x16_bf16 v[112:127], v[0:3], v[184:187], 0
v_and_b32_e64 v161, s49, v161
v_bfe_u32 v160, v161, 2, 14
v_lshrrev_b32_e64 v161, 18, v161
v_cvt_pk_f16_f32 v172, v172, v173
v_cvt_pk_f16_f32 v174, v174, v175
v_pk_fma_f16 v173, v172, v172, s48
v_mfma_f32_32x32x16_bf16 v[128:143], v[24:27], v[184:187], 0
ds_read_u16 v160, v160
ds_read_u16 v161, v161
v_cvt_pkrtz_f16_f32 v163, v162, v163
v_and_b32_e64 v163, s49, v163
v_bfe_u32 v162, v163, 2, 14
v_lshrrev_b32_e64 v163, 18, v163
v_pk_fma_f16 v175, v174, v174, s48
v_pk_mul_f16 v173, v172, v173
v_pk_mul_f16 v175, v174, v175
v_cvt_pkrtz_f16_f32 v165, v164, v165
v_and_b32_e64 v165, s49, v165
v_bfe_u32 v164, v165, 2, 14
ds_read_u16 v162, v162
ds_read_u16 v163, v163
v_lshrrev_b32 v165, 18, v165
v_exp_f16_sdwa v173, v173 dst_sel:WORD_0 dst_unused:UNUSED_PRESERVE src0_sel:WORD_0
s_waitcnt lgkmcnt(4)
v_mfma_f32_32x32x16_bf16 v[112:127], v[4:7], v[188:191], v[112:127]
ds_read_u16 v164, v164
ds_read_u16 v165, v165
v_exp_f16_sdwa v175, v175 dst_sel:WORD_0 dst_unused:UNUSED_PRESERVE src0_sel:WORD_0
v_cvt_pkrtz_f16_f32 v167, v166, v167
v_and_b32_e64 v167, s49, v167
v_bfe_u32 v166, v167, 2, 14
v_lshrrev_b32_e64 v167, 18, v167
v_exp_f16_sdwa v173, v173 dst_sel:WORD_1 dst_unused:UNUSED_PRESERVE src0_sel:WORD_1
v_cvt_pkrtz_f16_f32 v169, v168, v169
v_and_b32_e64 v169, s49, v169
v_bfe_u32 v168, v169, 2, 14
v_lshrrev_b32_e64 v169, 18, v169
v_exp_f16_sdwa v175, v175 dst_sel:WORD_1 dst_unused:UNUSED_PRESERVE src0_sel:WORD_1
ds_read_u16 v166, v166
ds_read_u16 v167, v167
ds_read_u16 v168, v168
ds_read_u16 v169, v169
v_mfma_f32_32x32x16_bf16 v[128:143], v[28:31], v[188:191], v[128:143]
ds_read_b128 v[184:187], v250 offset:10240
v_cvt_pkrtz_f16_f32 v171, v170, v171
v_and_b32_e64 v171, s49, v171
v_bfe_u32 v170, v171, 2, 14
v_lshrrev_b32_e64 v171, 18, v171
v_pk_add_f16 v173, v173, 1.0 op_sel_hi:[1,0]
v_pk_add_f16 v175, v175, 1.0 op_sel_hi:[1,0]
v_rcp_f16_sdwa v173, v173 dst_sel:WORD_0 dst_unused:UNUSED_PRESERVE src0_sel:WORD_0
v_mfma_f32_32x32x16_bf16 v[112:127], v[8:11], v[176:179], v[112:127]
ds_read_u16 v170, v170
ds_read_u16 v171, v171
v_rcp_f16_sdwa v175, v175 dst_sel:WORD_0 dst_unused:UNUSED_PRESERVE src0_sel:WORD_0
v_rcp_f16_sdwa v173, v173 dst_sel:WORD_1 dst_unused:UNUSED_PRESERVE src0_sel:WORD_1
v_rcp_f16_sdwa v175, v175 dst_sel:WORD_1 dst_unused:UNUSED_PRESERVE src0_sel:WORD_1
v_mfma_f32_32x32x16_bf16 v[128:143], v[32:35], v[176:179], v[128:143]
ds_read_b128 v[188:191], v250 offset:11264
v_pk_mul_f16 v172, v172, v173
v_pk_mul_f16 v174, v174, v175
v_fma_mix_f32 v224, v172, v172, v224 op_sel_hi:[1,1,0]
v_cvt_pkrtz_f16_f32 v97, v96, v97
v_fma_mix_f32 v224, v174, v174, v224 op_sel_hi:[1,1,0]
v_mfma_f32_32x32x16_bf16 v[112:127], v[12:15], v[180:183], v[112:127]
v_fma_mix_f32 v224, v172, v172, v224 op_sel:[1,1,0] op_sel_hi:[1,1,0]
v_and_b32_e64 v97, s49, v97
v_fma_mix_f32 v224, v174, v174, v224 op_sel:[1,1,0] op_sel_hi:[1,1,0]
v_bfe_u32 v96, v97, 2, 14
s_waitcnt lgkmcnt(6)
v_fma_mix_f32 v224, v160, v160, v224 op_sel_hi:[1,1,0]
v_lshrrev_b32 v97, 18, v97
v_fma_mix_f32 v224, v161, v161, v224 op_sel_hi:[1,1,0]
v_cvt_pk_f16_f32 v108, v108, v109
v_fma_mix_f32 v224, v162, v162, v224 op_sel_hi:[1,1,0]
v_cvt_pk_f16_f32 v110, v110, v111
v_fma_mix_f32 v224, v163, v163, v224 op_sel_hi:[1,1,0]
v_pk_fma_f16 v109, v108, v108, s48
v_mfma_f32_32x32x16_bf16 v[128:143], v[36:39], v[180:183], v[128:143]
ds_read_u16 v96, v96
ds_read_u16 v97, v97
v_fma_mix_f32 v224, v164, v164, v224 op_sel_hi:[1,1,0]
v_cvt_pkrtz_f16_f32 v99, v98, v99
v_fma_mix_f32 v224, v165, v165, v224 op_sel_hi:[1,1,0]
v_and_b32_e64 v99, s49, v99
v_bfe_u32 v98, v99, 2, 14
v_lshrrev_b32_e64 v99, 18, v99
v_pk_fma_f16 v111, v110, v110, s48
v_pk_mul_f16 v109, v108, v109
v_pk_mul_f16 v111, v110, v111
v_fma_mix_f32 v224, v166, v166, v224 op_sel_hi:[1,1,0]
v_cvt_pkrtz_f16_f32 v101, v100, v101
v_fma_mix_f32 v224, v167, v167, v224 op_sel_hi:[1,1,0]
ds_read_u16 v98, v98
ds_read_u16 v99, v99
ds_read_b128 v[176:179], v250 offset:12288
v_and_b32_e64 v101, s49, v101
v_bfe_u32 v100, v101, 2, 14
v_lshrrev_b32 v101, 18, v101
v_exp_f16_sdwa v109, v109 dst_sel:WORD_0 dst_unused:UNUSED_PRESERVE src0_sel:WORD_0
s_waitcnt lgkmcnt(5)
v_mfma_f32_32x32x16_bf16 v[112:127], v[16:19], v[184:187], v[112:127]
ds_read_u16 v100, v100
ds_read_u16 v101, v101
v_exp_f16_sdwa v111, v111 dst_sel:WORD_0 dst_unused:UNUSED_PRESERVE src0_sel:WORD_0
v_fma_mix_f32 v224, v168, v168, v224 op_sel_hi:[1,1,0]
v_cvt_pkrtz_f16_f32 v103, v102, v103
v_fma_mix_f32 v224, v169, v169, v224 op_sel_hi:[1,1,0]
v_and_b32_e64 v103, s49, v103
v_bfe_u32 v102, v103, 2, 14
v_lshrrev_b32_e64 v103, 18, v103
v_exp_f16_sdwa v109, v109 dst_sel:WORD_1 dst_unused:UNUSED_PRESERVE src0_sel:WORD_1
v_fma_mix_f32 v224, v170, v170, v224 op_sel_hi:[1,1,0]
v_cvt_pkrtz_f16_f32 v105, v104, v105
v_fma_mix_f32 v224, v171, v171, v224 op_sel_hi:[1,1,0]
v_and_b32_e64 v105, s49, v105
v_bfe_u32 v104, v105, 2, 14
ds_read_u16 v102, v102
ds_read_u16 v103, v103
v_lshrrev_b32_e64 v105, 18, v105
v_exp_f16_sdwa v111, v111 dst_sel:WORD_1 dst_unused:UNUSED_PRESERVE src0_sel:WORD_1
v_mfma_f32_32x32x16_bf16 v[128:143], v[40:43], v[184:187], v[128:143]
ds_read_u16 v104, v104
ds_read_u16 v105, v105
ds_read_b128 v[180:183], v250 offset:13312
v_cvt_pkrtz_f16_f32 v107, v106, v107
v_and_b32_e64 v107, s49, v107
v_bfe_u32 v106, v107, 2, 14
v_lshrrev_b32_e64 v107, 18, v107
v_pk_add_f16 v109, v109, 1.0 op_sel_hi:[1,0]
v_pk_add_f16 v111, v111, 1.0 op_sel_hi:[1,0]
v_rcp_f16_sdwa v109, v109 dst_sel:WORD_0 dst_unused:UNUSED_PRESERVE src0_sel:WORD_0
v_mfma_f32_32x32x16_bf16 v[112:127], v[20:23], v[188:191], v[112:127]
ds_read_u16 v106, v106
ds_read_u16 v107, v107
v_rcp_f16_sdwa v111, v111 dst_sel:WORD_0 dst_unused:UNUSED_PRESERVE src0_sel:WORD_0
v_rcp_f16_sdwa v109, v109 dst_sel:WORD_1 dst_unused:UNUSED_PRESERVE src0_sel:WORD_1
v_rcp_f16_sdwa v111, v111 dst_sel:WORD_1 dst_unused:UNUSED_PRESERVE src0_sel:WORD_1
v_mfma_f32_32x32x16_bf16 v[128:143], v[44:47], v[188:191], v[128:143]
ds_read_b128 v[184:187], v250 offset:14336
v_pk_mul_f16 v108, v108, v109
v_pk_mul_f16 v110, v110, v111
v_fma_mix_f32 v224, v108, v108, v224 op_sel_hi:[1,1,0]
buffer_store_dwordx4 v[0:3], v250, s[32:35], s80 offen
v_fma_mix_f32 v224, v110, v110, v224 op_sel_hi:[1,1,0]
s_waitcnt lgkmcnt(7)
v_mfma_f32_32x32x16_bf16 v[144:159], v[0:3], v[176:179], 0
v_fma_mix_f32 v224, v108, v108, v224 op_sel:[1,1,0] op_sel_hi:[1,1,0]
v_cvt_pkrtz_f16_f32 v113, v112, v113
v_fma_mix_f32 v224, v110, v110, v224 op_sel:[1,1,0] op_sel_hi:[1,1,0]
v_and_b32 v113, s49, v113
v_fma_mix_f32 v224, v96, v96, v224 op_sel_hi:[1,1,0]
v_bfe_u32 v112, v113, 2, 14
v_fma_mix_f32 v224, v97, v97, v224 op_sel_hi:[1,1,0]
v_lshrrev_b32_e64 v113, 18, v113
v_fma_mix_f32 v224, v98, v98, v224 op_sel_hi:[1,1,0]
v_cvt_pk_f16_f32 v124, v124, v125
v_fma_mix_f32 v224, v99, v99, v224 op_sel_hi:[1,1,0]
v_cvt_pk_f16_f32 v126, v126, v127
v_pk_fma_f16 v125, v124, v124, s48
v_mfma_f32_32x32x16_bf16 v[160:175], v[24:27], v[176:179], 0
ds_read_u16 v112, v112
ds_read_u16 v113, v113
v_fma_mix_f32 v224, v100, v100, v224 op_sel_hi:[1,1,0]
v_cvt_pkrtz_f16_f32 v115, v114, v115
v_fma_mix_f32 v224, v101, v101, v224 op_sel_hi:[1,1,0]
v_and_b32_e64 v115, s49, v115
v_bfe_u32 v114, v115, 2, 14
v_lshrrev_b32_e64 v115, 18, v115
v_pk_fma_f16 v127, v126, v126, s48
v_pk_mul_f16 v125, v124, v125
v_pk_mul_f16 v127, v126, v127
v_fma_mix_f32 v224, v102, v102, v224 op_sel_hi:[1,1,0]
v_cvt_pkrtz_f16_f32 v117, v116, v117
s_waitcnt lgkmcnt(3)
v_fma_mix_f32 v224, v103, v103, v224 op_sel_hi:[1,1,0]
ds_read_u16 v114, v114
ds_read_u16 v115, v115
ds_read_b128 v[188:191], v250 offset:15360
v_and_b32 v117, s49, v117
v_bfe_u32 v116, v117, 2, 14
v_lshrrev_b32_e64 v117, 18, v117
v_exp_f16_sdwa v125, v125 dst_sel:WORD_0 dst_unused:UNUSED_PRESERVE src0_sel:WORD_0
v_mfma_f32_32x32x16_bf16 v[144:159], v[4:7], v[180:183], v[144:159]
ds_read_u16 v116, v116
ds_read_u16 v117, v117
v_exp_f16_sdwa v127, v127 dst_sel:WORD_0 dst_unused:UNUSED_PRESERVE src0_sel:WORD_0
v_fma_mix_f32 v224, v104, v104, v224 op_sel_hi:[1,1,0]
v_cvt_pkrtz_f16_f32 v119, v118, v119
v_fma_mix_f32 v224, v105, v105, v224 op_sel_hi:[1,1,0]
v_and_b32_e64 v119, s49, v119
v_bfe_u32 v118, v119, 2, 14
v_lshrrev_b32_e64 v119, 18, v119
v_exp_f16_sdwa v125, v125 dst_sel:WORD_1 dst_unused:UNUSED_PRESERVE src0_sel:WORD_1
v_fma_mix_f32 v224, v106, v106, v224 op_sel_hi:[1,1,0]
v_cvt_pkrtz_f16_f32 v121, v120, v121
v_fma_mix_f32 v224, v107, v107, v224 op_sel_hi:[1,1,0]
v_and_b32_e64 v121, s49, v121
v_bfe_u32 v120, v121, 2, 14
ds_read_u16 v118, v118
ds_read_u16 v119, v119
v_lshrrev_b32_e64 v121, 18, v121
v_exp_f16_sdwa v127, v127 dst_sel:WORD_1 dst_unused:UNUSED_PRESERVE src0_sel:WORD_1
v_mfma_f32_32x32x16_bf16 v[160:175], v[28:31], v[180:183], v[160:175]
ds_read_u16 v120, v120
ds_read_u16 v121, v121
ds_read_b128 v[176:179], v250 offset:16384
v_cvt_pkrtz_f16_f32 v123, v122, v123
v_and_b32_e64 v123, s49, v123
v_bfe_u32 v122, v123, 2, 14
v_lshrrev_b32 v123, 18, v123
v_pk_add_f16 v125, v125, 1.0 op_sel_hi:[1,0]
v_pk_add_f16 v127, v127, 1.0 op_sel_hi:[1,0]
v_rcp_f16_sdwa v125, v125 dst_sel:WORD_0 dst_unused:UNUSED_PRESERVE src0_sel:WORD_0
s_waitcnt lgkmcnt(7)
v_mfma_f32_32x32x16_bf16 v[144:159], v[8:11], v[184:187], v[144:159]
ds_read_u16 v122, v122
ds_read_u16 v123, v123
v_rcp_f16_sdwa v127, v127 dst_sel:WORD_0 dst_unused:UNUSED_PRESERVE src0_sel:WORD_0
s_add_u32 s46, s80, 2097152
buffer_store_dwordx4 v[4:7], v250, s[32:35], s46 offen
v_rcp_f16_sdwa v125, v125 dst_sel:WORD_1 dst_unused:UNUSED_PRESERVE src0_sel:WORD_1
v_rcp_f16_sdwa v127, v127 dst_sel:WORD_1 dst_unused:UNUSED_PRESERVE src0_sel:WORD_1
v_mfma_f32_32x32x16_bf16 v[160:175], v[32:35], v[184:187], v[160:175]
ds_read_b128 v[180:183], v250 offset:17408
v_pk_mul_f16 v124, v124, v125
v_pk_mul_f16 v126, v126, v127
v_fma_mix_f32 v225, v124, v124, v225 op_sel_hi:[1,1,0]
v_cvt_pkrtz_f16_f32 v129, v128, v129
v_fma_mix_f32 v225, v126, v126, v225 op_sel_hi:[1,1,0]
v_mfma_f32_32x32x16_bf16 v[144:159], v[12:15], v[188:191], v[144:159]
v_fma_mix_f32 v225, v124, v124, v225 op_sel:[1,1,0] op_sel_hi:[1,1,0]
v_and_b32_e64 v129, s49, v129
v_fma_mix_f32 v225, v126, v126, v225 op_sel:[1,1,0] op_sel_hi:[1,1,0]
v_bfe_u32 v128, v129, 2, 14
v_fma_mix_f32 v225, v112, v112, v225 op_sel_hi:[1,1,0]
v_lshrrev_b32_e64 v129, 18, v129
v_fma_mix_f32 v225, v113, v113, v225 op_sel_hi:[1,1,0]
v_cvt_pk_f16_f32 v140, v140, v141
v_fma_mix_f32 v225, v114, v114, v225 op_sel_hi:[1,1,0]
v_cvt_pk_f16_f32 v142, v142, v143
v_fma_mix_f32 v225, v115, v115, v225 op_sel_hi:[1,1,0]
v_pk_fma_f16 v141, v140, v140, s48
v_mfma_f32_32x32x16_bf16 v[160:175], v[36:39], v[188:191], v[160:175]
ds_read_u16 v128, v128
ds_read_u16 v129, v129
s_waitcnt lgkmcnt(5)
v_fma_mix_f32 v225, v116, v116, v225 op_sel_hi:[1,1,0]
v_cvt_pkrtz_f16_f32 v131, v130, v131
v_fma_mix_f32 v225, v117, v117, v225 op_sel_hi:[1,1,0]
v_and_b32 v131, s49, v131
v_bfe_u32 v130, v131, 2, 14
v_lshrrev_b32_e64 v131, 18, v131
v_pk_fma_f16 v143, v142, v142, s48
v_pk_mul_f16 v141, v140, v141
v_pk_mul_f16 v143, v142, v143
v_fma_mix_f32 v225, v118, v118, v225 op_sel_hi:[1,1,0]
v_cvt_pkrtz_f16_f32 v133, v132, v133
v_fma_mix_f32 v225, v119, v119, v225 op_sel_hi:[1,1,0]
ds_read_u16 v130, v130
ds_read_u16 v131, v131
ds_read_b128 v[184:187], v250 offset:18432
v_and_b32_e64 v133, s49, v133
v_bfe_u32 v132, v133, 2, 14
v_lshrrev_b32_e64 v133, 18, v133
v_exp_f16_sdwa v141, v141 dst_sel:WORD_0 dst_unused:UNUSED_PRESERVE src0_sel:WORD_0
v_mfma_f32_32x32x16_bf16 v[144:159], v[16:19], v[176:179], v[144:159]
ds_read_u16 v132, v132
ds_read_u16 v133, v133
v_exp_f16_sdwa v143, v143 dst_sel:WORD_0 dst_unused:UNUSED_PRESERVE src0_sel:WORD_0
v_fma_mix_f32 v225, v120, v120, v225 op_sel_hi:[1,1,0]
v_cvt_pkrtz_f16_f32 v135, v134, v135
v_fma_mix_f32 v225, v121, v121, v225 op_sel_hi:[1,1,0]
v_and_b32_e64 v135, s49, v135
v_bfe_u32 v134, v135, 2, 14
v_lshrrev_b32 v135, 18, v135
v_exp_f16_sdwa v141, v141 dst_sel:WORD_1 dst_unused:UNUSED_PRESERVE src0_sel:WORD_1
s_waitcnt lgkmcnt(6)
v_fma_mix_f32 v225, v122, v122, v225 op_sel_hi:[1,1,0]
v_cvt_pkrtz_f16_f32 v137, v136, v137
v_fma_mix_f32 v225, v123, v123, v225 op_sel_hi:[1,1,0]
v_and_b32_e64 v137, s49, v137
v_bfe_u32 v136, v137, 2, 14
ds_read_u16 v134, v134
ds_read_u16 v135, v135
s_add_u32 s46, s80, 4194304
buffer_store_dwordx4 v[8:11], v250, s[32:35], s46 offen
v_lshrrev_b32_e64 v137, 18, v137
v_exp_f16_sdwa v143, v143 dst_sel:WORD_1 dst_unused:UNUSED_PRESERVE src0_sel:WORD_1
v_mfma_f32_32x32x16_bf16 v[160:175], v[40:43], v[176:179], v[160:175]
ds_read_u16 v136, v136
ds_read_u16 v137, v137
ds_read_b128 v[188:191], v250 offset:19456
v_cvt_pkrtz_f16_f32 v139, v138, v139
v_and_b32_e64 v139, s49, v139
v_bfe_u32 v138, v139, 2, 14
v_lshrrev_b32_e64 v139, 18, v139
v_pk_add_f16 v141, v141, 1.0 op_sel_hi:[1,0]
v_pk_add_f16 v143, v143, 1.0 op_sel_hi:[1,0]
v_rcp_f16_sdwa v141, v141 dst_sel:WORD_0 dst_unused:UNUSED_PRESERVE src0_sel:WORD_0
v_mfma_f32_32x32x16_bf16 v[144:159], v[20:23], v[180:183], v[144:159]
ds_read_u16 v138, v138
ds_read_u16 v139, v139
v_rcp_f16_sdwa v143, v143 dst_sel:WORD_0 dst_unused:UNUSED_PRESERVE src0_sel:WORD_0
v_rcp_f16_sdwa v141, v141 dst_sel:WORD_1 dst_unused:UNUSED_PRESERVE src0_sel:WORD_1
v_rcp_f16_sdwa v143, v143 dst_sel:WORD_1 dst_unused:UNUSED_PRESERVE src0_sel:WORD_1
v_mfma_f32_32x32x16_bf16 v[160:175], v[44:47], v[180:183], v[160:175]
ds_read_b128 v[176:179], v250 offset:20480
v_pk_mul_f16 v140, v140, v141
v_pk_mul_f16 v142, v142, v143
v_fma_mix_f32 v225, v140, v140, v225 op_sel_hi:[1,1,0]
s_nop 1
v_cvt_pkrtz_f16_f32 v145, v144, v145
v_fma_mix_f32 v225, v142, v142, v225 op_sel_hi:[1,1,0]
s_waitcnt lgkmcnt(7)
v_mfma_f32_32x32x16_bf16 v[96:111], v[0:3], v[184:187], 0
v_fma_mix_f32 v225, v140, v140, v225 op_sel:[1,1,0] op_sel_hi:[1,1,0]
v_and_b32_e64 v145, s49, v145
v_fma_mix_f32 v225, v142, v142, v225 op_sel:[1,1,0] op_sel_hi:[1,1,0]
v_bfe_u32 v144, v145, 2, 14
v_fma_mix_f32 v225, v128, v128, v225 op_sel_hi:[1,1,0]
v_lshrrev_b32_e64 v145, 18, v145
v_fma_mix_f32 v225, v129, v129, v225 op_sel_hi:[1,1,0]
v_cvt_pk_f16_f32 v156, v156, v157
v_fma_mix_f32 v225, v130, v130, v225 op_sel_hi:[1,1,0]
v_cvt_pk_f16_f32 v158, v158, v159
v_fma_mix_f32 v225, v131, v131, v225 op_sel_hi:[1,1,0]
s_add_u32 s46, s80, 6291456
buffer_store_dwordx4 v[12:15], v250, s[32:35], s46 offen
ds_read_u16 v144, v144
ds_read_u16 v145, v145
v_pk_fma_f16 v157, v156, v156, s48
v_mfma_f32_32x32x16_bf16 v[112:127], v[24:27], v[184:187], 0
v_fma_mix_f32 v225, v132, v132, v225 op_sel_hi:[1,1,0]
v_cvt_pkrtz_f16_f32 v147, v146, v147
v_fma_mix_f32 v225, v133, v133, v225 op_sel_hi:[1,1,0]
v_and_b32_e64 v147, s49, v147
v_bfe_u32 v146, v147, 2, 14
v_lshrrev_b32_e64 v147, 18, v147
v_pk_fma_f16 v159, v158, v158, s48
v_pk_mul_f16 v157, v156, v157
v_pk_mul_f16 v159, v158, v159
v_fma_mix_f32 v225, v134, v134, v225 op_sel_hi:[1,1,0]
v_cvt_pkrtz_f16_f32 v149, v148, v149
s_waitcnt lgkmcnt(3)
v_fma_mix_f32 v225, v135, v135, v225 op_sel_hi:[1,1,0]
ds_read_u16 v146, v146
ds_read_u16 v147, v147
ds_read_b128 v[180:183], v250 offset:21504
v_and_b32 v149, s49, v149
v_bfe_u32 v148, v149, 2, 14
v_lshrrev_b32_e64 v149, 18, v149
v_exp_f16_sdwa v157, v157 dst_sel:WORD_0 dst_unused:UNUSED_PRESERVE src0_sel:WORD_0
v_mfma_f32_32x32x16_bf16 v[96:111], v[4:7], v[188:191], v[96:111]
ds_read_u16 v148, v148
ds_read_u16 v149, v149
v_exp_f16_sdwa v159, v159 dst_sel:WORD_0 dst_unused:UNUSED_PRESERVE src0_sel:WORD_0
v_fma_mix_f32 v225, v136, v136, v225 op_sel_hi:[1,1,0]
v_cvt_pkrtz_f16_f32 v151, v150, v151
v_fma_mix_f32 v225, v137, v137, v225 op_sel_hi:[1,1,0]
v_and_b32_e64 v151, s49, v151
v_bfe_u32 v150, v151, 2, 14
v_lshrrev_b32_e64 v151, 18, v151
v_exp_f16_sdwa v157, v157 dst_sel:WORD_1 dst_unused:UNUSED_PRESERVE src0_sel:WORD_1
v_fma_mix_f32 v225, v138, v138, v225 op_sel_hi:[1,1,0]
v_cvt_pkrtz_f16_f32 v153, v152, v153
v_fma_mix_f32 v225, v139, v139, v225 op_sel_hi:[1,1,0]
v_and_b32_e64 v153, s49, v153
v_bfe_u32 v152, v153, 2, 14
ds_read_u16 v150, v150
ds_read_u16 v151, v151
v_lshrrev_b32_e64 v153, 18, v153
v_exp_f16_sdwa v159, v159 dst_sel:WORD_1 dst_unused:UNUSED_PRESERVE src0_sel:WORD_1
v_mfma_f32_32x32x16_bf16 v[112:127], v[28:31], v[188:191], v[112:127]
ds_read_u16 v152, v152
ds_read_u16 v153, v153
ds_read_b128 v[184:187], v250 offset:22528
v_cvt_pkrtz_f16_f32 v155, v154, v155
v_and_b32_e64 v155, s49, v155
v_bfe_u32 v154, v155, 2, 14
v_lshrrev_b32 v155, 18, v155
v_pk_add_f16 v157, v157, 1.0 op_sel_hi:[1,0]
v_pk_add_f16 v159, v159, 1.0 op_sel_hi:[1,0]
v_rcp_f16_sdwa v157, v157 dst_sel:WORD_0 dst_unused:UNUSED_PRESERVE src0_sel:WORD_0
s_waitcnt lgkmcnt(7)
v_mfma_f32_32x32x16_bf16 v[96:111], v[8:11], v[176:179], v[96:111]
ds_read_u16 v154, v154
ds_read_u16 v155, v155
v_rcp_f16_sdwa v159, v159 dst_sel:WORD_0 dst_unused:UNUSED_PRESERVE src0_sel:WORD_0
v_rcp_f16_sdwa v157, v157 dst_sel:WORD_1 dst_unused:UNUSED_PRESERVE src0_sel:WORD_1
s_add_u32 s46, s80, 8388608
buffer_store_dwordx4 v[16:19], v250, s[32:35], s46 offen
v_rcp_f16_sdwa v159, v159 dst_sel:WORD_1 dst_unused:UNUSED_PRESERVE src0_sel:WORD_1
v_mfma_f32_32x32x16_bf16 v[112:127], v[32:35], v[176:179], v[112:127]
ds_read_b128 v[188:191], v250 offset:23552
v_mov_b32 v223, 0
s_branch Law3
Lax3:
s_sleep 2
Law3:
ds_read_b32 v223, v247 offset:12
s_sub_u32 s76, s76, 1
s_cselect_b32 s44, 4, 0
s_cselect_b32 s76, 0, s76
s_waitcnt lgkmcnt(0)
v_readfirstlane_b32 s43, v223
s_nop 1
s_max_u32 s43, s43, s44
s_cmp_lt_u32 s43, 4
s_cbranch_scc1 Lax3
v_pk_mul_f16 v156, v156, v157
v_pk_mul_f16 v158, v158, v159
v_fma_mix_f32 v226, v156, v156, v226 op_sel_hi:[1,1,0]
v_mfma_f32_32x32x16_bf16 v[96:111], v[12:15], v[180:183], v[96:111]
v_fma_mix_f32 v226, v158, v158, v226 op_sel_hi:[1,1,0]
s_setprio 3
v_cvt_pkrtz_f16_f32 v161, v160, v161
v_fma_mix_f32 v226, v156, v156, v226 op_sel:[1,1,0] op_sel_hi:[1,1,0]
v_and_b32 v161, s49, v161
v_fma_mix_f32 v226, v158, v158, v226 op_sel:[1,1,0] op_sel_hi:[1,1,0]
v_bfe_u32 v160, v161, 2, 14
v_fma_mix_f32 v226, v144, v144, v226 op_sel_hi:[1,1,0]
v_lshrrev_b32_e64 v161, 18, v161
v_fma_mix_f32 v226, v145, v145, v226 op_sel_hi:[1,1,0]
v_cvt_pk_f16_f32 v172, v172, v173
v_fma_mix_f32 v226, v146, v146, v226 op_sel_hi:[1,1,0]
v_cvt_pk_f16_f32 v174, v174, v175
v_fma_mix_f32 v226, v147, v147, v226 op_sel_hi:[1,1,0]
v_pk_fma_f16 v173, v172, v172, s48
v_mfma_f32_32x32x16_bf16 v[112:127], v[36:39], v[180:183], v[112:127]
ds_read_u16 v160, v160
ds_read_u16 v161, v161
v_fma_mix_f32 v226, v148, v148, v226 op_sel_hi:[1,1,0]
v_cvt_pkrtz_f16_f32 v163, v162, v163
v_fma_mix_f32 v226, v149, v149, v226 op_sel_hi:[1,1,0]
v_and_b32_e64 v163, s49, v163
v_bfe_u32 v162, v163, 2, 14
v_lshrrev_b32_e64 v163, 18, v163
v_pk_fma_f16 v175, v174, v174, s48
v_pk_mul_f16 v173, v172, v173
v_pk_mul_f16 v175, v174, v175
v_fma_mix_f32 v226, v150, v150, v226 op_sel_hi:[1,1,0]
v_cvt_pkrtz_f16_f32 v165, v164, v165
v_fma_mix_f32 v226, v151, v151, v226 op_sel_hi:[1,1,0]
ds_read_u16 v162, v162
ds_read_u16 v163, v163
ds_read_b128 v[176:179], v250 offset:24576
v_and_b32_e64 v165, s49, v165
v_bfe_u32 v164, v165, 2, 14
v_lshrrev_b32_e64 v165, 18, v165
v_exp_f16_sdwa v173, v173 dst_sel:WORD_0 dst_unused:UNUSED_PRESERVE src0_sel:WORD_0
v_mfma_f32_32x32x16_bf16 v[96:111], v[16:19], v[184:187], v[96:111]
ds_read_u16 v164, v164
ds_read_u16 v165, v165
v_exp_f16_sdwa v175, v175 dst_sel:WORD_0 dst_unused:UNUSED_PRESERVE src0_sel:WORD_0
v_fma_mix_f32 v226, v152, v152, v226 op_sel_hi:[1,1,0]
v_cvt_pkrtz_f16_f32 v167, v166, v167
v_fma_mix_f32 v226, v153, v153, v226 op_sel_hi:[1,1,0]
v_and_b32_e64 v167, s49, v167
v_bfe_u32 v166, v167, 2, 14
v_lshrrev_b32_e64 v167, 18, v167
v_exp_f16_sdwa v173, v173 dst_sel:WORD_1 dst_unused:UNUSED_PRESERVE src0_sel:WORD_1
v_fma_mix_f32 v226, v154, v154, v226 op_sel_hi:[1,1,0]
v_cvt_pkrtz_f16_f32 v169, v168, v169
v_fma_mix_f32 v226, v155, v155, v226 op_sel_hi:[1,1,0]
v_and_b32_e64 v169, s49, v169
v_bfe_u32 v168, v169, 2, 14
ds_read_u16 v166, v166
ds_read_u16 v167, v167
v_lshrrev_b32_e64 v169, 18, v169
v_exp_f16_sdwa v175, v175 dst_sel:WORD_1 dst_unused:UNUSED_PRESERVE src0_sel:WORD_1
v_mfma_f32_32x32x16_bf16 v[112:127], v[40:43], v[184:187], v[112:127]
ds_read_u16 v168, v168
ds_read_u16 v169, v169
s_add_u32 s46, s80, 10485760
buffer_store_dwordx4 v[20:23], v250, s[32:35], s46 offen
ds_read_b128 v[180:183], v250 offset:25600
v_cvt_pkrtz_f16_f32 v171, v170, v171
v_and_b32_e64 v171, s49, v171
v_bfe_u32 v170, v171, 2, 14
v_lshrrev_b32_e64 v171, 18, v171
v_pk_add_f16 v173, v173, 1.0 op_sel_hi:[1,0]
v_pk_add_f16 v175, v175, 1.0 op_sel_hi:[1,0]
v_rcp_f16_sdwa v173, v173 dst_sel:WORD_0 dst_unused:UNUSED_PRESERVE src0_sel:WORD_0
v_mfma_f32_32x32x16_bf16 v[96:111], v[20:23], v[188:191], v[96:111]
ds_read_u16 v170, v170
ds_read_u16 v171, v171
v_rcp_f16_sdwa v175, v175 dst_sel:WORD_0 dst_unused:UNUSED_PRESERVE src0_sel:WORD_0
v_rcp_f16_sdwa v173, v173 dst_sel:WORD_1 dst_unused:UNUSED_PRESERVE src0_sel:WORD_1
v_rcp_f16_sdwa v175, v175 dst_sel:WORD_1 dst_unused:UNUSED_PRESERVE src0_sel:WORD_1
v_mfma_f32_32x32x16_bf16 v[112:127], v[44:47], v[188:191], v[112:127]
ds_read_b128 v[184:187], v250 offset:26624
v_pk_mul_f16 v172, v172, v173
v_pk_mul_f16 v174, v174, v175
v_fma_mix_f32 v226, v172, v172, v226 op_sel_hi:[1,1,0]
s_nop 1
v_cvt_pkrtz_f16_f32 v97, v96, v97
v_fma_mix_f32 v226, v174, v174, v226 op_sel_hi:[1,1,0]
s_waitcnt lgkmcnt(7)
v_mfma_f32_32x32x16_bf16 v[128:143], v[0:3], v[176:179], 0
v_fma_mix_f32 v226, v172, v172, v226 op_sel:[1,1,0] op_sel_hi:[1,1,0]
v_and_b32_e64 v97, s49, v97
v_fma_mix_f32 v226, v174, v174, v226 op_sel:[1,1,0] op_sel_hi:[1,1,0]
v_bfe_u32 v96, v97, 2, 14
v_fma_mix_f32 v226, v160, v160, v226 op_sel_hi:[1,1,0]
v_lshrrev_b32_e64 v97, 18, v97
v_fma_mix_f32 v226, v161, v161, v226 op_sel_hi:[1,1,0]
v_cvt_pk_f16_f32 v108, v108, v109
v_fma_mix_f32 v226, v162, v162, v226 op_sel_hi:[1,1,0]
v_cvt_pk_f16_f32 v110, v110, v111
v_fma_mix_f32 v226, v163, v163, v226 op_sel_hi:[1,1,0]
v_pk_fma_f16 v109, v108, v108, s48
v_mfma_f32_32x32x16_bf16 v[144:159], v[24:27], v[176:179], 0
ds_read_u16 v96, v96
ds_read_u16 v97, v97
v_fma_mix_f32 v226, v164, v164, v226 op_sel_hi:[1,1,0]
v_cvt_pkrtz_f16_f32 v99, v98, v99
v_fma_mix_f32 v226, v165, v165, v226 op_sel_hi:[1,1,0]
v_and_b32_e64 v99, s49, v99
v_bfe_u32 v98, v99, 2, 14
v_lshrrev_b32_e64 v99, 18, v99
v_pk_fma_f16 v111, v110, v110, s48
v_pk_mul_f16 v109, v108, v109
v_pk_mul_f16 v111, v110, v111
v_fma_mix_f32 v226, v166, v166, v226 op_sel_hi:[1,1,0]
v_cvt_pkrtz_f16_f32 v101, v100, v101
s_waitcnt lgkmcnt(3)
v_fma_mix_f32 v226, v167, v167, v226 op_sel_hi:[1,1,0]
ds_read_u16 v98, v98
ds_read_u16 v99, v99
ds_read_b128 v[188:191], v250 offset:27648
v_and_b32 v101, s49, v101
v_bfe_u32 v100, v101, 2, 14
v_lshrrev_b32_e64 v101, 18, v101
v_exp_f16_sdwa v109, v109 dst_sel:WORD_0 dst_unused:UNUSED_PRESERVE src0_sel:WORD_0
v_mfma_f32_32x32x16_bf16 v[128:143], v[4:7], v[180:183], v[128:143]
ds_read_u16 v100, v100
ds_read_u16 v101, v101
v_exp_f16_sdwa v111, v111 dst_sel:WORD_0 dst_unused:UNUSED_PRESERVE src0_sel:WORD_0
v_fma_mix_f32 v226, v168, v168, v226 op_sel_hi:[1,1,0]
v_cvt_pkrtz_f16_f32 v103, v102, v103
v_fma_mix_f32 v226, v169, v169, v226 op_sel_hi:[1,1,0]
v_and_b32_e64 v103, s49, v103
v_bfe_u32 v102, v103, 2, 14
v_lshrrev_b32_e64 v103, 18, v103
v_exp_f16_sdwa v109, v109 dst_sel:WORD_1 dst_unused:UNUSED_PRESERVE src0_sel:WORD_1
v_fma_mix_f32 v226, v170, v170, v226 op_sel_hi:[1,1,0]
v_cvt_pkrtz_f16_f32 v105, v104, v105
v_fma_mix_f32 v226, v171, v171, v226 op_sel_hi:[1,1,0]
v_and_b32_e64 v105, s49, v105
v_bfe_u32 v104, v105, 2, 14
ds_read_u16 v102, v102
ds_read_u16 v103, v103
v_lshrrev_b32_e64 v105, 18, v105
v_exp_f16_sdwa v111, v111 dst_sel:WORD_1 dst_unused:UNUSED_PRESERVE src0_sel:WORD_1
v_mfma_f32_32x32x16_bf16 v[144:159], v[28:31], v[180:183], v[144:159]
ds_read_u16 v104, v104
ds_read_u16 v105, v105
ds_read_b128 v[176:179], v250 offset:28672
v_cvt_pkrtz_f16_f32 v107, v106, v107
v_and_b32_e64 v107, s49, v107
v_bfe_u32 v106, v107, 2, 14
v_lshrrev_b32 v107, 18, v107
v_pk_add_f16 v109, v109, 1.0 op_sel_hi:[1,0]
v_pk_add_f16 v111, v111, 1.0 op_sel_hi:[1,0]
v_rcp_f16_sdwa v109, v109 dst_sel:WORD_0 dst_unused:UNUSED_PRESERVE src0_sel:WORD_0
s_waitcnt lgkmcnt(7)
v_mfma_f32_32x32x16_bf16 v[128:143], v[8:11], v[184:187], v[128:143]
ds_read_u16 v106, v106
ds_read_u16 v107, v107
v_rcp_f16_sdwa v111, v111 dst_sel:WORD_0 dst_unused:UNUSED_PRESERVE src0_sel:WORD_0
v_rcp_f16_sdwa v109, v109 dst_sel:WORD_1 dst_unused:UNUSED_PRESERVE src0_sel:WORD_1
v_rcp_f16_sdwa v111, v111 dst_sel:WORD_1 dst_unused:UNUSED_PRESERVE src0_sel:WORD_1
v_mfma_f32_32x32x16_bf16 v[144:159], v[32:35], v[184:187], v[144:159]
ds_read_b128 v[180:183], v250 offset:29696
v_pk_mul_f16 v108, v108, v109
v_pk_mul_f16 v110, v110, v111
v_fma_mix_f32 v227, v108, v108, v227 op_sel_hi:[1,1,0]
v_cvt_pkrtz_f16_f32 v113, v112, v113
v_fma_mix_f32 v227, v110, v110, v227 op_sel_hi:[1,1,0]
v_mfma_f32_32x32x16_bf16 v[128:143], v[12:15], v[188:191], v[128:143]
v_fma_mix_f32 v227, v108, v108, v227 op_sel:[1,1,0] op_sel_hi:[1,1,0]
v_and_b32_e64 v113, s49, v113
v_fma_mix_f32 v227, v110, v110, v227 op_sel:[1,1,0] op_sel_hi:[1,1,0]
v_bfe_u32 v112, v113, 2, 14
v_fma_mix_f32 v227, v96, v96, v227 op_sel_hi:[1,1,0]
v_lshrrev_b32_e64 v113, 18, v113
v_fma_mix_f32 v227, v97, v97, v227 op_sel_hi:[1,1,0]
v_cvt_pk_f16_f32 v124, v124, v125
v_fma_mix_f32 v227, v98, v98, v227 op_sel_hi:[1,1,0]
v_cvt_pk_f16_f32 v126, v126, v127
v_fma_mix_f32 v227, v99, v99, v227 op_sel_hi:[1,1,0]
v_pk_fma_f16 v125, v124, v124, s48
v_mfma_f32_32x32x16_bf16 v[144:159], v[36:39], v[188:191], v[144:159]
ds_read_u16 v112, v112
ds_read_u16 v113, v113
s_waitcnt lgkmcnt(5)
v_fma_mix_f32 v227, v100, v100, v227 op_sel_hi:[1,1,0]
v_cvt_pkrtz_f16_f32 v115, v114, v115
v_fma_mix_f32 v227, v101, v101, v227 op_sel_hi:[1,1,0]
v_and_b32 v115, s49, v115
v_bfe_u32 v114, v115, 2, 14
v_lshrrev_b32_e64 v115, 18, v115
v_pk_fma_f16 v127, v126, v126, s48
v_pk_mul_f16 v125, v124, v125
v_pk_mul_f16 v127, v126, v127
v_fma_mix_f32 v227, v102, v102, v227 op_sel_hi:[1,1,0]
v_cvt_pkrtz_f16_f32 v117, v116, v117
v_fma_mix_f32 v227, v103, v103, v227 op_sel_hi:[1,1,0]
ds_read_u16 v114, v114
ds_read_u16 v115, v115
ds_read_b128 v[184:187], v250 offset:30720
v_and_b32_e64 v117, s49, v117
v_bfe_u32 v116, v117, 2, 14
v_lshrrev_b32_e64 v117, 18, v117
v_exp_f16_sdwa v125, v125 dst_sel:WORD_0 dst_unused:UNUSED_PRESERVE src0_sel:WORD_0
v_mfma_f32_32x32x16_bf16 v[128:143], v[16:19], v[176:179], v[128:143]
ds_read_u16 v116, v116
ds_read_u16 v117, v117
v_exp_f16_sdwa v127, v127 dst_sel:WORD_0 dst_unused:UNUSED_PRESERVE src0_sel:WORD_0
v_fma_mix_f32 v227, v104, v104, v227 op_sel_hi:[1,1,0]
v_cvt_pkrtz_f16_f32 v119, v118, v119
v_fma_mix_f32 v227, v105, v105, v227 op_sel_hi:[1,1,0]
v_and_b32_e64 v119, s49, v119
v_bfe_u32 v118, v119, 2, 14
v_lshrrev_b32 v119, 18, v119
v_exp_f16_sdwa v125, v125 dst_sel:WORD_1 dst_unused:UNUSED_PRESERVE src0_sel:WORD_1
s_waitcnt lgkmcnt(6)
v_fma_mix_f32 v227, v106, v106, v227 op_sel_hi:[1,1,0]
v_cvt_pkrtz_f16_f32 v121, v120, v121
v_fma_mix_f32 v227, v107, v107, v227 op_sel_hi:[1,1,0]
v_and_b32_e64 v121, s49, v121
v_bfe_u32 v120, v121, 2, 14
ds_read_u16 v118, v118
ds_read_u16 v119, v119
v_lshrrev_b32_e64 v121, 18, v121
v_exp_f16_sdwa v127, v127 dst_sel:WORD_1 dst_unused:UNUSED_PRESERVE src0_sel:WORD_1
v_mfma_f32_32x32x16_bf16 v[144:159], v[40:43], v[176:179], v[144:159]
ds_read_u16 v120, v120
ds_read_u16 v121, v121
ds_read_b128 v[188:191], v250 offset:31744
v_cvt_pkrtz_f16_f32 v123, v122, v123
v_and_b32_e64 v123, s49, v123
v_bfe_u32 v122, v123, 2, 14
v_lshrrev_b32_e64 v123, 18, v123
v_pk_add_f16 v125, v125, 1.0 op_sel_hi:[1,0]
v_pk_add_f16 v127, v127, 1.0 op_sel_hi:[1,0]
v_rcp_f16_sdwa v125, v125 dst_sel:WORD_0 dst_unused:UNUSED_PRESERVE src0_sel:WORD_0
v_mfma_f32_32x32x16_bf16 v[128:143], v[20:23], v[180:183], v[128:143]
ds_read_u16 v122, v122
ds_read_u16 v123, v123
v_rcp_f16_sdwa v127, v127 dst_sel:WORD_0 dst_unused:UNUSED_PRESERVE src0_sel:WORD_0
v_rcp_f16_sdwa v125, v125 dst_sel:WORD_1 dst_unused:UNUSED_PRESERVE src0_sel:WORD_1
v_rcp_f16_sdwa v127, v127 dst_sel:WORD_1 dst_unused:UNUSED_PRESERVE src0_sel:WORD_1
v_mfma_f32_32x32x16_bf16 v[144:159], v[44:47], v[180:183], v[144:159]
ds_read_b128 v[176:179], v250 offset:32768
v_pk_mul_f16 v124, v124, v125
v_pk_mul_f16 v126, v126, v127
v_fma_mix_f32 v227, v124, v124, v227 op_sel_hi:[1,1,0]
s_cmp_lg_u32 s40, 7
s_cbranch_scc1 Lnoinit
s_waitcnt vmcnt(0)
v_mov_b32 v222, 1
v_mov_b32_e64 v223, 0
s_nop 4
s_mov_b64 exec, 1
buffer_atomic_add v222, v223, s[36:39], 0 offen
s_mov_b64 exec, -1
s_nop 1
Lnoinit:
v_cvt_pkrtz_f16_f32 v129, v128, v129
v_fma_mix_f32 v227, v126, v126, v227 op_sel_hi:[1,1,0]
s_waitcnt lgkmcnt(7)
v_mfma_f32_32x32x16_bf16 v[160:175], v[0:3], v[184:187], 0
v_fma_mix_f32 v227, v124, v124, v227 op_sel:[1,1,0] op_sel_hi:[1,1,0]
v_and_b32 v129, s49, v129
v_fma_mix_f32 v227, v126, v126, v227 op_sel:[1,1,0] op_sel_hi:[1,1,0]
v_bfe_u32 v128, v129, 2, 14
v_fma_mix_f32 v227, v112, v112, v227 op_sel_hi:[1,1,0]
v_lshrrev_b32_e64 v129, 18, v129
v_fma_mix_f32 v227, v113, v113, v227 op_sel_hi:[1,1,0]
v_cvt_pk_f16_f32 v140, v140, v141
v_fma_mix_f32 v227, v114, v114, v227 op_sel_hi:[1,1,0]
v_cvt_pk_f16_f32 v142, v142, v143
v_fma_mix_f32 v227, v115, v115, v227 op_sel_hi:[1,1,0]
v_pk_fma_f16 v141, v140, v140, s48
v_mfma_f32_32x32x16_bf16 v[96:111], v[24:27], v[184:187], 0
ds_read_u16 v128, v128
ds_read_u16 v129, v129
v_fma_mix_f32 v227, v116, v116, v227 op_sel_hi:[1,1,0]
v_cvt_pkrtz_f16_f32 v131, v130, v131
v_fma_mix_f32 v227, v117, v117, v227 op_sel_hi:[1,1,0]
v_and_b32_e64 v131, s49, v131
v_bfe_u32 v130, v131, 2, 14
v_lshrrev_b32_e64 v131, 18, v131
v_pk_fma_f16 v143, v142, v142, s48
v_pk_mul_f16 v141, v140, v141
v_pk_mul_f16 v143, v142, v143
v_fma_mix_f32 v227, v118, v118, v227 op_sel_hi:[1,1,0]
v_cvt_pkrtz_f16_f32 v133, v132, v133
s_waitcnt lgkmcnt(3)
v_fma_mix_f32 v227, v119, v119, v227 op_sel_hi:[1,1,0]
ds_read_u16 v130, v130
ds_read_u16 v131, v131
ds_read_b128 v[180:183], v250 offset:33792
v_and_b32 v133, s49, v133
v_bfe_u32 v132, v133, 2, 14
v_lshrrev_b32_e64 v133, 18, v133
v_exp_f16_sdwa v141, v141 dst_sel:WORD_0 dst_unused:UNUSED_PRESERVE src0_sel:WORD_0
v_mfma_f32_32x32x16_bf16 v[160:175], v[4:7], v[188:191], v[160:175]
ds_read_u16 v132, v132
ds_read_u16 v133, v133
v_exp_f16_sdwa v143, v143 dst_sel:WORD_0 dst_unused:UNUSED_PRESERVE src0_sel:WORD_0
v_fma_mix_f32 v227, v120, v120, v227 op_sel_hi:[1,1,0]
v_cvt_pkrtz_f16_f32 v135, v134, v135
v_fma_mix_f32 v227, v121, v121, v227 op_sel_hi:[1,1,0]
v_and_b32_e64 v135, s49, v135
v_bfe_u32 v134, v135, 2, 14
v_lshrrev_b32_e64 v135, 18, v135
v_exp_f16_sdwa v141, v141 dst_sel:WORD_1 dst_unused:UNUSED_PRESERVE src0_sel:WORD_1
v_fma_mix_f32 v227, v122, v122, v227 op_sel_hi:[1,1,0]
v_cvt_pkrtz_f16_f32 v137, v136, v137
v_fma_mix_f32 v227, v123, v123, v227 op_sel_hi:[1,1,0]
v_and_b32_e64 v137, s49, v137
v_bfe_u32 v136, v137, 2, 14
ds_read_u16 v134, v134
ds_read_u16 v135, v135
v_lshrrev_b32_e64 v137, 18, v137
v_exp_f16_sdwa v143, v143 dst_sel:WORD_1 dst_unused:UNUSED_PRESERVE src0_sel:WORD_1
v_mfma_f32_32x32x16_bf16 v[96:111], v[28:31], v[188:191], v[96:111]
ds_read_u16 v136, v136
ds_read_u16 v137, v137
ds_read_b128 v[184:187], v250 offset:34816
v_cvt_pkrtz_f16_f32 v139, v138, v139
v_and_b32_e64 v139, s49, v139
v_bfe_u32 v138, v139, 2, 14
v_lshrrev_b32 v139, 18, v139
v_pk_add_f16 v141, v141, 1.0 op_sel_hi:[1,0]
v_pk_add_f16 v143, v143, 1.0 op_sel_hi:[1,0]
v_rcp_f16_sdwa v141, v141 dst_sel:WORD_0 dst_unused:UNUSED_PRESERVE src0_sel:WORD_0
s_waitcnt lgkmcnt(7)
v_mfma_f32_32x32x16_bf16 v[160:175], v[8:11], v[176:179], v[160:175]
ds_read_u16 v138, v138
ds_read_u16 v139, v139
v_rcp_f16_sdwa v143, v143 dst_sel:WORD_0 dst_unused:UNUSED_PRESERVE src0_sel:WORD_0
v_rcp_f16_sdwa v141, v141 dst_sel:WORD_1 dst_unused:UNUSED_PRESERVE src0_sel:WORD_1
v_rcp_f16_sdwa v143, v143 dst_sel:WORD_1 dst_unused:UNUSED_PRESERVE src0_sel:WORD_1
v_mfma_f32_32x32x16_bf16 v[96:111], v[32:35], v[176:179], v[96:111]
ds_read_b128 v[188:191], v250 offset:35840
v_pk_mul_f16 v140, v140, v141
v_pk_mul_f16 v142, v142, v143
v_fma_mix_f32 v228, v140, v140, v228 op_sel_hi:[1,1,0]
s_add_u32 s66, s66, 786432
s_sub_u32 s81, s81, 13184
v_bfe_u32 v223, v250, 4, 6
v_and_b32 v222, 15, v223
v_lshlrev_b32 v222, 7, v222
v_lshrrev_b32 v223, 4, v223
v_mul_u32_u24 v223, 98304, v223
s_sub_u32 s43, s67, -8000
s_mul_i32 s44, s41, 192
s_add_u32 s43, s43, s44
v_add3_u32 v222, v222, v223, s43
s_mov_b32 m0, 163840
s_add_u32 s44, s66, 393216
buffer_load_dword v222, s[4:7], s66 offen lds
buffer_load_dword v222, s[4:7], s44 offen lds
v_fma_mix_f32 v228, v142, v142, v228 op_sel_hi:[1,1,0]
v_mfma_f32_32x32x16_bf16 v[160:175], v[12:15], v[180:183], v[160:175]
v_fma_mix_f32 v228, v140, v140, v228 op_sel:[1,1,0] op_sel_hi:[1,1,0]
v_cvt_pkrtz_f16_f32 v145, v144, v145
v_fma_mix_f32 v228, v142, v142, v228 op_sel:[1,1,0] op_sel_hi:[1,1,0]
v_and_b32_e64 v145, s49, v145
v_fma_mix_f32 v228, v128, v128, v228 op_sel_hi:[1,1,0]
v_bfe_u32 v144, v145, 2, 14
v_fma_mix_f32 v228, v129, v129, v228 op_sel_hi:[1,1,0]
v_lshrrev_b32_e64 v145, 18, v145
v_fma_mix_f32 v228, v130, v130, v228 op_sel_hi:[1,1,0]
v_cvt_pk_f16_f32 v156, v156, v157
v_fma_mix_f32 v228, v131, v131, v228 op_sel_hi:[1,1,0]
v_cvt_pk_f16_f32 v158, v158, v159
v_pk_fma_f16 v157, v156, v156, s48
v_mfma_f32_32x32x16_bf16 v[96:111], v[36:39], v[180:183], v[96:111]
ds_read_u16 v144, v144
ds_read_u16 v145, v145
s_waitcnt lgkmcnt(4)
v_fma_mix_f32 v228, v132, v132, v228 op_sel_hi:[1,1,0]
v_cvt_pkrtz_f16_f32 v147, v146, v147
v_fma_mix_f32 v228, v133, v133, v228 op_sel_hi:[1,1,0]
v_and_b32 v147, s49, v147
v_bfe_u32 v146, v147, 2, 14
v_lshrrev_b32_e64 v147, 18, v147
v_pk_fma_f16 v159, v158, v158, s48
v_pk_mul_f16 v157, v156, v157
v_pk_mul_f16 v159, v158, v159
v_fma_mix_f32 v228, v134, v134, v228 op_sel_hi:[1,1,0]
v_cvt_pkrtz_f16_f32 v149, v148, v149
v_fma_mix_f32 v228, v135, v135, v228 op_sel_hi:[1,1,0]
ds_read_u16 v146, v146
ds_read_u16 v147, v147
ds_read_b128 v[176:179], v250 offset:36864
v_and_b32_e64 v149, s49, v149
v_bfe_u32 v148, v149, 2, 14
v_lshrrev_b32_e64 v149, 18, v149
v_exp_f16_sdwa v157, v157 dst_sel:WORD_0 dst_unused:UNUSED_PRESERVE src0_sel:WORD_0
v_mfma_f32_32x32x16_bf16 v[160:175], v[16:19], v[184:187], v[160:175]
ds_read_u16 v148, v148
ds_read_u16 v149, v149
v_exp_f16_sdwa v159, v159 dst_sel:WORD_0 dst_unused:UNUSED_PRESERVE src0_sel:WORD_0
v_fma_mix_f32 v228, v136, v136, v228 op_sel_hi:[1,1,0]
v_cvt_pkrtz_f16_f32 v151, v150, v151
v_fma_mix_f32 v228, v137, v137, v228 op_sel_hi:[1,1,0]
v_and_b32_e64 v151, s49, v151
v_bfe_u32 v150, v151, 2, 14
v_lshrrev_b32_e64 v151, 18, v151
v_exp_f16_sdwa v157, v157 dst_sel:WORD_1 dst_unused:UNUSED_PRESERVE src0_sel:WORD_1
v_fma_mix_f32 v228, v138, v138, v228 op_sel_hi:[1,1,0]
v_cvt_pkrtz_f16_f32 v153, v152, v153
s_waitcnt lgkmcnt(5)
v_fma_mix_f32 v228, v139, v139, v228 op_sel_hi:[1,1,0]
v_and_b32 v153, s49, v153
v_bfe_u32 v152, v153, 2, 14
ds_read_u16 v150, v150
ds_read_u16 v151, v151
v_lshrrev_b32_e64 v153, 18, v153
v_exp_f16_sdwa v159, v159 dst_sel:WORD_1 dst_unused:UNUSED_PRESERVE src0_sel:WORD_1
v_mfma_f32_32x32x16_bf16 v[96:111], v[40:43], v[184:187], v[96:111]
ds_read_u16 v152, v152
ds_read_u16 v153, v153
ds_read_b128 v[180:183], v250 offset:37888
v_cvt_pkrtz_f16_f32 v155, v154, v155
v_and_b32_e64 v155, s49, v155
v_bfe_u32 v154, v155, 2, 14
v_lshrrev_b32_e64 v155, 18, v155
v_pk_add_f16 v157, v157, 1.0 op_sel_hi:[1,0]
v_pk_add_f16 v159, v159, 1.0 op_sel_hi:[1,0]
v_rcp_f16_sdwa v157, v157 dst_sel:WORD_0 dst_unused:UNUSED_PRESERVE src0_sel:WORD_0
v_mfma_f32_32x32x16_bf16 v[160:175], v[20:23], v[188:191], v[160:175]
ds_read_u16 v154, v154
ds_read_u16 v155, v155
v_rcp_f16_sdwa v159, v159 dst_sel:WORD_0 dst_unused:UNUSED_PRESERVE src0_sel:WORD_0
v_rcp_f16_sdwa v157, v157 dst_sel:WORD_1 dst_unused:UNUSED_PRESERVE src0_sel:WORD_1
v_rcp_f16_sdwa v159, v159 dst_sel:WORD_1 dst_unused:UNUSED_PRESERVE src0_sel:WORD_1
v_mfma_f32_32x32x16_bf16 v[96:111], v[44:47], v[188:191], v[96:111]
ds_read_b128 v[184:187], v250 offset:38912
v_pk_mul_f16 v156, v156, v157
v_pk_mul_f16 v158, v158, v159
v_fma_mix_f32 v228, v156, v156, v228 op_sel_hi:[1,1,0]
s_nop 1
v_cvt_pkrtz_f16_f32 v161, v160, v161
v_fma_mix_f32 v228, v158, v158, v228 op_sel_hi:[1,1,0]
s_waitcnt lgkmcnt(7)
v_mfma_f32_32x32x16_bf16 v[112:127], v[0:3], v[176:179], 0
v_fma_mix_f32 v228, v156, v156, v228 op_sel:[1,1,0] op_sel_hi:[1,1,0]
v_and_b32_e64 v161, s49, v161
v_fma_mix_f32 v228, v158, v158, v228 op_sel:[1,1,0] op_sel_hi:[1,1,0]
v_bfe_u32 v160, v161, 2, 14
v_fma_mix_f32 v228, v144, v144, v228 op_sel_hi:[1,1,0]
v_lshrrev_b32_e64 v161, 18, v161
v_fma_mix_f32 v228, v145, v145, v228 op_sel_hi:[1,1,0]
v_cvt_pk_f16_f32 v172, v172, v173
v_fma_mix_f32 v228, v146, v146, v228 op_sel_hi:[1,1,0]
v_cvt_pk_f16_f32 v174, v174, v175
v_fma_mix_f32 v228, v147, v147, v228 op_sel_hi:[1,1,0]
v_pk_fma_f16 v173, v172, v172, s48
v_mfma_f32_32x32x16_bf16 v[128:143], v[24:27], v[176:179], 0
ds_read_u16 v160, v160
ds_read_u16 v161, v161
v_fma_mix_f32 v228, v148, v148, v228 op_sel_hi:[1,1,0]
v_cvt_pkrtz_f16_f32 v163, v162, v163
v_fma_mix_f32 v228, v149, v149, v228 op_sel_hi:[1,1,0]
v_and_b32_e64 v163, s49, v163
v_bfe_u32 v162, v163, 2, 14
v_lshrrev_b32_e64 v163, 18, v163
v_pk_fma_f16 v175, v174, v174, s48
v_pk_mul_f16 v173, v172, v173
v_pk_mul_f16 v175, v174, v175
v_fma_mix_f32 v228, v150, v150, v228 op_sel_hi:[1,1,0]
v_cvt_pkrtz_f16_f32 v165, v164, v165
s_waitcnt lgkmcnt(3)
v_fma_mix_f32 v228, v151, v151, v228 op_sel_hi:[1,1,0]
ds_read_u16 v162, v162
ds_read_u16 v163, v163
ds_read_b128 v[188:191], v250 offset:39936
v_and_b32 v165, s49, v165
v_bfe_u32 v164, v165, 2, 14
v_lshrrev_b32_e64 v165, 18, v165
v_exp_f16_sdwa v173, v173 dst_sel:WORD_0 dst_unused:UNUSED_PRESERVE src0_sel:WORD_0
v_mfma_f32_32x32x16_bf16 v[112:127], v[4:7], v[180:183], v[112:127]
ds_read_u16 v164, v164
ds_read_u16 v165, v165
v_fma_mix_f32 v228, v152, v152, v228 op_sel_hi:[1,1,0]
v_exp_f16_sdwa v175, v175 dst_sel:WORD_0 dst_unused:UNUSED_PRESERVE src0_sel:WORD_0
v_fma_mix_f32 v228, v153, v153, v228 op_sel_hi:[1,1,0]
v_cvt_pkrtz_f16_f32 v167, v166, v167
v_and_b32_e64 v167, s49, v167
v_bfe_u32 v166, v167, 2, 14
v_lshrrev_b32_e64 v167, 18, v167
v_exp_f16_sdwa v173, v173 dst_sel:WORD_1 dst_unused:UNUSED_PRESERVE src0_sel:WORD_1
v_fma_mix_f32 v228, v154, v154, v228 op_sel_hi:[1,1,0]
v_cvt_pkrtz_f16_f32 v169, v168, v169
v_fma_mix_f32 v228, v155, v155, v228 op_sel_hi:[1,1,0]
v_and_b32_e64 v169, s49, v169
v_bfe_u32 v168, v169, 2, 14
ds_read_u16 v166, v166
ds_read_u16 v167, v167
v_lshrrev_b32_e64 v169, 18, v169
v_exp_f16_sdwa v175, v175 dst_sel:WORD_1 dst_unused:UNUSED_PRESERVE src0_sel:WORD_1
v_mfma_f32_32x32x16_bf16 v[128:143], v[28:31], v[180:183], v[128:143]
ds_read_u16 v168, v168
ds_read_u16 v169, v169
ds_read_b128 v[176:179], v250 offset:40960
v_cvt_pkrtz_f16_f32 v171, v170, v171
v_and_b32_e64 v171, s49, v171
v_bfe_u32 v170, v171, 2, 14
v_lshrrev_b32 v171, 18, v171
v_pk_add_f16 v173, v173, 1.0 op_sel_hi:[1,0]
v_pk_add_f16 v175, v175, 1.0 op_sel_hi:[1,0]
v_rcp_f16_sdwa v173, v173 dst_sel:WORD_0 dst_unused:UNUSED_PRESERVE src0_sel:WORD_0
s_waitcnt lgkmcnt(7)
v_mfma_f32_32x32x16_bf16 v[112:127], v[8:11], v[184:187], v[112:127]
ds_read_u16 v170, v170
ds_read_u16 v171, v171
v_rcp_f16_sdwa v175, v175 dst_sel:WORD_0 dst_unused:UNUSED_PRESERVE src0_sel:WORD_0
v_rcp_f16_sdwa v173, v173 dst_sel:WORD_1 dst_unused:UNUSED_PRESERVE src0_sel:WORD_1
v_rcp_f16_sdwa v175, v175 dst_sel:WORD_1 dst_unused:UNUSED_PRESERVE src0_sel:WORD_1
v_mfma_f32_32x32x16_bf16 v[128:143], v[32:35], v[184:187], v[128:143]
ds_read_b128 v[180:183], v250 offset:41984
v_pk_mul_f16 v172, v172, v173
v_pk_mul_f16 v174, v174, v175
v_fma_mix_f32 v229, v172, v172, v229 op_sel_hi:[1,1,0]
v_cvt_pkrtz_f16_f32 v97, v96, v97
v_fma_mix_f32 v229, v174, v174, v229 op_sel_hi:[1,1,0]
v_mfma_f32_32x32x16_bf16 v[112:127], v[12:15], v[188:191], v[112:127]
v_fma_mix_f32 v229, v172, v172, v229 op_sel:[1,1,0] op_sel_hi:[1,1,0]
v_and_b32_e64 v97, s49, v97
v_fma_mix_f32 v229, v174, v174, v229 op_sel:[1,1,0] op_sel_hi:[1,1,0]
v_bfe_u32 v96, v97, 2, 14
v_fma_mix_f32 v229, v160, v160, v229 op_sel_hi:[1,1,0]
v_lshrrev_b32_e64 v97, 18, v97
v_fma_mix_f32 v229, v161, v161, v229 op_sel_hi:[1,1,0]
v_cvt_pk_f16_f32 v108, v108, v109
v_fma_mix_f32 v229, v162, v162, v229 op_sel_hi:[1,1,0]
v_cvt_pk_f16_f32 v110, v110, v111
v_fma_mix_f32 v229, v163, v163, v229 op_sel_hi:[1,1,0]
v_pk_fma_f16 v109, v108, v108, s48
v_mfma_f32_32x32x16_bf16 v[128:143], v[36:39], v[188:191], v[128:143]
ds_read_u16 v96, v96
ds_read_u16 v97, v97
s_waitcnt lgkmcnt(5)
v_fma_mix_f32 v229, v164, v164, v229 op_sel_hi:[1,1,0]
v_cvt_pkrtz_f16_f32 v99, v98, v99
v_fma_mix_f32 v229, v165, v165, v229 op_sel_hi:[1,1,0]
v_and_b32 v99, s49, v99
v_bfe_u32 v98, v99, 2, 14
v_lshrrev_b32_e64 v99, 18, v99
v_pk_fma_f16 v111, v110, v110, s48
v_pk_mul_f16 v109, v108, v109
v_pk_mul_f16 v111, v110, v111
v_fma_mix_f32 v229, v166, v166, v229 op_sel_hi:[1,1,0]
v_cvt_pkrtz_f16_f32 v101, v100, v101
v_fma_mix_f32 v229, v167, v167, v229 op_sel_hi:[1,1,0]
ds_read_u16 v98, v98
ds_read_u16 v99, v99
ds_read_b128 v[184:187], v250 offset:43008
v_and_b32_e64 v101, s49, v101
v_bfe_u32 v100, v101, 2, 14
v_lshrrev_b32_e64 v101, 18, v101
v_exp_f16_sdwa v109, v109 dst_sel:WORD_0 dst_unused:UNUSED_PRESERVE src0_sel:WORD_0
v_mfma_f32_32x32x16_bf16 v[112:127], v[16:19], v[176:179], v[112:127]
ds_read_u16 v100, v100
ds_read_u16 v101, v101
v_fma_mix_f32 v229, v168, v168, v229 op_sel_hi:[1,1,0]
v_exp_f16_sdwa v111, v111 dst_sel:WORD_0 dst_unused:UNUSED_PRESERVE src0_sel:WORD_0
v_fma_mix_f32 v229, v169, v169, v229 op_sel_hi:[1,1,0]
v_cvt_pkrtz_f16_f32 v103, v102, v103
v_and_b32_e64 v103, s49, v103
v_bfe_u32 v102, v103, 2, 14
v_lshrrev_b32 v103, 18, v103
v_exp_f16_sdwa v109, v109 dst_sel:WORD_1 dst_unused:UNUSED_PRESERVE src0_sel:WORD_1
s_waitcnt lgkmcnt(6)
v_fma_mix_f32 v229, v170, v170, v229 op_sel_hi:[1,1,0]
v_cvt_pkrtz_f16_f32 v105, v104, v105
v_fma_mix_f32 v229, v171, v171, v229 op_sel_hi:[1,1,0]
v_and_b32_e64 v105, s49, v105
v_bfe_u32 v104, v105, 2, 14
ds_read_u16 v102, v102
ds_read_u16 v103, v103
v_lshrrev_b32_e64 v105, 18, v105
v_exp_f16_sdwa v111, v111 dst_sel:WORD_1 dst_unused:UNUSED_PRESERVE src0_sel:WORD_1
v_mfma_f32_32x32x16_bf16 v[128:143], v[40:43], v[176:179], v[128:143]
ds_read_u16 v104, v104
ds_read_u16 v105, v105
ds_read_b128 v[188:191], v250 offset:44032
v_cvt_pkrtz_f16_f32 v107, v106, v107
v_and_b32_e64 v107, s49, v107
v_bfe_u32 v106, v107, 2, 14
v_lshrrev_b32_e64 v107, 18, v107
v_pk_add_f16 v109, v109, 1.0 op_sel_hi:[1,0]
v_pk_add_f16 v111, v111, 1.0 op_sel_hi:[1,0]
v_rcp_f16_sdwa v109, v109 dst_sel:WORD_0 dst_unused:UNUSED_PRESERVE src0_sel:WORD_0
v_mfma_f32_32x32x16_bf16 v[112:127], v[20:23], v[180:183], v[112:127]
ds_read_u16 v106, v106
ds_read_u16 v107, v107
v_rcp_f16_sdwa v111, v111 dst_sel:WORD_0 dst_unused:UNUSED_PRESERVE src0_sel:WORD_0
v_rcp_f16_sdwa v109, v109 dst_sel:WORD_1 dst_unused:UNUSED_PRESERVE src0_sel:WORD_1
v_rcp_f16_sdwa v111, v111 dst_sel:WORD_1 dst_unused:UNUSED_PRESERVE src0_sel:WORD_1
v_mfma_f32_32x32x16_bf16 v[128:143], v[44:47], v[180:183], v[128:143]
ds_read_b128 v[176:179], v250 offset:45056
v_pk_mul_f16 v108, v108, v109
v_pk_mul_f16 v110, v110, v111
v_fma_mix_f32 v229, v108, v108, v229 op_sel_hi:[1,1,0]
s_nop 1
v_cvt_pkrtz_f16_f32 v113, v112, v113
v_fma_mix_f32 v229, v110, v110, v229 op_sel_hi:[1,1,0]
s_waitcnt lgkmcnt(7)
v_mfma_f32_32x32x16_bf16 v[144:159], v[0:3], v[184:187], 0
v_fma_mix_f32 v229, v108, v108, v229 op_sel:[1,1,0] op_sel_hi:[1,1,0]
v_and_b32_e64 v113, s49, v113
v_fma_mix_f32 v229, v110, v110, v229 op_sel:[1,1,0] op_sel_hi:[1,1,0]
v_bfe_u32 v112, v113, 2, 14
v_fma_mix_f32 v229, v96, v96, v229 op_sel_hi:[1,1,0]
v_lshrrev_b32_e64 v113, 18, v113
v_fma_mix_f32 v229, v97, v97, v229 op_sel_hi:[1,1,0]
v_cvt_pk_f16_f32 v124, v124, v125
v_fma_mix_f32 v229, v98, v98, v229 op_sel_hi:[1,1,0]
v_cvt_pk_f16_f32 v126, v126, v127
v_fma_mix_f32 v229, v99, v99, v229 op_sel_hi:[1,1,0]
v_pk_fma_f16 v125, v124, v124, s48
v_mfma_f32_32x32x16_bf16 v[160:175], v[24:27], v[184:187], 0
ds_read_u16 v112, v112
ds_read_u16 v113, v113
v_fma_mix_f32 v229, v100, v100, v229 op_sel_hi:[1,1,0]
v_cvt_pkrtz_f16_f32 v115, v114, v115
v_fma_mix_f32 v229, v101, v101, v229 op_sel_hi:[1,1,0]
v_and_b32_e64 v115, s49, v115
v_bfe_u32 v114, v115, 2, 14
v_lshrrev_b32_e64 v115, 18, v115
v_pk_fma_f16 v127, v126, v126, s48
v_pk_mul_f16 v125, v124, v125
v_pk_mul_f16 v127, v126, v127
v_fma_mix_f32 v229, v102, v102, v229 op_sel_hi:[1,1,0]
v_cvt_pkrtz_f16_f32 v117, v116, v117
s_waitcnt lgkmcnt(3)
v_fma_mix_f32 v229, v103, v103, v229 op_sel_hi:[1,1,0]
ds_read_u16 v114, v114
ds_read_u16 v115, v115
ds_read_b128 v[180:183], v250 offset:46080
v_and_b32 v117, s49, v117
v_bfe_u32 v116, v117, 2, 14
v_lshrrev_b32_e64 v117, 18, v117
v_exp_f16_sdwa v125, v125 dst_sel:WORD_0 dst_unused:UNUSED_PRESERVE src0_sel:WORD_0
v_mfma_f32_32x32x16_bf16 v[144:159], v[4:7], v[188:191], v[144:159]
ds_read_u16 v116, v116
ds_read_u16 v117, v117
v_fma_mix_f32 v229, v104, v104, v229 op_sel_hi:[1,1,0]
v_exp_f16_sdwa v127, v127 dst_sel:WORD_0 dst_unused:UNUSED_PRESERVE src0_sel:WORD_0
v_fma_mix_f32 v229, v105, v105, v229 op_sel_hi:[1,1,0]
v_cvt_pkrtz_f16_f32 v119, v118, v119
v_and_b32_e64 v119, s49, v119
v_bfe_u32 v118, v119, 2, 14
v_lshrrev_b32_e64 v119, 18, v119
v_exp_f16_sdwa v125, v125 dst_sel:WORD_1 dst_unused:UNUSED_PRESERVE src0_sel:WORD_1
v_fma_mix_f32 v229, v106, v106, v229 op_sel_hi:[1,1,0]
v_cvt_pkrtz_f16_f32 v121, v120, v121
v_fma_mix_f32 v229, v107, v107, v229 op_sel_hi:[1,1,0]
v_and_b32_e64 v121, s49, v121
v_bfe_u32 v120, v121, 2, 14
ds_read_u16 v118, v118
ds_read_u16 v119, v119
v_lshrrev_b32_e64 v121, 18, v121
v_exp_f16_sdwa v127, v127 dst_sel:WORD_1 dst_unused:UNUSED_PRESERVE src0_sel:WORD_1
v_mfma_f32_32x32x16_bf16 v[160:175], v[28:31], v[188:191], v[160:175]
ds_read_u16 v120, v120
ds_read_u16 v121, v121
ds_read_b128 v[184:187], v250 offset:47104
v_cvt_pkrtz_f16_f32 v123, v122, v123
v_and_b32_e64 v123, s49, v123
v_bfe_u32 v122, v123, 2, 14
v_lshrrev_b32 v123, 18, v123
v_pk_add_f16 v125, v125, 1.0 op_sel_hi:[1,0]
v_pk_add_f16 v127, v127, 1.0 op_sel_hi:[1,0]
v_rcp_f16_sdwa v125, v125 dst_sel:WORD_0 dst_unused:UNUSED_PRESERVE src0_sel:WORD_0
s_waitcnt lgkmcnt(7)
v_mfma_f32_32x32x16_bf16 v[144:159], v[8:11], v[176:179], v[144:159]
ds_read_u16 v122, v122
ds_read_u16 v123, v123
v_rcp_f16_sdwa v127, v127 dst_sel:WORD_0 dst_unused:UNUSED_PRESERVE src0_sel:WORD_0
v_rcp_f16_sdwa v125, v125 dst_sel:WORD_1 dst_unused:UNUSED_PRESERVE src0_sel:WORD_1
v_rcp_f16_sdwa v127, v127 dst_sel:WORD_1 dst_unused:UNUSED_PRESERVE src0_sel:WORD_1
v_mfma_f32_32x32x16_bf16 v[160:175], v[32:35], v[176:179], v[160:175]
ds_read_b128 v[188:191], v250 offset:48128
v_pk_mul_f16 v124, v124, v125
v_pk_mul_f16 v126, v126, v127
v_fma_mix_f32 v230, v124, v124, v230 op_sel_hi:[1,1,0]
v_cvt_pkrtz_f16_f32 v129, v128, v129
v_fma_mix_f32 v230, v126, v126, v230 op_sel_hi:[1,1,0]
v_mfma_f32_32x32x16_bf16 v[144:159], v[12:15], v[180:183], v[144:159]
v_fma_mix_f32 v230, v124, v124, v230 op_sel:[1,1,0] op_sel_hi:[1,1,0]
v_and_b32_e64 v129, s49, v129
v_fma_mix_f32 v230, v126, v126, v230 op_sel:[1,1,0] op_sel_hi:[1,1,0]
v_bfe_u32 v128, v129, 2, 14
v_fma_mix_f32 v230, v112, v112, v230 op_sel_hi:[1,1,0]
v_lshrrev_b32_e64 v129, 18, v129
v_fma_mix_f32 v230, v113, v113, v230 op_sel_hi:[1,1,0]
v_cvt_pk_f16_f32 v140, v140, v141
v_fma_mix_f32 v230, v114, v114, v230 op_sel_hi:[1,1,0]
v_cvt_pk_f16_f32 v142, v142, v143
v_fma_mix_f32 v230, v115, v115, v230 op_sel_hi:[1,1,0]
v_pk_fma_f16 v141, v140, v140, s48
v_mfma_f32_32x32x16_bf16 v[160:175], v[36:39], v[180:183], v[160:175]
ds_read_u16 v128, v128
ds_read_u16 v129, v129
s_waitcnt lgkmcnt(5)
v_fma_mix_f32 v230, v116, v116, v230 op_sel_hi:[1,1,0]
v_cvt_pkrtz_f16_f32 v131, v130, v131
v_fma_mix_f32 v230, v117, v117, v230 op_sel_hi:[1,1,0]
v_and_b32 v131, s49, v131
v_bfe_u32 v130, v131, 2, 14
v_lshrrev_b32_e64 v131, 18, v131
v_pk_fma_f16 v143, v142, v142, s48
v_pk_mul_f16 v141, v140, v141
v_pk_mul_f16 v143, v142, v143
v_fma_mix_f32 v230, v118, v118, v230 op_sel_hi:[1,1,0]
v_cvt_pkrtz_f16_f32 v133, v132, v133
v_fma_mix_f32 v230, v119, v119, v230 op_sel_hi:[1,1,0]
ds_read_u16 v130, v130
ds_read_u16 v131, v131
ds_read_b128 v[176:179], v250 offset:49152
v_and_b32_e64 v133, s49, v133
v_bfe_u32 v132, v133, 2, 14
v_lshrrev_b32_e64 v133, 18, v133
v_exp_f16_sdwa v141, v141 dst_sel:WORD_0 dst_unused:UNUSED_PRESERVE src0_sel:WORD_0
v_mfma_f32_32x32x16_bf16 v[144:159], v[16:19], v[184:187], v[144:159]
ds_read_u16 v132, v132
ds_read_u16 v133, v133
v_fma_mix_f32 v230, v120, v120, v230 op_sel_hi:[1,1,0]
v_exp_f16_sdwa v143, v143 dst_sel:WORD_0 dst_unused:UNUSED_PRESERVE src0_sel:WORD_0
v_fma_mix_f32 v230, v121, v121, v230 op_sel_hi:[1,1,0]
v_cvt_pkrtz_f16_f32 v135, v134, v135
v_and_b32_e64 v135, s49, v135
v_bfe_u32 v134, v135, 2, 14
v_lshrrev_b32 v135, 18, v135
v_exp_f16_sdwa v141, v141 dst_sel:WORD_1 dst_unused:UNUSED_PRESERVE src0_sel:WORD_1
s_waitcnt lgkmcnt(6)
v_fma_mix_f32 v230, v122, v122, v230 op_sel_hi:[1,1,0]
v_cvt_pkrtz_f16_f32 v137, v136, v137
v_fma_mix_f32 v230, v123, v123, v230 op_sel_hi:[1,1,0]
v_and_b32_e64 v137, s49, v137
v_bfe_u32 v136, v137, 2, 14
ds_read_u16 v134, v134
ds_read_u16 v135, v135
v_lshrrev_b32_e64 v137, 18, v137
v_exp_f16_sdwa v143, v143 dst_sel:WORD_1 dst_unused:UNUSED_PRESERVE src0_sel:WORD_1
v_mfma_f32_32x32x16_bf16 v[160:175], v[40:43], v[184:187], v[160:175]
ds_read_u16 v136, v136
ds_read_u16 v137, v137
ds_read_b128 v[180:183], v250 offset:50176
v_cvt_pkrtz_f16_f32 v139, v138, v139
v_and_b32_e64 v139, s49, v139
v_bfe_u32 v138, v139, 2, 14
v_lshrrev_b32_e64 v139, 18, v139
v_pk_add_f16 v141, v141, 1.0 op_sel_hi:[1,0]
v_pk_add_f16 v143, v143, 1.0 op_sel_hi:[1,0]
v_rcp_f16_sdwa v141, v141 dst_sel:WORD_0 dst_unused:UNUSED_PRESERVE src0_sel:WORD_0
v_mfma_f32_32x32x16_bf16 v[144:159], v[20:23], v[188:191], v[144:159]
ds_read_u16 v138, v138
ds_read_u16 v139, v139
v_rcp_f16_sdwa v143, v143 dst_sel:WORD_0 dst_unused:UNUSED_PRESERVE src0_sel:WORD_0
v_rcp_f16_sdwa v141, v141 dst_sel:WORD_1 dst_unused:UNUSED_PRESERVE src0_sel:WORD_1
v_rcp_f16_sdwa v143, v143 dst_sel:WORD_1 dst_unused:UNUSED_PRESERVE src0_sel:WORD_1
v_mfma_f32_32x32x16_bf16 v[160:175], v[44:47], v[188:191], v[160:175]
ds_read_b128 v[184:187], v250 offset:51200
v_pk_mul_f16 v140, v140, v141
v_pk_mul_f16 v142, v142, v143
v_fma_mix_f32 v230, v140, v140, v230 op_sel_hi:[1,1,0]
s_nop 1
v_cvt_pkrtz_f16_f32 v145, v144, v145
v_fma_mix_f32 v230, v142, v142, v230 op_sel_hi:[1,1,0]
s_waitcnt lgkmcnt(7)
v_mfma_f32_32x32x16_bf16 v[96:111], v[0:3], v[176:179], 0
v_fma_mix_f32 v230, v140, v140, v230 op_sel:[1,1,0] op_sel_hi:[1,1,0]
v_and_b32_e64 v145, s49, v145
v_fma_mix_f32 v230, v142, v142, v230 op_sel:[1,1,0] op_sel_hi:[1,1,0]
v_bfe_u32 v144, v145, 2, 14
v_fma_mix_f32 v230, v128, v128, v230 op_sel_hi:[1,1,0]
v_lshrrev_b32_e64 v145, 18, v145
v_fma_mix_f32 v230, v129, v129, v230 op_sel_hi:[1,1,0]
v_cvt_pk_f16_f32 v156, v156, v157
v_fma_mix_f32 v230, v130, v130, v230 op_sel_hi:[1,1,0]
v_cvt_pk_f16_f32 v158, v158, v159
v_fma_mix_f32 v230, v131, v131, v230 op_sel_hi:[1,1,0]
v_pk_fma_f16 v157, v156, v156, s48
v_mfma_f32_32x32x16_bf16 v[112:127], v[24:27], v[176:179], 0
ds_read_u16 v144, v144
ds_read_u16 v145, v145
v_fma_mix_f32 v230, v132, v132, v230 op_sel_hi:[1,1,0]
v_cvt_pkrtz_f16_f32 v147, v146, v147
v_fma_mix_f32 v230, v133, v133, v230 op_sel_hi:[1,1,0]
v_and_b32_e64 v147, s49, v147
v_bfe_u32 v146, v147, 2, 14
v_lshrrev_b32_e64 v147, 18, v147
v_pk_fma_f16 v159, v158, v158, s48
v_pk_mul_f16 v157, v156, v157
v_pk_mul_f16 v159, v158, v159
v_fma_mix_f32 v230, v134, v134, v230 op_sel_hi:[1,1,0]
v_cvt_pkrtz_f16_f32 v149, v148, v149
s_waitcnt lgkmcnt(3)
v_fma_mix_f32 v230, v135, v135, v230 op_sel_hi:[1,1,0]
ds_read_u16 v146, v146
ds_read_u16 v147, v147
ds_read_b128 v[188:191], v250 offset:52224
v_and_b32 v149, s49, v149
v_bfe_u32 v148, v149, 2, 14
v_lshrrev_b32_e64 v149, 18, v149
v_exp_f16_sdwa v157, v157 dst_sel:WORD_0 dst_unused:UNUSED_PRESERVE src0_sel:WORD_0
v_mfma_f32_32x32x16_bf16 v[96:111], v[4:7], v[180:183], v[96:111]
ds_read_u16 v148, v148
ds_read_u16 v149, v149
v_fma_mix_f32 v230, v136, v136, v230 op_sel_hi:[1,1,0]
v_exp_f16_sdwa v159, v159 dst_sel:WORD_0 dst_unused:UNUSED_PRESERVE src0_sel:WORD_0
v_fma_mix_f32 v230, v137, v137, v230 op_sel_hi:[1,1,0]
v_cvt_pkrtz_f16_f32 v151, v150, v151
v_and_b32_e64 v151, s49, v151
v_bfe_u32 v150, v151, 2, 14
v_lshrrev_b32_e64 v151, 18, v151
v_exp_f16_sdwa v157, v157 dst_sel:WORD_1 dst_unused:UNUSED_PRESERVE src0_sel:WORD_1
v_fma_mix_f32 v230, v138, v138, v230 op_sel_hi:[1,1,0]
v_cvt_pkrtz_f16_f32 v153, v152, v153
v_fma_mix_f32 v230, v139, v139, v230 op_sel_hi:[1,1,0]
v_and_b32_e64 v153, s49, v153
v_bfe_u32 v152, v153, 2, 14
ds_read_u16 v150, v150
ds_read_u16 v151, v151
v_lshrrev_b32_e64 v153, 18, v153
v_exp_f16_sdwa v159, v159 dst_sel:WORD_1 dst_unused:UNUSED_PRESERVE src0_sel:WORD_1
v_mfma_f32_32x32x16_bf16 v[112:127], v[28:31], v[180:183], v[112:127]
ds_read_u16 v152, v152
ds_read_u16 v153, v153
ds_read_b128 v[176:179], v250 offset:53248
v_cvt_pkrtz_f16_f32 v155, v154, v155
v_and_b32_e64 v155, s49, v155
v_bfe_u32 v154, v155, 2, 14
v_lshrrev_b32 v155, 18, v155
v_pk_add_f16 v157, v157, 1.0 op_sel_hi:[1,0]
v_pk_add_f16 v159, v159, 1.0 op_sel_hi:[1,0]
v_rcp_f16_sdwa v157, v157 dst_sel:WORD_0 dst_unused:UNUSED_PRESERVE src0_sel:WORD_0
s_waitcnt lgkmcnt(7)
v_mfma_f32_32x32x16_bf16 v[96:111], v[8:11], v[184:187], v[96:111]
ds_read_u16 v154, v154
ds_read_u16 v155, v155
v_rcp_f16_sdwa v159, v159 dst_sel:WORD_0 dst_unused:UNUSED_PRESERVE src0_sel:WORD_0
v_rcp_f16_sdwa v157, v157 dst_sel:WORD_1 dst_unused:UNUSED_PRESERVE src0_sel:WORD_1
v_rcp_f16_sdwa v159, v159 dst_sel:WORD_1 dst_unused:UNUSED_PRESERVE src0_sel:WORD_1
v_mfma_f32_32x32x16_bf16 v[112:127], v[32:35], v[184:187], v[112:127]
ds_read_b128 v[180:183], v250 offset:54272
v_pk_mul_f16 v156, v156, v157
v_pk_mul_f16 v158, v158, v159
v_fma_mix_f32 v231, v156, v156, v231 op_sel_hi:[1,1,0]
v_cvt_pkrtz_f16_f32 v161, v160, v161
v_fma_mix_f32 v231, v158, v158, v231 op_sel_hi:[1,1,0]
v_mfma_f32_32x32x16_bf16 v[96:111], v[12:15], v[188:191], v[96:111]
v_fma_mix_f32 v231, v156, v156, v231 op_sel:[1,1,0] op_sel_hi:[1,1,0]
v_and_b32_e64 v161, s49, v161
v_fma_mix_f32 v231, v158, v158, v231 op_sel:[1,1,0] op_sel_hi:[1,1,0]
v_bfe_u32 v160, v161, 2, 14
v_fma_mix_f32 v231, v144, v144, v231 op_sel_hi:[1,1,0]
v_lshrrev_b32_e64 v161, 18, v161
v_fma_mix_f32 v231, v145, v145, v231 op_sel_hi:[1,1,0]
v_cvt_pk_f16_f32 v172, v172, v173
v_fma_mix_f32 v231, v146, v146, v231 op_sel_hi:[1,1,0]
v_cvt_pk_f16_f32 v174, v174, v175
v_fma_mix_f32 v231, v147, v147, v231 op_sel_hi:[1,1,0]
v_pk_fma_f16 v173, v172, v172, s48
v_mfma_f32_32x32x16_bf16 v[112:127], v[36:39], v[188:191], v[112:127]
ds_read_u16 v160, v160
ds_read_u16 v161, v161
s_waitcnt lgkmcnt(5)
v_fma_mix_f32 v231, v148, v148, v231 op_sel_hi:[1,1,0]
v_cvt_pkrtz_f16_f32 v163, v162, v163
v_fma_mix_f32 v231, v149, v149, v231 op_sel_hi:[1,1,0]
v_and_b32 v163, s49, v163
v_bfe_u32 v162, v163, 2, 14
v_lshrrev_b32_e64 v163, 18, v163
v_pk_fma_f16 v175, v174, v174, s48
v_pk_mul_f16 v173, v172, v173
v_pk_mul_f16 v175, v174, v175
v_fma_mix_f32 v231, v150, v150, v231 op_sel_hi:[1,1,0]
v_cvt_pkrtz_f16_f32 v165, v164, v165
v_fma_mix_f32 v231, v151, v151, v231 op_sel_hi:[1,1,0]
ds_read_u16 v162, v162
ds_read_u16 v163, v163
ds_read_b128 v[184:187], v250 offset:55296
v_and_b32_e64 v165, s49, v165
v_bfe_u32 v164, v165, 2, 14
v_lshrrev_b32_e64 v165, 18, v165
v_exp_f16_sdwa v173, v173 dst_sel:WORD_0 dst_unused:UNUSED_PRESERVE src0_sel:WORD_0
v_mfma_f32_32x32x16_bf16 v[96:111], v[16:19], v[176:179], v[96:111]
ds_read_u16 v164, v164
ds_read_u16 v165, v165
v_fma_mix_f32 v231, v152, v152, v231 op_sel_hi:[1,1,0]
v_exp_f16_sdwa v175, v175 dst_sel:WORD_0 dst_unused:UNUSED_PRESERVE src0_sel:WORD_0
v_fma_mix_f32 v231, v153, v153, v231 op_sel_hi:[1,1,0]
v_cvt_pkrtz_f16_f32 v167, v166, v167
v_and_b32_e64 v167, s49, v167
v_bfe_u32 v166, v167, 2, 14
v_lshrrev_b32 v167, 18, v167
v_exp_f16_sdwa v173, v173 dst_sel:WORD_1 dst_unused:UNUSED_PRESERVE src0_sel:WORD_1
s_waitcnt lgkmcnt(6)
v_fma_mix_f32 v231, v154, v154, v231 op_sel_hi:[1,1,0]
v_cvt_pkrtz_f16_f32 v169, v168, v169
v_fma_mix_f32 v231, v155, v155, v231 op_sel_hi:[1,1,0]
v_and_b32_e64 v169, s49, v169
v_bfe_u32 v168, v169, 2, 14
ds_read_u16 v166, v166
ds_read_u16 v167, v167
v_lshrrev_b32_e64 v169, 18, v169
v_exp_f16_sdwa v175, v175 dst_sel:WORD_1 dst_unused:UNUSED_PRESERVE src0_sel:WORD_1
v_mfma_f32_32x32x16_bf16 v[112:127], v[40:43], v[176:179], v[112:127]
ds_read_u16 v168, v168
ds_read_u16 v169, v169
ds_read_b128 v[188:191], v250 offset:56320
v_cvt_pkrtz_f16_f32 v171, v170, v171
v_and_b32_e64 v171, s49, v171
v_bfe_u32 v170, v171, 2, 14
v_lshrrev_b32_e64 v171, 18, v171
v_pk_add_f16 v173, v173, 1.0 op_sel_hi:[1,0]
v_pk_add_f16 v175, v175, 1.0 op_sel_hi:[1,0]
v_rcp_f16_sdwa v173, v173 dst_sel:WORD_0 dst_unused:UNUSED_PRESERVE src0_sel:WORD_0
v_mfma_f32_32x32x16_bf16 v[96:111], v[20:23], v[180:183], v[96:111]
ds_read_u16 v170, v170
ds_read_u16 v171, v171
v_rcp_f16_sdwa v175, v175 dst_sel:WORD_0 dst_unused:UNUSED_PRESERVE src0_sel:WORD_0
v_rcp_f16_sdwa v173, v173 dst_sel:WORD_1 dst_unused:UNUSED_PRESERVE src0_sel:WORD_1
v_rcp_f16_sdwa v175, v175 dst_sel:WORD_1 dst_unused:UNUSED_PRESERVE src0_sel:WORD_1
v_mfma_f32_32x32x16_bf16 v[112:127], v[44:47], v[180:183], v[112:127]
ds_read_b128 v[176:179], v250 offset:57344
v_pk_mul_f16 v172, v172, v173
v_pk_mul_f16 v174, v174, v175
v_fma_mix_f32 v231, v172, v172, v231 op_sel_hi:[1,1,0]
s_nop 1
v_cvt_pkrtz_f16_f32 v97, v96, v97
v_fma_mix_f32 v231, v174, v174, v231 op_sel_hi:[1,1,0]
s_waitcnt lgkmcnt(7)
v_mfma_f32_32x32x16_bf16 v[128:143], v[0:3], v[184:187], 0
v_fma_mix_f32 v231, v172, v172, v231 op_sel:[1,1,0] op_sel_hi:[1,1,0]
v_and_b32_e64 v97, s49, v97
v_fma_mix_f32 v231, v174, v174, v231 op_sel:[1,1,0] op_sel_hi:[1,1,0]
v_bfe_u32 v96, v97, 2, 14
v_fma_mix_f32 v231, v160, v160, v231 op_sel_hi:[1,1,0]
v_lshrrev_b32_e64 v97, 18, v97
v_fma_mix_f32 v231, v161, v161, v231 op_sel_hi:[1,1,0]
v_cvt_pk_f16_f32 v108, v108, v109
v_fma_mix_f32 v231, v162, v162, v231 op_sel_hi:[1,1,0]
v_cvt_pk_f16_f32 v110, v110, v111
v_fma_mix_f32 v231, v163, v163, v231 op_sel_hi:[1,1,0]
v_pk_fma_f16 v109, v108, v108, s48
v_mfma_f32_32x32x16_bf16 v[144:159], v[24:27], v[184:187], 0
ds_read_u16 v96, v96
ds_read_u16 v97, v97
v_fma_mix_f32 v231, v164, v164, v231 op_sel_hi:[1,1,0]
v_cvt_pkrtz_f16_f32 v99, v98, v99
v_fma_mix_f32 v231, v165, v165, v231 op_sel_hi:[1,1,0]
v_and_b32_e64 v99, s49, v99
v_bfe_u32 v98, v99, 2, 14
v_lshrrev_b32_e64 v99, 18, v99
v_pk_fma_f16 v111, v110, v110, s48
v_pk_mul_f16 v109, v108, v109
v_pk_mul_f16 v111, v110, v111
v_fma_mix_f32 v231, v166, v166, v231 op_sel_hi:[1,1,0]
v_cvt_pkrtz_f16_f32 v101, v100, v101
s_waitcnt lgkmcnt(3)
v_fma_mix_f32 v231, v167, v167, v231 op_sel_hi:[1,1,0]
ds_read_u16 v98, v98
ds_read_u16 v99, v99
ds_read_b128 v[180:183], v250 offset:58368
v_and_b32 v101, s49, v101
v_bfe_u32 v100, v101, 2, 14
v_lshrrev_b32_e64 v101, 18, v101
v_exp_f16_sdwa v109, v109 dst_sel:WORD_0 dst_unused:UNUSED_PRESERVE src0_sel:WORD_0
v_mfma_f32_32x32x16_bf16 v[128:143], v[4:7], v[188:191], v[128:143]
ds_read_u16 v100, v100
ds_read_u16 v101, v101
v_fma_mix_f32 v231, v168, v168, v231 op_sel_hi:[1,1,0]
v_exp_f16_sdwa v111, v111 dst_sel:WORD_0 dst_unused:UNUSED_PRESERVE src0_sel:WORD_0
v_fma_mix_f32 v231, v169, v169, v231 op_sel_hi:[1,1,0]
v_cvt_pkrtz_f16_f32 v103, v102, v103
v_and_b32_e64 v103, s49, v103
v_bfe_u32 v102, v103, 2, 14
v_lshrrev_b32_e64 v103, 18, v103
v_exp_f16_sdwa v109, v109 dst_sel:WORD_1 dst_unused:UNUSED_PRESERVE src0_sel:WORD_1
v_fma_mix_f32 v231, v170, v170, v231 op_sel_hi:[1,1,0]
v_cvt_pkrtz_f16_f32 v105, v104, v105
v_fma_mix_f32 v231, v171, v171, v231 op_sel_hi:[1,1,0]
v_and_b32_e64 v105, s49, v105
v_bfe_u32 v104, v105, 2, 14
ds_read_u16 v102, v102
ds_read_u16 v103, v103
v_lshrrev_b32_e64 v105, 18, v105
v_exp_f16_sdwa v111, v111 dst_sel:WORD_1 dst_unused:UNUSED_PRESERVE src0_sel:WORD_1
v_mfma_f32_32x32x16_bf16 v[144:159], v[28:31], v[188:191], v[144:159]
ds_read_u16 v104, v104
ds_read_u16 v105, v105
ds_read_b128 v[184:187], v250 offset:59392
v_cvt_pkrtz_f16_f32 v107, v106, v107
v_and_b32_e64 v107, s49, v107
v_bfe_u32 v106, v107, 2, 14
v_lshrrev_b32 v107, 18, v107
v_pk_add_f16 v109, v109, 1.0 op_sel_hi:[1,0]
v_pk_add_f16 v111, v111, 1.0 op_sel_hi:[1,0]
v_rcp_f16_sdwa v109, v109 dst_sel:WORD_0 dst_unused:UNUSED_PRESERVE src0_sel:WORD_0
s_waitcnt lgkmcnt(7)
v_mfma_f32_32x32x16_bf16 v[128:143], v[8:11], v[176:179], v[128:143]
ds_read_u16 v106, v106
ds_read_u16 v107, v107
v_rcp_f16_sdwa v111, v111 dst_sel:WORD_0 dst_unused:UNUSED_PRESERVE src0_sel:WORD_0
v_rcp_f16_sdwa v109, v109 dst_sel:WORD_1 dst_unused:UNUSED_PRESERVE src0_sel:WORD_1
v_rcp_f16_sdwa v111, v111 dst_sel:WORD_1 dst_unused:UNUSED_PRESERVE src0_sel:WORD_1
v_mfma_f32_32x32x16_bf16 v[144:159], v[32:35], v[176:179], v[144:159]
ds_read_b128 v[188:191], v250 offset:60416
v_pk_mul_f16 v108, v108, v109
v_pk_mul_f16 v110, v110, v111
v_fma_mix_f32 v232, v108, v108, v232 op_sel_hi:[1,1,0]
v_add_u32_e64 v222, s83, v247
v_mov_b32 v223, 0
s_branch Law4
Lax4:
s_sleep 2
Law4:
ds_read_b32 v223, v222 offset:20
s_sub_u32 s76, s76, 1
s_cselect_b32 s44, 4, 0
s_cselect_b32 s76, 0, s76
s_waitcnt lgkmcnt(0)
v_readfirstlane_b32 s43, v223
s_nop 1
s_max_u32 s43, s43, s44
s_cmp_lt_u32 s43, 4
s_cbranch_scc1 Lax4
v_mfma_f32_32x32x16_bf16 v[128:143], v[12:15], v[180:183], v[128:143]
s_add_u32 s81, s81, 6592
s_cmp_eq_u32 s81, 65920
s_cselect_b32 s81, 0, s81
s_add_u32 s43, s81, s67
s_add_u32 m0, s43, 16
s_add_u32 s66, s66, 98304
buffer_load_dwordx4 v236, s[4:7], s66 offen lds
s_add_u32 m0, s43, 912
s_nop 0
buffer_load_dwordx4 v237, s[4:7], s66 offen lds
v_fma_mix_f32 v232, v110, v110, v232 op_sel_hi:[1,1,0]
v_cvt_pkrtz_f16_f32 v113, v112, v113
v_fma_mix_f32 v232, v108, v108, v232 op_sel:[1,1,0] op_sel_hi:[1,1,0]
v_and_b32_e64 v113, s49, v113
v_fma_mix_f32 v232, v110, v110, v232 op_sel:[1,1,0] op_sel_hi:[1,1,0]
v_bfe_u32 v112, v113, 2, 14
v_fma_mix_f32 v232, v96, v96, v232 op_sel_hi:[1,1,0]
v_lshrrev_b32_e64 v113, 18, v113
v_fma_mix_f32 v232, v97, v97, v232 op_sel_hi:[1,1,0]
v_cvt_pk_f16_f32 v124, v124, v125
v_fma_mix_f32 v232, v98, v98, v232 op_sel_hi:[1,1,0]
v_cvt_pk_f16_f32 v126, v126, v127
v_fma_mix_f32 v232, v99, v99, v232 op_sel_hi:[1,1,0]
v_pk_fma_f16 v125, v124, v124, s48
v_mfma_f32_32x32x16_bf16 v[144:159], v[36:39], v[180:183], v[144:159]
ds_read_u16 v112, v112
ds_read_u16 v113, v113
v_fma_mix_f32 v232, v100, v100, v232 op_sel_hi:[1,1,0]
v_cvt_pkrtz_f16_f32 v115, v114, v115
v_fma_mix_f32 v232, v101, v101, v232 op_sel_hi:[1,1,0]
v_and_b32_e64 v115, s49, v115
v_bfe_u32 v114, v115, 2, 14
v_lshrrev_b32_e64 v115, 18, v115
v_pk_fma_f16 v127, v126, v126, s48
v_pk_mul_f16 v125, v124, v125
v_pk_mul_f16 v127, v126, v127
v_fma_mix_f32 v232, v102, v102, v232 op_sel_hi:[1,1,0]
v_cvt_pkrtz_f16_f32 v117, v116, v117
v_fma_mix_f32 v232, v103, v103, v232 op_sel_hi:[1,1,0]
ds_read_u16 v114, v114
ds_read_u16 v115, v115
ds_read_b128 v[176:179], v250 offset:61440
v_and_b32_e64 v117, s49, v117
v_bfe_u32 v116, v117, 2, 14
v_lshrrev_b32_e64 v117, 18, v117
v_exp_f16_sdwa v125, v125 dst_sel:WORD_0 dst_unused:UNUSED_PRESERVE src0_sel:WORD_0
v_mfma_f32_32x32x16_bf16 v[128:143], v[16:19], v[184:187], v[128:143]
ds_read_u16 v116, v116
ds_read_u16 v117, v117
s_add_u32 s81, s81, 6592
s_cmp_eq_u32 s81, 65920
s_cselect_b32 s81, 0, s81
s_add_u32 s43, s81, s67
s_add_u32 m0, s43, 16
s_add_u32 s66, s66, 98304
buffer_load_dwordx4 v236, s[4:7], s66 offen lds
s_add_u32 m0, s43, 912
s_nop 0
buffer_load_dwordx4 v237, s[4:7], s66 offen lds
v_fma_mix_f32 v232, v104, v104, v232 op_sel_hi:[1,1,0]
v_exp_f16_sdwa v127, v127 dst_sel:WORD_0 dst_unused:UNUSED_PRESERVE src0_sel:WORD_0
v_fma_mix_f32 v232, v105, v105, v232 op_sel_hi:[1,1,0]
v_cvt_pkrtz_f16_f32 v119, v118, v119
v_and_b32_e64 v119, s49, v119
v_bfe_u32 v118, v119, 2, 14
v_lshrrev_b32_e64 v119, 18, v119
v_exp_f16_sdwa v125, v125 dst_sel:WORD_1 dst_unused:UNUSED_PRESERVE src0_sel:WORD_1
v_fma_mix_f32 v232, v106, v106, v232 op_sel_hi:[1,1,0]
v_cvt_pkrtz_f16_f32 v121, v120, v121
v_fma_mix_f32 v232, v107, v107, v232 op_sel_hi:[1,1,0]
v_and_b32_e64 v121, s49, v121
v_bfe_u32 v120, v121, 2, 14
ds_read_u16 v118, v118
ds_read_u16 v119, v119
v_lshrrev_b32_e64 v121, 18, v121
v_exp_f16_sdwa v127, v127 dst_sel:WORD_1 dst_unused:UNUSED_PRESERVE src0_sel:WORD_1
v_mfma_f32_32x32x16_bf16 v[144:159], v[40:43], v[184:187], v[144:159]
ds_read_u16 v120, v120
ds_read_u16 v121, v121
ds_read_b128 v[180:183], v250 offset:62464
v_cvt_pkrtz_f16_f32 v123, v122, v123
v_and_b32_e64 v123, s49, v123
v_bfe_u32 v122, v123, 2, 14
v_lshrrev_b32_e64 v123, 18, v123
v_pk_add_f16 v125, v125, 1.0 op_sel_hi:[1,0]
v_pk_add_f16 v127, v127, 1.0 op_sel_hi:[1,0]
v_rcp_f16_sdwa v125, v125 dst_sel:WORD_0 dst_unused:UNUSED_PRESERVE src0_sel:WORD_0
v_mfma_f32_32x32x16_bf16 v[128:143], v[20:23], v[188:191], v[128:143]
ds_read_u16 v122, v122
ds_read_u16 v123, v123
s_add_u32 s81, s81, 6592
s_cmp_eq_u32 s81, 65920
s_cselect_b32 s81, 0, s81
s_add_u32 s43, s81, s67
s_add_u32 m0, s43, 32
s_add_u32 s66, s66, 98304
buffer_load_dwordx4 v236, s[4:7], s66 offen lds
s_add_u32 m0, s43, 928
s_nop 0
buffer_load_dwordx4 v237, s[4:7], s66 offen lds
v_rcp_f16_sdwa v127, v127 dst_sel:WORD_0 dst_unused:UNUSED_PRESERVE src0_sel:WORD_0
v_rcp_f16_sdwa v125, v125 dst_sel:WORD_1 dst_unused:UNUSED_PRESERVE src0_sel:WORD_1
v_rcp_f16_sdwa v127, v127 dst_sel:WORD_1 dst_unused:UNUSED_PRESERVE src0_sel:WORD_1
v_mfma_f32_32x32x16_bf16 v[144:159], v[44:47], v[188:191], v[144:159]
ds_read_b128 v[184:187], v250 offset:63488
v_pk_mul_f16 v124, v124, v125
v_pk_mul_f16 v126, v126, v127
s_add_u32 s81, s81, 6592
s_cmp_eq_u32 s81, 65920
s_cselect_b32 s81, 0, s81
s_add_u32 s43, s81, s67
s_add_u32 m0, s43, 32
s_add_u32 s66, s66, 98304
buffer_load_dwordx4 v236, s[4:7], s66 offen lds
s_add_u32 m0, s43, 928
s_nop 0
buffer_load_dwordx4 v237, s[4:7], s66 offen lds
v_fma_mix_f32 v232, v124, v124, v232 op_sel_hi:[1,1,0]
v_cvt_pkrtz_f16_f32 v129, v128, v129
s_waitcnt lgkmcnt(7)
v_mfma_f32_32x32x16_bf16 v[160:175], v[0:3], v[176:179], 0
v_fma_mix_f32 v232, v126, v126, v232 op_sel_hi:[1,1,0]
v_and_b32 v129, s49, v129
v_fma_mix_f32 v232, v124, v124, v232 op_sel:[1,1,0] op_sel_hi:[1,1,0]
v_bfe_u32 v128, v129, 2, 14
v_fma_mix_f32 v232, v126, v126, v232 op_sel:[1,1,0] op_sel_hi:[1,1,0]
v_lshrrev_b32_e64 v129, 18, v129
v_fma_mix_f32 v232, v112, v112, v232 op_sel_hi:[1,1,0]
v_cvt_pk_f16_f32 v140, v140, v141
v_fma_mix_f32 v232, v113, v113, v232 op_sel_hi:[1,1,0]
v_cvt_pk_f16_f32 v142, v142, v143
v_fma_mix_f32 v232, v114, v114, v232 op_sel_hi:[1,1,0]
v_pk_fma_f16 v141, v140, v140, s48
v_fma_mix_f32 v232, v115, v115, v232 op_sel_hi:[1,1,0]
v_mfma_f32_32x32x16_bf16 v[96:111], v[24:27], v[176:179], 0
ds_read_u16 v128, v128
ds_read_u16 v129, v129
v_fma_mix_f32 v232, v116, v116, v232 op_sel_hi:[1,1,0]
v_cvt_pkrtz_f16_f32 v131, v130, v131
v_fma_mix_f32 v232, v117, v117, v232 op_sel_hi:[1,1,0]
v_and_b32_e64 v131, s49, v131
v_bfe_u32 v130, v131, 2, 14
v_lshrrev_b32_e64 v131, 18, v131
v_pk_fma_f16 v143, v142, v142, s48
v_pk_mul_f16 v141, v140, v141
v_pk_mul_f16 v143, v142, v143
v_fma_mix_f32 v232, v118, v118, v232 op_sel_hi:[1,1,0]
v_cvt_pkrtz_f16_f32 v133, v132, v133
s_waitcnt lgkmcnt(3)
v_fma_mix_f32 v232, v119, v119, v232 op_sel_hi:[1,1,0]
ds_read_u16 v130, v130
ds_read_u16 v131, v131
ds_read_b128 v[188:191], v250 offset:64512
s_add_u32 s81, s81, 6592
s_cmp_eq_u32 s81, 65920
s_cselect_b32 s81, 0, s81
s_add_u32 s43, s81, s67
s_add_u32 m0, s43, 48
s_add_u32 s66, s66, 98304
buffer_load_dwordx4 v236, s[4:7], s66 offen lds
s_add_u32 m0, s43, 944
s_nop 0
buffer_load_dwordx4 v237, s[4:7], s66 offen lds
v_and_b32 v133, s49, v133
v_bfe_u32 v132, v133, 2, 14
v_lshrrev_b32_e64 v133, 18, v133
v_exp_f16_sdwa v141, v141 dst_sel:WORD_0 dst_unused:UNUSED_PRESERVE src0_sel:WORD_0
v_mfma_f32_32x32x16_bf16 v[160:175], v[4:7], v[180:183], v[160:175]
ds_read_u16 v132, v132
ds_read_u16 v133, v133
v_fma_mix_f32 v232, v120, v120, v232 op_sel_hi:[1,1,0]
v_exp_f16_sdwa v143, v143 dst_sel:WORD_0 dst_unused:UNUSED_PRESERVE src0_sel:WORD_0
v_fma_mix_f32 v232, v121, v121, v232 op_sel_hi:[1,1,0]
v_cvt_pkrtz_f16_f32 v135, v134, v135
v_and_b32_e64 v135, s49, v135
v_bfe_u32 v134, v135, 2, 14
v_lshrrev_b32_e64 v135, 18, v135
v_exp_f16_sdwa v141, v141 dst_sel:WORD_1 dst_unused:UNUSED_PRESERVE src0_sel:WORD_1
v_fma_mix_f32 v232, v122, v122, v232 op_sel_hi:[1,1,0]
v_cvt_pkrtz_f16_f32 v137, v136, v137
v_fma_mix_f32 v232, v123, v123, v232 op_sel_hi:[1,1,0]
v_and_b32_e64 v137, s49, v137
v_bfe_u32 v136, v137, 2, 14
ds_read_u16 v134, v134
ds_read_u16 v135, v135
v_lshrrev_b32_e64 v137, 18, v137
v_exp_f16_sdwa v143, v143 dst_sel:WORD_1 dst_unused:UNUSED_PRESERVE src0_sel:WORD_1
v_mfma_f32_32x32x16_bf16 v[96:111], v[28:31], v[180:183], v[96:111]
ds_read_u16 v136, v136
ds_read_u16 v137, v137
ds_read_b128 v[176:179], v251
v_cvt_pkrtz_f16_f32 v139, v138, v139
v_and_b32_e64 v139, s49, v139
v_bfe_u32 v138, v139, 2, 14
v_lshrrev_b32 v139, 18, v139
v_pk_add_f16 v141, v141, 1.0 op_sel_hi:[1,0]
v_pk_add_f16 v143, v143, 1.0 op_sel_hi:[1,0]
v_rcp_f16_sdwa v141, v141 dst_sel:WORD_0 dst_unused:UNUSED_PRESERVE src0_sel:WORD_0
s_waitcnt lgkmcnt(7)
v_mfma_f32_32x32x16_bf16 v[160:175], v[8:11], v[184:187], v[160:175]
ds_read_u16 v138, v138
ds_read_u16 v139, v139
s_add_u32 s81, s81, 6592
s_cmp_eq_u32 s81, 65920
s_cselect_b32 s81, 0, s81
s_add_u32 s43, s81, s67
s_add_u32 m0, s43, 48
s_add_u32 s66, s66, 98304
buffer_load_dwordx4 v236, s[4:7], s66 offen lds
s_add_u32 m0, s43, 944
s_nop 0
buffer_load_dwordx4 v237, s[4:7], s66 offen lds
v_rcp_f16_sdwa v143, v143 dst_sel:WORD_0 dst_unused:UNUSED_PRESERVE src0_sel:WORD_0
v_rcp_f16_sdwa v141, v141 dst_sel:WORD_1 dst_unused:UNUSED_PRESERVE src0_sel:WORD_1
v_rcp_f16_sdwa v143, v143 dst_sel:WORD_1 dst_unused:UNUSED_PRESERVE src0_sel:WORD_1
v_mfma_f32_32x32x16_bf16 v[96:111], v[32:35], v[184:187], v[96:111]
ds_read_b128 v[180:183], v251 offset:1024
s_add_u32 s81, s81, 6592
s_cmp_eq_u32 s81, 65920
s_cselect_b32 s81, 0, s81
s_add_u32 s43, s81, s67
s_add_u32 m0, s43, 0
s_add_u32 s66, s66, 98304
buffer_load_dwordx4 v236, s[4:7], s66 offen lds
s_add_u32 m0, s43, 896
s_nop 0
buffer_load_dwordx4 v237, s[4:7], s66 offen lds
v_pk_mul_f16 v140, v140, v141
v_pk_mul_f16 v142, v142, v143
v_fma_mix_f32 v233, v140, v140, v233 op_sel_hi:[1,1,0]
v_cvt_pkrtz_f16_f32 v145, v144, v145
v_mfma_f32_32x32x16_bf16 v[160:175], v[12:15], v[188:191], v[160:175]
v_fma_mix_f32 v233, v142, v142, v233 op_sel_hi:[1,1,0]
v_and_b32_e64 v145, s49, v145
v_fma_mix_f32 v233, v140, v140, v233 op_sel:[1,1,0] op_sel_hi:[1,1,0]
v_bfe_u32 v144, v145, 2, 14
v_fma_mix_f32 v233, v142, v142, v233 op_sel:[1,1,0] op_sel_hi:[1,1,0]
v_lshrrev_b32_e64 v145, 18, v145
v_fma_mix_f32 v233, v128, v128, v233 op_sel_hi:[1,1,0]
v_cvt_pk_f16_f32 v156, v156, v157
v_fma_mix_f32 v233, v129, v129, v233 op_sel_hi:[1,1,0]
v_cvt_pk_f16_f32 v158, v158, v159
v_fma_mix_f32 v233, v130, v130, v233 op_sel_hi:[1,1,0]
v_pk_fma_f16 v157, v156, v156, s48
v_fma_mix_f32 v233, v131, v131, v233 op_sel_hi:[1,1,0]
v_mfma_f32_32x32x16_bf16 v[96:111], v[36:39], v[188:191], v[96:111]
ds_read_u16 v144, v144
ds_read_u16 v145, v145
s_waitcnt lgkmcnt(5)
v_fma_mix_f32 v233, v132, v132, v233 op_sel_hi:[1,1,0]
v_cvt_pkrtz_f16_f32 v147, v146, v147
v_fma_mix_f32 v233, v133, v133, v233 op_sel_hi:[1,1,0]
s_add_u32 s81, s81, 6592
s_cmp_eq_u32 s81, 65920
s_cselect_b32 s81, 0, s81
s_add_u32 s43, s81, s67
s_add_u32 m0, s43, 0
s_add_u32 s66, s66, 98304
buffer_load_dwordx4 v236, s[4:7], s66 offen lds
s_add_u32 m0, s43, 896
s_nop 0
buffer_load_dwordx4 v237, s[4:7], s66 offen lds
v_and_b32 v147, s49, v147
v_bfe_u32 v146, v147, 2, 14
v_lshrrev_b32_e64 v147, 18, v147
v_pk_fma_f16 v159, v158, v158, s48
v_pk_mul_f16 v157, v156, v157
v_pk_mul_f16 v159, v158, v159
v_fma_mix_f32 v233, v134, v134, v233 op_sel_hi:[1,1,0]
v_cvt_pkrtz_f16_f32 v149, v148, v149
v_fma_mix_f32 v233, v135, v135, v233 op_sel_hi:[1,1,0]
ds_read_u16 v146, v146
ds_read_u16 v147, v147
ds_read_b128 v[184:187], v251 offset:2048
v_and_b32_e64 v149, s49, v149
v_bfe_u32 v148, v149, 2, 14
v_lshrrev_b32_e64 v149, 18, v149
v_exp_f16_sdwa v157, v157 dst_sel:WORD_0 dst_unused:UNUSED_PRESERVE src0_sel:WORD_0
v_mfma_f32_32x32x16_bf16 v[160:175], v[16:19], v[176:179], v[160:175]
ds_read_u16 v148, v148
ds_read_u16 v149, v149
v_fma_mix_f32 v233, v136, v136, v233 op_sel_hi:[1,1,0]
v_exp_f16_sdwa v159, v159 dst_sel:WORD_0 dst_unused:UNUSED_PRESERVE src0_sel:WORD_0
v_fma_mix_f32 v233, v137, v137, v233 op_sel_hi:[1,1,0]
v_cvt_pkrtz_f16_f32 v151, v150, v151
v_and_b32_e64 v151, s49, v151
v_bfe_u32 v150, v151, 2, 14
v_lshrrev_b32 v151, 18, v151
v_exp_f16_sdwa v157, v157 dst_sel:WORD_1 dst_unused:UNUSED_PRESERVE src0_sel:WORD_1
s_waitcnt lgkmcnt(6)
v_fma_mix_f32 v233, v138, v138, v233 op_sel_hi:[1,1,0]
v_cvt_pkrtz_f16_f32 v153, v152, v153
v_fma_mix_f32 v233, v139, v139, v233 op_sel_hi:[1,1,0]
v_and_b32_e64 v153, s49, v153
v_bfe_u32 v152, v153, 2, 14
ds_read_u16 v150, v150
ds_read_u16 v151, v151
v_lshrrev_b32_e64 v153, 18, v153
v_exp_f16_sdwa v159, v159 dst_sel:WORD_1 dst_unused:UNUSED_PRESERVE src0_sel:WORD_1
v_mfma_f32_32x32x16_bf16 v[96:111], v[40:43], v[176:179], v[96:111]
ds_read_u16 v152, v152
ds_read_u16 v153, v153
ds_read_b128 v[188:191], v251 offset:3072
v_cvt_pkrtz_f16_f32 v155, v154, v155
v_and_b32_e64 v155, s49, v155
v_bfe_u32 v154, v155, 2, 14
v_lshrrev_b32_e64 v155, 18, v155
v_pk_add_f16 v157, v157, 1.0 op_sel_hi:[1,0]
v_pk_add_f16 v159, v159, 1.0 op_sel_hi:[1,0]
v_rcp_f16_sdwa v157, v157 dst_sel:WORD_0 dst_unused:UNUSED_PRESERVE src0_sel:WORD_0
v_mfma_f32_32x32x16_bf16 v[160:175], v[20:23], v[180:183], v[160:175]
ds_read_u16 v154, v154
ds_read_u16 v155, v155
v_rcp_f16_sdwa v159, v159 dst_sel:WORD_0 dst_unused:UNUSED_PRESERVE src0_sel:WORD_0
v_rcp_f16_sdwa v157, v157 dst_sel:WORD_1 dst_unused:UNUSED_PRESERVE src0_sel:WORD_1
v_rcp_f16_sdwa v159, v159 dst_sel:WORD_1 dst_unused:UNUSED_PRESERVE src0_sel:WORD_1
v_mfma_f32_32x32x16_bf16 v[96:111], v[44:47], v[180:183], v[96:111]
ds_read_b128 v[176:179], v251 offset:4096
v_pk_mul_f16 v156, v156, v157
v_pk_mul_f16 v158, v158, v159
v_fma_mix_f32 v233, v156, v156, v233 op_sel_hi:[1,1,0]
s_nop 1
v_cvt_pkrtz_f16_f32 v161, v160, v161
v_fma_mix_f32 v233, v158, v158, v233 op_sel_hi:[1,1,0]
s_waitcnt lgkmcnt(7)
v_mfma_f32_32x32x16_bf16 v[112:127], v[0:3], v[184:187], 0
v_fma_mix_f32 v233, v156, v156, v233 op_sel:[1,1,0] op_sel_hi:[1,1,0]
v_and_b32_e64 v161, s49, v161
v_fma_mix_f32 v233, v158, v158, v233 op_sel:[1,1,0] op_sel_hi:[1,1,0]
v_bfe_u32 v160, v161, 2, 14
v_fma_mix_f32 v233, v144, v144, v233 op_sel_hi:[1,1,0]
v_lshrrev_b32_e64 v161, 18, v161
v_fma_mix_f32 v233, v145, v145, v233 op_sel_hi:[1,1,0]
v_cvt_pk_f16_f32 v172, v172, v173
v_fma_mix_f32 v233, v146, v146, v233 op_sel_hi:[1,1,0]
v_cvt_pk_f16_f32 v174, v174, v175
v_fma_mix_f32 v233, v147, v147, v233 op_sel_hi:[1,1,0]
v_pk_fma_f16 v173, v172, v172, s48
v_mfma_f32_32x32x16_bf16 v[128:143], v[24:27], v[184:187], 0
ds_read_u16 v160, v160
ds_read_u16 v161, v161
v_fma_mix_f32 v233, v148, v148, v233 op_sel_hi:[1,1,0]
v_cvt_pkrtz_f16_f32 v163, v162, v163
v_fma_mix_f32 v233, v149, v149, v233 op_sel_hi:[1,1,0]
v_and_b32_e64 v163, s49, v163
v_bfe_u32 v162, v163, 2, 14
v_lshrrev_b32_e64 v163, 18, v163
v_pk_fma_f16 v175, v174, v174, s48
v_pk_mul_f16 v173, v172, v173
v_pk_mul_f16 v175, v174, v175
v_fma_mix_f32 v233, v150, v150, v233 op_sel_hi:[1,1,0]
v_cvt_pkrtz_f16_f32 v165, v164, v165
s_waitcnt lgkmcnt(3)
v_fma_mix_f32 v233, v151, v151, v233 op_sel_hi:[1,1,0]
ds_read_u16 v162, v162
ds_read_u16 v163, v163
ds_read_b128 v[180:183], v251 offset:5120
v_and_b32 v165, s49, v165
v_bfe_u32 v164, v165, 2, 14
v_lshrrev_b32_e64 v165, 18, v165
v_exp_f16_sdwa v173, v173 dst_sel:WORD_0 dst_unused:UNUSED_PRESERVE src0_sel:WORD_0
v_mfma_f32_32x32x16_bf16 v[112:127], v[4:7], v[188:191], v[112:127]
ds_read_u16 v164, v164
ds_read_u16 v165, v165
v_fma_mix_f32 v233, v152, v152, v233 op_sel_hi:[1,1,0]
v_exp_f16_sdwa v175, v175 dst_sel:WORD_0 dst_unused:UNUSED_PRESERVE src0_sel:WORD_0
v_fma_mix_f32 v233, v153, v153, v233 op_sel_hi:[1,1,0]
v_cvt_pkrtz_f16_f32 v167, v166, v167
v_and_b32_e64 v167, s49, v167
v_bfe_u32 v166, v167, 2, 14
v_lshrrev_b32_e64 v167, 18, v167
v_exp_f16_sdwa v173, v173 dst_sel:WORD_1 dst_unused:UNUSED_PRESERVE src0_sel:WORD_1
v_fma_mix_f32 v233, v154, v154, v233 op_sel_hi:[1,1,0]
v_cvt_pkrtz_f16_f32 v169, v168, v169
v_fma_mix_f32 v233, v155, v155, v233 op_sel_hi:[1,1,0]
v_and_b32_e64 v169, s49, v169
v_bfe_u32 v168, v169, 2, 14
ds_read_u16 v166, v166
ds_read_u16 v167, v167
v_lshrrev_b32_e64 v169, 18, v169
v_exp_f16_sdwa v175, v175 dst_sel:WORD_1 dst_unused:UNUSED_PRESERVE src0_sel:WORD_1
v_mfma_f32_32x32x16_bf16 v[128:143], v[28:31], v[188:191], v[128:143]
ds_read_u16 v168, v168
ds_read_u16 v169, v169
ds_read_b128 v[184:187], v251 offset:6144
v_cvt_pkrtz_f16_f32 v171, v170, v171
v_and_b32_e64 v171, s49, v171
v_bfe_u32 v170, v171, 2, 14
v_lshrrev_b32 v171, 18, v171
v_pk_add_f16 v173, v173, 1.0 op_sel_hi:[1,0]
v_pk_add_f16 v175, v175, 1.0 op_sel_hi:[1,0]
v_rcp_f16_sdwa v173, v173 dst_sel:WORD_0 dst_unused:UNUSED_PRESERVE src0_sel:WORD_0
s_waitcnt lgkmcnt(7)
v_mfma_f32_32x32x16_bf16 v[112:127], v[8:11], v[176:179], v[112:127]
ds_read_u16 v170, v170
ds_read_u16 v171, v171
v_rcp_f16_sdwa v175, v175 dst_sel:WORD_0 dst_unused:UNUSED_PRESERVE src0_sel:WORD_0
v_rcp_f16_sdwa v173, v173 dst_sel:WORD_1 dst_unused:UNUSED_PRESERVE src0_sel:WORD_1
v_rcp_f16_sdwa v175, v175 dst_sel:WORD_1 dst_unused:UNUSED_PRESERVE src0_sel:WORD_1
v_mfma_f32_32x32x16_bf16 v[128:143], v[32:35], v[176:179], v[128:143]
ds_read_b128 v[188:191], v251 offset:7168
v_pk_mul_f16 v172, v172, v173
v_pk_mul_f16 v174, v174, v175
v_fma_mix_f32 v234, v172, v172, v234 op_sel_hi:[1,1,0]
v_cvt_pkrtz_f16_f32 v97, v96, v97
v_fma_mix_f32 v234, v174, v174, v234 op_sel_hi:[1,1,0]
v_mfma_f32_32x32x16_bf16 v[112:127], v[12:15], v[180:183], v[112:127]
v_fma_mix_f32 v234, v172, v172, v234 op_sel:[1,1,0] op_sel_hi:[1,1,0]
v_and_b32_e64 v97, s49, v97
v_fma_mix_f32 v234, v174, v174, v234 op_sel:[1,1,0] op_sel_hi:[1,1,0]
v_bfe_u32 v96, v97, 2, 14
v_fma_mix_f32 v234, v160, v160, v234 op_sel_hi:[1,1,0]
v_lshrrev_b32_e64 v97, 18, v97
v_fma_mix_f32 v234, v161, v161, v234 op_sel_hi:[1,1,0]
v_cvt_pk_f16_f32 v108, v108, v109
v_fma_mix_f32 v234, v162, v162, v234 op_sel_hi:[1,1,0]
v_cvt_pk_f16_f32 v110, v110, v111
v_fma_mix_f32 v234, v163, v163, v234 op_sel_hi:[1,1,0]
v_pk_fma_f16 v109, v108, v108, s48
v_mfma_f32_32x32x16_bf16 v[128:143], v[36:39], v[180:183], v[128:143]
ds_read_u16 v96, v96
ds_read_u16 v97, v97
s_waitcnt lgkmcnt(5)
v_fma_mix_f32 v234, v164, v164, v234 op_sel_hi:[1,1,0]
v_cvt_pkrtz_f16_f32 v99, v98, v99
v_fma_mix_f32 v234, v165, v165, v234 op_sel_hi:[1,1,0]
v_and_b32 v99, s49, v99
v_bfe_u32 v98, v99, 2, 14
v_lshrrev_b32_e64 v99, 18, v99
v_pk_fma_f16 v111, v110, v110, s48
v_pk_mul_f16 v109, v108, v109
v_pk_mul_f16 v111, v110, v111
v_fma_mix_f32 v234, v166, v166, v234 op_sel_hi:[1,1,0]
v_cvt_pkrtz_f16_f32 v101, v100, v101
v_fma_mix_f32 v234, v167, v167, v234 op_sel_hi:[1,1,0]
ds_read_u16 v98, v98
ds_read_u16 v99, v99
v_and_b32_e64 v101, s49, v101
v_bfe_u32 v100, v101, 2, 14
v_lshrrev_b32_e64 v101, 18, v101
v_exp_f16_sdwa v109, v109 dst_sel:WORD_0 dst_unused:UNUSED_PRESERVE src0_sel:WORD_0
v_mfma_f32_32x32x16_bf16 v[112:127], v[16:19], v[184:187], v[112:127]
ds_read_u16 v100, v100
ds_read_u16 v101, v101
v_fma_mix_f32 v234, v168, v168, v234 op_sel_hi:[1,1,0]
v_exp_f16_sdwa v111, v111 dst_sel:WORD_0 dst_unused:UNUSED_PRESERVE src0_sel:WORD_0
v_fma_mix_f32 v234, v169, v169, v234 op_sel_hi:[1,1,0]
v_cvt_pkrtz_f16_f32 v103, v102, v103
v_and_b32_e64 v103, s49, v103
v_bfe_u32 v102, v103, 2, 14
v_lshrrev_b32 v103, 18, v103
v_exp_f16_sdwa v109, v109 dst_sel:WORD_1 dst_unused:UNUSED_PRESERVE src0_sel:WORD_1
s_waitcnt lgkmcnt(5)
v_fma_mix_f32 v234, v170, v170, v234 op_sel_hi:[1,1,0]
v_cvt_pkrtz_f16_f32 v105, v104, v105
v_fma_mix_f32 v234, v171, v171, v234 op_sel_hi:[1,1,0]
v_and_b32_e64 v105, s49, v105
v_bfe_u32 v104, v105, 2, 14
ds_read_u16 v102, v102
ds_read_u16 v103, v103
v_lshrrev_b32_e64 v105, 18, v105
v_exp_f16_sdwa v111, v111 dst_sel:WORD_1 dst_unused:UNUSED_PRESERVE src0_sel:WORD_1
v_mfma_f32_32x32x16_bf16 v[128:143], v[40:43], v[184:187], v[128:143]
ds_read_u16 v104, v104
ds_read_u16 v105, v105
v_cvt_pkrtz_f16_f32 v107, v106, v107
v_and_b32_e64 v107, s49, v107
v_bfe_u32 v106, v107, 2, 14
v_lshrrev_b32_e64 v107, 18, v107
v_pk_add_f16 v109, v109, 1.0 op_sel_hi:[1,0]
v_pk_add_f16 v111, v111, 1.0 op_sel_hi:[1,0]
v_rcp_f16_sdwa v109, v109 dst_sel:WORD_0 dst_unused:UNUSED_PRESERVE src0_sel:WORD_0
v_mfma_f32_32x32x16_bf16 v[112:127], v[20:23], v[188:191], v[112:127]
ds_read_u16 v106, v106
ds_read_u16 v107, v107
v_rcp_f16_sdwa v111, v111 dst_sel:WORD_0 dst_unused:UNUSED_PRESERVE src0_sel:WORD_0
v_rcp_f16_sdwa v109, v109 dst_sel:WORD_1 dst_unused:UNUSED_PRESERVE src0_sel:WORD_1
v_rcp_f16_sdwa v111, v111 dst_sel:WORD_1 dst_unused:UNUSED_PRESERVE src0_sel:WORD_1
v_mfma_f32_32x32x16_bf16 v[128:143], v[44:47], v[188:191], v[128:143]
v_pk_mul_f16 v108, v108, v109
v_pk_mul_f16 v110, v110, v111
v_fma_mix_f32 v234, v108, v108, v234 op_sel_hi:[1,1,0]
s_nop 2
v_cvt_pkrtz_f16_f32 v113, v112, v113
v_fma_mix_f32 v234, v110, v110, v234 op_sel_hi:[1,1,0]
v_and_b32 v113, s49, v113
v_fma_mix_f32 v234, v108, v108, v234 op_sel:[1,1,0] op_sel_hi:[1,1,0]
v_bfe_u32 v112, v113, 2, 14
v_fma_mix_f32 v234, v110, v110, v234 op_sel:[1,1,0] op_sel_hi:[1,1,0]
v_lshrrev_b32 v113, 18, v113
v_fma_mix_f32 v234, v96, v96, v234 op_sel_hi:[1,1,0]
v_cvt_pk_f16_f32 v124, v124, v125
s_waitcnt lgkmcnt(4)
v_fma_mix_f32 v234, v97, v97, v234 op_sel_hi:[1,1,0]
v_cvt_pk_f16_f32 v126, v126, v127
v_fma_mix_f32 v234, v98, v98, v234 op_sel_hi:[1,1,0]
v_pk_fma_f16 v125, v124, v124, s48
v_fma_mix_f32 v234, v99, v99, v234 op_sel_hi:[1,1,0]
v_cvt_pkrtz_f16_f32 v115, v114, v115
v_fma_mix_f32 v234, v100, v100, v234 op_sel_hi:[1,1,0]
v_and_b32_e64 v115, s49, v115
v_fma_mix_f32 v234, v101, v101, v234 op_sel_hi:[1,1,0]
v_bfe_u32 v114, v115, 2, 14
v_lshrrev_b32_e64 v115, 18, v115
ds_read_u16 v112, v112
ds_read_u16 v113, v113
ds_read_u16 v114, v114
ds_read_u16 v115, v115
s_add_u32 s43, s81, 6592
v_add_u32_e64 v212, s43, v246
v_subrev_u32 v222, 65920, v212
v_min_u32_e64 v212, v212, v222
v_add_u32 v212, 90112, v212
v_add_u32_e64 v213, s43, v246
v_add_u32 v213, 6592, v213
v_subrev_u32 v222, 65920, v213
v_min_u32_e64 v213, v213, v222
v_add_u32 v213, 90112, v213
v_add_u32_e64 v214, s43, v246
v_add_u32 v214, 13184, v214
v_add_u32_e64 v222, 16, v214
v_bfi_b32 v214, 48, v222, v214
v_subrev_u32 v222, 65920, v214
v_min_u32_e64 v214, v214, v222
v_add_u32 v214, 90112, v214
v_add_u32_e64 v215, s43, v246
v_add_u32 v215, 19776, v215
v_add_u32_e64 v222, 16, v215
v_bfi_b32 v215, 48, v222, v215
v_subrev_u32 v222, 65920, v215
v_min_u32_e64 v215, v215, v222
v_add_u32 v215, 90112, v215
v_pk_fma_f16 v127, v126, v126, s48
v_pk_mul_f16 v125, v124, v125
v_pk_mul_f16 v127, v126, v127
v_fma_mix_f32 v234, v102, v102, v234 op_sel_hi:[1,1,0]
v_cvt_pkrtz_f16_f32 v117, v116, v117
v_fma_mix_f32 v234, v103, v103, v234 op_sel_hi:[1,1,0]
v_and_b32_e64 v117, s49, v117
v_bfe_u32 v116, v117, 2, 14
v_lshrrev_b32 v117, 18, v117
v_exp_f16_sdwa v125, v125 dst_sel:WORD_0 dst_unused:UNUSED_PRESERVE src0_sel:WORD_0
s_waitcnt lgkmcnt(2)
v_fma_mix_f32 v234, v104, v104, v234 op_sel_hi:[1,1,0]
v_exp_f16_sdwa v127, v127 dst_sel:WORD_0 dst_unused:UNUSED_PRESERVE src0_sel:WORD_0
v_fma_mix_f32 v234, v105, v105, v234 op_sel_hi:[1,1,0]
v_cvt_pkrtz_f16_f32 v119, v118, v119
v_and_b32_e64 v119, s49, v119
ds_read_u16 v116, v116
ds_read_u16 v117, v117
v_bfe_u32 v118, v119, 2, 14
v_lshrrev_b32_e64 v119, 18, v119
v_exp_f16_sdwa v125, v125 dst_sel:WORD_1 dst_unused:UNUSED_PRESERVE src0_sel:WORD_1
v_fma_mix_f32 v234, v106, v106, v234 op_sel_hi:[1,1,0]
v_cvt_pkrtz_f16_f32 v121, v120, v121
v_fma_mix_f32 v234, v107, v107, v234 op_sel_hi:[1,1,0]
v_and_b32 v121, s49, v121
v_bfe_u32 v120, v121, 2, 14
ds_read_u16 v118, v118
ds_read_u16 v119, v119
s_waitcnt vmcnt(0)
ds_read_b128 v[144:147], v212
ds_read_b64 v[196:197], v238
ds_read_b64 v[198:199], v239
v_lshrrev_b32_e64 v121, 18, v121
v_exp_f16_sdwa v127, v127 dst_sel:WORD_1 dst_unused:UNUSED_PRESERVE src0_sel:WORD_1
v_cvt_pkrtz_f16_f32 v123, v122, v123
v_and_b32_e64 v123, s49, v123
v_bfe_u32 v122, v123, 2, 14
v_lshrrev_b32_e64 v123, 18, v123
v_pk_add_f16 v125, v125, 1.0 op_sel_hi:[1,0]
ds_read_u16 v120, v120
ds_read_u16 v121, v121
ds_read_b128 v[148:151], v213
ds_read_b128 v[152:155], v214
ds_read_b64 v[200:201], v238 offset:2400
ds_read_b64 v[202:203], v239 offset:2400
s_waitcnt lgkmcnt(13)
ds_read_b128 v[156:159], v215
ds_read_u16 v122, v122
s_waitcnt lgkmcnt(14)
ds_read_u16 v123, v123
v_pk_add_f16 v127, v127, 1.0 op_sel_hi:[1,0]
v_rcp_f16_sdwa v125, v125 dst_sel:WORD_0 dst_unused:UNUSED_PRESERVE src0_sel:WORD_0
v_rcp_f16_sdwa v127, v127 dst_sel:WORD_0 dst_unused:UNUSED_PRESERVE src0_sel:WORD_0
v_rcp_f16_sdwa v125, v125 dst_sel:WORD_1 dst_unused:UNUSED_PRESERVE src0_sel:WORD_1
v_rcp_f16_sdwa v127, v127 dst_sel:WORD_1 dst_unused:UNUSED_PRESERVE src0_sel:WORD_1
v_pk_mul_f16 v124, v124, v125
v_pk_mul_f16 v126, v126, v127
v_fma_mix_f32 v235, v124, v124, v235 op_sel_hi:[1,1,0]
s_waitcnt lgkmcnt(13)
ds_read_b64 v[204:205], v238 offset:4800
ds_read_b64 v[206:207], v239 offset:4800
s_waitcnt lgkmcnt(14)
ds_read_b128 v[160:163], v212 offset:16
v_fma_mix_f32 v235, v126, v126, v235 op_sel_hi:[1,1,0]
v_cvt_pkrtz_f16_f32 v129, v128, v129
v_fma_mix_f32 v235, v124, v124, v235 op_sel:[1,1,0] op_sel_hi:[1,1,0]
s_waitcnt lgkmcnt(12)
v_mfma_f32_16x16x32_bf16 v[48:51], v[196:199], v[144:147], 0
ds_read_b64 v[208:209], v238 offset:200
ds_read_b64 v[210:211], v239 offset:200
v_fma_mix_f32 v235, v126, v126, v235 op_sel:[1,1,0] op_sel_hi:[1,1,0]
v_and_b32 v129, s49, v129
v_fma_mix_f32 v235, v112, v112, v235 op_sel_hi:[1,1,0]
v_bfe_u32 v128, v129, 2, 14
v_fma_mix_f32 v235, v113, v113, v235 op_sel_hi:[1,1,0]
v_lshrrev_b32 v129, 18, v129
v_fma_mix_f32 v235, v114, v114, v235 op_sel_hi:[1,1,0]
v_cvt_pk_f16_f32 v140, v140, v141
ds_read_b128 v[164:167], v213 offset:16
s_waitcnt lgkmcnt(14)
ds_read_b128 v[168:171], v214 offset:16
v_fma_mix_f32 v235, v115, v115, v235 op_sel_hi:[1,1,0]
v_cvt_pk_f16_f32 v142, v142, v143
s_waitcnt lgkmcnt(13)
v_mfma_f32_16x16x32_bf16 v[96:99], v[196:199], v[148:151], 0
ds_read_b64 v[192:193], v238 offset:2600
ds_read_b64 v[194:195], v239 offset:2600
v_pk_fma_f16 v141, v140, v140, s48
v_fma_mix_f32 v235, v116, v116, v235 op_sel_hi:[1,1,0]
v_cvt_pkrtz_f16_f32 v131, v130, v131
s_waitcnt lgkmcnt(12)
v_mfma_f32_16x16x32_bf16 v[48:51], v[200:203], v[148:151], v[48:51]
ds_read_b128 v[172:175], v215 offset:16
ds_read_b64 v[196:197], v238 offset:5000
ds_read_b64 v[198:199], v239 offset:5000
v_mfma_f32_16x16x32_bf16 v[96:99], v[200:203], v[152:155], v[96:99]
v_fma_mix_f32 v235, v117, v117, v235 op_sel_hi:[1,1,0]
v_and_b32_e64 v131, s49, v131
v_bfe_u32 v130, v131, 2, 14
v_lshrrev_b32_e64 v131, 18, v131
v_pk_fma_f16 v143, v142, v142, s48
v_pk_mul_f16 v141, v140, v141
v_pk_mul_f16 v143, v142, v143
v_fma_mix_f32 v235, v118, v118, v235 op_sel_hi:[1,1,0]
v_cvt_pkrtz_f16_f32 v133, v132, v133
s_waitcnt lgkmcnt(14)
ds_read_b128 v[144:147], v212 offset:32
s_waitcnt lgkmcnt(14)
ds_read_b64 v[200:201], v238 offset:400
s_waitcnt lgkmcnt(14)
ds_read_b64 v[202:203], v239 offset:400
v_fma_mix_f32 v235, v119, v119, v235 op_sel_hi:[1,1,0]
s_waitcnt lgkmcnt(13)
v_mfma_f32_16x16x32_bf16 v[48:51], v[204:207], v[152:155], v[48:51]
ds_read_b128 v[148:151], v213 offset:32
ds_read_b128 v[152:155], v214 offset:32
v_mfma_f32_16x16x32_bf16 v[96:99], v[204:207], v[156:159], v[96:99]
s_waitcnt lgkmcnt(14)
ds_read_b64 v[204:205], v238 offset:2800
s_waitcnt lgkmcnt(14)
ds_read_b64 v[206:207], v239 offset:2800
s_waitcnt lgkmcnt(14)
v_mfma_f32_16x16x32_bf16 v[52:55], v[208:211], v[160:163], 0
v_and_b32_e64 v133, s49, v133
v_bfe_u32 v132, v133, 2, 14
s_waitcnt lgkmcnt(13)
v_mfma_f32_16x16x32_bf16 v[100:103], v[208:211], v[164:167], 0
ds_read_b128 v[156:159], v215 offset:32
ds_read_b64 v[208:209], v238 offset:5200
v_lshrrev_b32 v133, 18, v133
v_exp_f16_sdwa v141, v141 dst_sel:WORD_0 dst_unused:UNUSED_PRESERVE src0_sel:WORD_0
s_waitcnt lgkmcnt(12)
v_mfma_f32_16x16x32_bf16 v[52:55], v[192:195], v[164:167], v[52:55]
ds_read_b64 v[210:211], v239 offset:5200
ds_read_b128 v[160:163], v212 offset:48
v_mfma_f32_16x16x32_bf16 v[100:103], v[192:195], v[168:171], v[100:103]
ds_read_b64 v[192:193], v238 offset:600
s_waitcnt lgkmcnt(14)
ds_read_b64 v[194:195], v239 offset:600
s_waitcnt lgkmcnt(13)
v_mfma_f32_16x16x32_bf16 v[52:55], v[196:199], v[168:171], v[52:55]
ds_read_u16 v128, v128
ds_read_u16 v129, v129
v_mfma_f32_16x16x32_bf16 v[100:103], v[196:199], v[172:175], v[100:103]
s_waitcnt lgkmcnt(14)
ds_read_b128 v[164:167], v213 offset:48
s_waitcnt lgkmcnt(14)
ds_read_b128 v[168:171], v214 offset:48
s_waitcnt lgkmcnt(14)
v_mfma_f32_16x16x32_bf16 v[56:59], v[200:203], v[144:147], 0
ds_read_b64 v[196:197], v238 offset:3000
v_fma_mix_f32 v235, v120, v120, v235 op_sel_hi:[1,1,0]
s_waitcnt lgkmcnt(14)
v_mfma_f32_16x16x32_bf16 v[104:107], v[200:203], v[148:151], 0
ds_read_b64 v[198:199], v239 offset:3000
v_fma_mix_f32 v235, v121, v121, v235 op_sel_hi:[1,1,0]
v_exp_f16_sdwa v143, v143 dst_sel:WORD_0 dst_unused:UNUSED_PRESERVE src0_sel:WORD_0
s_waitcnt lgkmcnt(12)
v_mfma_f32_16x16x32_bf16 v[56:59], v[204:207], v[148:151], v[56:59]
ds_read_u16 v130, v130
ds_read_u16 v131, v131
ds_read_b128 v[172:175], v215 offset:48
v_mfma_f32_16x16x32_bf16 v[104:107], v[204:207], v[152:155], v[104:107]
s_waitcnt lgkmcnt(14)
ds_read_b64 v[200:201], v238 offset:5400
s_waitcnt lgkmcnt(14)
ds_read_b64 v[202:203], v239 offset:5400
s_waitcnt lgkmcnt(14)
v_mfma_f32_16x16x32_bf16 v[56:59], v[208:211], v[152:155], v[56:59]
ds_read_u16 v132, v132
v_cvt_pkrtz_f16_f32 v135, v134, v135
v_mfma_f32_16x16x32_bf16 v[104:107], v[208:211], v[156:159], v[104:107]
s_waitcnt lgkmcnt(14)
ds_read_u16 v133, v133
s_waitcnt lgkmcnt(14)
ds_read_b128 v[144:147], v212 offset:64
s_waitcnt lgkmcnt(14)
v_mfma_f32_16x16x32_bf16 v[60:63], v[192:195], v[160:163], 0
v_and_b32 v135, s49, v135
v_bfe_u32 v134, v135, 2, 14
v_lshrrev_b32_e64 v135, 18, v135
v_exp_f16_sdwa v141, v141 dst_sel:WORD_1 dst_unused:UNUSED_PRESERVE src0_sel:WORD_1
v_fma_mix_f32 v235, v122, v122, v235 op_sel_hi:[1,1,0]
v_cvt_pkrtz_f16_f32 v137, v136, v137
v_fma_mix_f32 v235, v123, v123, v235 op_sel_hi:[1,1,0]
v_and_b32 v137, s49, v137
ds_read_b64 v[204:205], v238 offset:800
s_waitcnt lgkmcnt(14)
ds_read_b64 v[206:207], v239 offset:800
s_waitcnt lgkmcnt(14)
ds_read_b128 v[148:151], v213 offset:64
s_waitcnt lgkmcnt(14)
v_mfma_f32_16x16x32_bf16 v[108:111], v[192:195], v[164:167], 0
v_bfe_u32 v136, v137, 2, 14
v_lshrrev_b32 v137, 18, v137
v_exp_f16_sdwa v143, v143 dst_sel:WORD_1 dst_unused:UNUSED_PRESERVE src0_sel:WORD_1
v_cvt_pkrtz_f16_f32 v139, v138, v139
s_waitcnt lgkmcnt(11)
v_mfma_f32_16x16x32_bf16 v[60:63], v[196:199], v[164:167], v[60:63]
ds_read_u16 v134, v134
ds_read_u16 v135, v135
ds_read_b128 v[152:155], v214 offset:64
v_mfma_f32_16x16x32_bf16 v[108:111], v[196:199], v[168:171], v[108:111]
ds_read_b64 v[208:209], v238 offset:3200
v_and_b32_e64 v139, s49, v139
v_bfe_u32 v138, v139, 2, 14
v_lshrrev_b32 v139, 18, v139
v_pk_add_f16 v141, v141, 1.0 op_sel_hi:[1,0]
v_pk_add_f16 v143, v143, 1.0 op_sel_hi:[1,0]
v_rcp_f16_sdwa v141, v141 dst_sel:WORD_0 dst_unused:UNUSED_PRESERVE src0_sel:WORD_0
v_rcp_f16_sdwa v143, v143 dst_sel:WORD_0 dst_unused:UNUSED_PRESERVE src0_sel:WORD_0
v_rcp_f16_sdwa v141, v141 dst_sel:WORD_1 dst_unused:UNUSED_PRESERVE src0_sel:WORD_1
s_waitcnt lgkmcnt(10)
v_mfma_f32_16x16x32_bf16 v[60:63], v[200:203], v[168:171], v[60:63]
ds_read_b64 v[210:211], v239 offset:3200
ds_read_b128 v[156:159], v215 offset:64
ds_read_b64 v[192:193], v238 offset:5600
ds_read_b64 v[194:195], v239 offset:5600
v_mfma_f32_16x16x32_bf16 v[108:111], v[200:203], v[172:175], v[108:111]
ds_read_u16 v136, v136
v_rcp_f16_sdwa v143, v143 dst_sel:WORD_1 dst_unused:UNUSED_PRESERVE src0_sel:WORD_1
v_pk_mul_f16 v140, v140, v141
v_pk_mul_f16 v142, v142, v143
v_fma_mix_f32 v235, v140, v140, v235 op_sel_hi:[1,1,0]
s_waitcnt lgkmcnt(14)
ds_read_u16 v137, v137
v_fma_mix_f32 v235, v142, v142, v235 op_sel_hi:[1,1,0]
s_waitcnt lgkmcnt(14)
ds_read_b128 v[160:163], v212 offset:80
s_waitcnt lgkmcnt(14)
ds_read_b64 v[196:197], v238 offset:1000
s_waitcnt lgkmcnt(14)
ds_read_b64 v[198:199], v239 offset:1000
s_waitcnt lgkmcnt(14)
v_mfma_f32_16x16x32_bf16 v[64:67], v[204:207], v[144:147], 0
v_fma_mix_f32 v235, v140, v140, v235 op_sel:[1,1,0] op_sel_hi:[1,1,0]
ds_read_u16 v138, v138
s_waitcnt lgkmcnt(14)
v_mfma_f32_16x16x32_bf16 v[112:115], v[204:207], v[148:151], 0
ds_read_u16 v139, v139
s_waitcnt lgkmcnt(14)
ds_read_b128 v[164:167], v213 offset:80
v_fma_mix_f32 v235, v142, v142, v235 op_sel:[1,1,0] op_sel_hi:[1,1,0]
s_nop 0
v_fma_mix_f32 v235, v128, v128, v235 op_sel_hi:[1,1,0]
s_waitcnt lgkmcnt(14)
ds_read_b128 v[168:171], v214 offset:80
v_fma_mix_f32 v235, v129, v129, v235 op_sel_hi:[1,1,0]
s_waitcnt lgkmcnt(14)
ds_read_b64 v[200:201], v238 offset:3400
v_fma_mix_f32 v235, v130, v130, v235 op_sel_hi:[1,1,0]
s_waitcnt lgkmcnt(13)
v_mfma_f32_16x16x32_bf16 v[64:67], v[208:211], v[148:151], v[64:67]
ds_read_b64 v[202:203], v239 offset:3400
v_fma_mix_f32 v235, v131, v131, v235 op_sel_hi:[1,1,0]
v_mfma_f32_16x16x32_bf16 v[112:115], v[208:211], v[152:155], v[112:115]
ds_read_b128 v[172:175], v215 offset:80
s_waitcnt lgkmcnt(14)
ds_read_b64 v[204:205], v238 offset:5800
s_waitcnt lgkmcnt(14)
ds_read_b64 v[206:207], v239 offset:5800
s_waitcnt lgkmcnt(14)
v_mfma_f32_16x16x32_bf16 v[64:67], v[192:195], v[152:155], v[64:67]
v_fma_mix_f32 v235, v132, v132, v235 op_sel_hi:[1,1,0]
v_mfma_f32_16x16x32_bf16 v[112:115], v[192:195], v[156:159], v[112:115]
ds_read_b128 v[144:147], v212 offset:96
v_fma_mix_f32 v235, v133, v133, v235 op_sel_hi:[1,1,0]
s_waitcnt lgkmcnt(14)
ds_read_b64 v[208:209], v238 offset:1200
s_waitcnt lgkmcnt(14)
ds_read_b64 v[210:211], v239 offset:1200
v_fma_mix_f32 v235, v134, v134, v235 op_sel_hi:[1,1,0]
s_waitcnt lgkmcnt(14)
ds_read_b128 v[148:151], v213 offset:96
v_fma_mix_f32 v235, v135, v135, v235 op_sel_hi:[1,1,0]
s_waitcnt lgkmcnt(13)
v_mfma_f32_16x16x32_bf16 v[68:71], v[196:199], v[160:163], 0
ds_read_b128 v[152:155], v214 offset:96
ds_read_b64 v[192:193], v238 offset:3600
s_waitcnt lgkmcnt(14)
ds_read_b64 v[194:195], v239 offset:3600
s_waitcnt lgkmcnt(13)
v_mfma_f32_16x16x32_bf16 v[116:119], v[196:199], v[164:167], 0
ds_read_b128 v[156:159], v215 offset:96
ds_read_b64 v[196:197], v238 offset:6000
s_waitcnt lgkmcnt(14)
ds_read_b64 v[198:199], v239 offset:6000
s_waitcnt lgkmcnt(13)
v_mfma_f32_16x16x32_bf16 v[68:71], v[200:203], v[164:167], v[68:71]
ds_read_b128 v[160:163], v212 offset:112
v_fma_mix_f32 v235, v136, v136, v235 op_sel_hi:[1,1,0]
v_mfma_f32_16x16x32_bf16 v[116:119], v[200:203], v[168:171], v[116:119]
ds_read_b64 v[200:201], v238 offset:1400
s_waitcnt lgkmcnt(14)
ds_read_b64 v[202:203], v239 offset:1400
s_waitcnt lgkmcnt(13)
v_mfma_f32_16x16x32_bf16 v[68:71], v[204:207], v[168:171], v[68:71]
ds_read_b128 v[164:167], v213 offset:112
v_fma_mix_f32 v235, v137, v137, v235 op_sel_hi:[1,1,0]
v_mfma_f32_16x16x32_bf16 v[116:119], v[204:207], v[172:175], v[116:119]
ds_read_b128 v[168:171], v214 offset:112
s_waitcnt lgkmcnt(14)
ds_read_b64 v[204:205], v238 offset:3800
s_waitcnt lgkmcnt(13)
v_mfma_f32_16x16x32_bf16 v[72:75], v[208:211], v[144:147], 0
ds_read_b64 v[206:207], v239 offset:3800
ds_read_b128 v[172:175], v215 offset:112
s_waitcnt lgkmcnt(14)
v_mfma_f32_16x16x32_bf16 v[120:123], v[208:211], v[148:151], 0
v_fma_mix_f32 v235, v138, v138, v235 op_sel_hi:[1,1,0]
ds_read_b64 v[208:209], v238 offset:6200
v_fma_mix_f32 v235, v139, v139, v235 op_sel_hi:[1,1,0]
s_waitcnt lgkmcnt(14)
ds_read_b64 v[210:211], v239 offset:6200
s_waitcnt lgkmcnt(13)
v_mfma_f32_16x16x32_bf16 v[72:75], v[192:195], v[148:151], v[72:75]
ds_read_b128 v[144:147], v212 offset:128
ds_read_b128 v[148:151], v213 offset:128
v_mfma_f32_16x16x32_bf16 v[120:123], v[192:195], v[152:155], v[120:123]
s_waitcnt lgkmcnt(14)
ds_read_b64 v[192:193], v238 offset:1600
s_waitcnt lgkmcnt(14)
ds_read_b64 v[194:195], v239 offset:1600
s_waitcnt lgkmcnt(14)
v_mfma_f32_16x16x32_bf16 v[72:75], v[196:199], v[152:155], v[72:75]
ds_read_b128 v[152:155], v214 offset:128
v_mfma_f32_16x16x32_bf16 v[120:123], v[196:199], v[156:159], v[120:123]
s_waitcnt lgkmcnt(14)
ds_read_b64 v[196:197], v238 offset:4000
s_waitcnt lgkmcnt(14)
ds_read_b64 v[198:199], v239 offset:4000
s_waitcnt lgkmcnt(14)
v_mfma_f32_16x16x32_bf16 v[76:79], v[200:203], v[160:163], 0
ds_read_b128 v[156:159], v215 offset:128
s_waitcnt lgkmcnt(14)
v_mfma_f32_16x16x32_bf16 v[124:127], v[200:203], v[164:167], 0
ds_read_b64 v[200:201], v238 offset:6400
s_waitcnt lgkmcnt(14)
ds_read_b64 v[202:203], v239 offset:6400
s_waitcnt lgkmcnt(13)
v_mfma_f32_16x16x32_bf16 v[76:79], v[204:207], v[164:167], v[76:79]
ds_read_b128 v[160:163], v212 offset:144
ds_read_b128 v[164:167], v213 offset:144
v_mfma_f32_16x16x32_bf16 v[124:127], v[204:207], v[168:171], v[124:127]
s_waitcnt lgkmcnt(14)
ds_read_b64 v[204:205], v238 offset:1800
s_waitcnt lgkmcnt(14)
ds_read_b64 v[206:207], v239 offset:1800
s_waitcnt lgkmcnt(14)
v_mfma_f32_16x16x32_bf16 v[76:79], v[208:211], v[168:171], v[76:79]
ds_read_b128 v[168:171], v214 offset:144
v_mfma_f32_16x16x32_bf16 v[124:127], v[208:211], v[172:175], v[124:127]
s_waitcnt lgkmcnt(14)
ds_read_b64 v[208:209], v238 offset:4200
s_waitcnt lgkmcnt(14)
ds_read_b64 v[210:211], v239 offset:4200
s_waitcnt lgkmcnt(13)
v_mfma_f32_16x16x32_bf16 v[80:83], v[192:195], v[144:147], 0
ds_read_b128 v[172:175], v215 offset:144
ds_read_b128 v[144:147], v212 offset:160
v_mfma_f32_16x16x32_bf16 v[128:131], v[192:195], v[148:151], 0
s_waitcnt lgkmcnt(14)
ds_read_b64 v[192:193], v238 offset:6600
s_waitcnt lgkmcnt(14)
ds_read_b64 v[194:195], v239 offset:6600
s_waitcnt lgkmcnt(14)
v_mfma_f32_16x16x32_bf16 v[80:83], v[196:199], v[148:151], v[80:83]
ds_read_b128 v[148:151], v213 offset:160
v_mfma_f32_16x16x32_bf16 v[128:131], v[196:199], v[152:155], v[128:131]
s_waitcnt lgkmcnt(14)
ds_read_b64 v[196:197], v238 offset:2000
s_waitcnt lgkmcnt(14)
ds_read_b64 v[198:199], v239 offset:2000
s_waitcnt lgkmcnt(14)
v_mfma_f32_16x16x32_bf16 v[80:83], v[200:203], v[152:155], v[80:83]
ds_read_b128 v[152:155], v214 offset:160
v_mfma_f32_16x16x32_bf16 v[128:131], v[200:203], v[156:159], v[128:131]
s_waitcnt lgkmcnt(14)
ds_read_b64 v[200:201], v238 offset:4400
s_waitcnt lgkmcnt(14)
ds_read_b64 v[202:203], v239 offset:4400
s_waitcnt lgkmcnt(13)
v_mfma_f32_16x16x32_bf16 v[84:87], v[204:207], v[160:163], 0
ds_read_b128 v[156:159], v215 offset:160
ds_read_b128 v[160:163], v212 offset:176
v_mfma_f32_16x16x32_bf16 v[132:135], v[204:207], v[164:167], 0
s_waitcnt lgkmcnt(14)
ds_read_b64 v[204:205], v238 offset:6800
s_waitcnt lgkmcnt(14)
ds_read_b64 v[206:207], v239 offset:6800
s_waitcnt lgkmcnt(14)
v_mfma_f32_16x16x32_bf16 v[84:87], v[208:211], v[164:167], v[84:87]
ds_read_b128 v[164:167], v213 offset:176
v_mfma_f32_16x16x32_bf16 v[132:135], v[208:211], v[168:171], v[132:135]
s_waitcnt lgkmcnt(14)
ds_read_b64 v[208:209], v238 offset:2200
s_waitcnt lgkmcnt(14)
ds_read_b64 v[210:211], v239 offset:2200
s_waitcnt lgkmcnt(13)
v_mfma_f32_16x16x32_bf16 v[84:87], v[192:195], v[168:171], v[84:87]
ds_read_b128 v[168:171], v214 offset:176
v_mfma_f32_16x16x32_bf16 v[132:135], v[192:195], v[172:175], v[132:135]
ds_read_b64 v[192:193], v238 offset:4600
s_waitcnt lgkmcnt(14)
ds_read_b64 v[194:195], v239 offset:4600
s_waitcnt lgkmcnt(13)
v_mfma_f32_16x16x32_bf16 v[88:91], v[196:199], v[144:147], 0
ds_read_b128 v[172:175], v215 offset:176
v_mfma_f32_16x16x32_bf16 v[136:139], v[196:199], v[148:151], 0
ds_read_b64 v[196:197], v238 offset:7000
s_waitcnt lgkmcnt(14)
ds_read_b64 v[198:199], v239 offset:7000
s_waitcnt lgkmcnt(13)
v_mfma_f32_16x16x32_bf16 v[88:91], v[200:203], v[148:151], v[88:91]
v_mfma_f32_16x16x32_bf16 v[136:139], v[200:203], v[152:155], v[136:139]
s_waitcnt lgkmcnt(9)
v_mfma_f32_16x16x32_bf16 v[88:91], v[204:207], v[152:155], v[88:91]
v_mfma_f32_16x16x32_bf16 v[136:139], v[204:207], v[156:159], v[136:139]
s_waitcnt lgkmcnt(6)
v_mfma_f32_16x16x32_bf16 v[92:95], v[208:211], v[160:163], 0
v_mfma_f32_16x16x32_bf16 v[140:143], v[208:211], v[164:167], 0
s_waitcnt lgkmcnt(3)
v_mfma_f32_16x16x32_bf16 v[92:95], v[192:195], v[164:167], v[92:95]
v_mfma_f32_16x16x32_bf16 v[140:143], v[192:195], v[168:171], v[140:143]
s_waitcnt lgkmcnt(0)
v_mfma_f32_16x16x32_bf16 v[92:95], v[196:199], v[168:171], v[92:95]
v_mfma_f32_16x16x32_bf16 v[140:143], v[196:199], v[172:175], v[140:143]
v_mov_b32 v223, 1
v_add_u32 v222, s83, v247
s_nop 7
s_mov_b64 exec, 1
ds_add_u32 v222, v223 offset:24
s_mov_b64 exec, -1
v_pk_mul_f32 v[242:243], v[48:49], v[48:49]
v_pk_add_f32 v[240:241], v[48:49], v[50:51]
v_pk_fma_f32 v[242:243], v[50:51], v[50:51], v[242:243]
v_pk_mul_f32 v[218:219], v[96:97], v[96:97]
v_pk_add_f32 v[216:217], v[96:97], v[98:99]
v_pk_fma_f32 v[218:219], v[98:99], v[98:99], v[218:219]
v_pk_fma_f32 v[242:243], v[52:53], v[52:53], v[242:243]
v_pk_add_f32 v[240:241], v[240:241], v[52:53]
v_pk_fma_f32 v[242:243], v[54:55], v[54:55], v[242:243]
v_pk_add_f32 v[240:241], v[240:241], v[54:55]
v_pk_fma_f32 v[218:219], v[100:101], v[100:101], v[218:219]
v_pk_add_f32 v[216:217], v[216:217], v[100:101]
v_pk_fma_f32 v[218:219], v[102:103], v[102:103], v[218:219]
v_pk_add_f32 v[216:217], v[216:217], v[102:103]
v_pk_fma_f32 v[242:243], v[56:57], v[56:57], v[242:243]
v_pk_add_f32 v[240:241], v[240:241], v[56:57]
v_pk_fma_f32 v[242:243], v[58:59], v[58:59], v[242:243]
v_pk_add_f32 v[240:241], v[240:241], v[58:59]
v_pk_fma_f32 v[218:219], v[104:105], v[104:105], v[218:219]
v_pk_add_f32 v[216:217], v[216:217], v[104:105]
v_pk_fma_f32 v[218:219], v[106:107], v[106:107], v[218:219]
v_pk_add_f32 v[216:217], v[216:217], v[106:107]
v_pk_fma_f32 v[242:243], v[60:61], v[60:61], v[242:243]
v_pk_add_f32 v[240:241], v[240:241], v[60:61]
v_pk_fma_f32 v[242:243], v[62:63], v[62:63], v[242:243]
v_pk_add_f32 v[240:241], v[240:241], v[62:63]
v_pk_fma_f32 v[218:219], v[108:109], v[108:109], v[218:219]
v_pk_add_f32 v[216:217], v[216:217], v[108:109]
v_pk_fma_f32 v[218:219], v[110:111], v[110:111], v[218:219]
v_pk_add_f32 v[216:217], v[216:217], v[110:111]
v_pk_fma_f32 v[242:243], v[64:65], v[64:65], v[242:243]
v_pk_add_f32 v[240:241], v[240:241], v[64:65]
v_pk_fma_f32 v[242:243], v[66:67], v[66:67], v[242:243]
v_pk_add_f32 v[240:241], v[240:241], v[66:67]
v_pk_fma_f32 v[218:219], v[112:113], v[112:113], v[218:219]
v_pk_add_f32 v[216:217], v[216:217], v[112:113]
v_pk_fma_f32 v[218:219], v[114:115], v[114:115], v[218:219]
v_pk_add_f32 v[216:217], v[216:217], v[114:115]
v_pk_fma_f32 v[242:243], v[68:69], v[68:69], v[242:243]
v_pk_add_f32 v[240:241], v[240:241], v[68:69]
v_pk_fma_f32 v[242:243], v[70:71], v[70:71], v[242:243]
v_pk_add_f32 v[240:241], v[240:241], v[70:71]
v_pk_fma_f32 v[218:219], v[116:117], v[116:117], v[218:219]
v_pk_add_f32 v[216:217], v[216:217], v[116:117]
v_pk_fma_f32 v[218:219], v[118:119], v[118:119], v[218:219]
v_pk_add_f32 v[216:217], v[216:217], v[118:119]
v_pk_fma_f32 v[242:243], v[72:73], v[72:73], v[242:243]
v_pk_add_f32 v[240:241], v[240:241], v[72:73]
v_pk_fma_f32 v[242:243], v[74:75], v[74:75], v[242:243]
v_pk_add_f32 v[240:241], v[240:241], v[74:75]
v_pk_fma_f32 v[218:219], v[120:121], v[120:121], v[218:219]
v_pk_add_f32 v[216:217], v[216:217], v[120:121]
v_pk_fma_f32 v[218:219], v[122:123], v[122:123], v[218:219]
v_pk_add_f32 v[216:217], v[216:217], v[122:123]
v_pk_fma_f32 v[242:243], v[76:77], v[76:77], v[242:243]
v_pk_add_f32 v[240:241], v[240:241], v[76:77]
v_pk_fma_f32 v[242:243], v[78:79], v[78:79], v[242:243]
v_pk_add_f32 v[240:241], v[240:241], v[78:79]
v_pk_fma_f32 v[218:219], v[124:125], v[124:125], v[218:219]
v_pk_add_f32 v[216:217], v[216:217], v[124:125]
v_pk_fma_f32 v[218:219], v[126:127], v[126:127], v[218:219]
v_pk_add_f32 v[216:217], v[216:217], v[126:127]
v_pk_fma_f32 v[242:243], v[80:81], v[80:81], v[242:243]
v_pk_add_f32 v[240:241], v[240:241], v[80:81]
v_pk_fma_f32 v[242:243], v[82:83], v[82:83], v[242:243]
v_pk_add_f32 v[240:241], v[240:241], v[82:83]
v_pk_fma_f32 v[218:219], v[128:129], v[128:129], v[218:219]
v_pk_add_f32 v[216:217], v[216:217], v[128:129]
v_pk_fma_f32 v[218:219], v[130:131], v[130:131], v[218:219]
v_pk_add_f32 v[216:217], v[216:217], v[130:131]
v_pk_fma_f32 v[242:243], v[84:85], v[84:85], v[242:243]
v_pk_add_f32 v[240:241], v[240:241], v[84:85]
v_pk_fma_f32 v[242:243], v[86:87], v[86:87], v[242:243]
v_pk_add_f32 v[240:241], v[240:241], v[86:87]
v_pk_fma_f32 v[218:219], v[132:133], v[132:133], v[218:219]
v_pk_add_f32 v[216:217], v[216:217], v[132:133]
v_pk_fma_f32 v[218:219], v[134:135], v[134:135], v[218:219]
v_pk_add_f32 v[216:217], v[216:217], v[134:135]
v_pk_fma_f32 v[242:243], v[88:89], v[88:89], v[242:243]
v_pk_add_f32 v[240:241], v[240:241], v[88:89]
v_pk_fma_f32 v[242:243], v[90:91], v[90:91], v[242:243]
v_pk_add_f32 v[240:241], v[240:241], v[90:91]
v_pk_fma_f32 v[218:219], v[136:137], v[136:137], v[218:219]
v_pk_add_f32 v[216:217], v[216:217], v[136:137]
v_pk_fma_f32 v[218:219], v[138:139], v[138:139], v[218:219]
v_pk_add_f32 v[216:217], v[216:217], v[138:139]
v_pk_fma_f32 v[242:243], v[92:93], v[92:93], v[242:243]
v_pk_add_f32 v[240:241], v[240:241], v[92:93]
v_pk_fma_f32 v[242:243], v[94:95], v[94:95], v[242:243]
v_pk_add_f32 v[240:241], v[240:241], v[94:95]
v_pk_fma_f32 v[218:219], v[140:141], v[140:141], v[218:219]
v_pk_add_f32 v[216:217], v[216:217], v[140:141]
v_pk_fma_f32 v[218:219], v[142:143], v[142:143], v[218:219]
v_pk_add_f32 v[216:217], v[216:217], v[142:143]
v_add_f32 v218, v218, v219
v_add_f32 v216, v216, v217
s_nop 1
v_permlane32_swap_b32 v216, v218
v_add_f32_e64 v216, v216, v218
v_mul_f32 v216, 1009429163, v216
v_mov_b32_e64 v218, v216
s_nop 1
v_permlane32_swap_b32 v216, v218
v_fma_f32 v218, -v216, v216, v218
v_max_f32_e64 v218, 0, v218
v_add_f32 v218, 925353388, v218
v_rsq_f32 v218, v218
v_add_f32 v240, v240, v241
v_mul_f32 v220, 3203396952, v218
v_mul_f32 v221, 3203396952, v218
v_mul_f32 v218, v216, v220
v_mul_f32 v219, v216, v220
v_add_f32 v242, v242, v243
s_nop 1
v_permlane32_swap_b32 v240, v242
v_add_f32 v240, v240, v242
v_mul_f32 v240, 1009429163, v240
v_mov_b32_e64 v242, v240
s_nop 1
v_permlane32_swap_b32 v240, v242
v_fma_f32 v242, -v240, v240, v242
v_max_f32_e64 v242, 0, v242
v_add_f32 v242, 925353388, v242
v_rsq_f32 v242, v242
s_nop 0
v_mul_f32 v244, 3203396952, v242
v_mul_f32 v245, 3203396952, v242
v_mul_f32 v242, v240, v244
v_mul_f32 v243, v240, v244
v_pk_fma_f32 v[48:49], v[48:49], v[244:245], v[242:243] neg_lo:[0,0,1] neg_hi:[0,0,1]
v_pk_fma_f32 v[50:51], v[50:51], v[244:245], v[242:243] neg_lo:[0,0,1] neg_hi:[0,0,1]
v_cvt_pk_bf16_f32 v48, v48, v49
v_cvt_pk_bf16_f32 v49, v50, v51
v_pk_fma_f32 v[52:53], v[52:53], v[244:245], v[242:243] neg_lo:[0,0,1] neg_hi:[0,0,1]
v_pk_fma_f32 v[54:55], v[54:55], v[244:245], v[242:243] neg_lo:[0,0,1] neg_hi:[0,0,1]
v_cvt_pk_bf16_f32 v50, v52, v53
v_cvt_pk_bf16_f32 v51, v54, v55
v_pk_fma_f32 v[56:57], v[56:57], v[244:245], v[242:243] neg_lo:[0,0,1] neg_hi:[0,0,1]
v_pk_fma_f32 v[58:59], v[58:59], v[244:245], v[242:243] neg_lo:[0,0,1] neg_hi:[0,0,1]
v_cvt_pk_bf16_f32 v52, v56, v57
v_cvt_pk_bf16_f32 v53, v58, v59
v_pk_fma_f32 v[60:61], v[60:61], v[244:245], v[242:243] neg_lo:[0,0,1] neg_hi:[0,0,1]
v_pk_fma_f32 v[62:63], v[62:63], v[244:245], v[242:243] neg_lo:[0,0,1] neg_hi:[0,0,1]
v_cvt_pk_bf16_f32 v54, v60, v61
v_cvt_pk_bf16_f32 v55, v62, v63
v_pk_fma_f32 v[64:65], v[64:65], v[244:245], v[242:243] neg_lo:[0,0,1] neg_hi:[0,0,1]
v_pk_fma_f32 v[66:67], v[66:67], v[244:245], v[242:243] neg_lo:[0,0,1] neg_hi:[0,0,1]
v_cvt_pk_bf16_f32 v56, v64, v65
v_cvt_pk_bf16_f32 v57, v66, v67
v_pk_fma_f32 v[68:69], v[68:69], v[244:245], v[242:243] neg_lo:[0,0,1] neg_hi:[0,0,1]
v_pk_fma_f32 v[70:71], v[70:71], v[244:245], v[242:243] neg_lo:[0,0,1] neg_hi:[0,0,1]
v_cvt_pk_bf16_f32 v58, v68, v69
v_cvt_pk_bf16_f32 v59, v70, v71
v_pk_fma_f32 v[72:73], v[72:73], v[244:245], v[242:243] neg_lo:[0,0,1] neg_hi:[0,0,1]
v_pk_fma_f32 v[74:75], v[74:75], v[244:245], v[242:243] neg_lo:[0,0,1] neg_hi:[0,0,1]
v_cvt_pk_bf16_f32 v60, v72, v73
v_cvt_pk_bf16_f32 v61, v74, v75
v_pk_fma_f32 v[76:77], v[76:77], v[244:245], v[242:243] neg_lo:[0,0,1] neg_hi:[0,0,1]
v_pk_fma_f32 v[78:79], v[78:79], v[244:245], v[242:243] neg_lo:[0,0,1] neg_hi:[0,0,1]
v_cvt_pk_bf16_f32 v62, v76, v77
v_cvt_pk_bf16_f32 v63, v78, v79
v_pk_fma_f32 v[80:81], v[80:81], v[244:245], v[242:243] neg_lo:[0,0,1] neg_hi:[0,0,1]
v_pk_fma_f32 v[82:83], v[82:83], v[244:245], v[242:243] neg_lo:[0,0,1] neg_hi:[0,0,1]
v_cvt_pk_bf16_f32 v64, v80, v81
v_cvt_pk_bf16_f32 v65, v82, v83
v_pk_fma_f32 v[84:85], v[84:85], v[244:245], v[242:243] neg_lo:[0,0,1] neg_hi:[0,0,1]
v_pk_fma_f32 v[86:87], v[86:87], v[244:245], v[242:243] neg_lo:[0,0,1] neg_hi:[0,0,1]
v_cvt_pk_bf16_f32 v66, v84, v85
v_cvt_pk_bf16_f32 v67, v86, v87
v_pk_fma_f32 v[88:89], v[88:89], v[244:245], v[242:243] neg_lo:[0,0,1] neg_hi:[0,0,1]
v_pk_fma_f32 v[90:91], v[90:91], v[244:245], v[242:243] neg_lo:[0,0,1] neg_hi:[0,0,1]
v_cvt_pk_bf16_f32 v68, v88, v89
v_cvt_pk_bf16_f32 v69, v90, v91
v_pk_fma_f32 v[92:93], v[92:93], v[244:245], v[242:243] neg_lo:[0,0,1] neg_hi:[0,0,1]
v_pk_fma_f32 v[94:95], v[94:95], v[244:245], v[242:243] neg_lo:[0,0,1] neg_hi:[0,0,1]
v_cvt_pk_bf16_f32 v70, v92, v93
v_cvt_pk_bf16_f32 v71, v94, v95
v_pk_fma_f32 v[96:97], v[96:97], v[220:221], v[218:219] neg_lo:[0,0,1] neg_hi:[0,0,1]
ds_read_b128 v[176:179], v250
v_cvt_pk_bf16_f32 v72, v96, v97
v_pk_fma_f32 v[98:99], v[98:99], v[220:221], v[218:219] neg_lo:[0,0,1] neg_hi:[0,0,1]
v_pk_fma_f32 v[100:101], v[100:101], v[220:221], v[218:219] neg_lo:[0,0,1] neg_hi:[0,0,1]
v_cvt_pk_bf16_f32 v73, v98, v99
v_cvt_pk_bf16_f32 v74, v100, v101
v_pk_fma_f32 v[102:103], v[102:103], v[220:221], v[218:219] neg_lo:[0,0,1] neg_hi:[0,0,1]
v_pk_fma_f32 v[104:105], v[104:105], v[220:221], v[218:219] neg_lo:[0,0,1] neg_hi:[0,0,1]
v_cvt_pk_bf16_f32 v75, v102, v103
v_cvt_pk_bf16_f32 v76, v104, v105
v_pk_fma_f32 v[106:107], v[106:107], v[220:221], v[218:219] neg_lo:[0,0,1] neg_hi:[0,0,1]
v_pk_fma_f32 v[108:109], v[108:109], v[220:221], v[218:219] neg_lo:[0,0,1] neg_hi:[0,0,1]
v_cvt_pk_bf16_f32 v77, v106, v107
v_cvt_pk_bf16_f32 v78, v108, v109
v_pk_fma_f32 v[110:111], v[110:111], v[220:221], v[218:219] neg_lo:[0,0,1] neg_hi:[0,0,1]
v_pk_fma_f32 v[112:113], v[112:113], v[220:221], v[218:219] neg_lo:[0,0,1] neg_hi:[0,0,1]
v_cvt_pk_bf16_f32 v79, v110, v111
v_cvt_pk_bf16_f32 v80, v112, v113
v_pk_fma_f32 v[114:115], v[114:115], v[220:221], v[218:219] neg_lo:[0,0,1] neg_hi:[0,0,1]
v_pk_fma_f32 v[116:117], v[116:117], v[220:221], v[218:219] neg_lo:[0,0,1] neg_hi:[0,0,1]
v_cvt_pk_bf16_f32 v81, v114, v115
v_cvt_pk_bf16_f32 v82, v116, v117
v_pk_fma_f32 v[118:119], v[118:119], v[220:221], v[218:219] neg_lo:[0,0,1] neg_hi:[0,0,1]
v_pk_fma_f32 v[120:121], v[120:121], v[220:221], v[218:219] neg_lo:[0,0,1] neg_hi:[0,0,1]
ds_read_b128 v[180:183], v250 offset:1024
v_cvt_pk_bf16_f32 v83, v118, v119
v_cvt_pk_bf16_f32 v84, v120, v121
v_pk_fma_f32 v[122:123], v[122:123], v[220:221], v[218:219] neg_lo:[0,0,1] neg_hi:[0,0,1]
v_pk_fma_f32 v[124:125], v[124:125], v[220:221], v[218:219] neg_lo:[0,0,1] neg_hi:[0,0,1]
v_cvt_pk_bf16_f32 v85, v122, v123
v_cvt_pk_bf16_f32 v86, v124, v125
v_pk_fma_f32 v[126:127], v[126:127], v[220:221], v[218:219] neg_lo:[0,0,1] neg_hi:[0,0,1]
v_pk_fma_f32 v[128:129], v[128:129], v[220:221], v[218:219] neg_lo:[0,0,1] neg_hi:[0,0,1]
v_cvt_pk_bf16_f32 v87, v126, v127
v_cvt_pk_bf16_f32 v88, v128, v129
v_pk_fma_f32 v[130:131], v[130:131], v[220:221], v[218:219] neg_lo:[0,0,1] neg_hi:[0,0,1]
v_pk_fma_f32 v[132:133], v[132:133], v[220:221], v[218:219] neg_lo:[0,0,1] neg_hi:[0,0,1]
v_cvt_pk_bf16_f32 v89, v130, v131
v_cvt_pk_bf16_f32 v90, v132, v133
v_pk_fma_f32 v[134:135], v[134:135], v[220:221], v[218:219] neg_lo:[0,0,1] neg_hi:[0,0,1]
v_pk_fma_f32 v[136:137], v[136:137], v[220:221], v[218:219] neg_lo:[0,0,1] neg_hi:[0,0,1]
v_cvt_pk_bf16_f32 v91, v134, v135
v_cvt_pk_bf16_f32 v92, v136, v137
v_pk_fma_f32 v[138:139], v[138:139], v[220:221], v[218:219] neg_lo:[0,0,1] neg_hi:[0,0,1]
v_pk_fma_f32 v[140:141], v[140:141], v[220:221], v[218:219] neg_lo:[0,0,1] neg_hi:[0,0,1]
v_cvt_pk_bf16_f32 v93, v138, v139
v_cvt_pk_bf16_f32 v94, v140, v141
v_pk_fma_f32 v[142:143], v[142:143], v[220:221], v[218:219] neg_lo:[0,0,1] neg_hi:[0,0,1]
ds_read_b128 v[184:187], v250 offset:2048
v_cvt_pk_bf16_f32 v95, v142, v143
v_cndmask_b32 v216, 0, v255, s[50:51]
v_and_b32 v216, 1006648320, v216
v_cndmask_b32 v217, 0, v255, s[52:53]
v_and_b32 v217, 1006648320, v217
v_cndmask_b32 v218, 0, v255, s[54:55]
v_and_b32 v218, 1006648320, v218
v_cndmask_b32 v219, 0, v255, s[56:57]
v_and_b32 v219, 1006648320, v219
v_cndmask_b32 v220, 0, v255, s[58:59]
v_and_b32 v220, 1006648320, v220
v_cndmask_b32 v221, 0, v255, s[60:61]
v_and_b32 v221, 1006648320, v221
v_cndmask_b32 v222, 0, v255, s[62:63]
v_and_b32 v222, 1006648320, v222
v_cndmask_b32 v223, 0, v255, s[64:65]
v_and_b32 v223, 1006648320, v223
s_waitcnt lgkmcnt(1)
v_mfma_f32_32x32x16_bf16 v[144:159], v[48:51], v[176:179], 0
s_cmp_lt_u32 s40, 4
s_cbranch_scc0 Lbk
s_setprio 2
Lbk:
ds_read_b128 v[188:191], v250 offset:3072
v_mfma_f32_32x32x16_bf16 v[160:175], v[72:75], v[176:179], 0
ds_read_b128 v[176:179], v250 offset:4096
v_mfma_f32_32x32x16_bf16 v[144:159], v[52:55], v[180:183], v[144:159]
v_mfma_f32_32x32x16_bf16 v[160:175], v[76:79], v[180:183], v[160:175]
ds_read_b128 v[180:183], v250 offset:5120
s_waitcnt lgkmcnt(3)
v_mfma_f32_32x32x16_bf16 v[144:159], v[56:59], v[184:187], v[144:159]
v_mfma_f32_32x32x16_bf16 v[160:175], v[80:83], v[184:187], v[160:175]
ds_read_b128 v[184:187], v250 offset:6144
s_waitcnt lgkmcnt(2)
v_mfma_f32_32x32x16_bf16 v[144:159], v[60:63], v[188:191], v[144:159]
v_mfma_f32_32x32x16_bf16 v[160:175], v[84:87], v[188:191], v[160:175]
ds_read_b128 v[188:191], v250 offset:7168
v_mfma_f32_32x32x16_bf16 v[144:159], v[64:67], v[176:179], v[144:159]
v_mfma_f32_32x32x16_bf16 v[160:175], v[88:91], v[176:179], v[160:175]
ds_read_b128 v[176:179], v250 offset:8192
s_waitcnt lgkmcnt(2)
v_mfma_f32_32x32x16_bf16 v[144:159], v[68:71], v[180:183], v[144:159]
v_mfma_f32_32x32x16_bf16 v[160:175], v[92:95], v[180:183], v[160:175]
ds_read_b128 v[180:183], v250 offset:9216
s_nop 9
v_cvt_pkrtz_f16_f32 v145, v144, v145
v_mfma_f32_32x32x16_bf16 v[112:127], v[48:51], v[184:187], 0
v_and_b32_e64 v145, s49, v145
v_bfe_u32 v144, v145, 2, 14
v_lshrrev_b32_e64 v145, 18, v145
v_cvt_pk_f16_f32 v156, v156, v157
v_cvt_pk_f16_f32 v158, v158, v159
v_mfma_f32_32x32x16_bf16 v[128:143], v[72:75], v[184:187], 0
ds_read_u16 v144, v144
ds_read_u16 v145, v145
v_pk_fma_f16 v157, v156, v156, s48
v_cvt_pkrtz_f16_f32 v147, v146, v147
v_and_b32_e64 v147, s49, v147
v_bfe_u32 v146, v147, 2, 14
v_lshrrev_b32_e64 v147, 18, v147
v_pk_fma_f16 v159, v158, v158, s48
v_pk_mul_f16 v157, v156, v157
v_pk_mul_f16 v159, v158, v159
v_cvt_pkrtz_f16_f32 v149, v148, v149
v_and_b32_e64 v149, s49, v149
v_bfe_u32 v148, v149, 2, 14
ds_read_u16 v146, v146
ds_read_u16 v147, v147
v_lshrrev_b32 v149, 18, v149
v_exp_f16_sdwa v157, v157 dst_sel:WORD_0 dst_unused:UNUSED_PRESERVE src0_sel:WORD_0
s_waitcnt lgkmcnt(4)
v_mfma_f32_32x32x16_bf16 v[112:127], v[52:55], v[188:191], v[112:127]
ds_read_u16 v148, v148
ds_read_u16 v149, v149
v_exp_f16_sdwa v159, v159 dst_sel:WORD_0 dst_unused:UNUSED_PRESERVE src0_sel:WORD_0
v_cvt_pkrtz_f16_f32 v151, v150, v151
v_and_b32_e64 v151, s49, v151
v_bfe_u32 v150, v151, 2, 14
v_lshrrev_b32_e64 v151, 18, v151
v_exp_f16_sdwa v157, v157 dst_sel:WORD_1 dst_unused:UNUSED_PRESERVE src0_sel:WORD_1
v_cvt_pkrtz_f16_f32 v153, v152, v153
v_and_b32_e64 v153, s49, v153
v_bfe_u32 v152, v153, 2, 14
v_lshrrev_b32_e64 v153, 18, v153
v_mfma_f32_32x32x16_bf16 v[128:143], v[76:79], v[188:191], v[128:143]
ds_read_u16 v150, v150
ds_read_u16 v151, v151
ds_read_u16 v152, v152
ds_read_u16 v153, v153
v_exp_f16_sdwa v159, v159 dst_sel:WORD_1 dst_unused:UNUSED_PRESERVE src0_sel:WORD_1
v_cvt_pkrtz_f16_f32 v155, v154, v155
v_and_b32_e64 v155, s49, v155
v_bfe_u32 v154, v155, 2, 14
v_lshrrev_b32_e64 v155, 18, v155
v_pk_add_f16 v157, v157, 1.0 op_sel_hi:[1,0]
v_pk_add_f16 v159, v159, 1.0 op_sel_hi:[1,0]
ds_read_b128 v[184:187], v250 offset:10240
ds_read_u16 v154, v154
ds_read_u16 v155, v155
v_rcp_f16_sdwa v157, v157 dst_sel:WORD_0 dst_unused:UNUSED_PRESERVE src0_sel:WORD_0
v_mfma_f32_32x32x16_bf16 v[112:127], v[56:59], v[176:179], v[112:127]
v_rcp_f16_sdwa v159, v159 dst_sel:WORD_0 dst_unused:UNUSED_PRESERVE src0_sel:WORD_0
v_rcp_f16_sdwa v157, v157 dst_sel:WORD_1 dst_unused:UNUSED_PRESERVE src0_sel:WORD_1
v_rcp_f16_sdwa v159, v159 dst_sel:WORD_1 dst_unused:UNUSED_PRESERVE src0_sel:WORD_1
v_mfma_f32_32x32x16_bf16 v[128:143], v[80:83], v[176:179], v[128:143]
ds_read_b128 v[188:191], v250 offset:11264
v_pk_mul_f16 v156, v156, v157
v_pk_mul_f16 v158, v158, v159
v_fma_mix_f32 v224, v156, v156, v224 op_sel_hi:[1,1,0]
v_cvt_pkrtz_f16_f32 v161, v160, v161
v_fma_mix_f32 v224, v158, v158, v224 op_sel_hi:[1,1,0]
v_mfma_f32_32x32x16_bf16 v[112:127], v[60:63], v[180:183], v[112:127]
v_fma_mix_f32 v224, v156, v156, v224 op_sel:[1,1,0] op_sel_hi:[1,1,0]
v_and_b32_e64 v161, s49, v161
v_fma_mix_f32 v224, v158, v158, v224 op_sel:[1,1,0] op_sel_hi:[1,1,0]
v_bfe_u32 v160, v161, 2, 14
s_waitcnt lgkmcnt(6)
v_fma_mix_f32 v224, v144, v144, v224 op_sel_hi:[1,1,0]
v_lshrrev_b32 v161, 18, v161
v_fma_mix_f32 v224, v145, v145, v224 op_sel_hi:[1,1,0]
v_cvt_pk_f16_f32 v172, v172, v173
v_fma_mix_f32 v224, v146, v146, v224 op_sel_hi:[1,1,0]
v_cvt_pk_f16_f32 v174, v174, v175
v_fma_mix_f32 v224, v147, v147, v224 op_sel_hi:[1,1,0]
v_mfma_f32_32x32x16_bf16 v[128:143], v[84:87], v[180:183], v[128:143]
ds_read_u16 v160, v160
ds_read_u16 v161, v161
v_pk_fma_f16 v173, v172, v172, s48
v_fma_mix_f32 v224, v148, v148, v224 op_sel_hi:[1,1,0]
v_cvt_pkrtz_f16_f32 v163, v162, v163
v_fma_mix_f32 v224, v149, v149, v224 op_sel_hi:[1,1,0]
v_and_b32_e64 v163, s49, v163
v_bfe_u32 v162, v163, 2, 14
v_lshrrev_b32_e64 v163, 18, v163
v_pk_fma_f16 v175, v174, v174, s48
v_pk_mul_f16 v173, v172, v173
v_pk_mul_f16 v175, v174, v175
v_fma_mix_f32 v224, v150, v150, v224 op_sel_hi:[1,1,0]
v_cvt_pkrtz_f16_f32 v165, v164, v165
v_fma_mix_f32 v224, v151, v151, v224 op_sel_hi:[1,1,0]
ds_read_u16 v162, v162
ds_read_u16 v163, v163
ds_read_b128 v[176:179], v250 offset:12288
v_and_b32_e64 v165, s49, v165
v_bfe_u32 v164, v165, 2, 14
v_lshrrev_b32 v165, 18, v165
v_exp_f16_sdwa v173, v173 dst_sel:WORD_0 dst_unused:UNUSED_PRESERVE src0_sel:WORD_0
s_waitcnt lgkmcnt(5)
v_mfma_f32_32x32x16_bf16 v[112:127], v[64:67], v[184:187], v[112:127]
ds_read_u16 v164, v164
ds_read_u16 v165, v165
v_fma_mix_f32 v224, v152, v152, v224 op_sel_hi:[1,1,0]
v_exp_f16_sdwa v175, v175 dst_sel:WORD_0 dst_unused:UNUSED_PRESERVE src0_sel:WORD_0
v_fma_mix_f32 v224, v153, v153, v224 op_sel_hi:[1,1,0]
v_cvt_pkrtz_f16_f32 v167, v166, v167
v_and_b32_e64 v167, s49, v167
v_bfe_u32 v166, v167, 2, 14
v_lshrrev_b32_e64 v167, 18, v167
v_exp_f16_sdwa v173, v173 dst_sel:WORD_1 dst_unused:UNUSED_PRESERVE src0_sel:WORD_1
v_fma_mix_f32 v224, v154, v154, v224 op_sel_hi:[1,1,0]
v_cvt_pkrtz_f16_f32 v169, v168, v169
v_fma_mix_f32 v224, v155, v155, v224 op_sel_hi:[1,1,0]
v_and_b32_e64 v169, s49, v169
v_bfe_u32 v168, v169, 2, 14
ds_read_u16 v166, v166
ds_read_u16 v167, v167
v_lshrrev_b32_e64 v169, 18, v169
v_mfma_f32_32x32x16_bf16 v[128:143], v[88:91], v[184:187], v[128:143]
ds_read_u16 v168, v168
ds_read_u16 v169, v169
v_exp_f16_sdwa v175, v175 dst_sel:WORD_1 dst_unused:UNUSED_PRESERVE src0_sel:WORD_1
v_cvt_pkrtz_f16_f32 v171, v170, v171
v_and_b32_e64 v171, s49, v171
v_bfe_u32 v170, v171, 2, 14
v_lshrrev_b32_e64 v171, 18, v171
v_pk_add_f16 v173, v173, 1.0 op_sel_hi:[1,0]
v_pk_add_f16 v175, v175, 1.0 op_sel_hi:[1,0]
ds_read_b128 v[180:183], v250 offset:13312
ds_read_u16 v170, v170
ds_read_u16 v171, v171
v_rcp_f16_sdwa v173, v173 dst_sel:WORD_0 dst_unused:UNUSED_PRESERVE src0_sel:WORD_0
v_mfma_f32_32x32x16_bf16 v[112:127], v[68:71], v[188:191], v[112:127]
v_rcp_f16_sdwa v175, v175 dst_sel:WORD_0 dst_unused:UNUSED_PRESERVE src0_sel:WORD_0
v_rcp_f16_sdwa v173, v173 dst_sel:WORD_1 dst_unused:UNUSED_PRESERVE src0_sel:WORD_1
v_rcp_f16_sdwa v175, v175 dst_sel:WORD_1 dst_unused:UNUSED_PRESERVE src0_sel:WORD_1
v_mfma_f32_32x32x16_bf16 v[128:143], v[92:95], v[188:191], v[128:143]
ds_read_b128 v[184:187], v250 offset:14336
v_pk_mul_f16 v172, v172, v173
v_pk_mul_f16 v174, v174, v175
v_fma_mix_f32 v224, v172, v172, v224 op_sel_hi:[1,1,0]
s_nop 3
v_cvt_pkrtz_f16_f32 v113, v112, v113
v_fma_mix_f32 v224, v174, v174, v224 op_sel_hi:[1,1,0]
s_waitcnt lgkmcnt(7)
v_mfma_f32_32x32x16_bf16 v[96:111], v[48:51], v[176:179], 0
v_fma_mix_f32 v224, v172, v172, v224 op_sel:[1,1,0] op_sel_hi:[1,1,0]
v_and_b32_e64 v113, s49, v113
v_fma_mix_f32 v224, v174, v174, v224 op_sel:[1,1,0] op_sel_hi:[1,1,0]
v_bfe_u32 v112, v113, 2, 14
v_fma_mix_f32 v224, v160, v160, v224 op_sel_hi:[1,1,0]
v_lshrrev_b32_e64 v113, 18, v113
v_fma_mix_f32 v224, v161, v161, v224 op_sel_hi:[1,1,0]
v_cvt_pk_f16_f32 v124, v124, v125
v_fma_mix_f32 v224, v162, v162, v224 op_sel_hi:[1,1,0]
v_cvt_pk_f16_f32 v126, v126, v127
v_fma_mix_f32 v224, v163, v163, v224 op_sel_hi:[1,1,0]
v_mfma_f32_32x32x16_bf16 v[144:159], v[176:179], v[72:75], 0
ds_read_u16 v112, v112
ds_read_u16 v113, v113
v_pk_fma_f16 v125, v124, v124, s48
v_fma_mix_f32 v224, v164, v164, v224 op_sel_hi:[1,1,0]
v_cvt_pkrtz_f16_f32 v115, v114, v115
v_fma_mix_f32 v224, v165, v165, v224 op_sel_hi:[1,1,0]
v_and_b32_e64 v115, s49, v115
v_bfe_u32 v114, v115, 2, 14
v_lshrrev_b32_e64 v115, 18, v115
v_pk_fma_f16 v127, v126, v126, s48
v_pk_mul_f16 v125, v124, v125
v_pk_mul_f16 v127, v126, v127
v_fma_mix_f32 v224, v166, v166, v224 op_sel_hi:[1,1,0]
v_cvt_pkrtz_f16_f32 v117, v116, v117
s_waitcnt lgkmcnt(3)
v_fma_mix_f32 v224, v167, v167, v224 op_sel_hi:[1,1,0]
ds_read_u16 v114, v114
ds_read_u16 v115, v115
ds_read_b128 v[188:191], v250 offset:15360
v_and_b32 v117, s49, v117
v_bfe_u32 v116, v117, 2, 14
v_lshrrev_b32_e64 v117, 18, v117
v_exp_f16_sdwa v125, v125 dst_sel:WORD_0 dst_unused:UNUSED_PRESERVE src0_sel:WORD_0
v_mfma_f32_32x32x16_bf16 v[96:111], v[52:55], v[180:183], v[96:111]
ds_read_u16 v116, v116
ds_read_u16 v117, v117
v_fma_mix_f32 v224, v168, v168, v224 op_sel_hi:[1,1,0]
v_exp_f16_sdwa v127, v127 dst_sel:WORD_0 dst_unused:UNUSED_PRESERVE src0_sel:WORD_0
v_fma_mix_f32 v224, v169, v169, v224 op_sel_hi:[1,1,0]
v_cvt_pkrtz_f16_f32 v119, v118, v119
v_and_b32_e64 v119, s49, v119
v_bfe_u32 v118, v119, 2, 14
v_lshrrev_b32_e64 v119, 18, v119
v_exp_f16_sdwa v125, v125 dst_sel:WORD_1 dst_unused:UNUSED_PRESERVE src0_sel:WORD_1
v_fma_mix_f32 v224, v170, v170, v224 op_sel_hi:[1,1,0]
v_cvt_pkrtz_f16_f32 v121, v120, v121
v_fma_mix_f32 v224, v171, v171, v224 op_sel_hi:[1,1,0]
v_and_b32_e64 v121, s49, v121
v_bfe_u32 v120, v121, 2, 14
ds_read_u16 v118, v118
ds_read_u16 v119, v119
v_lshrrev_b32_e64 v121, 18, v121
v_mfma_f32_32x32x16_bf16 v[144:159], v[180:183], v[76:79], v[144:159]
ds_read_u16 v120, v120
ds_read_u16 v121, v121
v_exp_f16_sdwa v127, v127 dst_sel:WORD_1 dst_unused:UNUSED_PRESERVE src0_sel:WORD_1
v_cvt_pkrtz_f16_f32 v123, v122, v123
v_and_b32_e64 v123, s49, v123
v_bfe_u32 v122, v123, 2, 14
v_lshrrev_b32 v123, 18, v123
v_pk_add_f16 v125, v125, 1.0 op_sel_hi:[1,0]
v_pk_add_f16 v127, v127, 1.0 op_sel_hi:[1,0]
ds_read_b128 v[176:179], v250 offset:16384
ds_read_u16 v122, v122
ds_read_u16 v123, v123
v_rcp_f16_sdwa v125, v125 dst_sel:WORD_0 dst_unused:UNUSED_PRESERVE src0_sel:WORD_0
s_waitcnt lgkmcnt(9)
v_mfma_f32_32x32x16_bf16 v[96:111], v[56:59], v[184:187], v[96:111]
v_rcp_f16_sdwa v127, v127 dst_sel:WORD_0 dst_unused:UNUSED_PRESERVE src0_sel:WORD_0
v_rcp_f16_sdwa v125, v125 dst_sel:WORD_1 dst_unused:UNUSED_PRESERVE src0_sel:WORD_1
v_rcp_f16_sdwa v127, v127 dst_sel:WORD_1 dst_unused:UNUSED_PRESERVE src0_sel:WORD_1
v_mfma_f32_32x32x16_bf16 v[144:159], v[184:187], v[80:83], v[144:159]
ds_read_b128 v[180:183], v250 offset:17408
v_pk_mul_f16 v124, v124, v125
v_pk_mul_f16 v126, v126, v127
v_fma_mix_f32 v225, v124, v124, v225 op_sel_hi:[1,1,0]
v_cvt_pkrtz_f16_f32 v129, v128, v129
v_fma_mix_f32 v225, v126, v126, v225 op_sel_hi:[1,1,0]
v_mfma_f32_32x32x16_bf16 v[96:111], v[60:63], v[188:191], v[96:111]
v_fma_mix_f32 v225, v124, v124, v225 op_sel:[1,1,0] op_sel_hi:[1,1,0]
v_and_b32_e64 v129, s49, v129
v_fma_mix_f32 v225, v126, v126, v225 op_sel:[1,1,0] op_sel_hi:[1,1,0]
v_bfe_u32 v128, v129, 2, 14
v_fma_mix_f32 v225, v112, v112, v225 op_sel_hi:[1,1,0]
v_lshrrev_b32_e64 v129, 18, v129
v_fma_mix_f32 v225, v113, v113, v225 op_sel_hi:[1,1,0]
v_cvt_pk_f16_f32 v140, v140, v141
v_fma_mix_f32 v225, v114, v114, v225 op_sel_hi:[1,1,0]
v_cvt_pk_f16_f32 v142, v142, v143
v_fma_mix_f32 v225, v115, v115, v225 op_sel_hi:[1,1,0]
v_mfma_f32_32x32x16_bf16 v[144:159], v[188:191], v[84:87], v[144:159]
ds_read_u16 v128, v128
ds_read_u16 v129, v129
v_pk_fma_f16 v141, v140, v140, s48
s_waitcnt lgkmcnt(5)
v_fma_mix_f32 v225, v116, v116, v225 op_sel_hi:[1,1,0]
v_cvt_pkrtz_f16_f32 v131, v130, v131
v_fma_mix_f32 v225, v117, v117, v225 op_sel_hi:[1,1,0]
v_and_b32 v131, s49, v131
v_bfe_u32 v130, v131, 2, 14
v_lshrrev_b32_e64 v131, 18, v131
v_pk_fma_f16 v143, v142, v142, s48
v_pk_mul_f16 v141, v140, v141
v_pk_mul_f16 v143, v142, v143
v_fma_mix_f32 v225, v118, v118, v225 op_sel_hi:[1,1,0]
v_cvt_pkrtz_f16_f32 v133, v132, v133
v_fma_mix_f32 v225, v119, v119, v225 op_sel_hi:[1,1,0]
ds_read_u16 v130, v130
ds_read_u16 v131, v131
ds_read_b128 v[184:187], v250 offset:18432
v_and_b32_e64 v133, s49, v133
v_bfe_u32 v132, v133, 2, 14
v_lshrrev_b32_e64 v133, 18, v133
v_exp_f16_sdwa v141, v141 dst_sel:WORD_0 dst_unused:UNUSED_PRESERVE src0_sel:WORD_0
v_mfma_f32_32x32x16_bf16 v[96:111], v[64:67], v[176:179], v[96:111]
ds_read_u16 v132, v132
ds_read_u16 v133, v133
v_fma_mix_f32 v225, v120, v120, v225 op_sel_hi:[1,1,0]
v_exp_f16_sdwa v143, v143 dst_sel:WORD_0 dst_unused:UNUSED_PRESERVE src0_sel:WORD_0
v_fma_mix_f32 v225, v121, v121, v225 op_sel_hi:[1,1,0]
v_cvt_pkrtz_f16_f32 v135, v134, v135
v_and_b32_e64 v135, s49, v135
v_bfe_u32 v134, v135, 2, 14
v_lshrrev_b32 v135, 18, v135
v_exp_f16_sdwa v141, v141 dst_sel:WORD_1 dst_unused:UNUSED_PRESERVE src0_sel:WORD_1
s_waitcnt lgkmcnt(5)
v_fma_mix_f32 v225, v122, v122, v225 op_sel_hi:[1,1,0]
v_cvt_pkrtz_f16_f32 v137, v136, v137
v_fma_mix_f32 v225, v123, v123, v225 op_sel_hi:[1,1,0]
v_and_b32_e64 v137, s49, v137
v_bfe_u32 v136, v137, 2, 14
ds_read_u16 v134, v134
ds_read_u16 v135, v135
v_lshrrev_b32_e64 v137, 18, v137
v_mfma_f32_32x32x16_bf16 v[144:159], v[176:179], v[88:91], v[144:159]
ds_read_u16 v136, v136
ds_read_u16 v137, v137
v_exp_f16_sdwa v143, v143 dst_sel:WORD_1 dst_unused:UNUSED_PRESERVE src0_sel:WORD_1
v_cvt_pkrtz_f16_f32 v139, v138, v139
v_and_b32_e64 v139, s49, v139
v_bfe_u32 v138, v139, 2, 14
v_lshrrev_b32_e64 v139, 18, v139
v_pk_add_f16 v141, v141, 1.0 op_sel_hi:[1,0]
v_pk_add_f16 v143, v143, 1.0 op_sel_hi:[1,0]
ds_read_b128 v[188:191], v250 offset:19456
ds_read_u16 v138, v138
ds_read_u16 v139, v139
v_rcp_f16_sdwa v141, v141 dst_sel:WORD_0 dst_unused:UNUSED_PRESERVE src0_sel:WORD_0
v_mfma_f32_32x32x16_bf16 v[96:111], v[68:71], v[180:183], v[96:111]
v_rcp_f16_sdwa v143, v143 dst_sel:WORD_0 dst_unused:UNUSED_PRESERVE src0_sel:WORD_0
v_rcp_f16_sdwa v141, v141 dst_sel:WORD_1 dst_unused:UNUSED_PRESERVE src0_sel:WORD_1
v_rcp_f16_sdwa v143, v143 dst_sel:WORD_1 dst_unused:UNUSED_PRESERVE src0_sel:WORD_1
v_mfma_f32_32x32x16_bf16 v[144:159], v[180:183], v[92:95], v[144:159]
ds_read_b128 v[176:179], v250 offset:20480
v_pk_mul_f16 v140, v140, v141
v_pk_mul_f16 v142, v142, v143
v_fma_mix_f32 v225, v140, v140, v225 op_sel_hi:[1,1,0]
s_nop 3
v_cvt_pkrtz_f16_f32 v97, v96, v97
v_fma_mix_f32 v225, v142, v142, v225 op_sel_hi:[1,1,0]
s_waitcnt lgkmcnt(7)
v_mfma_f32_32x32x16_bf16 v[160:175], v[48:51], v[184:187], 0
v_fma_mix_f32 v225, v140, v140, v225 op_sel:[1,1,0] op_sel_hi:[1,1,0]
v_and_b32_e64 v97, s49, v97
v_fma_mix_f32 v225, v142, v142, v225 op_sel:[1,1,0] op_sel_hi:[1,1,0]
v_bfe_u32 v96, v97, 2, 14
v_fma_mix_f32 v225, v128, v128, v225 op_sel_hi:[1,1,0]
v_lshrrev_b32_e64 v97, 18, v97
v_fma_mix_f32 v225, v129, v129, v225 op_sel_hi:[1,1,0]
v_cvt_pk_f16_f32 v108, v108, v109
v_fma_mix_f32 v225, v130, v130, v225 op_sel_hi:[1,1,0]
v_cvt_pk_f16_f32 v110, v110, v111
v_fma_mix_f32 v225, v131, v131, v225 op_sel_hi:[1,1,0]
v_mfma_f32_32x32x16_bf16 v[112:127], v[184:187], v[72:75], 0
ds_read_u16 v96, v96
ds_read_u16 v97, v97
v_pk_fma_f16 v109, v108, v108, s48
v_fma_mix_f32 v225, v132, v132, v225 op_sel_hi:[1,1,0]
v_cvt_pkrtz_f16_f32 v99, v98, v99
v_fma_mix_f32 v225, v133, v133, v225 op_sel_hi:[1,1,0]
v_and_b32_e64 v99, s49, v99
v_bfe_u32 v98, v99, 2, 14
v_lshrrev_b32_e64 v99, 18, v99
v_pk_fma_f16 v111, v110, v110, s48
v_pk_mul_f16 v109, v108, v109
v_pk_mul_f16 v111, v110, v111
v_fma_mix_f32 v225, v134, v134, v225 op_sel_hi:[1,1,0]
v_cvt_pkrtz_f16_f32 v101, v100, v101
s_waitcnt lgkmcnt(3)
v_fma_mix_f32 v225, v135, v135, v225 op_sel_hi:[1,1,0]
ds_read_u16 v98, v98
ds_read_u16 v99, v99
ds_read_b128 v[180:183], v250 offset:21504
v_and_b32 v101, s49, v101
v_bfe_u32 v100, v101, 2, 14
v_lshrrev_b32_e64 v101, 18, v101
v_exp_f16_sdwa v109, v109 dst_sel:WORD_0 dst_unused:UNUSED_PRESERVE src0_sel:WORD_0
v_mfma_f32_32x32x16_bf16 v[160:175], v[52:55], v[188:191], v[160:175]
ds_read_u16 v100, v100
ds_read_u16 v101, v101
v_fma_mix_f32 v225, v136, v136, v225 op_sel_hi:[1,1,0]
v_exp_f16_sdwa v111, v111 dst_sel:WORD_0 dst_unused:UNUSED_PRESERVE src0_sel:WORD_0
v_fma_mix_f32 v225, v137, v137, v225 op_sel_hi:[1,1,0]
v_cvt_pkrtz_f16_f32 v103, v102, v103
v_and_b32_e64 v103, s49, v103
v_bfe_u32 v102, v103, 2, 14
v_lshrrev_b32_e64 v103, 18, v103
v_exp_f16_sdwa v109, v109 dst_sel:WORD_1 dst_unused:UNUSED_PRESERVE src0_sel:WORD_1
v_fma_mix_f32 v225, v138, v138, v225 op_sel_hi:[1,1,0]
v_cvt_pkrtz_f16_f32 v105, v104, v105
v_fma_mix_f32 v225, v139, v139, v225 op_sel_hi:[1,1,0]
v_and_b32_e64 v105, s49, v105
v_bfe_u32 v104, v105, 2, 14
ds_read_u16 v102, v102
ds_read_u16 v103, v103
v_lshrrev_b32_e64 v105, 18, v105
v_mfma_f32_32x32x16_bf16 v[112:127], v[188:191], v[76:79], v[112:127]
ds_read_u16 v104, v104
ds_read_u16 v105, v105
v_exp_f16_sdwa v111, v111 dst_sel:WORD_1 dst_unused:UNUSED_PRESERVE src0_sel:WORD_1
v_cvt_pkrtz_f16_f32 v107, v106, v107
v_and_b32_e64 v107, s49, v107
v_bfe_u32 v106, v107, 2, 14
v_lshrrev_b32 v107, 18, v107
v_pk_add_f16 v109, v109, 1.0 op_sel_hi:[1,0]
v_pk_add_f16 v111, v111, 1.0 op_sel_hi:[1,0]
ds_read_b128 v[184:187], v250 offset:22528
ds_read_u16 v106, v106
ds_read_u16 v107, v107
v_rcp_f16_sdwa v109, v109 dst_sel:WORD_0 dst_unused:UNUSED_PRESERVE src0_sel:WORD_0
s_waitcnt lgkmcnt(9)
v_mfma_f32_32x32x16_bf16 v[160:175], v[56:59], v[176:179], v[160:175]
v_rcp_f16_sdwa v111, v111 dst_sel:WORD_0 dst_unused:UNUSED_PRESERVE src0_sel:WORD_0
v_rcp_f16_sdwa v109, v109 dst_sel:WORD_1 dst_unused:UNUSED_PRESERVE src0_sel:WORD_1
v_rcp_f16_sdwa v111, v111 dst_sel:WORD_1 dst_unused:UNUSED_PRESERVE src0_sel:WORD_1
v_mfma_f32_32x32x16_bf16 v[112:127], v[176:179], v[80:83], v[112:127]
ds_read_b128 v[188:191], v250 offset:23552
v_pk_mul_f16 v108, v108, v109
v_pk_mul_f16 v110, v110, v111
v_fma_mix_f32 v226, v108, v108, v226 op_sel_hi:[1,1,0]
v_cvt_pkrtz_f16_f32 v145, v144, v145
v_fma_mix_f32 v226, v110, v110, v226 op_sel_hi:[1,1,0]
v_mfma_f32_32x32x16_bf16 v[160:175], v[60:63], v[180:183], v[160:175]
v_fma_mix_f32 v226, v108, v108, v226 op_sel:[1,1,0] op_sel_hi:[1,1,0]
v_and_b32_e64 v145, s49, v145
v_fma_mix_f32 v226, v110, v110, v226 op_sel:[1,1,0] op_sel_hi:[1,1,0]
v_bfe_u32 v144, v145, 2, 14
v_fma_mix_f32 v226, v96, v96, v226 op_sel_hi:[1,1,0]
v_lshrrev_b32_e64 v145, 18, v145
v_fma_mix_f32 v226, v97, v97, v226 op_sel_hi:[1,1,0]
v_cvt_pk_f16_f32 v156, v156, v157
v_fma_mix_f32 v226, v98, v98, v226 op_sel_hi:[1,1,0]
v_cvt_pk_f16_f32 v158, v158, v159
v_fma_mix_f32 v226, v99, v99, v226 op_sel_hi:[1,1,0]
v_mfma_f32_32x32x16_bf16 v[112:127], v[180:183], v[84:87], v[112:127]
ds_read_u16 v144, v144
ds_read_u16_d16_hi v145, v145
v_pk_fma_f16 v157, v156, v156, s48
s_waitcnt lgkmcnt(5)
v_fma_mix_f32 v226, v100, v100, v226 op_sel_hi:[1,1,0]
v_cvt_pkrtz_f16_f32 v147, v146, v147
v_fma_mix_f32 v226, v101, v101, v226 op_sel_hi:[1,1,0]
v_and_b32 v147, s49, v147
v_bfe_u32 v146, v147, 2, 14
v_lshrrev_b32_e64 v147, 18, v147
v_pk_fma_f16 v159, v158, v158, s48
v_pk_mul_f16 v157, v156, v157
v_fma_mix_f32 v226, v102, v102, v226 op_sel_hi:[1,1,0]
v_cvt_pkrtz_f16_f32 v149, v148, v149
v_fma_mix_f32 v226, v103, v103, v226 op_sel_hi:[1,1,0]
v_and_b32_e64 v149, s49, v149
ds_read_u16 v146, v146
ds_read_u16_d16_hi v147, v147
ds_read_b128 v[176:179], v250 offset:24576
v_bfe_u32 v148, v149, 2, 14
v_lshrrev_b32_e64 v149, 18, v149
v_pk_mul_f16 v159, v158, v159
v_exp_f16_sdwa v157, v157 dst_sel:WORD_0 dst_unused:UNUSED_PRESERVE src0_sel:WORD_0
v_mfma_f32_32x32x16_bf16 v[160:175], v[64:67], v[184:187], v[160:175]
ds_read_u16 v148, v148
ds_read_u16_d16_hi v149, v149
v_fma_mix_f32 v226, v104, v104, v226 op_sel_hi:[1,1,0]
v_cvt_pkrtz_f16_f32 v151, v150, v151
v_fma_mix_f32 v226, v105, v105, v226 op_sel_hi:[1,1,0]
v_and_b32_e64 v151, s49, v151
v_bfe_u32 v150, v151, 2, 14
v_lshrrev_b32 v151, 18, v151
v_exp_f16_sdwa v159, v159 dst_sel:WORD_0 dst_unused:UNUSED_PRESERVE src0_sel:WORD_0
s_waitcnt lgkmcnt(6)
v_fma_mix_f32 v226, v106, v106, v226 op_sel_hi:[1,1,0]
v_cvt_pkrtz_f16_f32 v153, v152, v153
v_fma_mix_f32 v226, v107, v107, v226 op_sel_hi:[1,1,0]
v_and_b32_e64 v153, s49, v153
v_bfe_u32 v152, v153, 2, 14
ds_read_u16 v150, v150
ds_read_u16_d16_hi v151, v151
v_lshrrev_b32_e64 v153, 18, v153
v_exp_f16_sdwa v157, v157 dst_sel:WORD_1 dst_unused:UNUSED_PRESERVE src0_sel:WORD_1
v_mfma_f32_32x32x16_bf16 v[112:127], v[184:187], v[88:91], v[112:127]
ds_read_u16 v152, v152
ds_read_u16_d16_hi v153, v153
ds_read_b128 v[180:183], v250 offset:25600
v_cvt_pkrtz_f16_f32 v155, v154, v155
v_and_b32_e64 v155, s49, v155
v_bfe_u32 v154, v155, 2, 14
v_lshrrev_b32_e64 v155, 18, v155
v_exp_f16_sdwa v159, v159 dst_sel:WORD_1 dst_unused:UNUSED_PRESERVE src0_sel:WORD_1
v_pk_add_f16 v157, v157, 1.0 op_sel_hi:[1,0]
v_mfma_f32_32x32x16_bf16 v[160:175], v[68:71], v[188:191], v[160:175]
ds_read_u16 v154, v154
ds_read_u16_d16_hi v155, v155
v_pk_add_f16 v159, v159, 1.0 op_sel_hi:[1,0]
v_rcp_f16_sdwa v157, v157 dst_sel:WORD_0 dst_unused:UNUSED_PRESERVE src0_sel:WORD_0
v_rcp_f16_sdwa v159, v159 dst_sel:WORD_0 dst_unused:UNUSED_PRESERVE src0_sel:WORD_0
v_mfma_f32_32x32x16_bf16 v[112:127], v[188:191], v[92:95], v[112:127]
ds_read_b128 v[184:187], v250 offset:26624
v_rcp_f16_sdwa v157, v157 dst_sel:WORD_1 dst_unused:UNUSED_PRESERVE src0_sel:WORD_1
v_rcp_f16_sdwa v159, v159 dst_sel:WORD_1 dst_unused:UNUSED_PRESERVE src0_sel:WORD_1
s_waitcnt lgkmcnt(8)
v_or_b32 v0, v144, v145
v_mfma_f32_32x32x16_bf16 v[128:143], v[48:51], v[176:179], 0
v_pk_mul_f16 v6, v156, v157
v_pk_mul_f16 v7, v158, v159
v_or_b32_e64 v1, v146, v147
v_cvt_pkrtz_f16_f32 v161, v160, v161
v_and_b32_e64 v161, s49, v161
v_bfe_u32 v160, v161, 2, 14
v_lshrrev_b32_e64 v161, 18, v161
v_cvt_pk_f16_f32 v172, v172, v173
v_cvt_pk_f16_f32 v174, v174, v175
v_mfma_f32_32x32x16_bf16 v[96:111], v[176:179], v[72:75], 0
ds_read_u16 v160, v160
ds_read_u16 v161, v161
v_pk_fma_f16 v173, v172, v172, s48
v_or_b32_e64 v4, v148, v149
v_cvt_pkrtz_f16_f32 v163, v162, v163
v_and_b32_e64 v163, s49, v163
v_bfe_u32 v162, v163, 2, 14
v_lshrrev_b32_e64 v163, 18, v163
v_pk_fma_f16 v175, v174, v174, s48
v_pk_mul_f16 v173, v172, v173
v_pk_mul_f16 v175, v174, v175
s_waitcnt lgkmcnt(5)
v_or_b32 v5, v150, v151
v_cvt_pkrtz_f16_f32 v165, v164, v165
v_and_b32_e64 v165, s49, v165
ds_read_u16 v162, v162
ds_read_u16 v163, v163
ds_read_b128 v[188:191], v250 offset:27648
v_bfe_u32 v164, v165, 2, 14
v_lshrrev_b32_e64 v165, 18, v165
v_exp_f16_sdwa v173, v173 dst_sel:WORD_0 dst_unused:UNUSED_PRESERVE src0_sel:WORD_0
v_mfma_f32_32x32x16_bf16 v[128:143], v[52:55], v[180:183], v[128:143]
ds_read_u16 v164, v164
ds_read_u16 v165, v165
v_or_b32_e64 v2, v152, v153
v_exp_f16_sdwa v175, v175 dst_sel:WORD_0 dst_unused:UNUSED_PRESERVE src0_sel:WORD_0
v_cvt_pkrtz_f16_f32 v167, v166, v167
v_and_b32_e64 v167, s49, v167
v_bfe_u32 v166, v167, 2, 14
v_lshrrev_b32_e64 v167, 18, v167
v_exp_f16_sdwa v173, v173 dst_sel:WORD_1 dst_unused:UNUSED_PRESERVE src0_sel:WORD_1
s_waitcnt lgkmcnt(6)
v_or_b32 v3, v154, v155
v_cvt_pkrtz_f16_f32 v169, v168, v169
v_and_b32_e64 v169, s49, v169
v_bfe_u32 v168, v169, 2, 14
v_lshrrev_b32_e64 v169, 18, v169
ds_read_u16 v166, v166
ds_read_u16 v167, v167
ds_read_u16 v168, v168
ds_read_u16 v169, v169
v_mfma_f32_32x32x16_bf16 v[96:111], v[180:183], v[76:79], v[96:111]
v_exp_f16_sdwa v175, v175 dst_sel:WORD_1 dst_unused:UNUSED_PRESERVE src0_sel:WORD_1
v_cvt_pkrtz_f16_f32 v171, v170, v171
v_and_b32_e64 v171, s49, v171
v_bfe_u32 v170, v171, 2, 14
v_mfma_f32_32x32x16_f16 v[144:159], v[0:3], v[216:219], 0
ds_read_b128 v[176:179], v250 offset:28672
v_lshrrev_b32_e64 v171, 18, v171
v_pk_add_f16 v173, v173, 1.0 op_sel_hi:[1,0]
v_pk_add_f16 v175, v175, 1.0 op_sel_hi:[1,0]
v_rcp_f16_sdwa v173, v173 dst_sel:WORD_0 dst_unused:UNUSED_PRESERVE src0_sel:WORD_0
v_mfma_f32_32x32x16_f16 v[144:159], v[4:7], v[220:223], v[144:159]
ds_read_u16 v170, v170
ds_read_u16 v171, v171
v_permlane16_swap_b32 v0, v4
v_permlane16_swap_b32 v1, v5
v_permlane16_swap_b32 v2, v6
v_permlane16_swap_b32 v3, v7
v_mfma_f32_32x32x16_bf16 v[128:143], v[56:59], v[184:187], v[128:143]
v_rcp_f16_sdwa v175, v175 dst_sel:WORD_0 dst_unused:UNUSED_PRESERVE src0_sel:WORD_0
v_rcp_f16_sdwa v173, v173 dst_sel:WORD_1 dst_unused:UNUSED_PRESERVE src0_sel:WORD_1
v_rcp_f16_sdwa v175, v175 dst_sel:WORD_1 dst_unused:UNUSED_PRESERVE src0_sel:WORD_1
v_mfma_f32_32x32x16_bf16 v[96:111], v[184:187], v[80:83], v[96:111]
ds_read_b128 v[180:183], v250 offset:29696
v_fmac_f32_e64 v226, v144, v144
v_pk_mul_f16 v172, v172, v173
v_fmac_f32_e64 v226, v145, v145
v_pk_mul_f16 v174, v174, v175
v_fmac_f32 v226, v146, v146
v_fmac_f32 v226, v147, v147
v_fma_mix_f32 v227, v172, v172, v227 op_sel_hi:[1,1,0]
v_fmac_f32 v226, v148, v148
v_fmac_f32 v226, v149, v149
v_fma_mix_f32 v227, v174, v174, v227 op_sel_hi:[1,1,0]
s_waitcnt lgkmcnt(5)
v_mfma_f32_32x32x16_bf16 v[128:143], v[60:63], v[188:191], v[128:143]
v_fmac_f32 v226, v150, v150
v_fma_mix_f32 v227, v172, v172, v227 op_sel:[1,1,0] op_sel_hi:[1,1,0]
v_fmac_f32 v226, v151, v151
v_fmac_f32 v226, v152, v152
v_fma_mix_f32 v227, v174, v174, v227 op_sel:[1,1,0] op_sel_hi:[1,1,0]
v_fmac_f32_e64 v226, v153, v153
v_fma_mix_f32 v227, v160, v160, v227 op_sel_hi:[1,1,0]
v_fmac_f32_e64 v226, v154, v154
v_fma_mix_f32 v227, v161, v161, v227 op_sel_hi:[1,1,0]
v_cvt_pkrtz_f16_f32 v113, v112, v113
v_fma_mix_f32 v227, v162, v162, v227 op_sel_hi:[1,1,0]
v_and_b32_e64 v113, s49, v113
v_fma_mix_f32 v227, v163, v163, v227 op_sel_hi:[1,1,0]
v_bfe_u32 v112, v113, 2, 14
v_lshrrev_b32_e64 v113, 18, v113
v_cvt_pk_f16_f32 v124, v124, v125
v_fmac_f32_e64 v226, v155, v155
v_cvt_pk_f16_f32 v126, v126, v127
v_fmac_f32 v226, v156, v156
v_fmac_f32 v226, v157, v157
v_mfma_f32_32x32x16_bf16 v[96:111], v[188:191], v[84:87], v[96:111]
ds_read_u16 v112, v112
ds_read_u16_d16_hi v113, v113
v_pk_fma_f16 v125, v124, v124, s48
v_fmac_f32_e64 v226, v158, v158
v_fma_mix_f32 v227, v164, v164, v227 op_sel_hi:[1,1,0]
v_cvt_pkrtz_f16_f32 v115, v114, v115
v_fma_mix_f32 v227, v165, v165, v227 op_sel_hi:[1,1,0]
v_and_b32_e64 v115, s49, v115
v_bfe_u32 v114, v115, 2, 14
v_lshrrev_b32 v115, 18, v115
v_fmac_f32 v226, v159, v159
v_pk_fma_f16 v127, v126, v126, s48
v_pk_mul_f16 v125, v124, v125
v_fma_mix_f32 v227, v166, v166, v227 op_sel_hi:[1,1,0]
v_cvt_pkrtz_f16_f32 v117, v116, v117
v_fma_mix_f32 v227, v167, v167, v227 op_sel_hi:[1,1,0]
ds_read_u16 v114, v114
ds_read_u16_d16_hi v115, v115
ds_read_b128 v[184:187], v250 offset:30720
v_and_b32_e64 v117, s49, v117
v_bfe_u32 v116, v117, 2, 14
v_lshrrev_b32 v117, 18, v117
v_pk_mul_f16 v127, v126, v127
v_exp_f16_sdwa v125, v125 dst_sel:WORD_0 dst_unused:UNUSED_PRESERVE src0_sel:WORD_0
s_waitcnt lgkmcnt(5)
v_mfma_f32_32x32x16_bf16 v[128:143], v[64:67], v[176:179], v[128:143]
ds_read_u16 v116, v116
ds_read_u16_d16_hi v117, v117
v_fma_mix_f32 v227, v168, v168, v227 op_sel_hi:[1,1,0]
v_cvt_pkrtz_f16_f32 v119, v118, v119
v_fma_mix_f32 v227, v169, v169, v227 op_sel_hi:[1,1,0]
v_and_b32_e64 v119, s49, v119
v_bfe_u32 v118, v119, 2, 14
v_lshrrev_b32_e64 v119, 18, v119
v_exp_f16_sdwa v127, v127 dst_sel:WORD_0 dst_unused:UNUSED_PRESERVE src0_sel:WORD_0
v_fma_mix_f32 v227, v170, v170, v227 op_sel_hi:[1,1,0]
v_cvt_pkrtz_f16_f32 v121, v120, v121
v_fma_mix_f32 v227, v171, v171, v227 op_sel_hi:[1,1,0]
v_and_b32_e64 v121, s49, v121
v_bfe_u32 v120, v121, 2, 14
ds_read_u16 v118, v118
ds_read_u16_d16_hi v119, v119
v_lshrrev_b32_e64 v121, 18, v121
v_exp_f16_sdwa v125, v125 dst_sel:WORD_1 dst_unused:UNUSED_PRESERVE src0_sel:WORD_1
v_mfma_f32_32x32x16_bf16 v[96:111], v[176:179], v[88:91], v[96:111]
ds_read_u16 v120, v120
ds_read_u16_d16_hi v121, v121
ds_read_b128 v[188:191], v250 offset:31744
v_cvt_pkrtz_f16_f32 v123, v122, v123
v_and_b32_e64 v123, s49, v123
v_bfe_u32 v122, v123, 2, 14
v_lshrrev_b32_e64 v123, 18, v123
v_exp_f16_sdwa v127, v127 dst_sel:WORD_1 dst_unused:UNUSED_PRESERVE src0_sel:WORD_1
v_pk_add_f16 v125, v125, 1.0 op_sel_hi:[1,0]
v_mfma_f32_32x32x16_bf16 v[128:143], v[68:71], v[180:183], v[128:143]
ds_read_u16 v122, v122
ds_read_u16_d16_hi v123, v123
v_pk_add_f16 v127, v127, 1.0 op_sel_hi:[1,0]
v_rcp_f16_sdwa v125, v125 dst_sel:WORD_0 dst_unused:UNUSED_PRESERVE src0_sel:WORD_0
v_rcp_f16_sdwa v127, v127 dst_sel:WORD_0 dst_unused:UNUSED_PRESERVE src0_sel:WORD_0
v_mfma_f32_32x32x16_bf16 v[96:111], v[180:183], v[92:95], v[96:111]
ds_read_b128 v[176:179], v250 offset:32768
v_rcp_f16_sdwa v125, v125 dst_sel:WORD_1 dst_unused:UNUSED_PRESERVE src0_sel:WORD_1
v_rcp_f16_sdwa v127, v127 dst_sel:WORD_1 dst_unused:UNUSED_PRESERVE src0_sel:WORD_1
s_waitcnt lgkmcnt(7)
v_or_b32 v8, v112, v113
v_mfma_f32_32x32x16_bf16 v[144:159], v[48:51], v[184:187], 0
s_cmp_lg_u32 s40, 0
s_cbranch_scc1 Lpix
v_mov_b32_e64 v244, 0
Lpi:
buffer_load_dword v245, v244, s[36:39], 0 offen sc1
s_waitcnt vmcnt(0)
v_readfirstlane_b32 s43, v245
s_cmp_eq_u32 s76, 0
s_cbranch_scc1 Lpix
s_sub_u32 s76, s76, 1
s_cmp_lt_u32 s43, 256
s_cbranch_scc1 Lpi
Lpix:
v_pk_mul_f16 v14, v124, v125
v_pk_mul_f16 v15, v126, v127
v_or_b32_e64 v9, v114, v115
v_cvt_pkrtz_f16_f32 v129, v128, v129
v_and_b32_e64 v129, s49, v129
v_bfe_u32 v128, v129, 2, 14
v_lshrrev_b32_e64 v129, 18, v129
v_cvt_pk_f16_f32 v140, v140, v141
v_cvt_pk_f16_f32 v142, v142, v143
v_mfma_f32_32x32x16_bf16 v[160:175], v[184:187], v[72:75], 0
ds_read_u16 v128, v128
ds_read_u16 v129, v129
v_pk_fma_f16 v141, v140, v140, s48
v_or_b32_e64 v12, v116, v117
v_cvt_pkrtz_f16_f32 v131, v130, v131
v_and_b32_e64 v131, s49, v131
v_bfe_u32 v130, v131, 2, 14
v_lshrrev_b32_e64 v131, 18, v131
v_pk_fma_f16 v143, v142, v142, s48
v_pk_mul_f16 v141, v140, v141
v_pk_mul_f16 v143, v142, v143
s_waitcnt lgkmcnt(5)
v_or_b32 v13, v118, v119
v_cvt_pkrtz_f16_f32 v133, v132, v133
v_and_b32_e64 v133, s49, v133
ds_read_u16 v130, v130
ds_read_u16 v131, v131
ds_read_b128 v[180:183], v250 offset:33792
v_bfe_u32 v132, v133, 2, 14
v_lshrrev_b32_e64 v133, 18, v133
v_exp_f16_sdwa v141, v141 dst_sel:WORD_0 dst_unused:UNUSED_PRESERVE src0_sel:WORD_0
v_mfma_f32_32x32x16_bf16 v[144:159], v[52:55], v[188:191], v[144:159]
ds_read_u16 v132, v132
ds_read_u16 v133, v133
v_or_b32_e64 v10, v120, v121
v_exp_f16_sdwa v143, v143 dst_sel:WORD_0 dst_unused:UNUSED_PRESERVE src0_sel:WORD_0
v_cvt_pkrtz_f16_f32 v135, v134, v135
v_and_b32_e64 v135, s49, v135
v_bfe_u32 v134, v135, 2, 14
v_lshrrev_b32_e64 v135, 18, v135
v_exp_f16_sdwa v141, v141 dst_sel:WORD_1 dst_unused:UNUSED_PRESERVE src0_sel:WORD_1
s_waitcnt lgkmcnt(6)
v_or_b32 v11, v122, v123
v_cvt_pkrtz_f16_f32 v137, v136, v137
v_and_b32_e64 v137, s49, v137
v_bfe_u32 v136, v137, 2, 14
v_lshrrev_b32_e64 v137, 18, v137
ds_read_u16 v134, v134
ds_read_u16 v135, v135
ds_read_u16 v136, v136
ds_read_u16 v137, v137
v_mfma_f32_32x32x16_bf16 v[160:175], v[188:191], v[76:79], v[160:175]
v_exp_f16_sdwa v143, v143 dst_sel:WORD_1 dst_unused:UNUSED_PRESERVE src0_sel:WORD_1
v_cvt_pkrtz_f16_f32 v139, v138, v139
v_and_b32_e64 v139, s49, v139
v_bfe_u32 v138, v139, 2, 14
v_mfma_f32_32x32x16_f16 v[112:127], v[8:11], v[216:219], 0
ds_read_b128 v[184:187], v250 offset:34816
v_lshrrev_b32_e64 v139, 18, v139
v_pk_add_f16 v141, v141, 1.0 op_sel_hi:[1,0]
v_pk_add_f16 v143, v143, 1.0 op_sel_hi:[1,0]
v_rcp_f16_sdwa v141, v141 dst_sel:WORD_0 dst_unused:UNUSED_PRESERVE src0_sel:WORD_0
v_mfma_f32_32x32x16_f16 v[112:127], v[12:15], v[220:223], v[112:127]
ds_read_u16 v138, v138
ds_read_u16 v139, v139
v_permlane16_swap_b32 v8, v12
v_permlane16_swap_b32 v9, v13
v_permlane16_swap_b32 v10, v14
v_permlane16_swap_b32 v11, v15
v_mfma_f32_32x32x16_bf16 v[144:159], v[56:59], v[176:179], v[144:159]
v_rcp_f16_sdwa v143, v143 dst_sel:WORD_0 dst_unused:UNUSED_PRESERVE src0_sel:WORD_0
v_rcp_f16_sdwa v141, v141 dst_sel:WORD_1 dst_unused:UNUSED_PRESERVE src0_sel:WORD_1
v_rcp_f16_sdwa v143, v143 dst_sel:WORD_1 dst_unused:UNUSED_PRESERVE src0_sel:WORD_1
v_mfma_f32_32x32x16_bf16 v[160:175], v[176:179], v[80:83], v[160:175]
ds_read_b128 v[188:191], v250 offset:35840
v_fmac_f32_e64 v227, v112, v112
v_pk_mul_f16 v140, v140, v141
v_fmac_f32_e64 v227, v113, v113
v_pk_mul_f16 v142, v142, v143
v_fmac_f32 v227, v114, v114
v_fmac_f32 v227, v115, v115
v_fma_mix_f32 v228, v140, v140, v228 op_sel_hi:[1,1,0]
v_fmac_f32 v227, v116, v116
v_fmac_f32 v227, v117, v117
v_fma_mix_f32 v228, v142, v142, v228 op_sel_hi:[1,1,0]
s_waitcnt lgkmcnt(5)
v_mfma_f32_32x32x16_bf16 v[144:159], v[60:63], v[180:183], v[144:159]
v_fmac_f32 v227, v118, v118
v_fma_mix_f32 v228, v140, v140, v228 op_sel:[1,1,0] op_sel_hi:[1,1,0]
v_fmac_f32 v227, v119, v119
v_fmac_f32 v227, v120, v120
v_fma_mix_f32 v228, v142, v142, v228 op_sel:[1,1,0] op_sel_hi:[1,1,0]
v_fmac_f32_e64 v227, v121, v121
v_fma_mix_f32 v228, v128, v128, v228 op_sel_hi:[1,1,0]
v_fmac_f32_e64 v227, v122, v122
v_fma_mix_f32 v228, v129, v129, v228 op_sel_hi:[1,1,0]
v_cvt_pkrtz_f16_f32 v97, v96, v97
v_fma_mix_f32 v228, v130, v130, v228 op_sel_hi:[1,1,0]
v_and_b32_e64 v97, s49, v97
v_fma_mix_f32 v228, v131, v131, v228 op_sel_hi:[1,1,0]
v_bfe_u32 v96, v97, 2, 14
v_lshrrev_b32_e64 v97, 18, v97
v_cvt_pk_f16_f32 v108, v108, v109
v_fmac_f32_e64 v227, v123, v123
v_cvt_pk_f16_f32 v110, v110, v111
v_fmac_f32 v227, v124, v124
v_fmac_f32 v227, v125, v125
v_mfma_f32_32x32x16_bf16 v[160:175], v[180:183], v[84:87], v[160:175]
ds_read_u16 v96, v96
ds_read_u16_d16_hi v97, v97
v_pk_fma_f16 v109, v108, v108, s48
v_fmac_f32_e64 v227, v126, v126
v_fma_mix_f32 v228, v132, v132, v228 op_sel_hi:[1,1,0]
v_cvt_pkrtz_f16_f32 v99, v98, v99
v_fma_mix_f32 v228, v133, v133, v228 op_sel_hi:[1,1,0]
v_and_b32_e64 v99, s49, v99
v_bfe_u32 v98, v99, 2, 14
v_lshrrev_b32 v99, 18, v99
v_fmac_f32 v227, v127, v127
v_pk_fma_f16 v111, v110, v110, s48
v_pk_mul_f16 v109, v108, v109
v_fma_mix_f32 v228, v134, v134, v228 op_sel_hi:[1,1,0]
v_cvt_pkrtz_f16_f32 v101, v100, v101
v_fma_mix_f32 v228, v135, v135, v228 op_sel_hi:[1,1,0]
ds_read_u16 v98, v98
ds_read_u16_d16_hi v99, v99
ds_read_b128 v[176:179], v250 offset:36864
v_and_b32_e64 v101, s49, v101
v_bfe_u32 v100, v101, 2, 14
v_lshrrev_b32 v101, 18, v101
v_pk_mul_f16 v111, v110, v111
v_exp_f16_sdwa v109, v109 dst_sel:WORD_0 dst_unused:UNUSED_PRESERVE src0_sel:WORD_0
s_waitcnt lgkmcnt(5)
v_mfma_f32_32x32x16_bf16 v[144:159], v[64:67], v[184:187], v[144:159]
ds_read_u16 v100, v100
ds_read_u16_d16_hi v101, v101
v_fma_mix_f32 v228, v136, v136, v228 op_sel_hi:[1,1,0]
v_cvt_pkrtz_f16_f32 v103, v102, v103
v_fma_mix_f32 v228, v137, v137, v228 op_sel_hi:[1,1,0]
v_and_b32_e64 v103, s49, v103
v_bfe_u32 v102, v103, 2, 14
v_lshrrev_b32_e64 v103, 18, v103
v_exp_f16_sdwa v111, v111 dst_sel:WORD_0 dst_unused:UNUSED_PRESERVE src0_sel:WORD_0
v_fma_mix_f32 v228, v138, v138, v228 op_sel_hi:[1,1,0]
v_cvt_pkrtz_f16_f32 v105, v104, v105
v_fma_mix_f32 v228, v139, v139, v228 op_sel_hi:[1,1,0]
v_and_b32_e64 v105, s49, v105
v_bfe_u32 v104, v105, 2, 14
ds_read_u16 v102, v102
ds_read_u16_d16_hi v103, v103
v_lshrrev_b32_e64 v105, 18, v105
v_exp_f16_sdwa v109, v109 dst_sel:WORD_1 dst_unused:UNUSED_PRESERVE src0_sel:WORD_1
v_mfma_f32_32x32x16_bf16 v[160:175], v[184:187], v[88:91], v[160:175]
ds_read_u16 v104, v104
ds_read_u16_d16_hi v105, v105
ds_read_b128 v[180:183], v250 offset:37888
v_cvt_pkrtz_f16_f32 v107, v106, v107
v_and_b32_e64 v107, s49, v107
v_bfe_u32 v106, v107, 2, 14
v_lshrrev_b32_e64 v107, 18, v107
v_exp_f16_sdwa v111, v111 dst_sel:WORD_1 dst_unused:UNUSED_PRESERVE src0_sel:WORD_1
v_pk_add_f16 v109, v109, 1.0 op_sel_hi:[1,0]
v_mfma_f32_32x32x16_bf16 v[144:159], v[68:71], v[188:191], v[144:159]
ds_read_u16 v106, v106
ds_read_u16_d16_hi v107, v107
v_pk_add_f16 v111, v111, 1.0 op_sel_hi:[1,0]
v_rcp_f16_sdwa v109, v109 dst_sel:WORD_0 dst_unused:UNUSED_PRESERVE src0_sel:WORD_0
v_rcp_f16_sdwa v111, v111 dst_sel:WORD_0 dst_unused:UNUSED_PRESERVE src0_sel:WORD_0
v_mfma_f32_32x32x16_bf16 v[160:175], v[188:191], v[92:95], v[160:175]
ds_read_b128 v[184:187], v250 offset:38912
v_rcp_f16_sdwa v109, v109 dst_sel:WORD_1 dst_unused:UNUSED_PRESERVE src0_sel:WORD_1
v_rcp_f16_sdwa v111, v111 dst_sel:WORD_1 dst_unused:UNUSED_PRESERVE src0_sel:WORD_1
s_waitcnt lgkmcnt(7)
v_or_b32 v16, v96, v97
v_mfma_f32_32x32x16_bf16 v[112:127], v[48:51], v[176:179], 0
v_pk_mul_f16 v22, v108, v109
v_pk_mul_f16 v23, v110, v111
v_or_b32_e64 v17, v98, v99
v_cvt_pkrtz_f16_f32 v145, v144, v145
v_and_b32_e64 v145, s49, v145
v_bfe_u32 v144, v145, 2, 14
v_lshrrev_b32_e64 v145, 18, v145
v_cvt_pk_f16_f32 v156, v156, v157
v_cvt_pk_f16_f32 v158, v158, v159
v_mfma_f32_32x32x16_bf16 v[128:143], v[176:179], v[72:75], 0
ds_read_u16 v144, v144
ds_read_u16 v145, v145
v_pk_fma_f16 v157, v156, v156, s48
v_or_b32_e64 v20, v100, v101
v_cvt_pkrtz_f16_f32 v147, v146, v147
v_and_b32_e64 v147, s49, v147
v_bfe_u32 v146, v147, 2, 14
v_lshrrev_b32_e64 v147, 18, v147
v_pk_fma_f16 v159, v158, v158, s48
v_pk_mul_f16 v157, v156, v157
v_pk_mul_f16 v159, v158, v159
s_waitcnt lgkmcnt(5)
v_or_b32 v21, v102, v103
v_cvt_pkrtz_f16_f32 v149, v148, v149
v_and_b32_e64 v149, s49, v149
ds_read_u16 v146, v146
ds_read_u16 v147, v147
ds_read_b128 v[188:191], v250 offset:39936
v_bfe_u32 v148, v149, 2, 14
v_lshrrev_b32_e64 v149, 18, v149
v_exp_f16_sdwa v157, v157 dst_sel:WORD_0 dst_unused:UNUSED_PRESERVE src0_sel:WORD_0
v_mfma_f32_32x32x16_bf16 v[112:127], v[52:55], v[180:183], v[112:127]
ds_read_u16 v148, v148
ds_read_u16 v149, v149
v_or_b32_e64 v18, v104, v105
v_exp_f16_sdwa v159, v159 dst_sel:WORD_0 dst_unused:UNUSED_PRESERVE src0_sel:WORD_0
v_cvt_pkrtz_f16_f32 v151, v150, v151
v_and_b32_e64 v151, s49, v151
v_bfe_u32 v150, v151, 2, 14
v_lshrrev_b32_e64 v151, 18, v151
v_exp_f16_sdwa v157, v157 dst_sel:WORD_1 dst_unused:UNUSED_PRESERVE src0_sel:WORD_1
s_waitcnt lgkmcnt(6)
v_or_b32 v19, v106, v107
v_cvt_pkrtz_f16_f32 v153, v152, v153
v_and_b32_e64 v153, s49, v153
v_bfe_u32 v152, v153, 2, 14
v_lshrrev_b32_e64 v153, 18, v153
ds_read_u16 v150, v150
ds_read_u16 v151, v151
ds_read_u16 v152, v152
ds_read_u16 v153, v153
v_mfma_f32_32x32x16_bf16 v[128:143], v[180:183], v[76:79], v[128:143]
v_exp_f16_sdwa v159, v159 dst_sel:WORD_1 dst_unused:UNUSED_PRESERVE src0_sel:WORD_1
v_cvt_pkrtz_f16_f32 v155, v154, v155
v_and_b32_e64 v155, s49, v155
v_bfe_u32 v154, v155, 2, 14
v_mfma_f32_32x32x16_f16 v[96:111], v[16:19], v[216:219], 0
ds_read_b128 v[176:179], v250 offset:40960
v_lshrrev_b32_e64 v155, 18, v155
v_pk_add_f16 v157, v157, 1.0 op_sel_hi:[1,0]
v_pk_add_f16 v159, v159, 1.0 op_sel_hi:[1,0]
v_rcp_f16_sdwa v157, v157 dst_sel:WORD_0 dst_unused:UNUSED_PRESERVE src0_sel:WORD_0
v_mfma_f32_32x32x16_f16 v[96:111], v[20:23], v[220:223], v[96:111]
ds_read_u16 v154, v154
ds_read_u16 v155, v155
v_permlane16_swap_b32 v16, v20
v_permlane16_swap_b32 v17, v21
v_permlane16_swap_b32 v18, v22
v_permlane16_swap_b32 v19, v23
v_mfma_f32_32x32x16_bf16 v[112:127], v[56:59], v[184:187], v[112:127]
v_rcp_f16_sdwa v159, v159 dst_sel:WORD_0 dst_unused:UNUSED_PRESERVE src0_sel:WORD_0
v_rcp_f16_sdwa v157, v157 dst_sel:WORD_1 dst_unused:UNUSED_PRESERVE src0_sel:WORD_1
v_rcp_f16_sdwa v159, v159 dst_sel:WORD_1 dst_unused:UNUSED_PRESERVE src0_sel:WORD_1
v_mfma_f32_32x32x16_bf16 v[128:143], v[184:187], v[80:83], v[128:143]
ds_read_b128 v[180:183], v250 offset:41984
v_fmac_f32_e64 v228, v96, v96
v_pk_mul_f16 v156, v156, v157
v_fmac_f32_e64 v228, v97, v97
v_pk_mul_f16 v158, v158, v159
v_fmac_f32 v228, v98, v98
v_fmac_f32 v228, v99, v99
v_fma_mix_f32 v229, v156, v156, v229 op_sel_hi:[1,1,0]
v_fmac_f32 v228, v100, v100
v_fmac_f32 v228, v101, v101
v_fma_mix_f32 v229, v158, v158, v229 op_sel_hi:[1,1,0]
s_waitcnt lgkmcnt(5)
v_mfma_f32_32x32x16_bf16 v[112:127], v[60:63], v[188:191], v[112:127]
v_fmac_f32 v228, v102, v102
v_fma_mix_f32 v229, v156, v156, v229 op_sel:[1,1,0] op_sel_hi:[1,1,0]
v_fmac_f32 v228, v103, v103
v_fmac_f32 v228, v104, v104
v_fma_mix_f32 v229, v158, v158, v229 op_sel:[1,1,0] op_sel_hi:[1,1,0]
v_fmac_f32_e64 v228, v105, v105
v_fma_mix_f32 v229, v144, v144, v229 op_sel_hi:[1,1,0]
v_fmac_f32_e64 v228, v106, v106
v_fma_mix_f32 v229, v145, v145, v229 op_sel_hi:[1,1,0]
v_cvt_pkrtz_f16_f32 v161, v160, v161
v_fma_mix_f32 v229, v146, v146, v229 op_sel_hi:[1,1,0]
v_and_b32_e64 v161, s49, v161
v_fma_mix_f32 v229, v147, v147, v229 op_sel_hi:[1,1,0]
v_bfe_u32 v160, v161, 2, 14
v_lshrrev_b32_e64 v161, 18, v161
v_cvt_pk_f16_f32 v172, v172, v173
v_fmac_f32_e64 v228, v107, v107
v_cvt_pk_f16_f32 v174, v174, v175
v_fmac_f32 v228, v108, v108
v_fmac_f32 v228, v109, v109
v_mfma_f32_32x32x16_bf16 v[128:143], v[188:191], v[84:87], v[128:143]
ds_read_u16 v160, v160
ds_read_u16_d16_hi v161, v161
v_pk_fma_f16 v173, v172, v172, s48
v_fmac_f32_e64 v228, v110, v110
v_fma_mix_f32 v229, v148, v148, v229 op_sel_hi:[1,1,0]
v_cvt_pkrtz_f16_f32 v163, v162, v163
v_fma_mix_f32 v229, v149, v149, v229 op_sel_hi:[1,1,0]
v_and_b32_e64 v163, s49, v163
v_bfe_u32 v162, v163, 2, 14
v_lshrrev_b32 v163, 18, v163
v_fmac_f32 v228, v111, v111
v_pk_fma_f16 v175, v174, v174, s48
v_pk_mul_f16 v173, v172, v173
v_fma_mix_f32 v229, v150, v150, v229 op_sel_hi:[1,1,0]
v_cvt_pkrtz_f16_f32 v165, v164, v165
v_fma_mix_f32 v229, v151, v151, v229 op_sel_hi:[1,1,0]
ds_read_u16 v162, v162
ds_read_u16_d16_hi v163, v163
ds_read_b128 v[184:187], v250 offset:43008
v_and_b32_e64 v165, s49, v165
v_bfe_u32 v164, v165, 2, 14
v_lshrrev_b32 v165, 18, v165
v_pk_mul_f16 v175, v174, v175
v_exp_f16_sdwa v173, v173 dst_sel:WORD_0 dst_unused:UNUSED_PRESERVE src0_sel:WORD_0
s_waitcnt lgkmcnt(5)
v_mfma_f32_32x32x16_bf16 v[112:127], v[64:67], v[176:179], v[112:127]
ds_read_u16 v164, v164
ds_read_u16_d16_hi v165, v165
v_fma_mix_f32 v229, v152, v152, v229 op_sel_hi:[1,1,0]
v_cvt_pkrtz_f16_f32 v167, v166, v167
v_fma_mix_f32 v229, v153, v153, v229 op_sel_hi:[1,1,0]
v_and_b32_e64 v167, s49, v167
v_bfe_u32 v166, v167, 2, 14
v_lshrrev_b32_e64 v167, 18, v167
v_exp_f16_sdwa v175, v175 dst_sel:WORD_0 dst_unused:UNUSED_PRESERVE src0_sel:WORD_0
v_fma_mix_f32 v229, v154, v154, v229 op_sel_hi:[1,1,0]
v_cvt_pkrtz_f16_f32 v169, v168, v169
v_fma_mix_f32 v229, v155, v155, v229 op_sel_hi:[1,1,0]
v_and_b32_e64 v169, s49, v169
v_bfe_u32 v168, v169, 2, 14
ds_read_u16 v166, v166
ds_read_u16_d16_hi v167, v167
v_lshrrev_b32_e64 v169, 18, v169
v_exp_f16_sdwa v173, v173 dst_sel:WORD_1 dst_unused:UNUSED_PRESERVE src0_sel:WORD_1
v_mfma_f32_32x32x16_bf16 v[128:143], v[176:179], v[88:91], v[128:143]
ds_read_u16 v168, v168
ds_read_u16_d16_hi v169, v169
ds_read_b128 v[188:191], v250 offset:44032
v_cvt_pkrtz_f16_f32 v171, v170, v171
v_and_b32_e64 v171, s49, v171
v_bfe_u32 v170, v171, 2, 14
v_lshrrev_b32_e64 v171, 18, v171
v_exp_f16_sdwa v175, v175 dst_sel:WORD_1 dst_unused:UNUSED_PRESERVE src0_sel:WORD_1
v_pk_add_f16 v173, v173, 1.0 op_sel_hi:[1,0]
v_mfma_f32_32x32x16_bf16 v[112:127], v[68:71], v[180:183], v[112:127]
ds_read_u16 v170, v170
ds_read_u16_d16_hi v171, v171
v_pk_add_f16 v175, v175, 1.0 op_sel_hi:[1,0]
v_rcp_f16_sdwa v173, v173 dst_sel:WORD_0 dst_unused:UNUSED_PRESERVE src0_sel:WORD_0
v_rcp_f16_sdwa v175, v175 dst_sel:WORD_0 dst_unused:UNUSED_PRESERVE src0_sel:WORD_0
v_mfma_f32_32x32x16_bf16 v[128:143], v[180:183], v[92:95], v[128:143]
ds_read_b128 v[176:179], v250 offset:45056
v_rcp_f16_sdwa v173, v173 dst_sel:WORD_1 dst_unused:UNUSED_PRESERVE src0_sel:WORD_1
v_rcp_f16_sdwa v175, v175 dst_sel:WORD_1 dst_unused:UNUSED_PRESERVE src0_sel:WORD_1
s_waitcnt lgkmcnt(7)
v_or_b32 v192, v160, v161
v_mfma_f32_32x32x16_bf16 v[96:111], v[48:51], v[184:187], 0
v_pk_mul_f16 v198, v172, v173
v_pk_mul_f16 v199, v174, v175
v_or_b32_e64 v193, v162, v163
v_cvt_pkrtz_f16_f32 v113, v112, v113
v_and_b32_e64 v113, s49, v113
v_bfe_u32 v112, v113, 2, 14
v_lshrrev_b32_e64 v113, 18, v113
v_cvt_pk_f16_f32 v124, v124, v125
v_cvt_pk_f16_f32 v126, v126, v127
v_mfma_f32_32x32x16_bf16 v[144:159], v[184:187], v[72:75], 0
ds_read_u16 v112, v112
ds_read_u16 v113, v113
v_pk_fma_f16 v125, v124, v124, s48
v_or_b32_e64 v196, v164, v165
v_cvt_pkrtz_f16_f32 v115, v114, v115
v_and_b32_e64 v115, s49, v115
v_bfe_u32 v114, v115, 2, 14
v_lshrrev_b32_e64 v115, 18, v115
v_pk_fma_f16 v127, v126, v126, s48
v_pk_mul_f16 v125, v124, v125
v_pk_mul_f16 v127, v126, v127
s_waitcnt lgkmcnt(5)
v_or_b32 v197, v166, v167
v_cvt_pkrtz_f16_f32 v117, v116, v117
v_and_b32_e64 v117, s49, v117
ds_read_u16 v114, v114
ds_read_u16 v115, v115
ds_read_b128 v[180:183], v250 offset:46080
v_bfe_u32 v116, v117, 2, 14
v_lshrrev_b32_e64 v117, 18, v117
v_exp_f16_sdwa v125, v125 dst_sel:WORD_0 dst_unused:UNUSED_PRESERVE src0_sel:WORD_0
v_mfma_f32_32x32x16_bf16 v[96:111], v[52:55], v[188:191], v[96:111]
ds_read_u16 v116, v116
ds_read_u16 v117, v117
v_or_b32_e64 v194, v168, v169
v_exp_f16_sdwa v127, v127 dst_sel:WORD_0 dst_unused:UNUSED_PRESERVE src0_sel:WORD_0
v_cvt_pkrtz_f16_f32 v119, v118, v119
v_and_b32_e64 v119, s49, v119
v_bfe_u32 v118, v119, 2, 14
v_lshrrev_b32_e64 v119, 18, v119
v_exp_f16_sdwa v125, v125 dst_sel:WORD_1 dst_unused:UNUSED_PRESERVE src0_sel:WORD_1
s_waitcnt lgkmcnt(6)
v_or_b32 v195, v170, v171
v_cvt_pkrtz_f16_f32 v121, v120, v121
v_and_b32_e64 v121, s49, v121
v_bfe_u32 v120, v121, 2, 14
v_lshrrev_b32_e64 v121, 18, v121
ds_read_u16 v118, v118
ds_read_u16 v119, v119
ds_read_u16 v120, v120
ds_read_u16 v121, v121
v_mfma_f32_32x32x16_bf16 v[144:159], v[188:191], v[76:79], v[144:159]
v_exp_f16_sdwa v127, v127 dst_sel:WORD_1 dst_unused:UNUSED_PRESERVE src0_sel:WORD_1
v_cvt_pkrtz_f16_f32 v123, v122, v123
v_and_b32_e64 v123, s49, v123
v_bfe_u32 v122, v123, 2, 14
v_mfma_f32_32x32x16_f16 v[160:175], v[192:195], v[216:219], 0
ds_read_b128 v[184:187], v250 offset:47104
v_lshrrev_b32_e64 v123, 18, v123
v_pk_add_f16 v125, v125, 1.0 op_sel_hi:[1,0]
v_pk_add_f16 v127, v127, 1.0 op_sel_hi:[1,0]
v_rcp_f16_sdwa v125, v125 dst_sel:WORD_0 dst_unused:UNUSED_PRESERVE src0_sel:WORD_0
v_mfma_f32_32x32x16_f16 v[160:175], v[196:199], v[220:223], v[160:175]
ds_read_u16 v122, v122
ds_read_u16 v123, v123
v_permlane16_swap_b32 v192, v196
v_permlane16_swap_b32 v193, v197
v_permlane16_swap_b32 v194, v198
v_permlane16_swap_b32 v195, v199
v_mfma_f32_32x32x16_bf16 v[96:111], v[56:59], v[176:179], v[96:111]
v_rcp_f16_sdwa v127, v127 dst_sel:WORD_0 dst_unused:UNUSED_PRESERVE src0_sel:WORD_0
v_rcp_f16_sdwa v125, v125 dst_sel:WORD_1 dst_unused:UNUSED_PRESERVE src0_sel:WORD_1
v_rcp_f16_sdwa v127, v127 dst_sel:WORD_1 dst_unused:UNUSED_PRESERVE src0_sel:WORD_1
v_mfma_f32_32x32x16_bf16 v[144:159], v[176:179], v[80:83], v[144:159]
ds_read_b128 v[188:191], v250 offset:48128
v_fmac_f32_e64 v229, v160, v160
v_pk_mul_f16 v124, v124, v125
v_fmac_f32_e64 v229, v161, v161
v_pk_mul_f16 v126, v126, v127
v_fmac_f32 v229, v162, v162
v_fmac_f32 v229, v163, v163
v_fma_mix_f32 v230, v124, v124, v230 op_sel_hi:[1,1,0]
v_fmac_f32 v229, v164, v164
v_fmac_f32 v229, v165, v165
v_fma_mix_f32 v230, v126, v126, v230 op_sel_hi:[1,1,0]
s_waitcnt lgkmcnt(5)
v_mfma_f32_32x32x16_bf16 v[96:111], v[60:63], v[180:183], v[96:111]
v_fmac_f32 v229, v166, v166
v_fma_mix_f32 v230, v124, v124, v230 op_sel:[1,1,0] op_sel_hi:[1,1,0]
v_fmac_f32 v229, v167, v167
v_fmac_f32 v229, v168, v168
v_fma_mix_f32 v230, v126, v126, v230 op_sel:[1,1,0] op_sel_hi:[1,1,0]
v_fmac_f32_e64 v229, v169, v169
v_fma_mix_f32 v230, v112, v112, v230 op_sel_hi:[1,1,0]
v_fmac_f32_e64 v229, v170, v170
v_fma_mix_f32 v230, v113, v113, v230 op_sel_hi:[1,1,0]
v_cvt_pkrtz_f16_f32 v129, v128, v129
v_fma_mix_f32 v230, v114, v114, v230 op_sel_hi:[1,1,0]
v_and_b32_e64 v129, s49, v129
v_fma_mix_f32 v230, v115, v115, v230 op_sel_hi:[1,1,0]
v_bfe_u32 v128, v129, 2, 14
v_lshrrev_b32_e64 v129, 18, v129
v_cvt_pk_f16_f32 v140, v140, v141
v_fmac_f32_e64 v229, v171, v171
v_cvt_pk_f16_f32 v142, v142, v143
v_fmac_f32 v229, v172, v172
v_fmac_f32 v229, v173, v173
v_mfma_f32_32x32x16_bf16 v[144:159], v[180:183], v[84:87], v[144:159]
ds_read_u16 v128, v128
ds_read_u16_d16_hi v129, v129
v_pk_fma_f16 v141, v140, v140, s48
v_fmac_f32_e64 v229, v174, v174
v_fma_mix_f32 v230, v116, v116, v230 op_sel_hi:[1,1,0]
v_cvt_pkrtz_f16_f32 v131, v130, v131
v_fma_mix_f32 v230, v117, v117, v230 op_sel_hi:[1,1,0]
v_and_b32_e64 v131, s49, v131
v_bfe_u32 v130, v131, 2, 14
v_lshrrev_b32 v131, 18, v131
v_fmac_f32 v229, v175, v175
v_pk_fma_f16 v143, v142, v142, s48
v_pk_mul_f16 v141, v140, v141
v_fma_mix_f32 v230, v118, v118, v230 op_sel_hi:[1,1,0]
v_cvt_pkrtz_f16_f32 v133, v132, v133
v_fma_mix_f32 v230, v119, v119, v230 op_sel_hi:[1,1,0]
ds_read_u16 v130, v130
ds_read_u16_d16_hi v131, v131
ds_read_b128 v[176:179], v250 offset:49152
v_and_b32_e64 v133, s49, v133
v_bfe_u32 v132, v133, 2, 14
v_lshrrev_b32 v133, 18, v133
v_pk_mul_f16 v143, v142, v143
v_exp_f16_sdwa v141, v141 dst_sel:WORD_0 dst_unused:UNUSED_PRESERVE src0_sel:WORD_0
s_waitcnt lgkmcnt(5)
v_mfma_f32_32x32x16_bf16 v[96:111], v[64:67], v[184:187], v[96:111]
ds_read_u16 v132, v132
ds_read_u16_d16_hi v133, v133
v_fma_mix_f32 v230, v120, v120, v230 op_sel_hi:[1,1,0]
v_cvt_pkrtz_f16_f32 v135, v134, v135
v_fma_mix_f32 v230, v121, v121, v230 op_sel_hi:[1,1,0]
v_and_b32_e64 v135, s49, v135
v_bfe_u32 v134, v135, 2, 14
v_lshrrev_b32_e64 v135, 18, v135
v_exp_f16_sdwa v143, v143 dst_sel:WORD_0 dst_unused:UNUSED_PRESERVE src0_sel:WORD_0
v_fma_mix_f32 v230, v122, v122, v230 op_sel_hi:[1,1,0]
v_cvt_pkrtz_f16_f32 v137, v136, v137
v_fma_mix_f32 v230, v123, v123, v230 op_sel_hi:[1,1,0]
v_and_b32_e64 v137, s49, v137
v_bfe_u32 v136, v137, 2, 14
ds_read_u16 v134, v134
ds_read_u16_d16_hi v135, v135
v_lshrrev_b32_e64 v137, 18, v137
v_exp_f16_sdwa v141, v141 dst_sel:WORD_1 dst_unused:UNUSED_PRESERVE src0_sel:WORD_1
v_mfma_f32_32x32x16_bf16 v[144:159], v[184:187], v[88:91], v[144:159]
ds_read_u16 v136, v136
ds_read_u16_d16_hi v137, v137
ds_read_b128 v[180:183], v250 offset:50176
v_cvt_pkrtz_f16_f32 v139, v138, v139
v_and_b32_e64 v139, s49, v139
v_bfe_u32 v138, v139, 2, 14
v_lshrrev_b32_e64 v139, 18, v139
v_exp_f16_sdwa v143, v143 dst_sel:WORD_1 dst_unused:UNUSED_PRESERVE src0_sel:WORD_1
v_pk_add_f16 v141, v141, 1.0 op_sel_hi:[1,0]
v_mfma_f32_32x32x16_bf16 v[96:111], v[68:71], v[188:191], v[96:111]
ds_read_u16 v138, v138
ds_read_u16_d16_hi v139, v139
v_pk_add_f16 v143, v143, 1.0 op_sel_hi:[1,0]
v_rcp_f16_sdwa v141, v141 dst_sel:WORD_0 dst_unused:UNUSED_PRESERVE src0_sel:WORD_0
v_rcp_f16_sdwa v143, v143 dst_sel:WORD_0 dst_unused:UNUSED_PRESERVE src0_sel:WORD_0
v_mfma_f32_32x32x16_bf16 v[144:159], v[188:191], v[92:95], v[144:159]
ds_read_b128 v[184:187], v250 offset:51200
v_rcp_f16_sdwa v141, v141 dst_sel:WORD_1 dst_unused:UNUSED_PRESERVE src0_sel:WORD_1
v_rcp_f16_sdwa v143, v143 dst_sel:WORD_1 dst_unused:UNUSED_PRESERVE src0_sel:WORD_1
s_waitcnt lgkmcnt(7)
v_or_b32 v200, v128, v129
v_mfma_f32_32x32x16_bf16 v[160:175], v[48:51], v[176:179], 0
v_mov_b32 v239, 0
s_branch Law5
Lax5:
s_sleep 2
Law5:
ds_read_b32 v239, v247 offset:28
s_sub_u32 s76, s76, 1
s_cselect_b32 s44, 4, 0
s_cselect_b32 s76, 0, s76
s_waitcnt lgkmcnt(0)
v_readfirstlane_b32 s43, v239
s_nop 1
s_max_u32 s43, s43, s44
s_cmp_lt_u32 s43, 4
s_cbranch_scc1 Lax5
v_bfe_u32 v237, v250, 4, 6
v_lshrrev_b32_e64 v246, 2, v237
v_mul_u32_u24 v246, 192, v246
v_and_b32_e64 v237, 3, v237
v_lshl_add_u32 v246, v237, 4, v246
v_permlane32_swap_b32 v224, v225
v_add_f32 v224, v224, v225
v_permlane32_swap_b32 v226, v227
v_add_f32 v226, v226, v227
v_permlane32_swap_b32 v228, v229
v_add_f32 v228, v228, v229
v_pk_mul_f16 v206, v140, v141
v_pk_mul_f16 v207, v142, v143
ds_write_b32 v248, v224 offset:5120
ds_write_b32 v248, v226 offset:5376
ds_write_b32 v248, v228 offset:5632
v_or_b32_e64 v201, v130, v131
v_cvt_pkrtz_f16_f32 v97, v96, v97
v_and_b32_e64 v97, s49, v97
v_bfe_u32 v96, v97, 2, 14
v_lshrrev_b32_e64 v97, 18, v97
v_cvt_pk_f16_f32 v108, v108, v109
v_cvt_pk_f16_f32 v110, v110, v111
v_mfma_f32_32x32x16_bf16 v[112:127], v[176:179], v[72:75], 0
ds_read_u16 v96, v96
ds_read_u16 v97, v97
v_pk_fma_f16 v109, v108, v108, s48
v_or_b32_e64 v204, v132, v133
v_cvt_pkrtz_f16_f32 v99, v98, v99
v_and_b32_e64 v99, s49, v99
v_bfe_u32 v98, v99, 2, 14
v_lshrrev_b32_e64 v99, 18, v99
v_pk_fma_f16 v111, v110, v110, s48
v_pk_mul_f16 v109, v108, v109
v_pk_mul_f16 v111, v110, v111
v_or_b32_e64 v205, v134, v135
v_cvt_pkrtz_f16_f32 v101, v100, v101
v_and_b32_e64 v101, s49, v101
ds_read_u16 v98, v98
ds_read_u16 v99, v99
ds_read_b128 v[188:191], v250 offset:52224
v_bfe_u32 v100, v101, 2, 14
v_lshrrev_b32_e64 v101, 18, v101
v_exp_f16_sdwa v109, v109 dst_sel:WORD_0 dst_unused:UNUSED_PRESERVE src0_sel:WORD_0
v_mfma_f32_32x32x16_bf16 v[160:175], v[52:55], v[180:183], v[160:175]
ds_read_u16 v100, v100
ds_read_u16 v101, v101
s_add_u32 m0, s72, 0
s_add_u32 s43, s82, 0
buffer_load_dwordx4 v246, s[16:19], s43 offen lds
v_or_b32_e64 v202, v136, v137
v_exp_f16_sdwa v111, v111 dst_sel:WORD_0 dst_unused:UNUSED_PRESERVE src0_sel:WORD_0
v_cvt_pkrtz_f16_f32 v103, v102, v103
v_and_b32_e64 v103, s49, v103
v_bfe_u32 v102, v103, 2, 14
v_lshrrev_b32_e64 v103, 18, v103
v_exp_f16_sdwa v109, v109 dst_sel:WORD_1 dst_unused:UNUSED_PRESERVE src0_sel:WORD_1
v_or_b32_e64 v203, v138, v139
v_cvt_pkrtz_f16_f32 v105, v104, v105
v_and_b32_e64 v105, s49, v105
v_bfe_u32 v104, v105, 2, 14
v_lshrrev_b32_e64 v105, 18, v105
ds_read_u16 v102, v102
ds_read_u16 v103, v103
ds_read_u16 v104, v104
ds_read_u16 v105, v105
v_mfma_f32_32x32x16_bf16 v[112:127], v[180:183], v[76:79], v[112:127]
v_exp_f16_sdwa v111, v111 dst_sel:WORD_1 dst_unused:UNUSED_PRESERVE src0_sel:WORD_1
v_cvt_pkrtz_f16_f32 v107, v106, v107
v_and_b32_e64 v107, s49, v107
v_bfe_u32 v106, v107, 2, 14
v_mfma_f32_32x32x16_f16 v[128:143], v[200:203], v[216:219], 0
ds_read_b128 v[176:179], v250 offset:53248
v_lshrrev_b32_e64 v107, 18, v107
v_pk_add_f16 v109, v109, 1.0 op_sel_hi:[1,0]
v_pk_add_f16 v111, v111, 1.0 op_sel_hi:[1,0]
v_rcp_f16_sdwa v109, v109 dst_sel:WORD_0 dst_unused:UNUSED_PRESERVE src0_sel:WORD_0
v_mfma_f32_32x32x16_f16 v[128:143], v[204:207], v[220:223], v[128:143]
s_waitcnt lgkmcnt(7)
ds_read_u16 v106, v106
ds_read_u16 v107, v107
v_permlane16_swap_b32 v200, v204
v_permlane16_swap_b32 v201, v205
v_permlane16_swap_b32 v202, v206
v_permlane16_swap_b32 v203, v207
v_mfma_f32_32x32x16_bf16 v[160:175], v[56:59], v[184:187], v[160:175]
v_rcp_f16_sdwa v111, v111 dst_sel:WORD_0 dst_unused:UNUSED_PRESERVE src0_sel:WORD_0
v_rcp_f16_sdwa v109, v109 dst_sel:WORD_1 dst_unused:UNUSED_PRESERVE src0_sel:WORD_1
s_add_u32 m0, s72, 1024
s_add_u32 s43, s82, 64
buffer_load_dwordx4 v246, s[16:19], s43 offen lds
v_rcp_f16_sdwa v111, v111 dst_sel:WORD_1 dst_unused:UNUSED_PRESERVE src0_sel:WORD_1
v_mfma_f32_32x32x16_bf16 v[112:127], v[184:187], v[80:83], v[112:127]
ds_read_b128 v[180:183], v250 offset:54272
v_fmac_f32_e64 v230, v128, v128
v_pk_mul_f16 v108, v108, v109
v_fmac_f32_e64 v230, v129, v129
v_pk_mul_f16 v110, v110, v111
v_fmac_f32 v230, v130, v130
v_fmac_f32 v230, v131, v131
v_fma_mix_f32 v231, v108, v108, v231 op_sel_hi:[1,1,0]
v_fmac_f32 v230, v132, v132
v_fmac_f32 v230, v133, v133
v_fma_mix_f32 v231, v110, v110, v231 op_sel_hi:[1,1,0]
v_mfma_f32_32x32x16_bf16 v[160:175], v[60:63], v[188:191], v[160:175]
v_fmac_f32_e64 v230, v134, v134
v_fma_mix_f32 v231, v108, v108, v231 op_sel:[1,1,0] op_sel_hi:[1,1,0]
v_fmac_f32 v230, v135, v135
v_fmac_f32 v230, v136, v136
v_fma_mix_f32 v231, v110, v110, v231 op_sel:[1,1,0] op_sel_hi:[1,1,0]
v_fmac_f32_e64 v230, v137, v137
v_fma_mix_f32 v231, v96, v96, v231 op_sel_hi:[1,1,0]
v_fmac_f32_e64 v230, v138, v138
v_fma_mix_f32 v231, v97, v97, v231 op_sel_hi:[1,1,0]
v_cvt_pkrtz_f16_f32 v145, v144, v145
v_fma_mix_f32 v231, v98, v98, v231 op_sel_hi:[1,1,0]
v_and_b32_e64 v145, s49, v145
v_fma_mix_f32 v231, v99, v99, v231 op_sel_hi:[1,1,0]
v_bfe_u32 v144, v145, 2, 14
v_lshrrev_b32_e64 v145, 18, v145
v_cvt_pk_f16_f32 v156, v156, v157
v_fmac_f32_e64 v230, v139, v139
v_cvt_pk_f16_f32 v158, v158, v159
v_fmac_f32 v230, v140, v140
v_fmac_f32 v230, v141, v141
v_mfma_f32_32x32x16_bf16 v[112:127], v[188:191], v[84:87], v[112:127]
ds_read_u16 v144, v144
ds_read_u16_d16_hi v145, v145
v_pk_fma_f16 v157, v156, v156, s48
v_fmac_f32 v230, v142, v142
s_waitcnt lgkmcnt(2)
v_fma_mix_f32 v231, v100, v100, v231 op_sel_hi:[1,1,0]
v_cvt_pkrtz_f16_f32 v147, v146, v147
v_fma_mix_f32 v231, v101, v101, v231 op_sel_hi:[1,1,0]
v_and_b32_e64 v147, s49, v147
v_bfe_u32 v146, v147, 2, 14
v_lshrrev_b32 v147, 18, v147
v_fmac_f32 v230, v143, v143
v_pk_fma_f16 v159, v158, v158, s48
v_pk_mul_f16 v157, v156, v157
v_fma_mix_f32 v231, v102, v102, v231 op_sel_hi:[1,1,0]
v_cvt_pkrtz_f16_f32 v149, v148, v149
v_fma_mix_f32 v231, v103, v103, v231 op_sel_hi:[1,1,0]
ds_read_u16 v146, v146
ds_read_u16_d16_hi v147, v147
ds_read_b128 v[184:187], v250 offset:55296
v_and_b32_e64 v149, s49, v149
v_bfe_u32 v148, v149, 2, 14
v_lshrrev_b32_e64 v149, 18, v149
v_pk_mul_f16 v159, v158, v159
v_exp_f16_sdwa v157, v157 dst_sel:WORD_0 dst_unused:UNUSED_PRESERVE src0_sel:WORD_0
v_mfma_f32_32x32x16_bf16 v[160:175], v[64:67], v[176:179], v[160:175]
ds_read_u16 v148, v148
ds_read_u16_d16_hi v149, v149
s_add_u32 m0, s72, 2048
s_add_u32 s43, s82, 128
buffer_load_dwordx4 v246, s[16:19], s43 offen lds
v_fma_mix_f32 v231, v104, v104, v231 op_sel_hi:[1,1,0]
v_cvt_pkrtz_f16_f32 v151, v150, v151
v_fma_mix_f32 v231, v105, v105, v231 op_sel_hi:[1,1,0]
v_and_b32_e64 v151, s49, v151
v_bfe_u32 v150, v151, 2, 14
v_lshrrev_b32_e64 v151, 18, v151
v_exp_f16_sdwa v159, v159 dst_sel:WORD_0 dst_unused:UNUSED_PRESERVE src0_sel:WORD_0
v_fma_mix_f32 v231, v106, v106, v231 op_sel_hi:[1,1,0]
v_cvt_pkrtz_f16_f32 v153, v152, v153
v_fma_mix_f32 v231, v107, v107, v231 op_sel_hi:[1,1,0]
v_and_b32_e64 v153, s49, v153
v_bfe_u32 v152, v153, 2, 14
ds_read_u16 v150, v150
ds_read_u16_d16_hi v151, v151
v_lshrrev_b32_e64 v153, 18, v153
v_exp_f16_sdwa v157, v157 dst_sel:WORD_1 dst_unused:UNUSED_PRESERVE src0_sel:WORD_1
v_mfma_f32_32x32x16_bf16 v[112:127], v[176:179], v[88:91], v[112:127]
ds_read_u16 v152, v152
ds_read_u16_d16_hi v153, v153
ds_read_b128 v[188:191], v250 offset:56320
v_cvt_pkrtz_f16_f32 v155, v154, v155
v_and_b32_e64 v155, s49, v155
v_bfe_u32 v154, v155, 2, 14
v_lshrrev_b32_e64 v155, 18, v155
v_exp_f16_sdwa v159, v159 dst_sel:WORD_1 dst_unused:UNUSED_PRESERVE src0_sel:WORD_1
v_pk_add_f16 v157, v157, 1.0 op_sel_hi:[1,0]
v_mfma_f32_32x32x16_bf16 v[160:175], v[68:71], v[180:183], v[160:175]
ds_read_u16 v154, v154
ds_read_u16_d16_hi v155, v155
v_pk_add_f16 v159, v159, 1.0 op_sel_hi:[1,0]
v_rcp_f16_sdwa v157, v157 dst_sel:WORD_0 dst_unused:UNUSED_PRESERVE src0_sel:WORD_0
v_rcp_f16_sdwa v159, v159 dst_sel:WORD_0 dst_unused:UNUSED_PRESERVE src0_sel:WORD_0
s_add_u32 m0, s72, 3072
s_add_u32 s43, s82, 3072
buffer_load_dwordx4 v246, s[16:19], s43 offen lds
v_mfma_f32_32x32x16_bf16 v[112:127], v[180:183], v[92:95], v[112:127]
ds_read_b128 v[176:179], v250 offset:57344
v_rcp_f16_sdwa v157, v157 dst_sel:WORD_1 dst_unused:UNUSED_PRESERVE src0_sel:WORD_1
v_rcp_f16_sdwa v159, v159 dst_sel:WORD_1 dst_unused:UNUSED_PRESERVE src0_sel:WORD_1
s_waitcnt lgkmcnt(7)
v_or_b32 v208, v144, v145
v_mfma_f32_32x32x16_bf16 v[128:143], v[48:51], v[184:187], 0
v_pk_mul_f16 v214, v156, v157
v_pk_mul_f16 v215, v158, v159
v_or_b32_e64 v209, v146, v147
v_cvt_pkrtz_f16_f32 v161, v160, v161
v_and_b32_e64 v161, s49, v161
v_bfe_u32 v160, v161, 2, 14
v_lshrrev_b32_e64 v161, 18, v161
v_cvt_pk_f16_f32 v172, v172, v173
v_cvt_pk_f16_f32 v174, v174, v175
v_mfma_f32_32x32x16_bf16 v[96:111], v[72:75], v[184:187], 0
ds_read_u16 v160, v160
ds_read_u16 v161, v161
v_pk_fma_f16 v173, v172, v172, s48
v_or_b32_e64 v212, v148, v149
v_cvt_pkrtz_f16_f32 v163, v162, v163
v_and_b32_e64 v163, s49, v163
v_bfe_u32 v162, v163, 2, 14
v_lshrrev_b32_e64 v163, 18, v163
v_pk_fma_f16 v175, v174, v174, s48
v_pk_mul_f16 v173, v172, v173
v_pk_mul_f16 v175, v174, v175
s_waitcnt lgkmcnt(5)
v_or_b32 v213, v150, v151
v_cvt_pkrtz_f16_f32 v165, v164, v165
v_and_b32_e64 v165, s49, v165
ds_read_u16 v162, v162
ds_read_u16 v163, v163
ds_read_b128 v[180:183], v250 offset:58368
v_bfe_u32 v164, v165, 2, 14
v_lshrrev_b32_e64 v165, 18, v165
v_exp_f16_sdwa v173, v173 dst_sel:WORD_0 dst_unused:UNUSED_PRESERVE src0_sel:WORD_0
v_mfma_f32_32x32x16_bf16 v[128:143], v[52:55], v[188:191], v[128:143]
ds_read_u16 v164, v164
ds_read_u16 v165, v165
s_add_u32 m0, s72, 4096
s_add_u32 s43, s82, 3136
buffer_load_dwordx4 v246, s[16:19], s43 offen lds
v_or_b32_e64 v210, v152, v153
v_exp_f16_sdwa v175, v175 dst_sel:WORD_0 dst_unused:UNUSED_PRESERVE src0_sel:WORD_0
v_cvt_pkrtz_f16_f32 v167, v166, v167
v_and_b32_e64 v167, s49, v167
v_bfe_u32 v166, v167, 2, 14
v_lshrrev_b32_e64 v167, 18, v167
v_exp_f16_sdwa v173, v173 dst_sel:WORD_1 dst_unused:UNUSED_PRESERVE src0_sel:WORD_1
s_waitcnt lgkmcnt(6)
v_or_b32 v211, v154, v155
v_cvt_pkrtz_f16_f32 v169, v168, v169
v_and_b32_e64 v169, s49, v169
v_bfe_u32 v168, v169, 2, 14
v_lshrrev_b32_e64 v169, 18, v169
ds_read_u16 v166, v166
ds_read_u16 v167, v167
ds_read_u16 v168, v168
ds_read_u16 v169, v169
v_mfma_f32_32x32x16_bf16 v[96:111], v[76:79], v[188:191], v[96:111]
v_exp_f16_sdwa v175, v175 dst_sel:WORD_1 dst_unused:UNUSED_PRESERVE src0_sel:WORD_1
v_cvt_pkrtz_f16_f32 v171, v170, v171
v_and_b32_e64 v171, s49, v171
v_bfe_u32 v170, v171, 2, 14
v_mfma_f32_32x32x16_f16 v[144:159], v[208:211], v[216:219], 0
ds_read_b128 v[184:187], v250 offset:59392
v_lshrrev_b32_e64 v171, 18, v171
v_pk_add_f16 v173, v173, 1.0 op_sel_hi:[1,0]
v_pk_add_f16 v175, v175, 1.0 op_sel_hi:[1,0]
v_rcp_f16_sdwa v173, v173 dst_sel:WORD_0 dst_unused:UNUSED_PRESERVE src0_sel:WORD_0
v_mfma_f32_32x32x16_f16 v[144:159], v[212:215], v[220:223], v[144:159]
ds_read_u16 v170, v170
ds_read_u16 v171, v171
v_permlane16_swap_b32 v208, v212
v_permlane16_swap_b32 v209, v213
v_permlane16_swap_b32 v210, v214
v_permlane16_swap_b32 v211, v215
v_mfma_f32_32x32x16_bf16 v[128:143], v[56:59], v[176:179], v[128:143]
v_rcp_f16_sdwa v175, v175 dst_sel:WORD_0 dst_unused:UNUSED_PRESERVE src0_sel:WORD_0
v_rcp_f16_sdwa v173, v173 dst_sel:WORD_1 dst_unused:UNUSED_PRESERVE src0_sel:WORD_1
s_add_u32 m0, s72, 6144
s_add_u32 s43, s82, 6144
buffer_load_dwordx4 v246, s[16:19], s43 offen lds
v_rcp_f16_sdwa v175, v175 dst_sel:WORD_1 dst_unused:UNUSED_PRESERVE src0_sel:WORD_1
v_mfma_f32_32x32x16_bf16 v[96:111], v[80:83], v[176:179], v[96:111]
ds_read_b128 v[188:191], v250 offset:60416
v_fmac_f32_e64 v231, v144, v144
v_pk_mul_f16 v172, v172, v173
v_fmac_f32_e64 v231, v145, v145
v_pk_mul_f16 v174, v174, v175
v_fmac_f32 v231, v146, v146
v_fmac_f32 v231, v147, v147
v_fma_mix_f32 v232, v172, v172, v232 op_sel_hi:[1,1,0]
v_fmac_f32 v231, v148, v148
v_fmac_f32 v231, v149, v149
v_fma_mix_f32 v232, v174, v174, v232 op_sel_hi:[1,1,0]
s_waitcnt lgkmcnt(5)
v_mfma_f32_32x32x16_bf16 v[128:143], v[60:63], v[180:183], v[128:143]
v_fmac_f32 v231, v150, v150
v_fma_mix_f32 v232, v172, v172, v232 op_sel:[1,1,0] op_sel_hi:[1,1,0]
v_fmac_f32 v231, v151, v151
v_fmac_f32 v231, v152, v152
v_fma_mix_f32 v232, v174, v174, v232 op_sel:[1,1,0] op_sel_hi:[1,1,0]
v_fmac_f32_e64 v231, v153, v153
v_fma_mix_f32 v232, v160, v160, v232 op_sel_hi:[1,1,0]
v_fmac_f32_e64 v231, v154, v154
v_fma_mix_f32 v232, v161, v161, v232 op_sel_hi:[1,1,0]
v_cvt_pkrtz_f16_f32 v113, v112, v113
v_fma_mix_f32 v232, v162, v162, v232 op_sel_hi:[1,1,0]
v_and_b32_e64 v113, s49, v113
v_fma_mix_f32 v232, v163, v163, v232 op_sel_hi:[1,1,0]
v_bfe_u32 v112, v113, 2, 14
v_lshrrev_b32_e64 v113, 18, v113
v_cvt_pk_f16_f32 v124, v124, v125
v_fmac_f32_e64 v231, v155, v155
v_cvt_pk_f16_f32 v126, v126, v127
v_fmac_f32 v231, v156, v156
v_fmac_f32 v231, v157, v157
v_mfma_f32_32x32x16_bf16 v[96:111], v[84:87], v[180:183], v[96:111]
ds_read_u16 v112, v112
ds_read_u16_d16_hi v113, v113
v_pk_fma_f16 v125, v124, v124, s48
v_fmac_f32_e64 v231, v158, v158
v_fma_mix_f32 v232, v164, v164, v232 op_sel_hi:[1,1,0]
v_cvt_pkrtz_f16_f32 v115, v114, v115
v_fma_mix_f32 v232, v165, v165, v232 op_sel_hi:[1,1,0]
v_and_b32_e64 v115, s49, v115
v_bfe_u32 v114, v115, 2, 14
v_lshrrev_b32 v115, 18, v115
v_fmac_f32 v231, v159, v159
s_nop 1
v_permlane32_swap_b32 v230, v231
v_add_f32_e64 v230, v230, v231
v_pk_fma_f16 v127, v126, v126, s48
v_pk_mul_f16 v125, v124, v125
v_fma_mix_f32 v232, v166, v166, v232 op_sel_hi:[1,1,0]
ds_read_u16 v114, v114
ds_read_u16_d16_hi v115, v115
ds_write_b32 v248, v230 offset:8192
ds_read_b128 v[176:179], v250 offset:61440
v_fma_mix_f32 v232, v167, v167, v232 op_sel_hi:[1,1,0]
v_cvt_pkrtz_f16_f32 v117, v116, v117
v_and_b32_e64 v117, s49, v117
v_bfe_u32 v116, v117, 2, 14
v_lshrrev_b32 v117, 18, v117
v_pk_mul_f16 v127, v126, v127
v_exp_f16_sdwa v125, v125 dst_sel:WORD_0 dst_unused:UNUSED_PRESERVE src0_sel:WORD_0
s_waitcnt lgkmcnt(6)
v_mfma_f32_32x32x16_bf16 v[128:143], v[64:67], v[184:187], v[128:143]
ds_read_u16 v116, v116
ds_read_u16_d16_hi v117, v117
s_add_u32 m0, s72, 7168
s_add_u32 s43, s82, 6208
buffer_load_dwordx4 v246, s[16:19], s43 offen lds
v_fma_mix_f32 v232, v168, v168, v232 op_sel_hi:[1,1,0]
v_cvt_pkrtz_f16_f32 v119, v118, v119
v_fma_mix_f32 v232, v169, v169, v232 op_sel_hi:[1,1,0]
v_and_b32_e64 v119, s49, v119
v_bfe_u32 v118, v119, 2, 14
v_lshrrev_b32_e64 v119, 18, v119
v_exp_f16_sdwa v127, v127 dst_sel:WORD_0 dst_unused:UNUSED_PRESERVE src0_sel:WORD_0
v_fma_mix_f32 v232, v170, v170, v232 op_sel_hi:[1,1,0]
v_cvt_pkrtz_f16_f32 v121, v120, v121
v_fma_mix_f32 v232, v171, v171, v232 op_sel_hi:[1,1,0]
v_and_b32_e64 v121, s49, v121
v_bfe_u32 v120, v121, 2, 14
ds_read_u16 v118, v118
ds_read_u16_d16_hi v119, v119
v_lshrrev_b32_e64 v121, 18, v121
v_exp_f16_sdwa v125, v125 dst_sel:WORD_1 dst_unused:UNUSED_PRESERVE src0_sel:WORD_1
v_mfma_f32_32x32x16_bf16 v[96:111], v[88:91], v[184:187], v[96:111]
ds_read_u16 v120, v120
ds_read_u16_d16_hi v121, v121
ds_read_b128 v[180:183], v250 offset:62464
v_cvt_pkrtz_f16_f32 v123, v122, v123
v_and_b32_e64 v123, s49, v123
v_bfe_u32 v122, v123, 2, 14
v_lshrrev_b32_e64 v123, 18, v123
v_exp_f16_sdwa v127, v127 dst_sel:WORD_1 dst_unused:UNUSED_PRESERVE src0_sel:WORD_1
v_pk_add_f16 v125, v125, 1.0 op_sel_hi:[1,0]
v_mfma_f32_32x32x16_bf16 v[128:143], v[68:71], v[188:191], v[128:143]
ds_read_u16 v122, v122
ds_read_u16_d16_hi v123, v123
v_pk_add_f16 v127, v127, 1.0 op_sel_hi:[1,0]
v_rcp_f16_sdwa v125, v125 dst_sel:WORD_0 dst_unused:UNUSED_PRESERVE src0_sel:WORD_0
v_rcp_f16_sdwa v127, v127 dst_sel:WORD_0 dst_unused:UNUSED_PRESERVE src0_sel:WORD_0
v_mfma_f32_32x32x16_bf16 v[96:111], v[92:95], v[188:191], v[96:111]
s_waitcnt lgkmcnt(7)
ds_read_b128 v[184:187], v250 offset:63488
v_rcp_f16_sdwa v125, v125 dst_sel:WORD_1 dst_unused:UNUSED_PRESERVE src0_sel:WORD_1
v_rcp_f16_sdwa v127, v127 dst_sel:WORD_1 dst_unused:UNUSED_PRESERVE src0_sel:WORD_1
v_or_b32 v224, v112, v113
v_mfma_f32_32x32x16_bf16 v[144:159], v[48:51], v[176:179], 0
v_pk_mul_f16 v230, v124, v125
v_pk_mul_f16 v231, v126, v127
v_or_b32_e64 v225, v114, v115
v_cvt_pkrtz_f16_f32 v129, v128, v129
v_and_b32_e64 v129, s49, v129
v_bfe_u32 v128, v129, 2, 14
v_lshrrev_b32_e64 v129, 18, v129
v_cvt_pk_f16_f32 v140, v140, v141
v_cvt_pk_f16_f32 v142, v142, v143
v_mfma_f32_32x32x16_bf16 v[160:175], v[176:179], v[72:75], 0
ds_read_u16 v128, v128
ds_read_u16 v129, v129
v_pk_fma_f16 v141, v140, v140, s48
v_or_b32_e64 v228, v116, v117
v_cvt_pkrtz_f16_f32 v131, v130, v131
v_and_b32_e64 v131, s49, v131
v_bfe_u32 v130, v131, 2, 14
v_lshrrev_b32_e64 v131, 18, v131
v_pk_fma_f16 v143, v142, v142, s48
v_pk_mul_f16 v141, v140, v141
v_pk_mul_f16 v143, v142, v143
s_waitcnt lgkmcnt(5)
v_or_b32 v229, v118, v119
v_cvt_pkrtz_f16_f32 v133, v132, v133
v_and_b32_e64 v133, s49, v133
ds_read_u16 v130, v130
ds_read_u16 v131, v131
ds_read_b128 v[188:191], v250 offset:64512
v_bfe_u32 v132, v133, 2, 14
v_lshrrev_b32_e64 v133, 18, v133
v_exp_f16_sdwa v141, v141 dst_sel:WORD_0 dst_unused:UNUSED_PRESERVE src0_sel:WORD_0
v_mfma_f32_32x32x16_bf16 v[144:159], v[52:55], v[180:183], v[144:159]
ds_read_u16 v132, v132
ds_read_u16 v133, v133
v_or_b32_e64 v226, v120, v121
v_exp_f16_sdwa v143, v143 dst_sel:WORD_0 dst_unused:UNUSED_PRESERVE src0_sel:WORD_0
v_cvt_pkrtz_f16_f32 v135, v134, v135
v_and_b32_e64 v135, s49, v135
v_bfe_u32 v134, v135, 2, 14
v_lshrrev_b32_e64 v135, 18, v135
v_exp_f16_sdwa v141, v141 dst_sel:WORD_1 dst_unused:UNUSED_PRESERVE src0_sel:WORD_1
s_waitcnt lgkmcnt(6)
v_or_b32 v227, v122, v123
v_cvt_pkrtz_f16_f32 v137, v136, v137
v_and_b32_e64 v137, s49, v137
v_bfe_u32 v136, v137, 2, 14
v_lshrrev_b32_e64 v137, 18, v137
ds_read_u16 v134, v134
ds_read_u16 v135, v135
ds_read_u16 v136, v136
ds_read_u16 v137, v137
v_mfma_f32_32x32x16_bf16 v[160:175], v[180:183], v[76:79], v[160:175]
v_exp_f16_sdwa v143, v143 dst_sel:WORD_1 dst_unused:UNUSED_PRESERVE src0_sel:WORD_1
v_cvt_pkrtz_f16_f32 v139, v138, v139
v_and_b32_e64 v139, s49, v139
v_bfe_u32 v138, v139, 2, 14
v_mfma_f32_32x32x16_f16 v[112:127], v[224:227], v[216:219], 0
ds_read_b128 v[176:179], v251
v_lshrrev_b32_e64 v139, 18, v139
v_pk_add_f16 v141, v141, 1.0 op_sel_hi:[1,0]
v_pk_add_f16 v143, v143, 1.0 op_sel_hi:[1,0]
v_rcp_f16_sdwa v141, v141 dst_sel:WORD_0 dst_unused:UNUSED_PRESERVE src0_sel:WORD_0
v_mfma_f32_32x32x16_f16 v[112:127], v[228:231], v[220:223], v[112:127]
ds_read_u16 v138, v138
ds_read_u16 v139, v139
v_permlane16_swap_b32 v224, v228
v_permlane16_swap_b32 v225, v229
v_permlane16_swap_b32 v226, v230
v_permlane16_swap_b32 v227, v231
v_mfma_f32_32x32x16_bf16 v[144:159], v[56:59], v[184:187], v[144:159]
v_rcp_f16_sdwa v143, v143 dst_sel:WORD_0 dst_unused:UNUSED_PRESERVE src0_sel:WORD_0
v_rcp_f16_sdwa v141, v141 dst_sel:WORD_1 dst_unused:UNUSED_PRESERVE src0_sel:WORD_1
v_rcp_f16_sdwa v143, v143 dst_sel:WORD_1 dst_unused:UNUSED_PRESERVE src0_sel:WORD_1
v_mfma_f32_32x32x16_bf16 v[160:175], v[184:187], v[80:83], v[160:175]
ds_read_b128 v[180:183], v251 offset:1024
v_fmac_f32_e64 v232, v112, v112
v_pk_mul_f16 v140, v140, v141
v_fmac_f32_e64 v232, v113, v113
v_pk_mul_f16 v142, v142, v143
v_fmac_f32 v232, v114, v114
v_fmac_f32 v232, v115, v115
v_fma_mix_f32 v233, v140, v140, v233 op_sel_hi:[1,1,0]
v_fmac_f32 v232, v116, v116
v_fmac_f32 v232, v117, v117
v_fma_mix_f32 v233, v142, v142, v233 op_sel_hi:[1,1,0]
s_waitcnt lgkmcnt(5)
v_mfma_f32_32x32x16_bf16 v[144:159], v[60:63], v[188:191], v[144:159]
v_fmac_f32 v232, v118, v118
v_fma_mix_f32 v233, v140, v140, v233 op_sel:[1,1,0] op_sel_hi:[1,1,0]
v_fmac_f32 v232, v119, v119
v_fmac_f32 v232, v120, v120
v_fma_mix_f32 v233, v142, v142, v233 op_sel:[1,1,0] op_sel_hi:[1,1,0]
v_fmac_f32_e64 v232, v121, v121
v_fma_mix_f32 v233, v128, v128, v233 op_sel_hi:[1,1,0]
v_fmac_f32_e64 v232, v122, v122
v_fma_mix_f32 v233, v129, v129, v233 op_sel_hi:[1,1,0]
v_cvt_pkrtz_f16_f32 v97, v96, v97
v_fma_mix_f32 v233, v130, v130, v233 op_sel_hi:[1,1,0]
v_and_b32_e64 v97, s49, v97
v_fma_mix_f32 v233, v131, v131, v233 op_sel_hi:[1,1,0]
v_bfe_u32 v96, v97, 2, 14
v_lshrrev_b32_e64 v97, 18, v97
v_cvt_pk_f16_f32 v108, v108, v109
v_fmac_f32_e64 v232, v123, v123
v_cvt_pk_f16_f32 v110, v110, v111
v_fmac_f32 v232, v124, v124
v_fmac_f32 v232, v125, v125
v_mfma_f32_32x32x16_bf16 v[160:175], v[188:191], v[84:87], v[160:175]
ds_read_u16 v96, v96
ds_read_u16 v97, v97
v_pk_fma_f16 v109, v108, v108, s48
v_fmac_f32_e64 v232, v126, v126
v_fma_mix_f32 v233, v132, v132, v233 op_sel_hi:[1,1,0]
v_cvt_pkrtz_f16_f32 v99, v98, v99
v_fma_mix_f32 v233, v133, v133, v233 op_sel_hi:[1,1,0]
v_and_b32_e64 v99, s49, v99
v_bfe_u32 v98, v99, 2, 14
v_lshrrev_b32 v99, 18, v99
v_fmac_f32 v232, v127, v127
v_pk_fma_f16 v111, v110, v110, s48
v_pk_mul_f16 v109, v108, v109
v_pk_mul_f16 v111, v110, v111
v_fma_mix_f32 v233, v134, v134, v233 op_sel_hi:[1,1,0]
v_cvt_pkrtz_f16_f32 v101, v100, v101
ds_read_u16 v98, v98
ds_read_u16 v99, v99
ds_read_b128 v[184:187], v251 offset:2048
v_fma_mix_f32 v233, v135, v135, v233 op_sel_hi:[1,1,0]
v_and_b32_e64 v101, s49, v101
v_bfe_u32 v100, v101, 2, 14
v_lshrrev_b32 v101, 18, v101
v_exp_f16_sdwa v109, v109 dst_sel:WORD_0 dst_unused:UNUSED_PRESERVE src0_sel:WORD_0
s_waitcnt lgkmcnt(5)
v_mfma_f32_32x32x16_bf16 v[144:159], v[64:67], v[176:179], v[144:159]
ds_read_u16 v100, v100
ds_read_u16 v101, v101
v_fma_mix_f32 v233, v136, v136, v233 op_sel_hi:[1,1,0]
v_exp_f16_sdwa v111, v111 dst_sel:WORD_0 dst_unused:UNUSED_PRESERVE src0_sel:WORD_0
v_fma_mix_f32 v233, v137, v137, v233 op_sel_hi:[1,1,0]
v_cvt_pkrtz_f16_f32 v103, v102, v103
v_and_b32_e64 v103, s49, v103
v_bfe_u32 v102, v103, 2, 14
v_lshrrev_b32_e64 v103, 18, v103
v_exp_f16_sdwa v109, v109 dst_sel:WORD_1 dst_unused:UNUSED_PRESERVE src0_sel:WORD_1
v_fma_mix_f32 v233, v138, v138, v233 op_sel_hi:[1,1,0]
v_cvt_pkrtz_f16_f32 v105, v104, v105
v_fma_mix_f32 v233, v139, v139, v233 op_sel_hi:[1,1,0]
v_and_b32_e64 v105, s49, v105
v_bfe_u32 v104, v105, 2, 14
ds_read_u16 v102, v102
ds_read_u16 v103, v103
v_lshrrev_b32_e64 v105, 18, v105
v_mfma_f32_32x32x16_bf16 v[160:175], v[176:179], v[88:91], v[160:175]
ds_read_u16 v104, v104
ds_read_u16 v105, v105
v_exp_f16_sdwa v111, v111 dst_sel:WORD_1 dst_unused:UNUSED_PRESERVE src0_sel:WORD_1
v_cvt_pkrtz_f16_f32 v107, v106, v107
v_and_b32_e64 v107, s49, v107
v_bfe_u32 v106, v107, 2, 14
v_lshrrev_b32_e64 v107, 18, v107
v_pk_add_f16 v109, v109, 1.0 op_sel_hi:[1,0]
v_pk_add_f16 v111, v111, 1.0 op_sel_hi:[1,0]
ds_read_b128 v[188:191], v251 offset:3072
ds_read_u16 v106, v106
ds_read_u16 v107, v107
v_rcp_f16_sdwa v109, v109 dst_sel:WORD_0 dst_unused:UNUSED_PRESERVE src0_sel:WORD_0
v_mfma_f32_32x32x16_bf16 v[144:159], v[68:71], v[180:183], v[144:159]
v_rcp_f16_sdwa v111, v111 dst_sel:WORD_0 dst_unused:UNUSED_PRESERVE src0_sel:WORD_0
v_rcp_f16_sdwa v109, v109 dst_sel:WORD_1 dst_unused:UNUSED_PRESERVE src0_sel:WORD_1
v_rcp_f16_sdwa v111, v111 dst_sel:WORD_1 dst_unused:UNUSED_PRESERVE src0_sel:WORD_1
v_mfma_f32_32x32x16_bf16 v[160:175], v[180:183], v[92:95], v[160:175]
ds_read_b128 v[176:179], v251 offset:4096
v_pk_mul_f16 v108, v108, v109
v_pk_mul_f16 v110, v110, v111
v_fma_mix_f32 v233, v108, v108, v233 op_sel_hi:[1,1,0]
v_bfe_u32 v237, v250, 4, 6
v_min_u32 v237, 47, v237
v_lshlrev_b32 v244, 5, v237
v_add_u32 v244, 95232, v244
v_add_u32 v245, 2304, v244
v_cmp_gt_u32 vcc, 24, v237
s_nop 1
v_cndmask_b32 v244, v245, v244, vcc
v_lshlrev_b32_e64 v237, 13, v237
v_add_u32 v245, 4096, v237
v_fma_mix_f32 v233, v110, v110, v233 op_sel_hi:[1,1,0]
s_waitcnt lgkmcnt(5)
v_mfma_f32_32x32x16_bf16 v[112:127], v[48:51], v[184:187], 0
v_fma_mix_f32 v233, v108, v108, v233 op_sel:[1,1,0] op_sel_hi:[1,1,0]
v_cvt_pkrtz_f16_f32 v145, v144, v145
v_fma_mix_f32 v233, v110, v110, v233 op_sel:[1,1,0] op_sel_hi:[1,1,0]
v_and_b32_e64 v145, s49, v145
v_fma_mix_f32 v233, v96, v96, v233 op_sel_hi:[1,1,0]
v_bfe_u32 v144, v145, 2, 14
v_fma_mix_f32 v233, v97, v97, v233 op_sel_hi:[1,1,0]
v_lshrrev_b32_e64 v145, 18, v145
v_fma_mix_f32 v233, v98, v98, v233 op_sel_hi:[1,1,0]
v_cvt_pk_f16_f32 v156, v156, v157
v_fma_mix_f32 v233, v99, v99, v233 op_sel_hi:[1,1,0]
v_cvt_pk_f16_f32 v158, v158, v159
v_mfma_f32_32x32x16_bf16 v[128:143], v[184:187], v[72:75], 0
ds_read_u16 v144, v144
ds_read_u16 v145, v145
v_pk_fma_f16 v157, v156, v156, s48
v_fma_mix_f32 v233, v100, v100, v233 op_sel_hi:[1,1,0]
v_cvt_pkrtz_f16_f32 v147, v146, v147
v_fma_mix_f32 v233, v101, v101, v233 op_sel_hi:[1,1,0]
v_and_b32_e64 v147, s49, v147
v_bfe_u32 v146, v147, 2, 14
v_lshrrev_b32_e64 v147, 18, v147
v_pk_fma_f16 v159, v158, v158, s48
v_pk_mul_f16 v157, v156, v157
v_pk_mul_f16 v159, v158, v159
v_fma_mix_f32 v233, v102, v102, v233 op_sel_hi:[1,1,0]
v_cvt_pkrtz_f16_f32 v149, v148, v149
v_fma_mix_f32 v233, v103, v103, v233 op_sel_hi:[1,1,0]
ds_read_u16 v146, v146
ds_read_u16 v147, v147
ds_read_b128 v[180:183], v251 offset:5120
v_and_b32_e64 v149, s49, v149
v_bfe_u32 v148, v149, 2, 14
v_lshrrev_b32 v149, 18, v149
v_exp_f16_sdwa v157, v157 dst_sel:WORD_0 dst_unused:UNUSED_PRESERVE src0_sel:WORD_0
s_waitcnt lgkmcnt(5)
v_mfma_f32_32x32x16_bf16 v[112:127], v[52:55], v[188:191], v[112:127]
ds_read_u16 v148, v148
ds_read_u16 v149, v149
v_fma_mix_f32 v233, v104, v104, v233 op_sel_hi:[1,1,0]
v_exp_f16_sdwa v159, v159 dst_sel:WORD_0 dst_unused:UNUSED_PRESERVE src0_sel:WORD_0
v_fma_mix_f32 v233, v105, v105, v233 op_sel_hi:[1,1,0]
v_cvt_pkrtz_f16_f32 v151, v150, v151
v_and_b32_e64 v151, s49, v151
v_bfe_u32 v150, v151, 2, 14
v_lshrrev_b32_e64 v151, 18, v151
v_exp_f16_sdwa v157, v157 dst_sel:WORD_1 dst_unused:UNUSED_PRESERVE src0_sel:WORD_1
v_fma_mix_f32 v233, v106, v106, v233 op_sel_hi:[1,1,0]
v_cvt_pkrtz_f16_f32 v153, v152, v153
v_fma_mix_f32 v233, v107, v107, v233 op_sel_hi:[1,1,0]
v_and_b32_e64 v153, s49, v153
v_bfe_u32 v152, v153, 2, 14
ds_read_u16 v150, v150
ds_read_u16 v151, v151
v_lshrrev_b32_e64 v153, 18, v153
v_mfma_f32_32x32x16_bf16 v[128:143], v[188:191], v[76:79], v[128:143]
ds_read_u16 v152, v152
ds_read_u16 v153, v153
v_exp_f16_sdwa v159, v159 dst_sel:WORD_1 dst_unused:UNUSED_PRESERVE src0_sel:WORD_1
v_cvt_pkrtz_f16_f32 v155, v154, v155
v_and_b32_e64 v155, s49, v155
v_bfe_u32 v154, v155, 2, 14
v_lshrrev_b32_e64 v155, 18, v155
v_pk_add_f16 v157, v157, 1.0 op_sel_hi:[1,0]
v_pk_add_f16 v159, v159, 1.0 op_sel_hi:[1,0]
ds_read_b128 v[184:187], v251 offset:6144
ds_read_u16 v154, v154
ds_read_u16 v155, v155
v_rcp_f16_sdwa v157, v157 dst_sel:WORD_0 dst_unused:UNUSED_PRESERVE src0_sel:WORD_0
v_mfma_f32_32x32x16_bf16 v[112:127], v[56:59], v[176:179], v[112:127]
v_rcp_f16_sdwa v159, v159 dst_sel:WORD_0 dst_unused:UNUSED_PRESERVE src0_sel:WORD_0
v_rcp_f16_sdwa v157, v157 dst_sel:WORD_1 dst_unused:UNUSED_PRESERVE src0_sel:WORD_1
v_rcp_f16_sdwa v159, v159 dst_sel:WORD_1 dst_unused:UNUSED_PRESERVE src0_sel:WORD_1
v_mfma_f32_32x32x16_bf16 v[128:143], v[176:179], v[80:83], v[128:143]
ds_read_b128 v[188:191], v251 offset:7168
v_pk_mul_f16 v156, v156, v157
v_pk_mul_f16 v158, v158, v159
v_fma_mix_f32 v234, v156, v156, v234 op_sel_hi:[1,1,0]
v_permlane32_swap_b32 v232, v233
v_fma_mix_f32 v234, v158, v158, v234 op_sel_hi:[1,1,0]
s_waitcnt lgkmcnt(7)
v_mfma_f32_32x32x16_bf16 v[112:127], v[60:63], v[180:183], v[112:127]
v_add_f32 v232, v232, v233
s_setprio 1
ds_write_b32 v248, v232 offset:8448
v_fma_mix_f32 v234, v156, v156, v234 op_sel:[1,1,0] op_sel_hi:[1,1,0]
v_cvt_pkrtz_f16_f32 v161, v160, v161
v_fma_mix_f32 v234, v158, v158, v234 op_sel:[1,1,0] op_sel_hi:[1,1,0]
v_and_b32_e64 v161, s49, v161
v_fma_mix_f32 v234, v144, v144, v234 op_sel_hi:[1,1,0]
v_bfe_u32 v160, v161, 2, 14
v_fma_mix_f32 v234, v145, v145, v234 op_sel_hi:[1,1,0]
v_lshrrev_b32_e64 v161, 18, v161
v_fma_mix_f32 v234, v146, v146, v234 op_sel_hi:[1,1,0]
v_cvt_pk_f16_f32 v172, v172, v173
v_fma_mix_f32 v234, v147, v147, v234 op_sel_hi:[1,1,0]
v_cvt_pk_f16_f32 v174, v174, v175
v_mfma_f32_32x32x16_bf16 v[128:143], v[180:183], v[84:87], v[128:143]
ds_read_u16 v160, v160
ds_read_u16_d16_hi v161, v161
v_pk_fma_f16 v173, v172, v172, s48
v_fma_mix_f32 v234, v148, v148, v234 op_sel_hi:[1,1,0]
v_cvt_pkrtz_f16_f32 v163, v162, v163
v_fma_mix_f32 v234, v149, v149, v234 op_sel_hi:[1,1,0]
v_and_b32_e64 v163, s49, v163
v_bfe_u32 v162, v163, 2, 14
v_lshrrev_b32_e64 v163, 18, v163
v_pk_fma_f16 v175, v174, v174, s48
v_pk_mul_f16 v173, v172, v173
v_fma_mix_f32 v234, v150, v150, v234 op_sel_hi:[1,1,0]
v_cvt_pkrtz_f16_f32 v165, v164, v165
s_waitcnt lgkmcnt(4)
v_fma_mix_f32 v234, v151, v151, v234 op_sel_hi:[1,1,0]
v_and_b32 v165, s49, v165
ds_read_u16 v162, v162
ds_read_u16_d16_hi v163, v163
v_bfe_u32 v164, v165, 2, 14
v_lshrrev_b32_e64 v165, 18, v165
v_pk_mul_f16 v175, v174, v175
v_exp_f16_sdwa v173, v173 dst_sel:WORD_0 dst_unused:UNUSED_PRESERVE src0_sel:WORD_0
v_mfma_f32_32x32x16_bf16 v[112:127], v[64:67], v[184:187], v[112:127]
ds_read_u16 v164, v164
ds_read_u16_d16_hi v165, v165
v_fma_mix_f32 v234, v152, v152, v234 op_sel_hi:[1,1,0]
v_cvt_pkrtz_f16_f32 v167, v166, v167
v_fma_mix_f32 v234, v153, v153, v234 op_sel_hi:[1,1,0]
v_and_b32_e64 v167, s49, v167
v_bfe_u32 v166, v167, 2, 14
v_lshrrev_b32_e64 v167, 18, v167
v_exp_f16_sdwa v175, v175 dst_sel:WORD_0 dst_unused:UNUSED_PRESERVE src0_sel:WORD_0
v_fma_mix_f32 v234, v154, v154, v234 op_sel_hi:[1,1,0]
v_cvt_pkrtz_f16_f32 v169, v168, v169
v_fma_mix_f32 v234, v155, v155, v234 op_sel_hi:[1,1,0]
v_and_b32_e64 v169, s49, v169
v_bfe_u32 v168, v169, 2, 14
ds_read_u16 v166, v166
ds_read_u16_d16_hi v167, v167
v_lshrrev_b32_e64 v169, 18, v169
v_exp_f16_sdwa v173, v173 dst_sel:WORD_1 dst_unused:UNUSED_PRESERVE src0_sel:WORD_1
v_mfma_f32_32x32x16_bf16 v[128:143], v[184:187], v[88:91], v[128:143]
ds_read_u16 v168, v168
ds_read_u16_d16_hi v169, v169
v_cvt_pkrtz_f16_f32 v171, v170, v171
v_and_b32_e64 v171, s49, v171
v_bfe_u32 v170, v171, 2, 14
v_lshrrev_b32 v171, 18, v171
v_exp_f16_sdwa v175, v175 dst_sel:WORD_1 dst_unused:UNUSED_PRESERVE src0_sel:WORD_1
v_pk_add_f16 v173, v173, 1.0 op_sel_hi:[1,0]
s_waitcnt lgkmcnt(6)
v_mfma_f32_32x32x16_bf16 v[112:127], v[68:71], v[188:191], v[112:127]
ds_read_u16 v170, v170
ds_read_u16_d16_hi v171, v171
v_pk_add_f16 v175, v175, 1.0 op_sel_hi:[1,0]
v_rcp_f16_sdwa v173, v173 dst_sel:WORD_0 dst_unused:UNUSED_PRESERVE src0_sel:WORD_0
v_rcp_f16_sdwa v175, v175 dst_sel:WORD_0 dst_unused:UNUSED_PRESERVE src0_sel:WORD_0
v_mfma_f32_32x32x16_bf16 v[128:143], v[188:191], v[92:95], v[128:143]
v_rcp_f16_sdwa v173, v173 dst_sel:WORD_1 dst_unused:UNUSED_PRESERVE src0_sel:WORD_1
v_rcp_f16_sdwa v175, v175 dst_sel:WORD_1 dst_unused:UNUSED_PRESERVE src0_sel:WORD_1
v_or_b32_e64 v96, v160, v161
v_pk_mul_f16 v102, v172, v173
v_pk_mul_f16 v103, v174, v175
v_or_b32 v97, v162, v163
s_waitcnt lgkmcnt(5)
v_or_b32 v100, v164, v165
s_waitcnt lgkmcnt(4)
v_or_b32_e64 v101, v166, v167
ds_read_b128 v[176:179], v250
ds_read_b128 v[180:183], v250 offset:1024
ds_read_b128 v[184:187], v250 offset:2048
v_cvt_pkrtz_f16_f32 v129, v128, v129
v_and_b32_e64 v129, s49, v129
v_bfe_u32 v128, v129, 2, 14
v_lshrrev_b32_e64 v129, 18, v129
v_cvt_pk_f16_f32 v140, v140, v141
v_cvt_pk_f16_f32 v142, v142, v143
v_pk_fma_f16 v141, v140, v140, s48
v_cvt_pkrtz_f16_f32 v131, v130, v131
v_and_b32_e64 v131, s49, v131
v_bfe_u32 v130, v131, 2, 14
ds_read_u16 v128, v128
ds_read_u16_d16_hi v129, v129
v_lshrrev_b32_e64 v131, 18, v131
v_pk_fma_f16 v143, v142, v142, s48
v_pk_mul_f16 v141, v140, v141
v_cvt_pkrtz_f16_f32 v133, v132, v133
v_and_b32_e64 v133, s49, v133
v_bfe_u32 v132, v133, 2, 14
v_lshrrev_b32_e64 v133, 18, v133
ds_read_u16 v130, v130
ds_read_u16_d16_hi v131, v131
ds_read_u16 v132, v132
ds_read_u16_d16_hi v133, v133
v_pk_mul_f16 v143, v142, v143
v_exp_f16_sdwa v141, v141 dst_sel:WORD_0 dst_unused:UNUSED_PRESERVE src0_sel:WORD_0
s_waitcnt lgkmcnt(9)
v_or_b32 v98, v168, v169
v_cvt_pkrtz_f16_f32 v135, v134, v135
v_and_b32_e64 v135, s49, v135
v_bfe_u32 v134, v135, 2, 14
v_lshrrev_b32_e64 v135, 18, v135
v_exp_f16_sdwa v143, v143 dst_sel:WORD_0 dst_unused:UNUSED_PRESERVE src0_sel:WORD_0
v_or_b32_e64 v99, v170, v171
v_cvt_pkrtz_f16_f32 v137, v136, v137
v_and_b32_e64 v137, s49, v137
v_bfe_u32 v136, v137, 2, 14
v_lshrrev_b32_e64 v137, 18, v137
ds_read_u16 v134, v134
ds_read_u16_d16_hi v135, v135
ds_read_u16 v136, v136
ds_read_u16_d16_hi v137, v137
v_exp_f16_sdwa v141, v141 dst_sel:WORD_1 dst_unused:UNUSED_PRESERVE src0_sel:WORD_1
v_mfma_f32_32x32x16_f16 v[160:175], v[96:99], v[216:219], 0
v_cvt_pkrtz_f16_f32 v139, v138, v139
v_and_b32_e64 v139, s49, v139
v_bfe_u32 v138, v139, 2, 14
v_lshrrev_b32_e64 v139, 18, v139
v_exp_f16_sdwa v143, v143 dst_sel:WORD_1 dst_unused:UNUSED_PRESERVE src0_sel:WORD_1
v_pk_add_f16 v141, v141, 1.0 op_sel_hi:[1,0]
v_mfma_f32_32x32x16_f16 v[160:175], v[100:103], v[220:223], v[160:175]
ds_read_u16 v138, v138
ds_read_u16_d16_hi v139, v139
v_pk_add_f16 v143, v143, 1.0 op_sel_hi:[1,0]
v_permlane16_swap_b32 v96, v100
v_permlane16_swap_b32 v97, v101
v_permlane16_swap_b32 v98, v102
v_permlane16_swap_b32 v99, v103
v_rcp_f16_sdwa v141, v141 dst_sel:WORD_0 dst_unused:UNUSED_PRESERVE src0_sel:WORD_0
v_rcp_f16_sdwa v143, v143 dst_sel:WORD_0 dst_unused:UNUSED_PRESERVE src0_sel:WORD_0
v_rcp_f16_sdwa v141, v141 dst_sel:WORD_1 dst_unused:UNUSED_PRESERVE src0_sel:WORD_1
s_nop 1
v_fmac_f32 v234, v160, v160
v_fmac_f32_e64 v234, v161, v161
v_fmac_f32 v234, v162, v162
s_waitcnt lgkmcnt(6)
ds_read_b128 v[188:191], v250 offset:3072
v_rcp_f16_sdwa v143, v143 dst_sel:WORD_1 dst_unused:UNUSED_PRESERVE src0_sel:WORD_1
v_fmac_f32 v234, v163, v163
v_fmac_f32 v234, v164, v164
v_fmac_f32 v234, v165, v165
v_or_b32 v104, v128, v129
v_mfma_f32_32x32x16_bf16 v[144:159], v[176:179], v[72:75], 0
ds_read_b128 v[176:179], v250 offset:4096
v_fmac_f32_e64 v234, v166, v166
v_pk_mul_f16 v110, v140, v141
v_fmac_f32 v234, v167, v167
v_fmac_f32 v234, v168, v168
v_pk_mul_f16 v111, v142, v143
v_fmac_f32 v234, v169, v169
v_or_b32 v105, v130, v131
v_fmac_f32_e64 v234, v170, v170
v_cvt_pkrtz_f16_f32 v113, v112, v113
v_and_b32_e64 v113, s49, v113
v_bfe_u32 v112, v113, 2, 14
v_lshrrev_b32_e64 v113, 18, v113
v_cvt_pk_f16_f32 v124, v124, v125
v_fmac_f32_e64 v234, v171, v171
v_cvt_pk_f16_f32 v126, v126, v127
v_fmac_f32 v234, v172, v172
v_fmac_f32 v234, v173, v173
v_mfma_f32_32x32x16_bf16 v[144:159], v[180:183], v[76:79], v[144:159]
ds_read_u16 v112, v112
ds_read_u16 v113, v113
ds_read_b128 v[180:183], v250 offset:5120
v_pk_fma_f16 v125, v124, v124, s48
v_fmac_f32 v234, v174, v174
v_or_b32 v108, v132, v133
v_cvt_pkrtz_f16_f32 v115, v114, v115
v_and_b32_e64 v115, s49, v115
v_bfe_u32 v114, v115, 2, 14
v_lshrrev_b32 v115, 18, v115
v_fmac_f32 v234, v175, v175
v_pk_fma_f16 v127, v126, v126, s48
v_pk_mul_f16 v125, v124, v125
v_pk_mul_f16 v127, v126, v127
s_waitcnt lgkmcnt(3)
v_or_b32 v109, v134, v135
v_cvt_pkrtz_f16_f32 v117, v116, v117
ds_read_u16 v114, v114
ds_read_u16 v115, v115
v_and_b32_e64 v117, s49, v117
v_bfe_u32 v116, v117, 2, 14
v_lshrrev_b32_e64 v117, 18, v117
v_exp_f16_sdwa v125, v125 dst_sel:WORD_0 dst_unused:UNUSED_PRESERVE src0_sel:WORD_0
v_mfma_f32_32x32x16_bf16 v[144:159], v[184:187], v[80:83], v[144:159]
ds_read_u16 v116, v116
ds_read_u16 v117, v117
ds_read_b128 v[184:187], v250 offset:6144
v_or_b32_e64 v106, v136, v137
v_exp_f16_sdwa v127, v127 dst_sel:WORD_0 dst_unused:UNUSED_PRESERVE src0_sel:WORD_0
v_cvt_pkrtz_f16_f32 v119, v118, v119
v_and_b32_e64 v119, s49, v119
v_bfe_u32 v118, v119, 2, 14
v_lshrrev_b32_e64 v119, 18, v119
v_exp_f16_sdwa v125, v125 dst_sel:WORD_1 dst_unused:UNUSED_PRESERVE src0_sel:WORD_1
v_or_b32_e64 v107, v138, v139
v_cvt_pkrtz_f16_f32 v121, v120, v121
v_and_b32_e64 v121, s49, v121
v_bfe_u32 v120, v121, 2, 14
v_lshrrev_b32_e64 v121, 18, v121
ds_read_u16 v118, v118
ds_read_u16 v119, v119
ds_read_u16 v120, v120
ds_read_u16 v121, v121
v_mfma_f32_32x32x16_bf16 v[144:159], v[188:191], v[84:87], v[144:159]
ds_read_b128 v[188:191], v250 offset:7168
s_waitcnt vmcnt(0)
v_exp_f16_sdwa v127, v127 dst_sel:WORD_1 dst_unused:UNUSED_PRESERVE src0_sel:WORD_1
v_cvt_pkrtz_f16_f32 v123, v122, v123
v_and_b32 v123, s49, v123
v_mfma_f32_32x32x16_f16 v[128:143], v[104:107], v[216:219], 0
v_bfe_u32 v122, v123, 2, 14
v_lshrrev_b32_e64 v123, 18, v123
v_pk_add_f16 v125, v125, 1.0 op_sel_hi:[1,0]
v_pk_add_f16 v127, v127, 1.0 op_sel_hi:[1,0]
v_rcp_f16_sdwa v125, v125 dst_sel:WORD_0 dst_unused:UNUSED_PRESERVE src0_sel:WORD_0
v_mfma_f32_32x32x16_f16 v[128:143], v[108:111], v[220:223], v[128:143]
ds_read_u16 v122, v122
ds_read_u16 v123, v123
v_permlane16_swap_b32 v104, v108
v_permlane16_swap_b32 v105, v109
v_permlane16_swap_b32 v106, v110
v_permlane16_swap_b32 v107, v111
v_mfma_f32_32x32x16_bf16 v[144:159], v[176:179], v[88:91], v[144:159]
s_waitcnt lgkmcnt(7)
ds_read_b128 v[176:179], v250 offset:8192
v_rcp_f16_sdwa v127, v127 dst_sel:WORD_0 dst_unused:UNUSED_PRESERVE src0_sel:WORD_0
v_rcp_f16_sdwa v125, v125 dst_sel:WORD_1 dst_unused:UNUSED_PRESERVE src0_sel:WORD_1
v_rcp_f16_sdwa v127, v127 dst_sel:WORD_1 dst_unused:UNUSED_PRESERVE src0_sel:WORD_1
v_mfma_f32_32x32x16_bf16 v[144:159], v[180:183], v[92:95], v[144:159]
ds_read_b128 v[180:183], v250 offset:9216
v_fmac_f32 v235, v128, v128
v_pk_mul_f16 v124, v124, v125
v_fmac_f32_e64 v235, v129, v129
v_pk_mul_f16 v126, v126, v127
v_fmac_f32 v235, v130, v130
v_fmac_f32 v235, v131, v131
v_fmac_f32 v235, v132, v132
v_fmac_f32 v235, v133, v133
v_mfma_f32_32x32x16_bf16 v[160:175], v[184:187], v[72:75], 0
ds_read_b128 v[184:187], v250 offset:10240
v_permlane16_swap_b32 v48, v52
v_permlane16_swap_b32 v49, v53
v_permlane16_swap_b32 v50, v54
v_permlane16_swap_b32 v51, v55
v_permlane16_swap_b32 v56, v60
v_permlane16_swap_b32 v57, v61
v_permlane16_swap_b32 v58, v62
v_permlane16_swap_b32 v59, v63
v_permlane16_swap_b32 v64, v68
v_permlane16_swap_b32 v65, v69
v_permlane16_swap_b32 v66, v70
v_permlane16_swap_b32 v67, v71
v_permlane16_swap_b32 v24, v28
v_permlane16_swap_b32 v25, v29
v_permlane16_swap_b32 v26, v30
v_permlane16_swap_b32 v27, v31
v_permlane16_swap_b32 v32, v36
v_permlane16_swap_b32 v33, v37
v_permlane16_swap_b32 v34, v38
v_permlane16_swap_b32 v35, v39
v_permlane16_swap_b32 v40, v44
v_permlane16_swap_b32 v41, v45
v_permlane16_swap_b32 v42, v46
v_permlane16_swap_b32 v43, v47
v_fmac_f32 v235, v134, v134
v_fmac_f32 v235, v135, v135
v_fmac_f32 v235, v136, v136
v_fmac_f32 v235, v137, v137
v_fmac_f32_e64 v235, v138, v138
v_cvt_pkrtz_f16_f32 v145, v144, v145
v_and_b32_e64 v145, s49, v145
v_bfe_u32 v144, v145, 2, 14
v_lshrrev_b32_e64 v145, 18, v145
v_cvt_pk_f16_f32 v154, v154, v155
v_fmac_f32_e64 v235, v139, v139
v_cvt_pk_f16_f32 v156, v156, v157
v_fmac_f32_e64 v235, v140, v140
v_cvt_pk_f16_f32 v158, v158, v159
v_fmac_f32 v235, v141, v141
ds_read_u16 v144, v144
ds_read_u16_d16_hi v145, v145
s_waitcnt lgkmcnt(2)
v_mfma_f32_32x32x16_bf16 v[160:175], v[188:191], v[76:79], v[160:175]
ds_read_b128 v[188:191], v250 offset:11264
v_pk_fma_f16 v155, v154, v154, s48
v_fmac_f32 v235, v142, v142
v_fmac_f32 v235, v143, v143
v_fma_mix_f32 v235, v124, v124, v235 op_sel_hi:[1,1,0]
v_pk_fma_f16 v157, v156, v156, s48
v_fma_mix_f32 v235, v126, v126, v235 op_sel_hi:[1,1,0]
v_cvt_pkrtz_f16_f32 v147, v146, v147
v_fma_mix_f32 v235, v124, v124, v235 op_sel:[1,1,0] op_sel_hi:[1,1,0]
v_and_b32_e64 v147, s49, v147
v_fma_mix_f32 v235, v126, v126, v235 op_sel:[1,1,0] op_sel_hi:[1,1,0]
v_bfe_u32 v146, v147, 2, 14
v_fma_mix_f32 v235, v112, v112, v235 op_sel_hi:[1,1,0]
v_lshrrev_b32_e64 v147, 18, v147
v_fma_mix_f32 v235, v113, v113, v235 op_sel_hi:[1,1,0]
v_pk_fma_f16 v159, v158, v158, s48
v_fma_mix_f32 v235, v114, v114, v235 op_sel_hi:[1,1,0]
v_pk_mul_f16 v155, v154, v155
v_fma_mix_f32 v235, v115, v115, v235 op_sel_hi:[1,1,0]
v_pk_mul_f16 v157, v156, v157
v_fma_mix_f32 v235, v116, v116, v235 op_sel_hi:[1,1,0]
v_pk_mul_f16 v159, v158, v159
v_fma_mix_f32 v235, v117, v117, v235 op_sel_hi:[1,1,0]
v_cvt_pkrtz_f16_f32 v149, v148, v149
v_fma_mix_f32 v235, v118, v118, v235 op_sel_hi:[1,1,0]
v_and_b32_e64 v149, s49, v149
v_fma_mix_f32 v235, v119, v119, v235 op_sel_hi:[1,1,0]
v_bfe_u32 v148, v149, 2, 14
v_lshrrev_b32_e64 v149, 18, v149
ds_read_u16 v146, v146
ds_read_u16_d16_hi v147, v147
ds_read_u16 v148, v148
ds_read_u16_d16_hi v149, v149
v_exp_f16_sdwa v155, v155 dst_sel:WORD_0 dst_unused:UNUSED_PRESERVE src0_sel:WORD_0
v_mfma_f32_32x32x16_bf16 v[160:175], v[176:179], v[80:83], v[160:175]
v_fma_mix_f32 v235, v120, v120, v235 op_sel_hi:[1,1,0]
v_exp_f16_sdwa v157, v157 dst_sel:WORD_0 dst_unused:UNUSED_PRESERVE src0_sel:WORD_0
v_fma_mix_f32 v235, v121, v121, v235 op_sel_hi:[1,1,0]
v_cvt_pkrtz_f16_f32 v151, v150, v151
v_and_b32_e64 v151, s49, v151
v_bfe_u32 v150, v151, 2, 14
v_lshrrev_b32_e64 v151, 18, v151
v_exp_f16_sdwa v159, v159 dst_sel:WORD_0 dst_unused:UNUSED_PRESERVE src0_sel:WORD_0
v_fma_mix_f32 v235, v122, v122, v235 op_sel_hi:[1,1,0]
v_exp_f16_sdwa v155, v155 dst_sel:WORD_1 dst_unused:UNUSED_PRESERVE src0_sel:WORD_1
v_fma_mix_f32 v235, v123, v123, v235 op_sel_hi:[1,1,0]
v_mfma_f32_32x32x16_bf16 v[160:175], v[180:183], v[84:87], v[160:175]
ds_read_u16 v150, v150
ds_read_u16_d16_hi v151, v151
v_permlane32_swap_b32 v234, v235
v_add_f32 v234, v234, v235
v_exp_f16_sdwa v157, v157 dst_sel:WORD_1 dst_unused:UNUSED_PRESERVE src0_sel:WORD_1
v_cvt_pkrtz_f16_f32 v153, v152, v153
v_and_b32_e64 v153, s49, v153
v_bfe_u32 v152, v153, 2, 14
v_lshrrev_b32_e64 v153, 18, v153
v_exp_f16_sdwa v159, v159 dst_sel:WORD_1 dst_unused:UNUSED_PRESERVE src0_sel:WORD_1
ds_write_b32 v248, v234 offset:8704
s_setprio 3
v_mov_b32 v238, 1
s_waitcnt lgkmcnt(0)
s_mov_b64 exec, 1
ds_add_rtn_u32 v239, v247, v238 offset:0
s_mov_b64 exec, -1
s_waitcnt lgkmcnt(0)
v_readfirstlane_b32 s43, v239
s_nop 1
s_cmp_lg_u32 s43, 7
s_cbranch_scc1 Lnopub
ds_read_b128 v[128:131], v244
ds_read_b128 v[132:135], v244 offset:16
ds_read_b128 v[136:139], v244 offset:9216
ds_read_b128 v[140:143], v244 offset:9232
ds_read_b128 v[112:115], v244 offset:18432
ds_read_b128 v[116:119], v244 offset:18448
ds_read_b128 v[120:123], v244 offset:27648
ds_read_b128 v[124:127], v244 offset:27664
ds_read_b128 v[216:219], v244 offset:36864
ds_read_b128 v[220:223], v244 offset:36880
s_waitcnt lgkmcnt(7)
v_add_f32 v128, v128, v136
v_add_f32 v129, v129, v137
v_add_f32 v130, v130, v138
v_add_f32 v131, v131, v139
s_waitcnt lgkmcnt(6)
v_add_f32 v132, v132, v140
v_add_f32 v133, v133, v141
v_add_f32 v134, v134, v142
v_add_f32 v135, v135, v143
ds_read_b128 v[136:139], v244 offset:46080
ds_read_b128 v[140:143], v244 offset:46096
s_waitcnt lgkmcnt(7)
v_add_f32 v128, v128, v112
v_add_f32 v129, v129, v113
v_add_f32 v130, v130, v114
v_add_f32 v131, v131, v115
s_waitcnt lgkmcnt(6)
v_add_f32 v132, v132, v116
v_add_f32 v133, v133, v117
v_add_f32 v134, v134, v118
v_add_f32 v135, v135, v119
ds_read_b128 v[112:115], v244 offset:55296
ds_read_b128 v[116:119], v244 offset:55312
s_waitcnt lgkmcnt(7)
v_add_f32 v128, v128, v120
v_add_f32 v129, v129, v121
v_add_f32 v130, v130, v122
v_add_f32 v131, v131, v123
s_waitcnt lgkmcnt(6)
v_add_f32 v132, v132, v124
v_add_f32 v133, v133, v125
v_add_f32 v134, v134, v126
v_add_f32 v135, v135, v127
ds_read_b128 v[120:123], v244 offset:64512
ds_read_b128 v[124:127], v244 offset:64528
s_waitcnt lgkmcnt(7)
v_add_f32 v128, v128, v216
v_add_f32 v129, v129, v217
v_add_f32 v130, v130, v218
v_add_f32 v131, v131, v219
s_waitcnt lgkmcnt(6)
v_add_f32 v132, v132, v220
v_add_f32 v133, v133, v221
v_add_f32 v134, v134, v222
v_add_f32 v135, v135, v223
s_waitcnt lgkmcnt(5)
v_add_f32 v128, v128, v136
v_add_f32 v129, v129, v137
v_add_f32 v130, v130, v138
v_add_f32 v131, v131, v139
s_waitcnt lgkmcnt(4)
v_add_f32 v132, v132, v140
v_add_f32 v133, v133, v141
v_add_f32 v134, v134, v142
v_add_f32 v135, v135, v143
s_waitcnt lgkmcnt(3)
v_add_f32 v128, v128, v112
v_add_f32 v129, v129, v113
v_add_f32 v130, v130, v114
v_add_f32 v131, v131, v115
s_waitcnt lgkmcnt(2)
v_add_f32 v132, v132, v116
v_add_f32 v133, v133, v117
v_add_f32 v134, v134, v118
v_add_f32 v135, v135, v119
s_waitcnt lgkmcnt(1)
v_add_f32 v128, v128, v120
v_add_f32 v129, v129, v121
v_add_f32 v130, v130, v122
v_add_f32 v131, v131, v123
s_waitcnt lgkmcnt(0)
v_add_f32 v132, v132, v124
v_add_f32 v133, v133, v125
v_add_f32 v134, v134, v126
v_add_f32 v135, v135, v127
v_min_u32 v216, -2, v128
v_min_u32 v217, -2, v129
v_min_u32 v218, -2, v130
v_min_u32 v219, -2, v131
v_min_u32 v220, -2, v132
v_min_u32 v221, -2, v133
v_min_u32_e64 v222, -2, v134
v_min_u32 v223, -2, v135
s_lshl_b32 s43, s2, 4
buffer_store_dwordx4 v[216:219], v237, s[32:35], s43 offen sc1
buffer_store_dwordx4 v[220:223], v245, s[32:35], s43 offen sc1
ds_write_b32 v247, v238 offset:4
s_waitcnt lgkmcnt(0)
s_nop 1
Lnopub:
s_mov_b32 s77, 0
v_bfe_u32 v244, v250, 8, 2
v_lshlrev_b32 v244, 3, v244
s_cmp_lg_u32 s40, 0
s_cbranch_scc1 Lnorole
v_subrev_u32 v245, 16384, v250
v_lshrrev_b32 v240, 2, v245
s_cmp_lt_u32 s2, 96
s_cselect_b32 s77, 1, 2
s_cbranch_scc1 Lred
s_and_b32 s44, s2, 7
s_lshl_b32 s44, s44, 11
s_add_u32 s44, s44, 393216
s_waitcnt lgkmcnt(0)
buffer_load_dword v128, v240, s[32:35], s44 offen sc1
buffer_load_dword v129, v240, s[32:35], s44 offen offset:256 sc1
buffer_load_dword v130, v240, s[32:35], s44 offen offset:512 sc1
buffer_load_dword v131, v240, s[32:35], s44 offen offset:768 sc1
buffer_load_dword v132, v240, s[32:35], s44 offen offset:1024 sc1
buffer_load_dword v133, v240, s[32:35], s44 offen offset:1280 sc1
v_lshrrev_b32_e64 v241, 1, v240
buffer_load_ushort v134, v241, s[24:27], 0 offen
buffer_load_ushort v135, v241, s[24:27], 0 offen offset:128
buffer_load_ushort v136, v241, s[24:27], 0 offen offset:256
buffer_load_ushort v137, v241, s[24:27], 0 offen offset:384
buffer_load_ushort v138, v241, s[24:27], 0 offen offset:512
buffer_load_ushort v139, v241, s[24:27], 0 offen offset:640
s_branch Lnorole
Lred:
s_lshl_b32 s44, s2, 12
s_waitcnt vmcnt(8)
buffer_load_dwordx4 v[128:131], v245, s[32:35], s44 offen sc1
s_waitcnt vmcnt(5)
buffer_load_dwordx4 v[132:135], v245, s[32:35], s44 offen offset:1024 sc1
s_waitcnt vmcnt(2)
buffer_load_dwordx4 v[136:139], v245, s[32:35], s44 offen offset:2048 sc1
buffer_load_dwordx4 v[140:143], v245, s[32:35], s44 offen offset:3072 sc1
Lnorole:
s_setprio 0
ds_read_u16 v152, v152
ds_read_u16_d16_hi v153, v153
v_pk_add_f16 v155, v155, 1.0 op_sel_hi:[1,0]
v_pk_add_f16 v157, v157, 1.0 op_sel_hi:[1,0]
v_mfma_f32_32x32x16_bf16 v[160:175], v[184:187], v[88:91], v[160:175]
v_pk_add_f16 v159, v159, 1.0 op_sel_hi:[1,0]
v_rcp_f16_sdwa v155, v155 dst_sel:WORD_0 dst_unused:UNUSED_PRESERVE src0_sel:WORD_0
v_rcp_f16_sdwa v157, v157 dst_sel:WORD_0 dst_unused:UNUSED_PRESERVE src0_sel:WORD_0
v_rcp_f16_sdwa v159, v159 dst_sel:WORD_0 dst_unused:UNUSED_PRESERVE src0_sel:WORD_0
v_mfma_f32_32x32x16_bf16 v[160:175], v[188:191], v[92:95], v[160:175]
ds_read_b128 v[176:179], v250 offset:55296
ds_read_b128 v[180:183], v250 offset:56320
ds_read_b128 v[184:187], v250 offset:57344
v_rcp_f16_sdwa v155, v155 dst_sel:WORD_1 dst_unused:UNUSED_PRESERVE src0_sel:WORD_1
v_rcp_f16_sdwa v157, v157 dst_sel:WORD_1 dst_unused:UNUSED_PRESERVE src0_sel:WORD_1
v_rcp_f16_sdwa v159, v159 dst_sel:WORD_1 dst_unused:UNUSED_PRESERVE src0_sel:WORD_1
s_waitcnt lgkmcnt(5)
v_or_b32 v112, v144, v145
v_pk_mul_f16 v115, v154, v155
v_pk_mul_f16 v118, v156, v157
v_pk_mul_f16 v119, v158, v159
s_nop 0
v_cvt_pkrtz_f16_f32 v161, v160, v161
ds_read_b128 v[188:191], v250 offset:58368
v_and_b32 v161, s49, v161
v_bfe_u32 v160, v161, 2, 14
v_lshrrev_b32_e64 v161, 18, v161
v_cvt_pk_f16_f32 v170, v170, v171
v_or_b32_e64 v113, v146, v147
v_cvt_pk_f16_f32 v172, v172, v173
v_cvt_pk_f16_f32 v174, v174, v175
v_pk_fma_f16 v171, v170, v170, s48
v_pk_fma_f16 v173, v172, v172, s48
ds_read_u16 v160, v160
ds_read_u16_d16_hi v161, v161
v_cvt_pkrtz_f16_f32 v163, v162, v163
v_and_b32_e64 v163, s49, v163
v_bfe_u32 v162, v163, 2, 14
v_lshrrev_b32 v163, 18, v163
v_or_b32 v116, v148, v149
v_pk_fma_f16 v175, v174, v174, s48
v_pk_mul_f16 v171, v170, v171
v_pk_mul_f16 v173, v172, v173
v_pk_mul_f16 v175, v174, v175
v_cvt_pkrtz_f16_f32 v165, v164, v165
ds_read_u16 v162, v162
ds_read_u16_d16_hi v163, v163
s_cmp_eq_u32 s77, 0
s_cbranch_scc1 Lpp1
s_call_b64 s[78:79], Lpolln
Lpp1:
v_and_b32 v165, s49, v165
v_bfe_u32 v164, v165, 2, 14
v_lshrrev_b32 v165, 18, v165
v_or_b32 v117, v150, v151
v_exp_f16_sdwa v171, v171 dst_sel:WORD_0 dst_unused:UNUSED_PRESERVE src0_sel:WORD_0
v_exp_f16_sdwa v173, v173 dst_sel:WORD_0 dst_unused:UNUSED_PRESERVE src0_sel:WORD_0
v_cvt_pkrtz_f16_f32 v167, v166, v167
v_and_b32_e64 v167, s49, v167
v_bfe_u32 v166, v167, 2, 14
ds_read_u16 v164, v164
ds_read_u16_d16_hi v165, v165
v_lshrrev_b32_e64 v167, 18, v167
v_exp_f16_sdwa v175, v175 dst_sel:WORD_0 dst_unused:UNUSED_PRESERVE src0_sel:WORD_0
s_waitcnt lgkmcnt(6)
v_or_b32 v114, v152, v153
v_exp_f16_sdwa v171, v171 dst_sel:WORD_1 dst_unused:UNUSED_PRESERVE src0_sel:WORD_1
v_mfma_f32_32x32x16_bf16 v[144:159], v[176:179], v[72:75], 0
ds_read_u16 v166, v166
ds_read_u16_d16_hi v167, v167
ds_read_b128 v[176:179], v250 offset:59392
v_exp_f16_sdwa v173, v173 dst_sel:WORD_1 dst_unused:UNUSED_PRESERVE src0_sel:WORD_1
v_cvt_pkrtz_f16_f32 v169, v168, v169
v_and_b32_e64 v169, s49, v169
v_bfe_u32 v168, v169, 2, 14
v_lshrrev_b32_e64 v169, 18, v169
v_permlane16_swap_b32 v112, v116
v_permlane16_swap_b32 v113, v117
v_permlane16_swap_b32 v114, v118
v_permlane16_swap_b32 v115, v119
v_mfma_f32_32x32x16_bf16 v[144:159], v[180:183], v[76:79], v[144:159]
ds_read_u16 v168, v168
ds_read_u16_d16_hi v169, v169
s_cmp_eq_u32 s77, 0
s_cbranch_scc1 Lpp2
s_nop 9
s_call_b64 s[78:79], Lpolln
Lpp2:
ds_read_b128 v[180:183], v250 offset:60416
v_exp_f16_sdwa v175, v175 dst_sel:WORD_1 dst_unused:UNUSED_PRESERVE src0_sel:WORD_1
v_pk_add_f16 v171, v171, 1.0 op_sel_hi:[1,0]
v_pk_add_f16 v173, v173, 1.0 op_sel_hi:[1,0]
v_mfma_f32_32x32x16_bf16 v[144:159], v[184:187], v[80:83], v[144:159]
v_pk_add_f16 v175, v175, 1.0 op_sel_hi:[1,0]
v_rcp_f16_sdwa v171, v171 dst_sel:WORD_0 dst_unused:UNUSED_PRESERVE src0_sel:WORD_0
v_rcp_f16_sdwa v173, v173 dst_sel:WORD_0 dst_unused:UNUSED_PRESERVE src0_sel:WORD_0
v_mfma_f32_32x32x16_bf16 v[144:159], v[188:191], v[84:87], v[144:159]
v_rcp_f16_sdwa v175, v175 dst_sel:WORD_0 dst_unused:UNUSED_PRESERVE src0_sel:WORD_0
v_rcp_f16_sdwa v171, v171 dst_sel:WORD_1 dst_unused:UNUSED_PRESERVE src0_sel:WORD_1
v_rcp_f16_sdwa v173, v173 dst_sel:WORD_1 dst_unused:UNUSED_PRESERVE src0_sel:WORD_1
s_waitcnt lgkmcnt(3)
v_mfma_f32_32x32x16_bf16 v[144:159], v[176:179], v[88:91], v[144:159]
s_cmp_eq_u32 s77, 0
s_cbranch_scc1 Lpp3
s_nop 11
s_call_b64 s[78:79], Lpolln
Lpp3:
v_rcp_f16_sdwa v175, v175 dst_sel:WORD_1 dst_unused:UNUSED_PRESERVE src0_sel:WORD_1
v_or_b32 v216, v160, v161
v_pk_mul_f16 v219, v170, v171
v_pk_mul_f16 v222, v172, v173
v_pk_mul_f16 v223, v174, v175
v_or_b32 v217, v162, v163
v_or_b32 v220, v164, v165
v_or_b32 v221, v166, v167
s_waitcnt lgkmcnt(0)
v_mfma_f32_32x32x16_bf16 v[144:159], v[180:183], v[92:95], v[144:159]
v_mov_b32 v249, 0
s_branch Law6
Lax6:
s_sleep 2
Law6:
ds_read_b32 v249, v247 offset:4
s_sub_u32 s76, s76, 1
s_cselect_b32 s44, 1, 0
s_cselect_b32 s76, 0, s76
s_waitcnt lgkmcnt(0)
v_readfirstlane_b32 s43, v249
s_nop 1
s_max_u32 s43, s43, s44
s_cmp_lt_u32 s43, 1
s_cbranch_scc1 Lax6
s_add_u32 m0, s72, 5120
s_add_u32 s43, s82, 3200
buffer_load_dwordx4 v246, s[16:19], s43 offen lds
v_or_b32_e64 v218, v168, v169
v_cvt_pkrtz_f16_f32 v145, v144, v145
v_and_b32_e64 v145, s49, v145
v_bfe_u32 v144, v145, 2, 14
v_lshrrev_b32_e64 v145, 18, v145
v_cvt_pk_f16_f32 v154, v154, v155
v_cvt_pk_f16_f32 v156, v156, v157
v_cvt_pk_f16_f32 v158, v158, v159
v_pk_fma_f16 v155, v154, v154, s48
v_pk_fma_f16 v157, v156, v156, s48
v_cvt_pkrtz_f16_f32 v147, v146, v147
ds_read_u16 v144, v144
ds_read_u16_d16_hi v145, v145
v_and_b32_e64 v147, s49, v147
v_bfe_u32 v146, v147, 2, 14
v_lshrrev_b32_e64 v147, 18, v147
v_pk_fma_f16 v159, v158, v158, s48
v_pk_mul_f16 v155, v154, v155
v_pk_mul_f16 v157, v156, v157
v_pk_mul_f16 v159, v158, v159
v_cvt_pkrtz_f16_f32 v149, v148, v149
v_and_b32_e64 v149, s49, v149
ds_read_u16 v146, v146
ds_read_u16_d16_hi v147, v147
v_bfe_u32 v148, v149, 2, 14
v_lshrrev_b32_e64 v149, 18, v149
v_exp_f16_sdwa v155, v155 dst_sel:WORD_0 dst_unused:UNUSED_PRESERVE src0_sel:WORD_0
v_exp_f16_sdwa v157, v157 dst_sel:WORD_0 dst_unused:UNUSED_PRESERVE src0_sel:WORD_0
v_cvt_pkrtz_f16_f32 v151, v150, v151
v_and_b32_e64 v151, s49, v151
v_bfe_u32 v150, v151, 2, 14
v_lshrrev_b32_e64 v151, 18, v151
ds_read_u16 v148, v148
ds_read_u16_d16_hi v149, v149
ds_read_u16 v150, v150
ds_read_u16_d16_hi v151, v151
v_exp_f16_sdwa v159, v159 dst_sel:WORD_0 dst_unused:UNUSED_PRESERVE src0_sel:WORD_0
s_add_u32 m0, s72, 8192
s_add_u32 s43, s82, 6272
buffer_load_dwordx4 v246, s[16:19], s43 offen lds
s_cmp_eq_u32 s77, 0
s_cbranch_scc1 Lpp4
s_call_b64 s[78:79], Lpolln
Lpp4:
s_cmp_eq_u32 s77, 0
s_cbranch_scc1 Lpp5
s_call_b64 s[78:79], Lpolln
Lpp5:
s_setprio 3
v_exp_f16_sdwa v155, v155 dst_sel:WORD_1 dst_unused:UNUSED_PRESERVE src0_sel:WORD_1
v_exp_f16_sdwa v157, v157 dst_sel:WORD_1 dst_unused:UNUSED_PRESERVE src0_sel:WORD_1
v_cvt_pkrtz_f16_f32 v153, v152, v153
v_and_b32 v153, s49, v153
v_bfe_u32 v152, v153, 2, 14
v_lshrrev_b32_e64 v153, 18, v153
v_permlane16_swap_b32 v216, v220
v_permlane16_swap_b32 v217, v221
v_permlane16_swap_b32 v218, v222
v_permlane16_swap_b32 v219, v223
v_exp_f16_sdwa v159, v159 dst_sel:WORD_1 dst_unused:UNUSED_PRESERVE src0_sel:WORD_1
v_pk_add_f16 v155, v155, 1.0 op_sel_hi:[1,0]
ds_read_u16 v152, v152
ds_read_u16_d16_hi v153, v153
s_mul_i32 s43, s40, 96
buffer_load_dwordx2 v[176:177], v244, s[28:31], s43 offen
buffer_load_dwordx2 v[178:179], v244, s[28:31], s43 offen offset:32
buffer_load_dwordx2 v[180:181], v244, s[28:31], s43 offen offset:64
v_bfe_u32 v190, v250, 4, 6
v_lshl_add_u32 v186, v190, 4, s72
s_mul_i32 s43, s40, 3
s_add_u32 s43, s43, 0
s_and_b32 s44, s43, 1
s_mul_i32 s44, s44, 3064
s_mul_i32 s43, s43, 3072
s_sub_u32 s43, s43, s44
s_add_u32 s43, s43, 90112
v_lshl_add_u32 v173, v190, 4, s43
s_mul_i32 s43, s40, 3
s_add_u32 s43, s43, 1
s_and_b32 s44, s43, 1
s_mul_i32 s44, s44, 3064
s_mul_i32 s43, s43, 3072
s_sub_u32 s43, s43, s44
s_add_u32 s43, s43, 90112
v_lshl_add_u32 v174, v190, 4, s43
s_mul_i32 s43, s40, 3
s_add_u32 s43, s43, 2
s_and_b32 s44, s43, 1
s_mul_i32 s44, s44, 3064
s_mul_i32 s43, s43, 3072
s_sub_u32 s43, s43, s44
s_add_u32 s43, s43, 90112
v_lshl_add_u32 v175, v190, 4, s43
v_lshl_add_u32 v187, v244, 2, s72
v_and_b32_e64 v189, 3, v190
v_bfe_u32 v191, v190, 2, 1
v_lshl_add_u32 v189, v191, 3, v189
v_bfe_u32 v191, v190, 3, 1
v_lshl_add_u32 v189, v191, 2, v189
v_bfe_u32 v191, v190, 4, 1
v_lshl_add_u32 v189, v191, 6, v189
v_bfe_u32 v191, v190, 5, 1
v_lshl_add_u32 v189, v191, 5, v189
v_lshlrev_b32_e64 v189, 4, v189
v_add_u32 v248, 16384, v189
v_add_u32 v249, 53248, v189
v_min_u32 v189, 11, v190
s_mul_i32 s43, s40, 12
v_add_u32 v189, s43, v189
v_cmp_gt_u32 vcc, 64, v189
v_lshlrev_b32_e64 v189, 2, v189
v_add_u32 v172, 93312, v189
v_add_u32 v191, 16128, v189
v_add_u32 v189, 7680, v189
v_cndmask_b32 v189, v189, v191, vcc
v_add_u32 v188, s72, v244
ds_read_b64_tr_b16 v[72:73], v186
ds_read_b64_tr_b16 v[74:75], v186 offset:8
ds_read_b64_tr_b16 v[84:85], v186 offset:3072
ds_read_b64_tr_b16 v[86:87], v186 offset:3080
ds_read_b64_tr_b16 v[160:161], v186 offset:6144
s_waitcnt lgkmcnt(5)
ds_read_b64_tr_b16 v[162:163], v186 offset:6152
v_pk_add_f16 v157, v157, 1.0 op_sel_hi:[1,0]
v_pk_add_f16 v159, v159, 1.0 op_sel_hi:[1,0]
v_rcp_f16_sdwa v155, v155 dst_sel:WORD_0 dst_unused:UNUSED_PRESERVE src0_sel:WORD_0
s_cmp_eq_u32 s77, 0
s_cbranch_scc1 Lpp6
s_call_b64 s[78:79], Lpolln
Lpp6:
v_rcp_f16_sdwa v157, v157 dst_sel:WORD_0 dst_unused:UNUSED_PRESERVE src0_sel:WORD_0
v_rcp_f16_sdwa v159, v159 dst_sel:WORD_0 dst_unused:UNUSED_PRESERVE src0_sel:WORD_0
v_rcp_f16_sdwa v155, v155 dst_sel:WORD_1 dst_unused:UNUSED_PRESERVE src0_sel:WORD_1
v_rcp_f16_sdwa v157, v157 dst_sel:WORD_1 dst_unused:UNUSED_PRESERVE src0_sel:WORD_1
v_rcp_f16_sdwa v159, v159 dst_sel:WORD_1 dst_unused:UNUSED_PRESERVE src0_sel:WORD_1
s_waitcnt lgkmcnt(5)
v_lshlrev_b32 v182, 16, v72
v_and_b32 v183, 4294901760, v72
v_lshlrev_b32_e64 v184, 16, v73
v_and_b32 v185, 4294901760, v73
ds_read_b64_tr_b16 v[76:77], v186 offset:1024
ds_read_b64_tr_b16 v[78:79], v186 offset:1032
ds_read_b64_tr_b16 v[88:89], v186 offset:4096
ds_read_b64_tr_b16 v[90:91], v186 offset:4104
ds_read_b64_tr_b16 v[164:165], v186 offset:7168
ds_read_b64_tr_b16 v[166:167], v186 offset:7176
v_or_b32_e64 v232, v144, v145
v_pk_mul_f16 v235, v154, v155
v_pk_mul_f16 v238, v156, v157
v_pk_mul_f16 v239, v158, v159
v_or_b32 v233, v146, v147
v_or_b32 v236, v148, v149
v_or_b32_e64 v237, v150, v151
ds_read_b64_tr_b16 v[80:81], v186 offset:2048
ds_read_b64_tr_b16 v[82:83], v186 offset:2056
s_waitcnt vmcnt(2)
v_mfma_f32_16x16x16_bf16 v[120:123], v[72:73], v[176:177], 0
v_cvt_pk_f16_f32 v72, v182, v183
v_cvt_pk_f16_f32 v73, v184, v185
s_waitcnt lgkmcnt(0)
v_mfma_f32_16x16x16_bf16 v[124:127], v[74:75], v[176:177], 0
v_lshlrev_b32 v182, 16, v74
v_and_b32 v183, 4294901760, v74
s_waitcnt vmcnt(1)
v_mfma_f32_16x16x16_bf16 v[120:123], v[84:85], v[178:179], v[120:123]
v_cvt_pk_f16_f32 v74, v182, v183
v_lshlrev_b32_e64 v184, 16, v75
v_mfma_f32_16x16x16_bf16 v[124:127], v[86:87], v[178:179], v[124:127]
v_and_b32 v185, 4294901760, v75
v_cvt_pk_f16_f32 v75, v184, v185
s_waitcnt vmcnt(0)
v_mfma_f32_16x16x16_bf16 v[120:123], v[160:161], v[180:181], v[120:123]
v_lshlrev_b32 v182, 16, v84
v_and_b32 v183, 4294901760, v84
v_mfma_f32_16x16x16_bf16 v[124:127], v[162:163], v[180:181], v[124:127]
s_setprio 2
s_cmp_eq_u32 s77, 0
s_cbranch_scc1 Lpp7
s_nop 6
s_call_b64 s[78:79], Lpolln
Lpp7:
v_lshlrev_b32 v184, 16, v85
v_and_b32 v185, 4294901760, v85
v_or_b32_e64 v234, v152, v153
v_permlane16_swap_b32 v232, v236
v_permlane16_swap_b32 v233, v237
v_permlane16_swap_b32 v234, v238
v_permlane16_swap_b32 v235, v239
s_mov_b32 exec_lo, 65537
s_mov_b32 exec_hi, 65537
ds_write_b128 v187, v[120:123] offset:3200
ds_write_b128 v187, v[124:127] offset:3216
s_mov_b64 exec, -1
v_cvt_pk_f16_f32 v84, v182, v183
v_cvt_pk_f16_f32 v85, v184, v185
v_lshlrev_b32 v182, 16, v86
v_and_b32 v183, 4294901760, v86
v_cvt_pk_f16_f32 v86, v182, v183
v_lshlrev_b32_e64 v184, 16, v87
v_and_b32 v185, 4294901760, v87
v_cvt_pk_f16_f32 v87, v184, v185
v_lshlrev_b32_e64 v182, 16, v160
v_and_b32 v183, 4294901760, v160
v_cvt_pk_f16_f32 v160, v182, v183
v_lshlrev_b32_e64 v184, 16, v161
v_and_b32 v185, 4294901760, v161
v_cvt_pk_f16_f32 v161, v184, v185
v_lshlrev_b32_e64 v182, 16, v162
v_and_b32 v183, 4294901760, v162
v_cvt_pk_f16_f32 v162, v182, v183
s_cmp_eq_u32 s77, 0
s_cbranch_scc1 Lpp8
s_call_b64 s[78:79], Lpolln
Lpp8:
v_lshlrev_b32 v184, 16, v163
v_and_b32 v185, 4294901760, v163
v_cvt_pk_f16_f32 v163, v184, v185
v_mfma_f32_16x16x16_bf16 v[120:123], v[76:77], v[176:177], 0
v_lshlrev_b32_e64 v182, 16, v76
v_and_b32 v183, 4294901760, v76
v_mfma_f32_16x16x16_bf16 v[124:127], v[78:79], v[176:177], 0
v_cvt_pk_f16_f32 v76, v182, v183
v_lshlrev_b32_e64 v184, 16, v77
v_mfma_f32_16x16x16_bf16 v[120:123], v[88:89], v[178:179], v[120:123]
v_and_b32 v185, 4294901760, v77
v_cvt_pk_f16_f32 v77, v184, v185
v_mfma_f32_16x16x16_bf16 v[124:127], v[90:91], v[178:179], v[124:127]
v_lshlrev_b32_e64 v182, 16, v78
v_and_b32 v183, 4294901760, v78
v_mfma_f32_16x16x16_bf16 v[120:123], v[164:165], v[180:181], v[120:123]
v_cvt_pk_f16_f32 v78, v182, v183
v_lshlrev_b32 v184, 16, v79
v_mfma_f32_16x16x16_bf16 v[124:127], v[166:167], v[180:181], v[124:127]
s_setprio 1
v_and_b32 v185, 4294901760, v79
v_cvt_pk_f16_f32 v79, v184, v185
v_lshlrev_b32_e64 v182, 16, v88
v_and_b32 v183, 4294901760, v88
v_cvt_pk_f16_f32 v88, v182, v183
v_lshlrev_b32 v184, 16, v89
v_and_b32 v185, 4294901760, v89
v_cvt_pk_f16_f32 v89, v184, v185
s_nop 0
s_mov_b32 exec_lo, 65537
s_mov_b32 exec_hi, 65537
ds_write_b128 v187, v[120:123] offset:3328
ds_write_b128 v187, v[124:127] offset:3344
s_mov_b64 exec, -1
s_cmp_eq_u32 s77, 0
s_cbranch_scc1 Lpp9
s_call_b64 s[78:79], Lpolln
Lpp9:
v_lshlrev_b32_e64 v182, 16, v90
v_and_b32 v183, 4294901760, v90
v_cvt_pk_f16_f32 v90, v182, v183
ds_read_b64_tr_b16 v[92:93], v186 offset:5120
ds_read_b64_tr_b16 v[94:95], v186 offset:5128
ds_read_b64_tr_b16 v[168:169], v186 offset:8192
ds_read_b64_tr_b16 v[170:171], v186 offset:8200
v_lshlrev_b32_e64 v184, 16, v91
v_and_b32 v185, 4294901760, v91
v_cvt_pk_f16_f32 v91, v184, v185
v_lshlrev_b32_e64 v182, 16, v164
v_and_b32 v183, 4294901760, v164
v_cvt_pk_f16_f32 v164, v182, v183
v_lshlrev_b32_e64 v184, 16, v165
v_and_b32 v185, 4294901760, v165
v_cvt_pk_f16_f32 v165, v184, v185
v_lshlrev_b32_e64 v182, 16, v166
v_and_b32 v183, 4294901760, v166
v_cvt_pk_f16_f32 v166, v182, v183
v_lshlrev_b32_e64 v184, 16, v167
v_and_b32 v185, 4294901760, v167
v_cvt_pk_f16_f32 v167, v184, v185
v_mfma_f32_16x16x16_bf16 v[120:123], v[80:81], v[176:177], 0
v_lshlrev_b32_e64 v182, 16, v80
v_and_b32 v183, 4294901760, v80
v_mfma_f32_16x16x16_bf16 v[124:127], v[82:83], v[176:177], 0
v_cvt_pk_f16_f32 v80, v182, v183
v_lshlrev_b32 v184, 16, v81
s_waitcnt lgkmcnt(3)
v_mfma_f32_16x16x16_bf16 v[120:123], v[92:93], v[178:179], v[120:123]
v_and_b32 v185, 4294901760, v81
v_cvt_pk_f16_f32 v81, v184, v185
s_waitcnt lgkmcnt(1)
v_mfma_f32_16x16x16_bf16 v[124:127], v[94:95], v[178:179], v[124:127]
v_lshlrev_b32 v182, 16, v82
v_and_b32 v183, 4294901760, v82
v_mfma_f32_16x16x16_bf16 v[120:123], v[168:169], v[180:181], v[120:123]
v_cvt_pk_f16_f32 v82, v182, v183
v_lshlrev_b32_e64 v184, 16, v83
s_waitcnt lgkmcnt(0)
v_mfma_f32_16x16x16_bf16 v[124:127], v[170:171], v[180:181], v[124:127]
s_cmp_eq_u32 s77, 0
s_cbranch_scc1 Lpp10
s_nop 7
s_call_b64 s[78:79], Lpolln
Lpp10:
s_setprio 0
v_and_b32 v185, 4294901760, v83
v_cvt_pk_f16_f32 v83, v184, v185
v_lshlrev_b32_e64 v182, 16, v92
v_and_b32 v183, 4294901760, v92
v_cvt_pk_f16_f32 v92, v182, v183
v_lshlrev_b32_e64 v184, 16, v93
v_and_b32 v185, 4294901760, v93
v_cvt_pk_f16_f32 v93, v184, v185
s_mov_b32 exec_lo, 65537
s_mov_b32 exec_hi, 65537
ds_write_b128 v187, v[120:123] offset:3456
ds_write_b128 v187, v[124:127] offset:3472
s_mov_b64 exec, -1
ds_read_b128 v[120:123], v248
ds_read_b128 v[124:127], v248 offset:2048
v_lshlrev_b32 v182, 16, v94
v_and_b32 v183, 4294901760, v94
v_cvt_pk_f16_f32 v94, v182, v183
v_lshlrev_b32_e64 v184, 16, v95
v_and_b32 v185, 4294901760, v95
v_cvt_pk_f16_f32 v95, v184, v185
s_cmp_eq_u32 s77, 0
s_cbranch_scc1 Lpp11
s_call_b64 s[78:79], Lpolln
Lpp11:
v_lshlrev_b32 v182, 16, v168
v_and_b32 v183, 4294901760, v168
v_cvt_pk_f16_f32 v168, v182, v183
v_lshlrev_b32_e64 v184, 16, v169
v_and_b32 v185, 4294901760, v169
v_cvt_pk_f16_f32 v169, v184, v185
v_lshlrev_b32_e64 v182, 16, v170
v_and_b32 v183, 4294901760, v170
v_cvt_pk_f16_f32 v170, v182, v183
v_lshlrev_b32_e64 v184, 16, v171
v_and_b32 v185, 4294901760, v171
v_cvt_pk_f16_f32 v171, v184, v185
s_cmp_eq_u32 s77, 0
s_cbranch_scc1 Lpp12
s_call_b64 s[78:79], Lpolln
Lpp12:
s_waitcnt lgkmcnt(0)
s_barrier
s_setprio 2
ds_read_b32 v176, v172
ds_read_b32 v177, v172 offset:9216
ds_read_b32 v178, v172 offset:18432
ds_read_b32 v179, v172 offset:27648
ds_read_b32 v180, v172 offset:36864
ds_read_b32 v181, v172 offset:46080
ds_read_b32 v182, v172 offset:55296
ds_read_b32 v183, v172 offset:64512
v_mfma_f32_16x16x32_bf16 v[144:147], v[120:123], v[48:51], 0
s_cmp_eq_u32 s77, 0
s_cbranch_scc1 Lpp13
s_nop 7
s_call_b64 s[78:79], Lpolln
Lpp13:
v_mfma_f32_16x16x32_bf16 v[148:151], v[120:123], v[52:55], 0
v_mfma_f32_16x16x32_bf16 v[152:155], v[120:123], v[24:27], 0
ds_read_b128 v[120:123], v248 offset:4096
v_mfma_f32_16x16x32_bf16 v[144:147], v[124:127], v[56:59], v[144:147]
s_waitcnt lgkmcnt(7)
v_add_f32 v176, v176, v177
v_mfma_f32_16x16x32_bf16 v[148:151], v[124:127], v[60:63], v[148:151]
s_waitcnt lgkmcnt(6)
v_add_f32 v176, v176, v178
s_waitcnt lgkmcnt(5)
v_add_f32 v176, v176, v179
s_cmp_eq_u32 s77, 0
s_cbranch_scc1 Lpp14
s_nop 3
s_call_b64 s[78:79], Lpolln
Lpp14:
s_waitcnt lgkmcnt(4)
v_add_f32 v176, v176, v180
s_waitcnt lgkmcnt(3)
v_add_f32 v176, v176, v181
s_waitcnt lgkmcnt(2)
v_add_f32 v176, v176, v182
s_waitcnt lgkmcnt(1)
v_add_f32 v176, v176, v183
ds_write_b32 v189, v176
v_mfma_f32_16x16x32_bf16 v[152:155], v[124:127], v[32:35], v[152:155]
s_waitcnt lgkmcnt(1)
v_mfma_f32_16x16x32_bf16 v[144:147], v[120:123], v[64:67], v[144:147]
v_mfma_f32_16x16x32_bf16 v[148:151], v[120:123], v[68:71], v[148:151]
s_cmp_eq_u32 s77, 0
s_cbranch_scc1 Lpp15
s_nop 7
s_call_b64 s[78:79], Lpolln
Lpp15:
v_mfma_f32_16x16x32_bf16 v[152:155], v[120:123], v[40:43], v[152:155]
s_cmp_eq_u32 s77, 0
s_cbranch_scc1 Lpp16
s_nop 7
s_call_b64 s[78:79], Lpolln
Lpp16:
s_nop 1
v_cvt_pk_f16_f32 v144, v144, v145
v_pk_fma_f16 v145, v144, v144, s48
v_cvt_pkrtz_f16_f32 v147, v146, v147
v_pk_mul_f16 v145, v144, v145
v_cvt_pkrtz_f16_f32 v149, v148, v149
v_and_b32_e64 v149, s49, v149
v_bfe_u32 v148, v149, 2, 14
v_lshrrev_b32_e64 v149, 18, v149
v_cvt_pkrtz_f16_f32 v153, v152, v153
v_and_b32_e64 v153, s49, v153
v_bfe_u32 v152, v153, 2, 14
v_lshrrev_b32 v153, 18, v153
v_and_b32 v147, s49, v147
v_bfe_u32 v146, v147, 2, 14
ds_read_u16 v148, v148
ds_read_u16_d16_hi v149, v149
ds_read_u16 v152, v152
ds_read_u16_d16_hi v153, v153
v_lshrrev_b32_e64 v147, 18, v147
v_exp_f16_sdwa v145, v145 dst_sel:WORD_0 dst_unused:UNUSED_PRESERVE src0_sel:WORD_0
v_cvt_pkrtz_f16_f32 v151, v150, v151
v_and_b32_e64 v151, s49, v151
v_bfe_u32 v150, v151, 2, 14
v_lshrrev_b32_e64 v151, 18, v151
v_cvt_pkrtz_f16_f32 v155, v154, v155
ds_read_u16 v146, v146
ds_read_u16_d16_hi v147, v147
ds_read_u16 v150, v150
ds_read_u16_d16_hi v151, v151
s_cmp_eq_u32 s77, 0
s_cbranch_scc1 Lpp17
s_call_b64 s[78:79], Lpolln
Lpp17:
v_and_b32 v155, s49, v155
v_bfe_u32 v154, v155, 2, 14
v_lshrrev_b32_e64 v155, 18, v155
v_exp_f16_sdwa v145, v145 dst_sel:WORD_1 dst_unused:UNUSED_PRESERVE src0_sel:WORD_1
ds_read_u16 v154, v154
ds_read_u16_d16_hi v155, v155
v_pk_add_f16 v145, v145, 1.0 op_sel_hi:[1,0]
s_cmp_eq_u32 s77, 0
s_cbranch_scc1 Lpp18
s_call_b64 s[78:79], Lpolln
Lpp18:
v_rcp_f16_sdwa v145, v145 dst_sel:WORD_0 dst_unused:UNUSED_PRESERVE src0_sel:WORD_0
s_nop 0
v_rcp_f16_sdwa v145, v145 dst_sel:WORD_1 dst_unused:UNUSED_PRESERVE src0_sel:WORD_1
s_cmp_eq_u32 s77, 0
s_cbranch_scc1 Lpp19
s_call_b64 s[78:79], Lpolln
Lpp19:
v_pk_mul_f16 v144, v144, v145
s_waitcnt lgkmcnt(8)
v_or_b32 v148, v148, v149
s_waitcnt lgkmcnt(6)
v_or_b32 v152, v152, v153
s_waitcnt lgkmcnt(4)
v_or_b32 v145, v146, v147
s_waitcnt lgkmcnt(2)
v_or_b32 v149, v150, v151
s_waitcnt lgkmcnt(0)
v_or_b32 v153, v154, v155
s_cmp_lg_u32 s40, 0
s_cbranch_scc1 Lspinx
s_setprio 3
v_add_u32_e64 v176, 0, v190
v_mul_u32_u24 v191, 1366, v176
v_lshrrev_b32_e64 v191, 16, v191
v_mul_u32_u24 v191, 9120, v191
v_lshl_add_u32 v176, v176, 1, v191
v_add_u32 v176, 93184, v176
v_add_u32_e64 v177, 64, v190
v_mul_u32_u24 v191, 1366, v177
v_lshrrev_b32_e64 v191, 16, v191
v_mul_u32_u24 v191, 9120, v191
v_lshl_add_u32 v177, v177, 1, v191
v_add_u32 v177, 93184, v177
v_add_u32 v178, 128, v190
v_mul_u32_u24 v191, 1366, v178
v_lshrrev_b32_e64 v191, 16, v191
v_mul_u32_u24 v191, 9120, v191
v_lshl_add_u32 v178, v178, 1, v191
v_add_u32 v178, 93184, v178
v_add_u32 v179, 192, v190
v_mul_u32_u24 v191, 1366, v179
v_lshrrev_b32_e64 v191, 16, v191
v_mul_u32_u24 v191, 9120, v191
v_lshl_add_u32 v179, v179, 1, v191
v_add_u32 v179, 93184, v179
v_add_u32 v180, 256, v190
v_mul_u32_u24 v191, 1366, v180
v_lshrrev_b32_e64 v191, 16, v191
v_mul_u32_u24 v191, 9120, v191
v_lshl_add_u32 v180, v180, 1, v191
v_add_u32 v180, 93184, v180
v_add_u32 v181, 320, v190
v_mul_u32_u24 v191, 1366, v181
v_lshrrev_b32_e64 v191, 16, v191
v_mul_u32_u24 v191, 9120, v191
v_lshl_add_u32 v181, v181, 1, v191
v_add_u32 v181, 93184, v181
Lspin:
s_cmp_eq_u32 s77, 0
s_cbranch_scc1 Lspiny
s_cmp_eq_u32 s76, 0
s_cbranch_scc1 Lspiny
s_sub_u32 s76, s76, 1
s_call_b64 s[78:79], Lpoll
s_branch Lspin
Lspiny:
v_cvt_f16_f32 v128, v128
ds_write_b16 v176, v128
v_cvt_f16_f32_e64 v129, v129
ds_write_b16 v177, v129
v_cvt_f16_f32_e64 v130, v130
ds_write_b16 v178, v130
v_cvt_f16_f32_e64 v131, v131
ds_write_b16 v179, v131
v_cvt_f16_f32_e64 v132, v132
ds_write_b16 v180, v132
v_cvt_f16_f32 v133, v133
ds_write_b16 v181, v133
s_waitcnt lgkmcnt(0)
Lspinx:
s_waitcnt lgkmcnt(0)
s_barrier
ds_read_b64 v[176:177], v188 offset:3072
ds_read_b64 v[178:179], v188 offset:3104
ds_read_b64 v[180:181], v188 offset:3136
ds_read_b128 v[128:131], v254 offset:8192
ds_read_b128 v[132:135], v254 offset:8208
ds_read_b128 v[136:139], v254 offset:8320
ds_read_b128 v[140:143], v254 offset:8336
ds_read_b128 v[240:243], v254
ds_read_b128 v[244:247], v254 offset:16
s_waitcnt lgkmcnt(8)
v_pk_mul_f16 v72, v72, v176
v_pk_mul_f16 v73, v73, v177
v_add_u32 v72, 262148, v72
v_and_b32 v72, s49, v72
s_waitcnt lgkmcnt(6)
v_add_u32 v73, 262148, v73
v_and_b32 v73, s49, v73
v_pk_mul_f16 v74, v74, v176
v_pk_mul_f16 v75, v75, v177
v_add_u32 v74, 262148, v74
v_and_b32_e64 v74, s49, v74
v_add_u32 v75, 262148, v75
v_and_b32_e64 v75, s49, v75
v_pk_mul_f16 v76, v76, v176
v_pk_mul_f16 v77, v77, v177
v_add_u32 v76, 262148, v76
v_and_b32_e64 v76, s49, v76
v_add_u32 v77, 262148, v77
v_and_b32_e64 v77, s49, v77
ds_write_b64 v173, v[72:73]
ds_write_b64 v173, v[74:75] offset:3072
v_pk_mul_f16 v78, v78, v176
v_pk_mul_f16 v79, v79, v177
v_add_u32 v78, 262148, v78
v_and_b32_e64 v78, s49, v78
v_add_u32 v79, 262148, v79
v_and_b32_e64 v79, s49, v79
v_pk_mul_f16 v80, v80, v176
v_pk_mul_f16 v81, v81, v177
v_add_u32 v80, 262148, v80
v_and_b32_e64 v80, s49, v80
v_add_u32 v81, 262148, v81
v_and_b32_e64 v81, s49, v81
ds_write_b64 v173, v[76:77] offset:1024
ds_write_b64 v173, v[78:79] offset:4096
v_pk_mul_f16 v82, v82, v176
v_pk_mul_f16 v83, v83, v177
v_add_u32 v82, 262148, v82
v_and_b32_e64 v82, s49, v82
v_add_u32 v83, 262148, v83
v_and_b32_e64 v83, s49, v83
v_pk_mul_f16 v84, v84, v178
v_pk_mul_f16 v85, v85, v179
v_add_u32 v84, 262148, v84
v_and_b32_e64 v84, s49, v84
v_add_u32 v85, 262148, v85
v_and_b32_e64 v85, s49, v85
ds_write_b64 v173, v[80:81] offset:2048
ds_write_b64 v173, v[82:83] offset:5120
v_pk_mul_f16 v86, v86, v178
v_pk_mul_f16 v87, v87, v179
v_add_u32 v86, 262148, v86
v_and_b32_e64 v86, s49, v86
v_add_u32 v87, 262148, v87
v_and_b32_e64 v87, s49, v87
v_pk_mul_f16 v88, v88, v178
v_pk_mul_f16 v89, v89, v179
v_add_u32 v88, 262148, v88
v_and_b32_e64 v88, s49, v88
v_add_u32 v89, 262148, v89
v_and_b32_e64 v89, s49, v89
ds_write_b64 v174, v[84:85]
ds_write_b64 v174, v[86:87] offset:3072
v_pk_mul_f16 v90, v90, v178
v_pk_mul_f16 v91, v91, v179
v_add_u32 v90, 262148, v90
v_and_b32_e64 v90, s49, v90
v_add_u32 v91, 262148, v91
v_and_b32_e64 v91, s49, v91
v_pk_mul_f16 v92, v92, v178
v_pk_mul_f16 v93, v93, v179
v_add_u32 v92, 262148, v92
v_and_b32_e64 v92, s49, v92
v_add_u32 v93, 262148, v93
v_and_b32 v93, s49, v93
ds_write_b64 v174, v[88:89] offset:1024
s_waitcnt lgkmcnt(4)
ds_write_b64 v174, v[90:91] offset:4096
v_pk_mul_f16 v94, v94, v178
v_pk_mul_f16 v95, v95, v179
v_add_u32 v94, 262148, v94
v_and_b32_e64 v94, s49, v94
v_add_u32 v95, 262148, v95
v_and_b32_e64 v95, s49, v95
v_pk_mul_f16 v160, v160, v180
v_pk_mul_f16 v161, v161, v181
v_add_u32 v160, 262148, v160
v_and_b32_e64 v160, s49, v160
v_add_u32 v161, 262148, v161
v_and_b32_e64 v161, s49, v161
ds_write_b64 v174, v[92:93] offset:2048
ds_write_b64 v174, v[94:95] offset:5120
v_pk_mul_f16 v162, v162, v180
v_pk_mul_f16 v163, v163, v181
v_add_u32 v162, 262148, v162
v_and_b32_e64 v162, s49, v162
v_add_u32 v163, 262148, v163
v_and_b32_e64 v163, s49, v163
v_pk_mul_f16 v164, v164, v180
v_pk_mul_f16 v165, v165, v181
v_add_u32 v164, 262148, v164
v_and_b32_e64 v164, s49, v164
v_add_u32 v165, 262148, v165
v_and_b32_e64 v165, s49, v165
ds_write_b64 v175, v[160:161]
ds_write_b64 v175, v[162:163] offset:3072
v_pk_mul_f16 v166, v166, v180
v_pk_mul_f16 v167, v167, v181
v_add_u32 v166, 262148, v166
v_and_b32_e64 v166, s49, v166
v_add_u32 v167, 262148, v167
v_and_b32_e64 v167, s49, v167
v_pk_mul_f16 v168, v168, v180
v_pk_mul_f16 v169, v169, v181
v_add_u32 v168, 262148, v168
v_and_b32_e64 v168, s49, v168
v_add_u32 v169, 262148, v169
v_and_b32_e64 v169, s49, v169
ds_write_b64 v175, v[164:165] offset:1024
ds_write_b64 v175, v[166:167] offset:4096
v_pk_mul_f16 v170, v170, v180
v_pk_mul_f16 v171, v171, v181
v_add_u32 v170, 262148, v170
v_and_b32_e64 v170, s49, v170
v_add_u32 v171, 262148, v171
v_and_b32_e64 v171, s49, v171
ds_write_b64 v175, v[168:169] offset:2048
ds_write_b64 v175, v[170:171] offset:5120
ds_read_b128 v[176:179], v248 offset:256
s_waitcnt lgkmcnt(0)
s_barrier
ds_read_b128 v[180:183], v251 offset:20480
ds_read_b128 v[184:187], v251 offset:23552
ds_read_b128 v[188:191], v251 offset:21504
ds_read_b128 v[120:123], v251 offset:24576
buffer_load_dwordx4 v[156:159], v253, s[4:7], s71 offen
buffer_load_dwordx4 v[160:163], v253, s[4:7], s71 offen offset:64
s_setprio 3
v_mfma_f32_16x16x32_bf16 v[164:167], v[176:179], v[48:51], 0
s_waitcnt lgkmcnt(3)
v_mfma_f32_16x16x32_f16 v[72:75], v[180:183], v[4:7], v[128:131]
v_mfma_f32_16x16x32_f16 v[128:131], v[180:183], v[0:3], v[128:131]
ds_read_b128 v[180:183], v248 offset:2304
s_waitcnt lgkmcnt(3)
v_mfma_f32_16x16x32_f16 v[76:79], v[184:187], v[4:7], v[132:135]
v_mfma_f32_16x16x32_bf16 v[168:171], v[176:179], v[52:55], 0
v_mfma_f32_16x16x32_f16 v[132:135], v[184:187], v[0:3], v[132:135]
ds_read_b128 v[184:187], v251 offset:25600
s_waitcnt lgkmcnt(3)
v_mfma_f32_16x16x32_f16 v[80:83], v[188:191], v[4:7], v[136:139]
v_mfma_f32_16x16x32_f16 v[136:139], v[188:191], v[0:3], v[136:139]
ds_read_b128 v[188:191], v251 offset:26624
v_mfma_f32_16x16x32_bf16 v[172:175], v[176:179], v[24:27], 0
ds_read_b128 v[176:179], v251 offset:22528
s_waitcnt lgkmcnt(4)
v_mfma_f32_16x16x32_f16 v[84:87], v[120:123], v[4:7], v[140:143]
v_mfma_f32_16x16x32_f16 v[140:143], v[120:123], v[0:3], v[140:143]
ds_read_b128 v[120:123], v251 offset:29696
s_waitcnt lgkmcnt(4)
v_mfma_f32_16x16x32_bf16 v[164:167], v[180:183], v[56:59], v[164:167]
s_waitcnt lgkmcnt(3)
v_mfma_f32_16x16x32_f16 v[92:95], v[184:187], v[4:7], v[244:247]
v_mfma_f32_16x16x32_f16 v[244:247], v[184:187], v[0:3], v[244:247]
ds_read_b128 v[184:187], v251 offset:30720
v_mfma_f32_16x16x32_bf16 v[168:171], v[180:183], v[60:63], v[168:171]
s_waitcnt lgkmcnt(2)
v_mfma_f32_16x16x32_f16 v[88:91], v[176:179], v[4:7], v[240:243]
v_mfma_f32_16x16x32_f16 v[240:243], v[176:179], v[0:3], v[240:243]
ds_read_b128 v[176:179], v251 offset:27648
v_mfma_f32_16x16x32_f16 v[72:75], v[188:191], v[12:15], v[72:75]
v_mfma_f32_16x16x32_f16 v[128:131], v[188:191], v[8:11], v[128:131]
ds_read_b128 v[188:191], v251 offset:28672
s_waitcnt lgkmcnt(3)
v_mfma_f32_16x16x32_f16 v[76:79], v[120:123], v[12:15], v[76:79]
v_mfma_f32_16x16x32_bf16 v[172:175], v[180:183], v[32:35], v[172:175]
ds_read_b128 v[180:183], v248 offset:4352
v_mfma_f32_16x16x32_f16 v[132:135], v[120:123], v[8:11], v[132:135]
ds_read_b128 v[120:123], v251 offset:31744
s_waitcnt lgkmcnt(4)
v_mfma_f32_16x16x32_f16 v[84:87], v[184:187], v[12:15], v[84:87]
s_setprio 2
s_waitcnt lgkmcnt(3)
v_mfma_f32_16x16x32_f16 v[80:83], v[176:179], v[12:15], v[80:83]
v_mfma_f32_16x16x32_f16 v[136:139], v[176:179], v[8:11], v[136:139]
ds_read_b128 v[176:179], v251 offset:32768
v_mfma_f32_16x16x32_f16 v[140:143], v[184:187], v[8:11], v[140:143]
ds_read_b128 v[184:187], v248 offset:6144
s_waitcnt lgkmcnt(4)
v_mfma_f32_16x16x32_f16 v[88:91], v[188:191], v[12:15], v[88:91]
s_waitcnt lgkmcnt(3)
v_mfma_f32_16x16x32_bf16 v[164:167], v[180:183], v[64:67], v[164:167]
v_mfma_f32_16x16x32_bf16 v[168:171], v[180:183], v[68:71], v[168:171]
v_mfma_f32_16x16x32_f16 v[240:243], v[188:191], v[8:11], v[240:243]
ds_read_b128 v[188:191], v251 offset:33792
s_nop 4
v_cvt_pk_f16_f32 v164, v164, v165
s_waitcnt lgkmcnt(3)
v_mfma_f32_16x16x32_f16 v[92:95], v[120:123], v[12:15], v[92:95]
v_pk_fma_f16 v165, v164, v164, s48
v_cvt_pkrtz_f16_f32 v169, v168, v169
v_mfma_f32_16x16x32_f16 v[244:247], v[120:123], v[8:11], v[244:247]
ds_read_b128 v[120:123], v251 offset:36864
v_and_b32_e64 v169, s49, v169
v_mfma_f32_16x16x32_bf16 v[172:175], v[180:183], v[40:43], v[172:175]
ds_read_b128 v[180:183], v251 offset:35840
v_bfe_u32 v168, v169, 2, 14
s_waitcnt lgkmcnt(3)
v_mfma_f32_16x16x32_f16 v[72:75], v[176:179], v[20:23], v[72:75]
v_lshrrev_b32 v169, 18, v169
v_pk_mul_f16 v165, v164, v165
v_mfma_f32_16x16x32_f16 v[128:131], v[176:179], v[16:19], v[128:131]
ds_read_b128 v[176:179], v251 offset:34816
ds_read_u16 v168, v168
v_mfma_f32_16x16x32_bf16 v[124:127], v[184:187], v[48:51], 0
ds_read_u16_d16_hi v169, v169
v_cvt_pkrtz_f16_f32 v173, v172, v173
s_waitcnt lgkmcnt(5)
v_mfma_f32_16x16x32_f16 v[80:83], v[188:191], v[20:23], v[80:83]
v_and_b32 v173, s49, v173
v_bfe_u32 v172, v173, 2, 14
v_mfma_f32_16x16x32_f16 v[136:139], v[188:191], v[16:19], v[136:139]
ds_read_b128 v[188:191], v252 offset:4096
v_lshrrev_b32 v173, 18, v173
s_waitcnt lgkmcnt(4)
v_mfma_f32_16x16x32_f16 v[76:79], v[180:183], v[20:23], v[76:79]
ds_read_u16 v172, v172
ds_read_u16_d16_hi v173, v173
v_mfma_f32_16x16x32_f16 v[132:135], v[180:183], v[16:19], v[132:135]
ds_read_b128 v[180:183], v251 offset:37888
v_cvt_pkrtz_f16_f32 v167, v166, v167
v_mfma_f32_16x16x32_bf16 v[0:3], v[184:187], v[52:55], 0
v_and_b32_e64 v167, s49, v167
v_bfe_u32 v166, v167, 2, 14
v_mfma_f32_16x16x32_f16 v[84:87], v[120:123], v[20:23], v[84:87]
v_lshrrev_b32 v167, 18, v167
v_exp_f16_sdwa v165, v165 dst_sel:WORD_0 dst_unused:UNUSED_PRESERVE src0_sel:WORD_0
v_mfma_f32_16x16x32_f16 v[140:143], v[120:123], v[16:19], v[140:143]
ds_read_b128 v[120:123], v252 offset:7168
ds_read_u16 v166, v166
s_waitcnt lgkmcnt(7)
v_mfma_f32_16x16x32_f16 v[88:91], v[176:179], v[20:23], v[88:91]
ds_read_u16_d16_hi v167, v167
v_cvt_pkrtz_f16_f32 v171, v170, v171
v_mfma_f32_16x16x32_bf16 v[4:7], v[184:187], v[24:27], 0
ds_read_b128 v[184:187], v248 offset:8192
v_and_b32_e64 v171, s49, v171
v_mfma_f32_16x16x32_f16 v[240:243], v[176:179], v[16:19], v[240:243]
ds_read_b128 v[176:179], v252 offset:5120
v_bfe_u32 v170, v171, 2, 14
s_waitcnt lgkmcnt(8)
v_mfma_f32_16x16x32_f16 v[72:75], v[188:191], v[100:103], v[72:75]
s_setprio 1
v_lshrrev_b32_e64 v171, 18, v171
v_cvt_pkrtz_f16_f32 v175, v174, v175
v_mfma_f32_16x16x32_f16 v[128:131], v[188:191], v[96:99], v[128:131]
ds_read_b128 v[188:191], v252 offset:6144
ds_read_u16 v170, v170
s_waitcnt lgkmcnt(7)
v_mfma_f32_16x16x32_f16 v[92:95], v[180:183], v[20:23], v[92:95]
v_mov_b32 v20, 0
v_mov_b32_e64 v21, 0
v_mfma_f32_16x16x32_f16 v[244:247], v[180:183], v[16:19], v[244:247]
ds_read_b128 v[180:183], v252 offset:8192
v_mov_b32 v16, 0
v_mov_b32 v17, 0
v_cndmask_b32 v18, 0, v255, s[88:89]
v_cndmask_b32 v19, 0, v255, s[90:91]
s_waitcnt lgkmcnt(7)
v_mfma_f32_16x16x32_f16 v[76:79], v[120:123], v[100:103], v[76:79]
ds_read_u16_d16_hi v171, v171
v_and_b32 v175, s49, v175
v_mfma_f32_16x16x32_f16 v[132:135], v[120:123], v[96:99], v[132:135]
ds_read_b128 v[120:123], v252 offset:9216
v_bfe_u32 v174, v175, 2, 14
s_waitcnt lgkmcnt(6)
v_mfma_f32_16x16x32_bf16 v[124:127], v[184:187], v[56:59], v[124:127]
v_lshrrev_b32 v175, 18, v175
v_exp_f16_sdwa v165, v165 dst_sel:WORD_1 dst_unused:UNUSED_PRESERVE src0_sel:WORD_1
v_mfma_f32_16x16x32_bf16 v[0:3], v[184:187], v[60:63], v[0:3]
ds_read_u16 v174, v174
ds_read_u16_d16_hi v175, v175
s_waitcnt lgkmcnt(7)
v_mfma_f32_16x16x32_f16 v[80:83], v[176:179], v[100:103], v[80:83]
v_pk_add_f16 v165, v165, 1.0 op_sel_hi:[1,0]
v_mfma_f32_16x16x32_bf16 v[4:7], v[184:187], v[32:35], v[4:7]
ds_read_b128 v[184:187], v248 offset:10240
v_rcp_f16_sdwa v165, v165 dst_sel:WORD_0 dst_unused:UNUSED_PRESERVE src0_sel:WORD_0
v_mfma_f32_16x16x32_f16 v[136:139], v[176:179], v[96:99], v[136:139]
ds_read_b128 v[176:179], v252 offset:10240
v_rcp_f16_sdwa v165, v165 dst_sel:WORD_1 dst_unused:UNUSED_PRESERVE src0_sel:WORD_1
s_waitcnt lgkmcnt(6)
v_mfma_f32_16x16x32_f16 v[84:87], v[180:183], v[100:103], v[84:87]
v_mfma_f32_16x16x32_f16 v[140:143], v[180:183], v[96:99], v[140:143]
ds_read_b128 v[180:183], v252 offset:13312
v_mfma_f32_16x16x32_f16 v[88:91], v[188:191], v[100:103], v[88:91]
v_mfma_f32_16x16x32_f16 v[240:243], v[188:191], v[96:99], v[240:243]
ds_read_b128 v[188:191], v248 offset:6400
s_waitcnt lgkmcnt(6)
v_mfma_f32_16x16x32_f16 v[92:95], v[120:123], v[100:103], v[92:95]
s_waitcnt lgkmcnt(3)
v_mfma_f32_16x16x32_bf16 v[124:127], v[184:187], v[64:67], v[124:127]
v_or_b32_e64 v150, v168, v169
v_pk_mul_f16 v146, v164, v165
v_mfma_f32_16x16x32_bf16 v[0:3], v[184:187], v[68:71], v[0:3]
v_mfma_f32_16x16x32_f16 v[244:247], v[120:123], v[96:99], v[244:247]
ds_read_b128 v[120:123], v252 offset:14336
s_nop 2
v_cvt_pk_f16_f32 v124, v124, v125
s_waitcnt lgkmcnt(3)
v_mfma_f32_16x16x32_f16 v[72:75], v[176:179], v[108:111], v[72:75]
v_pk_fma_f16 v125, v124, v124, s48
v_cvt_pkrtz_f16_f32 v1, v0, v1
v_mfma_f32_16x16x32_f16 v[128:131], v[176:179], v[104:107], v[128:131]
ds_read_b128 v[176:179], v252 offset:12288
v_and_b32_e64 v1, s49, v1
v_mfma_f32_16x16x32_bf16 v[4:7], v[184:187], v[40:43], v[4:7]
ds_read_b128 v[184:187], v252 offset:11264
v_bfe_u32 v0, v1, 2, 14
s_waitcnt lgkmcnt(3)
v_mfma_f32_16x16x32_f16 v[76:79], v[180:183], v[108:111], v[76:79]
v_lshrrev_b32 v1, 18, v1
v_pk_mul_f16 v125, v124, v125
v_mfma_f32_16x16x32_f16 v[132:135], v[180:183], v[104:107], v[132:135]
ds_read_b128 v[180:183], v252 offset:15360
ds_read_u16 v0, v0
v_mfma_f32_16x16x32_bf16 v[8:11], v[188:191], v[48:51], 0
s_setprio 0
ds_read_u16_d16_hi v1, v1
v_cvt_pkrtz_f16_f32 v5, v4, v5
s_waitcnt lgkmcnt(5)
v_mfma_f32_16x16x32_f16 v[84:87], v[120:123], v[108:111], v[84:87]
v_and_b32_e64 v5, s49, v5
v_bfe_u32 v4, v5, 2, 14
v_mfma_f32_16x16x32_f16 v[140:143], v[120:123], v[104:107], v[140:143]
ds_read_b128 v[120:123], v251 offset:41984
v_lshrrev_b32 v5, 18, v5
s_waitcnt lgkmcnt(4)
v_mfma_f32_16x16x32_f16 v[80:83], v[184:187], v[108:111], v[80:83]
ds_read_u16 v4, v4
ds_read_u16_d16_hi v5, v5
v_mfma_f32_16x16x32_f16 v[136:139], v[184:187], v[104:107], v[136:139]
ds_read_b128 v[184:187], v251 offset:38912
v_cvt_pkrtz_f16_f32 v127, v126, v127
v_mfma_f32_16x16x32_bf16 v[12:15], v[188:191], v[52:55], 0
v_and_b32_e64 v127, s49, v127
v_bfe_u32 v126, v127, 2, 14
v_mfma_f32_16x16x32_f16 v[88:91], v[176:179], v[108:111], v[88:91]
v_lshrrev_b32_e64 v127, 18, v127
v_exp_f16_sdwa v125, v125 dst_sel:WORD_0 dst_unused:UNUSED_PRESERVE src0_sel:WORD_0
v_mfma_f32_16x16x32_f16 v[240:243], v[176:179], v[104:107], v[240:243]
ds_read_b128 v[176:179], v251 offset:39936
ds_read_u16 v126, v126
s_waitcnt lgkmcnt(7)
v_mfma_f32_16x16x32_f16 v[92:95], v[180:183], v[108:111], v[92:95]
ds_read_u16_d16_hi v127, v127
v_or_b32 v154, v172, v173
v_mfma_f32_16x16x32_bf16 v[96:99], v[188:191], v[24:27], 0
ds_read_b128 v[188:191], v248 offset:8448
v_cvt_pkrtz_f16_f32 v3, v2, v3
v_mfma_f32_16x16x32_f16 v[244:247], v[180:183], v[104:107], v[244:247]
ds_read_b128 v[180:183], v251 offset:43008
buffer_load_dwordx4 v[100:103], v253, s[4:7], s71 offen offset:128
buffer_load_dwordx4 v[104:107], v253, s[4:7], s71 offen offset:192
s_waitcnt lgkmcnt(8)
v_mfma_f32_16x16x32_f16 v[76:79], v[120:123], v[196:199], v[76:79]
v_and_b32 v3, s49, v3
v_bfe_u32 v2, v3, 2, 14
v_mfma_f32_16x16x32_f16 v[132:135], v[120:123], v[192:195], v[132:135]
ds_read_b128 v[120:123], v251 offset:44032
v_lshrrev_b32 v3, 18, v3
s_waitcnt lgkmcnt(6)
v_mfma_f32_16x16x32_f16 v[72:75], v[184:187], v[196:199], v[72:75]
ds_read_u16 v2, v2
ds_read_u16_d16_hi v3, v3
v_mfma_f32_16x16x32_f16 v[128:131], v[184:187], v[192:195], v[128:131]
ds_read_b128 v[184:187], v251 offset:40960
v_or_b32 v147, v166, v167
s_waitcnt lgkmcnt(8)
v_mfma_f32_16x16x32_f16 v[80:83], v[176:179], v[196:199], v[80:83]
v_cvt_pkrtz_f16_f32 v7, v6, v7
v_and_b32_e64 v7, s49, v7
v_mfma_f32_16x16x32_f16 v[136:139], v[176:179], v[192:195], v[136:139]
ds_read_b128 v[176:179], v251 offset:45056
v_bfe_u32 v6, v7, 2, 14
v_lshrrev_b32 v7, 18, v7
s_waitcnt lgkmcnt(6)
v_mfma_f32_16x16x32_bf16 v[8:11], v[188:191], v[56:59], v[8:11]
ds_read_u16 v6, v6
ds_read_u16_d16_hi v7, v7
v_mfma_f32_16x16x32_bf16 v[12:15], v[188:191], v[60:63], v[12:15]
v_exp_f16_sdwa v125, v125 dst_sel:WORD_1 dst_unused:UNUSED_PRESERVE src0_sel:WORD_1
s_waitcnt lgkmcnt(7)
v_mfma_f32_16x16x32_f16 v[84:87], v[180:183], v[196:199], v[84:87]
v_or_b32 v151, v170, v171
v_or_b32_e64 v155, v174, v175
v_mfma_f32_16x16x32_f16 v[140:143], v[180:183], v[192:195], v[140:143]
ds_read_b128 v[180:183], v251 offset:48128
v_pk_add_f16 v125, v125, 1.0 op_sel_hi:[1,0]
v_mfma_f32_16x16x32_bf16 v[96:99], v[188:191], v[32:35], v[96:99]
ds_read_b128 v[188:191], v248 offset:10496
v_rcp_f16_sdwa v125, v125 dst_sel:WORD_0 dst_unused:UNUSED_PRESERVE src0_sel:WORD_0
s_waitcnt lgkmcnt(7)
v_mfma_f32_16x16x32_f16 v[92:95], v[120:123], v[196:199], v[92:95]
s_setprio 3
v_rcp_f16_sdwa v125, v125 dst_sel:WORD_1 dst_unused:UNUSED_PRESERVE src0_sel:WORD_1
s_waitcnt lgkmcnt(5)
v_mfma_f32_16x16x32_f16 v[88:91], v[184:187], v[196:199], v[88:91]
v_mfma_f32_16x16x32_f16 v[240:243], v[184:187], v[192:195], v[240:243]
ds_read_b128 v[184:187], v251 offset:46080
v_mfma_f32_16x16x32_f16 v[244:247], v[120:123], v[192:195], v[244:247]
ds_read_b128 v[120:123], v248 offset:12288
s_waitcnt lgkmcnt(6)
v_mfma_f32_16x16x32_f16 v[72:75], v[176:179], v[204:207], v[72:75]
buffer_load_dwordx4 v[108:111], v253, s[4:7], s71 offen offset:256
buffer_load_dwordx4 v[192:195], v253, s[4:7], s71 offen offset:320
v_mfma_f32_16x16x32_f16 v[128:131], v[176:179], v[200:203], v[128:131]
ds_read_b128 v[176:179], v251 offset:47104
s_waitcnt lgkmcnt(4)
v_mfma_f32_16x16x32_f16 v[76:79], v[180:183], v[204:207], v[76:79]
s_waitcnt lgkmcnt(3)
v_mfma_f32_16x16x32_bf16 v[8:11], v[188:191], v[64:67], v[8:11]
v_or_b32_e64 v0, v0, v1
v_pk_mul_f16 v124, v124, v125
v_mfma_f32_16x16x32_bf16 v[12:15], v[188:191], v[68:71], v[12:15]
v_or_b32 v4, v4, v5
v_mfma_f32_16x16x32_f16 v[132:135], v[180:183], v[200:203], v[132:135]
ds_read_b128 v[180:183], v251 offset:50176
s_nop 1
v_cvt_pk_f16_f32 v8, v8, v9
v_mfma_f32_16x16x32_bf16 v[96:99], v[188:191], v[40:43], v[96:99]
ds_read_b128 v[188:191], v251 offset:49152
v_cvt_pkrtz_f16_f32 v13, v12, v13
s_waitcnt lgkmcnt(3)
v_mfma_f32_16x16x32_f16 v[80:83], v[184:187], v[204:207], v[80:83]
v_and_b32 v13, s49, v13
v_bfe_u32 v12, v13, 2, 14
v_mfma_f32_16x16x32_f16 v[136:139], v[184:187], v[200:203], v[136:139]
ds_read_b128 v[184:187], v251 offset:51200
v_lshrrev_b32 v13, 18, v13
v_mfma_f32_16x16x32_bf16 v[196:199], v[120:123], v[48:51], 0
ds_read_u16 v12, v12
ds_read_u16_d16_hi v13, v13
s_waitcnt lgkmcnt(5)
v_mfma_f32_16x16x32_f16 v[88:91], v[176:179], v[204:207], v[88:91]
v_pk_fma_f16 v9, v8, v8, s48
v_cvt_pkrtz_f16_f32 v97, v96, v97
v_mfma_f32_16x16x32_f16 v[240:243], v[176:179], v[200:203], v[240:243]
ds_read_b128 v[176:179], v251 offset:52224
v_and_b32 v97, s49, v97
s_waitcnt lgkmcnt(4)
v_mfma_f32_16x16x32_f16 v[84:87], v[188:191], v[204:207], v[84:87]
v_bfe_u32 v96, v97, 2, 14
v_lshrrev_b32_e64 v97, 18, v97
v_mfma_f32_16x16x32_f16 v[140:143], v[188:191], v[200:203], v[140:143]
ds_read_b128 v[188:191], v248 offset:14336
ds_read_u16 v96, v96
v_mfma_f32_16x16x32_bf16 v[164:167], v[120:123], v[52:55], 0
ds_read_u16_d16_hi v97, v97
v_pk_mul_f16 v9, v8, v9
v_mfma_f32_16x16x32_f16 v[92:95], v[180:183], v[204:207], v[92:95]
v_cvt_pkrtz_f16_f32 v11, v10, v11
v_and_b32_e64 v11, s49, v11
v_mfma_f32_16x16x32_f16 v[244:247], v[180:183], v[200:203], v[244:247]
ds_read_b128 v[180:183], v248 offset:16384
v_bfe_u32 v10, v11, 2, 14
s_waitcnt lgkmcnt(7)
v_mfma_f32_16x16x32_f16 v[72:75], v[184:187], v[212:215], v[72:75]
v_lshrrev_b32 v11, 18, v11
v_exp_f16_sdwa v9, v9 dst_sel:WORD_0 dst_unused:UNUSED_PRESERVE src0_sel:WORD_0
v_mfma_f32_16x16x32_bf16 v[168:171], v[120:123], v[24:27], 0
ds_read_b128 v[120:123], v251 offset:54272
ds_read_u16 v10, v10
v_mfma_f32_16x16x32_f16 v[128:131], v[184:187], v[208:211], v[128:131]
ds_read_b128 v[184:187], v251 offset:55296
s_setprio 2
ds_read_u16_d16_hi v11, v11
s_waitcnt lgkmcnt(7)
v_mfma_f32_16x16x32_bf16 v[196:199], v[188:191], v[56:59], v[196:199]
v_cvt_pkrtz_f16_f32 v15, v14, v15
v_and_b32_e64 v15, s49, v15
v_mfma_f32_16x16x32_bf16 v[164:167], v[188:191], v[60:63], v[164:167]
v_bfe_u32 v14, v15, 2, 14
v_lshrrev_b32_e64 v15, 18, v15
v_mfma_f32_16x16x32_f16 v[80:83], v[176:179], v[212:215], v[80:83]
ds_read_u16 v14, v14
ds_read_u16_d16_hi v15, v15
v_mfma_f32_16x16x32_bf16 v[168:171], v[188:191], v[32:35], v[168:171]
ds_read_b128 v[188:191], v251 offset:53248
v_or_b32 v125, v126, v127
s_waitcnt lgkmcnt(6)
v_mfma_f32_16x16x32_f16 v[76:79], v[120:123], v[212:215], v[76:79]
v_cvt_pkrtz_f16_f32 v99, v98, v99
v_and_b32_e64 v99, s49, v99
v_mfma_f32_16x16x32_f16 v[132:135], v[120:123], v[208:211], v[132:135]
ds_read_b128 v[120:123], v248 offset:12544
v_bfe_u32 v98, v99, 2, 14
v_mfma_f32_16x16x32_f16 v[136:139], v[176:179], v[208:211], v[136:139]
ds_read_b128 v[176:179], v251 offset:56320
v_lshrrev_b32_e64 v99, 18, v99
v_mfma_f32_16x16x32_bf16 v[196:199], v[180:183], v[64:67], v[196:199]
ds_read_u16 v98, v98
ds_read_u16_d16_hi v99, v99
s_waitcnt lgkmcnt(8)
v_mfma_f32_16x16x32_f16 v[84:87], v[184:187], v[212:215], v[84:87]
v_exp_f16_sdwa v9, v9 dst_sel:WORD_1 dst_unused:UNUSED_PRESERVE src0_sel:WORD_1
v_or_b32 v1, v2, v3
v_mfma_f32_16x16x32_f16 v[140:143], v[184:187], v[208:211], v[140:143]
ds_read_b128 v[184:187], v251 offset:60416
v_or_b32_e64 v5, v6, v7
v_mfma_f32_16x16x32_bf16 v[164:167], v[180:183], v[68:71], v[164:167]
v_pk_add_f16 v9, v9, 1.0 op_sel_hi:[1,0]
v_cvt_pk_f16_f32 v196, v196, v197
v_mfma_f32_16x16x32_bf16 v[168:171], v[180:183], v[40:43], v[168:171]
ds_read_b128 v[180:183], v251 offset:57344
v_rcp_f16_sdwa v9, v9 dst_sel:WORD_0 dst_unused:UNUSED_PRESERVE src0_sel:WORD_0
s_waitcnt lgkmcnt(6)
v_mfma_f32_16x16x32_f16 v[88:91], v[188:191], v[212:215], v[88:91]
s_nop 0
v_cvt_pkrtz_f16_f32 v165, v164, v165
v_and_b32_e64 v165, s49, v165
v_mfma_f32_16x16x32_f16 v[240:243], v[188:191], v[208:211], v[240:243]
ds_read_b128 v[188:191], v248 offset:14592
s_setprio 1
v_bfe_u32 v164, v165, 2, 14
s_waitcnt lgkmcnt(6)
v_mfma_f32_16x16x32_bf16 v[172:175], v[120:123], v[48:51], 0
v_lshrrev_b32 v165, 18, v165
v_rcp_f16_sdwa v9, v9 dst_sel:WORD_1 dst_unused:UNUSED_PRESERVE src0_sel:WORD_1
s_waitcnt lgkmcnt(5)
v_mfma_f32_16x16x32_f16 v[92:95], v[176:179], v[212:215], v[92:95]
ds_read_u16 v164, v164
ds_read_u16_d16_hi v165, v165
v_mfma_f32_16x16x32_f16 v[244:247], v[176:179], v[208:211], v[244:247]
ds_read_b128 v[176:179], v251 offset:61440
v_pk_fma_f16 v197, v196, v196, s48
v_mfma_f32_16x16x32_bf16 v[200:203], v[120:123], v[52:55], 0
v_cvt_pkrtz_f16_f32 v169, v168, v169
v_and_b32 v169, s49, v169
s_waitcnt lgkmcnt(4)
v_mfma_f32_16x16x32_f16 v[72:75], v[180:183], v[228:231], v[72:75]
v_bfe_u32 v168, v169, 2, 14
v_lshrrev_b32_e64 v169, 18, v169
v_mfma_f32_16x16x32_bf16 v[204:207], v[120:123], v[24:27], 0
ds_read_b128 v[120:123], v251 offset:58368
ds_read_u16 v168, v168
v_mfma_f32_16x16x32_f16 v[128:131], v[180:183], v[224:227], v[128:131]
ds_read_b128 v[180:183], v248 offset:16640
ds_read_u16_d16_hi v169, v169
v_mfma_f32_16x16x32_f16 v[76:79], v[184:187], v[228:231], v[76:79]
v_or_b32 v2, v12, v13
v_pk_mul_f16 v197, v196, v197
s_waitcnt lgkmcnt(7)
v_mfma_f32_16x16x32_bf16 v[172:175], v[188:191], v[56:59], v[172:175]
v_cvt_pkrtz_f16_f32 v199, v198, v199
v_and_b32_e64 v199, s49, v199
v_mfma_f32_16x16x32_f16 v[132:135], v[184:187], v[224:227], v[132:135]
ds_read_b128 v[184:187], v251 offset:59392
v_bfe_u32 v198, v199, 2, 14
v_lshrrev_b32_e64 v199, 18, v199
v_pk_mul_f16 v126, v8, v9
v_mfma_f32_16x16x32_bf16 v[200:203], v[188:191], v[60:63], v[200:203]
ds_read_u16 v198, v198
ds_read_u16_d16_hi v199, v199
s_waitcnt lgkmcnt(6)
v_mfma_f32_16x16x32_f16 v[80:83], v[120:123], v[228:231], v[80:83]
v_exp_f16_sdwa v197, v197 dst_sel:WORD_0 dst_unused:UNUSED_PRESERVE src0_sel:WORD_0
v_or_b32 v6, v96, v97
v_cvt_pkrtz_f16_f32 v167, v166, v167
v_and_b32_e64 v167, s49, v167
v_bfe_u32 v166, v167, 2, 14
v_lshrrev_b32_e64 v167, 18, v167
v_mfma_f32_16x16x32_bf16 v[204:207], v[188:191], v[32:35], v[204:207]
ds_read_u16 v166, v166
ds_read_u16_d16_hi v167, v167
ds_read_b128 v[188:191], v251 offset:62464
v_mfma_f32_16x16x32_f16 v[136:139], v[120:123], v[224:227], v[136:139]
ds_read_b128 v[120:123], v248 offset:18432
v_or_b32_e64 v127, v10, v11
v_cvt_pkrtz_f16_f32 v171, v170, v171
v_and_b32_e64 v171, s49, v171
v_bfe_u32 v170, v171, 2, 14
v_lshrrev_b32_e64 v171, 18, v171
v_mfma_f32_16x16x32_f16 v[84:87], v[176:179], v[228:231], v[84:87]
ds_read_u16 v170, v170
ds_read_u16_d16_hi v171, v171
s_setprio 0
s_waitcnt lgkmcnt(8)
v_mfma_f32_16x16x32_bf16 v[172:175], v[180:183], v[64:67], v[172:175]
v_exp_f16_sdwa v197, v197 dst_sel:WORD_1 dst_unused:UNUSED_PRESERVE src0_sel:WORD_1
v_mfma_f32_16x16x32_f16 v[140:143], v[176:179], v[224:227], v[140:143]
ds_read_b128 v[176:179], v251 offset:8192
v_or_b32_e64 v3, v14, v15
v_mfma_f32_16x16x32_bf16 v[200:203], v[180:183], v[68:71], v[200:203]
v_or_b32_e64 v7, v98, v99
v_pk_add_f16 v197, v197, 1.0 op_sel_hi:[1,0]
v_mfma_f32_16x16x32_f16 v[88:91], v[184:187], v[228:231], v[88:91]
v_rcp_f16_sdwa v197, v197 dst_sel:WORD_0 dst_unused:UNUSED_PRESERVE src0_sel:WORD_0
v_mfma_f32_16x16x32_f16 v[240:243], v[184:187], v[224:227], v[240:243]
ds_read_b128 v[184:187], v248 offset:20480
s_nop 1
v_cvt_pkrtz_f16_f32 v201, v200, v201
v_mfma_f32_16x16x32_bf16 v[204:207], v[180:183], v[40:43], v[204:207]
ds_read_b128 v[180:183], v251 offset:11264
v_and_b32_e64 v201, s49, v201
s_waitcnt lgkmcnt(6)
v_mfma_f32_16x16x32_f16 v[92:95], v[188:191], v[228:231], v[92:95]
v_bfe_u32 v200, v201, 2, 14
v_lshrrev_b32 v201, 18, v201
s_waitcnt lgkmcnt(5)
v_mfma_f32_16x16x32_bf16 v[208:211], v[120:123], v[48:51], 0
ds_read_u16 v200, v200
ds_read_u16_d16_hi v201, v201
v_mfma_f32_16x16x32_f16 v[244:247], v[188:191], v[224:227], v[244:247]
ds_read_b128 v[188:191], v251 offset:9216
v_cvt_pk_f16_f32 v172, v172, v173
v_mfma_f32_16x16x32_bf16 v[212:215], v[120:123], v[52:55], 0
v_rcp_f16_sdwa v197, v197 dst_sel:WORD_1 dst_unused:UNUSED_PRESERVE src0_sel:WORD_1
s_waitcnt lgkmcnt(5)
v_mfma_f32_16x16x32_f16 v[72:75], v[176:179], v[116:119], v[72:75]
v_pk_fma_f16 v173, v172, v172, s48
v_cvt_pkrtz_f16_f32 v205, v204, v205
v_mfma_f32_16x16x32_f16 v[128:131], v[176:179], v[112:115], v[128:131]
ds_read_b128 v[176:179], v248 offset:22528
v_and_b32 v205, s49, v205
v_mfma_f32_16x16x32_bf16 v[8:11], v[120:123], v[24:27], 0
ds_read_b128 v[120:123], v251 offset:12288
v_bfe_u32 v204, v205, 2, 14
s_waitcnt lgkmcnt(5)
v_mfma_f32_16x16x32_f16 v[76:79], v[180:183], v[116:119], v[76:79]
v_lshrrev_b32 v205, 18, v205
v_or_b32 v164, v164, v165
v_mfma_f32_16x16x32_bf16 v[208:211], v[184:187], v[56:59], v[208:211]
ds_read_u16 v204, v204
ds_read_u16_d16_hi v205, v205
s_setprio 3
v_mfma_f32_16x16x32_f16 v[132:135], v[180:183], v[112:115], v[132:135]
ds_read_b128 v[180:183], v251 offset:10240
v_pk_mul_f16 v173, v172, v173
v_cvt_pkrtz_f16_f32 v175, v174, v175
v_and_b32_e64 v175, s49, v175
v_bfe_u32 v174, v175, 2, 14
v_lshrrev_b32 v175, 18, v175
v_pk_mul_f16 v196, v196, v197
s_waitcnt lgkmcnt(5)
v_mfma_f32_16x16x32_f16 v[80:83], v[188:191], v[116:119], v[80:83]
ds_read_u16 v174, v174
ds_read_u16_d16_hi v175, v175
v_mfma_f32_16x16x32_bf16 v[212:215], v[184:187], v[60:63], v[212:215]
v_exp_f16_sdwa v173, v173 dst_sel:WORD_0 dst_unused:UNUSED_PRESERVE src0_sel:WORD_0
v_or_b32_e64 v168, v168, v169
v_mfma_f32_16x16x32_f16 v[136:139], v[188:191], v[112:115], v[136:139]
ds_read_b128 v[188:191], v248 offset:18688
v_cvt_pkrtz_f16_f32 v203, v202, v203
v_and_b32_e64 v203, s49, v203
v_bfe_u32 v202, v203, 2, 14
v_lshrrev_b32_e64 v203, 18, v203
v_mfma_f32_16x16x32_bf16 v[8:11], v[184:187], v[32:35], v[8:11]
ds_read_u16 v202, v202
ds_read_u16_d16_hi v203, v203
ds_read_b128 v[184:187], v251 offset:13312
s_waitcnt lgkmcnt(8)
v_mfma_f32_16x16x32_f16 v[84:87], v[120:123], v[116:119], v[84:87]
v_or_b32 v197, v198, v199
v_cvt_pkrtz_f16_f32 v207, v206, v207
v_and_b32_e64 v207, s49, v207
v_bfe_u32 v206, v207, 2, 14
v_lshrrev_b32_e64 v207, 18, v207
v_mfma_f32_16x16x32_bf16 v[208:211], v[176:179], v[64:67], v[208:211]
ds_read_u16 v206, v206
ds_read_u16_d16_hi v207, v207
v_mfma_f32_16x16x32_f16 v[140:143], v[120:123], v[112:115], v[140:143]
ds_read_b128 v[120:123], v251 offset:14336
v_exp_f16_sdwa v173, v173 dst_sel:WORD_1 dst_unused:UNUSED_PRESERVE src0_sel:WORD_1
v_or_b32 v165, v166, v167
s_waitcnt lgkmcnt(8)
v_mfma_f32_16x16x32_f16 v[88:91], v[180:183], v[116:119], v[88:91]
v_or_b32_e64 v169, v170, v171
v_pk_add_f16 v173, v173, 1.0 op_sel_hi:[1,0]
v_mfma_f32_16x16x32_bf16 v[212:215], v[176:179], v[68:71], v[212:215]
v_rcp_f16_sdwa v173, v173 dst_sel:WORD_0 dst_unused:UNUSED_PRESERVE src0_sel:WORD_0
v_mfma_f32_16x16x32_f16 v[240:243], v[180:183], v[112:115], v[240:243]
ds_read_b128 v[180:183], v248 offset:20736
v_cvt_pk_f16_f32 v208, v208, v209
v_mfma_f32_16x16x32_bf16 v[8:11], v[176:179], v[40:43], v[8:11]
ds_read_b128 v[176:179], v251 offset:17408
s_nop 1
v_cvt_pkrtz_f16_f32 v213, v212, v213
s_waitcnt lgkmcnt(5)
v_mfma_f32_16x16x32_f16 v[92:95], v[184:187], v[116:119], v[92:95]
s_setprio 2
v_and_b32 v213, s49, v213
v_bfe_u32 v212, v213, 2, 14
v_mfma_f32_16x16x32_f16 v[244:247], v[184:187], v[112:115], v[244:247]
ds_read_b128 v[184:187], v251 offset:15360
v_lshrrev_b32 v213, 18, v213
v_mfma_f32_16x16x32_bf16 v[12:15], v[188:191], v[48:51], 0
ds_read_u16 v212, v212
ds_read_u16_d16_hi v213, v213
s_waitcnt vmcnt(5)
v_mfma_f32_16x16x32_bf16 v[128:131], v[18:21], v[156:159], v[128:131]
v_rcp_f16_sdwa v173, v173 dst_sel:WORD_1 dst_unused:UNUSED_PRESERVE src0_sel:WORD_1
v_mfma_f32_16x16x32_bf16 v[132:135], v[16:19], v[156:159], v[132:135]
v_pk_fma_f16 v209, v208, v208, s48
v_cvt_pkrtz_f16_f32 v9, v8, v9
s_waitcnt vmcnt(4)
v_mfma_f32_16x16x32_bf16 v[136:139], v[18:21], v[160:163], v[136:139]
v_and_b32 v9, s49, v9
v_bfe_u32 v8, v9, 2, 14
v_mfma_f32_16x16x32_bf16 v[140:143], v[16:19], v[160:163], v[140:143]
v_lshrrev_b32_e64 v9, 18, v9
v_or_b32 v166, v200, v201
s_waitcnt lgkmcnt(4)
v_mfma_f32_16x16x32_f16 v[72:75], v[120:123], v[220:223], v[72:75]
ds_read_u16 v8, v8
ds_read_u16_d16_hi v9, v9
v_mfma_f32_16x16x32_bf16 v[96:99], v[188:191], v[52:55], 0
v_pk_mul_f16 v209, v208, v209
v_cvt_pkrtz_f16_f32 v211, v210, v211
v_mfma_f32_16x16x32_f16 v[128:131], v[120:123], v[216:219], v[128:131]
ds_read_b128 v[120:123], v248 offset:22784
v_and_b32_e64 v211, s49, v211
v_mfma_f32_16x16x32_bf16 v[224:227], v[188:191], v[24:27], 0
ds_read_b128 v[188:191], v251 offset:18432
v_bfe_u32 v210, v211, 2, 14
s_waitcnt lgkmcnt(5)
v_mfma_f32_16x16x32_f16 v[76:79], v[176:179], v[220:223], v[76:79]
v_lshrrev_b32 v211, 18, v211
v_pk_mul_f16 v198, v172, v173
v_mfma_f32_16x16x32_f16 v[132:135], v[176:179], v[216:219], v[132:135]
ds_read_b128 v[176:179], v251 offset:16384
ds_read_u16 v210, v210
v_mfma_f32_16x16x32_bf16 v[12:15], v[180:183], v[56:59], v[12:15]
ds_read_u16_d16_hi v211, v211
v_exp_f16_sdwa v209, v209 dst_sel:WORD_0 dst_unused:UNUSED_PRESERVE src0_sel:WORD_0
v_mfma_f32_16x16x32_f16 v[80:83], v[184:187], v[220:223], v[80:83]
v_or_b32_e64 v170, v204, v205
v_cvt_pkrtz_f16_f32 v215, v214, v215
v_mfma_f32_16x16x32_bf16 v[96:99], v[180:183], v[60:63], v[96:99]
v_and_b32_e64 v215, s49, v215
v_bfe_u32 v214, v215, 2, 14
v_mfma_f32_16x16x32_f16 v[136:139], v[184:187], v[216:219], v[136:139]
ds_read_b128 v[184:187], v248 offset:24576
v_lshrrev_b32_e64 v215, 18, v215
v_mfma_f32_16x16x32_bf16 v[224:227], v[180:183], v[32:35], v[224:227]
ds_read_u16 v214, v214
ds_read_u16_d16_hi v215, v215
ds_read_b128 v[180:183], v251 offset:19456
s_waitcnt lgkmcnt(7)
v_mfma_f32_16x16x32_f16 v[84:87], v[188:191], v[220:223], v[84:87]
v_or_b32 v199, v174, v175
v_cvt_pkrtz_f16_f32 v11, v10, v11
v_and_b32_e64 v11, s49, v11
v_bfe_u32 v10, v11, 2, 14
v_lshrrev_b32_e64 v11, 18, v11
v_mfma_f32_16x16x32_f16 v[140:143], v[188:191], v[216:219], v[140:143]
ds_read_u16 v10, v10
ds_read_u16_d16_hi v11, v11
ds_read_b128 v[188:191], v251 offset:63488
s_setprio 1
v_mfma_f32_16x16x32_bf16 v[12:15], v[120:123], v[64:67], v[12:15]
v_exp_f16_sdwa v209, v209 dst_sel:WORD_1 dst_unused:UNUSED_PRESERVE src0_sel:WORD_1
s_waitcnt lgkmcnt(8)
v_mfma_f32_16x16x32_f16 v[88:91], v[176:179], v[220:223], v[88:91]
v_or_b32_e64 v167, v202, v203
v_or_b32 v171, v206, v207
v_mfma_f32_16x16x32_bf16 v[96:99], v[120:123], v[68:71], v[96:99]
v_pk_add_f16 v209, v209, 1.0 op_sel_hi:[1,0]
s_nop 0
v_cvt_pk_f16_f32 v12, v12, v13
v_mfma_f32_16x16x32_f16 v[240:243], v[176:179], v[216:219], v[240:243]
ds_read_b128 v[176:179], v248 offset:26624
v_rcp_f16_sdwa v209, v209 dst_sel:WORD_0 dst_unused:UNUSED_PRESERVE src0_sel:WORD_0
v_mfma_f32_16x16x32_bf16 v[224:227], v[120:123], v[40:43], v[224:227]
ds_read_b128 v[120:123], v252 offset:1024
v_cvt_pkrtz_f16_f32 v97, v96, v97
s_waitcnt lgkmcnt(5)
v_mfma_f32_16x16x32_f16 v[92:95], v[180:183], v[220:223], v[92:95]
v_and_b32 v97, s49, v97
v_bfe_u32 v96, v97, 2, 14
v_mfma_f32_16x16x32_f16 v[244:247], v[180:183], v[216:219], v[244:247]
ds_read_b128 v[180:183], v251 offset:64512
v_lshrrev_b32 v97, 18, v97
v_mfma_f32_16x16x32_bf16 v[228:231], v[184:187], v[48:51], 0
ds_read_u16 v96, v96
ds_read_u16_d16_hi v97, v97
s_waitcnt vmcnt(3)
v_mfma_f32_16x16x32_bf16 v[240:243], v[18:21], v[100:103], v[240:243]
v_rcp_f16_sdwa v209, v209 dst_sel:WORD_1 dst_unused:UNUSED_PRESERVE src0_sel:WORD_1
v_mfma_f32_16x16x32_bf16 v[244:247], v[16:19], v[100:103], v[244:247]
v_pk_fma_f16 v13, v12, v12, s48
v_cvt_pkrtz_f16_f32 v225, v224, v225
s_waitcnt vmcnt(2)
v_mfma_f32_16x16x32_bf16 v[72:75], v[18:21], v[104:107], v[72:75]
v_and_b32 v225, s49, v225
v_bfe_u32 v224, v225, 2, 14
v_mfma_f32_16x16x32_bf16 v[76:79], v[16:19], v[104:107], v[76:79]
v_lshrrev_b32_e64 v225, 18, v225
v_or_b32 v212, v212, v213
s_waitcnt lgkmcnt(3)
v_mfma_f32_16x16x32_f16 v[72:75], v[188:191], v[236:239], v[72:75]
ds_read_u16 v224, v224
ds_read_u16_d16_hi v225, v225
v_mfma_f32_16x16x32_bf16 v[112:115], v[184:187], v[52:55], 0
v_pk_mul_f16 v13, v12, v13
v_cvt_pkrtz_f16_f32 v15, v14, v15
v_mfma_f32_16x16x32_f16 v[128:131], v[188:191], v[232:235], v[128:131]
ds_read_b128 v[188:191], v248 offset:28672
v_and_b32_e64 v15, s49, v15
v_mfma_f32_16x16x32_f16 v[76:79], v[120:123], v[236:239], v[76:79]
v_bfe_u32 v14, v15, 2, 14
v_lshrrev_b32_e64 v15, 18, v15
v_mfma_f32_16x16x32_bf16 v[116:119], v[184:187], v[24:27], 0
ds_read_b128 v[184:187], v252 offset:2048
ds_read_u16 v14, v14
v_mfma_f32_16x16x32_f16 v[132:135], v[120:123], v[232:235], v[132:135]
ds_read_b128 v[120:123], v252
s_setprio 0
ds_read_u16_d16_hi v15, v15
v_mfma_f32_16x16x32_bf16 v[228:231], v[176:179], v[56:59], v[228:231]
v_pk_mul_f16 v208, v208, v209
v_exp_f16_sdwa v13, v13 dst_sel:WORD_0 dst_unused:UNUSED_PRESERVE src0_sel:WORD_0
s_waitcnt lgkmcnt(7)
v_mfma_f32_16x16x32_f16 v[80:83], v[180:183], v[236:239], v[80:83]
v_or_b32_e64 v8, v8, v9
v_cvt_pkrtz_f16_f32 v99, v98, v99
v_mfma_f32_16x16x32_f16 v[136:139], v[180:183], v[232:235], v[136:139]
ds_read_b128 v[180:183], v248 offset:24832
v_and_b32_e64 v99, s49, v99
v_mfma_f32_16x16x32_bf16 v[112:115], v[176:179], v[60:63], v[112:115]
v_bfe_u32 v98, v99, 2, 14
v_lshrrev_b32 v99, 18, v99
s_waitcnt lgkmcnt(4)
v_mfma_f32_16x16x32_f16 v[84:87], v[184:187], v[236:239], v[84:87]
ds_read_u16 v98, v98
ds_read_u16_d16_hi v99, v99
v_mfma_f32_16x16x32_bf16 v[116:119], v[176:179], v[32:35], v[116:119]
ds_read_b128 v[176:179], v252 offset:3072
v_cvt_pk_bf16_f32 v128, v128, v129
v_cvt_pk_bf16_f32 v129, v130, v131
v_cvt_pk_bf16_f32 v130, v132, v133
v_cvt_pk_bf16_f32 v131, v134, v135
v_cvt_pk_bf16_f32 v72, v72, v73
v_cvt_pk_bf16_f32 v73, v74, v75
v_cvt_pk_bf16_f32 v74, v76, v77
v_cvt_pk_bf16_f32 v75, v78, v79
v_mfma_f32_16x16x32_f16 v[140:143], v[184:187], v[232:235], v[140:143]
ds_read_b128 v[132:135], v254 offset:8192
ds_read_b128 v[76:79], v254 offset:8208
ds_read_b128 v[184:187], v251 offset:8192
v_or_b32_e64 v209, v210, v211
v_cvt_pkrtz_f16_f32 v227, v226, v227
v_and_b32_e64 v227, s49, v227
v_bfe_u32 v226, v227, 2, 14
v_lshrrev_b32_e64 v227, 18, v227
v_cvt_pk_bf16_f32 v136, v136, v137
v_cvt_pk_bf16_f32 v137, v138, v139
v_cvt_pk_bf16_f32 v138, v140, v141
v_cvt_pk_bf16_f32 v139, v142, v143
v_mfma_f32_16x16x32_bf16 v[228:231], v[188:191], v[64:67], v[228:231]
ds_read_u16 v226, v226
ds_read_u16_d16_hi v227, v227
ds_read_b128 v[140:143], v254 offset:8320
s_waitcnt lgkmcnt(8)
v_mfma_f32_16x16x32_f16 v[88:91], v[120:123], v[236:239], v[88:91]
v_exp_f16_sdwa v13, v13 dst_sel:WORD_1 dst_unused:UNUSED_PRESERVE src0_sel:WORD_1
v_or_b32 v213, v214, v215
v_mfma_f32_16x16x32_f16 v[240:243], v[120:123], v[232:235], v[240:243]
ds_read_b128 v[120:123], v248 offset:26880
v_or_b32 v9, v10, v11
v_mfma_f32_16x16x32_bf16 v[112:115], v[188:191], v[68:71], v[112:115]
v_pk_add_f16 v13, v13, 1.0 op_sel_hi:[1,0]
v_cvt_pk_f16_f32 v228, v228, v229
s_waitcnt lgkmcnt(6)
v_mfma_f32_16x16x32_f16 v[92:95], v[176:179], v[236:239], v[92:95]
v_rcp_f16_sdwa v13, v13 dst_sel:WORD_0 dst_unused:UNUSED_PRESERVE src0_sel:WORD_0
v_cvt_pk_bf16_f32 v240, v240, v241
v_cvt_pk_bf16_f32 v241, v242, v243
v_mfma_f32_16x16x32_bf16 v[116:119], v[188:191], v[40:43], v[116:119]
ds_read_b128 v[188:191], v251 offset:11264
v_cvt_pkrtz_f16_f32 v113, v112, v113
v_mfma_f32_16x16x32_f16 v[244:247], v[176:179], v[232:235], v[244:247]
ds_read_b128 v[176:179], v251 offset:9216
v_and_b32 v113, s49, v113
s_waitcnt vmcnt(1)
v_mfma_f32_16x16x32_bf16 v[80:83], v[18:21], v[108:111], v[80:83]
v_bfe_u32 v112, v113, 2, 14
v_lshrrev_b32 v113, 18, v113
v_mfma_f32_16x16x32_bf16 v[84:87], v[16:19], v[108:111], v[84:87]
ds_read_u16 v112, v112
v_cvt_pk_bf16_f32 v242, v244, v245
v_cvt_pk_bf16_f32 v243, v246, v247
s_waitcnt vmcnt(0)
v_mfma_f32_16x16x32_bf16 v[88:91], v[18:21], v[192:195], v[88:91]
ds_read_b128 v[244:247], v254
v_cvt_pk_bf16_f32 v80, v80, v81
v_mfma_f32_16x16x32_bf16 v[92:95], v[16:19], v[192:195], v[92:95]
v_cvt_pk_bf16_f32 v81, v82, v83
v_cvt_pk_bf16_f32 v82, v84, v85
v_cvt_pk_bf16_f32 v83, v86, v87
v_mfma_f32_16x16x32_bf16 v[156:159], v[180:183], v[48:51], 0
ds_read_b128 v[84:87], v254 offset:8336
v_cvt_pk_bf16_f32 v88, v88, v89
v_cvt_pk_bf16_f32 v89, v90, v91
s_setprio 3
v_cvt_pk_bf16_f32 v90, v92, v93
v_cvt_pk_bf16_f32 v91, v94, v95
s_waitcnt lgkmcnt(4)
v_mfma_f32_16x16x32_f16 v[200:203], v[184:187], v[152:155], v[132:135]
ds_read_b128 v[92:95], v254 offset:16
ds_read_u16_d16_hi v113, v113
v_mfma_f32_16x16x32_f16 v[204:207], v[184:187], v[148:151], v[132:135]
v_rcp_f16_sdwa v13, v13 dst_sel:WORD_1 dst_unused:UNUSED_PRESERVE src0_sel:WORD_1
v_mfma_f32_16x16x32_bf16 v[160:163], v[180:183], v[52:55], 0
buffer_store_dwordx4 v[128:131], v253, s[8:11], s71 offen sc1
buffer_store_dwordx4 v[136:139], v253, s[8:11], s71 offen offset:64 sc1
v_pk_fma_f16 v229, v228, v228, s48
v_mfma_f32_16x16x32_f16 v[132:135], v[184:187], v[144:147], v[132:135]
ds_read_b128 v[184:187], v248 offset:28928
v_cvt_pkrtz_f16_f32 v117, v116, v117
v_mfma_f32_16x16x32_f16 v[216:219], v[188:191], v[152:155], v[76:79]
v_and_b32_e64 v117, s49, v117
v_bfe_u32 v116, v117, 2, 14
v_mfma_f32_16x16x32_bf16 v[172:175], v[180:183], v[24:27], 0
ds_read_b128 v[180:183], v251 offset:12288
v_lshrrev_b32_e64 v117, 18, v117
v_mfma_f32_16x16x32_f16 v[220:223], v[188:191], v[148:151], v[76:79]
ds_read_u16 v116, v116
ds_read_u16_d16_hi v117, v117
v_mfma_f32_16x16x32_bf16 v[156:159], v[120:123], v[56:59], v[156:159]
v_or_b32_e64 v214, v96, v97
v_pk_mul_f16 v229, v228, v229
v_mfma_f32_16x16x32_f16 v[76:79], v[188:191], v[144:147], v[76:79]
ds_read_b128 v[188:191], v251 offset:10240
v_cvt_pkrtz_f16_f32 v231, v230, v231
v_and_b32_e64 v231, s49, v231
v_bfe_u32 v230, v231, 2, 14
v_lshrrev_b32 v231, 18, v231
v_pk_mul_f16 v210, v12, v13
s_waitcnt lgkmcnt(5)
v_mfma_f32_16x16x32_f16 v[100:103], v[176:179], v[152:155], v[140:143]
ds_read_u16 v230, v230
ds_read_u16_d16_hi v231, v231
v_mfma_f32_16x16x32_bf16 v[160:163], v[120:123], v[60:63], v[160:163]
v_exp_f16_sdwa v229, v229 dst_sel:WORD_0 dst_unused:UNUSED_PRESERVE src0_sel:WORD_0
v_mfma_f32_16x16x32_f16 v[104:107], v[176:179], v[148:151], v[140:143]
v_or_b32_e64 v10, v224, v225
v_cvt_pkrtz_f16_f32 v115, v114, v115
v_and_b32_e64 v115, s49, v115
v_bfe_u32 v114, v115, 2, 14
v_lshrrev_b32_e64 v115, 18, v115
v_mfma_f32_16x16x32_bf16 v[172:175], v[120:123], v[32:35], v[172:175]
ds_read_u16 v114, v114
ds_read_u16_d16_hi v115, v115
ds_read_b128 v[120:123], v248 offset:30720
v_mfma_f32_16x16x32_f16 v[140:143], v[176:179], v[144:147], v[140:143]
ds_read_b128 v[176:179], v251 offset:13312
v_or_b32_e64 v211, v14, v15
v_cvt_pkrtz_f16_f32 v119, v118, v119
v_and_b32_e64 v119, s49, v119
v_bfe_u32 v118, v119, 2, 14
v_lshrrev_b32 v119, 18, v119
s_waitcnt lgkmcnt(6)
v_mfma_f32_16x16x32_f16 v[232:235], v[180:183], v[152:155], v[84:87]
ds_read_u16 v118, v118
ds_read_u16_d16_hi v119, v119
s_setprio 2
v_mfma_f32_16x16x32_bf16 v[156:159], v[184:187], v[64:67], v[156:159]
v_exp_f16_sdwa v229, v229 dst_sel:WORD_1 dst_unused:UNUSED_PRESERVE src0_sel:WORD_1
v_mfma_f32_16x16x32_f16 v[236:239], v[180:183], v[148:151], v[84:87]
v_or_b32 v215, v98, v99
v_or_b32 v11, v226, v227
v_mfma_f32_16x16x32_bf16 v[160:163], v[184:187], v[68:71], v[160:163]
v_pk_add_f16 v229, v229, 1.0 op_sel_hi:[1,0]
s_nop 1
v_cvt_pk_f16_f32 v156, v156, v157
v_mfma_f32_16x16x32_f16 v[84:87], v[180:183], v[144:147], v[84:87]
ds_read_b128 v[180:183], v251 offset:14336
v_rcp_f16_sdwa v229, v229 dst_sel:WORD_0 dst_unused:UNUSED_PRESERVE src0_sel:WORD_0
v_mfma_f32_16x16x32_f16 v[108:111], v[188:191], v[152:155], v[244:247]
v_cvt_pkrtz_f16_f32 v161, v160, v161
v_and_b32_e64 v161, s49, v161
v_mfma_f32_16x16x32_bf16 v[172:175], v[184:187], v[40:43], v[172:175]
ds_read_b128 v[184:187], v248 offset:32768
v_bfe_u32 v160, v161, 2, 14
v_mfma_f32_16x16x32_f16 v[192:195], v[188:191], v[148:151], v[244:247]
v_lshrrev_b32 v161, 18, v161
v_rcp_f16_sdwa v229, v229 dst_sel:WORD_1 dst_unused:UNUSED_PRESERVE src0_sel:WORD_1
s_waitcnt lgkmcnt(4)
v_mfma_f32_16x16x32_bf16 v[128:131], v[120:123], v[48:51], 0
ds_read_u16 v160, v160
ds_read_u16_d16_hi v161, v161
v_mfma_f32_16x16x32_f16 v[244:247], v[188:191], v[144:147], v[244:247]
ds_read_b128 v[188:191], v251 offset:17408
v_pk_fma_f16 v157, v156, v156, s48
v_mfma_f32_16x16x32_f16 v[96:99], v[176:179], v[152:155], v[92:95]
v_cvt_pkrtz_f16_f32 v173, v172, v173
v_and_b32_e64 v173, s49, v173
v_mfma_f32_16x16x32_bf16 v[136:139], v[120:123], v[52:55], 0
v_bfe_u32 v172, v173, 2, 14
v_lshrrev_b32_e64 v173, 18, v173
v_mfma_f32_16x16x32_f16 v[224:227], v[176:179], v[148:151], v[92:95]
ds_read_u16 v172, v172
ds_read_u16_d16_hi v173, v173
v_mfma_f32_16x16x32_bf16 v[12:15], v[120:123], v[24:27], 0
ds_read_b128 v[120:123], v248 offset:34816
v_or_b32_e64 v112, v112, v113
v_mfma_f32_16x16x32_f16 v[92:95], v[176:179], v[144:147], v[92:95]
ds_read_b128 v[176:179], v251 offset:15360
v_pk_mul_f16 v157, v156, v157
s_waitcnt lgkmcnt(7)
v_mfma_f32_16x16x32_f16 v[200:203], v[180:183], v[4:7], v[200:203]
s_setprio 1
v_cvt_pkrtz_f16_f32 v159, v158, v159
v_and_b32_e64 v159, s49, v159
v_mfma_f32_16x16x32_bf16 v[128:131], v[184:187], v[56:59], v[128:131]
v_bfe_u32 v158, v159, 2, 14
v_lshrrev_b32_e64 v159, 18, v159
v_mfma_f32_16x16x32_f16 v[204:207], v[180:183], v[0:3], v[204:207]
ds_read_u16 v158, v158
ds_read_u16_d16_hi v159, v159
v_pk_mul_f16 v228, v228, v229
v_mfma_f32_16x16x32_bf16 v[136:139], v[184:187], v[60:63], v[136:139]
v_exp_f16_sdwa v157, v157 dst_sel:WORD_0 dst_unused:UNUSED_PRESERVE src0_sel:WORD_0
v_mfma_f32_16x16x32_f16 v[132:135], v[180:183], v[124:127], v[132:135]
ds_read_b128 v[180:183], v251 offset:18432
v_or_b32 v116, v116, v117
s_waitcnt lgkmcnt(6)
v_mfma_f32_16x16x32_f16 v[216:219], v[188:191], v[4:7], v[216:219]
v_cvt_pkrtz_f16_f32 v163, v162, v163
v_and_b32_e64 v163, s49, v163
v_bfe_u32 v162, v163, 2, 14
v_lshrrev_b32_e64 v163, 18, v163
v_mfma_f32_16x16x32_bf16 v[12:15], v[184:187], v[32:35], v[12:15]
ds_read_u16 v162, v162
ds_read_u16_d16_hi v163, v163
ds_read_b128 v[184:187], v248 offset:30976
v_mfma_f32_16x16x32_f16 v[220:223], v[188:191], v[0:3], v[220:223]
v_or_b32_e64 v229, v230, v231
v_cvt_pkrtz_f16_f32 v175, v174, v175
v_and_b32_e64 v175, s49, v175
v_bfe_u32 v174, v175, 2, 14
v_lshrrev_b32 v175, 18, v175
s_waitcnt lgkmcnt(6)
v_mfma_f32_16x16x32_bf16 v[128:131], v[120:123], v[64:67], v[128:131]
ds_read_u16 v174, v174
ds_read_u16_d16_hi v175, v175
v_mfma_f32_16x16x32_f16 v[76:79], v[188:191], v[124:127], v[76:79]
ds_read_b128 v[188:191], v251 offset:16384
v_exp_f16_sdwa v157, v157 dst_sel:WORD_1 dst_unused:UNUSED_PRESERVE src0_sel:WORD_1
v_or_b32_e64 v113, v114, v115
v_mfma_f32_16x16x32_f16 v[100:103], v[176:179], v[4:7], v[100:103]
v_or_b32_e64 v117, v118, v119
v_pk_add_f16 v157, v157, 1.0 op_sel_hi:[1,0]
v_mfma_f32_16x16x32_bf16 v[136:139], v[120:123], v[68:71], v[136:139]
v_rcp_f16_sdwa v157, v157 dst_sel:WORD_0 dst_unused:UNUSED_PRESERVE src0_sel:WORD_0
v_mfma_f32_16x16x32_f16 v[104:107], v[176:179], v[0:3], v[104:107]
v_cvt_pk_f16_f32 v128, v128, v129
v_rcp_f16_sdwa v157, v157 dst_sel:WORD_1 dst_unused:UNUSED_PRESERVE src0_sel:WORD_1
v_mfma_f32_16x16x32_f16 v[140:143], v[176:179], v[124:127], v[140:143]
ds_read_b128 v[176:179], v251 offset:19456
s_nop 1
v_cvt_pkrtz_f16_f32 v137, v136, v137
v_mfma_f32_16x16x32_bf16 v[12:15], v[120:123], v[40:43], v[12:15]
ds_read_b128 v[120:123], v248 offset:33024
v_and_b32 v137, s49, v137
s_waitcnt lgkmcnt(5)
v_mfma_f32_16x16x32_f16 v[232:235], v[180:183], v[4:7], v[232:235]
s_setprio 0
v_bfe_u32 v136, v137, 2, 14
v_lshrrev_b32_e64 v137, 18, v137
v_mfma_f32_16x16x32_bf16 v[144:147], v[184:187], v[48:51], 0
ds_read_u16 v136, v136
ds_read_u16_d16_hi v137, v137
v_mfma_f32_16x16x32_f16 v[236:239], v[180:183], v[0:3], v[236:239]
v_pk_fma_f16 v129, v128, v128, s48
v_cvt_pkrtz_f16_f32 v13, v12, v13
v_mfma_f32_16x16x32_f16 v[84:87], v[180:183], v[124:127], v[84:87]
ds_read_b128 v[180:183], v248 offset:35072
v_and_b32_e64 v13, s49, v13
v_mfma_f32_16x16x32_bf16 v[148:151], v[184:187], v[52:55], 0
v_bfe_u32 v12, v13, 2, 14
v_lshrrev_b32 v13, 18, v13
s_waitcnt lgkmcnt(5)
v_mfma_f32_16x16x32_f16 v[108:111], v[188:191], v[4:7], v[108:111]
ds_read_u16 v12, v12
ds_read_u16_d16_hi v13, v13
v_mfma_f32_16x16x32_bf16 v[152:155], v[184:187], v[24:27], 0
ds_read_b128 v[184:187], v251 offset:23552
v_or_b32_e64 v114, v160, v161
v_mfma_f32_16x16x32_f16 v[192:195], v[188:191], v[0:3], v[192:195]
buffer_store_dwordx4 v[240:243], v253, s[8:11], s71 offen offset:128 sc1
buffer_store_dwordx4 v[72:75], v253, s[8:11], s71 offen offset:192 sc1
v_pk_mul_f16 v129, v128, v129
v_mfma_f32_16x16x32_f16 v[244:247], v[188:191], v[124:127], v[244:247]
ds_read_b128 v[188:191], v249
buffer_load_dwordx4 v[240:243], v253, s[4:7], s70 offen
buffer_load_dwordx4 v[72:75], v253, s[4:7], s70 offen offset:64
s_waitcnt lgkmcnt(7)
v_mfma_f32_16x16x32_bf16 v[144:147], v[120:123], v[56:59], v[144:147]
v_cvt_pkrtz_f16_f32 v131, v130, v131
v_and_b32 v131, s49, v131
v_mfma_f32_16x16x32_f16 v[96:99], v[176:179], v[4:7], v[96:99]
ds_read_b128 v[4:7], v251 offset:20480
v_bfe_u32 v130, v131, 2, 14
v_lshrrev_b32_e64 v131, 18, v131
v_pk_mul_f16 v230, v156, v157
v_mfma_f32_16x16x32_bf16 v[148:151], v[120:123], v[60:63], v[148:151]
ds_read_u16 v130, v130
ds_read_u16_d16_hi v131, v131
v_mfma_f32_16x16x32_f16 v[224:227], v[176:179], v[0:3], v[224:227]
v_exp_f16_sdwa v129, v129 dst_sel:WORD_0 dst_unused:UNUSED_PRESERVE src0_sel:WORD_0
v_or_b32_e64 v118, v172, v173
v_cvt_pkrtz_f16_f32 v139, v138, v139
v_and_b32_e64 v139, s49, v139
v_bfe_u32 v138, v139, 2, 14
v_lshrrev_b32_e64 v139, 18, v139
v_mfma_f32_16x16x32_f16 v[92:95], v[176:179], v[124:127], v[92:95]
ds_read_u16 v138, v138
ds_read_u16_d16_hi v139, v139
ds_read_b128 v[176:179], v251 offset:24576
v_mfma_f32_16x16x32_bf16 v[152:155], v[120:123], v[32:35], v[152:155]
ds_read_b128 v[120:123], v251 offset:21504
buffer_load_dwordx4 v[124:127], v253, s[4:7], s70 offen offset:128
buffer_load_dwordx4 v[0:3], v253, s[4:7], s70 offen offset:192
s_waitcnt lgkmcnt(6)
v_mfma_f32_16x16x32_f16 v[200:203], v[4:7], v[168:171], v[200:203]
v_or_b32 v231, v158, v159
v_cvt_pkrtz_f16_f32 v15, v14, v15
v_and_b32_e64 v15, s49, v15
v_bfe_u32 v14, v15, 2, 14
v_lshrrev_b32_e64 v15, 18, v15
v_mfma_f32_16x16x32_bf16 v[144:147], v[180:183], v[64:67], v[144:147]
ds_read_u16 v14, v14
ds_read_u16_d16_hi v15, v15
s_setprio 3
v_mfma_f32_16x16x32_f16 v[204:207], v[4:7], v[164:167], v[204:207]
v_exp_f16_sdwa v129, v129 dst_sel:WORD_1 dst_unused:UNUSED_PRESERVE src0_sel:WORD_1
v_or_b32 v115, v162, v163
v_mfma_f32_16x16x32_f16 v[132:135], v[4:7], v[196:199], v[132:135]
ds_read_b128 v[4:7], v249 offset:2048
v_or_b32_e64 v119, v174, v175
v_mfma_f32_16x16x32_bf16 v[148:151], v[180:183], v[68:71], v[148:151]
v_pk_add_f16 v129, v129, 1.0 op_sel_hi:[1,0]
v_cvt_pk_f16_f32 v144, v144, v145
v_mfma_f32_16x16x32_f16 v[216:219], v[184:187], v[168:171], v[216:219]
v_rcp_f16_sdwa v129, v129 dst_sel:WORD_0 dst_unused:UNUSED_PRESERVE src0_sel:WORD_0
v_mfma_f32_16x16x32_bf16 v[152:155], v[180:183], v[40:43], v[152:155]
ds_read_b128 v[180:183], v251 offset:22528
s_nop 1
v_cvt_pkrtz_f16_f32 v149, v148, v149
v_mfma_f32_16x16x32_f16 v[220:223], v[184:187], v[164:167], v[220:223]
v_and_b32 v149, s49, v149
v_bfe_u32 v148, v149, 2, 14
v_mfma_f32_16x16x32_f16 v[76:79], v[184:187], v[196:199], v[76:79]
ds_read_b128 v[184:187], v249 offset:4096
v_lshrrev_b32 v149, 18, v149
v_mfma_f32_16x16x32_bf16 v[156:159], v[188:191], v[48:51], 0
ds_read_u16 v148, v148
ds_read_u16_d16_hi v149, v149
s_waitcnt lgkmcnt(6)
v_mfma_f32_16x16x32_f16 v[100:103], v[120:123], v[168:171], v[100:103]
v_rcp_f16_sdwa v129, v129 dst_sel:WORD_1 dst_unused:UNUSED_PRESERVE src0_sel:WORD_1
v_mfma_f32_16x16x32_bf16 v[160:163], v[188:191], v[52:55], 0
v_pk_fma_f16 v145, v144, v144, s48
v_cvt_pkrtz_f16_f32 v153, v152, v153
v_mfma_f32_16x16x32_f16 v[104:107], v[120:123], v[164:167], v[104:107]
v_and_b32_e64 v153, s49, v153
v_bfe_u32 v152, v153, 2, 14
v_mfma_f32_16x16x32_f16 v[140:143], v[120:123], v[196:199], v[140:143]
ds_read_b128 v[120:123], v251 offset:26624
v_lshrrev_b32_e64 v153, 18, v153
v_mfma_f32_16x16x32_bf16 v[172:175], v[188:191], v[24:27], 0
ds_read_b128 v[188:191], v251 offset:25600
ds_read_u16 v152, v152
v_mfma_f32_16x16x32_f16 v[232:235], v[176:179], v[168:171], v[232:235]
ds_read_u16_d16_hi v153, v153
s_setprio 2
v_or_b32_e64 v136, v136, v137
s_waitcnt lgkmcnt(6)
v_mfma_f32_16x16x32_bf16 v[156:159], v[4:7], v[56:59], v[156:159]
v_pk_mul_f16 v145, v144, v145
v_cvt_pkrtz_f16_f32 v147, v146, v147
v_mfma_f32_16x16x32_f16 v[236:239], v[176:179], v[164:167], v[236:239]
v_and_b32_e64 v147, s49, v147
v_bfe_u32 v146, v147, 2, 14
v_mfma_f32_16x16x32_f16 v[84:87], v[176:179], v[196:199], v[84:87]
ds_read_b128 v[176:179], v249 offset:256
v_lshrrev_b32_e64 v147, 18, v147
v_pk_mul_f16 v128, v128, v129
v_mfma_f32_16x16x32_bf16 v[160:163], v[4:7], v[60:63], v[160:163]
ds_read_u16 v146, v146
ds_read_u16_d16_hi v147, v147
v_mfma_f32_16x16x32_f16 v[108:111], v[180:183], v[168:171], v[108:111]
v_exp_f16_sdwa v145, v145 dst_sel:WORD_0 dst_unused:UNUSED_PRESERVE src0_sel:WORD_0
v_or_b32_e64 v12, v12, v13
v_cvt_pkrtz_f16_f32 v151, v150, v151
v_and_b32_e64 v151, s49, v151
v_bfe_u32 v150, v151, 2, 14
v_lshrrev_b32_e64 v151, 18, v151
v_mfma_f32_16x16x32_f16 v[192:195], v[180:183], v[164:167], v[192:195]
ds_read_u16 v150, v150
ds_read_u16_d16_hi v151, v151
v_mfma_f32_16x16x32_bf16 v[172:175], v[4:7], v[32:35], v[172:175]
ds_read_b128 v[4:7], v251 offset:29696
v_or_b32_e64 v129, v130, v131
v_mfma_f32_16x16x32_f16 v[244:247], v[180:183], v[196:199], v[244:247]
ds_read_b128 v[180:183], v249 offset:2304
v_cvt_pkrtz_f16_f32 v155, v154, v155
v_and_b32_e64 v155, s49, v155
v_bfe_u32 v154, v155, 2, 14
v_lshrrev_b32_e64 v155, 18, v155
v_mfma_f32_16x16x32_bf16 v[156:159], v[184:187], v[64:67], v[156:159]
ds_read_u16 v154, v154
ds_read_u16_d16_hi v155, v155
s_waitcnt lgkmcnt(8)
v_mfma_f32_16x16x32_f16 v[96:99], v[188:191], v[168:171], v[96:99]
v_exp_f16_sdwa v145, v145 dst_sel:WORD_1 dst_unused:UNUSED_PRESERVE src0_sel:WORD_1
v_or_b32 v137, v138, v139
v_mfma_f32_16x16x32_f16 v[224:227], v[188:191], v[164:167], v[224:227]
v_or_b32_e64 v13, v14, v15
v_pk_add_f16 v145, v145, 1.0 op_sel_hi:[1,0]
v_mfma_f32_16x16x32_bf16 v[160:163], v[184:187], v[68:71], v[160:163]
v_rcp_f16_sdwa v145, v145 dst_sel:WORD_0 dst_unused:UNUSED_PRESERVE src0_sel:WORD_0
v_mfma_f32_16x16x32_f16 v[92:95], v[188:191], v[196:199], v[92:95]
ds_read_b128 v[188:191], v251 offset:30720
v_cvt_pkrtz_f16_f32 v157, v156, v157
v_mfma_f32_16x16x32_bf16 v[172:175], v[184:187], v[40:43], v[172:175]
ds_read_b128 v[184:187], v251 offset:27648
v_and_b32 v157, s49, v157
v_mfma_f32_16x16x32_f16 v[200:203], v[120:123], v[8:11], v[200:203]
s_setprio 1
v_bfe_u32 v156, v157, 2, 14
v_lshrrev_b32_e64 v157, 18, v157
v_mfma_f32_16x16x32_f16 v[204:207], v[120:123], v[212:215], v[204:207]
ds_read_u16 v156, v156
ds_read_u16_d16_hi v157, v157
v_mfma_f32_16x16x32_bf16 v[196:199], v[176:179], v[48:51], 0
v_rcp_f16_sdwa v145, v145 dst_sel:WORD_1 dst_unused:UNUSED_PRESERVE src0_sel:WORD_1
v_mfma_f32_16x16x32_f16 v[132:135], v[120:123], v[208:211], v[132:135]
ds_read_b128 v[120:123], v249 offset:4352
v_cvt_pkrtz_f16_f32 v161, v160, v161
v_mfma_f32_16x16x32_bf16 v[164:167], v[176:179], v[52:55], 0
v_and_b32 v161, s49, v161
v_bfe_u32 v160, v161, 2, 14
s_waitcnt lgkmcnt(5)
v_mfma_f32_16x16x32_f16 v[216:219], v[4:7], v[8:11], v[216:219]
v_lshrrev_b32_e64 v161, 18, v161
v_cvt_pkrtz_f16_f32 v173, v172, v173
v_mfma_f32_16x16x32_f16 v[220:223], v[4:7], v[212:215], v[220:223]
ds_read_u16 v160, v160
ds_read_u16_d16_hi v161, v161
v_mfma_f32_16x16x32_bf16 v[168:171], v[176:179], v[24:27], 0
ds_read_b128 v[176:179], v251 offset:28672
v_and_b32_e64 v173, s49, v173
v_mfma_f32_16x16x32_f16 v[76:79], v[4:7], v[208:211], v[76:79]
ds_read_b128 v[4:7], v249 offset:6144
v_bfe_u32 v172, v173, 2, 14
v_mfma_f32_16x16x32_bf16 v[196:199], v[180:183], v[56:59], v[196:199]
v_lshrrev_b32_e64 v173, 18, v173
v_or_b32 v138, v148, v149
s_waitcnt lgkmcnt(6)
v_mfma_f32_16x16x32_f16 v[100:103], v[184:187], v[8:11], v[100:103]
ds_read_u16 v172, v172
ds_read_u16_d16_hi v173, v173
buffer_store_dwordx4 v[80:83], v253, s[8:11], s71 offen offset:256 sc1
buffer_store_dwordx4 v[88:91], v253, s[8:11], s71 offen offset:320 sc1
v_mfma_f32_16x16x32_f16 v[104:107], v[184:187], v[212:215], v[104:107]
v_pk_mul_f16 v130, v144, v145
v_cvt_pkrtz_f16_f32 v159, v158, v159
v_mfma_f32_16x16x32_bf16 v[164:167], v[180:183], v[60:63], v[164:167]
v_and_b32_e64 v159, s49, v159
v_bfe_u32 v158, v159, 2, 14
v_lshrrev_b32_e64 v159, 18, v159
v_mfma_f32_16x16x32_f16 v[140:143], v[184:187], v[208:211], v[140:143]
ds_read_u16 v158, v158
ds_read_u16_d16_hi v159, v159
ds_read_b128 v[184:187], v251 offset:32768
v_or_b32_e64 v14, v152, v153
v_mfma_f32_16x16x32_bf16 v[168:171], v[180:183], v[32:35], v[168:171]
ds_read_b128 v[180:183], v251 offset:31744
v_cvt_pkrtz_f16_f32 v163, v162, v163
v_and_b32_e64 v163, s49, v163
v_bfe_u32 v162, v163, 2, 14
v_lshrrev_b32_e64 v163, 18, v163
buffer_load_dwordx4 v[80:83], v253, s[4:7], s70 offen offset:256
ds_read_u16 v162, v162
ds_read_u16_d16_hi v163, v163
buffer_load_dwordx4 v[88:91], v253, s[4:7], s70 offen offset:320
v_mfma_f32_16x16x32_f16 v[232:235], v[188:191], v[8:11], v[232:235]
v_or_b32_e64 v131, v146, v147
v_cvt_pkrtz_f16_f32 v175, v174, v175
v_mfma_f32_16x16x32_f16 v[236:239], v[188:191], v[212:215], v[236:239]
s_setprio 0
v_and_b32 v175, s49, v175
v_bfe_u32 v174, v175, 2, 14
v_lshrrev_b32 v175, 18, v175
s_waitcnt lgkmcnt(7)
v_mfma_f32_16x16x32_bf16 v[196:199], v[120:123], v[64:67], v[196:199]
ds_read_u16 v174, v174
ds_read_u16_d16_hi v175, v175
v_mfma_f32_16x16x32_f16 v[84:87], v[188:191], v[208:211], v[84:87]
ds_read_b128 v[188:191], v249 offset:8192
v_or_b32_e64 v139, v150, v151
v_mfma_f32_16x16x32_bf16 v[164:167], v[120:123], v[68:71], v[164:167]
v_or_b32 v15, v154, v155
s_nop 0
v_cvt_pk_f16_f32 v196, v196, v197
v_mfma_f32_16x16x32_f16 v[108:111], v[176:179], v[8:11], v[108:111]
v_pk_fma_f16 v197, v196, v196, s48
v_or_b32 v156, v156, v157
v_mfma_f32_16x16x32_f16 v[192:195], v[176:179], v[212:215], v[192:195]
s_nop 0
v_cvt_pkrtz_f16_f32 v165, v164, v165
v_and_b32_e64 v165, s49, v165
v_mfma_f32_16x16x32_bf16 v[168:171], v[120:123], v[40:43], v[168:171]
ds_read_b128 v[120:123], v251 offset:35840
v_bfe_u32 v164, v165, 2, 14
v_mfma_f32_16x16x32_f16 v[244:247], v[176:179], v[208:211], v[244:247]
ds_read_b128 v[176:179], v251 offset:33792
v_lshrrev_b32_e64 v165, 18, v165
v_mfma_f32_16x16x32_bf16 v[144:147], v[4:7], v[48:51], 0
ds_read_u16 v164, v164
ds_read_u16_d16_hi v165, v165
s_waitcnt lgkmcnt(8)
v_mfma_f32_16x16x32_f16 v[96:99], v[180:183], v[8:11], v[96:99]
v_cvt_pkrtz_f16_f32 v169, v168, v169
v_and_b32 v169, s49, v169
v_mfma_f32_16x16x32_f16 v[224:227], v[180:183], v[212:215], v[224:227]
v_bfe_u32 v168, v169, 2, 14
v_lshrrev_b32_e64 v169, 18, v169
v_mfma_f32_16x16x32_bf16 v[148:151], v[4:7], v[52:55], 0
ds_read_u16 v168, v168
ds_read_u16_d16_hi v169, v169
v_mfma_f32_16x16x32_f16 v[92:95], v[180:183], v[208:211], v[92:95]
ds_read_b128 v[180:183], v251 offset:36864
v_pk_mul_f16 v197, v196, v197
v_mfma_f32_16x16x32_f16 v[200:203], v[184:187], v[116:119], v[200:203]
v_cvt_pkrtz_f16_f32 v199, v198, v199
v_and_b32_e64 v199, s49, v199
v_mfma_f32_16x16x32_bf16 v[152:155], v[4:7], v[24:27], 0
ds_read_b128 v[4:7], v249 offset:10240
v_bfe_u32 v198, v199, 2, 14
v_mfma_f32_16x16x32_f16 v[204:207], v[184:187], v[112:115], v[204:207]
s_setprio 3
v_lshrrev_b32 v199, 18, v199
v_or_b32 v160, v160, v161
s_waitcnt lgkmcnt(6)
v_mfma_f32_16x16x32_bf16 v[144:147], v[188:191], v[56:59], v[144:147]
ds_read_u16 v198, v198
ds_read_u16_d16_hi v199, v199
v_mfma_f32_16x16x32_f16 v[132:135], v[184:187], v[228:231], v[132:135]
ds_read_b128 v[184:187], v249 offset:6400
v_exp_f16_sdwa v197, v197 dst_sel:WORD_0 dst_unused:UNUSED_PRESERVE src0_sel:WORD_0
v_mfma_f32_16x16x32_f16 v[216:219], v[120:123], v[116:119], v[216:219]
v_cvt_pkrtz_f16_f32 v167, v166, v167
v_and_b32_e64 v167, s49, v167
v_mfma_f32_16x16x32_bf16 v[148:151], v[188:191], v[60:63], v[148:151]
v_bfe_u32 v166, v167, 2, 14
v_lshrrev_b32_e64 v167, 18, v167
v_mfma_f32_16x16x32_f16 v[220:223], v[120:123], v[112:115], v[220:223]
ds_read_u16 v166, v166
ds_read_u16_d16_hi v167, v167
v_mfma_f32_16x16x32_bf16 v[152:155], v[188:191], v[32:35], v[152:155]
ds_read_b128 v[188:191], v251 offset:34816
v_or_b32_e64 v172, v172, v173
v_mfma_f32_16x16x32_f16 v[76:79], v[120:123], v[228:231], v[76:79]
ds_read_b128 v[120:123], v251 offset:37888
v_cvt_pkrtz_f16_f32 v171, v170, v171
v_and_b32_e64 v171, s49, v171
v_bfe_u32 v170, v171, 2, 14
v_lshrrev_b32_e64 v171, 18, v171
v_mfma_f32_16x16x32_f16 v[100:103], v[176:179], v[116:119], v[100:103]
ds_read_u16 v170, v170
ds_read_u16_d16_hi v171, v171
s_waitcnt lgkmcnt(8)
v_mfma_f32_16x16x32_bf16 v[144:147], v[4:7], v[64:67], v[144:147]
v_or_b32 v157, v158, v159
v_exp_f16_sdwa v197, v197 dst_sel:WORD_1 dst_unused:UNUSED_PRESERVE src0_sel:WORD_1
v_mfma_f32_16x16x32_f16 v[104:107], v[176:179], v[112:115], v[104:107]
v_or_b32_e64 v161, v162, v163
v_or_b32 v173, v174, v175
v_mfma_f32_16x16x32_bf16 v[148:151], v[4:7], v[68:71], v[148:151]
v_pk_add_f16 v197, v197, 1.0 op_sel_hi:[1,0]
s_nop 0
v_cvt_pk_f16_f32 v144, v144, v145
v_mfma_f32_16x16x32_f16 v[140:143], v[176:179], v[228:231], v[140:143]
ds_read_b128 v[176:179], v249 offset:8448
v_rcp_f16_sdwa v197, v197 dst_sel:WORD_0 dst_unused:UNUSED_PRESERVE src0_sel:WORD_0
v_mfma_f32_16x16x32_f16 v[232:235], v[180:183], v[116:119], v[232:235]
s_nop 0
v_cvt_pkrtz_f16_f32 v149, v148, v149
v_and_b32 v149, s49, v149
v_mfma_f32_16x16x32_bf16 v[152:155], v[4:7], v[40:43], v[152:155]
ds_read_b128 v[4:7], v251 offset:38912
v_bfe_u32 v148, v149, 2, 14
v_mfma_f32_16x16x32_f16 v[236:239], v[180:183], v[112:115], v[236:239]
s_setprio 2
v_lshrrev_b32_e64 v149, 18, v149
v_rcp_f16_sdwa v197, v197 dst_sel:WORD_1 dst_unused:UNUSED_PRESERVE src0_sel:WORD_1
s_waitcnt lgkmcnt(4)
v_mfma_f32_16x16x32_bf16 v[208:211], v[184:187], v[48:51], 0
ds_read_u16 v148, v148
ds_read_u16_d16_hi v149, v149
v_mfma_f32_16x16x32_f16 v[84:87], v[180:183], v[228:231], v[84:87]
ds_read_b128 v[180:183], v249 offset:10496
v_pk_fma_f16 v145, v144, v144, s48
v_mfma_f32_16x16x32_f16 v[108:111], v[188:191], v[116:119], v[108:111]
v_cvt_pkrtz_f16_f32 v153, v152, v153
v_and_b32_e64 v153, s49, v153
v_mfma_f32_16x16x32_bf16 v[212:215], v[184:187], v[52:55], 0
v_bfe_u32 v152, v153, 2, 14
v_lshrrev_b32_e64 v153, 18, v153
v_mfma_f32_16x16x32_f16 v[192:195], v[188:191], v[112:115], v[192:195]
ds_read_u16 v152, v152
ds_read_u16_d16_hi v153, v153
v_mfma_f32_16x16x32_bf16 v[8:11], v[184:187], v[24:27], 0
ds_read_b128 v[184:187], v251 offset:41984
v_or_b32_e64 v162, v164, v165
v_mfma_f32_16x16x32_f16 v[244:247], v[188:191], v[228:231], v[244:247]
ds_read_b128 v[188:191], v251 offset:39936
v_pk_mul_f16 v145, v144, v145
v_mfma_f32_16x16x32_f16 v[96:99], v[120:123], v[116:119], v[96:99]
v_cvt_pkrtz_f16_f32 v147, v146, v147
v_and_b32 v147, s49, v147
s_waitcnt lgkmcnt(7)
v_mfma_f32_16x16x32_bf16 v[208:211], v[176:179], v[56:59], v[208:211]
v_bfe_u32 v146, v147, 2, 14
v_lshrrev_b32_e64 v147, 18, v147
v_mfma_f32_16x16x32_f16 v[224:227], v[120:123], v[112:115], v[224:227]
ds_read_u16 v146, v146
ds_read_u16_d16_hi v147, v147
v_pk_mul_f16 v158, v196, v197
v_mfma_f32_16x16x32_bf16 v[212:215], v[176:179], v[60:63], v[212:215]
v_exp_f16_sdwa v145, v145 dst_sel:WORD_0 dst_unused:UNUSED_PRESERVE src0_sel:WORD_0
v_mfma_f32_16x16x32_f16 v[92:95], v[120:123], v[228:231], v[92:95]
ds_read_b128 v[120:123], v249 offset:12288
v_or_b32 v174, v168, v169
s_waitcnt vmcnt(7)
v_mfma_f32_16x16x32_bf16 v[132:135], v[18:21], v[240:243], v[132:135]
v_cvt_pkrtz_f16_f32 v151, v150, v151
v_and_b32_e64 v151, s49, v151
v_mfma_f32_16x16x32_bf16 v[76:79], v[16:19], v[240:243], v[76:79]
v_bfe_u32 v150, v151, 2, 14
v_lshrrev_b32 v151, 18, v151
s_waitcnt vmcnt(6)
v_mfma_f32_16x16x32_bf16 v[140:143], v[18:21], v[72:75], v[140:143]
ds_read_u16 v150, v150
ds_read_u16_d16_hi v151, v151
v_mfma_f32_16x16x32_bf16 v[84:87], v[16:19], v[72:75], v[84:87]
buffer_load_dwordx4 v[228:231], v253, s[4:7], s69 offen
buffer_load_dwordx4 v[112:115], v253, s[4:7], s69 offen offset:64
v_or_b32_e64 v159, v198, v199
v_mfma_f32_16x16x32_f16 v[200:203], v[4:7], v[12:15], v[200:203]
v_cvt_pkrtz_f16_f32 v155, v154, v155
v_and_b32_e64 v155, s49, v155
v_mfma_f32_16x16x32_bf16 v[8:11], v[176:179], v[32:35], v[8:11]
ds_read_b128 v[176:179], v251 offset:43008
v_bfe_u32 v154, v155, 2, 14
v_mfma_f32_16x16x32_f16 v[204:207], v[4:7], v[136:139], v[204:207]
v_lshrrev_b32 v155, 18, v155
v_exp_f16_sdwa v145, v145 dst_sel:WORD_1 dst_unused:UNUSED_PRESERVE src0_sel:WORD_1
s_waitcnt lgkmcnt(3)
v_mfma_f32_16x16x32_bf16 v[208:211], v[180:183], v[64:67], v[208:211]
ds_read_u16 v154, v154
ds_read_u16_d16_hi v155, v155
s_setprio 1
v_mfma_f32_16x16x32_f16 v[132:135], v[4:7], v[128:131], v[132:135]
ds_read_b128 v[4:7], v249 offset:14336
v_or_b32 v163, v166, v167
v_mfma_f32_16x16x32_f16 v[216:219], v[184:187], v[12:15], v[216:219]
v_or_b32_e64 v175, v170, v171
v_pk_add_f16 v145, v145, 1.0 op_sel_hi:[1,0]
v_mfma_f32_16x16x32_bf16 v[212:215], v[180:183], v[68:71], v[212:215]
v_rcp_f16_sdwa v145, v145 dst_sel:WORD_0 dst_unused:UNUSED_PRESERVE src0_sel:WORD_0
v_mfma_f32_16x16x32_f16 v[220:223], v[184:187], v[136:139], v[220:223]
v_cvt_pk_f16_f32 v208, v208, v209
v_rcp_f16_sdwa v145, v145 dst_sel:WORD_1 dst_unused:UNUSED_PRESERVE src0_sel:WORD_1
v_mfma_f32_16x16x32_f16 v[76:79], v[184:187], v[128:131], v[76:79]
ds_read_b128 v[184:187], v251 offset:44032
s_nop 1
v_cvt_pkrtz_f16_f32 v213, v212, v213
v_mfma_f32_16x16x32_bf16 v[8:11], v[180:183], v[40:43], v[8:11]
ds_read_b128 v[180:183], v251 offset:40960
v_and_b32 v213, s49, v213
v_mfma_f32_16x16x32_f16 v[100:103], v[188:191], v[12:15], v[100:103]
v_bfe_u32 v212, v213, 2, 14
v_lshrrev_b32_e64 v213, 18, v213
v_mfma_f32_16x16x32_bf16 v[116:119], v[120:123], v[48:51], 0
ds_read_u16 v212, v212
ds_read_u16_d16_hi v213, v213
v_mfma_f32_16x16x32_f16 v[104:107], v[188:191], v[136:139], v[104:107]
v_pk_fma_f16 v209, v208, v208, s48
v_cvt_pkrtz_f16_f32 v9, v8, v9
v_mfma_f32_16x16x32_f16 v[140:143], v[188:191], v[128:131], v[140:143]
ds_read_b128 v[188:191], v249 offset:16384
v_and_b32_e64 v9, s49, v9
v_mfma_f32_16x16x32_bf16 v[240:243], v[120:123], v[52:55], 0
v_bfe_u32 v8, v9, 2, 14
v_lshrrev_b32 v9, 18, v9
s_waitcnt lgkmcnt(5)
v_mfma_f32_16x16x32_f16 v[232:235], v[176:179], v[12:15], v[232:235]
ds_read_u16 v8, v8
ds_read_u16_d16_hi v9, v9
v_mfma_f32_16x16x32_bf16 v[72:75], v[120:123], v[24:27], 0
ds_read_b128 v[120:123], v251 offset:45056
v_or_b32 v148, v148, v149
v_mfma_f32_16x16x32_f16 v[236:239], v[176:179], v[136:139], v[236:239]
s_setprio 0
v_pk_mul_f16 v209, v208, v209
v_cvt_pkrtz_f16_f32 v211, v210, v211
v_mfma_f32_16x16x32_f16 v[84:87], v[176:179], v[128:131], v[84:87]
ds_read_b128 v[176:179], v249 offset:12544
v_and_b32_e64 v211, s49, v211
v_mfma_f32_16x16x32_bf16 v[116:119], v[4:7], v[56:59], v[116:119]
v_bfe_u32 v210, v211, 2, 14
v_lshrrev_b32 v211, 18, v211
s_waitcnt lgkmcnt(6)
v_mfma_f32_16x16x32_f16 v[108:111], v[180:183], v[12:15], v[108:111]
ds_read_u16 v210, v210
ds_read_u16_d16_hi v211, v211
v_pk_mul_f16 v144, v144, v145
v_mfma_f32_16x16x32_bf16 v[240:243], v[4:7], v[60:63], v[240:243]
v_exp_f16_sdwa v209, v209 dst_sel:WORD_0 dst_unused:UNUSED_PRESERVE src0_sel:WORD_0
v_mfma_f32_16x16x32_f16 v[192:195], v[180:183], v[136:139], v[192:195]
v_or_b32_e64 v152, v152, v153
v_cvt_pkrtz_f16_f32 v215, v214, v215
v_and_b32_e64 v215, s49, v215
v_bfe_u32 v214, v215, 2, 14
v_lshrrev_b32_e64 v215, 18, v215
v_mfma_f32_16x16x32_f16 v[244:247], v[180:183], v[128:131], v[244:247]
ds_read_u16 v214, v214
ds_read_u16_d16_hi v215, v215
ds_read_b128 v[180:183], v251 offset:46080
v_mfma_f32_16x16x32_bf16 v[72:75], v[4:7], v[32:35], v[72:75]
ds_read_b128 v[4:7], v251 offset:48128
v_or_b32_e64 v145, v146, v147
v_mfma_f32_16x16x32_f16 v[96:99], v[184:187], v[12:15], v[96:99]
v_cvt_pkrtz_f16_f32 v11, v10, v11
v_and_b32_e64 v11, s49, v11
v_bfe_u32 v10, v11, 2, 14
v_lshrrev_b32 v11, 18, v11
s_waitcnt lgkmcnt(6)
v_mfma_f32_16x16x32_bf16 v[116:119], v[188:191], v[64:67], v[116:119]
ds_read_u16 v10, v10
ds_read_u16_d16_hi v11, v11
v_mfma_f32_16x16x32_f16 v[224:227], v[184:187], v[136:139], v[224:227]
v_exp_f16_sdwa v209, v209 dst_sel:WORD_1 dst_unused:UNUSED_PRESERVE src0_sel:WORD_1
v_or_b32_e64 v149, v150, v151
v_mfma_f32_16x16x32_f16 v[92:95], v[184:187], v[128:131], v[92:95]
ds_read_b128 v[184:187], v249 offset:14592
v_or_b32_e64 v153, v154, v155
v_mfma_f32_16x16x32_bf16 v[240:243], v[188:191], v[68:71], v[240:243]
v_pk_add_f16 v209, v209, 1.0 op_sel_hi:[1,0]
v_cvt_pk_f16_f32 v116, v116, v117
s_waitcnt vmcnt(7)
v_mfma_f32_16x16x32_bf16 v[244:247], v[18:21], v[124:127], v[244:247]
v_rcp_f16_sdwa v209, v209 dst_sel:WORD_0 dst_unused:UNUSED_PRESERVE src0_sel:WORD_0
v_mfma_f32_16x16x32_bf16 v[92:95], v[16:19], v[124:127], v[92:95]
s_nop 1
v_cvt_pkrtz_f16_f32 v241, v240, v241
v_and_b32 v241, s49, v241
s_waitcnt vmcnt(6)
v_mfma_f32_16x16x32_bf16 v[204:207], v[18:21], v[0:3], v[204:207]
v_bfe_u32 v240, v241, 2, 14
v_lshrrev_b32_e64 v241, 18, v241
v_mfma_f32_16x16x32_bf16 v[220:223], v[16:19], v[0:3], v[220:223]
ds_read_u16 v240, v240
ds_read_u16_d16_hi v241, v241
v_mfma_f32_16x16x32_f16 v[200:203], v[120:123], v[172:175], v[200:203]
v_rcp_f16_sdwa v209, v209 dst_sel:WORD_1 dst_unused:UNUSED_PRESERVE src0_sel:WORD_1
v_mfma_f32_16x16x32_bf16 v[72:75], v[188:191], v[40:43], v[72:75]
ds_read_b128 v[188:191], v251 offset:49152
v_pk_fma_f16 v117, v116, v116, s48
v_mfma_f32_16x16x32_f16 v[204:207], v[120:123], v[160:163], v[204:207]
v_or_b32_e64 v150, v212, v213
v_pk_mul_f16 v117, v116, v117
v_mfma_f32_16x16x32_f16 v[132:135], v[120:123], v[156:159], v[132:135]
ds_read_b128 v[120:123], v249 offset:16640
s_setprio 3
v_cvt_pkrtz_f16_f32 v73, v72, v73
v_mfma_f32_16x16x32_bf16 v[196:199], v[176:179], v[48:51], 0
v_and_b32 v73, s49, v73
v_bfe_u32 v72, v73, 2, 14
s_waitcnt lgkmcnt(4)
v_mfma_f32_16x16x32_f16 v[216:219], v[4:7], v[172:175], v[216:219]
v_lshrrev_b32 v73, 18, v73
v_cvt_pkrtz_f16_f32 v119, v118, v119
v_mfma_f32_16x16x32_bf16 v[164:167], v[176:179], v[52:55], 0
ds_read_u16 v72, v72
ds_read_u16_d16_hi v73, v73
v_mfma_f32_16x16x32_f16 v[220:223], v[4:7], v[160:163], v[220:223]
v_and_b32_e64 v119, s49, v119
v_bfe_u32 v118, v119, 2, 14
v_mfma_f32_16x16x32_f16 v[76:79], v[4:7], v[156:159], v[76:79]
ds_read_b128 v[4:7], v251 offset:50176
v_lshrrev_b32_e64 v119, 18, v119
v_mfma_f32_16x16x32_bf16 v[168:171], v[176:179], v[24:27], 0
ds_read_b128 v[176:179], v251 offset:47104
ds_read_u16 v118, v118
v_mfma_f32_16x16x32_f16 v[100:103], v[180:183], v[172:175], v[100:103]
ds_read_u16_d16_hi v119, v119
v_pk_mul_f16 v146, v208, v209
v_mfma_f32_16x16x32_bf16 v[196:199], v[184:187], v[56:59], v[196:199]
v_exp_f16_sdwa v117, v117 dst_sel:WORD_0 dst_unused:UNUSED_PRESERVE src0_sel:WORD_0
v_mfma_f32_16x16x32_f16 v[104:107], v[180:183], v[160:163], v[104:107]
v_or_b32_e64 v154, v8, v9
v_cvt_pkrtz_f16_f32 v243, v242, v243
v_mfma_f32_16x16x32_f16 v[140:143], v[180:183], v[156:159], v[140:143]
ds_read_b128 v[180:183], v249 offset:18432
v_and_b32_e64 v243, s49, v243
v_mfma_f32_16x16x32_bf16 v[164:167], v[184:187], v[60:63], v[164:167]
v_bfe_u32 v242, v243, 2, 14
v_lshrrev_b32 v243, 18, v243
s_waitcnt lgkmcnt(6)
v_mfma_f32_16x16x32_f16 v[232:235], v[188:191], v[172:175], v[232:235]
ds_read_u16 v242, v242
ds_read_u16_d16_hi v243, v243
v_mfma_f32_16x16x32_f16 v[236:239], v[188:191], v[160:163], v[236:239]
v_or_b32_e64 v147, v210, v211
v_cvt_pkrtz_f16_f32 v75, v74, v75
v_mfma_f32_16x16x32_bf16 v[168:171], v[184:187], v[32:35], v[168:171]
ds_read_b128 v[184:187], v251 offset:51200
v_and_b32_e64 v75, s49, v75
v_mfma_f32_16x16x32_f16 v[84:87], v[188:191], v[156:159], v[84:87]
ds_read_b128 v[188:191], v249 offset:20480
v_bfe_u32 v74, v75, 2, 14
v_lshrrev_b32_e64 v75, 18, v75
v_mfma_f32_16x16x32_bf16 v[196:199], v[120:123], v[64:67], v[196:199]
ds_read_u16 v74, v74
ds_read_u16_d16_hi v75, v75
s_setprio 2
s_waitcnt lgkmcnt(8)
v_mfma_f32_16x16x32_f16 v[108:111], v[176:179], v[172:175], v[108:111]
v_exp_f16_sdwa v117, v117 dst_sel:WORD_1 dst_unused:UNUSED_PRESERVE src0_sel:WORD_1
v_or_b32_e64 v151, v214, v215
v_mfma_f32_16x16x32_f16 v[192:195], v[176:179], v[160:163], v[192:195]
v_or_b32_e64 v155, v10, v11
v_pk_add_f16 v117, v117, 1.0 op_sel_hi:[1,0]
v_mfma_f32_16x16x32_bf16 v[164:167], v[120:123], v[68:71], v[164:167]
v_rcp_f16_sdwa v117, v117 dst_sel:WORD_0 dst_unused:UNUSED_PRESERVE src0_sel:WORD_0
v_mfma_f32_16x16x32_f16 v[244:247], v[176:179], v[156:159], v[244:247]
ds_read_b128 v[176:179], v249 offset:22528
v_cvt_pk_f16_f32 v196, v196, v197
v_mfma_f32_16x16x32_bf16 v[168:171], v[120:123], v[40:43], v[168:171]
ds_read_b128 v[120:123], v251 offset:54272
s_nop 1
v_cvt_pkrtz_f16_f32 v165, v164, v165
v_mfma_f32_16x16x32_f16 v[96:99], v[4:7], v[172:175], v[96:99]
v_and_b32 v165, s49, v165
v_bfe_u32 v164, v165, 2, 14
v_mfma_f32_16x16x32_f16 v[224:227], v[4:7], v[160:163], v[224:227]
buffer_load_dwordx4 v[128:131], v250, s[32:35], s80 offen
s_add_u32 s46, s80, 2097152
buffer_load_dwordx4 v[136:139], v250, s[32:35], s46 offen
v_lshrrev_b32 v165, 18, v165
s_waitcnt lgkmcnt(4)
v_mfma_f32_16x16x32_bf16 v[12:15], v[180:183], v[48:51], 0
ds_read_u16 v164, v164
ds_read_u16_d16_hi v165, v165
v_mfma_f32_16x16x32_f16 v[92:95], v[4:7], v[156:159], v[92:95]
ds_read_b128 v[4:7], v251 offset:52224
v_rcp_f16_sdwa v117, v117 dst_sel:WORD_1 dst_unused:UNUSED_PRESERVE src0_sel:WORD_1
v_mfma_f32_16x16x32_bf16 v[124:127], v[180:183], v[52:55], 0
v_pk_fma_f16 v197, v196, v196, s48
v_cvt_pkrtz_f16_f32 v169, v168, v169
v_mfma_f32_16x16x32_f16 v[200:203], v[184:187], v[152:155], v[200:203]
v_and_b32_e64 v169, s49, v169
v_bfe_u32 v168, v169, 2, 14
v_mfma_f32_16x16x32_bf16 v[0:3], v[180:183], v[24:27], 0
ds_read_b128 v[180:183], v249 offset:18688
v_lshrrev_b32_e64 v169, 18, v169
v_mfma_f32_16x16x32_f16 v[204:207], v[184:187], v[148:151], v[204:207]
ds_read_u16 v168, v168
ds_read_u16_d16_hi v169, v169
s_setprio 1
v_mfma_f32_16x16x32_bf16 v[12:15], v[188:191], v[56:59], v[12:15]
v_or_b32 v240, v240, v241
v_pk_mul_f16 v197, v196, v197
v_mfma_f32_16x16x32_f16 v[132:135], v[184:187], v[144:147], v[132:135]
ds_read_b128 v[184:187], v251 offset:55296
v_cvt_pkrtz_f16_f32 v199, v198, v199
v_and_b32_e64 v199, s49, v199
v_bfe_u32 v198, v199, 2, 14
v_lshrrev_b32_e64 v199, 18, v199
v_pk_mul_f16 v116, v116, v117
v_mfma_f32_16x16x32_bf16 v[124:127], v[188:191], v[60:63], v[124:127]
ds_read_u16 v198, v198
ds_read_u16_d16_hi v199, v199
s_waitcnt lgkmcnt(7)
v_mfma_f32_16x16x32_f16 v[216:219], v[120:123], v[152:155], v[216:219]
v_exp_f16_sdwa v197, v197 dst_sel:WORD_0 dst_unused:UNUSED_PRESERVE src0_sel:WORD_0
v_or_b32 v72, v72, v73
v_cvt_pkrtz_f16_f32 v167, v166, v167
v_and_b32_e64 v167, s49, v167
v_bfe_u32 v166, v167, 2, 14
v_lshrrev_b32_e64 v167, 18, v167
v_mfma_f32_16x16x32_bf16 v[0:3], v[188:191], v[32:35], v[0:3]
ds_read_u16 v166, v166
ds_read_u16_d16_hi v167, v167
ds_read_b128 v[188:191], v249 offset:20736
v_mfma_f32_16x16x32_f16 v[220:223], v[120:123], v[148:151], v[220:223]
v_or_b32_e64 v117, v118, v119
v_cvt_pkrtz_f16_f32 v171, v170, v171
v_and_b32_e64 v171, s49, v171
v_bfe_u32 v170, v171, 2, 14
v_lshrrev_b32_e64 v171, 18, v171
v_mfma_f32_16x16x32_bf16 v[12:15], v[176:179], v[64:67], v[12:15]
ds_read_u16 v170, v170
ds_read_u16_d16_hi v171, v171
v_mfma_f32_16x16x32_f16 v[76:79], v[120:123], v[144:147], v[76:79]
ds_read_b128 v[120:123], v251 offset:53248
v_exp_f16_sdwa v197, v197 dst_sel:WORD_1 dst_unused:UNUSED_PRESERVE src0_sel:WORD_1
v_or_b32_e64 v241, v242, v243
v_mfma_f32_16x16x32_bf16 v[124:127], v[176:179], v[68:71], v[124:127]
v_or_b32 v73, v74, v75
v_pk_add_f16 v197, v197, 1.0 op_sel_hi:[1,0]
s_waitcnt lgkmcnt(6)
v_mfma_f32_16x16x32_f16 v[100:103], v[4:7], v[152:155], v[100:103]
v_rcp_f16_sdwa v197, v197 dst_sel:WORD_0 dst_unused:UNUSED_PRESERVE src0_sel:WORD_0
v_mfma_f32_16x16x32_bf16 v[0:3], v[176:179], v[40:43], v[0:3]
ds_read_b128 v[176:179], v249 offset:22784
s_nop 0
v_cvt_pkrtz_f16_f32 v125, v124, v125
v_mfma_f32_16x16x32_f16 v[104:107], v[4:7], v[148:151], v[104:107]
s_setprio 0
v_and_b32_e64 v125, s49, v125
v_bfe_u32 v124, v125, 2, 14
v_mfma_f32_16x16x32_bf16 v[208:211], v[180:183], v[48:51], 0
v_lshrrev_b32_e64 v125, 18, v125
v_cvt_pk_f16_f32 v12, v12, v13
v_mfma_f32_16x16x32_f16 v[140:143], v[4:7], v[144:147], v[140:143]
ds_read_b128 v[4:7], v251 offset:56320
ds_read_u16 v124, v124
v_mfma_f32_16x16x32_bf16 v[212:215], v[180:183], v[52:55], 0
ds_read_u16_d16_hi v125, v125
v_rcp_f16_sdwa v197, v197 dst_sel:WORD_1 dst_unused:UNUSED_PRESERVE src0_sel:WORD_1
v_mfma_f32_16x16x32_f16 v[232:235], v[184:187], v[152:155], v[232:235]
v_pk_fma_f16 v13, v12, v12, s48
v_cvt_pkrtz_f16_f32 v1, v0, v1
v_mfma_f32_16x16x32_bf16 v[8:11], v[180:183], v[24:27], 0
ds_read_b128 v[180:183], v249 offset:24576
v_and_b32_e64 v1, s49, v1
v_mfma_f32_16x16x32_f16 v[236:239], v[184:187], v[148:151], v[236:239]
v_bfe_u32 v0, v1, 2, 14
v_lshrrev_b32 v1, 18, v1
s_waitcnt lgkmcnt(4)
v_mfma_f32_16x16x32_bf16 v[208:211], v[188:191], v[56:59], v[208:211]
ds_read_u16 v0, v0
ds_read_u16_d16_hi v1, v1
s_add_u32 s46, s80, 4194304
buffer_load_dwordx4 v[156:159], v250, s[32:35], s46 offen
s_add_u32 s46, s80, 6291456
buffer_load_dwordx4 v[160:163], v250, s[32:35], s46 offen
v_mfma_f32_16x16x32_f16 v[84:87], v[184:187], v[144:147], v[84:87]
ds_read_b128 v[184:187], v251 offset:57344
v_or_b32_e64 v242, v164, v165
v_pk_mul_f16 v13, v12, v13
v_cvt_pkrtz_f16_f32 v15, v14, v15
v_and_b32_e64 v15, s49, v15
v_bfe_u32 v14, v15, 2, 14
v_lshrrev_b32_e64 v15, 18, v15
v_pk_mul_f16 v118, v196, v197
v_mfma_f32_16x16x32_bf16 v[212:215], v[188:191], v[60:63], v[212:215]
ds_read_u16 v14, v14
ds_read_u16_d16_hi v15, v15
buffer_load_dwordx4 v[172:175], v253, s[4:7], s69 offen offset:128
v_mfma_f32_16x16x32_f16 v[108:111], v[120:123], v[152:155], v[108:111]
v_exp_f16_sdwa v13, v13 dst_sel:WORD_0 dst_unused:UNUSED_PRESERVE src0_sel:WORD_0
v_or_b32_e64 v74, v168, v169
v_cvt_pkrtz_f16_f32 v127, v126, v127
v_and_b32_e64 v127, s49, v127
v_bfe_u32 v126, v127, 2, 14
v_lshrrev_b32_e64 v127, 18, v127
v_mfma_f32_16x16x32_bf16 v[8:11], v[188:191], v[32:35], v[8:11]
ds_read_u16 v126, v126
ds_read_u16_d16_hi v127, v127
ds_read_b128 v[188:191], v249 offset:26624
v_mfma_f32_16x16x32_f16 v[192:195], v[120:123], v[148:151], v[192:195]
v_or_b32_e64 v119, v198, v199
v_cvt_pkrtz_f16_f32 v3, v2, v3
v_and_b32_e64 v3, s49, v3
v_bfe_u32 v2, v3, 2, 14
v_lshrrev_b32 v3, 18, v3
v_mfma_f32_16x16x32_bf16 v[208:211], v[176:179], v[64:67], v[208:211]
ds_read_u16 v2, v2
ds_read_u16_d16_hi v3, v3
s_setprio 3
v_mfma_f32_16x16x32_f16 v[244:247], v[120:123], v[144:147], v[244:247]
ds_read_b128 v[120:123], v251 offset:60416
v_exp_f16_sdwa v13, v13 dst_sel:WORD_1 dst_unused:UNUSED_PRESERVE src0_sel:WORD_1
v_or_b32_e64 v243, v166, v167
v_mfma_f32_16x16x32_bf16 v[212:215], v[176:179], v[68:71], v[212:215]
v_or_b32 v75, v170, v171
v_pk_add_f16 v13, v13, 1.0 op_sel_hi:[1,0]
s_waitcnt lgkmcnt(6)
v_mfma_f32_16x16x32_f16 v[96:99], v[4:7], v[152:155], v[96:99]
v_rcp_f16_sdwa v13, v13 dst_sel:WORD_0 dst_unused:UNUSED_PRESERVE src0_sel:WORD_0
v_mfma_f32_16x16x32_bf16 v[8:11], v[176:179], v[40:43], v[8:11]
ds_read_b128 v[176:179], v249 offset:28672
s_nop 0
v_cvt_pkrtz_f16_f32 v213, v212, v213
v_mfma_f32_16x16x32_f16 v[224:227], v[4:7], v[148:151], v[224:227]
v_and_b32 v213, s49, v213
v_bfe_u32 v212, v213, 2, 14
v_mfma_f32_16x16x32_bf16 v[196:199], v[180:183], v[48:51], 0
v_lshrrev_b32 v213, 18, v213
v_cvt_pk_f16_f32 v208, v208, v209
v_mfma_f32_16x16x32_f16 v[92:95], v[4:7], v[144:147], v[92:95]
ds_read_b128 v[4:7], v251 offset:58368
ds_read_u16 v212, v212
s_waitcnt vmcnt(8)
v_mfma_f32_16x16x32_bf16 v[104:107], v[18:21], v[80:83], v[104:107]
ds_read_u16_d16_hi v213, v213
v_rcp_f16_sdwa v13, v13 dst_sel:WORD_1 dst_unused:UNUSED_PRESERVE src0_sel:WORD_1
v_mfma_f32_16x16x32_bf16 v[236:239], v[16:19], v[80:83], v[236:239]
v_pk_fma_f16 v209, v208, v208, s48
v_cvt_pkrtz_f16_f32 v9, v8, v9
s_waitcnt vmcnt(7)
v_mfma_f32_16x16x32_bf16 v[192:195], v[18:21], v[88:91], v[192:195]
v_and_b32 v9, s49, v9
v_bfe_u32 v8, v9, 2, 14
v_mfma_f32_16x16x32_bf16 v[224:227], v[16:19], v[88:91], v[224:227]
v_lshrrev_b32 v9, 18, v9
v_or_b32 v124, v124, v125
v_mfma_f32_16x16x32_bf16 v[164:167], v[180:183], v[52:55], 0
ds_read_u16 v8, v8
ds_read_u16_d16_hi v9, v9
v_mfma_f32_16x16x32_f16 v[200:203], v[184:187], v[72:75], v[200:203]
v_pk_mul_f16 v209, v208, v209
v_cvt_pkrtz_f16_f32 v211, v210, v211
v_mfma_f32_16x16x32_bf16 v[168:171], v[180:183], v[24:27], 0
ds_read_b128 v[180:183], v249 offset:24832
v_and_b32 v211, s49, v211
v_mfma_f32_16x16x32_f16 v[204:207], v[184:187], v[240:243], v[204:207]
s_setprio 2
v_bfe_u32 v210, v211, 2, 14
v_lshrrev_b32 v211, 18, v211
s_waitcnt lgkmcnt(4)
v_mfma_f32_16x16x32_bf16 v[196:199], v[188:191], v[56:59], v[196:199]
ds_read_u16 v210, v210
ds_read_u16_d16_hi v211, v211
v_mfma_f32_16x16x32_f16 v[132:135], v[184:187], v[116:119], v[132:135]
ds_read_b128 v[184:187], v251 offset:61440
v_pk_mul_f16 v12, v12, v13
v_mfma_f32_16x16x32_bf16 v[164:167], v[188:191], v[60:63], v[164:167]
v_exp_f16_sdwa v209, v209 dst_sel:WORD_0 dst_unused:UNUSED_PRESERVE src0_sel:WORD_0
v_mfma_f32_16x16x32_f16 v[216:219], v[120:123], v[72:75], v[216:219]
v_or_b32_e64 v0, v0, v1
v_cvt_pkrtz_f16_f32 v215, v214, v215
v_and_b32_e64 v215, s49, v215
v_bfe_u32 v214, v215, 2, 14
v_lshrrev_b32_e64 v215, 18, v215
v_mfma_f32_16x16x32_bf16 v[168:171], v[188:191], v[32:35], v[168:171]
ds_read_u16 v214, v214
ds_read_u16_d16_hi v215, v215
ds_read_b128 v[188:191], v249 offset:26880
v_mfma_f32_16x16x32_f16 v[220:223], v[120:123], v[240:243], v[220:223]
v_or_b32_e64 v13, v14, v15
v_cvt_pkrtz_f16_f32 v11, v10, v11
v_and_b32_e64 v11, s49, v11
v_bfe_u32 v10, v11, 2, 14
v_lshrrev_b32_e64 v11, 18, v11
v_mfma_f32_16x16x32_bf16 v[196:199], v[176:179], v[64:67], v[196:199]
ds_read_u16 v10, v10
ds_read_u16_d16_hi v11, v11
s_add_u32 s46, s80, 8388608
buffer_load_dwordx4 v[144:147], v250, s[32:35], s46 offen
s_add_u32 s46, s80, 10485760
buffer_load_dwordx4 v[148:151], v250, s[32:35], s46 offen
v_mfma_f32_16x16x32_f16 v[76:79], v[120:123], v[116:119], v[76:79]
ds_read_b128 v[120:123], v251 offset:59392
v_exp_f16_sdwa v209, v209 dst_sel:WORD_1 dst_unused:UNUSED_PRESERVE src0_sel:WORD_1
v_or_b32_e64 v125, v126, v127
v_mfma_f32_16x16x32_bf16 v[164:167], v[176:179], v[68:71], v[164:167]
v_or_b32_e64 v1, v2, v3
v_pk_add_f16 v209, v209, 1.0 op_sel_hi:[1,0]
v_mfma_f32_16x16x32_f16 v[100:103], v[4:7], v[72:75], v[100:103]
v_rcp_f16_sdwa v209, v209 dst_sel:WORD_0 dst_unused:UNUSED_PRESERVE src0_sel:WORD_0
v_mfma_f32_16x16x32_bf16 v[168:171], v[176:179], v[40:43], v[168:171]
ds_read_b128 v[176:179], v249 offset:28928
s_nop 1
v_cvt_pkrtz_f16_f32 v165, v164, v165
v_mfma_f32_16x16x32_f16 v[104:107], v[4:7], v[240:243], v[104:107]
s_setprio 1
v_and_b32 v165, s49, v165
v_bfe_u32 v164, v165, 2, 14
s_waitcnt lgkmcnt(5)
v_mfma_f32_16x16x32_bf16 v[152:155], v[180:183], v[48:51], 0
v_lshrrev_b32_e64 v165, 18, v165
v_cvt_pk_f16_f32 v196, v196, v197
v_mfma_f32_16x16x32_f16 v[140:143], v[4:7], v[116:119], v[140:143]
ds_read_b128 v[4:7], v251 offset:62464
ds_read_u16 v164, v164
v_mfma_f32_16x16x32_bf16 v[80:83], v[180:183], v[52:55], 0
ds_read_u16_d16_hi v165, v165
v_rcp_f16_sdwa v209, v209 dst_sel:WORD_1 dst_unused:UNUSED_PRESERVE src0_sel:WORD_1
v_mfma_f32_16x16x32_f16 v[232:235], v[184:187], v[72:75], v[232:235]
v_pk_fma_f16 v197, v196, v196, s48
v_cvt_pkrtz_f16_f32 v169, v168, v169
v_mfma_f32_16x16x32_bf16 v[88:91], v[180:183], v[24:27], 0
ds_read_b128 v[180:183], v249 offset:30720
v_and_b32_e64 v169, s49, v169
v_mfma_f32_16x16x32_f16 v[236:239], v[184:187], v[240:243], v[236:239]
v_bfe_u32 v168, v169, 2, 14
v_lshrrev_b32 v169, 18, v169
s_waitcnt lgkmcnt(4)
v_mfma_f32_16x16x32_bf16 v[152:155], v[188:191], v[56:59], v[152:155]
ds_read_u16 v168, v168
ds_read_u16_d16_hi v169, v169
v_mfma_f32_16x16x32_f16 v[84:87], v[184:187], v[116:119], v[84:87]
ds_read_b128 v[184:187], v251 offset:63488
v_or_b32_e64 v126, v212, v213
v_pk_mul_f16 v197, v196, v197
v_cvt_pkrtz_f16_f32 v199, v198, v199
v_and_b32_e64 v199, s49, v199
v_bfe_u32 v198, v199, 2, 14
v_lshrrev_b32_e64 v199, 18, v199
v_pk_mul_f16 v14, v208, v209
v_mfma_f32_16x16x32_bf16 v[80:83], v[188:191], v[60:63], v[80:83]
ds_read_u16 v198, v198
ds_read_u16_d16_hi v199, v199
v_mfma_f32_16x16x32_f16 v[108:111], v[120:123], v[72:75], v[108:111]
v_exp_f16_sdwa v197, v197 dst_sel:WORD_0 dst_unused:UNUSED_PRESERVE src0_sel:WORD_0
v_or_b32_e64 v2, v8, v9
v_cvt_pkrtz_f16_f32 v167, v166, v167
v_and_b32_e64 v167, s49, v167
v_bfe_u32 v166, v167, 2, 14
v_lshrrev_b32_e64 v167, 18, v167
v_mfma_f32_16x16x32_bf16 v[88:91], v[188:191], v[32:35], v[88:91]
ds_read_u16 v166, v166
ds_read_u16_d16_hi v167, v167
ds_read_b128 v[188:191], v249 offset:32768
v_mfma_f32_16x16x32_f16 v[192:195], v[120:123], v[240:243], v[192:195]
v_or_b32 v15, v210, v211
s_setprio 0
v_cvt_pkrtz_f16_f32 v171, v170, v171
v_and_b32_e64 v171, s49, v171
v_bfe_u32 v170, v171, 2, 14
v_lshrrev_b32_e64 v171, 18, v171
v_mfma_f32_16x16x32_bf16 v[152:155], v[176:179], v[64:67], v[152:155]
ds_read_u16 v170, v170
ds_read_u16_d16_hi v171, v171
v_mfma_f32_16x16x32_f16 v[244:247], v[120:123], v[116:119], v[244:247]
ds_read_b128 v[120:123], v252 offset:1024
v_exp_f16_sdwa v197, v197 dst_sel:WORD_1 dst_unused:UNUSED_PRESERVE src0_sel:WORD_1
v_or_b32_e64 v127, v214, v215
v_mfma_f32_16x16x32_bf16 v[80:83], v[176:179], v[68:71], v[80:83]
v_or_b32 v3, v10, v11
v_pk_add_f16 v197, v197, 1.0 op_sel_hi:[1,0]
s_waitcnt lgkmcnt(7)
v_mfma_f32_16x16x32_f16 v[96:99], v[4:7], v[72:75], v[96:99]
v_rcp_f16_sdwa v197, v197 dst_sel:WORD_0 dst_unused:UNUSED_PRESERVE src0_sel:WORD_0
v_mfma_f32_16x16x32_bf16 v[88:91], v[176:179], v[40:43], v[88:91]
ds_read_b128 v[176:179], v249 offset:34816
s_nop 0
v_cvt_pkrtz_f16_f32 v81, v80, v81
v_mfma_f32_16x16x32_f16 v[224:227], v[4:7], v[240:243], v[224:227]
v_and_b32 v81, s49, v81
v_bfe_u32 v80, v81, 2, 14
v_mfma_f32_16x16x32_bf16 v[208:211], v[180:183], v[48:51], 0
v_lshrrev_b32_e64 v81, 18, v81
v_cvt_pk_f16_f32 v152, v152, v153
v_mfma_f32_16x16x32_f16 v[92:95], v[4:7], v[116:119], v[92:95]
ds_read_b128 v[4:7], v251 offset:64512
ds_read_u16 v80, v80
v_mfma_f32_16x16x32_bf16 v[212:215], v[180:183], v[52:55], 0
ds_read_u16_d16_hi v81, v81
v_rcp_f16_sdwa v197, v197 dst_sel:WORD_1 dst_unused:UNUSED_PRESERVE src0_sel:WORD_1
v_mfma_f32_16x16x32_f16 v[200:203], v[184:187], v[0:3], v[200:203]
v_pk_fma_f16 v153, v152, v152, s48
v_cvt_pkrtz_f16_f32 v89, v88, v89
v_mfma_f32_16x16x32_bf16 v[8:11], v[180:183], v[24:27], 0
ds_read_b128 v[180:183], v249 offset:30976
v_and_b32 v89, s49, v89
v_mfma_f32_16x16x32_f16 v[204:207], v[184:187], v[124:127], v[204:207]
s_setprio 3
v_bfe_u32 v88, v89, 2, 14
v_lshrrev_b32 v89, 18, v89
s_waitcnt lgkmcnt(4)
v_mfma_f32_16x16x32_bf16 v[208:211], v[188:191], v[56:59], v[208:211]
ds_read_u16 v88, v88
ds_read_u16_d16_hi v89, v89
v_mfma_f32_16x16x32_f16 v[132:135], v[184:187], v[12:15], v[132:135]
ds_read_b128 v[184:187], v252 offset:2048
v_or_b32_e64 v164, v164, v165
v_pk_mul_f16 v153, v152, v153
v_cvt_pkrtz_f16_f32 v155, v154, v155
v_and_b32_e64 v155, s49, v155
v_bfe_u32 v154, v155, 2, 14
v_lshrrev_b32_e64 v155, 18, v155
v_pk_mul_f16 v196, v196, v197
v_mfma_f32_16x16x32_bf16 v[212:215], v[188:191], v[60:63], v[212:215]
ds_read_u16 v154, v154
ds_read_u16_d16_hi v155, v155
v_mfma_f32_16x16x32_f16 v[216:219], v[120:123], v[0:3], v[216:219]
v_exp_f16_sdwa v153, v153 dst_sel:WORD_0 dst_unused:UNUSED_PRESERVE src0_sel:WORD_0
v_or_b32_e64 v168, v168, v169
v_cvt_pkrtz_f16_f32 v83, v82, v83
v_and_b32_e64 v83, s49, v83
v_bfe_u32 v82, v83, 2, 14
v_lshrrev_b32_e64 v83, 18, v83
v_mfma_f32_16x16x32_bf16 v[8:11], v[188:191], v[32:35], v[8:11]
ds_read_u16 v82, v82
ds_read_u16_d16_hi v83, v83
v_mfma_f32_16x16x32_f16 v[220:223], v[120:123], v[124:127], v[220:223]
ds_read_b128 v[188:191], v249 offset:35072
v_or_b32_e64 v197, v198, v199
v_cvt_pkrtz_f16_f32 v91, v90, v91
v_and_b32_e64 v91, s49, v91
v_bfe_u32 v90, v91, 2, 14
v_lshrrev_b32_e64 v91, 18, v91
v_mfma_f32_16x16x32_bf16 v[208:211], v[176:179], v[64:67], v[208:211]
ds_read_u16 v90, v90
ds_read_u16_d16_hi v91, v91
s_waitcnt vmcnt(5)
v_permlane16_swap_b32 v128, v136
v_permlane16_swap_b32 v129, v137
v_permlane16_swap_b32 v130, v138
v_permlane16_swap_b32 v131, v139
s_waitcnt vmcnt(3)
v_permlane16_swap_b32 v156, v160
v_permlane16_swap_b32 v157, v161
v_permlane16_swap_b32 v158, v162
v_permlane16_swap_b32 v159, v163
v_mfma_f32_16x16x32_f16 v[76:79], v[120:123], v[12:15], v[76:79]
v_exp_f16_sdwa v153, v153 dst_sel:WORD_1 dst_unused:UNUSED_PRESERVE src0_sel:WORD_1
v_or_b32_e64 v165, v166, v167
v_mfma_f32_16x16x32_bf16 v[212:215], v[176:179], v[68:71], v[212:215]
ds_read_b128 v[120:123], v252 offset:3072
v_or_b32 v169, v170, v171
s_waitcnt lgkmcnt(6)
v_mfma_f32_16x16x32_f16 v[100:103], v[4:7], v[0:3], v[100:103]
v_pk_add_f16 v153, v153, 1.0 op_sel_hi:[1,0]
v_cvt_pk_f16_f32 v208, v208, v209
v_mfma_f32_16x16x32_bf16 v[8:11], v[176:179], v[40:43], v[8:11]
ds_read_b128 v[176:179], v248
v_rcp_f16_sdwa v153, v153 dst_sel:WORD_0 dst_unused:UNUSED_PRESERVE src0_sel:WORD_0
v_mfma_f32_16x16x32_f16 v[104:107], v[4:7], v[124:127], v[104:107]
v_cvt_pkrtz_f16_f32 v213, v212, v213
v_and_b32 v213, s49, v213
v_mfma_f32_16x16x32_bf16 v[116:119], v[180:183], v[48:51], 0
s_setprio 2
ds_read_b128 v[48:51], v252
v_bfe_u32 v212, v213, 2, 14
v_mfma_f32_16x16x32_f16 v[140:143], v[4:7], v[12:15], v[140:143]
ds_read_b128 v[4:7], v252 offset:4096
v_lshrrev_b32_e64 v213, 18, v213
v_mfma_f32_16x16x32_bf16 v[240:243], v[180:183], v[52:55], 0
ds_read_b128 v[52:55], v249 offset:33024
ds_read_u16 v212, v212
v_mfma_f32_16x16x32_f16 v[232:235], v[184:187], v[0:3], v[232:235]
ds_read_u16_d16_hi v213, v213
v_rcp_f16_sdwa v153, v153 dst_sel:WORD_1 dst_unused:UNUSED_PRESERVE src0_sel:WORD_1
v_mfma_f32_16x16x32_bf16 v[72:75], v[180:183], v[24:27], 0
ds_read_b128 v[180:183], v248 offset:2048
v_pk_fma_f16 v209, v208, v208, s48
v_mfma_f32_16x16x32_f16 v[236:239], v[184:187], v[124:127], v[236:239]
v_cvt_pkrtz_f16_f32 v9, v8, v9
v_and_b32_e64 v9, s49, v9
v_bfe_u32 v8, v9, 2, 14
v_lshrrev_b32_e64 v9, 18, v9
ds_read_u16 v8, v8
ds_read_u16_d16_hi v9, v9
s_waitcnt lgkmcnt(5)
v_mfma_f32_16x16x32_bf16 v[116:119], v[52:55], v[56:59], v[116:119]
s_waitcnt vmcnt(0)
v_permlane16_swap_b32 v144, v148
v_permlane16_swap_b32 v145, v149
v_permlane16_swap_b32 v146, v150
v_permlane16_swap_b32 v147, v151
v_mfma_f32_16x16x32_f16 v[84:87], v[184:187], v[12:15], v[84:87]
v_or_b32_e64 v166, v80, v81
v_pk_mul_f16 v209, v208, v209
v_cvt_pkrtz_f16_f32 v211, v210, v211
v_and_b32_e64 v211, s49, v211
v_bfe_u32 v210, v211, 2, 14
v_lshrrev_b32_e64 v211, 18, v211
v_pk_mul_f16 v198, v152, v153
ds_read_b128 v[184:187], v252 offset:7168
ds_read_u16 v210, v210
ds_read_u16_d16_hi v211, v211
v_mfma_f32_16x16x32_bf16 v[240:243], v[52:55], v[60:63], v[240:243]
v_exp_f16_sdwa v209, v209 dst_sel:WORD_0 dst_unused:UNUSED_PRESERVE src0_sel:WORD_0
v_mfma_f32_16x16x32_f16 v[108:111], v[48:51], v[0:3], v[108:111]
v_or_b32_e64 v170, v88, v89
v_cvt_pkrtz_f16_f32 v215, v214, v215
v_and_b32_e64 v215, s49, v215
v_bfe_u32 v214, v215, 2, 14
v_lshrrev_b32_e64 v215, 18, v215
v_mfma_f32_16x16x32_bf16 v[72:75], v[52:55], v[32:35], v[72:75]
ds_read_u16 v214, v214
ds_read_u16_d16_hi v215, v215
v_mfma_f32_16x16x32_f16 v[192:195], v[48:51], v[124:127], v[192:195]
ds_read_b128 v[52:55], v248 offset:4096
v_or_b32 v199, v154, v155
s_setprio 1
v_cvt_pkrtz_f16_f32 v11, v10, v11
v_and_b32_e64 v11, s49, v11
v_bfe_u32 v10, v11, 2, 14
v_lshrrev_b32_e64 v11, 18, v11
v_mfma_f32_16x16x32_bf16 v[116:119], v[188:191], v[64:67], v[116:119]
ds_read_u16 v10, v10
ds_read_u16_d16_hi v11, v11
v_mfma_f32_16x16x32_f16 v[244:247], v[48:51], v[12:15], v[244:247]
v_exp_f16_sdwa v209, v209 dst_sel:WORD_1 dst_unused:UNUSED_PRESERVE src0_sel:WORD_1
v_or_b32_e64 v167, v82, v83
v_mfma_f32_16x16x32_bf16 v[240:243], v[188:191], v[68:71], v[240:243]
ds_read_b128 v[48:51], v252 offset:5120
v_or_b32_e64 v171, v90, v91
v_mfma_f32_16x16x32_f16 v[96:99], v[120:123], v[0:3], v[96:99]
v_pk_add_f16 v209, v209, 1.0 op_sel_hi:[1,0]
v_cvt_pk_f16_f32 v116, v116, v117
v_mfma_f32_16x16x32_bf16 v[72:75], v[188:191], v[40:43], v[72:75]
ds_read_b128 v[188:191], v248 offset:256
v_rcp_f16_sdwa v209, v209 dst_sel:WORD_0 dst_unused:UNUSED_PRESERVE src0_sel:WORD_0
v_mfma_f32_16x16x32_f16 v[224:227], v[120:123], v[124:127], v[224:227]
v_cvt_pkrtz_f16_f32 v241, v240, v241
v_and_b32_e64 v241, s49, v241
v_mfma_f32_16x16x32_bf16 v[24:27], v[176:179], v[28:31], 0
v_bfe_u32 v240, v241, 2, 14
v_lshrrev_b32 v241, 18, v241
v_mfma_f32_16x16x32_f16 v[92:95], v[120:123], v[12:15], v[92:95]
s_waitcnt lgkmcnt(4)
ds_read_b128 v[120:123], v252 offset:8192
ds_read_u16 v240, v240
v_mfma_f32_16x16x32_bf16 v[200:203], v[18:21], v[228:231], v[200:203]
ds_read_u16_d16_hi v241, v241
v_rcp_f16_sdwa v209, v209 dst_sel:WORD_1 dst_unused:UNUSED_PRESERVE src0_sel:WORD_1
v_mfma_f32_16x16x32_bf16 v[216:219], v[16:19], v[228:231], v[216:219]
v_pk_fma_f16 v117, v116, v116, s48
v_cvt_pkrtz_f16_f32 v73, v72, v73
v_mfma_f32_16x16x32_bf16 v[100:103], v[18:21], v[112:115], v[100:103]
v_and_b32_e64 v73, s49, v73
v_bfe_u32 v72, v73, 2, 14
v_mfma_f32_16x16x32_bf16 v[232:235], v[16:19], v[112:115], v[232:235]
v_lshrrev_b32 v73, 18, v73
v_or_b32 v212, v212, v213
v_mfma_f32_16x16x32_bf16 v[56:59], v[176:179], v[128:131], 0
ds_read_u16 v72, v72
ds_read_u16_d16_hi v73, v73
v_mfma_f32_16x16x32_f16 v[200:203], v[4:7], v[168:171], v[200:203]
v_pk_mul_f16 v117, v116, v117
v_cvt_pkrtz_f16_f32 v119, v118, v119
v_mfma_f32_16x16x32_bf16 v[60:63], v[176:179], v[136:139], 0
ds_read_b128 v[176:179], v248 offset:2304
v_and_b32 v119, s49, v119
v_mfma_f32_16x16x32_f16 v[204:207], v[4:7], v[164:167], v[204:207]
s_setprio 0
v_bfe_u32 v118, v119, 2, 14
v_lshrrev_b32_e64 v119, 18, v119
v_mfma_f32_16x16x32_bf16 v[24:27], v[180:183], v[36:39], v[24:27]
ds_read_u16 v118, v118
ds_read_u16_d16_hi v119, v119
v_mfma_f32_16x16x32_f16 v[132:135], v[4:7], v[196:199], v[132:135]
ds_read_b128 v[4:7], v252 offset:6144
v_pk_mul_f16 v208, v208, v209
v_mfma_f32_16x16x32_bf16 v[56:59], v[180:183], v[156:159], v[56:59]
v_exp_f16_sdwa v117, v117 dst_sel:WORD_0 dst_unused:UNUSED_PRESERVE src0_sel:WORD_0
v_mfma_f32_16x16x32_f16 v[216:219], v[184:187], v[168:171], v[216:219]
v_or_b32_e64 v8, v8, v9
v_cvt_pkrtz_f16_f32 v243, v242, v243
v_and_b32_e64 v243, s49, v243
v_bfe_u32 v242, v243, 2, 14
v_lshrrev_b32_e64 v243, 18, v243
v_mfma_f32_16x16x32_bf16 v[60:63], v[180:183], v[160:163], v[60:63]
ds_read_u16 v242, v242
ds_read_u16_d16_hi v243, v243
v_mfma_f32_16x16x32_f16 v[220:223], v[184:187], v[164:167], v[220:223]
s_waitcnt lgkmcnt(6)
ds_read_b128 v[180:183], v248 offset:4352
v_or_b32 v209, v210, v211
v_cvt_pkrtz_f16_f32 v75, v74, v75
v_and_b32_e64 v75, s49, v75
v_bfe_u32 v74, v75, 2, 14
v_lshrrev_b32_e64 v75, 18, v75
v_mfma_f32_16x16x32_bf16 v[24:27], v[52:55], v[44:47], v[24:27]
ds_read_u16 v74, v74
ds_read_u16_d16_hi v75, v75
v_mfma_f32_16x16x32_f16 v[76:79], v[184:187], v[196:199], v[76:79]
v_exp_f16_sdwa v117, v117 dst_sel:WORD_1 dst_unused:UNUSED_PRESERVE src0_sel:WORD_1
v_or_b32_e64 v213, v214, v215
v_mfma_f32_16x16x32_bf16 v[56:59], v[52:55], v[144:147], v[56:59]
ds_read_b128 v[184:187], v252 offset:9216
v_or_b32_e64 v9, v10, v11
v_mfma_f32_16x16x32_f16 v[100:103], v[48:51], v[168:171], v[100:103]
v_pk_add_f16 v117, v117, 1.0 op_sel_hi:[1,0]
v_cvt_pk_f16_f32 v24, v24, v25
v_mfma_f32_16x16x32_bf16 v[60:63], v[52:55], v[148:151], v[60:63]
ds_read_b128 v[52:55], v248 offset:6144
v_rcp_f16_sdwa v117, v117 dst_sel:WORD_0 dst_unused:UNUSED_PRESERVE src0_sel:WORD_0
v_mfma_f32_16x16x32_f16 v[104:107], v[48:51], v[164:167], v[104:107]
s_setprio 3
v_cvt_pkrtz_f16_f32 v57, v56, v57
v_and_b32 v57, s49, v57
v_mfma_f32_16x16x32_bf16 v[32:35], v[188:191], v[28:31], 0
v_bfe_u32 v56, v57, 2, 14
v_lshrrev_b32_e64 v57, 18, v57
v_mfma_f32_16x16x32_f16 v[140:143], v[48:51], v[196:199], v[140:143]
ds_read_b128 v[48:51], v252 offset:10240
ds_read_u16 v56, v56
v_mfma_f32_16x16x32_bf16 v[152:155], v[188:191], v[128:131], 0
ds_read_u16_d16_hi v57, v57
v_rcp_f16_sdwa v117, v117 dst_sel:WORD_1 dst_unused:UNUSED_PRESERVE src0_sel:WORD_1
v_mfma_f32_16x16x32_f16 v[232:235], v[120:123], v[168:171], v[232:235]
v_pk_fma_f16 v25, v24, v24, s48
v_cvt_pkrtz_f16_f32 v61, v60, v61
v_mfma_f32_16x16x32_bf16 v[80:83], v[188:191], v[136:139], 0
ds_read_b128 v[188:191], v248 offset:8192
v_and_b32_e64 v61, s49, v61
v_mfma_f32_16x16x32_f16 v[236:239], v[120:123], v[164:167], v[236:239]
v_bfe_u32 v60, v61, 2, 14
v_lshrrev_b32 v61, 18, v61
s_waitcnt lgkmcnt(4)
v_mfma_f32_16x16x32_bf16 v[32:35], v[176:179], v[36:39], v[32:35]
ds_read_u16 v60, v60
ds_read_u16_d16_hi v61, v61
v_mfma_f32_16x16x32_f16 v[84:87], v[120:123], v[196:199], v[84:87]
v_or_b32_e64 v214, v240, v241
v_pk_mul_f16 v25, v24, v25
v_cvt_pkrtz_f16_f32 v27, v26, v27
v_and_b32_e64 v27, s49, v27
v_bfe_u32 v26, v27, 2, 14
v_lshrrev_b32_e64 v27, 18, v27
v_pk_mul_f16 v210, v116, v117
ds_read_b128 v[120:123], v252 offset:13312
ds_read_u16 v26, v26
ds_read_u16_d16_hi v27, v27
v_mfma_f32_16x16x32_bf16 v[152:155], v[176:179], v[156:159], v[152:155]
v_exp_f16_sdwa v25, v25 dst_sel:WORD_0 dst_unused:UNUSED_PRESERVE src0_sel:WORD_0
v_mfma_f32_16x16x32_f16 v[108:111], v[4:7], v[168:171], v[108:111]
v_or_b32_e64 v10, v72, v73
v_cvt_pkrtz_f16_f32 v59, v58, v59
v_and_b32_e64 v59, s49, v59
v_bfe_u32 v58, v59, 2, 14
v_lshrrev_b32_e64 v59, 18, v59
v_mfma_f32_16x16x32_bf16 v[80:83], v[176:179], v[160:163], v[80:83]
ds_read_u16 v58, v58
ds_read_u16_d16_hi v59, v59
v_mfma_f32_16x16x32_f16 v[192:195], v[4:7], v[164:167], v[192:195]
ds_read_b128 v[176:179], v248 offset:10240
v_or_b32 v211, v118, v119
s_setprio 2
v_cvt_pkrtz_f16_f32 v63, v62, v63
v_and_b32_e64 v63, s49, v63
v_bfe_u32 v62, v63, 2, 14
v_lshrrev_b32_e64 v63, 18, v63
v_mfma_f32_16x16x32_bf16 v[32:35], v[180:183], v[44:47], v[32:35]
ds_read_u16 v62, v62
ds_read_u16_d16_hi v63, v63
v_mfma_f32_16x16x32_f16 v[244:247], v[4:7], v[196:199], v[244:247]
v_exp_f16_sdwa v25, v25 dst_sel:WORD_1 dst_unused:UNUSED_PRESERVE src0_sel:WORD_1
v_or_b32_e64 v215, v242, v243
v_mfma_f32_16x16x32_bf16 v[152:155], v[180:183], v[144:147], v[152:155]
ds_read_b128 v[4:7], v252 offset:11264
v_or_b32 v11, v74, v75
v_mfma_f32_16x16x32_f16 v[96:99], v[184:187], v[168:171], v[96:99]
v_pk_add_f16 v25, v25, 1.0 op_sel_hi:[1,0]
v_cvt_pk_f16_f32 v32, v32, v33
v_mfma_f32_16x16x32_bf16 v[80:83], v[180:183], v[148:151], v[80:83]
s_waitcnt lgkmcnt(6)
ds_read_b128 v[180:183], v248 offset:6400
v_rcp_f16_sdwa v25, v25 dst_sel:WORD_0 dst_unused:UNUSED_PRESERVE src0_sel:WORD_0
v_mfma_f32_16x16x32_f16 v[224:227], v[184:187], v[164:167], v[224:227]
v_cvt_pkrtz_f16_f32 v153, v152, v153
v_and_b32_e64 v153, s49, v153
v_mfma_f32_16x16x32_bf16 v[88:91], v[52:55], v[28:31], 0
v_bfe_u32 v152, v153, 2, 14
v_lshrrev_b32_e64 v153, 18, v153
v_mfma_f32_16x16x32_f16 v[92:95], v[184:187], v[196:199], v[92:95]
ds_read_b128 v[184:187], v252 offset:14336
ds_read_u16 v152, v152
v_mfma_f32_16x16x32_bf16 v[64:67], v[52:55], v[128:131], 0
ds_read_u16_d16_hi v153, v153
v_rcp_f16_sdwa v25, v25 dst_sel:WORD_1 dst_unused:UNUSED_PRESERVE src0_sel:WORD_1
v_mfma_f32_16x16x32_f16 v[200:203], v[48:51], v[8:11], v[200:203]
v_pk_fma_f16 v33, v32, v32, s48
v_cvt_pkrtz_f16_f32 v81, v80, v81
v_mfma_f32_16x16x32_bf16 v[68:71], v[52:55], v[136:139], 0
ds_read_b128 v[52:55], v248 offset:8448
v_and_b32 v81, s49, v81
v_mfma_f32_16x16x32_f16 v[204:207], v[48:51], v[212:215], v[204:207]
s_setprio 1
v_bfe_u32 v80, v81, 2, 14
v_lshrrev_b32_e64 v81, 18, v81
v_mfma_f32_16x16x32_bf16 v[88:91], v[188:191], v[36:39], v[88:91]
ds_read_u16 v80, v80
ds_read_u16_d16_hi v81, v81
v_mfma_f32_16x16x32_f16 v[132:135], v[48:51], v[208:211], v[132:135]
v_or_b32_e64 v56, v56, v57
v_pk_mul_f16 v33, v32, v33
v_cvt_pkrtz_f16_f32 v35, v34, v35
v_and_b32_e64 v35, s49, v35
v_bfe_u32 v34, v35, 2, 14
v_lshrrev_b32 v35, 18, v35
v_pk_mul_f16 v24, v24, v25
ds_read_b128 v[48:51], v252 offset:12288
ds_read_u16 v34, v34
s_waitcnt lgkmcnt(7)
ds_read_u16_d16_hi v35, v35
v_mfma_f32_16x16x32_bf16 v[64:67], v[188:191], v[156:159], v[64:67]
v_exp_f16_sdwa v33, v33 dst_sel:WORD_0 dst_unused:UNUSED_PRESERVE src0_sel:WORD_0
v_mfma_f32_16x16x32_f16 v[216:219], v[120:123], v[8:11], v[216:219]
v_or_b32_e64 v60, v60, v61
v_cvt_pkrtz_f16_f32 v155, v154, v155
v_and_b32_e64 v155, s49, v155
v_bfe_u32 v154, v155, 2, 14
v_lshrrev_b32_e64 v155, 18, v155
v_mfma_f32_16x16x32_bf16 v[68:71], v[188:191], v[160:163], v[68:71]
ds_read_u16 v154, v154
ds_read_u16_d16_hi v155, v155
v_mfma_f32_16x16x32_f16 v[220:223], v[120:123], v[212:215], v[220:223]
ds_read_b128 v[188:191], v248 offset:10496
v_or_b32_e64 v25, v26, v27
v_cvt_pkrtz_f16_f32 v83, v82, v83
v_and_b32_e64 v83, s49, v83
v_bfe_u32 v82, v83, 2, 14
v_lshrrev_b32_e64 v83, 18, v83
v_mfma_f32_16x16x32_bf16 v[88:91], v[176:179], v[44:47], v[88:91]
ds_read_u16 v82, v82
ds_read_u16_d16_hi v83, v83
v_mfma_f32_16x16x32_f16 v[76:79], v[120:123], v[208:211], v[76:79]
v_exp_f16_sdwa v33, v33 dst_sel:WORD_1 dst_unused:UNUSED_PRESERVE src0_sel:WORD_1
v_or_b32_e64 v57, v58, v59
v_mfma_f32_16x16x32_bf16 v[64:67], v[176:179], v[144:147], v[64:67]
ds_read_b128 v[120:123], v252 offset:15360
v_or_b32_e64 v61, v62, v63
v_mfma_f32_16x16x32_f16 v[100:103], v[4:7], v[8:11], v[100:103]
v_pk_add_f16 v33, v33, 1.0 op_sel_hi:[1,0]
v_cvt_pk_f16_f32 v88, v88, v89
v_mfma_f32_16x16x32_bf16 v[68:71], v[176:179], v[148:151], v[68:71]
ds_read_b128 v[176:179], v248 offset:12288
v_rcp_f16_sdwa v33, v33 dst_sel:WORD_0 dst_unused:UNUSED_PRESERVE src0_sel:WORD_0
v_mfma_f32_16x16x32_f16 v[104:107], v[4:7], v[212:215], v[104:107]
s_setprio 0
v_cvt_pkrtz_f16_f32 v65, v64, v65
v_and_b32 v65, s49, v65
v_mfma_f32_16x16x32_bf16 v[40:43], v[180:183], v[28:31], 0
v_bfe_u32 v64, v65, 2, 14
v_lshrrev_b32 v65, 18, v65
v_mfma_f32_16x16x32_f16 v[140:143], v[4:7], v[208:211], v[140:143]
s_waitcnt lgkmcnt(4)
ds_read_b128 v[4:7], v251 offset:8192
ds_read_u16 v64, v64
v_mfma_f32_16x16x32_bf16 v[12:15], v[180:183], v[128:131], 0
ds_read_u16_d16_hi v65, v65
v_rcp_f16_sdwa v33, v33 dst_sel:WORD_1 dst_unused:UNUSED_PRESERVE src0_sel:WORD_1
v_mfma_f32_16x16x32_f16 v[232:235], v[184:187], v[8:11], v[232:235]
v_pk_fma_f16 v89, v88, v88, s48
v_cvt_pkrtz_f16_f32 v69, v68, v69
v_mfma_f32_16x16x32_bf16 v[124:127], v[180:183], v[136:139], 0
ds_read_b128 v[180:183], v248 offset:14336
v_and_b32_e64 v69, s49, v69
v_mfma_f32_16x16x32_f16 v[236:239], v[184:187], v[212:215], v[236:239]
v_bfe_u32 v68, v69, 2, 14
v_lshrrev_b32_e64 v69, 18, v69
v_mfma_f32_16x16x32_bf16 v[40:43], v[52:55], v[36:39], v[40:43]
ds_read_u16 v68, v68
ds_read_u16_d16_hi v69, v69
v_mfma_f32_16x16x32_f16 v[84:87], v[184:187], v[208:211], v[84:87]
v_or_b32_e64 v58, v152, v153
v_pk_mul_f16 v89, v88, v89
v_cvt_pkrtz_f16_f32 v91, v90, v91
v_and_b32_e64 v91, s49, v91
v_bfe_u32 v90, v91, 2, 14
v_lshrrev_b32_e64 v91, 18, v91
v_pk_mul_f16 v26, v32, v33
ds_read_b128 v[184:187], v251 offset:11264
ds_read_u16 v90, v90
ds_read_u16_d16_hi v91, v91
v_mfma_f32_16x16x32_bf16 v[12:15], v[52:55], v[156:159], v[12:15]
v_exp_f16_sdwa v89, v89 dst_sel:WORD_0 dst_unused:UNUSED_PRESERVE src0_sel:WORD_0
v_mfma_f32_16x16x32_f16 v[108:111], v[48:51], v[8:11], v[108:111]
v_or_b32_e64 v62, v80, v81
v_cvt_pkrtz_f16_f32 v67, v66, v67
v_and_b32_e64 v67, s49, v67
v_bfe_u32 v66, v67, 2, 14
v_lshrrev_b32_e64 v67, 18, v67
v_mfma_f32_16x16x32_bf16 v[124:127], v[52:55], v[160:163], v[124:127]
ds_read_u16 v66, v66
ds_read_u16_d16_hi v67, v67
v_mfma_f32_16x16x32_f16 v[192:195], v[48:51], v[212:215], v[192:195]
s_waitcnt lgkmcnt(6)
ds_read_b128 v[52:55], v248 offset:16384
v_or_b32 v27, v34, v35
s_setprio 3
v_cvt_pkrtz_f16_f32 v71, v70, v71
v_and_b32 v71, s49, v71
v_bfe_u32 v70, v71, 2, 14
v_lshrrev_b32_e64 v71, 18, v71
v_mfma_f32_16x16x32_bf16 v[40:43], v[188:191], v[44:47], v[40:43]
ds_read_u16 v70, v70
ds_read_u16_d16_hi v71, v71
v_mfma_f32_16x16x32_f16 v[244:247], v[48:51], v[208:211], v[244:247]
v_cvt_pk_bf16_f32 v132, v132, v133
v_cvt_pk_bf16_f32 v133, v134, v135
v_cvt_pk_bf16_f32 v134, v76, v77
v_cvt_pk_bf16_f32 v135, v78, v79
v_cvt_pk_bf16_f32 v204, v204, v205
v_cvt_pk_bf16_f32 v205, v206, v207
v_cvt_pk_bf16_f32 v206, v220, v221
v_cvt_pk_bf16_f32 v207, v222, v223
v_cvt_pk_bf16_f32 v200, v200, v201
v_cvt_pk_bf16_f32 v201, v202, v203
v_cvt_pk_bf16_f32 v202, v216, v217
v_cvt_pk_bf16_f32 v203, v218, v219
v_exp_f16_sdwa v89, v89 dst_sel:WORD_1 dst_unused:UNUSED_PRESERVE src0_sel:WORD_1
v_or_b32_e64 v59, v154, v155
v_cvt_pk_bf16_f32 v140, v140, v141
v_cvt_pk_bf16_f32 v141, v142, v143
v_cvt_pk_bf16_f32 v142, v84, v85
v_cvt_pk_bf16_f32 v143, v86, v87
ds_read_b128 v[76:79], v254 offset:8192
ds_read_b128 v[220:223], v254 offset:8208
ds_read_b128 v[48:51], v251 offset:9216
v_cvt_pk_bf16_f32 v104, v104, v105
v_cvt_pk_bf16_f32 v105, v106, v107
v_cvt_pk_bf16_f32 v106, v236, v237
v_cvt_pk_bf16_f32 v107, v238, v239
v_cvt_pk_bf16_f32 v100, v100, v101
v_cvt_pk_bf16_f32 v101, v102, v103
v_cvt_pk_bf16_f32 v102, v232, v233
v_cvt_pk_bf16_f32 v103, v234, v235
v_mfma_f32_16x16x32_bf16 v[12:15], v[188:191], v[144:147], v[12:15]
ds_read_b128 v[84:87], v254 offset:8320
ds_read_b128 v[236:239], v254 offset:8336
v_mfma_f32_16x16x32_f16 v[96:99], v[120:123], v[8:11], v[96:99]
v_cvt_pk_bf16_f32 v244, v244, v245
v_cvt_pk_bf16_f32 v245, v246, v247
v_cvt_pk_bf16_f32 v192, v192, v193
v_cvt_pk_bf16_f32 v193, v194, v195
v_or_b32_e64 v63, v82, v83
v_mfma_f32_16x16x32_bf16 v[124:127], v[188:191], v[148:151], v[124:127]
v_pk_add_f16 v89, v89, 1.0 op_sel_hi:[1,0]
v_cvt_pkrtz_f16_f32 v13, v12, v13
v_mfma_f32_16x16x32_f16 v[224:227], v[120:123], v[212:215], v[224:227]
ds_read_b128 v[188:191], v248 offset:12544
v_rcp_f16_sdwa v89, v89 dst_sel:WORD_0 dst_unused:UNUSED_PRESERVE src0_sel:WORD_0
v_mfma_f32_16x16x32_bf16 v[0:3], v[176:179], v[28:31], 0
v_and_b32_e64 v13, s49, v13
v_bfe_u32 v12, v13, 2, 14
v_mfma_f32_16x16x32_f16 v[92:95], v[120:123], v[208:211], v[92:95]
s_nop 1
v_cvt_pk_bf16_f32 v194, v224, v225
v_cvt_pk_bf16_f32 v195, v226, v227
v_mfma_f32_16x16x32_bf16 v[108:111], v[18:21], v[172:175], v[108:111]
s_waitcnt lgkmcnt(2)
ds_read_b128 v[224:227], v254 offset:16
ds_read_b128 v[120:123], v251 offset:12288
v_mfma_f32_16x16x32_bf16 v[96:99], v[16:19], v[172:175], v[96:99]
v_lshrrev_b32_e64 v13, 18, v13
v_cvt_pk_bf16_f32 v246, v92, v93
v_cvt_pk_bf16_f32 v247, v94, v95
v_mfma_f32_16x16x32_bf16 v[228:231], v[176:179], v[128:131], 0
ds_read_b128 v[92:95], v254
v_cvt_pk_bf16_f32 v108, v108, v109
v_cvt_pk_bf16_f32 v109, v110, v111
v_mfma_f32_16x16x32_f16 v[116:119], v[4:7], v[60:63], v[76:79]
v_cvt_pk_bf16_f32 v110, v96, v97
v_cvt_pk_bf16_f32 v111, v98, v99
v_cvt_pk_f16_f32 v40, v40, v41
v_mfma_f32_16x16x32_bf16 v[112:115], v[176:179], v[136:139], 0
ds_read_u16 v12, v12
ds_read_u16_d16_hi v13, v13
v_rcp_f16_sdwa v89, v89 dst_sel:WORD_1 dst_unused:UNUSED_PRESERVE src0_sel:WORD_1
buffer_store_dwordx4 v[132:135], v253, s[8:11], s70 offen sc1
buffer_store_dwordx4 v[140:143], v253, s[8:11], s70 offen offset:64 sc1
v_mfma_f32_16x16x32_f16 v[240:243], v[4:7], v[56:59], v[76:79]
ds_read_b128 v[176:179], v248 offset:14592
s_setprio 2
v_pk_fma_f16 v41, v40, v40, s48
v_cvt_pkrtz_f16_f32 v125, v124, v125
v_and_b32 v125, s49, v125
v_bfe_u32 v124, v125, 2, 14
v_lshrrev_b32_e64 v125, 18, v125
v_mfma_f32_16x16x32_bf16 v[0:3], v[180:183], v[36:39], v[0:3]
ds_read_u16 v124, v124
ds_read_u16_d16_hi v125, v125
v_mfma_f32_16x16x32_f16 v[76:79], v[4:7], v[24:27], v[76:79]
v_or_b32_e64 v64, v64, v65
v_pk_mul_f16 v41, v40, v41
v_cvt_pkrtz_f16_f32 v43, v42, v43
v_and_b32_e64 v43, s49, v43
v_bfe_u32 v42, v43, 2, 14
v_lshrrev_b32_e64 v43, 18, v43
v_pk_mul_f16 v88, v88, v89
ds_read_b128 v[4:7], v251 offset:10240
ds_read_u16 v42, v42
ds_read_u16_d16_hi v43, v43
v_mfma_f32_16x16x32_bf16 v[228:231], v[180:183], v[156:159], v[228:231]
v_exp_f16_sdwa v41, v41 dst_sel:WORD_0 dst_unused:UNUSED_PRESERVE src0_sel:WORD_0
v_mfma_f32_16x16x32_f16 v[72:75], v[184:187], v[60:63], v[220:223]
v_or_b32_e64 v68, v68, v69
v_cvt_pkrtz_f16_f32 v15, v14, v15
v_and_b32_e64 v15, s49, v15
v_bfe_u32 v14, v15, 2, 14
v_lshrrev_b32_e64 v15, 18, v15
v_mfma_f32_16x16x32_bf16 v[112:115], v[180:183], v[160:163], v[112:115]
ds_read_u16 v14, v14
ds_read_u16_d16_hi v15, v15
v_mfma_f32_16x16x32_f16 v[196:199], v[184:187], v[56:59], v[220:223]
s_waitcnt lgkmcnt(7)
ds_read_b128 v[180:183], v248 offset:16640
v_or_b32 v89, v90, v91
v_cvt_pkrtz_f16_f32 v127, v126, v127
v_and_b32_e64 v127, s49, v127
v_bfe_u32 v126, v127, 2, 14
v_lshrrev_b32_e64 v127, 18, v127
v_mfma_f32_16x16x32_bf16 v[0:3], v[52:55], v[44:47], v[0:3]
ds_read_u16 v126, v126
ds_read_u16_d16_hi v127, v127
v_mfma_f32_16x16x32_f16 v[220:223], v[184:187], v[24:27], v[220:223]
v_exp_f16_sdwa v41, v41 dst_sel:WORD_1 dst_unused:UNUSED_PRESERVE src0_sel:WORD_1
v_or_b32_e64 v65, v66, v67
v_mfma_f32_16x16x32_bf16 v[228:231], v[52:55], v[144:147], v[228:231]
ds_read_b128 v[184:187], v251 offset:13312
v_or_b32_e64 v69, v70, v71
v_mfma_f32_16x16x32_f16 v[164:167], v[48:51], v[60:63], v[84:87]
v_pk_add_f16 v41, v41, 1.0 op_sel_hi:[1,0]
v_cvt_pk_f16_f32 v0, v0, v1
v_mfma_f32_16x16x32_bf16 v[112:115], v[52:55], v[148:151], v[112:115]
ds_read_b128 v[52:55], v248 offset:18432
v_rcp_f16_sdwa v41, v41 dst_sel:WORD_0 dst_unused:UNUSED_PRESERVE src0_sel:WORD_0
v_mfma_f32_16x16x32_f16 v[168:171], v[48:51], v[56:59], v[84:87]
s_setprio 1
v_cvt_pkrtz_f16_f32 v229, v228, v229
v_and_b32 v229, s49, v229
v_mfma_f32_16x16x32_bf16 v[32:35], v[188:191], v[28:31], 0
v_bfe_u32 v228, v229, 2, 14
v_lshrrev_b32_e64 v229, 18, v229
v_mfma_f32_16x16x32_f16 v[84:87], v[48:51], v[24:27], v[84:87]
ds_read_b128 v[48:51], v251 offset:14336
ds_read_u16 v228, v228
v_mfma_f32_16x16x32_bf16 v[152:155], v[188:191], v[128:131], 0
ds_read_u16_d16_hi v229, v229
v_rcp_f16_sdwa v41, v41 dst_sel:WORD_1 dst_unused:UNUSED_PRESERVE src0_sel:WORD_1
v_mfma_f32_16x16x32_f16 v[208:211], v[120:123], v[60:63], v[236:239]
v_pk_fma_f16 v1, v0, v0, s48
v_cvt_pkrtz_f16_f32 v113, v112, v113
v_mfma_f32_16x16x32_bf16 v[80:83], v[188:191], v[136:139], 0
s_waitcnt lgkmcnt(5)
ds_read_b128 v[188:191], v248 offset:20480
v_and_b32 v113, s49, v113
v_mfma_f32_16x16x32_f16 v[212:215], v[120:123], v[56:59], v[236:239]
v_bfe_u32 v112, v113, 2, 14
v_lshrrev_b32_e64 v113, 18, v113
v_mfma_f32_16x16x32_bf16 v[32:35], v[176:179], v[36:39], v[32:35]
ds_read_u16 v112, v112
ds_read_u16_d16_hi v113, v113
v_mfma_f32_16x16x32_f16 v[236:239], v[120:123], v[24:27], v[236:239]
v_or_b32_e64 v66, v12, v13
v_pk_mul_f16 v1, v0, v1
v_cvt_pkrtz_f16_f32 v3, v2, v3
v_and_b32_e64 v3, s49, v3
v_bfe_u32 v2, v3, 2, 14
v_lshrrev_b32_e64 v3, 18, v3
v_pk_mul_f16 v90, v40, v41
ds_read_b128 v[120:123], v251 offset:17408
ds_read_u16 v2, v2
ds_read_u16_d16_hi v3, v3
v_mfma_f32_16x16x32_bf16 v[152:155], v[176:179], v[156:159], v[152:155]
v_exp_f16_sdwa v1, v1 dst_sel:WORD_0 dst_unused:UNUSED_PRESERVE src0_sel:WORD_0
v_mfma_f32_16x16x32_f16 v[8:11], v[4:7], v[60:63], v[92:95]
v_or_b32_e64 v70, v124, v125
v_cvt_pkrtz_f16_f32 v231, v230, v231
v_and_b32_e64 v231, s49, v231
v_bfe_u32 v230, v231, 2, 14
v_lshrrev_b32_e64 v231, 18, v231
v_mfma_f32_16x16x32_bf16 v[80:83], v[176:179], v[160:163], v[80:83]
ds_read_u16 v230, v230
ds_read_u16_d16_hi v231, v231
v_mfma_f32_16x16x32_f16 v[172:175], v[4:7], v[56:59], v[92:95]
ds_read_b128 v[176:179], v248 offset:22528
v_or_b32 v91, v42, v43
s_setprio 0
v_cvt_pkrtz_f16_f32 v115, v114, v115
v_and_b32_e64 v115, s49, v115
v_bfe_u32 v114, v115, 2, 14
v_lshrrev_b32 v115, 18, v115
v_mfma_f32_16x16x32_bf16 v[32:35], v[180:183], v[44:47], v[32:35]
ds_read_u16 v114, v114
s_waitcnt lgkmcnt(7)
ds_read_u16_d16_hi v115, v115
v_mfma_f32_16x16x32_f16 v[92:95], v[4:7], v[24:27], v[92:95]
v_exp_f16_sdwa v1, v1 dst_sel:WORD_1 dst_unused:UNUSED_PRESERVE src0_sel:WORD_1
v_or_b32_e64 v67, v14, v15
v_mfma_f32_16x16x32_bf16 v[152:155], v[180:183], v[144:147], v[152:155]
ds_read_b128 v[4:7], v251 offset:15360
v_or_b32_e64 v71, v126, v127
v_mfma_f32_16x16x32_f16 v[216:219], v[184:187], v[60:63], v[224:227]
v_pk_add_f16 v1, v1, 1.0 op_sel_hi:[1,0]
v_cvt_pk_f16_f32 v32, v32, v33
v_mfma_f32_16x16x32_bf16 v[80:83], v[180:183], v[148:151], v[80:83]
ds_read_b128 v[180:183], v248 offset:18688
v_rcp_f16_sdwa v1, v1 dst_sel:WORD_0 dst_unused:UNUSED_PRESERVE src0_sel:WORD_0
v_mfma_f32_16x16x32_f16 v[232:235], v[184:187], v[56:59], v[224:227]
v_cvt_pkrtz_f16_f32 v153, v152, v153
v_and_b32_e64 v153, s49, v153
v_mfma_f32_16x16x32_bf16 v[96:99], v[52:55], v[28:31], 0
v_bfe_u32 v152, v153, 2, 14
v_lshrrev_b32_e64 v153, 18, v153
v_mfma_f32_16x16x32_f16 v[224:227], v[184:187], v[24:27], v[224:227]
ds_read_b128 v[184:187], v251 offset:18432
ds_read_u16 v152, v152
v_mfma_f32_16x16x32_bf16 v[132:135], v[52:55], v[128:131], 0
ds_read_u16_d16_hi v153, v153
v_rcp_f16_sdwa v1, v1 dst_sel:WORD_1 dst_unused:UNUSED_PRESERVE src0_sel:WORD_1
v_mfma_f32_16x16x32_f16 v[116:119], v[48:51], v[68:71], v[116:119]
v_pk_fma_f16 v33, v32, v32, s48
v_cvt_pkrtz_f16_f32 v81, v80, v81
v_mfma_f32_16x16x32_bf16 v[140:143], v[52:55], v[136:139], 0
ds_read_b128 v[52:55], v248 offset:20736
v_and_b32 v81, s49, v81
v_mfma_f32_16x16x32_f16 v[240:243], v[48:51], v[64:67], v[240:243]
s_setprio 3
v_bfe_u32 v80, v81, 2, 14
v_lshrrev_b32 v81, 18, v81
v_mfma_f32_16x16x32_bf16 v[96:99], v[188:191], v[36:39], v[96:99]
ds_read_u16 v80, v80
s_waitcnt lgkmcnt(5)
ds_read_u16_d16_hi v81, v81
v_mfma_f32_16x16x32_f16 v[76:79], v[48:51], v[88:91], v[76:79]
buffer_store_dwordx4 v[244:247], v253, s[8:11], s70 offen offset:128 sc1
buffer_store_dwordx4 v[204:207], v253, s[8:11], s70 offen offset:192 sc1
v_or_b32_e64 v228, v228, v229
v_pk_mul_f16 v33, v32, v33
v_cvt_pkrtz_f16_f32 v35, v34, v35
v_and_b32_e64 v35, s49, v35
v_bfe_u32 v34, v35, 2, 14
v_lshrrev_b32_e64 v35, 18, v35
v_pk_mul_f16 v0, v0, v1
ds_read_b128 v[48:51], v251 offset:16384
ds_read_u16 v34, v34
ds_read_u16_d16_hi v35, v35
v_mfma_f32_16x16x32_bf16 v[132:135], v[188:191], v[156:159], v[132:135]
v_exp_f16_sdwa v33, v33 dst_sel:WORD_0 dst_unused:UNUSED_PRESERVE src0_sel:WORD_0
v_mfma_f32_16x16x32_f16 v[72:75], v[120:123], v[68:71], v[72:75]
v_or_b32_e64 v112, v112, v113
v_cvt_pkrtz_f16_f32 v155, v154, v155
v_and_b32_e64 v155, s49, v155
v_bfe_u32 v154, v155, 2, 14
v_lshrrev_b32_e64 v155, 18, v155
v_mfma_f32_16x16x32_bf16 v[140:143], v[188:191], v[160:163], v[140:143]
ds_read_u16 v154, v154
ds_read_u16_d16_hi v155, v155
v_mfma_f32_16x16x32_f16 v[196:199], v[120:123], v[64:67], v[196:199]
ds_read_b128 v[188:191], v248 offset:22784
v_or_b32_e64 v1, v2, v3
v_cvt_pkrtz_f16_f32 v83, v82, v83
v_and_b32_e64 v83, s49, v83
v_bfe_u32 v82, v83, 2, 14
v_lshrrev_b32_e64 v83, 18, v83
v_mfma_f32_16x16x32_bf16 v[96:99], v[176:179], v[44:47], v[96:99]
ds_read_u16 v82, v82
ds_read_u16_d16_hi v83, v83
v_mfma_f32_16x16x32_f16 v[220:223], v[120:123], v[88:91], v[220:223]
v_exp_f16_sdwa v33, v33 dst_sel:WORD_1 dst_unused:UNUSED_PRESERVE src0_sel:WORD_1
v_or_b32_e64 v229, v230, v231
v_mfma_f32_16x16x32_bf16 v[132:135], v[176:179], v[144:147], v[132:135]
ds_read_b128 v[120:123], v251 offset:19456
v_or_b32_e64 v113, v114, v115
v_mfma_f32_16x16x32_f16 v[164:167], v[4:7], v[68:71], v[164:167]
v_pk_add_f16 v33, v33, 1.0 op_sel_hi:[1,0]
v_cvt_pk_f16_f32 v96, v96, v97
v_mfma_f32_16x16x32_bf16 v[140:143], v[176:179], v[148:151], v[140:143]
s_waitcnt lgkmcnt(6)
ds_read_b128 v[176:179], v248 offset:24576
v_rcp_f16_sdwa v33, v33 dst_sel:WORD_0 dst_unused:UNUSED_PRESERVE src0_sel:WORD_0
v_mfma_f32_16x16x32_f16 v[168:171], v[4:7], v[64:67], v[168:171]
s_setprio 2
v_cvt_pkrtz_f16_f32 v133, v132, v133
v_and_b32_e64 v133, s49, v133
v_mfma_f32_16x16x32_bf16 v[40:43], v[180:183], v[28:31], 0
v_bfe_u32 v132, v133, 2, 14
v_lshrrev_b32_e64 v133, 18, v133
v_mfma_f32_16x16x32_f16 v[84:87], v[4:7], v[88:91], v[84:87]
ds_read_b128 v[4:7], v251 offset:20480
ds_read_u16 v132, v132
v_mfma_f32_16x16x32_bf16 v[12:15], v[180:183], v[128:131], 0
ds_read_u16_d16_hi v133, v133
v_rcp_f16_sdwa v33, v33 dst_sel:WORD_1 dst_unused:UNUSED_PRESERVE src0_sel:WORD_1
v_mfma_f32_16x16x32_f16 v[208:211], v[184:187], v[68:71], v[208:211]
v_pk_fma_f16 v97, v96, v96, s48
v_cvt_pkrtz_f16_f32 v141, v140, v141
v_mfma_f32_16x16x32_bf16 v[124:127], v[180:183], v[136:139], 0
ds_read_b128 v[180:183], v248 offset:26624
v_and_b32_e64 v141, s49, v141
v_mfma_f32_16x16x32_f16 v[212:215], v[184:187], v[64:67], v[212:215]
v_bfe_u32 v140, v141, 2, 14
v_lshrrev_b32_e64 v141, 18, v141
v_mfma_f32_16x16x32_bf16 v[40:43], v[52:55], v[36:39], v[40:43]
ds_read_u16 v140, v140
ds_read_u16_d16_hi v141, v141
v_mfma_f32_16x16x32_f16 v[236:239], v[184:187], v[88:91], v[236:239]
v_or_b32_e64 v230, v152, v153
v_pk_mul_f16 v97, v96, v97
v_cvt_pkrtz_f16_f32 v99, v98, v99
v_and_b32_e64 v99, s49, v99
v_bfe_u32 v98, v99, 2, 14
v_lshrrev_b32 v99, 18, v99
v_pk_mul_f16 v2, v32, v33
ds_read_b128 v[184:187], v251 offset:23552
ds_read_u16 v98, v98
s_waitcnt lgkmcnt(7)
ds_read_u16_d16_hi v99, v99
v_mfma_f32_16x16x32_bf16 v[12:15], v[52:55], v[156:159], v[12:15]
v_exp_f16_sdwa v97, v97 dst_sel:WORD_0 dst_unused:UNUSED_PRESERVE src0_sel:WORD_0
v_mfma_f32_16x16x32_f16 v[8:11], v[48:51], v[68:71], v[8:11]
v_or_b32_e64 v114, v80, v81
v_cvt_pkrtz_f16_f32 v135, v134, v135
v_and_b32_e64 v135, s49, v135
v_bfe_u32 v134, v135, 2, 14
v_lshrrev_b32_e64 v135, 18, v135
v_mfma_f32_16x16x32_bf16 v[124:127], v[52:55], v[160:163], v[124:127]
ds_read_u16 v134, v134
ds_read_u16_d16_hi v135, v135
v_mfma_f32_16x16x32_f16 v[172:175], v[48:51], v[64:67], v[172:175]
ds_read_b128 v[52:55], v248 offset:28672
v_or_b32 v3, v34, v35
s_setprio 1
v_cvt_pkrtz_f16_f32 v143, v142, v143
v_and_b32_e64 v143, s49, v143
v_bfe_u32 v142, v143, 2, 14
v_lshrrev_b32_e64 v143, 18, v143
v_mfma_f32_16x16x32_bf16 v[40:43], v[188:191], v[44:47], v[40:43]
ds_read_u16 v142, v142
ds_read_u16_d16_hi v143, v143
v_mfma_f32_16x16x32_f16 v[92:95], v[48:51], v[88:91], v[92:95]
v_exp_f16_sdwa v97, v97 dst_sel:WORD_1 dst_unused:UNUSED_PRESERVE src0_sel:WORD_1
v_or_b32_e64 v231, v154, v155
v_mfma_f32_16x16x32_bf16 v[12:15], v[188:191], v[144:147], v[12:15]
ds_read_b128 v[48:51], v251 offset:21504
v_or_b32_e64 v115, v82, v83
v_mfma_f32_16x16x32_f16 v[216:219], v[120:123], v[68:71], v[216:219]
v_pk_add_f16 v97, v97, 1.0 op_sel_hi:[1,0]
v_cvt_pk_f16_f32 v40, v40, v41
v_mfma_f32_16x16x32_bf16 v[124:127], v[188:191], v[148:151], v[124:127]
ds_read_b128 v[188:191], v248 offset:24832
v_rcp_f16_sdwa v97, v97 dst_sel:WORD_0 dst_unused:UNUSED_PRESERVE src0_sel:WORD_0
v_mfma_f32_16x16x32_f16 v[232:235], v[120:123], v[64:67], v[232:235]
v_cvt_pkrtz_f16_f32 v13, v12, v13
v_and_b32_e64 v13, s49, v13
v_mfma_f32_16x16x32_bf16 v[24:27], v[176:179], v[28:31], 0
v_bfe_u32 v12, v13, 2, 14
v_lshrrev_b32 v13, 18, v13
v_mfma_f32_16x16x32_f16 v[224:227], v[120:123], v[88:91], v[224:227]
s_waitcnt lgkmcnt(4)
ds_read_b128 v[120:123], v251 offset:24576
ds_read_u16 v12, v12
v_mfma_f32_16x16x32_bf16 v[56:59], v[176:179], v[128:131], 0
ds_read_u16_d16_hi v13, v13
v_rcp_f16_sdwa v97, v97 dst_sel:WORD_1 dst_unused:UNUSED_PRESERVE src0_sel:WORD_1
v_mfma_f32_16x16x32_f16 v[116:119], v[4:7], v[112:115], v[116:119]
v_pk_fma_f16 v41, v40, v40, s48
v_cvt_pkrtz_f16_f32 v125, v124, v125
v_mfma_f32_16x16x32_bf16 v[60:63], v[176:179], v[136:139], 0
ds_read_b128 v[176:179], v248 offset:26880
v_and_b32 v125, s49, v125
v_mfma_f32_16x16x32_f16 v[240:243], v[4:7], v[228:231], v[240:243]
s_setprio 0
v_bfe_u32 v124, v125, 2, 14
v_lshrrev_b32_e64 v125, 18, v125
v_mfma_f32_16x16x32_bf16 v[24:27], v[180:183], v[36:39], v[24:27]
ds_read_u16 v124, v124
ds_read_u16_d16_hi v125, v125
v_mfma_f32_16x16x32_f16 v[76:79], v[4:7], v[0:3], v[76:79]
v_or_b32_e64 v132, v132, v133
v_pk_mul_f16 v41, v40, v41
v_cvt_pkrtz_f16_f32 v43, v42, v43
v_and_b32_e64 v43, s49, v43
v_bfe_u32 v42, v43, 2, 14
v_lshrrev_b32_e64 v43, 18, v43
v_pk_mul_f16 v96, v96, v97
ds_read_b128 v[4:7], v251 offset:22528
ds_read_u16 v42, v42
ds_read_u16_d16_hi v43, v43
v_mfma_f32_16x16x32_bf16 v[56:59], v[180:183], v[156:159], v[56:59]
v_exp_f16_sdwa v41, v41 dst_sel:WORD_0 dst_unused:UNUSED_PRESERVE src0_sel:WORD_0
v_mfma_f32_16x16x32_f16 v[72:75], v[184:187], v[112:115], v[72:75]
buffer_store_dwordx4 v[104:107], v253, s[8:11], s70 offen offset:256 sc1
buffer_store_dwordx4 v[192:195], v253, s[8:11], s70 offen offset:320 sc1
v_or_b32_e64 v140, v140, v141
v_cvt_pkrtz_f16_f32 v15, v14, v15
v_and_b32_e64 v15, s49, v15
v_bfe_u32 v14, v15, 2, 14
v_lshrrev_b32_e64 v15, 18, v15
v_mfma_f32_16x16x32_bf16 v[60:63], v[180:183], v[160:163], v[60:63]
ds_read_u16 v14, v14
ds_read_u16_d16_hi v15, v15
v_mfma_f32_16x16x32_f16 v[196:199], v[184:187], v[228:231], v[196:199]
s_waitcnt lgkmcnt(6)
ds_read_b128 v[180:183], v248 offset:28928
v_or_b32 v97, v98, v99
v_cvt_pkrtz_f16_f32 v127, v126, v127
v_and_b32_e64 v127, s49, v127
v_bfe_u32 v126, v127, 2, 14
v_lshrrev_b32_e64 v127, 18, v127
v_mfma_f32_16x16x32_bf16 v[24:27], v[52:55], v[44:47], v[24:27]
ds_read_u16 v126, v126
ds_read_u16_d16_hi v127, v127
v_mfma_f32_16x16x32_f16 v[220:223], v[184:187], v[0:3], v[220:223]
v_exp_f16_sdwa v41, v41 dst_sel:WORD_1 dst_unused:UNUSED_PRESERVE src0_sel:WORD_1
v_or_b32_e64 v133, v134, v135
v_mfma_f32_16x16x32_bf16 v[56:59], v[52:55], v[144:147], v[56:59]
ds_read_b128 v[184:187], v251 offset:25600
v_or_b32_e64 v141, v142, v143
v_mfma_f32_16x16x32_f16 v[164:167], v[48:51], v[112:115], v[164:167]
v_pk_add_f16 v41, v41, 1.0 op_sel_hi:[1,0]
v_cvt_pk_f16_f32 v24, v24, v25
v_mfma_f32_16x16x32_bf16 v[60:63], v[52:55], v[148:151], v[60:63]
ds_read_b128 v[52:55], v248 offset:30720
v_rcp_f16_sdwa v41, v41 dst_sel:WORD_0 dst_unused:UNUSED_PRESERVE src0_sel:WORD_0
v_mfma_f32_16x16x32_f16 v[168:171], v[48:51], v[228:231], v[168:171]
s_setprio 3
v_cvt_pkrtz_f16_f32 v57, v56, v57
v_and_b32 v57, s49, v57
v_mfma_f32_16x16x32_bf16 v[244:247], v[188:191], v[28:31], 0
v_bfe_u32 v56, v57, 2, 14
v_lshrrev_b32_e64 v57, 18, v57
v_mfma_f32_16x16x32_f16 v[84:87], v[48:51], v[0:3], v[84:87]
ds_read_b128 v[48:51], v251 offset:26624
ds_read_u16 v56, v56
v_mfma_f32_16x16x32_bf16 v[204:207], v[188:191], v[128:131], 0
ds_read_u16_d16_hi v57, v57
v_rcp_f16_sdwa v41, v41 dst_sel:WORD_1 dst_unused:UNUSED_PRESERVE src0_sel:WORD_1
v_mfma_f32_16x16x32_f16 v[208:211], v[120:123], v[112:115], v[208:211]
v_pk_fma_f16 v25, v24, v24, s48
v_cvt_pkrtz_f16_f32 v61, v60, v61
v_mfma_f32_16x16x32_bf16 v[32:35], v[188:191], v[136:139], 0
ds_read_b128 v[188:191], v248 offset:32768
v_and_b32_e64 v61, s49, v61
v_mfma_f32_16x16x32_f16 v[212:215], v[120:123], v[228:231], v[212:215]
v_bfe_u32 v60, v61, 2, 14
v_lshrrev_b32 v61, 18, v61
v_mfma_f32_16x16x32_bf16 v[244:247], v[176:179], v[36:39], v[244:247]
s_waitcnt lgkmcnt(4)
ds_read_u16 v60, v60
ds_read_u16_d16_hi v61, v61
v_mfma_f32_16x16x32_f16 v[236:239], v[120:123], v[0:3], v[236:239]
v_or_b32_e64 v134, v12, v13
v_pk_mul_f16 v25, v24, v25
v_cvt_pkrtz_f16_f32 v27, v26, v27
v_and_b32_e64 v27, s49, v27
v_bfe_u32 v26, v27, 2, 14
v_lshrrev_b32_e64 v27, 18, v27
v_pk_mul_f16 v98, v40, v41
ds_read_b128 v[120:123], v251 offset:29696
ds_read_u16 v26, v26
ds_read_u16_d16_hi v27, v27
v_mfma_f32_16x16x32_bf16 v[204:207], v[176:179], v[156:159], v[204:207]
buffer_load_dwordx4 v[152:155], v253, s[4:7], s69 offen offset:192
v_exp_f16_sdwa v25, v25 dst_sel:WORD_0 dst_unused:UNUSED_PRESERVE src0_sel:WORD_0
v_mfma_f32_16x16x32_f16 v[8:11], v[4:7], v[112:115], v[8:11]
v_or_b32_e64 v142, v124, v125
v_cvt_pkrtz_f16_f32 v59, v58, v59
v_and_b32_e64 v59, s49, v59
v_bfe_u32 v58, v59, 2, 14
v_lshrrev_b32_e64 v59, 18, v59
v_mfma_f32_16x16x32_bf16 v[32:35], v[176:179], v[160:163], v[32:35]
ds_read_u16 v58, v58
ds_read_u16_d16_hi v59, v59
v_mfma_f32_16x16x32_f16 v[172:175], v[4:7], v[228:231], v[172:175]
ds_read_b128 v[176:179], v248 offset:34816
v_or_b32 v99, v42, v43
s_setprio 2
v_cvt_pkrtz_f16_f32 v63, v62, v63
v_and_b32_e64 v63, s49, v63
v_bfe_u32 v62, v63, 2, 14
v_lshrrev_b32_e64 v63, 18, v63
v_mfma_f32_16x16x32_bf16 v[244:247], v[180:183], v[44:47], v[244:247]
ds_read_u16 v62, v62
ds_read_u16_d16_hi v63, v63
v_mfma_f32_16x16x32_f16 v[92:95], v[4:7], v[0:3], v[92:95]
v_exp_f16_sdwa v25, v25 dst_sel:WORD_1 dst_unused:UNUSED_PRESERVE src0_sel:WORD_1
v_or_b32_e64 v135, v14, v15
v_mfma_f32_16x16x32_bf16 v[204:207], v[180:183], v[144:147], v[204:207]
ds_read_b128 v[4:7], v251 offset:27648
v_or_b32 v143, v126, v127
v_mfma_f32_16x16x32_f16 v[216:219], v[184:187], v[112:115], v[216:219]
v_pk_add_f16 v25, v25, 1.0 op_sel_hi:[1,0]
v_cvt_pk_f16_f32 v244, v244, v245
v_mfma_f32_16x16x32_bf16 v[32:35], v[180:183], v[148:151], v[32:35]
s_waitcnt lgkmcnt(6)
ds_read_b128 v[180:183], v248 offset:30976
v_rcp_f16_sdwa v25, v25 dst_sel:WORD_0 dst_unused:UNUSED_PRESERVE src0_sel:WORD_0
v_mfma_f32_16x16x32_f16 v[232:235], v[184:187], v[228:231], v[232:235]
v_cvt_pkrtz_f16_f32 v205, v204, v205
v_and_b32_e64 v205, s49, v205
v_mfma_f32_16x16x32_bf16 v[80:83], v[52:55], v[28:31], 0
v_bfe_u32 v204, v205, 2, 14
v_lshrrev_b32_e64 v205, 18, v205
v_mfma_f32_16x16x32_f16 v[224:227], v[184:187], v[0:3], v[224:227]
ds_read_b128 v[184:187], v251 offset:30720
ds_read_u16 v204, v204
v_mfma_f32_16x16x32_bf16 v[88:91], v[52:55], v[128:131], 0
ds_read_u16_d16_hi v205, v205
v_rcp_f16_sdwa v25, v25 dst_sel:WORD_1 dst_unused:UNUSED_PRESERVE src0_sel:WORD_1
v_mfma_f32_16x16x32_f16 v[116:119], v[48:51], v[140:143], v[116:119]
v_pk_fma_f16 v245, v244, v244, s48
v_cvt_pkrtz_f16_f32 v33, v32, v33
v_mfma_f32_16x16x32_bf16 v[64:67], v[52:55], v[136:139], 0
ds_read_b128 v[52:55], v248 offset:33024
v_and_b32 v33, s49, v33
v_mfma_f32_16x16x32_f16 v[240:243], v[48:51], v[132:135], v[240:243]
s_setprio 1
v_bfe_u32 v32, v33, 2, 14
v_lshrrev_b32_e64 v33, 18, v33
v_mfma_f32_16x16x32_bf16 v[80:83], v[188:191], v[36:39], v[80:83]
ds_read_u16 v32, v32
ds_read_u16_d16_hi v33, v33
v_mfma_f32_16x16x32_f16 v[76:79], v[48:51], v[96:99], v[76:79]
v_or_b32_e64 v56, v56, v57
v_pk_mul_f16 v245, v244, v245
v_cvt_pkrtz_f16_f32 v247, v246, v247
v_and_b32_e64 v247, s49, v247
v_bfe_u32 v246, v247, 2, 14
v_lshrrev_b32 v247, 18, v247
v_pk_mul_f16 v24, v24, v25
ds_read_b128 v[48:51], v251 offset:28672
ds_read_u16 v246, v246
s_waitcnt lgkmcnt(7)
ds_read_u16_d16_hi v247, v247
v_mfma_f32_16x16x32_bf16 v[88:91], v[188:191], v[156:159], v[88:91]
v_exp_f16_sdwa v245, v245 dst_sel:WORD_0 dst_unused:UNUSED_PRESERVE src0_sel:WORD_0
v_mfma_f32_16x16x32_f16 v[72:75], v[120:123], v[140:143], v[72:75]
v_or_b32_e64 v60, v60, v61
v_cvt_pkrtz_f16_f32 v207, v206, v207
v_and_b32_e64 v207, s49, v207
v_bfe_u32 v206, v207, 2, 14
v_lshrrev_b32_e64 v207, 18, v207
v_mfma_f32_16x16x32_bf16 v[64:67], v[188:191], v[160:163], v[64:67]
ds_read_u16 v206, v206
ds_read_u16_d16_hi v207, v207
v_mfma_f32_16x16x32_f16 v[196:199], v[120:123], v[132:135], v[196:199]
ds_read_b128 v[188:191], v248 offset:35072
v_or_b32_e64 v25, v26, v27
buffer_store_dwordx4 v[200:203], v253, s[8:11], s69 offen sc1
buffer_store_dwordx4 v[100:103], v253, s[8:11], s69 offen offset:64 sc1
v_cvt_pkrtz_f16_f32 v35, v34, v35
v_and_b32_e64 v35, s49, v35
v_bfe_u32 v34, v35, 2, 14
v_lshrrev_b32_e64 v35, 18, v35
v_mfma_f32_16x16x32_bf16 v[80:83], v[176:179], v[44:47], v[80:83]
ds_read_u16 v34, v34
ds_read_u16_d16_hi v35, v35
v_mfma_f32_16x16x32_f16 v[220:223], v[120:123], v[96:99], v[220:223]
v_exp_f16_sdwa v245, v245 dst_sel:WORD_1 dst_unused:UNUSED_PRESERVE src0_sel:WORD_1
v_or_b32_e64 v57, v58, v59
v_mfma_f32_16x16x32_bf16 v[88:91], v[176:179], v[144:147], v[88:91]
ds_read_b128 v[120:123], v251 offset:31744
v_or_b32_e64 v61, v62, v63
v_mfma_f32_16x16x32_f16 v[164:167], v[4:7], v[140:143], v[164:167]
v_pk_add_f16 v245, v245, 1.0 op_sel_hi:[1,0]
v_cvt_pk_f16_f32 v80, v80, v81
v_mfma_f32_16x16x32_bf16 v[64:67], v[176:179], v[148:151], v[64:67]
ds_read_b128 v[176:179], v249
v_rcp_f16_sdwa v245, v245 dst_sel:WORD_0 dst_unused:UNUSED_PRESERVE src0_sel:WORD_0
v_mfma_f32_16x16x32_f16 v[168:171], v[4:7], v[132:135], v[168:171]
s_setprio 0
v_cvt_pkrtz_f16_f32 v89, v88, v89
v_and_b32 v89, s49, v89
v_mfma_f32_16x16x32_bf16 v[68:71], v[180:183], v[28:31], 0
v_bfe_u32 v88, v89, 2, 14
v_lshrrev_b32 v89, 18, v89
v_mfma_f32_16x16x32_f16 v[84:87], v[4:7], v[96:99], v[84:87]
s_waitcnt lgkmcnt(4)
ds_read_b128 v[4:7], v251 offset:32768
ds_read_u16 v88, v88
v_mfma_f32_16x16x32_bf16 v[104:107], v[180:183], v[128:131], 0
ds_read_u16_d16_hi v89, v89
v_rcp_f16_sdwa v245, v245 dst_sel:WORD_1 dst_unused:UNUSED_PRESERVE src0_sel:WORD_1
v_mfma_f32_16x16x32_f16 v[208:211], v[184:187], v[140:143], v[208:211]
v_pk_fma_f16 v81, v80, v80, s48
v_cvt_pkrtz_f16_f32 v65, v64, v65
v_mfma_f32_16x16x32_bf16 v[192:195], v[180:183], v[136:139], 0
ds_read_b128 v[180:183], v249 offset:2048
v_and_b32_e64 v65, s49, v65
v_mfma_f32_16x16x32_f16 v[212:215], v[184:187], v[132:135], v[212:215]
v_bfe_u32 v64, v65, 2, 14
v_lshrrev_b32_e64 v65, 18, v65
v_mfma_f32_16x16x32_bf16 v[68:71], v[52:55], v[36:39], v[68:71]
ds_read_u16 v64, v64
ds_read_u16_d16_hi v65, v65
v_mfma_f32_16x16x32_f16 v[236:239], v[184:187], v[96:99], v[236:239]
v_or_b32_e64 v58, v204, v205
v_pk_mul_f16 v81, v80, v81
v_cvt_pkrtz_f16_f32 v83, v82, v83
v_and_b32_e64 v83, s49, v83
v_bfe_u32 v82, v83, 2, 14
v_lshrrev_b32_e64 v83, 18, v83
v_pk_mul_f16 v26, v244, v245
ds_read_b128 v[184:187], v251 offset:35840
ds_read_u16 v82, v82
ds_read_u16_d16_hi v83, v83
v_mfma_f32_16x16x32_bf16 v[104:107], v[52:55], v[156:159], v[104:107]
buffer_load_dwordx4 v[40:43], v253, s[4:7], s69 offen offset:256
buffer_load_dwordx4 v[12:15], v253, s[4:7], s69 offen offset:320
v_exp_f16_sdwa v81, v81 dst_sel:WORD_0 dst_unused:UNUSED_PRESERVE src0_sel:WORD_0
v_mfma_f32_16x16x32_f16 v[8:11], v[48:51], v[140:143], v[8:11]
v_or_b32_e64 v62, v32, v33
v_cvt_pkrtz_f16_f32 v91, v90, v91
v_and_b32_e64 v91, s49, v91
v_bfe_u32 v90, v91, 2, 14
v_lshrrev_b32_e64 v91, 18, v91
v_mfma_f32_16x16x32_bf16 v[192:195], v[52:55], v[160:163], v[192:195]
ds_read_u16 v90, v90
ds_read_u16_d16_hi v91, v91
v_mfma_f32_16x16x32_f16 v[172:175], v[48:51], v[132:135], v[172:175]
s_waitcnt lgkmcnt(6)
ds_read_b128 v[52:55], v249 offset:4096
v_or_b32 v27, v246, v247
s_setprio 3
v_cvt_pkrtz_f16_f32 v67, v66, v67
v_and_b32 v67, s49, v67
v_bfe_u32 v66, v67, 2, 14
v_lshrrev_b32_e64 v67, 18, v67
v_mfma_f32_16x16x32_bf16 v[68:71], v[188:191], v[44:47], v[68:71]
ds_read_u16 v66, v66
ds_read_u16_d16_hi v67, v67
v_mfma_f32_16x16x32_f16 v[92:95], v[48:51], v[96:99], v[92:95]
v_exp_f16_sdwa v81, v81 dst_sel:WORD_1 dst_unused:UNUSED_PRESERVE src0_sel:WORD_1
v_or_b32_e64 v59, v206, v207
v_mfma_f32_16x16x32_bf16 v[104:107], v[188:191], v[144:147], v[104:107]
ds_read_b128 v[48:51], v251 offset:33792
v_or_b32_e64 v63, v34, v35
v_mfma_f32_16x16x32_f16 v[216:219], v[120:123], v[140:143], v[216:219]
v_pk_add_f16 v81, v81, 1.0 op_sel_hi:[1,0]
v_cvt_pk_f16_f32 v68, v68, v69
v_mfma_f32_16x16x32_bf16 v[192:195], v[188:191], v[148:151], v[192:195]
ds_read_b128 v[188:191], v249 offset:256
v_rcp_f16_sdwa v81, v81 dst_sel:WORD_0 dst_unused:UNUSED_PRESERVE src0_sel:WORD_0
v_mfma_f32_16x16x32_f16 v[232:235], v[120:123], v[132:135], v[232:235]
v_cvt_pkrtz_f16_f32 v105, v104, v105
v_and_b32_e64 v105, s49, v105
v_mfma_f32_16x16x32_bf16 v[124:127], v[176:179], v[28:31], 0
v_bfe_u32 v104, v105, 2, 14
v_lshrrev_b32_e64 v105, 18, v105
v_mfma_f32_16x16x32_f16 v[224:227], v[120:123], v[96:99], v[224:227]
ds_read_b128 v[120:123], v251 offset:36864
ds_read_u16 v104, v104
v_mfma_f32_16x16x32_bf16 v[0:3], v[176:179], v[128:131], 0
ds_read_u16_d16_hi v105, v105
v_rcp_f16_sdwa v81, v81 dst_sel:WORD_1 dst_unused:UNUSED_PRESERVE src0_sel:WORD_1
v_mfma_f32_16x16x32_f16 v[116:119], v[4:7], v[60:63], v[116:119]
v_pk_fma_f16 v69, v68, v68, s48
v_cvt_pkrtz_f16_f32 v193, v192, v193
v_mfma_f32_16x16x32_bf16 v[228:231], v[176:179], v[136:139], 0
ds_read_b128 v[176:179], v249 offset:2304
v_and_b32 v193, s49, v193
v_mfma_f32_16x16x32_f16 v[240:243], v[4:7], v[56:59], v[240:243]
s_setprio 2
v_bfe_u32 v192, v193, 2, 14
v_lshrrev_b32 v193, 18, v193
v_mfma_f32_16x16x32_bf16 v[124:127], v[180:183], v[36:39], v[124:127]
s_waitcnt lgkmcnt(4)
ds_read_u16 v192, v192
ds_read_u16_d16_hi v193, v193
v_mfma_f32_16x16x32_f16 v[76:79], v[4:7], v[24:27], v[76:79]
v_or_b32_e64 v88, v88, v89
v_pk_mul_f16 v69, v68, v69
v_cvt_pkrtz_f16_f32 v71, v70, v71
v_and_b32_e64 v71, s49, v71
v_bfe_u32 v70, v71, 2, 14
v_lshrrev_b32_e64 v71, 18, v71
v_pk_mul_f16 v80, v80, v81
ds_read_b128 v[4:7], v251 offset:34816
ds_read_u16 v70, v70
ds_read_u16_d16_hi v71, v71
v_mfma_f32_16x16x32_bf16 v[0:3], v[180:183], v[156:159], v[0:3]
v_exp_f16_sdwa v69, v69 dst_sel:WORD_0 dst_unused:UNUSED_PRESERVE src0_sel:WORD_0
v_mfma_f32_16x16x32_f16 v[72:75], v[184:187], v[60:63], v[72:75]
v_or_b32_e64 v64, v64, v65
v_cvt_pkrtz_f16_f32 v107, v106, v107
v_and_b32_e64 v107, s49, v107
v_bfe_u32 v106, v107, 2, 14
v_lshrrev_b32_e64 v107, 18, v107
v_mfma_f32_16x16x32_bf16 v[228:231], v[180:183], v[160:163], v[228:231]
ds_read_u16 v106, v106
ds_read_u16_d16_hi v107, v107
v_mfma_f32_16x16x32_f16 v[196:199], v[184:187], v[56:59], v[196:199]
ds_read_b128 v[180:183], v249 offset:4352
v_or_b32_e64 v81, v82, v83
v_cvt_pkrtz_f16_f32 v195, v194, v195
v_and_b32_e64 v195, s49, v195
v_bfe_u32 v194, v195, 2, 14
v_lshrrev_b32_e64 v195, 18, v195
v_mfma_f32_16x16x32_bf16 v[124:127], v[52:55], v[44:47], v[124:127]
ds_read_u16 v194, v194
ds_read_u16_d16_hi v195, v195
v_mfma_f32_16x16x32_f16 v[220:223], v[184:187], v[24:27], v[220:223]
v_exp_f16_sdwa v69, v69 dst_sel:WORD_1 dst_unused:UNUSED_PRESERVE src0_sel:WORD_1
v_or_b32_e64 v89, v90, v91
v_mfma_f32_16x16x32_bf16 v[0:3], v[52:55], v[144:147], v[0:3]
ds_read_b128 v[184:187], v251 offset:37888
buffer_store_dwordx4 v[108:111], v253, s[8:11], s69 offen offset:128 sc1
v_or_b32_e64 v65, v66, v67
v_mfma_f32_16x16x32_f16 v[164:167], v[48:51], v[60:63], v[164:167]
v_pk_add_f16 v69, v69, 1.0 op_sel_hi:[1,0]
v_cvt_pk_f16_f32 v124, v124, v125
v_mfma_f32_16x16x32_bf16 v[228:231], v[52:55], v[148:151], v[228:231]
s_waitcnt lgkmcnt(6)
ds_read_b128 v[52:55], v249 offset:6144
v_rcp_f16_sdwa v69, v69 dst_sel:WORD_0 dst_unused:UNUSED_PRESERVE src0_sel:WORD_0
v_mfma_f32_16x16x32_f16 v[168:171], v[48:51], v[56:59], v[168:171]
s_setprio 1
v_cvt_pkrtz_f16_f32 v1, v0, v1
v_and_b32_e64 v1, s49, v1
v_mfma_f32_16x16x32_bf16 v[112:115], v[188:191], v[28:31], 0
v_bfe_u32 v0, v1, 2, 14
v_lshrrev_b32_e64 v1, 18, v1
v_mfma_f32_16x16x32_f16 v[84:87], v[48:51], v[24:27], v[84:87]
ds_read_b128 v[48:51], v251 offset:38912
ds_read_u16 v0, v0
v_mfma_f32_16x16x32_bf16 v[200:203], v[188:191], v[128:131], 0
ds_read_u16_d16_hi v1, v1
v_rcp_f16_sdwa v69, v69 dst_sel:WORD_1 dst_unused:UNUSED_PRESERVE src0_sel:WORD_1
v_mfma_f32_16x16x32_f16 v[208:211], v[120:123], v[60:63], v[208:211]
v_pk_fma_f16 v125, v124, v124, s48
v_cvt_pkrtz_f16_f32 v229, v228, v229
v_mfma_f32_16x16x32_bf16 v[100:103], v[188:191], v[136:139], 0
ds_read_b128 v[188:191], v249 offset:8192
v_and_b32_e64 v229, s49, v229
v_mfma_f32_16x16x32_f16 v[212:215], v[120:123], v[56:59], v[212:215]
v_bfe_u32 v228, v229, 2, 14
v_lshrrev_b32_e64 v229, 18, v229
v_mfma_f32_16x16x32_bf16 v[112:115], v[176:179], v[36:39], v[112:115]
ds_read_u16 v228, v228
ds_read_u16_d16_hi v229, v229
v_mfma_f32_16x16x32_f16 v[236:239], v[120:123], v[24:27], v[236:239]
v_or_b32_e64 v90, v104, v105
v_pk_mul_f16 v125, v124, v125
v_cvt_pkrtz_f16_f32 v127, v126, v127
v_and_b32_e64 v127, s49, v127
v_bfe_u32 v126, v127, 2, 14
v_lshrrev_b32 v127, 18, v127
v_pk_mul_f16 v82, v68, v69
ds_read_b128 v[120:123], v251 offset:41984
ds_read_u16 v126, v126
s_waitcnt lgkmcnt(7)
ds_read_u16_d16_hi v127, v127
v_mfma_f32_16x16x32_bf16 v[200:203], v[176:179], v[156:159], v[200:203]
buffer_load_dwordx4 v[244:247], v253, s[4:7], s68 offen
buffer_load_dwordx4 v[204:207], v253, s[4:7], s68 offen offset:64
v_exp_f16_sdwa v125, v125 dst_sel:WORD_0 dst_unused:UNUSED_PRESERVE src0_sel:WORD_0
v_mfma_f32_16x16x32_f16 v[8:11], v[4:7], v[60:63], v[8:11]
v_or_b32_e64 v66, v192, v193
v_cvt_pkrtz_f16_f32 v3, v2, v3
v_and_b32_e64 v3, s49, v3
v_bfe_u32 v2, v3, 2, 14
v_lshrrev_b32_e64 v3, 18, v3
v_mfma_f32_16x16x32_bf16 v[100:103], v[176:179], v[160:163], v[100:103]
ds_read_u16 v2, v2
ds_read_u16_d16_hi v3, v3
v_mfma_f32_16x16x32_f16 v[172:175], v[4:7], v[56:59], v[172:175]
ds_read_b128 v[176:179], v249 offset:10240
s_setprio 0
v_or_b32 v83, v70, v71
v_cvt_pkrtz_f16_f32 v231, v230, v231
v_and_b32_e64 v231, s49, v231
v_bfe_u32 v230, v231, 2, 14
v_lshrrev_b32_e64 v231, 18, v231
v_mfma_f32_16x16x32_bf16 v[112:115], v[180:183], v[44:47], v[112:115]
ds_read_u16 v230, v230
ds_read_u16_d16_hi v231, v231
v_mfma_f32_16x16x32_f16 v[92:95], v[4:7], v[24:27], v[92:95]
v_exp_f16_sdwa v125, v125 dst_sel:WORD_1 dst_unused:UNUSED_PRESERVE src0_sel:WORD_1
v_or_b32_e64 v91, v106, v107
v_mfma_f32_16x16x32_bf16 v[200:203], v[180:183], v[144:147], v[200:203]
ds_read_b128 v[4:7], v251 offset:39936
v_or_b32_e64 v67, v194, v195
v_mfma_f32_16x16x32_f16 v[216:219], v[184:187], v[60:63], v[216:219]
v_pk_add_f16 v125, v125, 1.0 op_sel_hi:[1,0]
v_cvt_pkrtz_f16_f32 v113, v112, v113
v_mfma_f32_16x16x32_bf16 v[100:103], v[180:183], v[148:151], v[100:103]
ds_read_b128 v[180:183], v249 offset:6400
v_rcp_f16_sdwa v125, v125 dst_sel:WORD_0 dst_unused:UNUSED_PRESERVE src0_sel:WORD_0
v_mfma_f32_16x16x32_f16 v[232:235], v[184:187], v[56:59], v[232:235]
v_and_b32_e64 v113, s49, v113
v_bfe_u32 v112, v113, 2, 14
v_mfma_f32_16x16x32_bf16 v[32:35], v[52:55], v[28:31], 0
v_lshrrev_b32 v113, 18, v113
v_rcp_f16_sdwa v125, v125 dst_sel:WORD_1 dst_unused:UNUSED_PRESERVE src0_sel:WORD_1
v_mfma_f32_16x16x32_f16 v[224:227], v[184:187], v[24:27], v[224:227]
s_waitcnt lgkmcnt(4)
ds_read_b128 v[184:187], v251 offset:43008
ds_read_u16 v112, v112
v_mfma_f32_16x16x32_bf16 v[96:99], v[52:55], v[128:131], 0
ds_read_u16_d16_hi v113, v113
v_cvt_pkrtz_f16_f32 v201, v200, v201
v_mfma_f32_16x16x32_f16 v[116:119], v[48:51], v[64:67], v[116:119]
v_and_b32_e64 v201, s49, v201
v_bfe_u32 v200, v201, 2, 14
v_mfma_f32_16x16x32_bf16 v[132:135], v[52:55], v[136:139], 0
ds_read_b128 v[52:55], v249 offset:8448
v_lshrrev_b32 v201, 18, v201
v_mfma_f32_16x16x32_f16 v[240:243], v[48:51], v[88:91], v[240:243]
s_setprio 3
ds_read_u16 v200, v200
ds_read_u16_d16_hi v201, v201
v_mfma_f32_16x16x32_bf16 v[32:35], v[188:191], v[36:39], v[32:35]
v_cvt_pkrtz_f16_f32 v101, v100, v101
v_and_b32_e64 v101, s49, v101
v_mfma_f32_16x16x32_f16 v[76:79], v[48:51], v[80:83], v[76:79]
v_bfe_u32 v100, v101, 2, 14
v_lshrrev_b32 v101, 18, v101
v_or_b32 v0, v0, v1
v_pk_mul_f16 v124, v124, v125
v_mfma_f32_16x16x32_bf16 v[96:99], v[188:191], v[156:159], v[96:99]
ds_read_u16 v100, v100
ds_read_u16_d16_hi v101, v101
ds_read_b128 v[48:51], v251 offset:40960
v_mfma_f32_16x16x32_f16 v[72:75], v[120:123], v[64:67], v[72:75]
v_cvt_pkrtz_f16_f32 v115, v114, v115
v_and_b32_e64 v115, s49, v115
v_bfe_u32 v114, v115, 2, 14
v_lshrrev_b32 v115, 18, v115
v_or_b32 v228, v228, v229
v_mfma_f32_16x16x32_bf16 v[132:135], v[188:191], v[160:163], v[132:135]
ds_read_u16 v114, v114
ds_read_u16_d16_hi v115, v115
v_cvt_pkrtz_f16_f32 v203, v202, v203
v_and_b32_e64 v203, s49, v203
v_bfe_u32 v202, v203, 2, 14
v_lshrrev_b32 v203, 18, v203
v_mfma_f32_16x16x32_f16 v[196:199], v[120:123], v[88:91], v[196:199]
s_waitcnt lgkmcnt(7)
ds_read_u16 v202, v202
ds_read_u16_d16_hi v203, v203
ds_read_b128 v[188:191], v249 offset:10496
v_or_b32_e64 v125, v126, v127
v_cvt_pkrtz_f16_f32 v103, v102, v103
v_and_b32_e64 v103, s49, v103
v_bfe_u32 v102, v103, 2, 14
v_lshrrev_b32_e64 v103, 18, v103
v_mfma_f32_16x16x32_bf16 v[32:35], v[176:179], v[44:47], v[32:35]
ds_read_u16 v102, v102
ds_read_u16_d16_hi v103, v103
v_mfma_f32_16x16x32_f16 v[220:223], v[120:123], v[80:83], v[220:223]
v_or_b32_e64 v1, v2, v3
v_or_b32 v229, v230, v231
v_mfma_f32_16x16x32_bf16 v[96:99], v[176:179], v[144:147], v[96:99]
ds_read_b128 v[120:123], v251 offset:44032
s_nop 0
v_cvt_pk_f16_f32 v32, v32, v33
v_mfma_f32_16x16x32_f16 v[164:167], v[4:7], v[64:67], v[164:167]
v_pk_fma_f16 v33, v32, v32, s48
v_or_b32_e64 v126, v112, v113
v_mfma_f32_16x16x32_bf16 v[132:135], v[176:179], v[148:151], v[132:135]
ds_read_b128 v[176:179], v249 offset:12288
v_cvt_pkrtz_f16_f32 v97, v96, v97
v_mfma_f32_16x16x32_f16 v[168:171], v[4:7], v[88:91], v[168:171]
s_setprio 2
v_and_b32 v97, s49, v97
v_bfe_u32 v96, v97, 2, 14
v_mfma_f32_16x16x32_bf16 v[140:143], v[180:183], v[28:31], 0
v_lshrrev_b32 v97, 18, v97
v_cvt_pkrtz_f16_f32 v133, v132, v133
v_mfma_f32_16x16x32_f16 v[84:87], v[4:7], v[80:83], v[84:87]
ds_read_b128 v[4:7], v251 offset:45056
s_waitcnt lgkmcnt(8)
ds_read_u16 v96, v96
v_mfma_f32_16x16x32_bf16 v[108:111], v[180:183], v[128:131], 0
ds_read_u16_d16_hi v97, v97
v_and_b32_e64 v133, s49, v133
v_mfma_f32_16x16x32_f16 v[208:211], v[184:187], v[64:67], v[208:211]
v_bfe_u32 v132, v133, 2, 14
v_lshrrev_b32_e64 v133, 18, v133
v_mfma_f32_16x16x32_bf16 v[68:71], v[180:183], v[136:139], 0
ds_read_b128 v[180:183], v249 offset:14336
ds_read_u16 v132, v132
v_mfma_f32_16x16x32_f16 v[212:215], v[184:187], v[88:91], v[212:215]
ds_read_u16_d16_hi v133, v133
v_pk_mul_f16 v33, v32, v33
v_mfma_f32_16x16x32_bf16 v[140:143], v[52:55], v[36:39], v[140:143]
v_cvt_pkrtz_f16_f32 v35, v34, v35
v_and_b32_e64 v35, s49, v35
v_mfma_f32_16x16x32_f16 v[236:239], v[184:187], v[80:83], v[236:239]
ds_read_b128 v[184:187], v251 offset:48128
v_bfe_u32 v34, v35, 2, 14
v_lshrrev_b32 v35, 18, v35
v_mfma_f32_16x16x32_bf16 v[108:111], v[52:55], v[156:159], v[108:111]
ds_read_u16 v34, v34
s_waitcnt lgkmcnt(9)
ds_read_u16_d16_hi v35, v35
buffer_load_dwordx4 v[104:107], v253, s[4:7], s68 offen offset:128
buffer_load_dwordx4 v[192:195], v253, s[4:7], s68 offen offset:192
v_mfma_f32_16x16x32_f16 v[8:11], v[48:51], v[64:67], v[8:11]
v_or_b32_e64 v2, v200, v201
v_exp_f16_sdwa v33, v33 dst_sel:WORD_0 dst_unused:UNUSED_PRESERVE src0_sel:WORD_0
v_cvt_pkrtz_f16_f32 v99, v98, v99
v_and_b32_e64 v99, s49, v99
v_bfe_u32 v98, v99, 2, 14
v_lshrrev_b32_e64 v99, 18, v99
v_mfma_f32_16x16x32_bf16 v[68:71], v[52:55], v[160:163], v[68:71]
ds_read_u16 v98, v98
ds_read_u16_d16_hi v99, v99
v_mfma_f32_16x16x32_f16 v[172:175], v[48:51], v[88:91], v[172:175]
v_or_b32_e64 v230, v100, v101
v_cvt_pkrtz_f16_f32 v135, v134, v135
v_and_b32_e64 v135, s49, v135
v_bfe_u32 v134, v135, 2, 14
v_lshrrev_b32 v135, 18, v135
v_mfma_f32_16x16x32_bf16 v[140:143], v[188:191], v[44:47], v[140:143]
ds_read_b128 v[52:55], v249 offset:16384
s_setprio 1
ds_read_u16 v134, v134
ds_read_u16_d16_hi v135, v135
v_or_b32_e64 v127, v114, v115
v_mfma_f32_16x16x32_f16 v[92:95], v[48:51], v[80:83], v[92:95]
v_exp_f16_sdwa v33, v33 dst_sel:WORD_1 dst_unused:UNUSED_PRESERVE src0_sel:WORD_1
v_or_b32 v3, v202, v203
v_mfma_f32_16x16x32_bf16 v[108:111], v[188:191], v[144:147], v[108:111]
s_waitcnt lgkmcnt(8)
ds_read_b128 v[48:51], v251 offset:46080
v_or_b32_e64 v231, v102, v103
v_mfma_f32_16x16x32_f16 v[216:219], v[120:123], v[64:67], v[216:219]
v_pk_add_f16 v33, v33, 1.0 op_sel_hi:[1,0]
v_cvt_pk_f16_f32 v140, v140, v141
v_mfma_f32_16x16x32_bf16 v[68:71], v[188:191], v[148:151], v[68:71]
ds_read_b128 v[188:191], v249 offset:12544
v_rcp_f16_sdwa v33, v33 dst_sel:WORD_0 dst_unused:UNUSED_PRESERVE src0_sel:WORD_0
v_mfma_f32_16x16x32_f16 v[232:235], v[120:123], v[88:91], v[232:235]
v_cvt_pkrtz_f16_f32 v109, v108, v109
v_and_b32_e64 v109, s49, v109
v_mfma_f32_16x16x32_bf16 v[24:27], v[176:179], v[28:31], 0
v_bfe_u32 v108, v109, 2, 14
v_lshrrev_b32_e64 v109, 18, v109
v_mfma_f32_16x16x32_f16 v[224:227], v[120:123], v[80:83], v[224:227]
ds_read_b128 v[120:123], v251 offset:49152
ds_read_u16 v108, v108
v_mfma_f32_16x16x32_bf16 v[56:59], v[176:179], v[128:131], 0
ds_read_u16_d16_hi v109, v109
v_rcp_f16_sdwa v33, v33 dst_sel:WORD_1 dst_unused:UNUSED_PRESERVE src0_sel:WORD_1
v_mfma_f32_16x16x32_f16 v[116:119], v[4:7], v[228:231], v[116:119]
v_pk_fma_f16 v141, v140, v140, s48
v_cvt_pkrtz_f16_f32 v69, v68, v69
v_mfma_f32_16x16x32_bf16 v[60:63], v[176:179], v[136:139], 0
ds_read_b128 v[176:179], v249 offset:14592
v_and_b32 v69, s49, v69
v_mfma_f32_16x16x32_f16 v[240:243], v[4:7], v[0:3], v[240:243]
s_setprio 0
v_bfe_u32 v68, v69, 2, 14
v_lshrrev_b32 v69, 18, v69
v_mfma_f32_16x16x32_bf16 v[24:27], v[180:183], v[36:39], v[24:27]
ds_read_u16 v68, v68
s_waitcnt lgkmcnt(6)
ds_read_u16_d16_hi v69, v69
v_mfma_f32_16x16x32_f16 v[76:79], v[4:7], v[124:127], v[76:79]
v_or_b32_e64 v96, v96, v97
v_pk_mul_f16 v141, v140, v141
v_cvt_pkrtz_f16_f32 v143, v142, v143
v_and_b32_e64 v143, s49, v143
v_bfe_u32 v142, v143, 2, 14
v_lshrrev_b32_e64 v143, 18, v143
v_pk_mul_f16 v32, v32, v33
ds_read_b128 v[4:7], v251 offset:47104
ds_read_u16 v142, v142
ds_read_u16_d16_hi v143, v143
v_mfma_f32_16x16x32_bf16 v[56:59], v[180:183], v[156:159], v[56:59]
v_exp_f16_sdwa v141, v141 dst_sel:WORD_0 dst_unused:UNUSED_PRESERVE src0_sel:WORD_0
v_mfma_f32_16x16x32_f16 v[72:75], v[184:187], v[228:231], v[72:75]
v_or_b32_e64 v132, v132, v133
v_cvt_pkrtz_f16_f32 v111, v110, v111
v_and_b32_e64 v111, s49, v111
v_bfe_u32 v110, v111, 2, 14
v_lshrrev_b32_e64 v111, 18, v111
v_mfma_f32_16x16x32_bf16 v[60:63], v[180:183], v[160:163], v[60:63]
ds_read_u16 v110, v110
ds_read_u16_d16_hi v111, v111
v_mfma_f32_16x16x32_f16 v[196:199], v[184:187], v[0:3], v[196:199]
ds_read_b128 v[180:183], v249 offset:16640
v_or_b32_e64 v33, v34, v35
v_cvt_pkrtz_f16_f32 v71, v70, v71
v_and_b32_e64 v71, s49, v71
v_bfe_u32 v70, v71, 2, 14
v_lshrrev_b32_e64 v71, 18, v71
v_mfma_f32_16x16x32_bf16 v[24:27], v[52:55], v[44:47], v[24:27]
ds_read_u16 v70, v70
ds_read_u16_d16_hi v71, v71
v_mfma_f32_16x16x32_f16 v[220:223], v[184:187], v[124:127], v[220:223]
v_exp_f16_sdwa v141, v141 dst_sel:WORD_1 dst_unused:UNUSED_PRESERVE src0_sel:WORD_1
v_or_b32 v97, v98, v99
v_mfma_f32_16x16x32_bf16 v[56:59], v[52:55], v[144:147], v[56:59]
s_waitcnt lgkmcnt(6)
ds_read_b128 v[184:187], v251 offset:50176
v_or_b32_e64 v133, v134, v135
v_mfma_f32_16x16x32_f16 v[164:167], v[48:51], v[228:231], v[164:167]
v_pk_add_f16 v141, v141, 1.0 op_sel_hi:[1,0]
v_cvt_pk_f16_f32 v24, v24, v25
v_mfma_f32_16x16x32_bf16 v[60:63], v[52:55], v[148:151], v[60:63]
ds_read_b128 v[52:55], v249 offset:18432
v_rcp_f16_sdwa v141, v141 dst_sel:WORD_0 dst_unused:UNUSED_PRESERVE src0_sel:WORD_0
v_mfma_f32_16x16x32_f16 v[168:171], v[48:51], v[0:3], v[168:171]
s_setprio 3
v_cvt_pkrtz_f16_f32 v57, v56, v57
v_and_b32 v57, s49, v57
v_mfma_f32_16x16x32_bf16 v[112:115], v[188:191], v[28:31], 0
v_bfe_u32 v56, v57, 2, 14
v_lshrrev_b32_e64 v57, 18, v57
v_mfma_f32_16x16x32_f16 v[84:87], v[48:51], v[124:127], v[84:87]
ds_read_b128 v[48:51], v251 offset:51200
ds_read_u16 v56, v56
v_mfma_f32_16x16x32_bf16 v[200:203], v[188:191], v[128:131], 0
ds_read_u16_d16_hi v57, v57
v_rcp_f16_sdwa v141, v141 dst_sel:WORD_1 dst_unused:UNUSED_PRESERVE src0_sel:WORD_1
v_mfma_f32_16x16x32_f16 v[208:211], v[120:123], v[228:231], v[208:211]
v_pk_fma_f16 v25, v24, v24, s48
v_cvt_pkrtz_f16_f32 v61, v60, v61
v_mfma_f32_16x16x32_bf16 v[100:103], v[188:191], v[136:139], 0
ds_read_b128 v[188:191], v249 offset:20480
v_and_b32_e64 v61, s49, v61
v_mfma_f32_16x16x32_f16 v[212:215], v[120:123], v[0:3], v[212:215]
v_bfe_u32 v60, v61, 2, 14
v_lshrrev_b32_e64 v61, 18, v61
v_mfma_f32_16x16x32_bf16 v[112:115], v[176:179], v[36:39], v[112:115]
ds_read_u16 v60, v60
ds_read_u16_d16_hi v61, v61
v_mfma_f32_16x16x32_f16 v[236:239], v[120:123], v[124:127], v[236:239]
v_or_b32_e64 v98, v108, v109
v_pk_mul_f16 v25, v24, v25
v_cvt_pkrtz_f16_f32 v27, v26, v27
v_and_b32_e64 v27, s49, v27
v_bfe_u32 v26, v27, 2, 14
v_lshrrev_b32 v27, 18, v27
v_pk_mul_f16 v34, v140, v141
ds_read_b128 v[120:123], v251 offset:54272
s_waitcnt lgkmcnt(6)
ds_read_u16 v26, v26
ds_read_u16_d16_hi v27, v27
v_mfma_f32_16x16x32_bf16 v[200:203], v[176:179], v[156:159], v[200:203]
buffer_load_dwordx4 v[80:83], v253, s[4:7], s68 offen offset:256
buffer_load_dwordx4 v[88:91], v253, s[4:7], s68 offen offset:320
v_exp_f16_sdwa v25, v25 dst_sel:WORD_0 dst_unused:UNUSED_PRESERVE src0_sel:WORD_0
v_mfma_f32_16x16x32_f16 v[8:11], v[4:7], v[228:231], v[8:11]
v_or_b32_e64 v134, v68, v69
v_cvt_pkrtz_f16_f32 v59, v58, v59
v_and_b32_e64 v59, s49, v59
v_bfe_u32 v58, v59, 2, 14
v_lshrrev_b32_e64 v59, 18, v59
v_mfma_f32_16x16x32_bf16 v[100:103], v[176:179], v[160:163], v[100:103]
ds_read_u16 v58, v58
ds_read_u16_d16_hi v59, v59
v_mfma_f32_16x16x32_f16 v[172:175], v[4:7], v[0:3], v[172:175]
ds_read_b128 v[176:179], v249 offset:22528
s_setprio 2
v_or_b32 v35, v142, v143
v_cvt_pkrtz_f16_f32 v63, v62, v63
v_and_b32_e64 v63, s49, v63
v_bfe_u32 v62, v63, 2, 14
v_lshrrev_b32_e64 v63, 18, v63
v_mfma_f32_16x16x32_bf16 v[112:115], v[180:183], v[44:47], v[112:115]
ds_read_u16 v62, v62
ds_read_u16_d16_hi v63, v63
v_mfma_f32_16x16x32_f16 v[92:95], v[4:7], v[124:127], v[92:95]
v_exp_f16_sdwa v25, v25 dst_sel:WORD_1 dst_unused:UNUSED_PRESERVE src0_sel:WORD_1
v_or_b32_e64 v99, v110, v111
v_mfma_f32_16x16x32_bf16 v[200:203], v[180:183], v[144:147], v[200:203]
ds_read_b128 v[4:7], v251 offset:52224
v_or_b32_e64 v135, v70, v71
v_mfma_f32_16x16x32_f16 v[216:219], v[184:187], v[228:231], v[216:219]
v_pk_add_f16 v25, v25, 1.0 op_sel_hi:[1,0]
v_cvt_pk_f16_f32 v112, v112, v113
v_mfma_f32_16x16x32_bf16 v[100:103], v[180:183], v[148:151], v[100:103]
ds_read_b128 v[180:183], v249 offset:18688
v_rcp_f16_sdwa v25, v25 dst_sel:WORD_0 dst_unused:UNUSED_PRESERVE src0_sel:WORD_0
v_mfma_f32_16x16x32_f16 v[232:235], v[184:187], v[0:3], v[232:235]
v_cvt_pkrtz_f16_f32 v201, v200, v201
v_and_b32_e64 v201, s49, v201
v_mfma_f32_16x16x32_bf16 v[64:67], v[52:55], v[28:31], 0
v_bfe_u32 v200, v201, 2, 14
v_lshrrev_b32_e64 v201, 18, v201
v_mfma_f32_16x16x32_f16 v[224:227], v[184:187], v[124:127], v[224:227]
s_waitcnt lgkmcnt(4)
ds_read_b128 v[184:187], v251 offset:55296
ds_read_u16 v200, v200
s_waitcnt vmcnt(11)
v_mfma_f32_16x16x32_bf16 v[76:79], v[18:21], v[152:155], v[76:79]
ds_read_u16_d16_hi v201, v201
v_rcp_f16_sdwa v25, v25 dst_sel:WORD_1 dst_unused:UNUSED_PRESERVE src0_sel:WORD_1
v_mfma_f32_16x16x32_bf16 v[220:223], v[16:19], v[152:155], v[220:223]
v_pk_fma_f16 v113, v112, v112, s48
v_cvt_pkrtz_f16_f32 v101, v100, v101
v_mfma_f32_16x16x32_bf16 v[140:143], v[52:55], v[128:131], 0
v_and_b32_e64 v101, s49, v101
v_bfe_u32 v100, v101, 2, 14
v_mfma_f32_16x16x32_f16 v[116:119], v[48:51], v[132:135], v[116:119]
v_lshrrev_b32 v101, 18, v101
v_or_b32 v56, v56, v57
v_mfma_f32_16x16x32_bf16 v[108:111], v[52:55], v[136:139], 0
ds_read_b128 v[52:55], v249 offset:20736
ds_read_u16 v100, v100
v_mfma_f32_16x16x32_f16 v[240:243], v[48:51], v[96:99], v[240:243]
s_setprio 1
ds_read_u16_d16_hi v101, v101
v_pk_mul_f16 v113, v112, v113
v_mfma_f32_16x16x32_bf16 v[64:67], v[188:191], v[36:39], v[64:67]
v_cvt_pkrtz_f16_f32 v115, v114, v115
v_and_b32 v115, s49, v115
v_mfma_f32_16x16x32_f16 v[76:79], v[48:51], v[32:35], v[76:79]
ds_read_b128 v[48:51], v251 offset:53248
v_bfe_u32 v114, v115, 2, 14
v_lshrrev_b32_e64 v115, 18, v115
v_pk_mul_f16 v24, v24, v25
v_mfma_f32_16x16x32_bf16 v[140:143], v[188:191], v[156:159], v[140:143]
ds_read_u16 v114, v114
ds_read_u16_d16_hi v115, v115
v_mfma_f32_16x16x32_f16 v[72:75], v[120:123], v[132:135], v[72:75]
v_exp_f16_sdwa v113, v113 dst_sel:WORD_0 dst_unused:UNUSED_PRESERVE src0_sel:WORD_0
v_or_b32_e64 v60, v60, v61
v_cvt_pkrtz_f16_f32 v203, v202, v203
v_and_b32_e64 v203, s49, v203
v_bfe_u32 v202, v203, 2, 14
v_lshrrev_b32_e64 v203, 18, v203
v_mfma_f32_16x16x32_bf16 v[108:111], v[188:191], v[160:163], v[108:111]
ds_read_u16 v202, v202
ds_read_u16_d16_hi v203, v203
v_mfma_f32_16x16x32_f16 v[196:199], v[120:123], v[96:99], v[196:199]
s_waitcnt lgkmcnt(6)
ds_read_b128 v[188:191], v249 offset:22784
v_or_b32 v25, v26, v27
v_cvt_pkrtz_f16_f32 v103, v102, v103
v_and_b32_e64 v103, s49, v103
v_bfe_u32 v102, v103, 2, 14
v_lshrrev_b32_e64 v103, 18, v103
v_mfma_f32_16x16x32_bf16 v[64:67], v[176:179], v[44:47], v[64:67]
ds_read_u16 v102, v102
ds_read_u16_d16_hi v103, v103
v_mfma_f32_16x16x32_f16 v[220:223], v[120:123], v[32:35], v[220:223]
v_exp_f16_sdwa v113, v113 dst_sel:WORD_1 dst_unused:UNUSED_PRESERVE src0_sel:WORD_1
v_or_b32_e64 v57, v58, v59
v_mfma_f32_16x16x32_bf16 v[140:143], v[176:179], v[144:147], v[140:143]
ds_read_b128 v[120:123], v251 offset:56320
v_or_b32_e64 v61, v62, v63
v_mfma_f32_16x16x32_f16 v[164:167], v[4:7], v[132:135], v[164:167]
v_pk_add_f16 v113, v113, 1.0 op_sel_hi:[1,0]
v_cvt_pk_f16_f32 v64, v64, v65
v_mfma_f32_16x16x32_bf16 v[108:111], v[176:179], v[148:151], v[108:111]
ds_read_b128 v[176:179], v249 offset:24576
v_rcp_f16_sdwa v113, v113 dst_sel:WORD_0 dst_unused:UNUSED_PRESERVE src0_sel:WORD_0
v_mfma_f32_16x16x32_f16 v[168:171], v[4:7], v[96:99], v[168:171]
s_setprio 0
v_cvt_pkrtz_f16_f32 v141, v140, v141
v_and_b32 v141, s49, v141
v_mfma_f32_16x16x32_bf16 v[68:71], v[180:183], v[28:31], 0
v_bfe_u32 v140, v141, 2, 14
v_lshrrev_b32_e64 v141, 18, v141
v_mfma_f32_16x16x32_f16 v[84:87], v[4:7], v[32:35], v[84:87]
ds_read_b128 v[4:7], v251 offset:57344
ds_read_u16 v140, v140
v_mfma_f32_16x16x32_bf16 v[124:127], v[180:183], v[128:131], 0
ds_read_u16_d16_hi v141, v141
v_rcp_f16_sdwa v113, v113 dst_sel:WORD_1 dst_unused:UNUSED_PRESERVE src0_sel:WORD_1
v_mfma_f32_16x16x32_f16 v[208:211], v[184:187], v[132:135], v[208:211]
v_pk_fma_f16 v65, v64, v64, s48
v_cvt_pkrtz_f16_f32 v109, v108, v109
v_mfma_f32_16x16x32_bf16 v[0:3], v[180:183], v[136:139], 0
ds_read_b128 v[180:183], v249 offset:26624
v_and_b32_e64 v109, s49, v109
v_mfma_f32_16x16x32_f16 v[212:215], v[184:187], v[96:99], v[212:215]
v_bfe_u32 v108, v109, 2, 14
v_lshrrev_b32 v109, 18, v109
v_mfma_f32_16x16x32_bf16 v[68:71], v[52:55], v[36:39], v[68:71]
s_waitcnt lgkmcnt(4)
ds_read_u16 v108, v108
ds_read_u16_d16_hi v109, v109
v_mfma_f32_16x16x32_f16 v[236:239], v[184:187], v[32:35], v[236:239]
v_or_b32_e64 v58, v200, v201
v_pk_mul_f16 v65, v64, v65
v_cvt_pkrtz_f16_f32 v67, v66, v67
v_and_b32_e64 v67, s49, v67
v_bfe_u32 v66, v67, 2, 14
v_lshrrev_b32_e64 v67, 18, v67
v_pk_mul_f16 v26, v112, v113
ds_read_b128 v[184:187], v251 offset:60416
ds_read_u16 v66, v66
ds_read_u16_d16_hi v67, v67
v_mfma_f32_16x16x32_bf16 v[124:127], v[52:55], v[156:159], v[124:127]
v_exp_f16_sdwa v65, v65 dst_sel:WORD_0 dst_unused:UNUSED_PRESERVE src0_sel:WORD_0
v_mfma_f32_16x16x32_f16 v[8:11], v[48:51], v[132:135], v[8:11]
v_or_b32_e64 v62, v100, v101
v_cvt_pkrtz_f16_f32 v143, v142, v143
v_and_b32_e64 v143, s49, v143
v_bfe_u32 v142, v143, 2, 14
v_lshrrev_b32_e64 v143, 18, v143
v_mfma_f32_16x16x32_bf16 v[0:3], v[52:55], v[160:163], v[0:3]
ds_read_u16 v142, v142
ds_read_u16_d16_hi v143, v143
v_mfma_f32_16x16x32_f16 v[172:175], v[48:51], v[96:99], v[172:175]
ds_read_b128 v[52:55], v249 offset:28672
s_setprio 3
v_or_b32 v27, v114, v115
v_cvt_pkrtz_f16_f32 v111, v110, v111
v_and_b32_e64 v111, s49, v111
v_bfe_u32 v110, v111, 2, 14
v_lshrrev_b32_e64 v111, 18, v111
v_mfma_f32_16x16x32_bf16 v[68:71], v[188:191], v[44:47], v[68:71]
ds_read_u16 v110, v110
ds_read_u16_d16_hi v111, v111
v_mfma_f32_16x16x32_f16 v[92:95], v[48:51], v[32:35], v[92:95]
v_exp_f16_sdwa v65, v65 dst_sel:WORD_1 dst_unused:UNUSED_PRESERVE src0_sel:WORD_1
v_or_b32_e64 v59, v202, v203
v_mfma_f32_16x16x32_bf16 v[124:127], v[188:191], v[144:147], v[124:127]
ds_read_b128 v[48:51], v251 offset:58368
v_or_b32 v63, v102, v103
v_mfma_f32_16x16x32_f16 v[216:219], v[120:123], v[132:135], v[216:219]
v_pk_add_f16 v65, v65, 1.0 op_sel_hi:[1,0]
v_cvt_pk_f16_f32 v68, v68, v69
v_mfma_f32_16x16x32_bf16 v[0:3], v[188:191], v[148:151], v[0:3]
s_waitcnt lgkmcnt(6)
ds_read_b128 v[188:191], v249 offset:24832
v_rcp_f16_sdwa v65, v65 dst_sel:WORD_0 dst_unused:UNUSED_PRESERVE src0_sel:WORD_0
v_mfma_f32_16x16x32_f16 v[232:235], v[120:123], v[96:99], v[232:235]
v_cvt_pkrtz_f16_f32 v125, v124, v125
v_and_b32_e64 v125, s49, v125
v_mfma_f32_16x16x32_bf16 v[228:231], v[176:179], v[28:31], 0
v_bfe_u32 v124, v125, 2, 14
v_lshrrev_b32 v125, 18, v125
v_mfma_f32_16x16x32_f16 v[224:227], v[120:123], v[32:35], v[224:227]
ds_read_b128 v[120:123], v251 offset:61440
ds_read_u16 v124, v124
s_waitcnt vmcnt(8)
v_mfma_f32_16x16x32_bf16 v[84:87], v[18:21], v[40:43], v[84:87]
ds_read_u16_d16_hi v125, v125
v_rcp_f16_sdwa v65, v65 dst_sel:WORD_1 dst_unused:UNUSED_PRESERVE src0_sel:WORD_1
v_mfma_f32_16x16x32_bf16 v[236:239], v[16:19], v[40:43], v[236:239]
v_pk_fma_f16 v69, v68, v68, s48
v_cvt_pkrtz_f16_f32 v1, v0, v1
s_waitcnt vmcnt(7)
v_mfma_f32_16x16x32_bf16 v[92:95], v[18:21], v[12:15], v[92:95]
v_and_b32 v1, s49, v1
v_bfe_u32 v0, v1, 2, 14
v_mfma_f32_16x16x32_bf16 v[224:227], v[16:19], v[12:15], v[224:227]
v_lshrrev_b32 v1, 18, v1
v_or_b32 v140, v140, v141
v_mfma_f32_16x16x32_bf16 v[152:155], v[176:179], v[128:131], 0
ds_read_u16 v0, v0
ds_read_u16_d16_hi v1, v1
v_mfma_f32_16x16x32_f16 v[116:119], v[4:7], v[60:63], v[116:119]
v_pk_mul_f16 v69, v68, v69
v_cvt_pkrtz_f16_f32 v71, v70, v71
v_mfma_f32_16x16x32_bf16 v[112:115], v[176:179], v[136:139], 0
ds_read_b128 v[176:179], v249 offset:26880
v_and_b32 v71, s49, v71
v_mfma_f32_16x16x32_f16 v[240:243], v[4:7], v[56:59], v[240:243]
s_setprio 2
v_bfe_u32 v70, v71, 2, 14
v_lshrrev_b32 v71, 18, v71
v_mfma_f32_16x16x32_bf16 v[228:231], v[180:183], v[36:39], v[228:231]
ds_read_u16 v70, v70
ds_read_u16_d16_hi v71, v71
v_mfma_f32_16x16x32_f16 v[76:79], v[4:7], v[24:27], v[76:79]
s_waitcnt lgkmcnt(5)
ds_read_b128 v[4:7], v251 offset:59392
v_pk_mul_f16 v64, v64, v65
v_mfma_f32_16x16x32_bf16 v[152:155], v[180:183], v[156:159], v[152:155]
v_exp_f16_sdwa v69, v69 dst_sel:WORD_0 dst_unused:UNUSED_PRESERVE src0_sel:WORD_0
v_mfma_f32_16x16x32_f16 v[72:75], v[184:187], v[60:63], v[72:75]
v_or_b32_e64 v108, v108, v109
v_cvt_pkrtz_f16_f32 v127, v126, v127
v_and_b32_e64 v127, s49, v127
v_bfe_u32 v126, v127, 2, 14
v_lshrrev_b32_e64 v127, 18, v127
v_mfma_f32_16x16x32_bf16 v[112:115], v[180:183], v[160:163], v[112:115]
ds_read_u16 v126, v126
ds_read_u16_d16_hi v127, v127
v_mfma_f32_16x16x32_f16 v[196:199], v[184:187], v[56:59], v[196:199]
ds_read_b128 v[180:183], v249 offset:28928
v_or_b32_e64 v65, v66, v67
v_cvt_pkrtz_f16_f32 v3, v2, v3
v_and_b32_e64 v3, s49, v3
v_bfe_u32 v2, v3, 2, 14
v_lshrrev_b32_e64 v3, 18, v3
v_mfma_f32_16x16x32_bf16 v[228:231], v[52:55], v[44:47], v[228:231]
ds_read_u16 v2, v2
ds_read_u16_d16_hi v3, v3
v_mfma_f32_16x16x32_f16 v[220:223], v[184:187], v[24:27], v[220:223]
v_exp_f16_sdwa v69, v69 dst_sel:WORD_1 dst_unused:UNUSED_PRESERVE src0_sel:WORD_1
v_or_b32_e64 v141, v142, v143
v_mfma_f32_16x16x32_bf16 v[152:155], v[52:55], v[144:147], v[152:155]
ds_read_b128 v[184:187], v251 offset:62464
v_or_b32_e64 v109, v110, v111
v_mfma_f32_16x16x32_f16 v[164:167], v[48:51], v[60:63], v[164:167]
v_pk_add_f16 v69, v69, 1.0 op_sel_hi:[1,0]
v_cvt_pk_f16_f32 v228, v228, v229
v_mfma_f32_16x16x32_bf16 v[112:115], v[52:55], v[148:151], v[112:115]
ds_read_b128 v[52:55], v249 offset:30720
v_rcp_f16_sdwa v69, v69 dst_sel:WORD_0 dst_unused:UNUSED_PRESERVE src0_sel:WORD_0
v_mfma_f32_16x16x32_f16 v[168:171], v[48:51], v[56:59], v[168:171]
s_setprio 1
v_cvt_pkrtz_f16_f32 v153, v152, v153
v_and_b32 v153, s49, v153
v_mfma_f32_16x16x32_bf16 v[200:203], v[188:191], v[28:31], 0
v_bfe_u32 v152, v153, 2, 14
v_lshrrev_b32 v153, 18, v153
v_mfma_f32_16x16x32_f16 v[84:87], v[48:51], v[24:27], v[84:87]
ds_read_b128 v[48:51], v251 offset:63488
ds_read_u16 v152, v152
v_mfma_f32_16x16x32_bf16 v[100:103], v[188:191], v[128:131], 0
s_waitcnt lgkmcnt(6)
ds_read_u16_d16_hi v153, v153
v_rcp_f16_sdwa v69, v69 dst_sel:WORD_1 dst_unused:UNUSED_PRESERVE src0_sel:WORD_1
v_mfma_f32_16x16x32_f16 v[208:211], v[120:123], v[60:63], v[208:211]
v_pk_fma_f16 v229, v228, v228, s48
v_cvt_pkrtz_f16_f32 v113, v112, v113
v_mfma_f32_16x16x32_bf16 v[32:35], v[188:191], v[136:139], 0
ds_read_b128 v[188:191], v249 offset:32768
v_and_b32_e64 v113, s49, v113
v_mfma_f32_16x16x32_f16 v[212:215], v[120:123], v[56:59], v[212:215]
v_bfe_u32 v112, v113, 2, 14
v_lshrrev_b32_e64 v113, 18, v113
v_mfma_f32_16x16x32_bf16 v[200:203], v[176:179], v[36:39], v[200:203]
ds_read_u16 v112, v112
ds_read_u16_d16_hi v113, v113
v_mfma_f32_16x16x32_f16 v[236:239], v[120:123], v[24:27], v[236:239]
v_or_b32_e64 v142, v124, v125
v_pk_mul_f16 v229, v228, v229
v_cvt_pkrtz_f16_f32 v231, v230, v231
v_and_b32_e64 v231, s49, v231
v_bfe_u32 v230, v231, 2, 14
v_lshrrev_b32_e64 v231, 18, v231
v_pk_mul_f16 v66, v68, v69
ds_read_b128 v[120:123], v252 offset:1024
ds_read_u16 v230, v230
ds_read_u16_d16_hi v231, v231
v_mfma_f32_16x16x32_bf16 v[100:103], v[176:179], v[156:159], v[100:103]
v_exp_f16_sdwa v229, v229 dst_sel:WORD_0 dst_unused:UNUSED_PRESERVE src0_sel:WORD_0
v_mfma_f32_16x16x32_f16 v[8:11], v[4:7], v[60:63], v[8:11]
v_or_b32_e64 v110, v0, v1
v_cvt_pkrtz_f16_f32 v155, v154, v155
v_and_b32_e64 v155, s49, v155
v_bfe_u32 v154, v155, 2, 14
v_lshrrev_b32_e64 v155, 18, v155
v_mfma_f32_16x16x32_bf16 v[32:35], v[176:179], v[160:163], v[32:35]
ds_read_u16 v154, v154
ds_read_u16_d16_hi v155, v155
v_mfma_f32_16x16x32_f16 v[172:175], v[4:7], v[56:59], v[172:175]
s_waitcnt lgkmcnt(6)
ds_read_b128 v[176:179], v249 offset:34816
s_setprio 0
v_or_b32_e64 v67, v70, v71
v_cvt_pkrtz_f16_f32 v115, v114, v115
v_and_b32_e64 v115, s49, v115
v_bfe_u32 v114, v115, 2, 14
v_lshrrev_b32_e64 v115, 18, v115
v_mfma_f32_16x16x32_bf16 v[200:203], v[180:183], v[44:47], v[200:203]
ds_read_u16 v114, v114
ds_read_u16_d16_hi v115, v115
v_mfma_f32_16x16x32_f16 v[92:95], v[4:7], v[24:27], v[92:95]
v_exp_f16_sdwa v229, v229 dst_sel:WORD_1 dst_unused:UNUSED_PRESERVE src0_sel:WORD_1
v_or_b32_e64 v143, v126, v127
v_mfma_f32_16x16x32_bf16 v[100:103], v[180:183], v[144:147], v[100:103]
ds_read_b128 v[4:7], v251 offset:64512
v_or_b32_e64 v111, v2, v3
v_mfma_f32_16x16x32_f16 v[216:219], v[184:187], v[60:63], v[216:219]
v_pk_add_f16 v229, v229, 1.0 op_sel_hi:[1,0]
v_cvt_pk_f16_f32 v200, v200, v201
v_mfma_f32_16x16x32_bf16 v[32:35], v[180:183], v[148:151], v[32:35]
ds_read_b128 v[180:183], v249 offset:30976
v_rcp_f16_sdwa v229, v229 dst_sel:WORD_0 dst_unused:UNUSED_PRESERVE src0_sel:WORD_0
v_mfma_f32_16x16x32_f16 v[232:235], v[184:187], v[56:59], v[232:235]
v_cvt_pkrtz_f16_f32 v101, v100, v101
v_and_b32_e64 v101, s49, v101
v_mfma_f32_16x16x32_bf16 v[96:99], v[52:55], v[28:31], 0
v_bfe_u32 v100, v101, 2, 14
v_lshrrev_b32 v101, 18, v101
v_mfma_f32_16x16x32_f16 v[224:227], v[184:187], v[24:27], v[224:227]
ds_read_b128 v[184:187], v252 offset:2048
ds_read_u16 v100, v100
s_waitcnt vmcnt(5)
v_mfma_f32_16x16x32_bf16 v[240:243], v[18:21], v[244:247], v[240:243]
ds_read_u16_d16_hi v101, v101
v_rcp_f16_sdwa v229, v229 dst_sel:WORD_1 dst_unused:UNUSED_PRESERVE src0_sel:WORD_1
v_mfma_f32_16x16x32_bf16 v[196:199], v[16:19], v[244:247], v[196:199]
v_pk_fma_f16 v201, v200, v200, s48
v_cvt_pkrtz_f16_f32 v33, v32, v33
s_waitcnt vmcnt(4)
v_mfma_f32_16x16x32_bf16 v[168:171], v[18:21], v[204:207], v[168:171]
v_and_b32 v33, s49, v33
v_bfe_u32 v32, v33, 2, 14
v_mfma_f32_16x16x32_bf16 v[212:215], v[16:19], v[204:207], v[212:215]
v_lshrrev_b32_e64 v33, 18, v33
v_or_b32 v152, v152, v153
v_mfma_f32_16x16x32_bf16 v[132:135], v[52:55], v[128:131], 0
ds_read_u16 v32, v32
s_waitcnt lgkmcnt(4)
ds_read_u16_d16_hi v33, v33
v_mfma_f32_16x16x32_f16 v[116:119], v[48:51], v[108:111], v[116:119]
v_pk_mul_f16 v201, v200, v201
v_cvt_pkrtz_f16_f32 v203, v202, v203
v_mfma_f32_16x16x32_bf16 v[40:43], v[52:55], v[136:139], 0
ds_read_b128 v[52:55], v249 offset:33024
v_and_b32 v203, s49, v203
v_mfma_f32_16x16x32_f16 v[240:243], v[48:51], v[140:143], v[240:243]
s_setprio 3
v_bfe_u32 v202, v203, 2, 14
v_lshrrev_b32_e64 v203, 18, v203
v_mfma_f32_16x16x32_bf16 v[96:99], v[188:191], v[36:39], v[96:99]
ds_read_u16 v202, v202
ds_read_u16_d16_hi v203, v203
v_mfma_f32_16x16x32_f16 v[76:79], v[48:51], v[64:67], v[76:79]
ds_read_b128 v[48:51], v252
v_pk_mul_f16 v228, v228, v229
v_mfma_f32_16x16x32_bf16 v[132:135], v[188:191], v[156:159], v[132:135]
v_exp_f16_sdwa v201, v201 dst_sel:WORD_0 dst_unused:UNUSED_PRESERVE src0_sel:WORD_0
v_mfma_f32_16x16x32_f16 v[72:75], v[120:123], v[108:111], v[72:75]
v_or_b32_e64 v112, v112, v113
v_cvt_pkrtz_f16_f32 v103, v102, v103
v_and_b32_e64 v103, s49, v103
v_bfe_u32 v102, v103, 2, 14
v_lshrrev_b32_e64 v103, 18, v103
v_mfma_f32_16x16x32_bf16 v[40:43], v[188:191], v[160:163], v[40:43]
ds_read_u16 v102, v102
ds_read_u16_d16_hi v103, v103
v_mfma_f32_16x16x32_f16 v[196:199], v[120:123], v[140:143], v[196:199]
ds_read_b128 v[188:191], v249 offset:35072
v_or_b32_e64 v229, v230, v231
v_cvt_pkrtz_f16_f32 v35, v34, v35
v_and_b32_e64 v35, s49, v35
v_bfe_u32 v34, v35, 2, 14
v_lshrrev_b32_e64 v35, 18, v35
v_mfma_f32_16x16x32_bf16 v[96:99], v[176:179], v[44:47], v[96:99]
ds_read_u16 v34, v34
ds_read_u16_d16_hi v35, v35
v_mfma_f32_16x16x32_f16 v[220:223], v[120:123], v[64:67], v[220:223]
v_exp_f16_sdwa v201, v201 dst_sel:WORD_1 dst_unused:UNUSED_PRESERVE src0_sel:WORD_1
v_or_b32_e64 v153, v154, v155
v_mfma_f32_16x16x32_bf16 v[132:135], v[176:179], v[144:147], v[132:135]
ds_read_b128 v[120:123], v252 offset:3072
v_or_b32_e64 v113, v114, v115
v_mfma_f32_16x16x32_f16 v[164:167], v[4:7], v[108:111], v[164:167]
v_pk_add_f16 v201, v201, 1.0 op_sel_hi:[1,0]
v_cvt_pk_f16_f32 v96, v96, v97
v_mfma_f32_16x16x32_bf16 v[40:43], v[176:179], v[148:151], v[40:43]
v_rcp_f16_sdwa v201, v201 dst_sel:WORD_0 dst_unused:UNUSED_PRESERVE src0_sel:WORD_0
v_mfma_f32_16x16x32_f16 v[168:171], v[4:7], v[140:143], v[168:171]
s_setprio 2
s_waitcnt lgkmcnt(5)
ds_read_b128 v[176:179], v252 offset:4096
v_cvt_pkrtz_f16_f32 v133, v132, v133
v_mfma_f32_16x16x32_bf16 v[12:15], v[180:183], v[28:31], 0
v_and_b32_e64 v133, s49, v133
v_bfe_u32 v132, v133, 2, 14
v_mfma_f32_16x16x32_f16 v[84:87], v[4:7], v[64:67], v[84:87]
v_lshrrev_b32_e64 v133, 18, v133
v_rcp_f16_sdwa v201, v201 dst_sel:WORD_1 dst_unused:UNUSED_PRESERVE src0_sel:WORD_1
v_mfma_f32_16x16x32_bf16 v[68:71], v[180:183], v[128:131], 0
ds_read_u16 v132, v132
ds_read_u16_d16_hi v133, v133
v_mfma_f32_16x16x32_f16 v[208:211], v[184:187], v[108:111], v[208:211]
v_pk_fma_f16 v97, v96, v96, s48
v_cvt_pkrtz_f16_f32 v41, v40, v41
v_mfma_f32_16x16x32_bf16 v[124:127], v[180:183], v[136:139], 0
v_and_b32_e64 v41, s49, v41
v_bfe_u32 v40, v41, 2, 14
v_mfma_f32_16x16x32_f16 v[212:215], v[184:187], v[140:143], v[212:215]
v_lshrrev_b32 v41, 18, v41
v_or_b32 v154, v100, v101
v_mfma_f32_16x16x32_bf16 v[12:15], v[52:55], v[36:39], v[12:15]
ds_read_u16 v40, v40
ds_read_u16_d16_hi v41, v41
v_mfma_f32_16x16x32_f16 v[236:239], v[184:187], v[64:67], v[236:239]
ds_read_b128 v[4:7], v252 offset:7168
v_pk_mul_f16 v97, v96, v97
v_cvt_pkrtz_f16_f32 v99, v98, v99
v_and_b32_e64 v99, s49, v99
v_bfe_u32 v98, v99, 2, 14
v_lshrrev_b32_e64 v99, 18, v99
v_pk_mul_f16 v230, v200, v201
v_mfma_f32_16x16x32_bf16 v[68:71], v[52:55], v[156:159], v[68:71]
ds_read_u16 v98, v98
ds_read_u16_d16_hi v99, v99
v_mfma_f32_16x16x32_f16 v[8:11], v[48:51], v[108:111], v[8:11]
v_exp_f16_sdwa v97, v97 dst_sel:WORD_0 dst_unused:UNUSED_PRESERVE src0_sel:WORD_0
v_or_b32_e64 v114, v32, v33
v_cvt_pkrtz_f16_f32 v135, v134, v135
v_and_b32_e64 v135, s49, v135
v_bfe_u32 v134, v135, 2, 14
v_lshrrev_b32_e64 v135, 18, v135
v_mfma_f32_16x16x32_bf16 v[124:127], v[52:55], v[160:163], v[124:127]
ds_read_u16 v134, v134
ds_read_u16_d16_hi v135, v135
v_mfma_f32_16x16x32_f16 v[172:175], v[48:51], v[140:143], v[172:175]
s_setprio 1
v_or_b32 v231, v202, v203
v_cvt_pkrtz_f16_f32 v43, v42, v43
v_and_b32_e64 v43, s49, v43
v_bfe_u32 v42, v43, 2, 14
v_lshrrev_b32 v43, 18, v43
s_waitcnt lgkmcnt(6)
v_mfma_f32_16x16x32_bf16 v[12:15], v[188:191], v[44:47], v[12:15]
ds_read_u16 v42, v42
ds_read_u16_d16_hi v43, v43
v_mfma_f32_16x16x32_f16 v[92:95], v[48:51], v[64:67], v[92:95]
v_exp_f16_sdwa v97, v97 dst_sel:WORD_1 dst_unused:UNUSED_PRESERVE src0_sel:WORD_1
v_or_b32_e64 v155, v102, v103
v_mfma_f32_16x16x32_bf16 v[68:71], v[188:191], v[144:147], v[68:71]
ds_read_b128 v[180:183], v252 offset:5120
v_or_b32_e64 v115, v34, v35
v_mfma_f32_16x16x32_f16 v[216:219], v[120:123], v[108:111], v[216:219]
v_pk_add_f16 v97, v97, 1.0 op_sel_hi:[1,0]
v_cvt_pk_f16_f32 v12, v12, v13
v_mfma_f32_16x16x32_bf16 v[124:127], v[188:191], v[148:151], v[124:127]
v_rcp_f16_sdwa v97, v97 dst_sel:WORD_0 dst_unused:UNUSED_PRESERVE src0_sel:WORD_0
v_mfma_f32_16x16x32_f16 v[232:235], v[120:123], v[140:143], v[232:235]
ds_read_b128 v[184:187], v252 offset:8192
v_cvt_pkrtz_f16_f32 v69, v68, v69
v_mfma_f32_16x16x32_f16 v[224:227], v[120:123], v[64:67], v[224:227]
v_and_b32 v69, s49, v69
v_bfe_u32 v68, v69, 2, 14
s_waitcnt vmcnt(3)
v_mfma_f32_16x16x32_bf16 v[172:175], v[18:21], v[104:107], v[172:175]
v_lshrrev_b32 v69, 18, v69
v_rcp_f16_sdwa v97, v97 dst_sel:WORD_1 dst_unused:UNUSED_PRESERVE src0_sel:WORD_1
v_mfma_f32_16x16x32_bf16 v[232:235], v[16:19], v[104:107], v[232:235]
ds_read_u16 v68, v68
ds_read_u16_d16_hi v69, v69
s_waitcnt vmcnt(2)
v_mfma_f32_16x16x32_bf16 v[116:119], v[18:21], v[192:195], v[116:119]
v_pk_fma_f16 v13, v12, v12, s48
v_cvt_pkrtz_f16_f32 v125, v124, v125
v_mfma_f32_16x16x32_bf16 v[72:75], v[16:19], v[192:195], v[72:75]
v_and_b32_e64 v125, s49, v125
v_bfe_u32 v124, v125, 2, 14
v_mfma_f32_16x16x32_f16 v[116:119], v[176:179], v[112:115], v[116:119]
v_lshrrev_b32_e64 v125, 18, v125
v_or_b32 v132, v132, v133
v_mfma_f32_16x16x32_f16 v[240:243], v[176:179], v[152:155], v[240:243]
s_setprio 0
ds_read_u16 v124, v124
ds_read_u16_d16_hi v125, v125
v_mfma_f32_16x16x32_f16 v[76:79], v[176:179], v[228:231], v[76:79]
ds_read_b128 v[52:55], v252 offset:6144
v_pk_mul_f16 v13, v12, v13
v_cvt_pkrtz_f16_f32 v15, v14, v15
v_and_b32_e64 v15, s49, v15
v_bfe_u32 v14, v15, 2, 14
v_lshrrev_b32 v15, 18, v15
v_pk_mul_f16 v96, v96, v97
s_waitcnt lgkmcnt(5)
v_mfma_f32_16x16x32_f16 v[72:75], v[4:7], v[112:115], v[72:75]
ds_read_u16 v14, v14
ds_read_u16_d16_hi v15, v15
v_exp_f16_sdwa v13, v13 dst_sel:WORD_0 dst_unused:UNUSED_PRESERVE src0_sel:WORD_0
v_or_b32_e64 v40, v40, v41
v_cvt_pkrtz_f16_f32 v71, v70, v71
v_and_b32_e64 v71, s49, v71
v_bfe_u32 v70, v71, 2, 14
v_lshrrev_b32_e64 v71, 18, v71
v_mfma_f32_16x16x32_f16 v[196:199], v[4:7], v[152:155], v[196:199]
ds_read_u16 v70, v70
ds_read_u16_d16_hi v71, v71
v_or_b32_e64 v97, v98, v99
v_cvt_pkrtz_f16_f32 v127, v126, v127
v_and_b32_e64 v127, s49, v127
v_bfe_u32 v126, v127, 2, 14
v_lshrrev_b32_e64 v127, 18, v127
v_mfma_f32_16x16x32_f16 v[220:223], v[4:7], v[228:231], v[220:223]
ds_read_u16 v126, v126
ds_read_u16_d16_hi v127, v127
v_exp_f16_sdwa v13, v13 dst_sel:WORD_1 dst_unused:UNUSED_PRESERVE src0_sel:WORD_1
v_or_b32_e64 v133, v134, v135
v_mfma_f32_16x16x32_f16 v[164:167], v[180:183], v[112:115], v[164:167]
ds_read_b128 v[48:51], v252 offset:9216
v_or_b32 v41, v42, v43
v_mfma_f32_16x16x32_f16 v[168:171], v[180:183], v[152:155], v[168:171]
v_pk_add_f16 v13, v13, 1.0 op_sel_hi:[1,0]
s_setprio 3
ds_read_b128 v[188:191], v252 offset:10240
v_rcp_f16_sdwa v13, v13 dst_sel:WORD_0 dst_unused:UNUSED_PRESERVE src0_sel:WORD_0
v_mfma_f32_16x16x32_f16 v[84:87], v[180:183], v[228:231], v[84:87]
ds_read_b128 v[120:123], v252 offset:13312
v_rcp_f16_sdwa v13, v13 dst_sel:WORD_1 dst_unused:UNUSED_PRESERVE src0_sel:WORD_1
v_mfma_f32_16x16x32_f16 v[208:211], v[184:187], v[112:115], v[208:211]
ds_read_b128 v[176:179], v252 offset:11264
s_waitcnt lgkmcnt(8)
v_or_b32 v134, v68, v69
v_mfma_f32_16x16x32_f16 v[212:215], v[184:187], v[152:155], v[212:215]
v_pk_mul_f16 v98, v12, v13
v_or_b32_e64 v42, v124, v125
v_mfma_f32_16x16x32_f16 v[236:239], v[184:187], v[228:231], v[236:239]
ds_read_b128 v[4:7], v252 offset:14336
v_or_b32_e64 v99, v14, v15
v_mfma_f32_16x16x32_f16 v[8:11], v[52:55], v[112:115], v[8:11]
ds_read_b128 v[180:183], v252 offset:12288
s_waitcnt lgkmcnt(8)
v_or_b32 v135, v70, v71
v_mfma_f32_16x16x32_f16 v[172:175], v[52:55], v[152:155], v[172:175]
s_setprio 2
s_waitcnt lgkmcnt(6)
v_or_b32_e64 v43, v126, v127
ds_read_b128 v[184:187], v252 offset:15360
v_mfma_f32_16x16x32_f16 v[92:95], v[52:55], v[228:231], v[92:95]
s_waitcnt lgkmcnt(6)
v_mfma_f32_16x16x32_f16 v[216:219], v[48:51], v[112:115], v[216:219]
v_mfma_f32_16x16x32_f16 v[232:235], v[48:51], v[152:155], v[232:235]
v_mfma_f32_16x16x32_f16 v[224:227], v[48:51], v[228:231], v[224:227]
s_waitcnt vmcnt(1)
v_mfma_f32_16x16x32_bf16 v[164:167], v[18:21], v[80:83], v[164:167]
v_mfma_f32_16x16x32_bf16 v[208:211], v[16:19], v[80:83], v[208:211]
s_waitcnt vmcnt(0)
v_mfma_f32_16x16x32_bf16 v[8:11], v[18:21], v[88:91], v[8:11]
v_mfma_f32_16x16x32_bf16 v[216:219], v[16:19], v[88:91], v[216:219]
s_waitcnt lgkmcnt(0)
v_mfma_f32_16x16x32_f16 v[116:119], v[188:191], v[40:43], v[116:119]
v_mfma_f32_16x16x32_f16 v[240:243], v[188:191], v[132:135], v[240:243]
v_mfma_f32_16x16x32_f16 v[76:79], v[188:191], v[96:99], v[76:79]
s_setprio 1
s_nop 4
v_cvt_pk_bf16_f32 v116, v116, v117
v_mfma_f32_16x16x32_f16 v[72:75], v[120:123], v[40:43], v[72:75]
v_cvt_pk_bf16_f32 v117, v118, v119
v_cvt_pk_bf16_f32 v240, v240, v241
v_mfma_f32_16x16x32_f16 v[196:199], v[120:123], v[132:135], v[196:199]
v_cvt_pk_bf16_f32 v76, v76, v77
v_cvt_pk_bf16_f32 v77, v78, v79
v_mfma_f32_16x16x32_f16 v[220:223], v[120:123], v[96:99], v[220:223]
v_cvt_pk_bf16_f32 v241, v242, v243
s_nop 0
v_cvt_pk_bf16_f32 v118, v72, v73
v_mfma_f32_16x16x32_f16 v[164:167], v[176:179], v[40:43], v[164:167]
s_nop 0
v_cvt_pk_bf16_f32 v242, v196, v197
v_cvt_pk_bf16_f32 v243, v198, v199
v_mfma_f32_16x16x32_f16 v[168:171], v[176:179], v[132:135], v[168:171]
v_cvt_pk_bf16_f32 v78, v220, v221
v_cvt_pk_bf16_f32 v79, v222, v223
v_mfma_f32_16x16x32_f16 v[84:87], v[176:179], v[96:99], v[84:87]
v_cvt_pk_bf16_f32 v119, v74, v75
v_cvt_pk_bf16_f32 v164, v164, v165
v_mfma_f32_16x16x32_f16 v[208:211], v[4:7], v[40:43], v[208:211]
s_nop 1
v_cvt_pk_bf16_f32 v168, v168, v169
v_cvt_pk_bf16_f32 v169, v170, v171
v_mfma_f32_16x16x32_f16 v[212:215], v[4:7], v[132:135], v[212:215]
v_cvt_pk_bf16_f32 v84, v84, v85
v_cvt_pk_bf16_f32 v85, v86, v87
v_mfma_f32_16x16x32_f16 v[236:239], v[4:7], v[96:99], v[236:239]
v_cvt_pk_bf16_f32 v165, v166, v167
v_cvt_pk_bf16_f32 v166, v208, v209
v_cvt_pk_bf16_f32 v167, v210, v211
v_mfma_f32_16x16x32_f16 v[8:11], v[180:183], v[40:43], v[8:11]
s_nop 0
v_cvt_pk_bf16_f32 v170, v212, v213
v_cvt_pk_bf16_f32 v171, v214, v215
v_mfma_f32_16x16x32_f16 v[172:175], v[180:183], v[132:135], v[172:175]
v_cvt_pk_bf16_f32 v86, v236, v237
v_cvt_pk_bf16_f32 v87, v238, v239
v_mfma_f32_16x16x32_f16 v[92:95], v[180:183], v[96:99], v[92:95]
s_nop 0
v_cvt_pk_bf16_f32 v8, v8, v9
v_cvt_pk_bf16_f32 v9, v10, v11
v_mfma_f32_16x16x32_f16 v[216:219], v[184:187], v[40:43], v[216:219]
s_nop 0
v_cvt_pk_bf16_f32 v172, v172, v173
v_cvt_pk_bf16_f32 v173, v174, v175
v_mfma_f32_16x16x32_f16 v[232:235], v[184:187], v[132:135], v[232:235]
v_cvt_pk_bf16_f32 v92, v92, v93
v_cvt_pk_bf16_f32 v93, v94, v95
s_setprio 0
v_mfma_f32_16x16x32_f16 v[224:227], v[184:187], v[96:99], v[224:227]
v_cvt_pk_bf16_f32 v10, v216, v217
v_cvt_pk_bf16_f32 v11, v218, v219
s_nop 1
v_cvt_pk_bf16_f32 v174, v232, v233
v_cvt_pk_bf16_f32 v175, v234, v235
s_nop 1
v_cvt_pk_bf16_f32 v94, v224, v225
v_cvt_pk_bf16_f32 v95, v226, v227
buffer_store_dwordx4 v[76:79], v253, s[8:11], s69 offen offset:192 sc1
buffer_store_dwordx4 v[84:87], v253, s[8:11], s69 offen offset:256 sc1
buffer_store_dwordx4 v[92:95], v253, s[8:11], s69 offen offset:320 sc1
buffer_store_dwordx4 v[240:243], v253, s[8:11], s68 offen sc1
buffer_store_dwordx4 v[168:171], v253, s[8:11], s68 offen offset:64 sc1
buffer_store_dwordx4 v[172:175], v253, s[8:11], s68 offen offset:128 sc1
buffer_store_dwordx4 v[116:119], v253, s[8:11], s68 offen offset:192 sc1
buffer_store_dwordx4 v[164:167], v253, s[8:11], s68 offen offset:256 sc1
buffer_store_dwordx4 v[8:11], v253, s[8:11], s68 offen offset:320 sc1
s_endpgm
Lpolln:
s_getreg_b32 s43, hwreg(HW_REG_IB_STS, 0, 4)
s_cmp_eq_u32 s43, 0
s_cbranch_scc1 Lpoll
s_setpc_b64 s[78:79]
Lpoll:
s_waitcnt vmcnt(0)
s_cmp_eq_u32 s77, 2
s_cbranch_scc1 LpollC
v_max_u32 v241, v128, v129
v_max3_u32 v241, v241, v130, v131
v_max3_u32 v241, v241, v132, v133
v_max3_u32 v241, v241, v134, v135
v_max3_u32 v241, v241, v136, v137
v_max3_u32 v241, v241, v138, v139
v_max3_u32 v241, v241, v140, v141
v_max3_u32 v241, v241, v142, v143
v_cmp_eq_u32 vcc, -1, v241
s_nop 4
s_cbranch_vccz LpollR
s_lshl_b32 s44, s2, 12
buffer_load_dwordx4 v[128:131], v245, s[32:35], s44 offen sc1
buffer_load_dwordx4 v[132:135], v245, s[32:35], s44 offen offset:1024 sc1
buffer_load_dwordx4 v[136:139], v245, s[32:35], s44 offen offset:2048 sc1
buffer_load_dwordx4 v[140:143], v245, s[32:35], s44 offen offset:3072 sc1
s_setpc_b64 s[78:79]
LpollR:
v_add_f32 v128, v128, v132
v_add_f32 v140, v136, v140
v_add_f32 v140, v128, v140
v_add_f32 v129, v129, v133
v_add_f32 v141, v137, v141
v_add_f32 v141, v129, v141
v_add_f32 v130, v130, v134
v_add_f32 v142, v138, v142
v_add_f32 v142, v130, v142
v_add_f32 v131, v131, v135
v_add_f32 v143, v139, v143
v_add_f32 v143, v131, v143
v_add_f32_dpp v140, v140, v140 row_ror:8 row_mask:0xf bank_mask:0xf
s_nop 1
v_add_f32_dpp v140, v140, v140 row_ror:4 row_mask:0xf bank_mask:0xf
s_nop 1
v_add_f32_dpp v140, v140, v140 row_ror:2 row_mask:0xf bank_mask:0xf
s_nop 1
v_add_f32_dpp v140, v140, v140 row_ror:1 row_mask:0xf bank_mask:0xf
v_mov_b32 v241, v140
s_nop 1
v_permlane16_swap_b32 v140, v241
v_add_f32 v140, v140, v241
v_mov_b32 v241, v140
s_nop 1
v_permlane32_swap_b32 v140, v241
v_add_f32 v140, v140, v241
v_min_u32 v140, -2, v140
v_add_f32_dpp v141, v141, v141 row_ror:8 row_mask:0xf bank_mask:0xf
s_nop 1
v_add_f32_dpp v141, v141, v141 row_ror:4 row_mask:0xf bank_mask:0xf
s_nop 1
v_add_f32_dpp v141, v141, v141 row_ror:2 row_mask:0xf bank_mask:0xf
s_nop 1
v_add_f32_dpp v141, v141, v141 row_ror:1 row_mask:0xf bank_mask:0xf
v_mov_b32 v241, v141
s_nop 1
v_permlane16_swap_b32 v141, v241
v_add_f32 v141, v141, v241
v_mov_b32 v241, v141
s_nop 1
v_permlane32_swap_b32 v141, v241
v_add_f32 v141, v141, v241
v_min_u32 v141, -2, v141
v_add_f32_dpp v142, v142, v142 row_ror:8 row_mask:0xf bank_mask:0xf
s_nop 1
v_add_f32_dpp v142, v142, v142 row_ror:4 row_mask:0xf bank_mask:0xf
s_nop 1
v_add_f32_dpp v142, v142, v142 row_ror:2 row_mask:0xf bank_mask:0xf
s_nop 1
v_add_f32_dpp v142, v142, v142 row_ror:1 row_mask:0xf bank_mask:0xf
v_mov_b32 v241, v142
s_nop 1
v_permlane16_swap_b32 v142, v241
v_add_f32 v142, v142, v241
v_mov_b32 v241, v142
s_nop 1
v_permlane32_swap_b32 v142, v241
v_add_f32 v142, v142, v241
v_min_u32 v142, -2, v142
v_add_f32_dpp v143, v143, v143 row_ror:8 row_mask:0xf bank_mask:0xf
s_nop 1
v_add_f32_dpp v143, v143, v143 row_ror:4 row_mask:0xf bank_mask:0xf
s_nop 1
v_add_f32_dpp v143, v143, v143 row_ror:2 row_mask:0xf bank_mask:0xf
s_nop 1
v_add_f32_dpp v143, v143, v143 row_ror:1 row_mask:0xf bank_mask:0xf
v_mov_b32 v241, v143
s_nop 1
v_permlane16_swap_b32 v143, v241
v_add_f32 v143, v143, v241
v_mov_b32 v241, v143
s_nop 1
v_permlane32_swap_b32 v143, v241
v_add_f32 v143, v143, v241
v_min_u32 v143, -2, v143
s_lshl_b32 s44, s2, 4
s_add_u32 s44, s44, 393216
v_lshlrev_b32_e64 v241, 9, v240
s_mov_b64 exec, 0xff
buffer_store_dwordx4 v[140:143], v241, s[32:35], s44 offen sc1
s_mov_b64 exec, -1
s_mov_b32 s77, 2
s_and_b32 s44, s2, 7
s_lshl_b32 s44, s44, 11
s_add_u32 s44, s44, 393216
buffer_load_dword v128, v240, s[32:35], s44 offen sc1
buffer_load_dword v129, v240, s[32:35], s44 offen offset:256 sc1
buffer_load_dword v130, v240, s[32:35], s44 offen offset:512 sc1
buffer_load_dword v131, v240, s[32:35], s44 offen offset:768 sc1
buffer_load_dword v132, v240, s[32:35], s44 offen offset:1024 sc1
buffer_load_dword v133, v240, s[32:35], s44 offen offset:1280 sc1
v_lshrrev_b32 v241, 1, v240
buffer_load_ushort v134, v241, s[24:27], 0 offen
buffer_load_ushort v135, v241, s[24:27], 0 offen offset:128
buffer_load_ushort v136, v241, s[24:27], 0 offen offset:256
buffer_load_ushort v137, v241, s[24:27], 0 offen offset:384
buffer_load_ushort v138, v241, s[24:27], 0 offen offset:512
buffer_load_ushort v139, v241, s[24:27], 0 offen offset:640
s_setpc_b64 s[78:79]
LpollC:
v_max3_u32 v241, v128, v129, v130
v_max3_u32 v241, v241, v131, v132
v_max_u32 v241, v241, v133
v_cmp_eq_u32 vcc, -1, v241
s_nop 4
s_cbranch_vccz LpollS
s_and_b32 s44, s2, 7
s_lshl_b32 s44, s44, 11
s_add_u32 s44, s44, 393216
buffer_load_dword v128, v240, s[32:35], s44 offen sc1
buffer_load_dword v129, v240, s[32:35], s44 offen offset:256 sc1
buffer_load_dword v130, v240, s[32:35], s44 offen offset:512 sc1
buffer_load_dword v131, v240, s[32:35], s44 offen offset:768 sc1
buffer_load_dword v132, v240, s[32:35], s44 offen offset:1024 sc1
buffer_load_dword v133, v240, s[32:35], s44 offen offset:1280 sc1
s_setpc_b64 s[78:79]
LpollS:
s_mov_b32 s43, 1083289508
v_mov_b32 v242, 897988541
v_fma_f32 v128, v128, s43, v242
v_sqrt_f32 v128, v128
v_lshlrev_b32_e64 v134, 16, v134
v_fma_f32 v129, v129, s43, v242
v_sqrt_f32 v129, v129
v_lshlrev_b32 v135, 16, v135
v_fma_f32 v130, v130, s43, v242
v_sqrt_f32 v130, v130
v_lshlrev_b32 v136, 16, v136
v_fma_f32 v131, v131, s43, v242
v_sqrt_f32 v131, v131
v_lshlrev_b32 v137, 16, v137
v_fma_f32 v132, v132, s43, v242
v_sqrt_f32 v132, v132
v_lshlrev_b32 v138, 16, v138
v_fma_f32 v133, v133, s43, v242
v_sqrt_f32 v133, v133
v_lshlrev_b32 v139, 16, v139
v_add_f32 v243, v128, v129
v_add_f32 v243, v243, v130
v_add_f32 v243, v243, v131
v_add_f32 v243, v243, v132
v_add_f32 v243, v243, v133
s_nop 1
v_add_f32_dpp v243, v243, v243 row_ror:8 row_mask:0xf bank_mask:0xf
s_nop 1
v_add_f32_dpp v243, v243, v243 row_ror:4 row_mask:0xf bank_mask:0xf
s_nop 1
v_add_f32_dpp v243, v243, v243 row_ror:2 row_mask:0xf bank_mask:0xf
s_nop 1
v_add_f32_dpp v243, v243, v243 row_ror:1 row_mask:0xf bank_mask:0xf
v_mov_b32 v241, v243
s_nop 1
v_permlane16_swap_b32 v243, v241
v_add_f32 v243, v243, v241
v_mov_b32 v241, v243
s_nop 1
v_permlane32_swap_b32 v243, v241
v_add_f32_e64 v243, v243, v241
s_mov_b32 s43, 992651947
v_fma_f32 v243, v243, s43, v242
v_rcp_f32 v243, v243
s_nop 0
v_mul_f32_e64 v128, v128, v243
v_fma_f32 v128, v128, v134, 1.0
v_mul_f32 v128, 3221786265, v128
v_mul_f32_e64 v129, v129, v243
v_fma_f32 v129, v129, v135, 1.0
v_mul_f32 v129, 3221786265, v129
v_mul_f32_e64 v130, v130, v243
v_fma_f32 v130, v130, v136, 1.0
v_mul_f32 v130, 3221786265, v130
v_mul_f32_e64 v131, v131, v243
v_fma_f32 v131, v131, v137, 1.0
v_mul_f32 v131, 3221786265, v131
v_mul_f32_e64 v132, v132, v243
v_fma_f32 v132, v132, v138, 1.0
v_mul_f32 v132, 3221786265, v132
v_mul_f32_e64 v133, v133, v243
v_fma_f32 v133, v133, v139, 1.0
v_mul_f32 v133, 3221786265, v133
s_mov_b32 s77, 0
s_nop 1
s_setpc_b64 s[78:79]
Lend:
s_endpgm

.section .rodata,"a"
.p2align 6
.amdhsa_kernel standalone__modern_conv_block_convnext_v2__vision_kernel
  .amdhsa_next_free_vgpr 256
  .amdhsa_next_free_sgpr 102
  .amdhsa_accum_offset 256
  .amdhsa_group_segment_fixed_size 0
  .amdhsa_kernarg_size 72
  .amdhsa_user_sgpr_count 2
  .amdhsa_user_sgpr_kernarg_segment_ptr 1
  .amdhsa_system_sgpr_workgroup_id_x 1
.end_amdhsa_kernel
```

```asm
; @launch grid=(256,1,1) block=(512,1,1) lds=163840
.amdgcn_target "amdgcn-amd-amdhsa--gfx950"
.text
.globl standalone__modern_conv_block_convnext_v2__vision_kernel
.p2align 8
.type standalone__modern_conv_block_convnext_v2__vision_kernel,@function
standalone__modern_conv_block_convnext_v2__vision_kernel:
s_cmp_ge_u32 s2, 256
s_cbranch_scc1 Lend
s_load_dwordx16 s[80:95], s[0:1], 0
s_load_dwordx2 s[96:97], s[0:1], 64
v_mov_b32 v119, v0
v_and_b32 v118, 63, v0
v_lshrrev_b32 v120, 6, v0
s_nop 0
v_readfirstlane_b32 s40, v120
s_getpc_b64 s[74:75]
Lpc:
s_lshr_b32 s43, s2, 3
s_and_b32 s43, s43, 15
s_lshl_b32 s43, s43, 13
v_lshrrev_b32_e64 v122, 3, v0
v_lshl_add_u32 v122, v122, 7, s43
v_min_u32 v122, Lend-Lpc, v122
global_load_dword v112, v122, s[74:75]
s_and_b32 s43, s2, 7
s_lshr_b32 s44, s2, 3
s_and_b32 s41, s43, 3
s_lshl_b32 s41, s41, 2
s_and_b32 s45, s44, 3
s_add_u32 s41, s41, s45
s_lshr_b32 s42, s43, 2
s_lshl_b32 s42, s42, 3
s_lshr_b32 s45, s44, 2
s_add_u32 s42, s42, s45
s_lshl_b32 s41, s41, 5
s_lshl_b32 s42, s42, 5
s_and_b32 s43, s40, 3
s_mul_i32 s43, s43, 1536
s_add_u32 s67, s43, 90112
s_mul_i32 s44, s41, 192
s_add_u32 s43, s43, s44
s_sub_u32 s43, s43, 192
v_lshl_add_u32 v121, v118, 4, s43
v_add_u32 v123, 896, v121
v_mov_b32 v122, 2147483648
s_mov_b32 s44, 98304
v_cmp_gt_u32 vcc, s44, v121
s_nop 1
v_cndmask_b32 v236, v122, v121, vcc
v_cmp_gt_u32 vcc, s44, v123
s_nop 1
v_cndmask_b32 v237, v122, v123, vcc
s_mul_i32 s66, s42, 98304
v_min_u32 v128, 215, v119
v_lshlrev_b32_e64 v130, 3, v128
v_lshlrev_b32 v250, 4, v118
s_waitcnt lgkmcnt(0)
s_mov_b32 s4, s80
s_and_b32 s5, s81, 65535
s_mov_b32 s6, 50331648
s_mov_b32 s7, 131072
s_cmp_ge_u32 s40, 4
s_cbranch_scc1 Lrowb
s_mov_b32 s20, s82
s_and_b32 s21, s83, 65535
s_mov_b32 s22, 1728
s_mov_b32 s23, 131072
buffer_load_dwordx2 v[126:127], v130, s[20:23], 0 offen
s_add_u32 m0, s67, 0
s_sub_u32 s45, s66, 98304
s_cmp_eq_u32 s42, 0
s_cselect_b32 s45, 1073741824, s45
buffer_load_dwordx4 v236, s[4:7], s45 offen lds
s_add_u32 m0, s67, 6592
s_nop 0
buffer_load_dwordx4 v236, s[4:7], s66 offen lds
s_add_u32 m0, s67, 13200
s_add_u32 s66, s66, 98304
buffer_load_dwordx4 v236, s[4:7], s66 offen lds
s_add_u32 m0, s67, 19792
s_add_u32 s66, s66, 98304
buffer_load_dwordx4 v236, s[4:7], s66 offen lds
s_add_u32 m0, s67, 26400
s_add_u32 s66, s66, 98304
buffer_load_dwordx4 v236, s[4:7], s66 offen lds
s_add_u32 m0, s67, 32992
s_add_u32 s66, s66, 98304
buffer_load_dwordx4 v236, s[4:7], s66 offen lds
s_add_u32 m0, s67, 39600
s_add_u32 s66, s66, 98304
buffer_load_dwordx4 v236, s[4:7], s66 offen lds
s_add_u32 m0, s67, 46192
s_add_u32 s66, s66, 98304
buffer_load_dwordx4 v236, s[4:7], s66 offen lds
s_add_u32 m0, s67, 52736
s_add_u32 s66, s66, 98304
buffer_load_dwordx4 v236, s[4:7], s66 offen lds
s_add_u32 m0, s67, 59328
s_add_u32 s66, s66, 98304
buffer_load_dwordx4 v236, s[4:7], s66 offen lds
s_branch Lsetup
Lrowb:
s_add_u32 m0, s67, 896
s_sub_u32 s45, s66, 98304
s_cmp_eq_u32 s42, 0
s_cselect_b32 s45, 1073741824, s45
buffer_load_dwordx4 v237, s[4:7], s45 offen lds
s_add_u32 m0, s67, 7488
s_nop 0
buffer_load_dwordx4 v237, s[4:7], s66 offen lds
s_add_u32 m0, s67, 14096
s_add_u32 s66, s66, 98304
buffer_load_dwordx4 v237, s[4:7], s66 offen lds
s_add_u32 m0, s67, 20688
s_add_u32 s66, s66, 98304
buffer_load_dwordx4 v237, s[4:7], s66 offen lds
s_add_u32 m0, s67, 27296
s_add_u32 s66, s66, 98304
buffer_load_dwordx4 v237, s[4:7], s66 offen lds
s_add_u32 m0, s67, 33888
s_add_u32 s66, s66, 98304
buffer_load_dwordx4 v237, s[4:7], s66 offen lds
s_add_u32 m0, s67, 40496
s_add_u32 s66, s66, 98304
buffer_load_dwordx4 v237, s[4:7], s66 offen lds
s_add_u32 m0, s67, 47088
s_add_u32 s66, s66, 98304
buffer_load_dwordx4 v237, s[4:7], s66 offen lds
s_add_u32 m0, s67, 53632
s_add_u32 s66, s66, 98304
buffer_load_dwordx4 v237, s[4:7], s66 offen lds
s_add_u32 m0, s67, 60224
s_add_u32 s66, s66, 98304
buffer_load_dwordx4 v237, s[4:7], s66 offen lds
s_mov_b32 s12, s84
s_and_b32 s13, s85, 65535
s_mov_b32 s14, 73728
s_mov_b32 s15, 131072
v_lshrrev_b32 v115, 2, v118
v_mul_u32_u24 v115, 768, v115
v_and_b32_e64 v125, 3, v118
v_lshl_add_u32 v115, v125, 4, v115
s_and_b32 s43, s40, 3
s_add_u32 s43, s43, 0
s_mul_i32 s44, s43, 43
s_lshr_b32 s44, s44, 8
s_lshl_b32 s46, s43, 10
s_add_u32 m0, s46, 16384
s_mul_i32 s46, s44, 6
s_sub_u32 s43, s43, s46
s_mul_i32 s43, s43, 12288
s_lshl_b32 s44, s44, 6
s_add_u32 s43, s43, s44
buffer_load_dwordx4 v115, s[12:15], s43 offen lds
s_and_b32 s43, s40, 3
s_add_u32 s43, s43, 4
s_mul_i32 s44, s43, 43
s_lshr_b32 s44, s44, 8
s_lshl_b32 s46, s43, 10
s_add_u32 m0, s46, 16384
s_mul_i32 s46, s44, 6
s_sub_u32 s43, s43, s46
s_mul_i32 s43, s43, 12288
s_lshl_b32 s44, s44, 6
s_add_u32 s43, s43, s44
buffer_load_dwordx4 v115, s[12:15], s43 offen lds
s_and_b32 s43, s40, 3
s_add_u32 s43, s43, 8
s_mul_i32 s44, s43, 43
s_lshr_b32 s44, s44, 8
s_lshl_b32 s46, s43, 10
s_add_u32 m0, s46, 16384
s_mul_i32 s46, s44, 6
s_sub_u32 s43, s43, s46
s_mul_i32 s43, s43, 12288
s_lshl_b32 s44, s44, 6
s_add_u32 s43, s43, s44
buffer_load_dwordx4 v115, s[12:15], s43 offen lds
s_and_b32 s43, s40, 3
s_add_u32 s43, s43, 12
s_mul_i32 s44, s43, 43
s_lshr_b32 s44, s44, 8
s_lshl_b32 s46, s43, 10
s_add_u32 m0, s46, 16384
s_mul_i32 s46, s44, 6
s_sub_u32 s43, s43, s46
s_mul_i32 s43, s43, 12288
s_lshl_b32 s44, s44, 6
s_add_u32 s43, s43, s44
buffer_load_dwordx4 v115, s[12:15], s43 offen lds
s_and_b32 s43, s40, 3
s_add_u32 s43, s43, 16
s_mul_i32 s44, s43, 43
s_lshr_b32 s44, s44, 8
s_lshl_b32 s46, s43, 10
s_add_u32 m0, s46, 16384
s_mul_i32 s46, s44, 6
s_sub_u32 s43, s43, s46
s_mul_i32 s43, s43, 12288
s_lshl_b32 s44, s44, 6
s_add_u32 s43, s43, s44
buffer_load_dwordx4 v115, s[12:15], s43 offen lds
s_and_b32 s43, s40, 3
s_add_u32 s43, s43, 20
s_mul_i32 s44, s43, 43
s_lshr_b32 s44, s44, 8
s_lshl_b32 s46, s43, 10
s_add_u32 m0, s46, 16384
s_mul_i32 s46, s44, 6
s_sub_u32 s43, s43, s46
s_mul_i32 s43, s43, 12288
s_lshl_b32 s44, s44, 6
s_add_u32 s43, s43, s44
buffer_load_dwordx4 v115, s[12:15], s43 offen lds
v_bfe_u32 v141, v250, 4, 6
v_and_b32 v140, 15, v141
v_lshlrev_b32 v140, 7, v140
v_lshrrev_b32 v141, 4, v141
v_mul_u32_u24 v141, 98304, v141
s_sub_u32 s43, s67, -8000
s_mul_i32 s44, s41, 192
s_add_u32 s43, s43, s44
v_add3_u32 v140, v140, v141, s43
s_mov_b32 m0, 163840
s_add_u32 s44, s66, 393216
buffer_load_dword v140, s[4:7], s66 offen lds
buffer_load_dword v140, s[4:7], s44 offen lds
s_waitcnt vmcnt(8)
s_barrier
s_setprio 0
s_and_b32 s43, s40, 3
s_add_u32 s43, s43, 24
s_mul_i32 s44, s43, 43
s_lshr_b32 s44, s44, 8
s_lshl_b32 s46, s43, 10
s_add_u32 m0, s46, 16384
s_mul_i32 s46, s44, 6
s_sub_u32 s43, s43, s46
s_mul_i32 s43, s43, 12288
s_lshl_b32 s44, s44, 6
s_add_u32 s43, s43, s44
buffer_load_dwordx4 v115, s[12:15], s43 offen lds
s_and_b32 s43, s40, 3
s_add_u32 s43, s43, 28
s_mul_i32 s44, s43, 43
s_lshr_b32 s44, s44, 8
s_lshl_b32 s46, s43, 10
s_add_u32 m0, s46, 16384
s_mul_i32 s46, s44, 6
s_sub_u32 s43, s43, s46
s_mul_i32 s43, s43, 12288
s_lshl_b32 s44, s44, 6
s_add_u32 s43, s43, s44
buffer_load_dwordx4 v115, s[12:15], s43 offen lds
s_and_b32 s43, s40, 3
s_add_u32 s43, s43, 32
s_mul_i32 s44, s43, 43
s_lshr_b32 s44, s44, 8
s_lshl_b32 s46, s43, 10
s_add_u32 m0, s46, 16384
s_mul_i32 s46, s44, 6
s_sub_u32 s43, s43, s46
s_mul_i32 s43, s43, 12288
s_lshl_b32 s44, s44, 6
s_add_u32 s43, s43, s44
buffer_load_dwordx4 v115, s[12:15], s43 offen lds
s_and_b32 s43, s40, 3
s_add_u32 s43, s43, 36
s_mul_i32 s44, s43, 43
s_lshr_b32 s44, s44, 8
s_lshl_b32 s46, s43, 10
s_add_u32 m0, s46, 16384
s_mul_i32 s46, s44, 6
s_sub_u32 s43, s43, s46
s_mul_i32 s43, s43, 12288
s_lshl_b32 s44, s44, 6
s_add_u32 s43, s43, s44
buffer_load_dwordx4 v115, s[12:15], s43 offen lds
s_and_b32 s43, s40, 3
s_add_u32 s43, s43, 40
s_mul_i32 s44, s43, 43
s_lshr_b32 s44, s44, 8
s_lshl_b32 s46, s43, 10
s_add_u32 m0, s46, 16384
s_mul_i32 s46, s44, 6
s_sub_u32 s43, s43, s46
s_mul_i32 s43, s43, 12288
s_lshl_b32 s44, s44, 6
s_add_u32 s43, s43, s44
buffer_load_dwordx4 v115, s[12:15], s43 offen lds
s_and_b32 s43, s40, 3
s_add_u32 s43, s43, 44
s_mul_i32 s44, s43, 43
s_lshr_b32 s44, s44, 8
s_lshl_b32 s46, s43, 10
s_add_u32 m0, s46, 16384
s_mul_i32 s46, s44, 6
s_sub_u32 s43, s43, s46
s_mul_i32 s43, s43, 12288
s_lshl_b32 s44, s44, 6
s_add_u32 s43, s43, s44
buffer_load_dwordx4 v115, s[12:15], s43 offen lds
s_and_b32 s43, s40, 3
s_add_u32 s43, s43, 48
s_mul_i32 s44, s43, 43
s_lshr_b32 s44, s44, 8
s_lshl_b32 s46, s43, 10
s_add_u32 m0, s46, 16384
s_mul_i32 s46, s44, 6
s_sub_u32 s43, s43, s46
s_mul_i32 s43, s43, 12288
s_lshl_b32 s44, s44, 6
s_add_u32 s43, s43, s44
buffer_load_dwordx4 v115, s[12:15], s43 offen lds
s_and_b32 s43, s40, 3
s_add_u32 s43, s43, 52
s_mul_i32 s44, s43, 43
s_lshr_b32 s44, s44, 8
s_lshl_b32 s46, s43, 10
s_add_u32 m0, s46, 16384
s_mul_i32 s46, s44, 6
s_sub_u32 s43, s43, s46
s_mul_i32 s43, s43, 12288
s_lshl_b32 s44, s44, 6
s_add_u32 s43, s43, s44
buffer_load_dwordx4 v115, s[12:15], s43 offen lds
s_and_b32 s43, s40, 3
s_add_u32 s43, s43, 56
s_mul_i32 s44, s43, 43
s_lshr_b32 s44, s44, 8
s_lshl_b32 s46, s43, 10
s_add_u32 m0, s46, 16384
s_mul_i32 s46, s44, 6
s_sub_u32 s43, s43, s46
s_mul_i32 s43, s43, 12288
s_lshl_b32 s44, s44, 6
s_add_u32 s43, s43, s44
buffer_load_dwordx4 v115, s[12:15], s43 offen lds
s_and_b32 s43, s40, 3
s_add_u32 s43, s43, 60
s_mul_i32 s44, s43, 43
s_lshr_b32 s44, s44, 8
s_lshl_b32 s46, s43, 10
s_add_u32 m0, s46, 16384
s_mul_i32 s46, s44, 6
s_sub_u32 s43, s43, s46
s_mul_i32 s43, s43, 12288
s_lshl_b32 s44, s44, 6
s_add_u32 s43, s43, s44
buffer_load_dwordx4 v115, s[12:15], s43 offen lds
s_and_b32 s43, s40, 3
s_add_u32 s43, s43, 64
s_mul_i32 s44, s43, 43
s_lshr_b32 s44, s44, 8
s_lshl_b32 s46, s43, 10
s_add_u32 m0, s46, 16384
s_mul_i32 s46, s44, 6
s_sub_u32 s43, s43, s46
s_mul_i32 s43, s43, 12288
s_lshl_b32 s44, s44, 6
s_add_u32 s43, s43, s44
buffer_load_dwordx4 v115, s[12:15], s43 offen lds
s_and_b32 s43, s40, 3
s_add_u32 s43, s43, 68
s_mul_i32 s44, s43, 43
s_lshr_b32 s44, s44, 8
s_lshl_b32 s46, s43, 10
s_add_u32 m0, s46, 16384
s_mul_i32 s46, s44, 6
s_sub_u32 s43, s43, s46
s_mul_i32 s43, s43, 12288
s_lshl_b32 s44, s44, 6
s_add_u32 s43, s43, s44
buffer_load_dwordx4 v115, s[12:15], s43 offen lds
Lsetup:
s_mov_b32 s16, s86
s_and_b32 s17, s87, 65535
s_mov_b32 s18, 73728
s_mov_b32 s19, 131072
s_mov_b32 s24, s88
s_and_b32 s25, s89, 65535
s_mov_b32 s26, 768
s_mov_b32 s27, 131072
s_mov_b32 s28, s90
s_and_b32 s29, s91, 65535
s_mov_b32 s30, 768
s_mov_b32 s31, 131072
s_mov_b32 s8, s92
s_and_b32 s9, s93, 65535
s_mov_b32 s10, 50331648
s_mov_b32 s11, 131072
s_mov_b32 s36, s94
s_and_b32 s37, s95, 65535
s_mov_b32 s38, 256
s_mov_b32 s39, 131072
s_mov_b32 s32, s96
s_and_b32 s33, s97, 65535
s_mov_b32 s34, 83886080
s_mov_b32 s35, 131072
v_lshlrev_b32_e64 v250, 4, v118
v_add_u32 v250, 16384, v250
v_lshlrev_b32_e64 v251, 4, v118
v_add_u32 v251, 81920, v251
v_lshlrev_b32_e64 v252, 4, v118
v_add_u32 v252, 147456, v252
s_lshl_b32 s73, s2, 3
s_add_u32 s73, s73, s40
s_lshl_b32 s80, s73, 10
s_add_u32 s80, s80, 4177920
s_mul_i32 s73, s73, 16
s_add_u32 s73, s73, 1048576
s_mov_b32 s48, 1156203754
s_mov_b32 s49, 4294508536
v_and_b32 v131, 15, v118
v_lshrrev_b32 v132, 4, v118
v_and_b32_e64 v133, 3, v131
v_mul_u32_u24 v134, 13200, v133
v_lshrrev_b32_e64 v133, 2, v131
v_lshl_add_u32 v133, v133, 1, v132
v_mul_u32_u24 v133, 192, v133
s_sub_u32 s43, s67, 90112
v_add3_u32 v246, v133, v134, s43
v_bfe_u32 v133, v131, 2, 1
v_sub_u32 v133, v132, v133
v_lshrrev_b32 v134, 3, v131
v_and_b32_e64 v135, 3, v131
v_lshl_add_u32 v135, v134, 2, v135
v_lshlrev_b32_e64 v136, 6, v133
v_lshl_add_u32 v136, v135, 3, v136
v_add_u32 v136, 156040, v136
v_mov_b32 v137, 156032
v_cmp_gt_u32 vcc, 3, v133
s_nop 1
v_cndmask_b32 v136, v137, v136, vcc
v_cmp_eq_u32 vcc, 0, v134
s_nop 1
v_cndmask_b32 v238, v137, v136, vcc
v_cndmask_b32 v239, v136, v137, vcc
v_lshrrev_b32 v133, 2, v131
v_bfe_u32 v135, v131, 1, 1
v_cmp_eq_u32 vcc, v133, v132
s_nop 1
v_cndmask_b32 v135, 8, v135, vcc
v_cmp_eq_u32 s[88:89], 0, v135
v_cmp_eq_u32 s[90:91], 1, v135
v_lshlrev_b32 v254, 5, v132
v_add_u32 v254, 7936, v254
v_lshlrev_b32 v253, 4, v132
v_and_b32 v131, 31, v118
v_lshrrev_b32_e64 v132, 5, v118
v_bfe_u32 v133, v131, 2, 1
v_bfe_u32 v134, v131, 3, 1
v_bfe_u32 v135, v131, 1, 1
v_lshrrev_b32 v136, 4, v131
v_lshl_add_u32 v135, v136, 1, v135
v_lshl_add_u32 v135, v134, 2, v135
v_cmp_eq_u32 vcc, v133, v132
s_nop 1
v_cndmask_b32 v135, 8, v135, vcc
v_cmp_eq_u32 s[50:51], 0, v135
v_cmp_eq_u32 s[52:53], 1, v135
v_cmp_eq_u32 s[54:55], 2, v135
v_cmp_eq_u32 s[56:57], 3, v135
v_cmp_eq_u32 s[58:59], 4, v135
v_cmp_eq_u32 s[60:61], 5, v135
v_cmp_eq_u32 s[62:63], 6, v135
v_cmp_eq_u32 s[64:65], 7, v135
v_and_b32 v136, 1, v131
v_lshlrev_b32 v136, 4, v136
v_mov_b32 v255, 16256
v_lshlrev_b32 v255, v136, v255
v_and_b32 v137, 19, v131
v_lshl_add_u32 v137, v133, 3, v137
v_lshl_add_u32 v137, v134, 2, v137
v_lshlrev_b32_e64 v137, 2, v137
v_lshl_add_u32 v137, v132, 7, v137
s_mul_i32 s82, s40, 9216
s_add_u32 s72, s82, 90112
v_add_u32 v248, s72, v137
v_and_b32 v133, 3, v118
v_mul_u32_u24 v134, 196608, v133
v_bfe_u32 v133, v118, 2, 2
v_mul_u32_u24 v133, 384, v133
v_add3_u32 v253, v253, v133, v134
s_mul_i32 s46, s41, 192
s_add_u32 s46, s46, s67
s_sub_u32 s46, s46, 90112
s_and_b32 s83, s40, 4
s_lshl_b32 s44, s83, 1
s_add_u32 s44, s44, s42
s_add_u32 s43, s44, 0
s_mul_i32 s43, s43, 98304
s_add_u32 s68, s43, s46
s_add_u32 s43, s44, 1
s_mul_i32 s43, s43, 98304
s_add_u32 s69, s43, s46
s_add_u32 s43, s44, 16
s_mul_i32 s43, s43, 98304
s_add_u32 s70, s43, s46
s_add_u32 s43, s44, 17
s_mul_i32 s43, s43, 98304
s_add_u32 s71, s43, s46
s_mov_b32 s92, 2863311530
s_mov_b32 s94, 3435973836
s_mov_b32 s93, 2863311530
s_mov_b32 s95, 3435973836
s_mov_b32 s81, 59328
s_mov_b32 s76, 200000
v_mov_b32 v247, 8128
v_lshrrev_b32 v148, 5, v118
v_lshlrev_b32 v116, 8, v148
v_bfe_u32 v148, v118, 2, 2
v_lshl_add_u32 v116, v148, 6, v116
v_bfe_u32 v148, v118, 4, 1
v_lshl_add_u32 v116, v148, 5, v116
v_and_b32_e64 v148, 1, v118
v_lshl_add_u32 v116, v148, 4, v116
v_bfe_u32 v148, v118, 1, 1
v_lshl_add_u32 v116, v148, 3, v116
s_and_b32 s43, s40, 3
s_lshl_b32 s43, s43, 10
v_add_u32_e64 v117, s43, v250
s_add_u32 s43, s43, 16384
v_add_u32 v116, s43, v116
v_mov_b32 v224, 0
v_mov_b32 v225, 0
v_mov_b32 v226, 0
v_mov_b32 v227, 0
v_mov_b32 v228, 0
v_mov_b32 v229, 0
v_mov_b32 v230, 0
v_mov_b32 v231, 0
v_mov_b32 v232, 0
v_mov_b32 v233, 0
v_mov_b32 v234, 0
v_mov_b32 v235, 0
s_cmp_ge_u32 s40, 4
s_cbranch_scc1 Lwa
v_mov_b32 v65, 0
v_mov_b32 v67, 0
v_mov_b32 v68, 0
v_mov_b32 v70, 0
v_mov_b32 v72, 0
v_mov_b32 v73, 0
v_min_u32 v140, 35, v119
v_mul_u32_u24 v140, 200, v140
v_add_u32 v140, 156032, v140
v_and_b32 v141, 31, v119
v_lshlrev_b32 v141, 3, v141
v_bfe_u32 v142, v119, 5, 1
v_lshl_add_u32 v141, v142, 13, v141
v_add_u32 v141, 7936, v141
v_cmp_gt_u32 vcc, 64, v119
s_nop 1
v_cndmask_b32 v140, v141, v140, vcc
ds_write_b64 v140, v[72:73]
v_lshrrev_b32 v140, 1, v128
v_mul_u32_u24 v141, 57, v140
v_lshrrev_b32 v141, 11, v141
v_mul_u32_u24 v142, 171, v140
v_lshrrev_b32_e64 v142, 11, v142
v_mul_u32_u24 v140, 200, v140
v_mul_u32_u24 v142, 2336, v142
v_mul_u32_u24 v141, 2208, v141
v_sub_u32 v140, v140, v142
v_add_u32 v140, v140, v141
v_and_b32_e64 v141, 1, v128
v_lshl_add_u32 v140, v141, 5, v140
v_add_u32 v140, 156040, v140
v_and_b32 v120, 255, v119
v_lshlrev_b32 v121, 8, v120
v_add_u32 v0, 4, v121
v_cvt_f32_f16 v0, v0
v_add_u32 v1, 12, v121
v_cvt_f32_f16 v1, v1
v_add_u32 v2, 20, v121
v_cvt_f32_f16 v2, v2
v_add_u32 v3, 28, v121
v_cvt_f32_f16 v3, v3
v_add_u32 v4, 36, v121
v_cvt_f32_f16 v4, v4
v_add_u32 v5, 44, v121
v_cvt_f32_f16 v5, v5
v_add_u32 v6, 52, v121
v_cvt_f32_f16 v6, v6
v_add_u32 v7, 60, v121
v_cvt_f32_f16_e64 v7, v7
v_add_u32 v8, 68, v121
v_cvt_f32_f16_e64 v8, v8
v_add_u32 v9, 76, v121
v_cvt_f32_f16_e64 v9, v9
v_add_u32 v10, 84, v121
v_cvt_f32_f16_e64 v10, v10
v_add_u32 v11, 92, v121
v_cvt_f32_f16_e64 v11, v11
v_add_u32 v12, 100, v121
v_cvt_f32_f16_e64 v12, v12
v_add_u32 v13, 108, v121
v_cvt_f32_f16_e64 v13, v13
v_add_u32 v14, 116, v121
v_cvt_f32_f16_e64 v14, v14
v_add_u32 v15, 124, v121
v_cvt_f32_f16_e64 v15, v15
v_add_u32 v16, 132, v121
v_cvt_f32_f16_e64 v16, v16
v_add_u32 v17, 140, v121
v_cvt_f32_f16_e64 v17, v17
v_add_u32 v18, 148, v121
v_cvt_f32_f16_e64 v18, v18
v_add_u32 v19, 156, v121
v_cvt_f32_f16_e64 v19, v19
v_add_u32 v20, 164, v121
v_cvt_f32_f16_e64 v20, v20
v_add_u32 v21, 172, v121
v_cvt_f32_f16_e64 v21, v21
v_add_u32 v22, 180, v121
v_cvt_f32_f16_e64 v22, v22
v_add_u32 v23, 188, v121
v_cvt_f32_f16_e64 v23, v23
v_add_u32 v24, 196, v121
v_cvt_f32_f16_e64 v24, v24
v_add_u32 v25, 204, v121
v_cvt_f32_f16_e64 v25, v25
v_add_u32 v26, 212, v121
v_cvt_f32_f16_e64 v26, v26
v_add_u32 v27, 220, v121
v_cvt_f32_f16_e64 v27, v27
v_add_u32 v28, 228, v121
v_cvt_f32_f16_e64 v28, v28
v_add_u32 v29, 236, v121
v_cvt_f32_f16_e64 v29, v29
v_add_u32 v30, 244, v121
v_cvt_f32_f16_e64 v30, v30
v_add_u32 v31, 252, v121
v_cvt_f32_f16_e64 v31, v31
v_fmaak_f32 v32, v0, v0, 0x409d30fc
v_mul_f32_e64 v32, v0, v32
v_fmaak_f32 v33, v1, v1, 0x409d30fc
v_mul_f32_e64 v33, v1, v33
v_fmaak_f32 v34, v2, v2, 0x409d30fc
v_mul_f32_e64 v34, v2, v34
v_fmaak_f32 v35, v3, v3, 0x409d30fc
v_mul_f32_e64 v35, v3, v35
v_fmaak_f32 v36, v4, v4, 0x409d30fc
v_mul_f32_e64 v36, v4, v36
v_fmaak_f32 v37, v5, v5, 0x409d30fc
v_mul_f32_e64 v37, v5, v37
v_fmaak_f32 v38, v6, v6, 0x409d30fc
v_mul_f32_e64 v38, v6, v38
v_fmaak_f32 v39, v7, v7, 0x409d30fc
v_mul_f32_e64 v39, v7, v39
v_fmaak_f32 v40, v8, v8, 0x409d30fc
v_mul_f32_e64 v40, v8, v40
v_fmaak_f32 v41, v9, v9, 0x409d30fc
v_mul_f32_e64 v41, v9, v41
v_fmaak_f32 v42, v10, v10, 0x409d30fc
v_mul_f32_e64 v42, v10, v42
v_fmaak_f32 v43, v11, v11, 0x409d30fc
v_mul_f32_e64 v43, v11, v43
v_fmaak_f32 v44, v12, v12, 0x409d30fc
v_mul_f32_e64 v44, v12, v44
v_fmaak_f32 v45, v13, v13, 0x409d30fc
v_mul_f32_e64 v45, v13, v45
v_fmaak_f32 v46, v14, v14, 0x409d30fc
v_mul_f32_e64 v46, v14, v46
v_fmaak_f32 v47, v15, v15, 0x409d30fc
v_mul_f32_e64 v47, v15, v47
v_fmaak_f32 v48, v16, v16, 0x409d30fc
v_mul_f32_e64 v48, v16, v48
v_fmaak_f32 v49, v17, v17, 0x409d30fc
v_mul_f32_e64 v49, v17, v49
v_fmaak_f32 v50, v18, v18, 0x409d30fc
v_mul_f32_e64 v50, v18, v50
v_fmaak_f32 v51, v19, v19, 0x409d30fc
v_mul_f32_e64 v51, v19, v51
v_fmaak_f32 v52, v20, v20, 0x409d30fc
v_mul_f32_e64 v52, v20, v52
v_fmaak_f32 v53, v21, v21, 0x409d30fc
v_mul_f32_e64 v53, v21, v53
v_fmaak_f32 v54, v22, v22, 0x409d30fc
v_mul_f32_e64 v54, v22, v54
v_fmaak_f32 v55, v23, v23, 0x409d30fc
v_mul_f32_e64 v55, v23, v55
v_fmaak_f32 v56, v24, v24, 0x409d30fc
v_mul_f32_e64 v56, v24, v56
v_fmaak_f32 v57, v25, v25, 0x409d30fc
v_mul_f32_e64 v57, v25, v57
v_fmaak_f32 v58, v26, v26, 0x409d30fc
v_mul_f32_e64 v58, v26, v58
v_fmaak_f32 v59, v27, v27, 0x409d30fc
v_mul_f32_e64 v59, v27, v59
v_fmaak_f32 v60, v28, v28, 0x409d30fc
v_mul_f32_e64 v60, v28, v60
v_fmaak_f32 v61, v29, v29, 0x409d30fc
v_mul_f32_e64 v61, v29, v61
v_fmaak_f32 v62, v30, v30, 0x409d30fc
v_mul_f32_e64 v62, v30, v62
v_fmaak_f32 v63, v31, v31, 0x409d30fc
v_mul_f32 v63, v31, v63
v_exp_f32 v32, v32
v_exp_f32 v33, v33
v_exp_f32 v34, v34
v_exp_f32 v35, v35
v_exp_f32 v36, v36
v_exp_f32 v37, v37
v_exp_f32 v38, v38
v_exp_f32 v39, v39
v_exp_f32 v40, v40
v_exp_f32 v41, v41
v_exp_f32 v42, v42
v_exp_f32 v43, v43
v_exp_f32 v44, v44
v_exp_f32 v45, v45
v_exp_f32 v46, v46
v_exp_f32 v47, v47
v_exp_f32 v48, v48
v_exp_f32 v49, v49
v_exp_f32 v50, v50
v_exp_f32 v51, v51
v_exp_f32 v52, v52
v_exp_f32 v53, v53
v_exp_f32 v54, v54
v_exp_f32 v55, v55
v_exp_f32 v56, v56
v_exp_f32 v57, v57
v_exp_f32 v58, v58
v_exp_f32 v59, v59
v_exp_f32 v60, v60
v_exp_f32 v61, v61
v_exp_f32 v62, v62
v_exp_f32 v63, v63
v_add_f32 v32, 1.0, v32
v_add_f32 v33, 1.0, v33
v_add_f32 v34, 1.0, v34
v_add_f32 v35, 1.0, v35
v_add_f32 v36, 1.0, v36
v_add_f32 v37, 1.0, v37
v_add_f32 v38, 1.0, v38
v_add_f32 v39, 1.0, v39
v_add_f32 v40, 1.0, v40
v_add_f32 v41, 1.0, v41
v_add_f32 v42, 1.0, v42
v_add_f32 v43, 1.0, v43
v_add_f32 v44, 1.0, v44
v_add_f32 v45, 1.0, v45
v_add_f32 v46, 1.0, v46
v_add_f32 v47, 1.0, v47
v_add_f32 v48, 1.0, v48
v_add_f32 v49, 1.0, v49
v_add_f32 v50, 1.0, v50
v_add_f32 v51, 1.0, v51
v_add_f32 v52, 1.0, v52
v_add_f32 v53, 1.0, v53
v_add_f32 v54, 1.0, v54
v_add_f32 v55, 1.0, v55
v_add_f32 v56, 1.0, v56
v_add_f32 v57, 1.0, v57
v_add_f32 v58, 1.0, v58
v_add_f32 v59, 1.0, v59
v_add_f32 v60, 1.0, v60
v_add_f32 v61, 1.0, v61
v_add_f32 v62, 1.0, v62
v_add_f32 v63, 1.0, v63
v_rcp_f32 v32, v32
v_rcp_f32 v33, v33
v_rcp_f32 v34, v34
v_rcp_f32 v35, v35
v_rcp_f32 v36, v36
v_rcp_f32 v37, v37
v_rcp_f32 v38, v38
v_rcp_f32 v39, v39
v_rcp_f32 v40, v40
v_rcp_f32 v41, v41
v_rcp_f32 v42, v42
v_rcp_f32 v43, v43
v_rcp_f32 v44, v44
v_rcp_f32 v45, v45
v_rcp_f32 v46, v46
v_rcp_f32 v47, v47
v_rcp_f32 v48, v48
v_rcp_f32 v49, v49
v_rcp_f32 v50, v50
v_rcp_f32 v51, v51
v_rcp_f32 v52, v52
v_rcp_f32 v53, v53
v_rcp_f32 v54, v54
v_rcp_f32 v55, v55
v_rcp_f32 v56, v56
v_rcp_f32 v57, v57
v_rcp_f32 v58, v58
v_rcp_f32 v59, v59
v_rcp_f32 v60, v60
v_rcp_f32 v61, v61
v_rcp_f32 v62, v62
v_rcp_f32 v63, v63
v_mul_f32 v0, v0, v32
v_mul_f32 v1, v1, v33
v_mul_f32 v2, v2, v34
v_mul_f32 v3, v3, v35
v_mul_f32 v4, v4, v36
v_mul_f32 v5, v5, v37
v_mul_f32 v6, v6, v38
v_mul_f32 v7, v7, v39
v_mul_f32 v8, v8, v40
v_mul_f32 v9, v9, v41
v_mul_f32 v10, v10, v42
v_mul_f32 v11, v11, v43
v_mul_f32 v12, v12, v44
v_mul_f32 v13, v13, v45
v_mul_f32 v14, v14, v46
v_mul_f32 v15, v15, v47
v_mul_f32 v16, v16, v48
v_mul_f32 v17, v17, v49
v_mul_f32 v18, v18, v50
v_mul_f32 v19, v19, v51
v_mul_f32 v20, v20, v52
v_mul_f32 v21, v21, v53
v_mul_f32 v22, v22, v54
v_mul_f32 v23, v23, v55
v_mul_f32 v24, v24, v56
v_mul_f32 v25, v25, v57
v_mul_f32 v26, v26, v58
v_mul_f32 v27, v27, v59
v_mul_f32 v28, v28, v60
v_mul_f32 v29, v29, v61
v_mul_f32 v30, v30, v62
v_mul_f32_e64 v31, v31, v63
v_cvt_pk_f16_f32 v32, v0, v1
v_cvt_pk_f16_f32 v33, v2, v3
v_cvt_pk_f16_f32 v34, v4, v5
v_cvt_pk_f16_f32 v35, v6, v7
v_cvt_pk_f16_f32 v36, v8, v9
v_cvt_pk_f16_f32 v37, v10, v11
v_cvt_pk_f16_f32 v38, v12, v13
v_cvt_pk_f16_f32 v39, v14, v15
v_cvt_pk_f16_f32 v40, v16, v17
v_cvt_pk_f16_f32 v41, v18, v19
v_cvt_pk_f16_f32 v42, v20, v21
v_cvt_pk_f16_f32 v43, v22, v23
v_cvt_pk_f16_f32 v44, v24, v25
v_cvt_pk_f16_f32 v45, v26, v27
v_cvt_pk_f16_f32 v46, v28, v29
v_cvt_pk_f16_f32 v47, v30, v31
v_add_u32 v32, 131074, v32
v_and_b32 v32, 4294770684, v32
v_add_u32 v33, 131074, v33
v_and_b32 v33, 4294770684, v33
v_add_u32 v34, 131074, v34
v_and_b32 v34, 4294770684, v34
v_add_u32 v35, 131074, v35
v_and_b32 v35, 4294770684, v35
v_add_u32 v36, 131074, v36
v_and_b32 v36, 4294770684, v36
v_add_u32 v37, 131074, v37
v_and_b32 v37, 4294770684, v37
v_add_u32 v38, 131074, v38
v_and_b32 v38, 4294770684, v38
v_add_u32 v39, 131074, v39
v_and_b32 v39, 4294770684, v39
v_add_u32 v40, 131074, v40
v_and_b32 v40, 4294770684, v40
v_add_u32 v41, 131074, v41
v_and_b32 v41, 4294770684, v41
v_add_u32 v42, 131074, v42
v_and_b32 v42, 4294770684, v42
v_add_u32 v43, 131074, v43
v_and_b32 v43, 4294770684, v43
v_add_u32 v44, 131074, v44
v_and_b32 v44, 4294770684, v44
v_add_u32 v45, 131074, v45
v_and_b32 v45, 4294770684, v45
v_add_u32 v46, 131074, v46
v_and_b32 v46, 4294770684, v46
v_add_u32 v47, 131074, v47
v_and_b32 v47, 4294770684, v47
v_lshlrev_b32 v121, 6, v120
v_bfe_u32 v120, v120, 2, 5
v_cmp_ne_u32 vcc, 31, v120
s_and_saveexec_b64 s[74:75], vcc
ds_write_b128 v121, v[32:35]
ds_write_b128 v121, v[36:39] offset:16
ds_write_b128 v121, v[40:43] offset:32
ds_write_b128 v121, v[44:47] offset:48
s_mov_b64 exec, s[74:75]
s_waitcnt vmcnt(10)
v_and_b32 v64, 65535, v126
ds_write_b64 v140, v[64:65]
v_and_b32 v66, 4294901760, v126
ds_write_b64 v140, v[66:67] offset:8
v_and_b32 v69, 65535, v127
ds_write_b64 v140, v[68:69] offset:16
v_and_b32 v71, 4294901760, v127
ds_write_b64 v140, v[70:71] offset:24
s_waitcnt vmcnt(0) lgkmcnt(0)
s_barrier
Lwa:
s_cmp_lt_u32 s40, 4
s_cbranch_scc1 Lsu1
s_waitcnt vmcnt(14)
v_add_u32 v113, 65536, v116
v_add_u32 v114, 65536, v117
ds_read_b64_tr_b16 v[0:1], v116
ds_read_b64_tr_b16 v[2:3], v116 offset:512
ds_read_b64_tr_b16 v[4:5], v116 offset:4096
ds_read_b64_tr_b16 v[6:7], v116 offset:4608
ds_read_b64_tr_b16 v[8:9], v116 offset:8192
ds_read_b64_tr_b16 v[10:11], v116 offset:8704
ds_read_b64_tr_b16 v[12:13], v116 offset:12288
ds_read_b64_tr_b16 v[14:15], v116 offset:12800
ds_read_b64_tr_b16 v[16:17], v116 offset:16384
ds_read_b64_tr_b16 v[18:19], v116 offset:16896
ds_read_b64_tr_b16 v[20:21], v116 offset:20480
ds_read_b64_tr_b16 v[22:23], v116 offset:20992
s_waitcnt lgkmcnt(10)
ds_write_b128 v117, v[0:3]
s_waitcnt lgkmcnt(9)
ds_write_b128 v117, v[4:7] offset:4096
s_waitcnt lgkmcnt(8)
ds_write_b128 v117, v[8:11] offset:8192
s_waitcnt lgkmcnt(7)
ds_write_b128 v117, v[12:15] offset:12288
s_waitcnt lgkmcnt(6)
ds_write_b128 v117, v[16:19] offset:16384
s_waitcnt lgkmcnt(5)
ds_write_b128 v117, v[20:23] offset:20480
v_mov_b32_e64 v223, 1
s_waitcnt lgkmcnt(0)
s_mov_b64 exec, 1
ds_add_u32 v247, v223 offset:8
s_mov_b64 exec, -1
s_nop 0
v_mov_b32_e64 v223, 0
s_branch Law1
Lax1:
s_sleep 2
Law1:
ds_read_b32 v223, v247 offset:16
s_sub_u32 s76, s76, 1
s_cselect_b32 s44, 4, 0
s_cselect_b32 s76, 0, s76
s_waitcnt lgkmcnt(0)
v_readfirstlane_b32 s43, v223
s_nop 1
s_max_u32 s43, s43, s44
s_cmp_lt_u32 s43, 4
s_cbranch_scc1 Lax1
s_add_u32 s81, s81, 6592
s_cmp_eq_u32 s81, 65920
s_cselect_b32 s81, 0, s81
s_add_u32 s43, s81, s67
s_add_u32 m0, s43, 16
s_add_u32 s66, s66, 98304
buffer_load_dwordx4 v236, s[4:7], s66 offen lds
s_add_u32 m0, s43, 912
s_nop 0
buffer_load_dwordx4 v237, s[4:7], s66 offen lds
s_add_u32 s81, s81, 6592
s_cmp_eq_u32 s81, 65920
s_cselect_b32 s81, 0, s81
s_add_u32 s43, s81, s67
s_add_u32 m0, s43, 16
s_add_u32 s66, s66, 98304
buffer_load_dwordx4 v236, s[4:7], s66 offen lds
s_add_u32 m0, s43, 912
s_nop 0
buffer_load_dwordx4 v237, s[4:7], s66 offen lds
s_add_u32 s81, s81, 6592
s_cmp_eq_u32 s81, 65920
s_cselect_b32 s81, 0, s81
s_add_u32 s43, s81, s67
s_add_u32 m0, s43, 32
s_add_u32 s66, s66, 98304
buffer_load_dwordx4 v236, s[4:7], s66 offen lds
s_add_u32 m0, s43, 928
s_nop 0
buffer_load_dwordx4 v237, s[4:7], s66 offen lds
s_add_u32 s81, s81, 6592
s_cmp_eq_u32 s81, 65920
s_cselect_b32 s81, 0, s81
s_add_u32 s43, s81, s67
s_add_u32 m0, s43, 32
s_add_u32 s66, s66, 98304
buffer_load_dwordx4 v236, s[4:7], s66 offen lds
s_add_u32 m0, s43, 928
s_nop 0
buffer_load_dwordx4 v237, s[4:7], s66 offen lds
s_add_u32 s81, s81, 6592
s_cmp_eq_u32 s81, 65920
s_cselect_b32 s81, 0, s81
s_add_u32 s43, s81, s67
s_add_u32 m0, s43, 48
s_add_u32 s66, s66, 98304
buffer_load_dwordx4 v236, s[4:7], s66 offen lds
s_add_u32 m0, s43, 944
s_nop 0
buffer_load_dwordx4 v237, s[4:7], s66 offen lds
s_add_u32 s81, s81, 6592
s_cmp_eq_u32 s81, 65920
s_cselect_b32 s81, 0, s81
s_add_u32 s43, s81, s67
s_add_u32 m0, s43, 48
s_add_u32 s66, s66, 98304
buffer_load_dwordx4 v236, s[4:7], s66 offen lds
s_add_u32 m0, s43, 944
s_nop 0
buffer_load_dwordx4 v237, s[4:7], s66 offen lds
s_add_u32 s81, s81, 6592
s_cmp_eq_u32 s81, 65920
s_cselect_b32 s81, 0, s81
s_add_u32 s43, s81, s67
s_add_u32 m0, s43, 0
s_add_u32 s66, s66, 98304
buffer_load_dwordx4 v236, s[4:7], s66 offen lds
s_add_u32 m0, s43, 896
s_nop 0
buffer_load_dwordx4 v237, s[4:7], s66 offen lds
s_add_u32 s81, s81, 6592
s_cmp_eq_u32 s81, 65920
s_cselect_b32 s81, 0, s81
s_add_u32 s43, s81, s67
s_add_u32 m0, s43, 0
s_add_u32 s66, s66, 98304
buffer_load_dwordx4 v236, s[4:7], s66 offen lds
s_add_u32 m0, s43, 896
s_nop 0
buffer_load_dwordx4 v237, s[4:7], s66 offen lds
s_waitcnt vmcnt(16)
v_add_u32 v113, 65536, v116
v_add_u32 v114, 65536, v117
ds_read_b64_tr_b16 v[0:1], v116 offset:24576
ds_read_b64_tr_b16 v[2:3], v116 offset:25088
ds_read_b64_tr_b16 v[4:5], v116 offset:28672
ds_read_b64_tr_b16 v[6:7], v116 offset:29184
ds_read_b64_tr_b16 v[8:9], v116 offset:32768
ds_read_b64_tr_b16 v[10:11], v116 offset:33280
ds_read_b64_tr_b16 v[12:13], v116 offset:36864
ds_read_b64_tr_b16 v[14:15], v116 offset:37376
ds_read_b64_tr_b16 v[16:17], v116 offset:40960
ds_read_b64_tr_b16 v[18:19], v116 offset:41472
ds_read_b64_tr_b16 v[20:21], v116 offset:45056
ds_read_b64_tr_b16 v[22:23], v116 offset:45568
ds_read_b64_tr_b16 v[24:25], v116 offset:49152
ds_read_b64_tr_b16 v[26:27], v116 offset:49664
ds_read_b64_tr_b16 v[28:29], v116 offset:53248
s_waitcnt lgkmcnt(14)
ds_read_b64_tr_b16 v[30:31], v116 offset:53760
s_waitcnt lgkmcnt(14)
ds_read_b64_tr_b16 v[32:33], v116 offset:57344
s_waitcnt lgkmcnt(14)
ds_read_b64_tr_b16 v[34:35], v116 offset:57856
s_waitcnt lgkmcnt(14)
ds_read_b64_tr_b16 v[36:37], v116 offset:61440
s_waitcnt lgkmcnt(14)
ds_read_b64_tr_b16 v[38:39], v116 offset:61952
s_waitcnt lgkmcnt(14)
ds_read_b64_tr_b16 v[40:41], v113
s_waitcnt lgkmcnt(14)
ds_read_b64_tr_b16 v[42:43], v113 offset:512
s_waitcnt lgkmcnt(14)
ds_read_b64_tr_b16 v[44:45], v113 offset:4096
s_waitcnt lgkmcnt(14)
ds_read_b64_tr_b16 v[46:47], v113 offset:4608
s_waitcnt lgkmcnt(14)
ds_write_b128 v117, v[0:3] offset:24576
s_waitcnt lgkmcnt(14)
ds_write_b128 v117, v[4:7] offset:28672
s_waitcnt lgkmcnt(14)
ds_write_b128 v117, v[8:11] offset:32768
s_waitcnt lgkmcnt(14)
ds_write_b128 v117, v[12:15] offset:36864
s_waitcnt lgkmcnt(14)
ds_write_b128 v117, v[16:19] offset:40960
s_waitcnt lgkmcnt(14)
ds_write_b128 v117, v[20:23] offset:45056
s_waitcnt lgkmcnt(14)
ds_write_b128 v117, v[24:27] offset:49152
s_waitcnt lgkmcnt(14)
ds_write_b128 v117, v[28:31] offset:53248
s_waitcnt lgkmcnt(14)
ds_write_b128 v117, v[32:35] offset:57344
s_waitcnt lgkmcnt(14)
s_waitcnt lgkmcnt(13)
ds_write_b128 v117, v[36:39] offset:61440
s_waitcnt lgkmcnt(12)
ds_write_b128 v114, v[40:43]
s_waitcnt lgkmcnt(11)
ds_write_b128 v114, v[44:47] offset:4096
v_mov_b32 v223, 1
s_waitcnt lgkmcnt(0)
s_mov_b64 exec, 1
ds_add_u32 v247, v223 offset:12
s_mov_b64 exec, -1
s_cmp_lg_u32 s40, 7
s_cbranch_scc1 Lnosent
v_bfe_u32 v104, v250, 4, 6
v_mov_b32 v108, -1
v_mov_b32 v109, -1
v_mov_b32 v110, -1
v_mov_b32 v111, -1
v_lshlrev_b32_e64 v100, 12, v104
v_add_u32 v101, 262144, v100
v_cmp_gt_u32 vcc, 32, v104
v_mov_b32 v105, 2147483648
s_nop 0
v_cndmask_b32 v101, v105, v101, vcc
s_lshl_b32 s43, s2, 4
buffer_store_dwordx4 v[108:111], v100, s[32:35], s43 offen sc1
buffer_store_dwordx4 v[108:111], v101, s[32:35], s43 offen sc1
s_add_u32 s43, s43, 393216
s_cmp_lt_u32 s2, 96
s_cselect_b32 s43, s43, 1073741824
v_lshlrev_b32 v103, 11, v104
s_mov_b64 exec, 0xff
buffer_store_dwordx4 v[108:111], v103, s[32:35], s43 offen sc1
s_mov_b64 exec, -1
s_nop 1
Lnosent:
s_setprio 3
s_waitcnt vmcnt(0)
Lsu1:
s_add_u32 s43, s81, 6592
v_add_u32_e64 v212, s43, v246
v_subrev_u32 v222, 65920, v212
v_min_u32_e64 v212, v212, v222
v_add_u32 v212, 90112, v212
v_add_u32_e64 v213, s43, v246
v_add_u32 v213, 6592, v213
v_subrev_u32 v222, 65920, v213
v_min_u32_e64 v213, v213, v222
v_add_u32 v213, 90112, v213
v_add_u32_e64 v214, s43, v246
v_add_u32 v214, 13184, v214
v_add_u32_e64 v222, 16, v214
v_bfi_b32 v214, 48, v222, v214
v_subrev_u32 v222, 65920, v214
v_min_u32_e64 v214, v214, v222
v_add_u32 v214, 90112, v214
v_add_u32_e64 v215, s43, v246
v_add_u32 v215, 19776, v215
v_add_u32_e64 v222, 16, v215
v_bfi_b32 v215, 48, v222, v215
v_subrev_u32 v222, 65920, v215
v_min_u32 v215, v215, v222
v_add_u32 v215, 90112, v215
ds_read_b128 v[144:147], v212
ds_read_b64 v[192:193], v238
ds_read_b64 v[194:195], v239
ds_read_b128 v[148:151], v213
ds_read_b128 v[152:155], v214
ds_read_b64 v[196:197], v238 offset:2400
ds_read_b64 v[198:199], v239 offset:2400
ds_read_b128 v[156:159], v215
ds_read_b64 v[200:201], v238 offset:4800
ds_read_b64 v[202:203], v239 offset:4800
ds_read_b128 v[160:163], v212 offset:16
ds_read_b64 v[204:205], v238 offset:200
ds_read_b64 v[206:207], v239 offset:200
ds_read_b128 v[164:167], v213 offset:16
ds_read_b128 v[168:171], v214 offset:16
s_waitcnt lgkmcnt(14)
ds_read_b64 v[208:209], v238 offset:2600
s_waitcnt lgkmcnt(13)
v_mfma_f32_16x16x32_bf16 v[0:3], v[192:195], v[144:147], 0
ds_read_b64 v[210:211], v239 offset:2600
ds_read_b128 v[172:175], v215 offset:16
s_waitcnt lgkmcnt(14)
v_mfma_f32_16x16x32_bf16 v[48:51], v[192:195], v[148:151], 0
ds_read_b64 v[192:193], v238 offset:5000
s_waitcnt lgkmcnt(14)
ds_read_b64 v[194:195], v239 offset:5000
s_waitcnt lgkmcnt(13)
v_mfma_f32_16x16x32_bf16 v[0:3], v[196:199], v[148:151], v[0:3]
ds_read_b128 v[144:147], v212 offset:32
ds_read_b128 v[148:151], v213 offset:32
v_mfma_f32_16x16x32_bf16 v[48:51], v[196:199], v[152:155], v[48:51]
s_waitcnt lgkmcnt(14)
ds_read_b64 v[196:197], v238 offset:400
s_waitcnt lgkmcnt(14)
ds_read_b64 v[198:199], v239 offset:400
s_waitcnt lgkmcnt(14)
v_mfma_f32_16x16x32_bf16 v[0:3], v[200:203], v[152:155], v[0:3]
ds_read_b128 v[152:155], v214 offset:32
v_mfma_f32_16x16x32_bf16 v[48:51], v[200:203], v[156:159], v[48:51]
s_waitcnt lgkmcnt(14)
ds_read_b64 v[200:201], v238 offset:2800
s_waitcnt lgkmcnt(14)
ds_read_b64 v[202:203], v239 offset:2800
s_waitcnt lgkmcnt(14)
v_mfma_f32_16x16x32_bf16 v[4:7], v[204:207], v[160:163], 0
ds_read_b128 v[156:159], v215 offset:32
s_waitcnt lgkmcnt(14)
v_mfma_f32_16x16x32_bf16 v[52:55], v[204:207], v[164:167], 0
ds_read_b64 v[204:205], v238 offset:5200
s_waitcnt lgkmcnt(14)
ds_read_b64 v[206:207], v239 offset:5200
s_waitcnt lgkmcnt(13)
v_mfma_f32_16x16x32_bf16 v[4:7], v[208:211], v[164:167], v[4:7]
ds_read_b128 v[160:163], v212 offset:48
ds_read_b128 v[164:167], v213 offset:48
v_mfma_f32_16x16x32_bf16 v[52:55], v[208:211], v[168:171], v[52:55]
s_waitcnt lgkmcnt(14)
ds_read_b64 v[208:209], v238 offset:600
s_waitcnt lgkmcnt(14)
ds_read_b64 v[210:211], v239 offset:600
s_waitcnt lgkmcnt(14)
v_mfma_f32_16x16x32_bf16 v[4:7], v[192:195], v[168:171], v[4:7]
ds_read_b128 v[168:171], v214 offset:48
v_mfma_f32_16x16x32_bf16 v[52:55], v[192:195], v[172:175], v[52:55]
s_waitcnt lgkmcnt(14)
ds_read_b64 v[192:193], v238 offset:3000
s_waitcnt lgkmcnt(14)
ds_read_b64 v[194:195], v239 offset:3000
s_waitcnt lgkmcnt(13)
v_mfma_f32_16x16x32_bf16 v[8:11], v[196:199], v[144:147], 0
ds_read_b128 v[172:175], v215 offset:48
ds_read_b128 v[144:147], v212 offset:64
v_mfma_f32_16x16x32_bf16 v[56:59], v[196:199], v[148:151], 0
s_waitcnt lgkmcnt(14)
ds_read_b64 v[196:197], v238 offset:5400
s_waitcnt lgkmcnt(14)
ds_read_b64 v[198:199], v239 offset:5400
s_waitcnt lgkmcnt(14)
v_mfma_f32_16x16x32_bf16 v[8:11], v[200:203], v[148:151], v[8:11]
ds_read_b128 v[148:151], v213 offset:64
v_mfma_f32_16x16x32_bf16 v[56:59], v[200:203], v[152:155], v[56:59]
s_waitcnt lgkmcnt(14)
ds_read_b64 v[200:201], v238 offset:800
s_waitcnt lgkmcnt(14)
ds_read_b64 v[202:203], v239 offset:800
s_waitcnt lgkmcnt(14)
v_mfma_f32_16x16x32_bf16 v[8:11], v[204:207], v[152:155], v[8:11]
ds_read_b128 v[152:155], v214 offset:64
v_mfma_f32_16x16x32_bf16 v[56:59], v[204:207], v[156:159], v[56:59]
s_waitcnt lgkmcnt(14)
ds_read_b64 v[204:205], v238 offset:3200
s_waitcnt lgkmcnt(14)
ds_read_b64 v[206:207], v239 offset:3200
s_waitcnt lgkmcnt(13)
v_mfma_f32_16x16x32_bf16 v[12:15], v[208:211], v[160:163], 0
ds_read_b128 v[156:159], v215 offset:64
ds_read_b128 v[160:163], v212 offset:80
v_mfma_f32_16x16x32_bf16 v[60:63], v[208:211], v[164:167], 0
s_waitcnt lgkmcnt(14)
ds_read_b64 v[208:209], v238 offset:5600
s_waitcnt lgkmcnt(14)
ds_read_b64 v[210:211], v239 offset:5600
s_waitcnt lgkmcnt(14)
v_mfma_f32_16x16x32_bf16 v[12:15], v[192:195], v[164:167], v[12:15]
ds_read_b128 v[164:167], v213 offset:80
v_mfma_f32_16x16x32_bf16 v[60:63], v[192:195], v[168:171], v[60:63]
s_waitcnt lgkmcnt(14)
ds_read_b64 v[192:193], v238 offset:1000
s_waitcnt lgkmcnt(14)
ds_read_b64 v[194:195], v239 offset:1000
s_waitcnt lgkmcnt(13)
v_mfma_f32_16x16x32_bf16 v[12:15], v[196:199], v[168:171], v[12:15]
ds_read_b128 v[168:171], v214 offset:80
v_mfma_f32_16x16x32_bf16 v[60:63], v[196:199], v[172:175], v[60:63]
ds_read_b64 v[196:197], v238 offset:3400
s_waitcnt lgkmcnt(14)
ds_read_b64 v[198:199], v239 offset:3400
s_waitcnt lgkmcnt(13)
v_mfma_f32_16x16x32_bf16 v[16:19], v[200:203], v[144:147], 0
ds_read_b128 v[172:175], v215 offset:80
ds_read_b128 v[144:147], v212 offset:96
v_mfma_f32_16x16x32_bf16 v[64:67], v[200:203], v[148:151], 0
s_waitcnt lgkmcnt(14)
ds_read_b64 v[200:201], v238 offset:5800
s_waitcnt lgkmcnt(14)
ds_read_b64 v[202:203], v239 offset:5800
s_waitcnt lgkmcnt(14)
v_mfma_f32_16x16x32_bf16 v[16:19], v[204:207], v[148:151], v[16:19]
ds_read_b128 v[148:151], v213 offset:96
v_mfma_f32_16x16x32_bf16 v[64:67], v[204:207], v[152:155], v[64:67]
s_waitcnt lgkmcnt(14)
ds_read_b64 v[204:205], v238 offset:1200
s_waitcnt lgkmcnt(14)
ds_read_b64 v[206:207], v239 offset:1200
s_waitcnt lgkmcnt(13)
v_mfma_f32_16x16x32_bf16 v[16:19], v[208:211], v[152:155], v[16:19]
ds_read_b128 v[152:155], v214 offset:96
v_mfma_f32_16x16x32_bf16 v[64:67], v[208:211], v[156:159], v[64:67]
ds_read_b64 v[208:209], v238 offset:3600
s_waitcnt lgkmcnt(14)
ds_read_b64 v[210:211], v239 offset:3600
s_waitcnt lgkmcnt(13)
v_mfma_f32_16x16x32_bf16 v[20:23], v[192:195], v[160:163], 0
ds_read_b128 v[156:159], v215 offset:96
ds_read_b128 v[160:163], v212 offset:112
v_mfma_f32_16x16x32_bf16 v[68:71], v[192:195], v[164:167], 0
s_waitcnt lgkmcnt(14)
ds_read_b64 v[192:193], v238 offset:6000
s_waitcnt lgkmcnt(14)
ds_read_b64 v[194:195], v239 offset:6000
s_waitcnt lgkmcnt(14)
v_mfma_f32_16x16x32_bf16 v[20:23], v[196:199], v[164:167], v[20:23]
ds_read_b128 v[164:167], v213 offset:112
v_mfma_f32_16x16x32_bf16 v[68:71], v[196:199], v[168:171], v[68:71]
s_waitcnt lgkmcnt(14)
ds_read_b64 v[196:197], v238 offset:1400
s_waitcnt lgkmcnt(14)
ds_read_b64 v[198:199], v239 offset:1400
s_waitcnt lgkmcnt(13)
v_mfma_f32_16x16x32_bf16 v[20:23], v[200:203], v[168:171], v[20:23]
ds_read_b128 v[168:171], v214 offset:112
v_mfma_f32_16x16x32_bf16 v[68:71], v[200:203], v[172:175], v[68:71]
ds_read_b64 v[200:201], v238 offset:3800
s_waitcnt lgkmcnt(14)
ds_read_b64 v[202:203], v239 offset:3800
s_waitcnt lgkmcnt(13)
v_mfma_f32_16x16x32_bf16 v[24:27], v[204:207], v[144:147], 0
ds_read_b128 v[172:175], v215 offset:112
ds_read_b128 v[144:147], v212 offset:128
v_mfma_f32_16x16x32_bf16 v[72:75], v[204:207], v[148:151], 0
s_waitcnt lgkmcnt(14)
ds_read_b64 v[204:205], v238 offset:6200
s_waitcnt lgkmcnt(14)
ds_read_b64 v[206:207], v239 offset:6200
s_waitcnt lgkmcnt(14)
v_mfma_f32_16x16x32_bf16 v[24:27], v[208:211], v[148:151], v[24:27]
ds_read_b128 v[148:151], v213 offset:128
v_mfma_f32_16x16x32_bf16 v[72:75], v[208:211], v[152:155], v[72:75]
s_waitcnt lgkmcnt(14)
ds_read_b64 v[208:209], v238 offset:1600
s_waitcnt lgkmcnt(14)
ds_read_b64 v[210:211], v239 offset:1600
s_waitcnt lgkmcnt(13)
v_mfma_f32_16x16x32_bf16 v[24:27], v[192:195], v[152:155], v[24:27]
ds_read_b128 v[152:155], v214 offset:128
v_mfma_f32_16x16x32_bf16 v[72:75], v[192:195], v[156:159], v[72:75]
ds_read_b64 v[192:193], v238 offset:4000
s_waitcnt lgkmcnt(14)
ds_read_b64 v[194:195], v239 offset:4000
s_waitcnt lgkmcnt(13)
v_mfma_f32_16x16x32_bf16 v[28:31], v[196:199], v[160:163], 0
ds_read_b128 v[156:159], v215 offset:128
ds_read_b128 v[160:163], v212 offset:144
v_mfma_f32_16x16x32_bf16 v[76:79], v[196:199], v[164:167], 0
s_waitcnt lgkmcnt(14)
ds_read_b64 v[196:197], v238 offset:6400
s_waitcnt lgkmcnt(14)
ds_read_b64 v[198:199], v239 offset:6400
s_waitcnt lgkmcnt(14)
v_mfma_f32_16x16x32_bf16 v[28:31], v[200:203], v[164:167], v[28:31]
ds_read_b128 v[164:167], v213 offset:144
v_mfma_f32_16x16x32_bf16 v[76:79], v[200:203], v[168:171], v[76:79]
s_waitcnt lgkmcnt(14)
ds_read_b64 v[200:201], v238 offset:1800
s_waitcnt lgkmcnt(14)
ds_read_b64 v[202:203], v239 offset:1800
s_waitcnt lgkmcnt(13)
v_mfma_f32_16x16x32_bf16 v[28:31], v[204:207], v[168:171], v[28:31]
ds_read_b128 v[168:171], v214 offset:144
v_mfma_f32_16x16x32_bf16 v[76:79], v[204:207], v[172:175], v[76:79]
ds_read_b64 v[204:205], v238 offset:4200
s_waitcnt lgkmcnt(14)
ds_read_b64 v[206:207], v239 offset:4200
s_waitcnt lgkmcnt(13)
v_mfma_f32_16x16x32_bf16 v[32:35], v[208:211], v[144:147], 0
ds_read_b128 v[172:175], v215 offset:144
ds_read_b128 v[144:147], v212 offset:160
v_mfma_f32_16x16x32_bf16 v[80:83], v[208:211], v[148:151], 0
s_waitcnt lgkmcnt(14)
ds_read_b64 v[208:209], v238 offset:6600
s_waitcnt lgkmcnt(14)
ds_read_b64 v[210:211], v239 offset:6600
s_waitcnt lgkmcnt(14)
v_mfma_f32_16x16x32_bf16 v[32:35], v[192:195], v[148:151], v[32:35]
ds_read_b128 v[148:151], v213 offset:160
v_mfma_f32_16x16x32_bf16 v[80:83], v[192:195], v[152:155], v[80:83]
s_waitcnt lgkmcnt(14)
ds_read_b64 v[192:193], v238 offset:2000
s_waitcnt lgkmcnt(14)
ds_read_b64 v[194:195], v239 offset:2000
s_waitcnt lgkmcnt(13)
v_mfma_f32_16x16x32_bf16 v[32:35], v[196:199], v[152:155], v[32:35]
ds_read_b128 v[152:155], v214 offset:160
v_mfma_f32_16x16x32_bf16 v[80:83], v[196:199], v[156:159], v[80:83]
ds_read_b64 v[196:197], v238 offset:4400
s_waitcnt lgkmcnt(14)
ds_read_b64 v[198:199], v239 offset:4400
s_waitcnt lgkmcnt(13)
v_mfma_f32_16x16x32_bf16 v[36:39], v[200:203], v[160:163], 0
ds_read_b128 v[156:159], v215 offset:160
ds_read_b128 v[160:163], v212 offset:176
v_mfma_f32_16x16x32_bf16 v[84:87], v[200:203], v[164:167], 0
s_waitcnt lgkmcnt(14)
ds_read_b64 v[200:201], v238 offset:6800
s_waitcnt lgkmcnt(14)
ds_read_b64 v[202:203], v239 offset:6800
s_waitcnt lgkmcnt(14)
v_mfma_f32_16x16x32_bf16 v[36:39], v[204:207], v[164:167], v[36:39]
ds_read_b128 v[164:167], v213 offset:176
v_mfma_f32_16x16x32_bf16 v[84:87], v[204:207], v[168:171], v[84:87]
s_waitcnt lgkmcnt(14)
ds_read_b64 v[204:205], v238 offset:2200
s_waitcnt lgkmcnt(14)
ds_read_b64 v[206:207], v239 offset:2200
s_waitcnt lgkmcnt(13)
v_mfma_f32_16x16x32_bf16 v[36:39], v[208:211], v[168:171], v[36:39]
ds_read_b128 v[168:171], v214 offset:176
v_mfma_f32_16x16x32_bf16 v[84:87], v[208:211], v[172:175], v[84:87]
ds_read_b64 v[208:209], v238 offset:4600
s_waitcnt lgkmcnt(14)
ds_read_b64 v[210:211], v239 offset:4600
s_waitcnt lgkmcnt(13)
v_mfma_f32_16x16x32_bf16 v[40:43], v[192:195], v[144:147], 0
ds_read_b128 v[172:175], v215 offset:176
v_mfma_f32_16x16x32_bf16 v[88:91], v[192:195], v[148:151], 0
ds_read_b64 v[192:193], v238 offset:7000
s_waitcnt lgkmcnt(14)
ds_read_b64 v[194:195], v239 offset:7000
s_waitcnt lgkmcnt(13)
v_mfma_f32_16x16x32_bf16 v[40:43], v[196:199], v[148:151], v[40:43]
v_mfma_f32_16x16x32_bf16 v[88:91], v[196:199], v[152:155], v[88:91]
s_waitcnt lgkmcnt(9)
v_mfma_f32_16x16x32_bf16 v[40:43], v[200:203], v[152:155], v[40:43]
v_mfma_f32_16x16x32_bf16 v[88:91], v[200:203], v[156:159], v[88:91]
s_waitcnt lgkmcnt(6)
v_mfma_f32_16x16x32_bf16 v[44:47], v[204:207], v[160:163], 0
v_mfma_f32_16x16x32_bf16 v[92:95], v[204:207], v[164:167], 0
s_waitcnt lgkmcnt(3)
v_mfma_f32_16x16x32_bf16 v[44:47], v[208:211], v[164:167], v[44:47]
v_mfma_f32_16x16x32_bf16 v[92:95], v[208:211], v[168:171], v[92:95]
s_waitcnt lgkmcnt(0)
v_mfma_f32_16x16x32_bf16 v[44:47], v[192:195], v[168:171], v[44:47]
v_mfma_f32_16x16x32_bf16 v[92:95], v[192:195], v[172:175], v[92:95]
v_mov_b32_e64 v223, 1
v_add_u32 v222, s83, v247
s_nop 7
s_mov_b64 exec, 1
ds_add_u32 v222, v223 offset:16
s_mov_b64 exec, -1
v_pk_mul_f32 v[242:243], v[0:1], v[0:1]
v_pk_add_f32 v[240:241], v[0:1], v[2:3]
v_pk_fma_f32 v[242:243], v[2:3], v[2:3], v[242:243]
v_pk_mul_f32 v[218:219], v[48:49], v[48:49]
v_pk_add_f32 v[216:217], v[48:49], v[50:51]
v_pk_fma_f32 v[218:219], v[50:51], v[50:51], v[218:219]
v_pk_fma_f32 v[242:243], v[4:5], v[4:5], v[242:243]
v_pk_add_f32 v[240:241], v[240:241], v[4:5]
v_pk_fma_f32 v[242:243], v[6:7], v[6:7], v[242:243]
v_pk_add_f32 v[240:241], v[240:241], v[6:7]
v_pk_fma_f32 v[218:219], v[52:53], v[52:53], v[218:219]
v_pk_add_f32 v[216:217], v[216:217], v[52:53]
v_pk_fma_f32 v[218:219], v[54:55], v[54:55], v[218:219]
v_pk_add_f32 v[216:217], v[216:217], v[54:55]
v_pk_fma_f32 v[242:243], v[8:9], v[8:9], v[242:243]
v_pk_add_f32 v[240:241], v[240:241], v[8:9]
v_pk_fma_f32 v[242:243], v[10:11], v[10:11], v[242:243]
v_pk_add_f32 v[240:241], v[240:241], v[10:11]
v_pk_fma_f32 v[218:219], v[56:57], v[56:57], v[218:219]
v_pk_add_f32 v[216:217], v[216:217], v[56:57]
v_pk_fma_f32 v[218:219], v[58:59], v[58:59], v[218:219]
v_pk_add_f32 v[216:217], v[216:217], v[58:59]
v_pk_fma_f32 v[242:243], v[12:13], v[12:13], v[242:243]
v_pk_add_f32 v[240:241], v[240:241], v[12:13]
v_pk_fma_f32 v[242:243], v[14:15], v[14:15], v[242:243]
v_pk_add_f32 v[240:241], v[240:241], v[14:15]
v_pk_fma_f32 v[218:219], v[60:61], v[60:61], v[218:219]
v_pk_add_f32 v[216:217], v[216:217], v[60:61]
v_pk_fma_f32 v[218:219], v[62:63], v[62:63], v[218:219]
v_pk_add_f32 v[216:217], v[216:217], v[62:63]
v_pk_fma_f32 v[242:243], v[16:17], v[16:17], v[242:243]
v_pk_add_f32 v[240:241], v[240:241], v[16:17]
v_pk_fma_f32 v[242:243], v[18:19], v[18:19], v[242:243]
v_pk_add_f32 v[240:241], v[240:241], v[18:19]
v_pk_fma_f32 v[218:219], v[64:65], v[64:65], v[218:219]
v_pk_add_f32 v[216:217], v[216:217], v[64:65]
v_pk_fma_f32 v[218:219], v[66:67], v[66:67], v[218:219]
v_pk_add_f32 v[216:217], v[216:217], v[66:67]
v_pk_fma_f32 v[242:243], v[20:21], v[20:21], v[242:243]
v_pk_add_f32 v[240:241], v[240:241], v[20:21]
v_pk_fma_f32 v[242:243], v[22:23], v[22:23], v[242:243]
v_pk_add_f32 v[240:241], v[240:241], v[22:23]
v_pk_fma_f32 v[218:219], v[68:69], v[68:69], v[218:219]
v_pk_add_f32 v[216:217], v[216:217], v[68:69]
v_pk_fma_f32 v[218:219], v[70:71], v[70:71], v[218:219]
v_pk_add_f32 v[216:217], v[216:217], v[70:71]
v_pk_fma_f32 v[242:243], v[24:25], v[24:25], v[242:243]
v_pk_add_f32 v[240:241], v[240:241], v[24:25]
v_pk_fma_f32 v[242:243], v[26:27], v[26:27], v[242:243]
v_pk_add_f32 v[240:241], v[240:241], v[26:27]
v_pk_fma_f32 v[218:219], v[72:73], v[72:73], v[218:219]
v_pk_add_f32 v[216:217], v[216:217], v[72:73]
v_pk_fma_f32 v[218:219], v[74:75], v[74:75], v[218:219]
v_pk_add_f32 v[216:217], v[216:217], v[74:75]
v_pk_fma_f32 v[242:243], v[28:29], v[28:29], v[242:243]
v_pk_add_f32 v[240:241], v[240:241], v[28:29]
v_pk_fma_f32 v[242:243], v[30:31], v[30:31], v[242:243]
v_pk_add_f32 v[240:241], v[240:241], v[30:31]
v_pk_fma_f32 v[218:219], v[76:77], v[76:77], v[218:219]
v_pk_add_f32 v[216:217], v[216:217], v[76:77]
v_pk_fma_f32 v[218:219], v[78:79], v[78:79], v[218:219]
v_pk_add_f32 v[216:217], v[216:217], v[78:79]
v_pk_fma_f32 v[242:243], v[32:33], v[32:33], v[242:243]
v_pk_add_f32 v[240:241], v[240:241], v[32:33]
v_pk_fma_f32 v[242:243], v[34:35], v[34:35], v[242:243]
v_pk_add_f32 v[240:241], v[240:241], v[34:35]
v_pk_fma_f32 v[218:219], v[80:81], v[80:81], v[218:219]
v_pk_add_f32 v[216:217], v[216:217], v[80:81]
v_pk_fma_f32 v[218:219], v[82:83], v[82:83], v[218:219]
v_pk_add_f32 v[216:217], v[216:217], v[82:83]
v_pk_fma_f32 v[242:243], v[36:37], v[36:37], v[242:243]
v_pk_add_f32 v[240:241], v[240:241], v[36:37]
v_pk_fma_f32 v[242:243], v[38:39], v[38:39], v[242:243]
v_pk_add_f32 v[240:241], v[240:241], v[38:39]
v_pk_fma_f32 v[218:219], v[84:85], v[84:85], v[218:219]
v_pk_add_f32 v[216:217], v[216:217], v[84:85]
v_pk_fma_f32 v[218:219], v[86:87], v[86:87], v[218:219]
v_pk_add_f32 v[216:217], v[216:217], v[86:87]
v_pk_fma_f32 v[242:243], v[40:41], v[40:41], v[242:243]
v_pk_add_f32 v[240:241], v[240:241], v[40:41]
v_pk_fma_f32 v[242:243], v[42:43], v[42:43], v[242:243]
v_pk_add_f32 v[240:241], v[240:241], v[42:43]
v_pk_fma_f32 v[218:219], v[88:89], v[88:89], v[218:219]
v_pk_add_f32 v[216:217], v[216:217], v[88:89]
v_pk_fma_f32 v[218:219], v[90:91], v[90:91], v[218:219]
v_pk_add_f32 v[216:217], v[216:217], v[90:91]
v_pk_fma_f32 v[242:243], v[44:45], v[44:45], v[242:243]
v_pk_add_f32 v[240:241], v[240:241], v[44:45]
v_pk_fma_f32 v[242:243], v[46:47], v[46:47], v[242:243]
v_pk_add_f32 v[240:241], v[240:241], v[46:47]
v_pk_fma_f32 v[218:219], v[92:93], v[92:93], v[218:219]
v_pk_add_f32 v[216:217], v[216:217], v[92:93]
v_pk_fma_f32 v[218:219], v[94:95], v[94:95], v[218:219]
v_pk_add_f32 v[216:217], v[216:217], v[94:95]
v_add_f32 v218, v218, v219
v_add_f32 v216, v216, v217
s_nop 1
v_permlane32_swap_b32 v216, v218
v_add_f32_e64 v216, v216, v218
v_mul_f32 v216, 1009429163, v216
v_mov_b32_e64 v218, v216
s_nop 1
v_permlane32_swap_b32 v216, v218
v_fma_f32 v218, -v216, v216, v218
v_max_f32_e64 v218, 0, v218
v_add_f32 v218, 925353388, v218
v_rsq_f32 v218, v218
v_add_f32 v240, v240, v241
v_mul_f32 v220, 3203396952, v218
v_mul_f32 v221, 3203396952, v218
v_mul_f32 v218, v216, v220
v_mul_f32 v219, v216, v220
v_add_f32 v242, v242, v243
s_nop 1
v_permlane32_swap_b32 v240, v242
v_add_f32 v240, v240, v242
v_mul_f32 v240, 1009429163, v240
v_mov_b32_e64 v242, v240
s_nop 1
v_permlane32_swap_b32 v240, v242
v_fma_f32 v242, -v240, v240, v242
v_max_f32_e64 v242, 0, v242
v_add_f32 v242, 925353388, v242
v_rsq_f32 v242, v242
s_nop 0
v_mul_f32 v244, 3203396952, v242
v_mul_f32 v245, 3203396952, v242
v_mul_f32 v242, v240, v244
v_mul_f32 v243, v240, v244
v_pk_fma_f32 v[0:1], v[0:1], v[244:245], v[242:243] neg_lo:[0,0,1] neg_hi:[0,0,1]
v_pk_fma_f32 v[2:3], v[2:3], v[244:245], v[242:243] neg_lo:[0,0,1] neg_hi:[0,0,1]
v_cvt_pk_bf16_f32 v0, v0, v1
v_cvt_pk_bf16_f32 v1, v2, v3
v_pk_fma_f32 v[4:5], v[4:5], v[244:245], v[242:243] neg_lo:[0,0,1] neg_hi:[0,0,1]
v_pk_fma_f32 v[6:7], v[6:7], v[244:245], v[242:243] neg_lo:[0,0,1] neg_hi:[0,0,1]
v_cvt_pk_bf16_f32 v2, v4, v5
v_cvt_pk_bf16_f32 v3, v6, v7
v_pk_fma_f32 v[8:9], v[8:9], v[244:245], v[242:243] neg_lo:[0,0,1] neg_hi:[0,0,1]
v_pk_fma_f32 v[10:11], v[10:11], v[244:245], v[242:243] neg_lo:[0,0,1] neg_hi:[0,0,1]
v_cvt_pk_bf16_f32 v4, v8, v9
v_cvt_pk_bf16_f32 v5, v10, v11
v_pk_fma_f32 v[12:13], v[12:13], v[244:245], v[242:243] neg_lo:[0,0,1] neg_hi:[0,0,1]
v_pk_fma_f32 v[14:15], v[14:15], v[244:245], v[242:243] neg_lo:[0,0,1] neg_hi:[0,0,1]
v_cvt_pk_bf16_f32 v6, v12, v13
v_cvt_pk_bf16_f32 v7, v14, v15
v_pk_fma_f32 v[16:17], v[16:17], v[244:245], v[242:243] neg_lo:[0,0,1] neg_hi:[0,0,1]
v_pk_fma_f32 v[18:19], v[18:19], v[244:245], v[242:243] neg_lo:[0,0,1] neg_hi:[0,0,1]
v_cvt_pk_bf16_f32 v8, v16, v17
v_cvt_pk_bf16_f32 v9, v18, v19
v_pk_fma_f32 v[20:21], v[20:21], v[244:245], v[242:243] neg_lo:[0,0,1] neg_hi:[0,0,1]
v_pk_fma_f32 v[22:23], v[22:23], v[244:245], v[242:243] neg_lo:[0,0,1] neg_hi:[0,0,1]
v_cvt_pk_bf16_f32 v10, v20, v21
v_cvt_pk_bf16_f32 v11, v22, v23
v_pk_fma_f32 v[24:25], v[24:25], v[244:245], v[242:243] neg_lo:[0,0,1] neg_hi:[0,0,1]
v_pk_fma_f32 v[26:27], v[26:27], v[244:245], v[242:243] neg_lo:[0,0,1] neg_hi:[0,0,1]
v_cvt_pk_bf16_f32 v12, v24, v25
v_cvt_pk_bf16_f32 v13, v26, v27
v_mov_b32 v223, 0
s_branch Law2
Lax2:
s_sleep 2
Law2:
ds_read_b32 v223, v247 offset:8
s_sub_u32 s76, s76, 1
s_cselect_b32 s44, 4, 0
s_cselect_b32 s76, 0, s76
s_waitcnt lgkmcnt(0)
v_readfirstlane_b32 s43, v223
s_nop 1
s_max_u32 s43, s43, s44
s_cmp_lt_u32 s43, 4
s_cbranch_scc1 Lax2
v_pk_fma_f32 v[28:29], v[28:29], v[244:245], v[242:243] neg_lo:[0,0,1] neg_hi:[0,0,1]
v_pk_fma_f32 v[30:31], v[30:31], v[244:245], v[242:243] neg_lo:[0,0,1] neg_hi:[0,0,1]
v_cvt_pk_bf16_f32 v14, v28, v29
v_cvt_pk_bf16_f32 v15, v30, v31
v_pk_fma_f32 v[32:33], v[32:33], v[244:245], v[242:243] neg_lo:[0,0,1] neg_hi:[0,0,1]
v_pk_fma_f32 v[34:35], v[34:35], v[244:245], v[242:243] neg_lo:[0,0,1] neg_hi:[0,0,1]
v_cvt_pk_bf16_f32 v16, v32, v33
v_cvt_pk_bf16_f32 v17, v34, v35
v_pk_fma_f32 v[36:37], v[36:37], v[244:245], v[242:243] neg_lo:[0,0,1] neg_hi:[0,0,1]
v_pk_fma_f32 v[38:39], v[38:39], v[244:245], v[242:243] neg_lo:[0,0,1] neg_hi:[0,0,1]
v_cvt_pk_bf16_f32 v18, v36, v37
v_cvt_pk_bf16_f32 v19, v38, v39
v_pk_fma_f32 v[40:41], v[40:41], v[244:245], v[242:243] neg_lo:[0,0,1] neg_hi:[0,0,1]
v_pk_fma_f32 v[42:43], v[42:43], v[244:245], v[242:243] neg_lo:[0,0,1] neg_hi:[0,0,1]
v_cvt_pk_bf16_f32 v20, v40, v41
v_cvt_pk_bf16_f32 v21, v42, v43
v_pk_fma_f32 v[44:45], v[44:45], v[244:245], v[242:243] neg_lo:[0,0,1] neg_hi:[0,0,1]
v_pk_fma_f32 v[46:47], v[46:47], v[244:245], v[242:243] neg_lo:[0,0,1] neg_hi:[0,0,1]
v_cvt_pk_bf16_f32 v22, v44, v45
v_cvt_pk_bf16_f32 v23, v46, v47
v_pk_fma_f32 v[48:49], v[48:49], v[220:221], v[218:219] neg_lo:[0,0,1] neg_hi:[0,0,1]
ds_read_b128 v[176:179], v250
v_cvt_pk_bf16_f32 v24, v48, v49
v_pk_fma_f32 v[50:51], v[50:51], v[220:221], v[218:219] neg_lo:[0,0,1] neg_hi:[0,0,1]
v_pk_fma_f32 v[52:53], v[52:53], v[220:221], v[218:219] neg_lo:[0,0,1] neg_hi:[0,0,1]
v_cvt_pk_bf16_f32 v25, v50, v51
v_cvt_pk_bf16_f32 v26, v52, v53
v_pk_fma_f32 v[54:55], v[54:55], v[220:221], v[218:219] neg_lo:[0,0,1] neg_hi:[0,0,1]
v_pk_fma_f32 v[56:57], v[56:57], v[220:221], v[218:219] neg_lo:[0,0,1] neg_hi:[0,0,1]
v_cvt_pk_bf16_f32 v27, v54, v55
v_cvt_pk_bf16_f32 v28, v56, v57
v_pk_fma_f32 v[58:59], v[58:59], v[220:221], v[218:219] neg_lo:[0,0,1] neg_hi:[0,0,1]
v_pk_fma_f32 v[60:61], v[60:61], v[220:221], v[218:219] neg_lo:[0,0,1] neg_hi:[0,0,1]
v_cvt_pk_bf16_f32 v29, v58, v59
v_cvt_pk_bf16_f32 v30, v60, v61
v_pk_fma_f32 v[62:63], v[62:63], v[220:221], v[218:219] neg_lo:[0,0,1] neg_hi:[0,0,1]
v_pk_fma_f32 v[64:65], v[64:65], v[220:221], v[218:219] neg_lo:[0,0,1] neg_hi:[0,0,1]
v_cvt_pk_bf16_f32 v31, v62, v63
v_cvt_pk_bf16_f32 v32, v64, v65
v_pk_fma_f32 v[66:67], v[66:67], v[220:221], v[218:219] neg_lo:[0,0,1] neg_hi:[0,0,1]
v_pk_fma_f32 v[68:69], v[68:69], v[220:221], v[218:219] neg_lo:[0,0,1] neg_hi:[0,0,1]
v_cvt_pk_bf16_f32 v33, v66, v67
v_cvt_pk_bf16_f32 v34, v68, v69
v_pk_fma_f32 v[70:71], v[70:71], v[220:221], v[218:219] neg_lo:[0,0,1] neg_hi:[0,0,1]
v_pk_fma_f32 v[72:73], v[72:73], v[220:221], v[218:219] neg_lo:[0,0,1] neg_hi:[0,0,1]
ds_read_b128 v[180:183], v250 offset:1024
v_cvt_pk_bf16_f32 v35, v70, v71
v_cvt_pk_bf16_f32 v36, v72, v73
v_pk_fma_f32 v[74:75], v[74:75], v[220:221], v[218:219] neg_lo:[0,0,1] neg_hi:[0,0,1]
v_pk_fma_f32 v[76:77], v[76:77], v[220:221], v[218:219] neg_lo:[0,0,1] neg_hi:[0,0,1]
v_cvt_pk_bf16_f32 v37, v74, v75
v_cvt_pk_bf16_f32 v38, v76, v77
v_pk_fma_f32 v[78:79], v[78:79], v[220:221], v[218:219] neg_lo:[0,0,1] neg_hi:[0,0,1]
v_pk_fma_f32 v[80:81], v[80:81], v[220:221], v[218:219] neg_lo:[0,0,1] neg_hi:[0,0,1]
v_cvt_pk_bf16_f32 v39, v78, v79
v_cvt_pk_bf16_f32 v40, v80, v81
v_pk_fma_f32 v[82:83], v[82:83], v[220:221], v[218:219] neg_lo:[0,0,1] neg_hi:[0,0,1]
v_pk_fma_f32 v[84:85], v[84:85], v[220:221], v[218:219] neg_lo:[0,0,1] neg_hi:[0,0,1]
v_cvt_pk_bf16_f32 v41, v82, v83
v_cvt_pk_bf16_f32 v42, v84, v85
v_pk_fma_f32 v[86:87], v[86:87], v[220:221], v[218:219] neg_lo:[0,0,1] neg_hi:[0,0,1]
v_pk_fma_f32 v[88:89], v[88:89], v[220:221], v[218:219] neg_lo:[0,0,1] neg_hi:[0,0,1]
v_cvt_pk_bf16_f32 v43, v86, v87
v_cvt_pk_bf16_f32 v44, v88, v89
v_pk_fma_f32 v[90:91], v[90:91], v[220:221], v[218:219] neg_lo:[0,0,1] neg_hi:[0,0,1]
v_pk_fma_f32 v[92:93], v[92:93], v[220:221], v[218:219] neg_lo:[0,0,1] neg_hi:[0,0,1]
v_cvt_pk_bf16_f32 v45, v90, v91
v_cvt_pk_bf16_f32 v46, v92, v93
v_pk_fma_f32 v[94:95], v[94:95], v[220:221], v[218:219] neg_lo:[0,0,1] neg_hi:[0,0,1]
ds_read_b128 v[184:187], v250 offset:2048
v_cvt_pk_bf16_f32 v47, v94, v95
s_waitcnt lgkmcnt(2)
v_mfma_f32_32x32x16_bf16 v[160:175], v[0:3], v[176:179], 0
ds_read_b128 v[188:191], v250 offset:3072
v_mfma_f32_32x32x16_bf16 v[96:111], v[24:27], v[176:179], 0
ds_read_b128 v[176:179], v250 offset:4096
s_waitcnt lgkmcnt(3)
v_mfma_f32_32x32x16_bf16 v[160:175], v[4:7], v[180:183], v[160:175]
v_mfma_f32_32x32x16_bf16 v[96:111], v[28:31], v[180:183], v[96:111]
ds_read_b128 v[180:183], v250 offset:5120
s_waitcnt lgkmcnt(3)
v_mfma_f32_32x32x16_bf16 v[160:175], v[8:11], v[184:187], v[160:175]
v_mfma_f32_32x32x16_bf16 v[96:111], v[32:35], v[184:187], v[96:111]
ds_read_b128 v[184:187], v250 offset:6144
s_waitcnt lgkmcnt(2)
v_mfma_f32_32x32x16_bf16 v[160:175], v[12:15], v[188:191], v[160:175]
v_mfma_f32_32x32x16_bf16 v[96:111], v[36:39], v[188:191], v[96:111]
ds_read_b128 v[188:191], v250 offset:7168
v_mfma_f32_32x32x16_bf16 v[160:175], v[16:19], v[176:179], v[160:175]
v_mfma_f32_32x32x16_bf16 v[96:111], v[40:43], v[176:179], v[96:111]
ds_read_b128 v[176:179], v250 offset:8192
s_waitcnt lgkmcnt(2)
v_mfma_f32_32x32x16_bf16 v[160:175], v[20:23], v[180:183], v[160:175]
v_mfma_f32_32x32x16_bf16 v[96:111], v[44:47], v[180:183], v[96:111]
ds_read_b128 v[180:183], v250 offset:9216
s_nop 9
v_cvt_pkrtz_f16_f32 v161, v160, v161
v_mfma_f32_32x32x16_bf16 v[112:127], v[0:3], v[184:187], 0
v_and_b32_e64 v161, s49, v161
v_bfe_u32 v160, v161, 2, 14
v_lshrrev_b32_e64 v161, 18, v161
v_cvt_pk_f16_f32 v172, v172, v173
v_cvt_pk_f16_f32 v174, v174, v175
v_pk_fma_f16 v173, v172, v172, s48
v_mfma_f32_32x32x16_bf16 v[128:143], v[24:27], v[184:187], 0
ds_read_u16 v160, v160
ds_read_u16 v161, v161
v_cvt_pkrtz_f16_f32 v163, v162, v163
v_and_b32_e64 v163, s49, v163
v_bfe_u32 v162, v163, 2, 14
v_lshrrev_b32_e64 v163, 18, v163
v_pk_fma_f16 v175, v174, v174, s48
v_pk_mul_f16 v173, v172, v173
v_pk_mul_f16 v175, v174, v175
v_cvt_pkrtz_f16_f32 v165, v164, v165
v_and_b32_e64 v165, s49, v165
v_bfe_u32 v164, v165, 2, 14
ds_read_u16 v162, v162
ds_read_u16 v163, v163
v_lshrrev_b32 v165, 18, v165
v_exp_f16_sdwa v173, v173 dst_sel:WORD_0 dst_unused:UNUSED_PRESERVE src0_sel:WORD_0
s_waitcnt lgkmcnt(4)
v_mfma_f32_32x32x16_bf16 v[112:127], v[4:7], v[188:191], v[112:127]
ds_read_u16 v164, v164
ds_read_u16 v165, v165
v_exp_f16_sdwa v175, v175 dst_sel:WORD_0 dst_unused:UNUSED_PRESERVE src0_sel:WORD_0
v_cvt_pkrtz_f16_f32 v167, v166, v167
v_and_b32_e64 v167, s49, v167
v_bfe_u32 v166, v167, 2, 14
v_lshrrev_b32_e64 v167, 18, v167
v_exp_f16_sdwa v173, v173 dst_sel:WORD_1 dst_unused:UNUSED_PRESERVE src0_sel:WORD_1
v_cvt_pkrtz_f16_f32 v169, v168, v169
v_and_b32_e64 v169, s49, v169
v_bfe_u32 v168, v169, 2, 14
v_lshrrev_b32_e64 v169, 18, v169
v_exp_f16_sdwa v175, v175 dst_sel:WORD_1 dst_unused:UNUSED_PRESERVE src0_sel:WORD_1
ds_read_u16 v166, v166
ds_read_u16 v167, v167
ds_read_u16 v168, v168
ds_read_u16 v169, v169
v_mfma_f32_32x32x16_bf16 v[128:143], v[28:31], v[188:191], v[128:143]
ds_read_b128 v[184:187], v250 offset:10240
v_cvt_pkrtz_f16_f32 v171, v170, v171
v_and_b32_e64 v171, s49, v171
v_bfe_u32 v170, v171, 2, 14
v_lshrrev_b32_e64 v171, 18, v171
v_pk_add_f16 v173, v173, 1.0 op_sel_hi:[1,0]
v_pk_add_f16 v175, v175, 1.0 op_sel_hi:[1,0]
v_rcp_f16_sdwa v173, v173 dst_sel:WORD_0 dst_unused:UNUSED_PRESERVE src0_sel:WORD_0
v_mfma_f32_32x32x16_bf16 v[112:127], v[8:11], v[176:179], v[112:127]
ds_read_u16 v170, v170
ds_read_u16 v171, v171
v_rcp_f16_sdwa v175, v175 dst_sel:WORD_0 dst_unused:UNUSED_PRESERVE src0_sel:WORD_0
v_rcp_f16_sdwa v173, v173 dst_sel:WORD_1 dst_unused:UNUSED_PRESERVE src0_sel:WORD_1
v_rcp_f16_sdwa v175, v175 dst_sel:WORD_1 dst_unused:UNUSED_PRESERVE src0_sel:WORD_1
v_mfma_f32_32x32x16_bf16 v[128:143], v[32:35], v[176:179], v[128:143]
ds_read_b128 v[188:191], v250 offset:11264
v_pk_mul_f16 v172, v172, v173
v_pk_mul_f16 v174, v174, v175
v_fma_mix_f32 v224, v172, v172, v224 op_sel_hi:[1,1,0]
v_cvt_pkrtz_f16_f32 v97, v96, v97
v_fma_mix_f32 v224, v174, v174, v224 op_sel_hi:[1,1,0]
v_mfma_f32_32x32x16_bf16 v[112:127], v[12:15], v[180:183], v[112:127]
v_fma_mix_f32 v224, v172, v172, v224 op_sel:[1,1,0] op_sel_hi:[1,1,0]
v_and_b32_e64 v97, s49, v97
v_fma_mix_f32 v224, v174, v174, v224 op_sel:[1,1,0] op_sel_hi:[1,1,0]
v_bfe_u32 v96, v97, 2, 14
s_waitcnt lgkmcnt(6)
v_fma_mix_f32 v224, v160, v160, v224 op_sel_hi:[1,1,0]
v_lshrrev_b32 v97, 18, v97
v_fma_mix_f32 v224, v161, v161, v224 op_sel_hi:[1,1,0]
v_cvt_pk_f16_f32 v108, v108, v109
v_fma_mix_f32 v224, v162, v162, v224 op_sel_hi:[1,1,0]
v_cvt_pk_f16_f32 v110, v110, v111
v_fma_mix_f32 v224, v163, v163, v224 op_sel_hi:[1,1,0]
v_pk_fma_f16 v109, v108, v108, s48
v_mfma_f32_32x32x16_bf16 v[128:143], v[36:39], v[180:183], v[128:143]
ds_read_u16 v96, v96
ds_read_u16 v97, v97
v_fma_mix_f32 v224, v164, v164, v224 op_sel_hi:[1,1,0]
v_cvt_pkrtz_f16_f32 v99, v98, v99
v_fma_mix_f32 v224, v165, v165, v224 op_sel_hi:[1,1,0]
v_and_b32_e64 v99, s49, v99
v_bfe_u32 v98, v99, 2, 14
v_lshrrev_b32_e64 v99, 18, v99
v_pk_fma_f16 v111, v110, v110, s48
v_pk_mul_f16 v109, v108, v109
v_pk_mul_f16 v111, v110, v111
v_fma_mix_f32 v224, v166, v166, v224 op_sel_hi:[1,1,0]
v_cvt_pkrtz_f16_f32 v101, v100, v101
v_fma_mix_f32 v224, v167, v167, v224 op_sel_hi:[1,1,0]
ds_read_u16 v98, v98
ds_read_u16 v99, v99
ds_read_b128 v[176:179], v250 offset:12288
v_and_b32_e64 v101, s49, v101
v_bfe_u32 v100, v101, 2, 14
v_lshrrev_b32 v101, 18, v101
v_exp_f16_sdwa v109, v109 dst_sel:WORD_0 dst_unused:UNUSED_PRESERVE src0_sel:WORD_0
s_waitcnt lgkmcnt(5)
v_mfma_f32_32x32x16_bf16 v[112:127], v[16:19], v[184:187], v[112:127]
ds_read_u16 v100, v100
ds_read_u16 v101, v101
v_exp_f16_sdwa v111, v111 dst_sel:WORD_0 dst_unused:UNUSED_PRESERVE src0_sel:WORD_0
v_fma_mix_f32 v224, v168, v168, v224 op_sel_hi:[1,1,0]
v_cvt_pkrtz_f16_f32 v103, v102, v103
v_fma_mix_f32 v224, v169, v169, v224 op_sel_hi:[1,1,0]
v_and_b32_e64 v103, s49, v103
v_bfe_u32 v102, v103, 2, 14
v_lshrrev_b32_e64 v103, 18, v103
v_exp_f16_sdwa v109, v109 dst_sel:WORD_1 dst_unused:UNUSED_PRESERVE src0_sel:WORD_1
v_fma_mix_f32 v224, v170, v170, v224 op_sel_hi:[1,1,0]
v_cvt_pkrtz_f16_f32 v105, v104, v105
v_fma_mix_f32 v224, v171, v171, v224 op_sel_hi:[1,1,0]
v_and_b32_e64 v105, s49, v105
v_bfe_u32 v104, v105, 2, 14
ds_read_u16 v102, v102
ds_read_u16 v103, v103
v_lshrrev_b32_e64 v105, 18, v105
v_exp_f16_sdwa v111, v111 dst_sel:WORD_1 dst_unused:UNUSED_PRESERVE src0_sel:WORD_1
v_mfma_f32_32x32x16_bf16 v[128:143], v[40:43], v[184:187], v[128:143]
ds_read_u16 v104, v104
ds_read_u16 v105, v105
ds_read_b128 v[180:183], v250 offset:13312
v_cvt_pkrtz_f16_f32 v107, v106, v107
v_and_b32_e64 v107, s49, v107
v_bfe_u32 v106, v107, 2, 14
v_lshrrev_b32_e64 v107, 18, v107
v_pk_add_f16 v109, v109, 1.0 op_sel_hi:[1,0]
v_pk_add_f16 v111, v111, 1.0 op_sel_hi:[1,0]
v_rcp_f16_sdwa v109, v109 dst_sel:WORD_0 dst_unused:UNUSED_PRESERVE src0_sel:WORD_0
v_mfma_f32_32x32x16_bf16 v[112:127], v[20:23], v[188:191], v[112:127]
ds_read_u16 v106, v106
ds_read_u16 v107, v107
v_rcp_f16_sdwa v111, v111 dst_sel:WORD_0 dst_unused:UNUSED_PRESERVE src0_sel:WORD_0
v_rcp_f16_sdwa v109, v109 dst_sel:WORD_1 dst_unused:UNUSED_PRESERVE src0_sel:WORD_1
v_rcp_f16_sdwa v111, v111 dst_sel:WORD_1 dst_unused:UNUSED_PRESERVE src0_sel:WORD_1
v_mfma_f32_32x32x16_bf16 v[128:143], v[44:47], v[188:191], v[128:143]
ds_read_b128 v[184:187], v250 offset:14336
v_pk_mul_f16 v108, v108, v109
v_pk_mul_f16 v110, v110, v111
v_fma_mix_f32 v224, v108, v108, v224 op_sel_hi:[1,1,0]
buffer_store_dwordx4 v[0:3], v250, s[32:35], s80 offen
v_fma_mix_f32 v224, v110, v110, v224 op_sel_hi:[1,1,0]
s_waitcnt lgkmcnt(7)
v_mfma_f32_32x32x16_bf16 v[144:159], v[0:3], v[176:179], 0
v_fma_mix_f32 v224, v108, v108, v224 op_sel:[1,1,0] op_sel_hi:[1,1,0]
v_cvt_pkrtz_f16_f32 v113, v112, v113
v_fma_mix_f32 v224, v110, v110, v224 op_sel:[1,1,0] op_sel_hi:[1,1,0]
v_and_b32 v113, s49, v113
v_fma_mix_f32 v224, v96, v96, v224 op_sel_hi:[1,1,0]
v_bfe_u32 v112, v113, 2, 14
v_fma_mix_f32 v224, v97, v97, v224 op_sel_hi:[1,1,0]
v_lshrrev_b32_e64 v113, 18, v113
v_fma_mix_f32 v224, v98, v98, v224 op_sel_hi:[1,1,0]
v_cvt_pk_f16_f32 v124, v124, v125
v_fma_mix_f32 v224, v99, v99, v224 op_sel_hi:[1,1,0]
v_cvt_pk_f16_f32 v126, v126, v127
v_pk_fma_f16 v125, v124, v124, s48
v_mfma_f32_32x32x16_bf16 v[160:175], v[24:27], v[176:179], 0
ds_read_u16 v112, v112
ds_read_u16 v113, v113
v_fma_mix_f32 v224, v100, v100, v224 op_sel_hi:[1,1,0]
v_cvt_pkrtz_f16_f32 v115, v114, v115
v_fma_mix_f32 v224, v101, v101, v224 op_sel_hi:[1,1,0]
v_and_b32_e64 v115, s49, v115
v_bfe_u32 v114, v115, 2, 14
v_lshrrev_b32_e64 v115, 18, v115
v_pk_fma_f16 v127, v126, v126, s48
v_pk_mul_f16 v125, v124, v125
v_pk_mul_f16 v127, v126, v127
v_fma_mix_f32 v224, v102, v102, v224 op_sel_hi:[1,1,0]
v_cvt_pkrtz_f16_f32 v117, v116, v117
s_waitcnt lgkmcnt(3)
v_fma_mix_f32 v224, v103, v103, v224 op_sel_hi:[1,1,0]
ds_read_u16 v114, v114
ds_read_u16 v115, v115
ds_read_b128 v[188:191], v250 offset:15360
v_and_b32 v117, s49, v117
v_bfe_u32 v116, v117, 2, 14
v_lshrrev_b32_e64 v117, 18, v117
v_exp_f16_sdwa v125, v125 dst_sel:WORD_0 dst_unused:UNUSED_PRESERVE src0_sel:WORD_0
v_mfma_f32_32x32x16_bf16 v[144:159], v[4:7], v[180:183], v[144:159]
ds_read_u16 v116, v116
ds_read_u16 v117, v117
v_exp_f16_sdwa v127, v127 dst_sel:WORD_0 dst_unused:UNUSED_PRESERVE src0_sel:WORD_0
v_fma_mix_f32 v224, v104, v104, v224 op_sel_hi:[1,1,0]
v_cvt_pkrtz_f16_f32 v119, v118, v119
v_fma_mix_f32 v224, v105, v105, v224 op_sel_hi:[1,1,0]
v_and_b32_e64 v119, s49, v119
v_bfe_u32 v118, v119, 2, 14
v_lshrrev_b32_e64 v119, 18, v119
v_exp_f16_sdwa v125, v125 dst_sel:WORD_1 dst_unused:UNUSED_PRESERVE src0_sel:WORD_1
v_fma_mix_f32 v224, v106, v106, v224 op_sel_hi:[1,1,0]
v_cvt_pkrtz_f16_f32 v121, v120, v121
v_fma_mix_f32 v224, v107, v107, v224 op_sel_hi:[1,1,0]
v_and_b32_e64 v121, s49, v121
v_bfe_u32 v120, v121, 2, 14
ds_read_u16 v118, v118
ds_read_u16 v119, v119
v_lshrrev_b32_e64 v121, 18, v121
v_exp_f16_sdwa v127, v127 dst_sel:WORD_1 dst_unused:UNUSED_PRESERVE src0_sel:WORD_1
v_mfma_f32_32x32x16_bf16 v[160:175], v[28:31], v[180:183], v[160:175]
ds_read_u16 v120, v120
ds_read_u16 v121, v121
ds_read_b128 v[176:179], v250 offset:16384
v_cvt_pkrtz_f16_f32 v123, v122, v123
v_and_b32_e64 v123, s49, v123
v_bfe_u32 v122, v123, 2, 14
v_lshrrev_b32 v123, 18, v123
v_pk_add_f16 v125, v125, 1.0 op_sel_hi:[1,0]
v_pk_add_f16 v127, v127, 1.0 op_sel_hi:[1,0]
v_rcp_f16_sdwa v125, v125 dst_sel:WORD_0 dst_unused:UNUSED_PRESERVE src0_sel:WORD_0
s_waitcnt lgkmcnt(7)
v_mfma_f32_32x32x16_bf16 v[144:159], v[8:11], v[184:187], v[144:159]
ds_read_u16 v122, v122
ds_read_u16 v123, v123
v_rcp_f16_sdwa v127, v127 dst_sel:WORD_0 dst_unused:UNUSED_PRESERVE src0_sel:WORD_0
s_add_u32 s46, s80, 2097152
buffer_store_dwordx4 v[4:7], v250, s[32:35], s46 offen
v_rcp_f16_sdwa v125, v125 dst_sel:WORD_1 dst_unused:UNUSED_PRESERVE src0_sel:WORD_1
v_rcp_f16_sdwa v127, v127 dst_sel:WORD_1 dst_unused:UNUSED_PRESERVE src0_sel:WORD_1
v_mfma_f32_32x32x16_bf16 v[160:175], v[32:35], v[184:187], v[160:175]
ds_read_b128 v[180:183], v250 offset:17408
v_pk_mul_f16 v124, v124, v125
v_pk_mul_f16 v126, v126, v127
v_fma_mix_f32 v225, v124, v124, v225 op_sel_hi:[1,1,0]
v_cvt_pkrtz_f16_f32 v129, v128, v129
v_fma_mix_f32 v225, v126, v126, v225 op_sel_hi:[1,1,0]
v_mfma_f32_32x32x16_bf16 v[144:159], v[12:15], v[188:191], v[144:159]
v_fma_mix_f32 v225, v124, v124, v225 op_sel:[1,1,0] op_sel_hi:[1,1,0]
v_and_b32_e64 v129, s49, v129
v_fma_mix_f32 v225, v126, v126, v225 op_sel:[1,1,0] op_sel_hi:[1,1,0]
v_bfe_u32 v128, v129, 2, 14
v_fma_mix_f32 v225, v112, v112, v225 op_sel_hi:[1,1,0]
v_lshrrev_b32_e64 v129, 18, v129
v_fma_mix_f32 v225, v113, v113, v225 op_sel_hi:[1,1,0]
v_cvt_pk_f16_f32 v140, v140, v141
v_fma_mix_f32 v225, v114, v114, v225 op_sel_hi:[1,1,0]
v_cvt_pk_f16_f32 v142, v142, v143
v_fma_mix_f32 v225, v115, v115, v225 op_sel_hi:[1,1,0]
v_pk_fma_f16 v141, v140, v140, s48
v_mfma_f32_32x32x16_bf16 v[160:175], v[36:39], v[188:191], v[160:175]
ds_read_u16 v128, v128
ds_read_u16 v129, v129
s_waitcnt lgkmcnt(5)
v_fma_mix_f32 v225, v116, v116, v225 op_sel_hi:[1,1,0]
v_cvt_pkrtz_f16_f32 v131, v130, v131
v_fma_mix_f32 v225, v117, v117, v225 op_sel_hi:[1,1,0]
v_and_b32 v131, s49, v131
v_bfe_u32 v130, v131, 2, 14
v_lshrrev_b32_e64 v131, 18, v131
v_pk_fma_f16 v143, v142, v142, s48
v_pk_mul_f16 v141, v140, v141
v_pk_mul_f16 v143, v142, v143
v_fma_mix_f32 v225, v118, v118, v225 op_sel_hi:[1,1,0]
v_cvt_pkrtz_f16_f32 v133, v132, v133
v_fma_mix_f32 v225, v119, v119, v225 op_sel_hi:[1,1,0]
ds_read_u16 v130, v130
ds_read_u16 v131, v131
ds_read_b128 v[184:187], v250 offset:18432
v_and_b32_e64 v133, s49, v133
v_bfe_u32 v132, v133, 2, 14
v_lshrrev_b32_e64 v133, 18, v133
v_exp_f16_sdwa v141, v141 dst_sel:WORD_0 dst_unused:UNUSED_PRESERVE src0_sel:WORD_0
v_mfma_f32_32x32x16_bf16 v[144:159], v[16:19], v[176:179], v[144:159]
ds_read_u16 v132, v132
ds_read_u16 v133, v133
v_exp_f16_sdwa v143, v143 dst_sel:WORD_0 dst_unused:UNUSED_PRESERVE src0_sel:WORD_0
v_fma_mix_f32 v225, v120, v120, v225 op_sel_hi:[1,1,0]
v_cvt_pkrtz_f16_f32 v135, v134, v135
v_fma_mix_f32 v225, v121, v121, v225 op_sel_hi:[1,1,0]
v_and_b32_e64 v135, s49, v135
v_bfe_u32 v134, v135, 2, 14
v_lshrrev_b32 v135, 18, v135
v_exp_f16_sdwa v141, v141 dst_sel:WORD_1 dst_unused:UNUSED_PRESERVE src0_sel:WORD_1
s_waitcnt lgkmcnt(6)
v_fma_mix_f32 v225, v122, v122, v225 op_sel_hi:[1,1,0]
v_cvt_pkrtz_f16_f32 v137, v136, v137
v_fma_mix_f32 v225, v123, v123, v225 op_sel_hi:[1,1,0]
v_and_b32_e64 v137, s49, v137
v_bfe_u32 v136, v137, 2, 14
ds_read_u16 v134, v134
ds_read_u16 v135, v135
s_add_u32 s46, s80, 4194304
buffer_store_dwordx4 v[8:11], v250, s[32:35], s46 offen
v_lshrrev_b32_e64 v137, 18, v137
v_exp_f16_sdwa v143, v143 dst_sel:WORD_1 dst_unused:UNUSED_PRESERVE src0_sel:WORD_1
v_mfma_f32_32x32x16_bf16 v[160:175], v[40:43], v[176:179], v[160:175]
ds_read_u16 v136, v136
ds_read_u16 v137, v137
ds_read_b128 v[188:191], v250 offset:19456
v_cvt_pkrtz_f16_f32 v139, v138, v139
v_and_b32_e64 v139, s49, v139
v_bfe_u32 v138, v139, 2, 14
v_lshrrev_b32_e64 v139, 18, v139
v_pk_add_f16 v141, v141, 1.0 op_sel_hi:[1,0]
v_pk_add_f16 v143, v143, 1.0 op_sel_hi:[1,0]
v_rcp_f16_sdwa v141, v141 dst_sel:WORD_0 dst_unused:UNUSED_PRESERVE src0_sel:WORD_0
v_mfma_f32_32x32x16_bf16 v[144:159], v[20:23], v[180:183], v[144:159]
ds_read_u16 v138, v138
ds_read_u16 v139, v139
v_rcp_f16_sdwa v143, v143 dst_sel:WORD_0 dst_unused:UNUSED_PRESERVE src0_sel:WORD_0
v_rcp_f16_sdwa v141, v141 dst_sel:WORD_1 dst_unused:UNUSED_PRESERVE src0_sel:WORD_1
v_rcp_f16_sdwa v143, v143 dst_sel:WORD_1 dst_unused:UNUSED_PRESERVE src0_sel:WORD_1
v_mfma_f32_32x32x16_bf16 v[160:175], v[44:47], v[180:183], v[160:175]
ds_read_b128 v[176:179], v250 offset:20480
v_pk_mul_f16 v140, v140, v141
v_pk_mul_f16 v142, v142, v143
v_fma_mix_f32 v225, v140, v140, v225 op_sel_hi:[1,1,0]
s_nop 1
v_cvt_pkrtz_f16_f32 v145, v144, v145
v_fma_mix_f32 v225, v142, v142, v225 op_sel_hi:[1,1,0]
s_waitcnt lgkmcnt(7)
v_mfma_f32_32x32x16_bf16 v[96:111], v[0:3], v[184:187], 0
v_fma_mix_f32 v225, v140, v140, v225 op_sel:[1,1,0] op_sel_hi:[1,1,0]
v_and_b32_e64 v145, s49, v145
v_fma_mix_f32 v225, v142, v142, v225 op_sel:[1,1,0] op_sel_hi:[1,1,0]
v_bfe_u32 v144, v145, 2, 14
v_fma_mix_f32 v225, v128, v128, v225 op_sel_hi:[1,1,0]
v_lshrrev_b32_e64 v145, 18, v145
v_fma_mix_f32 v225, v129, v129, v225 op_sel_hi:[1,1,0]
v_cvt_pk_f16_f32 v156, v156, v157
v_fma_mix_f32 v225, v130, v130, v225 op_sel_hi:[1,1,0]
v_cvt_pk_f16_f32 v158, v158, v159
v_fma_mix_f32 v225, v131, v131, v225 op_sel_hi:[1,1,0]
s_add_u32 s46, s80, 6291456
buffer_store_dwordx4 v[12:15], v250, s[32:35], s46 offen
ds_read_u16 v144, v144
ds_read_u16 v145, v145
v_pk_fma_f16 v157, v156, v156, s48
v_mfma_f32_32x32x16_bf16 v[112:127], v[24:27], v[184:187], 0
v_fma_mix_f32 v225, v132, v132, v225 op_sel_hi:[1,1,0]
v_cvt_pkrtz_f16_f32 v147, v146, v147
v_fma_mix_f32 v225, v133, v133, v225 op_sel_hi:[1,1,0]
v_and_b32_e64 v147, s49, v147
v_bfe_u32 v146, v147, 2, 14
v_lshrrev_b32_e64 v147, 18, v147
v_pk_fma_f16 v159, v158, v158, s48
v_pk_mul_f16 v157, v156, v157
v_pk_mul_f16 v159, v158, v159
v_fma_mix_f32 v225, v134, v134, v225 op_sel_hi:[1,1,0]
v_cvt_pkrtz_f16_f32 v149, v148, v149
s_waitcnt lgkmcnt(3)
v_fma_mix_f32 v225, v135, v135, v225 op_sel_hi:[1,1,0]
ds_read_u16 v146, v146
ds_read_u16 v147, v147
ds_read_b128 v[180:183], v250 offset:21504
v_and_b32 v149, s49, v149
v_bfe_u32 v148, v149, 2, 14
v_lshrrev_b32_e64 v149, 18, v149
v_exp_f16_sdwa v157, v157 dst_sel:WORD_0 dst_unused:UNUSED_PRESERVE src0_sel:WORD_0
v_mfma_f32_32x32x16_bf16 v[96:111], v[4:7], v[188:191], v[96:111]
ds_read_u16 v148, v148
ds_read_u16 v149, v149
v_exp_f16_sdwa v159, v159 dst_sel:WORD_0 dst_unused:UNUSED_PRESERVE src0_sel:WORD_0
v_fma_mix_f32 v225, v136, v136, v225 op_sel_hi:[1,1,0]
v_cvt_pkrtz_f16_f32 v151, v150, v151
v_fma_mix_f32 v225, v137, v137, v225 op_sel_hi:[1,1,0]
v_and_b32_e64 v151, s49, v151
v_bfe_u32 v150, v151, 2, 14
v_lshrrev_b32_e64 v151, 18, v151
v_exp_f16_sdwa v157, v157 dst_sel:WORD_1 dst_unused:UNUSED_PRESERVE src0_sel:WORD_1
v_fma_mix_f32 v225, v138, v138, v225 op_sel_hi:[1,1,0]
v_cvt_pkrtz_f16_f32 v153, v152, v153
v_fma_mix_f32 v225, v139, v139, v225 op_sel_hi:[1,1,0]
v_and_b32_e64 v153, s49, v153
v_bfe_u32 v152, v153, 2, 14
ds_read_u16 v150, v150
ds_read_u16 v151, v151
v_lshrrev_b32_e64 v153, 18, v153
v_exp_f16_sdwa v159, v159 dst_sel:WORD_1 dst_unused:UNUSED_PRESERVE src0_sel:WORD_1
v_mfma_f32_32x32x16_bf16 v[112:127], v[28:31], v[188:191], v[112:127]
ds_read_u16 v152, v152
ds_read_u16 v153, v153
ds_read_b128 v[184:187], v250 offset:22528
v_cvt_pkrtz_f16_f32 v155, v154, v155
v_and_b32_e64 v155, s49, v155
v_bfe_u32 v154, v155, 2, 14
v_lshrrev_b32 v155, 18, v155
v_pk_add_f16 v157, v157, 1.0 op_sel_hi:[1,0]
v_pk_add_f16 v159, v159, 1.0 op_sel_hi:[1,0]
v_rcp_f16_sdwa v157, v157 dst_sel:WORD_0 dst_unused:UNUSED_PRESERVE src0_sel:WORD_0
s_waitcnt lgkmcnt(7)
v_mfma_f32_32x32x16_bf16 v[96:111], v[8:11], v[176:179], v[96:111]
ds_read_u16 v154, v154
ds_read_u16 v155, v155
v_rcp_f16_sdwa v159, v159 dst_sel:WORD_0 dst_unused:UNUSED_PRESERVE src0_sel:WORD_0
v_rcp_f16_sdwa v157, v157 dst_sel:WORD_1 dst_unused:UNUSED_PRESERVE src0_sel:WORD_1
s_add_u32 s46, s80, 8388608
buffer_store_dwordx4 v[16:19], v250, s[32:35], s46 offen
v_rcp_f16_sdwa v159, v159 dst_sel:WORD_1 dst_unused:UNUSED_PRESERVE src0_sel:WORD_1
v_mfma_f32_32x32x16_bf16 v[112:127], v[32:35], v[176:179], v[112:127]
ds_read_b128 v[188:191], v250 offset:23552
v_mov_b32 v223, 0
s_branch Law3
Lax3:
s_sleep 2
Law3:
ds_read_b32 v223, v247 offset:12
s_sub_u32 s76, s76, 1
s_cselect_b32 s44, 4, 0
s_cselect_b32 s76, 0, s76
s_waitcnt lgkmcnt(0)
v_readfirstlane_b32 s43, v223
s_nop 1
s_max_u32 s43, s43, s44
s_cmp_lt_u32 s43, 4
s_cbranch_scc1 Lax3
v_pk_mul_f16 v156, v156, v157
v_pk_mul_f16 v158, v158, v159
v_fma_mix_f32 v226, v156, v156, v226 op_sel_hi:[1,1,0]
v_mfma_f32_32x32x16_bf16 v[96:111], v[12:15], v[180:183], v[96:111]
v_fma_mix_f32 v226, v158, v158, v226 op_sel_hi:[1,1,0]
s_setprio 3
v_cvt_pkrtz_f16_f32 v161, v160, v161
v_fma_mix_f32 v226, v156, v156, v226 op_sel:[1,1,0] op_sel_hi:[1,1,0]
v_and_b32 v161, s49, v161
v_fma_mix_f32 v226, v158, v158, v226 op_sel:[1,1,0] op_sel_hi:[1,1,0]
v_bfe_u32 v160, v161, 2, 14
v_fma_mix_f32 v226, v144, v144, v226 op_sel_hi:[1,1,0]
v_lshrrev_b32_e64 v161, 18, v161
v_fma_mix_f32 v226, v145, v145, v226 op_sel_hi:[1,1,0]
v_cvt_pk_f16_f32 v172, v172, v173
v_fma_mix_f32 v226, v146, v146, v226 op_sel_hi:[1,1,0]
v_cvt_pk_f16_f32 v174, v174, v175
v_fma_mix_f32 v226, v147, v147, v226 op_sel_hi:[1,1,0]
v_pk_fma_f16 v173, v172, v172, s48
v_mfma_f32_32x32x16_bf16 v[112:127], v[36:39], v[180:183], v[112:127]
ds_read_u16 v160, v160
ds_read_u16 v161, v161
v_fma_mix_f32 v226, v148, v148, v226 op_sel_hi:[1,1,0]
v_cvt_pkrtz_f16_f32 v163, v162, v163
v_fma_mix_f32 v226, v149, v149, v226 op_sel_hi:[1,1,0]
v_and_b32_e64 v163, s49, v163
v_bfe_u32 v162, v163, 2, 14
v_lshrrev_b32_e64 v163, 18, v163
v_pk_fma_f16 v175, v174, v174, s48
v_pk_mul_f16 v173, v172, v173
v_pk_mul_f16 v175, v174, v175
v_fma_mix_f32 v226, v150, v150, v226 op_sel_hi:[1,1,0]
v_cvt_pkrtz_f16_f32 v165, v164, v165
v_fma_mix_f32 v226, v151, v151, v226 op_sel_hi:[1,1,0]
ds_read_u16 v162, v162
ds_read_u16 v163, v163
ds_read_b128 v[176:179], v250 offset:24576
v_and_b32_e64 v165, s49, v165
v_bfe_u32 v164, v165, 2, 14
v_lshrrev_b32_e64 v165, 18, v165
v_exp_f16_sdwa v173, v173 dst_sel:WORD_0 dst_unused:UNUSED_PRESERVE src0_sel:WORD_0
v_mfma_f32_32x32x16_bf16 v[96:111], v[16:19], v[184:187], v[96:111]
ds_read_u16 v164, v164
ds_read_u16 v165, v165
v_exp_f16_sdwa v175, v175 dst_sel:WORD_0 dst_unused:UNUSED_PRESERVE src0_sel:WORD_0
v_fma_mix_f32 v226, v152, v152, v226 op_sel_hi:[1,1,0]
v_cvt_pkrtz_f16_f32 v167, v166, v167
v_fma_mix_f32 v226, v153, v153, v226 op_sel_hi:[1,1,0]
v_and_b32_e64 v167, s49, v167
v_bfe_u32 v166, v167, 2, 14
v_lshrrev_b32_e64 v167, 18, v167
v_exp_f16_sdwa v173, v173 dst_sel:WORD_1 dst_unused:UNUSED_PRESERVE src0_sel:WORD_1
v_fma_mix_f32 v226, v154, v154, v226 op_sel_hi:[1,1,0]
v_cvt_pkrtz_f16_f32 v169, v168, v169
v_fma_mix_f32 v226, v155, v155, v226 op_sel_hi:[1,1,0]
v_and_b32_e64 v169, s49, v169
v_bfe_u32 v168, v169, 2, 14
ds_read_u16 v166, v166
ds_read_u16 v167, v167
v_lshrrev_b32_e64 v169, 18, v169
v_exp_f16_sdwa v175, v175 dst_sel:WORD_1 dst_unused:UNUSED_PRESERVE src0_sel:WORD_1
v_mfma_f32_32x32x16_bf16 v[112:127], v[40:43], v[184:187], v[112:127]
ds_read_u16 v168, v168
ds_read_u16 v169, v169
s_add_u32 s46, s80, 10485760
buffer_store_dwordx4 v[20:23], v250, s[32:35], s46 offen
ds_read_b128 v[180:183], v250 offset:25600
v_cvt_pkrtz_f16_f32 v171, v170, v171
v_and_b32_e64 v171, s49, v171
v_bfe_u32 v170, v171, 2, 14
v_lshrrev_b32_e64 v171, 18, v171
v_pk_add_f16 v173, v173, 1.0 op_sel_hi:[1,0]
v_pk_add_f16 v175, v175, 1.0 op_sel_hi:[1,0]
v_rcp_f16_sdwa v173, v173 dst_sel:WORD_0 dst_unused:UNUSED_PRESERVE src0_sel:WORD_0
v_mfma_f32_32x32x16_bf16 v[96:111], v[20:23], v[188:191], v[96:111]
ds_read_u16 v170, v170
ds_read_u16 v171, v171
v_rcp_f16_sdwa v175, v175 dst_sel:WORD_0 dst_unused:UNUSED_PRESERVE src0_sel:WORD_0
v_rcp_f16_sdwa v173, v173 dst_sel:WORD_1 dst_unused:UNUSED_PRESERVE src0_sel:WORD_1
v_rcp_f16_sdwa v175, v175 dst_sel:WORD_1 dst_unused:UNUSED_PRESERVE src0_sel:WORD_1
v_mfma_f32_32x32x16_bf16 v[112:127], v[44:47], v[188:191], v[112:127]
ds_read_b128 v[184:187], v250 offset:26624
v_pk_mul_f16 v172, v172, v173
v_pk_mul_f16 v174, v174, v175
v_fma_mix_f32 v226, v172, v172, v226 op_sel_hi:[1,1,0]
s_nop 1
v_cvt_pkrtz_f16_f32 v97, v96, v97
v_fma_mix_f32 v226, v174, v174, v226 op_sel_hi:[1,1,0]
s_waitcnt lgkmcnt(7)
v_mfma_f32_32x32x16_bf16 v[128:143], v[0:3], v[176:179], 0
v_fma_mix_f32 v226, v172, v172, v226 op_sel:[1,1,0] op_sel_hi:[1,1,0]
v_and_b32_e64 v97, s49, v97
v_fma_mix_f32 v226, v174, v174, v226 op_sel:[1,1,0] op_sel_hi:[1,1,0]
v_bfe_u32 v96, v97, 2, 14
v_fma_mix_f32 v226, v160, v160, v226 op_sel_hi:[1,1,0]
v_lshrrev_b32_e64 v97, 18, v97
v_fma_mix_f32 v226, v161, v161, v226 op_sel_hi:[1,1,0]
v_cvt_pk_f16_f32 v108, v108, v109
v_fma_mix_f32 v226, v162, v162, v226 op_sel_hi:[1,1,0]
v_cvt_pk_f16_f32 v110, v110, v111
v_fma_mix_f32 v226, v163, v163, v226 op_sel_hi:[1,1,0]
v_pk_fma_f16 v109, v108, v108, s48
v_mfma_f32_32x32x16_bf16 v[144:159], v[24:27], v[176:179], 0
ds_read_u16 v96, v96
ds_read_u16 v97, v97
v_fma_mix_f32 v226, v164, v164, v226 op_sel_hi:[1,1,0]
v_cvt_pkrtz_f16_f32 v99, v98, v99
v_fma_mix_f32 v226, v165, v165, v226 op_sel_hi:[1,1,0]
v_and_b32_e64 v99, s49, v99
v_bfe_u32 v98, v99, 2, 14
v_lshrrev_b32_e64 v99, 18, v99
v_pk_fma_f16 v111, v110, v110, s48
v_pk_mul_f16 v109, v108, v109
v_pk_mul_f16 v111, v110, v111
v_fma_mix_f32 v226, v166, v166, v226 op_sel_hi:[1,1,0]
v_cvt_pkrtz_f16_f32 v101, v100, v101
s_waitcnt lgkmcnt(3)
v_fma_mix_f32 v226, v167, v167, v226 op_sel_hi:[1,1,0]
ds_read_u16 v98, v98
ds_read_u16 v99, v99
ds_read_b128 v[188:191], v250 offset:27648
v_and_b32 v101, s49, v101
v_bfe_u32 v100, v101, 2, 14
v_lshrrev_b32_e64 v101, 18, v101
v_exp_f16_sdwa v109, v109 dst_sel:WORD_0 dst_unused:UNUSED_PRESERVE src0_sel:WORD_0
v_mfma_f32_32x32x16_bf16 v[128:143], v[4:7], v[180:183], v[128:143]
ds_read_u16 v100, v100
ds_read_u16 v101, v101
v_exp_f16_sdwa v111, v111 dst_sel:WORD_0 dst_unused:UNUSED_PRESERVE src0_sel:WORD_0
v_fma_mix_f32 v226, v168, v168, v226 op_sel_hi:[1,1,0]
v_cvt_pkrtz_f16_f32 v103, v102, v103
v_fma_mix_f32 v226, v169, v169, v226 op_sel_hi:[1,1,0]
v_and_b32_e64 v103, s49, v103
v_bfe_u32 v102, v103, 2, 14
v_lshrrev_b32_e64 v103, 18, v103
v_exp_f16_sdwa v109, v109 dst_sel:WORD_1 dst_unused:UNUSED_PRESERVE src0_sel:WORD_1
v_fma_mix_f32 v226, v170, v170, v226 op_sel_hi:[1,1,0]
v_cvt_pkrtz_f16_f32 v105, v104, v105
v_fma_mix_f32 v226, v171, v171, v226 op_sel_hi:[1,1,0]
v_and_b32_e64 v105, s49, v105
v_bfe_u32 v104, v105, 2, 14
ds_read_u16 v102, v102
ds_read_u16 v103, v103
v_lshrrev_b32_e64 v105, 18, v105
v_exp_f16_sdwa v111, v111 dst_sel:WORD_1 dst_unused:UNUSED_PRESERVE src0_sel:WORD_1
v_mfma_f32_32x32x16_bf16 v[144:159], v[28:31], v[180:183], v[144:159]
ds_read_u16 v104, v104
ds_read_u16 v105, v105
ds_read_b128 v[176:179], v250 offset:28672
v_cvt_pkrtz_f16_f32 v107, v106, v107
v_and_b32_e64 v107, s49, v107
v_bfe_u32 v106, v107, 2, 14
v_lshrrev_b32 v107, 18, v107
v_pk_add_f16 v109, v109, 1.0 op_sel_hi:[1,0]
v_pk_add_f16 v111, v111, 1.0 op_sel_hi:[1,0]
v_rcp_f16_sdwa v109, v109 dst_sel:WORD_0 dst_unused:UNUSED_PRESERVE src0_sel:WORD_0
s_waitcnt lgkmcnt(7)
v_mfma_f32_32x32x16_bf16 v[128:143], v[8:11], v[184:187], v[128:143]
ds_read_u16 v106, v106
ds_read_u16 v107, v107
v_rcp_f16_sdwa v111, v111 dst_sel:WORD_0 dst_unused:UNUSED_PRESERVE src0_sel:WORD_0
v_rcp_f16_sdwa v109, v109 dst_sel:WORD_1 dst_unused:UNUSED_PRESERVE src0_sel:WORD_1
v_rcp_f16_sdwa v111, v111 dst_sel:WORD_1 dst_unused:UNUSED_PRESERVE src0_sel:WORD_1
v_mfma_f32_32x32x16_bf16 v[144:159], v[32:35], v[184:187], v[144:159]
ds_read_b128 v[180:183], v250 offset:29696
v_pk_mul_f16 v108, v108, v109
v_pk_mul_f16 v110, v110, v111
v_fma_mix_f32 v227, v108, v108, v227 op_sel_hi:[1,1,0]
v_cvt_pkrtz_f16_f32 v113, v112, v113
v_fma_mix_f32 v227, v110, v110, v227 op_sel_hi:[1,1,0]
v_mfma_f32_32x32x16_bf16 v[128:143], v[12:15], v[188:191], v[128:143]
v_fma_mix_f32 v227, v108, v108, v227 op_sel:[1,1,0] op_sel_hi:[1,1,0]
v_and_b32_e64 v113, s49, v113
v_fma_mix_f32 v227, v110, v110, v227 op_sel:[1,1,0] op_sel_hi:[1,1,0]
v_bfe_u32 v112, v113, 2, 14
v_fma_mix_f32 v227, v96, v96, v227 op_sel_hi:[1,1,0]
v_lshrrev_b32_e64 v113, 18, v113
v_fma_mix_f32 v227, v97, v97, v227 op_sel_hi:[1,1,0]
v_cvt_pk_f16_f32 v124, v124, v125
v_fma_mix_f32 v227, v98, v98, v227 op_sel_hi:[1,1,0]
v_cvt_pk_f16_f32 v126, v126, v127
v_fma_mix_f32 v227, v99, v99, v227 op_sel_hi:[1,1,0]
v_pk_fma_f16 v125, v124, v124, s48
v_mfma_f32_32x32x16_bf16 v[144:159], v[36:39], v[188:191], v[144:159]
ds_read_u16 v112, v112
ds_read_u16 v113, v113
s_waitcnt lgkmcnt(5)
v_fma_mix_f32 v227, v100, v100, v227 op_sel_hi:[1,1,0]
v_cvt_pkrtz_f16_f32 v115, v114, v115
v_fma_mix_f32 v227, v101, v101, v227 op_sel_hi:[1,1,0]
v_and_b32 v115, s49, v115
v_bfe_u32 v114, v115, 2, 14
v_lshrrev_b32_e64 v115, 18, v115
v_pk_fma_f16 v127, v126, v126, s48
v_pk_mul_f16 v125, v124, v125
v_pk_mul_f16 v127, v126, v127
v_fma_mix_f32 v227, v102, v102, v227 op_sel_hi:[1,1,0]
v_cvt_pkrtz_f16_f32 v117, v116, v117
v_fma_mix_f32 v227, v103, v103, v227 op_sel_hi:[1,1,0]
ds_read_u16 v114, v114
ds_read_u16 v115, v115
ds_read_b128 v[184:187], v250 offset:30720
v_and_b32_e64 v117, s49, v117
v_bfe_u32 v116, v117, 2, 14
v_lshrrev_b32_e64 v117, 18, v117
v_exp_f16_sdwa v125, v125 dst_sel:WORD_0 dst_unused:UNUSED_PRESERVE src0_sel:WORD_0
v_mfma_f32_32x32x16_bf16 v[128:143], v[16:19], v[176:179], v[128:143]
ds_read_u16 v116, v116
ds_read_u16 v117, v117
v_exp_f16_sdwa v127, v127 dst_sel:WORD_0 dst_unused:UNUSED_PRESERVE src0_sel:WORD_0
v_fma_mix_f32 v227, v104, v104, v227 op_sel_hi:[1,1,0]
v_cvt_pkrtz_f16_f32 v119, v118, v119
v_fma_mix_f32 v227, v105, v105, v227 op_sel_hi:[1,1,0]
v_and_b32_e64 v119, s49, v119
v_bfe_u32 v118, v119, 2, 14
v_lshrrev_b32 v119, 18, v119
v_exp_f16_sdwa v125, v125 dst_sel:WORD_1 dst_unused:UNUSED_PRESERVE src0_sel:WORD_1
s_waitcnt lgkmcnt(6)
v_fma_mix_f32 v227, v106, v106, v227 op_sel_hi:[1,1,0]
v_cvt_pkrtz_f16_f32 v121, v120, v121
v_fma_mix_f32 v227, v107, v107, v227 op_sel_hi:[1,1,0]
v_and_b32_e64 v121, s49, v121
v_bfe_u32 v120, v121, 2, 14
ds_read_u16 v118, v118
ds_read_u16 v119, v119
v_lshrrev_b32_e64 v121, 18, v121
v_exp_f16_sdwa v127, v127 dst_sel:WORD_1 dst_unused:UNUSED_PRESERVE src0_sel:WORD_1
v_mfma_f32_32x32x16_bf16 v[144:159], v[40:43], v[176:179], v[144:159]
ds_read_u16 v120, v120
ds_read_u16 v121, v121
ds_read_b128 v[188:191], v250 offset:31744
v_cvt_pkrtz_f16_f32 v123, v122, v123
v_and_b32_e64 v123, s49, v123
v_bfe_u32 v122, v123, 2, 14
v_lshrrev_b32_e64 v123, 18, v123
v_pk_add_f16 v125, v125, 1.0 op_sel_hi:[1,0]
v_pk_add_f16 v127, v127, 1.0 op_sel_hi:[1,0]
v_rcp_f16_sdwa v125, v125 dst_sel:WORD_0 dst_unused:UNUSED_PRESERVE src0_sel:WORD_0
v_mfma_f32_32x32x16_bf16 v[128:143], v[20:23], v[180:183], v[128:143]
ds_read_u16 v122, v122
ds_read_u16 v123, v123
v_rcp_f16_sdwa v127, v127 dst_sel:WORD_0 dst_unused:UNUSED_PRESERVE src0_sel:WORD_0
v_rcp_f16_sdwa v125, v125 dst_sel:WORD_1 dst_unused:UNUSED_PRESERVE src0_sel:WORD_1
v_rcp_f16_sdwa v127, v127 dst_sel:WORD_1 dst_unused:UNUSED_PRESERVE src0_sel:WORD_1
v_mfma_f32_32x32x16_bf16 v[144:159], v[44:47], v[180:183], v[144:159]
ds_read_b128 v[176:179], v250 offset:32768
v_pk_mul_f16 v124, v124, v125
v_pk_mul_f16 v126, v126, v127
v_fma_mix_f32 v227, v124, v124, v227 op_sel_hi:[1,1,0]
s_cmp_lg_u32 s40, 7
s_cbranch_scc1 Lnoinit
s_waitcnt vmcnt(0)
v_mov_b32 v222, 1
v_mov_b32_e64 v223, 0
s_nop 4
s_mov_b64 exec, 1
buffer_atomic_add v222, v223, s[36:39], 0 offen
s_mov_b64 exec, -1
s_nop 1
Lnoinit:
v_cvt_pkrtz_f16_f32 v129, v128, v129
v_fma_mix_f32 v227, v126, v126, v227 op_sel_hi:[1,1,0]
s_waitcnt lgkmcnt(7)
v_mfma_f32_32x32x16_bf16 v[160:175], v[0:3], v[184:187], 0
v_fma_mix_f32 v227, v124, v124, v227 op_sel:[1,1,0] op_sel_hi:[1,1,0]
v_and_b32 v129, s49, v129
v_fma_mix_f32 v227, v126, v126, v227 op_sel:[1,1,0] op_sel_hi:[1,1,0]
v_bfe_u32 v128, v129, 2, 14
v_fma_mix_f32 v227, v112, v112, v227 op_sel_hi:[1,1,0]
v_lshrrev_b32_e64 v129, 18, v129
v_fma_mix_f32 v227, v113, v113, v227 op_sel_hi:[1,1,0]
v_cvt_pk_f16_f32 v140, v140, v141
v_fma_mix_f32 v227, v114, v114, v227 op_sel_hi:[1,1,0]
v_cvt_pk_f16_f32 v142, v142, v143
v_fma_mix_f32 v227, v115, v115, v227 op_sel_hi:[1,1,0]
v_pk_fma_f16 v141, v140, v140, s48
v_mfma_f32_32x32x16_bf16 v[96:111], v[24:27], v[184:187], 0
ds_read_u16 v128, v128
ds_read_u16 v129, v129
v_fma_mix_f32 v227, v116, v116, v227 op_sel_hi:[1,1,0]
v_cvt_pkrtz_f16_f32 v131, v130, v131
v_fma_mix_f32 v227, v117, v117, v227 op_sel_hi:[1,1,0]
v_and_b32_e64 v131, s49, v131
v_bfe_u32 v130, v131, 2, 14
v_lshrrev_b32_e64 v131, 18, v131
v_pk_fma_f16 v143, v142, v142, s48
v_pk_mul_f16 v141, v140, v141
v_pk_mul_f16 v143, v142, v143
v_fma_mix_f32 v227, v118, v118, v227 op_sel_hi:[1,1,0]
v_cvt_pkrtz_f16_f32 v133, v132, v133
s_waitcnt lgkmcnt(3)
v_fma_mix_f32 v227, v119, v119, v227 op_sel_hi:[1,1,0]
ds_read_u16 v130, v130
ds_read_u16 v131, v131
ds_read_b128 v[180:183], v250 offset:33792
v_and_b32 v133, s49, v133
v_bfe_u32 v132, v133, 2, 14
v_lshrrev_b32_e64 v133, 18, v133
v_exp_f16_sdwa v141, v141 dst_sel:WORD_0 dst_unused:UNUSED_PRESERVE src0_sel:WORD_0
v_mfma_f32_32x32x16_bf16 v[160:175], v[4:7], v[188:191], v[160:175]
ds_read_u16 v132, v132
ds_read_u16 v133, v133
v_exp_f16_sdwa v143, v143 dst_sel:WORD_0 dst_unused:UNUSED_PRESERVE src0_sel:WORD_0
v_fma_mix_f32 v227, v120, v120, v227 op_sel_hi:[1,1,0]
v_cvt_pkrtz_f16_f32 v135, v134, v135
v_fma_mix_f32 v227, v121, v121, v227 op_sel_hi:[1,1,0]
v_and_b32_e64 v135, s49, v135
v_bfe_u32 v134, v135, 2, 14
v_lshrrev_b32_e64 v135, 18, v135
v_exp_f16_sdwa v141, v141 dst_sel:WORD_1 dst_unused:UNUSED_PRESERVE src0_sel:WORD_1
v_fma_mix_f32 v227, v122, v122, v227 op_sel_hi:[1,1,0]
v_cvt_pkrtz_f16_f32 v137, v136, v137
v_fma_mix_f32 v227, v123, v123, v227 op_sel_hi:[1,1,0]
v_and_b32_e64 v137, s49, v137
v_bfe_u32 v136, v137, 2, 14
ds_read_u16 v134, v134
ds_read_u16 v135, v135
v_lshrrev_b32_e64 v137, 18, v137
v_exp_f16_sdwa v143, v143 dst_sel:WORD_1 dst_unused:UNUSED_PRESERVE src0_sel:WORD_1
v_mfma_f32_32x32x16_bf16 v[96:111], v[28:31], v[188:191], v[96:111]
ds_read_u16 v136, v136
ds_read_u16 v137, v137
ds_read_b128 v[184:187], v250 offset:34816
v_cvt_pkrtz_f16_f32 v139, v138, v139
v_and_b32_e64 v139, s49, v139
v_bfe_u32 v138, v139, 2, 14
v_lshrrev_b32 v139, 18, v139
v_pk_add_f16 v141, v141, 1.0 op_sel_hi:[1,0]
v_pk_add_f16 v143, v143, 1.0 op_sel_hi:[1,0]
v_rcp_f16_sdwa v141, v141 dst_sel:WORD_0 dst_unused:UNUSED_PRESERVE src0_sel:WORD_0
s_waitcnt lgkmcnt(7)
v_mfma_f32_32x32x16_bf16 v[160:175], v[8:11], v[176:179], v[160:175]
ds_read_u16 v138, v138
ds_read_u16 v139, v139
v_rcp_f16_sdwa v143, v143 dst_sel:WORD_0 dst_unused:UNUSED_PRESERVE src0_sel:WORD_0
v_rcp_f16_sdwa v141, v141 dst_sel:WORD_1 dst_unused:UNUSED_PRESERVE src0_sel:WORD_1
v_rcp_f16_sdwa v143, v143 dst_sel:WORD_1 dst_unused:UNUSED_PRESERVE src0_sel:WORD_1
v_mfma_f32_32x32x16_bf16 v[96:111], v[32:35], v[176:179], v[96:111]
ds_read_b128 v[188:191], v250 offset:35840
v_pk_mul_f16 v140, v140, v141
v_pk_mul_f16 v142, v142, v143
v_fma_mix_f32 v228, v140, v140, v228 op_sel_hi:[1,1,0]
s_add_u32 s66, s66, 786432
s_sub_u32 s81, s81, 13184
v_bfe_u32 v223, v250, 4, 6
v_and_b32 v222, 15, v223
v_lshlrev_b32 v222, 7, v222
v_lshrrev_b32 v223, 4, v223
v_mul_u32_u24 v223, 98304, v223
s_sub_u32 s43, s67, -8000
s_mul_i32 s44, s41, 192
s_add_u32 s43, s43, s44
v_add3_u32 v222, v222, v223, s43
s_mov_b32 m0, 163840
s_add_u32 s44, s66, 393216
buffer_load_dword v222, s[4:7], s66 offen lds
buffer_load_dword v222, s[4:7], s44 offen lds
v_fma_mix_f32 v228, v142, v142, v228 op_sel_hi:[1,1,0]
v_mfma_f32_32x32x16_bf16 v[160:175], v[12:15], v[180:183], v[160:175]
v_fma_mix_f32 v228, v140, v140, v228 op_sel:[1,1,0] op_sel_hi:[1,1,0]
v_cvt_pkrtz_f16_f32 v145, v144, v145
v_fma_mix_f32 v228, v142, v142, v228 op_sel:[1,1,0] op_sel_hi:[1,1,0]
v_and_b32_e64 v145, s49, v145
v_fma_mix_f32 v228, v128, v128, v228 op_sel_hi:[1,1,0]
v_bfe_u32 v144, v145, 2, 14
v_fma_mix_f32 v228, v129, v129, v228 op_sel_hi:[1,1,0]
v_lshrrev_b32_e64 v145, 18, v145
v_fma_mix_f32 v228, v130, v130, v228 op_sel_hi:[1,1,0]
v_cvt_pk_f16_f32 v156, v156, v157
v_fma_mix_f32 v228, v131, v131, v228 op_sel_hi:[1,1,0]
v_cvt_pk_f16_f32 v158, v158, v159
v_pk_fma_f16 v157, v156, v156, s48
v_mfma_f32_32x32x16_bf16 v[96:111], v[36:39], v[180:183], v[96:111]
ds_read_u16 v144, v144
ds_read_u16 v145, v145
s_waitcnt lgkmcnt(4)
v_fma_mix_f32 v228, v132, v132, v228 op_sel_hi:[1,1,0]
v_cvt_pkrtz_f16_f32 v147, v146, v147
v_fma_mix_f32 v228, v133, v133, v228 op_sel_hi:[1,1,0]
v_and_b32 v147, s49, v147
v_bfe_u32 v146, v147, 2, 14
v_lshrrev_b32_e64 v147, 18, v147
v_pk_fma_f16 v159, v158, v158, s48
v_pk_mul_f16 v157, v156, v157
v_pk_mul_f16 v159, v158, v159
v_fma_mix_f32 v228, v134, v134, v228 op_sel_hi:[1,1,0]
v_cvt_pkrtz_f16_f32 v149, v148, v149
v_fma_mix_f32 v228, v135, v135, v228 op_sel_hi:[1,1,0]
ds_read_u16 v146, v146
ds_read_u16 v147, v147
ds_read_b128 v[176:179], v250 offset:36864
v_and_b32_e64 v149, s49, v149
v_bfe_u32 v148, v149, 2, 14
v_lshrrev_b32_e64 v149, 18, v149
v_exp_f16_sdwa v157, v157 dst_sel:WORD_0 dst_unused:UNUSED_PRESERVE src0_sel:WORD_0
v_mfma_f32_32x32x16_bf16 v[160:175], v[16:19], v[184:187], v[160:175]
ds_read_u16 v148, v148
ds_read_u16 v149, v149
v_exp_f16_sdwa v159, v159 dst_sel:WORD_0 dst_unused:UNUSED_PRESERVE src0_sel:WORD_0
v_fma_mix_f32 v228, v136, v136, v228 op_sel_hi:[1,1,0]
v_cvt_pkrtz_f16_f32 v151, v150, v151
v_fma_mix_f32 v228, v137, v137, v228 op_sel_hi:[1,1,0]
v_and_b32_e64 v151, s49, v151
v_bfe_u32 v150, v151, 2, 14
v_lshrrev_b32_e64 v151, 18, v151
v_exp_f16_sdwa v157, v157 dst_sel:WORD_1 dst_unused:UNUSED_PRESERVE src0_sel:WORD_1
v_fma_mix_f32 v228, v138, v138, v228 op_sel_hi:[1,1,0]
v_cvt_pkrtz_f16_f32 v153, v152, v153
s_waitcnt lgkmcnt(5)
v_fma_mix_f32 v228, v139, v139, v228 op_sel_hi:[1,1,0]
v_and_b32 v153, s49, v153
v_bfe_u32 v152, v153, 2, 14
ds_read_u16 v150, v150
ds_read_u16 v151, v151
v_lshrrev_b32_e64 v153, 18, v153
v_exp_f16_sdwa v159, v159 dst_sel:WORD_1 dst_unused:UNUSED_PRESERVE src0_sel:WORD_1
v_mfma_f32_32x32x16_bf16 v[96:111], v[40:43], v[184:187], v[96:111]
ds_read_u16 v152, v152
ds_read_u16 v153, v153
ds_read_b128 v[180:183], v250 offset:37888
v_cvt_pkrtz_f16_f32 v155, v154, v155
v_and_b32_e64 v155, s49, v155
v_bfe_u32 v154, v155, 2, 14
v_lshrrev_b32_e64 v155, 18, v155
v_pk_add_f16 v157, v157, 1.0 op_sel_hi:[1,0]
v_pk_add_f16 v159, v159, 1.0 op_sel_hi:[1,0]
v_rcp_f16_sdwa v157, v157 dst_sel:WORD_0 dst_unused:UNUSED_PRESERVE src0_sel:WORD_0
v_mfma_f32_32x32x16_bf16 v[160:175], v[20:23], v[188:191], v[160:175]
ds_read_u16 v154, v154
ds_read_u16 v155, v155
v_rcp_f16_sdwa v159, v159 dst_sel:WORD_0 dst_unused:UNUSED_PRESERVE src0_sel:WORD_0
v_rcp_f16_sdwa v157, v157 dst_sel:WORD_1 dst_unused:UNUSED_PRESERVE src0_sel:WORD_1
v_rcp_f16_sdwa v159, v159 dst_sel:WORD_1 dst_unused:UNUSED_PRESERVE src0_sel:WORD_1
v_mfma_f32_32x32x16_bf16 v[96:111], v[44:47], v[188:191], v[96:111]
ds_read_b128 v[184:187], v250 offset:38912
v_pk_mul_f16 v156, v156, v157
v_pk_mul_f16 v158, v158, v159
v_fma_mix_f32 v228, v156, v156, v228 op_sel_hi:[1,1,0]
s_nop 1
v_cvt_pkrtz_f16_f32 v161, v160, v161
v_fma_mix_f32 v228, v158, v158, v228 op_sel_hi:[1,1,0]
s_waitcnt lgkmcnt(7)
v_mfma_f32_32x32x16_bf16 v[112:127], v[0:3], v[176:179], 0
v_fma_mix_f32 v228, v156, v156, v228 op_sel:[1,1,0] op_sel_hi:[1,1,0]
v_and_b32_e64 v161, s49, v161
v_fma_mix_f32 v228, v158, v158, v228 op_sel:[1,1,0] op_sel_hi:[1,1,0]
v_bfe_u32 v160, v161, 2, 14
v_fma_mix_f32 v228, v144, v144, v228 op_sel_hi:[1,1,0]
v_lshrrev_b32_e64 v161, 18, v161
v_fma_mix_f32 v228, v145, v145, v228 op_sel_hi:[1,1,0]
v_cvt_pk_f16_f32 v172, v172, v173
v_fma_mix_f32 v228, v146, v146, v228 op_sel_hi:[1,1,0]
v_cvt_pk_f16_f32 v174, v174, v175
v_fma_mix_f32 v228, v147, v147, v228 op_sel_hi:[1,1,0]
v_pk_fma_f16 v173, v172, v172, s48
v_mfma_f32_32x32x16_bf16 v[128:143], v[24:27], v[176:179], 0
ds_read_u16 v160, v160
ds_read_u16 v161, v161
v_fma_mix_f32 v228, v148, v148, v228 op_sel_hi:[1,1,0]
v_cvt_pkrtz_f16_f32 v163, v162, v163
v_fma_mix_f32 v228, v149, v149, v228 op_sel_hi:[1,1,0]
v_and_b32_e64 v163, s49, v163
v_bfe_u32 v162, v163, 2, 14
v_lshrrev_b32_e64 v163, 18, v163
v_pk_fma_f16 v175, v174, v174, s48
v_pk_mul_f16 v173, v172, v173
v_pk_mul_f16 v175, v174, v175
v_fma_mix_f32 v228, v150, v150, v228 op_sel_hi:[1,1,0]
v_cvt_pkrtz_f16_f32 v165, v164, v165
s_waitcnt lgkmcnt(3)
v_fma_mix_f32 v228, v151, v151, v228 op_sel_hi:[1,1,0]
ds_read_u16 v162, v162
ds_read_u16 v163, v163
ds_read_b128 v[188:191], v250 offset:39936
v_and_b32 v165, s49, v165
v_bfe_u32 v164, v165, 2, 14
v_lshrrev_b32_e64 v165, 18, v165
v_exp_f16_sdwa v173, v173 dst_sel:WORD_0 dst_unused:UNUSED_PRESERVE src0_sel:WORD_0
v_mfma_f32_32x32x16_bf16 v[112:127], v[4:7], v[180:183], v[112:127]
ds_read_u16 v164, v164
ds_read_u16 v165, v165
v_fma_mix_f32 v228, v152, v152, v228 op_sel_hi:[1,1,0]
v_exp_f16_sdwa v175, v175 dst_sel:WORD_0 dst_unused:UNUSED_PRESERVE src0_sel:WORD_0
v_fma_mix_f32 v228, v153, v153, v228 op_sel_hi:[1,1,0]
v_cvt_pkrtz_f16_f32 v167, v166, v167
v_and_b32_e64 v167, s49, v167
v_bfe_u32 v166, v167, 2, 14
v_lshrrev_b32_e64 v167, 18, v167
v_exp_f16_sdwa v173, v173 dst_sel:WORD_1 dst_unused:UNUSED_PRESERVE src0_sel:WORD_1
v_fma_mix_f32 v228, v154, v154, v228 op_sel_hi:[1,1,0]
v_cvt_pkrtz_f16_f32 v169, v168, v169
v_fma_mix_f32 v228, v155, v155, v228 op_sel_hi:[1,1,0]
v_and_b32_e64 v169, s49, v169
v_bfe_u32 v168, v169, 2, 14
ds_read_u16 v166, v166
ds_read_u16 v167, v167
v_lshrrev_b32_e64 v169, 18, v169
v_exp_f16_sdwa v175, v175 dst_sel:WORD_1 dst_unused:UNUSED_PRESERVE src0_sel:WORD_1
v_mfma_f32_32x32x16_bf16 v[128:143], v[28:31], v[180:183], v[128:143]
ds_read_u16 v168, v168
ds_read_u16 v169, v169
ds_read_b128 v[176:179], v250 offset:40960
v_cvt_pkrtz_f16_f32 v171, v170, v171
v_and_b32_e64 v171, s49, v171
v_bfe_u32 v170, v171, 2, 14
v_lshrrev_b32 v171, 18, v171
v_pk_add_f16 v173, v173, 1.0 op_sel_hi:[1,0]
v_pk_add_f16 v175, v175, 1.0 op_sel_hi:[1,0]
v_rcp_f16_sdwa v173, v173 dst_sel:WORD_0 dst_unused:UNUSED_PRESERVE src0_sel:WORD_0
s_waitcnt lgkmcnt(7)
v_mfma_f32_32x32x16_bf16 v[112:127], v[8:11], v[184:187], v[112:127]
ds_read_u16 v170, v170
ds_read_u16 v171, v171
v_rcp_f16_sdwa v175, v175 dst_sel:WORD_0 dst_unused:UNUSED_PRESERVE src0_sel:WORD_0
v_rcp_f16_sdwa v173, v173 dst_sel:WORD_1 dst_unused:UNUSED_PRESERVE src0_sel:WORD_1
v_rcp_f16_sdwa v175, v175 dst_sel:WORD_1 dst_unused:UNUSED_PRESERVE src0_sel:WORD_1
v_mfma_f32_32x32x16_bf16 v[128:143], v[32:35], v[184:187], v[128:143]
ds_read_b128 v[180:183], v250 offset:41984
v_pk_mul_f16 v172, v172, v173
v_pk_mul_f16 v174, v174, v175
v_fma_mix_f32 v229, v172, v172, v229 op_sel_hi:[1,1,0]
v_cvt_pkrtz_f16_f32 v97, v96, v97
v_fma_mix_f32 v229, v174, v174, v229 op_sel_hi:[1,1,0]
v_mfma_f32_32x32x16_bf16 v[112:127], v[12:15], v[188:191], v[112:127]
v_fma_mix_f32 v229, v172, v172, v229 op_sel:[1,1,0] op_sel_hi:[1,1,0]
v_and_b32_e64 v97, s49, v97
v_fma_mix_f32 v229, v174, v174, v229 op_sel:[1,1,0] op_sel_hi:[1,1,0]
v_bfe_u32 v96, v97, 2, 14
v_fma_mix_f32 v229, v160, v160, v229 op_sel_hi:[1,1,0]
v_lshrrev_b32_e64 v97, 18, v97
v_fma_mix_f32 v229, v161, v161, v229 op_sel_hi:[1,1,0]
v_cvt_pk_f16_f32 v108, v108, v109
v_fma_mix_f32 v229, v162, v162, v229 op_sel_hi:[1,1,0]
v_cvt_pk_f16_f32 v110, v110, v111
v_fma_mix_f32 v229, v163, v163, v229 op_sel_hi:[1,1,0]
v_pk_fma_f16 v109, v108, v108, s48
v_mfma_f32_32x32x16_bf16 v[128:143], v[36:39], v[188:191], v[128:143]
ds_read_u16 v96, v96
ds_read_u16 v97, v97
s_waitcnt lgkmcnt(5)
v_fma_mix_f32 v229, v164, v164, v229 op_sel_hi:[1,1,0]
v_cvt_pkrtz_f16_f32 v99, v98, v99
v_fma_mix_f32 v229, v165, v165, v229 op_sel_hi:[1,1,0]
v_and_b32 v99, s49, v99
v_bfe_u32 v98, v99, 2, 14
v_lshrrev_b32_e64 v99, 18, v99
v_pk_fma_f16 v111, v110, v110, s48
v_pk_mul_f16 v109, v108, v109
v_pk_mul_f16 v111, v110, v111
v_fma_mix_f32 v229, v166, v166, v229 op_sel_hi:[1,1,0]
v_cvt_pkrtz_f16_f32 v101, v100, v101
v_fma_mix_f32 v229, v167, v167, v229 op_sel_hi:[1,1,0]
ds_read_u16 v98, v98
ds_read_u16 v99, v99
ds_read_b128 v[184:187], v250 offset:43008
v_and_b32_e64 v101, s49, v101
v_bfe_u32 v100, v101, 2, 14
v_lshrrev_b32_e64 v101, 18, v101
v_exp_f16_sdwa v109, v109 dst_sel:WORD_0 dst_unused:UNUSED_PRESERVE src0_sel:WORD_0
v_mfma_f32_32x32x16_bf16 v[112:127], v[16:19], v[176:179], v[112:127]
ds_read_u16 v100, v100
ds_read_u16 v101, v101
v_fma_mix_f32 v229, v168, v168, v229 op_sel_hi:[1,1,0]
v_exp_f16_sdwa v111, v111 dst_sel:WORD_0 dst_unused:UNUSED_PRESERVE src0_sel:WORD_0
v_fma_mix_f32 v229, v169, v169, v229 op_sel_hi:[1,1,0]
v_cvt_pkrtz_f16_f32 v103, v102, v103
v_and_b32_e64 v103, s49, v103
v_bfe_u32 v102, v103, 2, 14
v_lshrrev_b32 v103, 18, v103
v_exp_f16_sdwa v109, v109 dst_sel:WORD_1 dst_unused:UNUSED_PRESERVE src0_sel:WORD_1
s_waitcnt lgkmcnt(6)
v_fma_mix_f32 v229, v170, v170, v229 op_sel_hi:[1,1,0]
v_cvt_pkrtz_f16_f32 v105, v104, v105
v_fma_mix_f32 v229, v171, v171, v229 op_sel_hi:[1,1,0]
v_and_b32_e64 v105, s49, v105
v_bfe_u32 v104, v105, 2, 14
ds_read_u16 v102, v102
ds_read_u16 v103, v103
v_lshrrev_b32_e64 v105, 18, v105
v_exp_f16_sdwa v111, v111 dst_sel:WORD_1 dst_unused:UNUSED_PRESERVE src0_sel:WORD_1
v_mfma_f32_32x32x16_bf16 v[128:143], v[40:43], v[176:179], v[128:143]
ds_read_u16 v104, v104
ds_read_u16 v105, v105
ds_read_b128 v[188:191], v250 offset:44032
v_cvt_pkrtz_f16_f32 v107, v106, v107
v_and_b32_e64 v107, s49, v107
v_bfe_u32 v106, v107, 2, 14
v_lshrrev_b32_e64 v107, 18, v107
v_pk_add_f16 v109, v109, 1.0 op_sel_hi:[1,0]
v_pk_add_f16 v111, v111, 1.0 op_sel_hi:[1,0]
v_rcp_f16_sdwa v109, v109 dst_sel:WORD_0 dst_unused:UNUSED_PRESERVE src0_sel:WORD_0
v_mfma_f32_32x32x16_bf16 v[112:127], v[20:23], v[180:183], v[112:127]
ds_read_u16 v106, v106
ds_read_u16 v107, v107
v_rcp_f16_sdwa v111, v111 dst_sel:WORD_0 dst_unused:UNUSED_PRESERVE src0_sel:WORD_0
v_rcp_f16_sdwa v109, v109 dst_sel:WORD_1 dst_unused:UNUSED_PRESERVE src0_sel:WORD_1
v_rcp_f16_sdwa v111, v111 dst_sel:WORD_1 dst_unused:UNUSED_PRESERVE src0_sel:WORD_1
v_mfma_f32_32x32x16_bf16 v[128:143], v[44:47], v[180:183], v[128:143]
ds_read_b128 v[176:179], v250 offset:45056
v_pk_mul_f16 v108, v108, v109
v_pk_mul_f16 v110, v110, v111
v_fma_mix_f32 v229, v108, v108, v229 op_sel_hi:[1,1,0]
s_nop 1
v_cvt_pkrtz_f16_f32 v113, v112, v113
v_fma_mix_f32 v229, v110, v110, v229 op_sel_hi:[1,1,0]
s_waitcnt lgkmcnt(7)
v_mfma_f32_32x32x16_bf16 v[144:159], v[0:3], v[184:187], 0
v_fma_mix_f32 v229, v108, v108, v229 op_sel:[1,1,0] op_sel_hi:[1,1,0]
v_and_b32_e64 v113, s49, v113
v_fma_mix_f32 v229, v110, v110, v229 op_sel:[1,1,0] op_sel_hi:[1,1,0]
v_bfe_u32 v112, v113, 2, 14
v_fma_mix_f32 v229, v96, v96, v229 op_sel_hi:[1,1,0]
v_lshrrev_b32_e64 v113, 18, v113
v_fma_mix_f32 v229, v97, v97, v229 op_sel_hi:[1,1,0]
v_cvt_pk_f16_f32 v124, v124, v125
v_fma_mix_f32 v229, v98, v98, v229 op_sel_hi:[1,1,0]
v_cvt_pk_f16_f32 v126, v126, v127
v_fma_mix_f32 v229, v99, v99, v229 op_sel_hi:[1,1,0]
v_pk_fma_f16 v125, v124, v124, s48
v_mfma_f32_32x32x16_bf16 v[160:175], v[24:27], v[184:187], 0
ds_read_u16 v112, v112
ds_read_u16 v113, v113
v_fma_mix_f32 v229, v100, v100, v229 op_sel_hi:[1,1,0]
v_cvt_pkrtz_f16_f32 v115, v114, v115
v_fma_mix_f32 v229, v101, v101, v229 op_sel_hi:[1,1,0]
v_and_b32_e64 v115, s49, v115
v_bfe_u32 v114, v115, 2, 14
v_lshrrev_b32_e64 v115, 18, v115
v_pk_fma_f16 v127, v126, v126, s48
v_pk_mul_f16 v125, v124, v125
v_pk_mul_f16 v127, v126, v127
v_fma_mix_f32 v229, v102, v102, v229 op_sel_hi:[1,1,0]
v_cvt_pkrtz_f16_f32 v117, v116, v117
s_waitcnt lgkmcnt(3)
v_fma_mix_f32 v229, v103, v103, v229 op_sel_hi:[1,1,0]
ds_read_u16 v114, v114
ds_read_u16 v115, v115
ds_read_b128 v[180:183], v250 offset:46080
v_and_b32 v117, s49, v117
v_bfe_u32 v116, v117, 2, 14
v_lshrrev_b32_e64 v117, 18, v117
v_exp_f16_sdwa v125, v125 dst_sel:WORD_0 dst_unused:UNUSED_PRESERVE src0_sel:WORD_0
v_mfma_f32_32x32x16_bf16 v[144:159], v[4:7], v[188:191], v[144:159]
ds_read_u16 v116, v116
ds_read_u16 v117, v117
v_fma_mix_f32 v229, v104, v104, v229 op_sel_hi:[1,1,0]
v_exp_f16_sdwa v127, v127 dst_sel:WORD_0 dst_unused:UNUSED_PRESERVE src0_sel:WORD_0
v_fma_mix_f32 v229, v105, v105, v229 op_sel_hi:[1,1,0]
v_cvt_pkrtz_f16_f32 v119, v118, v119
v_and_b32_e64 v119, s49, v119
v_bfe_u32 v118, v119, 2, 14
v_lshrrev_b32_e64 v119, 18, v119
v_exp_f16_sdwa v125, v125 dst_sel:WORD_1 dst_unused:UNUSED_PRESERVE src0_sel:WORD_1
v_fma_mix_f32 v229, v106, v106, v229 op_sel_hi:[1,1,0]
v_cvt_pkrtz_f16_f32 v121, v120, v121
v_fma_mix_f32 v229, v107, v107, v229 op_sel_hi:[1,1,0]
v_and_b32_e64 v121, s49, v121
v_bfe_u32 v120, v121, 2, 14
ds_read_u16 v118, v118
ds_read_u16 v119, v119
v_lshrrev_b32_e64 v121, 18, v121
v_exp_f16_sdwa v127, v127 dst_sel:WORD_1 dst_unused:UNUSED_PRESERVE src0_sel:WORD_1
v_mfma_f32_32x32x16_bf16 v[160:175], v[28:31], v[188:191], v[160:175]
ds_read_u16 v120, v120
ds_read_u16 v121, v121
ds_read_b128 v[184:187], v250 offset:47104
v_cvt_pkrtz_f16_f32 v123, v122, v123
v_and_b32_e64 v123, s49, v123
v_bfe_u32 v122, v123, 2, 14
v_lshrrev_b32 v123, 18, v123
v_pk_add_f16 v125, v125, 1.0 op_sel_hi:[1,0]
v_pk_add_f16 v127, v127, 1.0 op_sel_hi:[1,0]
v_rcp_f16_sdwa v125, v125 dst_sel:WORD_0 dst_unused:UNUSED_PRESERVE src0_sel:WORD_0
s_waitcnt lgkmcnt(7)
v_mfma_f32_32x32x16_bf16 v[144:159], v[8:11], v[176:179], v[144:159]
ds_read_u16 v122, v122
ds_read_u16 v123, v123
v_rcp_f16_sdwa v127, v127 dst_sel:WORD_0 dst_unused:UNUSED_PRESERVE src0_sel:WORD_0
v_rcp_f16_sdwa v125, v125 dst_sel:WORD_1 dst_unused:UNUSED_PRESERVE src0_sel:WORD_1
v_rcp_f16_sdwa v127, v127 dst_sel:WORD_1 dst_unused:UNUSED_PRESERVE src0_sel:WORD_1
v_mfma_f32_32x32x16_bf16 v[160:175], v[32:35], v[176:179], v[160:175]
ds_read_b128 v[188:191], v250 offset:48128
v_pk_mul_f16 v124, v124, v125
v_pk_mul_f16 v126, v126, v127
v_fma_mix_f32 v230, v124, v124, v230 op_sel_hi:[1,1,0]
v_cvt_pkrtz_f16_f32 v129, v128, v129
v_fma_mix_f32 v230, v126, v126, v230 op_sel_hi:[1,1,0]
v_mfma_f32_32x32x16_bf16 v[144:159], v[12:15], v[180:183], v[144:159]
v_fma_mix_f32 v230, v124, v124, v230 op_sel:[1,1,0] op_sel_hi:[1,1,0]
v_and_b32_e64 v129, s49, v129
v_fma_mix_f32 v230, v126, v126, v230 op_sel:[1,1,0] op_sel_hi:[1,1,0]
v_bfe_u32 v128, v129, 2, 14
v_fma_mix_f32 v230, v112, v112, v230 op_sel_hi:[1,1,0]
v_lshrrev_b32_e64 v129, 18, v129
v_fma_mix_f32 v230, v113, v113, v230 op_sel_hi:[1,1,0]
v_cvt_pk_f16_f32 v140, v140, v141
v_fma_mix_f32 v230, v114, v114, v230 op_sel_hi:[1,1,0]
v_cvt_pk_f16_f32 v142, v142, v143
v_fma_mix_f32 v230, v115, v115, v230 op_sel_hi:[1,1,0]
v_pk_fma_f16 v141, v140, v140, s48
v_mfma_f32_32x32x16_bf16 v[160:175], v[36:39], v[180:183], v[160:175]
ds_read_u16 v128, v128
ds_read_u16 v129, v129
s_waitcnt lgkmcnt(5)
v_fma_mix_f32 v230, v116, v116, v230 op_sel_hi:[1,1,0]
v_cvt_pkrtz_f16_f32 v131, v130, v131
v_fma_mix_f32 v230, v117, v117, v230 op_sel_hi:[1,1,0]
v_and_b32 v131, s49, v131
v_bfe_u32 v130, v131, 2, 14
v_lshrrev_b32_e64 v131, 18, v131
v_pk_fma_f16 v143, v142, v142, s48
v_pk_mul_f16 v141, v140, v141
v_pk_mul_f16 v143, v142, v143
v_fma_mix_f32 v230, v118, v118, v230 op_sel_hi:[1,1,0]
v_cvt_pkrtz_f16_f32 v133, v132, v133
v_fma_mix_f32 v230, v119, v119, v230 op_sel_hi:[1,1,0]
ds_read_u16 v130, v130
ds_read_u16 v131, v131
ds_read_b128 v[176:179], v250 offset:49152
v_and_b32_e64 v133, s49, v133
v_bfe_u32 v132, v133, 2, 14
v_lshrrev_b32_e64 v133, 18, v133
v_exp_f16_sdwa v141, v141 dst_sel:WORD_0 dst_unused:UNUSED_PRESERVE src0_sel:WORD_0
v_mfma_f32_32x32x16_bf16 v[144:159], v[16:19], v[184:187], v[144:159]
ds_read_u16 v132, v132
ds_read_u16 v133, v133
v_fma_mix_f32 v230, v120, v120, v230 op_sel_hi:[1,1,0]
v_exp_f16_sdwa v143, v143 dst_sel:WORD_0 dst_unused:UNUSED_PRESERVE src0_sel:WORD_0
v_fma_mix_f32 v230, v121, v121, v230 op_sel_hi:[1,1,0]
v_cvt_pkrtz_f16_f32 v135, v134, v135
v_and_b32_e64 v135, s49, v135
v_bfe_u32 v134, v135, 2, 14
v_lshrrev_b32 v135, 18, v135
v_exp_f16_sdwa v141, v141 dst_sel:WORD_1 dst_unused:UNUSED_PRESERVE src0_sel:WORD_1
s_waitcnt lgkmcnt(6)
v_fma_mix_f32 v230, v122, v122, v230 op_sel_hi:[1,1,0]
v_cvt_pkrtz_f16_f32 v137, v136, v137
v_fma_mix_f32 v230, v123, v123, v230 op_sel_hi:[1,1,0]
v_and_b32_e64 v137, s49, v137
v_bfe_u32 v136, v137, 2, 14
ds_read_u16 v134, v134
ds_read_u16 v135, v135
v_lshrrev_b32_e64 v137, 18, v137
v_exp_f16_sdwa v143, v143 dst_sel:WORD_1 dst_unused:UNUSED_PRESERVE src0_sel:WORD_1
v_mfma_f32_32x32x16_bf16 v[160:175], v[40:43], v[184:187], v[160:175]
ds_read_u16 v136, v136
ds_read_u16 v137, v137
ds_read_b128 v[180:183], v250 offset:50176
v_cvt_pkrtz_f16_f32 v139, v138, v139
v_and_b32_e64 v139, s49, v139
v_bfe_u32 v138, v139, 2, 14
v_lshrrev_b32_e64 v139, 18, v139
v_pk_add_f16 v141, v141, 1.0 op_sel_hi:[1,0]
v_pk_add_f16 v143, v143, 1.0 op_sel_hi:[1,0]
v_rcp_f16_sdwa v141, v141 dst_sel:WORD_0 dst_unused:UNUSED_PRESERVE src0_sel:WORD_0
v_mfma_f32_32x32x16_bf16 v[144:159], v[20:23], v[188:191], v[144:159]
ds_read_u16 v138, v138
ds_read_u16 v139, v139
v_rcp_f16_sdwa v143, v143 dst_sel:WORD_0 dst_unused:UNUSED_PRESERVE src0_sel:WORD_0
v_rcp_f16_sdwa v141, v141 dst_sel:WORD_1 dst_unused:UNUSED_PRESERVE src0_sel:WORD_1
v_rcp_f16_sdwa v143, v143 dst_sel:WORD_1 dst_unused:UNUSED_PRESERVE src0_sel:WORD_1
v_mfma_f32_32x32x16_bf16 v[160:175], v[44:47], v[188:191], v[160:175]
ds_read_b128 v[184:187], v250 offset:51200
v_pk_mul_f16 v140, v140, v141
v_pk_mul_f16 v142, v142, v143
v_fma_mix_f32 v230, v140, v140, v230 op_sel_hi:[1,1,0]
s_nop 1
v_cvt_pkrtz_f16_f32 v145, v144, v145
v_fma_mix_f32 v230, v142, v142, v230 op_sel_hi:[1,1,0]
s_waitcnt lgkmcnt(7)
v_mfma_f32_32x32x16_bf16 v[96:111], v[0:3], v[176:179], 0
v_fma_mix_f32 v230, v140, v140, v230 op_sel:[1,1,0] op_sel_hi:[1,1,0]
v_and_b32_e64 v145, s49, v145
v_fma_mix_f32 v230, v142, v142, v230 op_sel:[1,1,0] op_sel_hi:[1,1,0]
v_bfe_u32 v144, v145, 2, 14
v_fma_mix_f32 v230, v128, v128, v230 op_sel_hi:[1,1,0]
v_lshrrev_b32_e64 v145, 18, v145
v_fma_mix_f32 v230, v129, v129, v230 op_sel_hi:[1,1,0]
v_cvt_pk_f16_f32 v156, v156, v157
v_fma_mix_f32 v230, v130, v130, v230 op_sel_hi:[1,1,0]
v_cvt_pk_f16_f32 v158, v158, v159
v_fma_mix_f32 v230, v131, v131, v230 op_sel_hi:[1,1,0]
v_pk_fma_f16 v157, v156, v156, s48
v_mfma_f32_32x32x16_bf16 v[112:127], v[24:27], v[176:179], 0
ds_read_u16 v144, v144
ds_read_u16 v145, v145
v_fma_mix_f32 v230, v132, v132, v230 op_sel_hi:[1,1,0]
v_cvt_pkrtz_f16_f32 v147, v146, v147
v_fma_mix_f32 v230, v133, v133, v230 op_sel_hi:[1,1,0]
v_and_b32_e64 v147, s49, v147
v_bfe_u32 v146, v147, 2, 14
v_lshrrev_b32_e64 v147, 18, v147
v_pk_fma_f16 v159, v158, v158, s48
v_pk_mul_f16 v157, v156, v157
v_pk_mul_f16 v159, v158, v159
v_fma_mix_f32 v230, v134, v134, v230 op_sel_hi:[1,1,0]
v_cvt_pkrtz_f16_f32 v149, v148, v149
s_waitcnt lgkmcnt(3)
v_fma_mix_f32 v230, v135, v135, v230 op_sel_hi:[1,1,0]
ds_read_u16 v146, v146
ds_read_u16 v147, v147
ds_read_b128 v[188:191], v250 offset:52224
v_and_b32 v149, s49, v149
v_bfe_u32 v148, v149, 2, 14
v_lshrrev_b32_e64 v149, 18, v149
v_exp_f16_sdwa v157, v157 dst_sel:WORD_0 dst_unused:UNUSED_PRESERVE src0_sel:WORD_0
v_mfma_f32_32x32x16_bf16 v[96:111], v[4:7], v[180:183], v[96:111]
ds_read_u16 v148, v148
ds_read_u16 v149, v149
v_fma_mix_f32 v230, v136, v136, v230 op_sel_hi:[1,1,0]
v_exp_f16_sdwa v159, v159 dst_sel:WORD_0 dst_unused:UNUSED_PRESERVE src0_sel:WORD_0
v_fma_mix_f32 v230, v137, v137, v230 op_sel_hi:[1,1,0]
v_cvt_pkrtz_f16_f32 v151, v150, v151
v_and_b32_e64 v151, s49, v151
v_bfe_u32 v150, v151, 2, 14
v_lshrrev_b32_e64 v151, 18, v151
v_exp_f16_sdwa v157, v157 dst_sel:WORD_1 dst_unused:UNUSED_PRESERVE src0_sel:WORD_1
v_fma_mix_f32 v230, v138, v138, v230 op_sel_hi:[1,1,0]
v_cvt_pkrtz_f16_f32 v153, v152, v153
v_fma_mix_f32 v230, v139, v139, v230 op_sel_hi:[1,1,0]
v_and_b32_e64 v153, s49, v153
v_bfe_u32 v152, v153, 2, 14
ds_read_u16 v150, v150
ds_read_u16 v151, v151
v_lshrrev_b32_e64 v153, 18, v153
v_exp_f16_sdwa v159, v159 dst_sel:WORD_1 dst_unused:UNUSED_PRESERVE src0_sel:WORD_1
v_mfma_f32_32x32x16_bf16 v[112:127], v[28:31], v[180:183], v[112:127]
ds_read_u16 v152, v152
ds_read_u16 v153, v153
ds_read_b128 v[176:179], v250 offset:53248
v_cvt_pkrtz_f16_f32 v155, v154, v155
v_and_b32_e64 v155, s49, v155
v_bfe_u32 v154, v155, 2, 14
v_lshrrev_b32 v155, 18, v155
v_pk_add_f16 v157, v157, 1.0 op_sel_hi:[1,0]
v_pk_add_f16 v159, v159, 1.0 op_sel_hi:[1,0]
v_rcp_f16_sdwa v157, v157 dst_sel:WORD_0 dst_unused:UNUSED_PRESERVE src0_sel:WORD_0
s_waitcnt lgkmcnt(7)
v_mfma_f32_32x32x16_bf16 v[96:111], v[8:11], v[184:187], v[96:111]
ds_read_u16 v154, v154
ds_read_u16 v155, v155
v_rcp_f16_sdwa v159, v159 dst_sel:WORD_0 dst_unused:UNUSED_PRESERVE src0_sel:WORD_0
v_rcp_f16_sdwa v157, v157 dst_sel:WORD_1 dst_unused:UNUSED_PRESERVE src0_sel:WORD_1
v_rcp_f16_sdwa v159, v159 dst_sel:WORD_1 dst_unused:UNUSED_PRESERVE src0_sel:WORD_1
v_mfma_f32_32x32x16_bf16 v[112:127], v[32:35], v[184:187], v[112:127]
ds_read_b128 v[180:183], v250 offset:54272
v_pk_mul_f16 v156, v156, v157
v_pk_mul_f16 v158, v158, v159
v_fma_mix_f32 v231, v156, v156, v231 op_sel_hi:[1,1,0]
v_cvt_pkrtz_f16_f32 v161, v160, v161
v_fma_mix_f32 v231, v158, v158, v231 op_sel_hi:[1,1,0]
v_mfma_f32_32x32x16_bf16 v[96:111], v[12:15], v[188:191], v[96:111]
v_fma_mix_f32 v231, v156, v156, v231 op_sel:[1,1,0] op_sel_hi:[1,1,0]
v_and_b32_e64 v161, s49, v161
v_fma_mix_f32 v231, v158, v158, v231 op_sel:[1,1,0] op_sel_hi:[1,1,0]
v_bfe_u32 v160, v161, 2, 14
v_fma_mix_f32 v231, v144, v144, v231 op_sel_hi:[1,1,0]
v_lshrrev_b32_e64 v161, 18, v161
v_fma_mix_f32 v231, v145, v145, v231 op_sel_hi:[1,1,0]
v_cvt_pk_f16_f32 v172, v172, v173
v_fma_mix_f32 v231, v146, v146, v231 op_sel_hi:[1,1,0]
v_cvt_pk_f16_f32 v174, v174, v175
v_fma_mix_f32 v231, v147, v147, v231 op_sel_hi:[1,1,0]
v_pk_fma_f16 v173, v172, v172, s48
v_mfma_f32_32x32x16_bf16 v[112:127], v[36:39], v[188:191], v[112:127]
ds_read_u16 v160, v160
ds_read_u16 v161, v161
s_waitcnt lgkmcnt(5)
v_fma_mix_f32 v231, v148, v148, v231 op_sel_hi:[1,1,0]
v_cvt_pkrtz_f16_f32 v163, v162, v163
v_fma_mix_f32 v231, v149, v149, v231 op_sel_hi:[1,1,0]
v_and_b32 v163, s49, v163
v_bfe_u32 v162, v163, 2, 14
v_lshrrev_b32_e64 v163, 18, v163
v_pk_fma_f16 v175, v174, v174, s48
v_pk_mul_f16 v173, v172, v173
v_pk_mul_f16 v175, v174, v175
v_fma_mix_f32 v231, v150, v150, v231 op_sel_hi:[1,1,0]
v_cvt_pkrtz_f16_f32 v165, v164, v165
v_fma_mix_f32 v231, v151, v151, v231 op_sel_hi:[1,1,0]
ds_read_u16 v162, v162
ds_read_u16 v163, v163
ds_read_b128 v[184:187], v250 offset:55296
v_and_b32_e64 v165, s49, v165
v_bfe_u32 v164, v165, 2, 14
v_lshrrev_b32_e64 v165, 18, v165
v_exp_f16_sdwa v173, v173 dst_sel:WORD_0 dst_unused:UNUSED_PRESERVE src0_sel:WORD_0
v_mfma_f32_32x32x16_bf16 v[96:111], v[16:19], v[176:179], v[96:111]
ds_read_u16 v164, v164
ds_read_u16 v165, v165
v_fma_mix_f32 v231, v152, v152, v231 op_sel_hi:[1,1,0]
v_exp_f16_sdwa v175, v175 dst_sel:WORD_0 dst_unused:UNUSED_PRESERVE src0_sel:WORD_0
v_fma_mix_f32 v231, v153, v153, v231 op_sel_hi:[1,1,0]
v_cvt_pkrtz_f16_f32 v167, v166, v167
v_and_b32_e64 v167, s49, v167
v_bfe_u32 v166, v167, 2, 14
v_lshrrev_b32 v167, 18, v167
v_exp_f16_sdwa v173, v173 dst_sel:WORD_1 dst_unused:UNUSED_PRESERVE src0_sel:WORD_1
s_waitcnt lgkmcnt(6)
v_fma_mix_f32 v231, v154, v154, v231 op_sel_hi:[1,1,0]
v_cvt_pkrtz_f16_f32 v169, v168, v169
v_fma_mix_f32 v231, v155, v155, v231 op_sel_hi:[1,1,0]
v_and_b32_e64 v169, s49, v169
v_bfe_u32 v168, v169, 2, 14
ds_read_u16 v166, v166
ds_read_u16 v167, v167
v_lshrrev_b32_e64 v169, 18, v169
v_exp_f16_sdwa v175, v175 dst_sel:WORD_1 dst_unused:UNUSED_PRESERVE src0_sel:WORD_1
v_mfma_f32_32x32x16_bf16 v[112:127], v[40:43], v[176:179], v[112:127]
ds_read_u16 v168, v168
ds_read_u16 v169, v169
ds_read_b128 v[188:191], v250 offset:56320
v_cvt_pkrtz_f16_f32 v171, v170, v171
v_and_b32_e64 v171, s49, v171
v_bfe_u32 v170, v171, 2, 14
v_lshrrev_b32_e64 v171, 18, v171
v_pk_add_f16 v173, v173, 1.0 op_sel_hi:[1,0]
v_pk_add_f16 v175, v175, 1.0 op_sel_hi:[1,0]
v_rcp_f16_sdwa v173, v173 dst_sel:WORD_0 dst_unused:UNUSED_PRESERVE src0_sel:WORD_0
v_mfma_f32_32x32x16_bf16 v[96:111], v[20:23], v[180:183], v[96:111]
ds_read_u16 v170, v170
ds_read_u16 v171, v171
v_rcp_f16_sdwa v175, v175 dst_sel:WORD_0 dst_unused:UNUSED_PRESERVE src0_sel:WORD_0
v_rcp_f16_sdwa v173, v173 dst_sel:WORD_1 dst_unused:UNUSED_PRESERVE src0_sel:WORD_1
v_rcp_f16_sdwa v175, v175 dst_sel:WORD_1 dst_unused:UNUSED_PRESERVE src0_sel:WORD_1
v_mfma_f32_32x32x16_bf16 v[112:127], v[44:47], v[180:183], v[112:127]
ds_read_b128 v[176:179], v250 offset:57344
v_pk_mul_f16 v172, v172, v173
v_pk_mul_f16 v174, v174, v175
v_fma_mix_f32 v231, v172, v172, v231 op_sel_hi:[1,1,0]
s_nop 1
v_cvt_pkrtz_f16_f32 v97, v96, v97
v_fma_mix_f32 v231, v174, v174, v231 op_sel_hi:[1,1,0]
s_waitcnt lgkmcnt(7)
v_mfma_f32_32x32x16_bf16 v[128:143], v[0:3], v[184:187], 0
v_fma_mix_f32 v231, v172, v172, v231 op_sel:[1,1,0] op_sel_hi:[1,1,0]
v_and_b32_e64 v97, s49, v97
v_fma_mix_f32 v231, v174, v174, v231 op_sel:[1,1,0] op_sel_hi:[1,1,0]
v_bfe_u32 v96, v97, 2, 14
v_fma_mix_f32 v231, v160, v160, v231 op_sel_hi:[1,1,0]
v_lshrrev_b32_e64 v97, 18, v97
v_fma_mix_f32 v231, v161, v161, v231 op_sel_hi:[1,1,0]
v_cvt_pk_f16_f32 v108, v108, v109
v_fma_mix_f32 v231, v162, v162, v231 op_sel_hi:[1,1,0]
v_cvt_pk_f16_f32 v110, v110, v111
v_fma_mix_f32 v231, v163, v163, v231 op_sel_hi:[1,1,0]
v_pk_fma_f16 v109, v108, v108, s48
v_mfma_f32_32x32x16_bf16 v[144:159], v[24:27], v[184:187], 0
ds_read_u16 v96, v96
ds_read_u16 v97, v97
v_fma_mix_f32 v231, v164, v164, v231 op_sel_hi:[1,1,0]
v_cvt_pkrtz_f16_f32 v99, v98, v99
v_fma_mix_f32 v231, v165, v165, v231 op_sel_hi:[1,1,0]
v_and_b32_e64 v99, s49, v99
v_bfe_u32 v98, v99, 2, 14
v_lshrrev_b32_e64 v99, 18, v99
v_pk_fma_f16 v111, v110, v110, s48
v_pk_mul_f16 v109, v108, v109
v_pk_mul_f16 v111, v110, v111
v_fma_mix_f32 v231, v166, v166, v231 op_sel_hi:[1,1,0]
v_cvt_pkrtz_f16_f32 v101, v100, v101
s_waitcnt lgkmcnt(3)
v_fma_mix_f32 v231, v167, v167, v231 op_sel_hi:[1,1,0]
ds_read_u16 v98, v98
ds_read_u16 v99, v99
ds_read_b128 v[180:183], v250 offset:58368
v_and_b32 v101, s49, v101
v_bfe_u32 v100, v101, 2, 14
v_lshrrev_b32_e64 v101, 18, v101
v_exp_f16_sdwa v109, v109 dst_sel:WORD_0 dst_unused:UNUSED_PRESERVE src0_sel:WORD_0
v_mfma_f32_32x32x16_bf16 v[128:143], v[4:7], v[188:191], v[128:143]
ds_read_u16 v100, v100
ds_read_u16 v101, v101
v_fma_mix_f32 v231, v168, v168, v231 op_sel_hi:[1,1,0]
v_exp_f16_sdwa v111, v111 dst_sel:WORD_0 dst_unused:UNUSED_PRESERVE src0_sel:WORD_0
v_fma_mix_f32 v231, v169, v169, v231 op_sel_hi:[1,1,0]
v_cvt_pkrtz_f16_f32 v103, v102, v103
v_and_b32_e64 v103, s49, v103
v_bfe_u32 v102, v103, 2, 14
v_lshrrev_b32_e64 v103, 18, v103
v_exp_f16_sdwa v109, v109 dst_sel:WORD_1 dst_unused:UNUSED_PRESERVE src0_sel:WORD_1
v_fma_mix_f32 v231, v170, v170, v231 op_sel_hi:[1,1,0]
v_cvt_pkrtz_f16_f32 v105, v104, v105
v_fma_mix_f32 v231, v171, v171, v231 op_sel_hi:[1,1,0]
v_and_b32_e64 v105, s49, v105
v_bfe_u32 v104, v105, 2, 14
ds_read_u16 v102, v102
ds_read_u16 v103, v103
v_lshrrev_b32_e64 v105, 18, v105
v_exp_f16_sdwa v111, v111 dst_sel:WORD_1 dst_unused:UNUSED_PRESERVE src0_sel:WORD_1
v_mfma_f32_32x32x16_bf16 v[144:159], v[28:31], v[188:191], v[144:159]
ds_read_u16 v104, v104
ds_read_u16 v105, v105
ds_read_b128 v[184:187], v250 offset:59392
v_cvt_pkrtz_f16_f32 v107, v106, v107
v_and_b32_e64 v107, s49, v107
v_bfe_u32 v106, v107, 2, 14
v_lshrrev_b32 v107, 18, v107
v_pk_add_f16 v109, v109, 1.0 op_sel_hi:[1,0]
v_pk_add_f16 v111, v111, 1.0 op_sel_hi:[1,0]
v_rcp_f16_sdwa v109, v109 dst_sel:WORD_0 dst_unused:UNUSED_PRESERVE src0_sel:WORD_0
s_waitcnt lgkmcnt(7)
v_mfma_f32_32x32x16_bf16 v[128:143], v[8:11], v[176:179], v[128:143]
ds_read_u16 v106, v106
ds_read_u16 v107, v107
v_rcp_f16_sdwa v111, v111 dst_sel:WORD_0 dst_unused:UNUSED_PRESERVE src0_sel:WORD_0
v_rcp_f16_sdwa v109, v109 dst_sel:WORD_1 dst_unused:UNUSED_PRESERVE src0_sel:WORD_1
v_rcp_f16_sdwa v111, v111 dst_sel:WORD_1 dst_unused:UNUSED_PRESERVE src0_sel:WORD_1
v_mfma_f32_32x32x16_bf16 v[144:159], v[32:35], v[176:179], v[144:159]
ds_read_b128 v[188:191], v250 offset:60416
v_pk_mul_f16 v108, v108, v109
v_pk_mul_f16 v110, v110, v111
v_fma_mix_f32 v232, v108, v108, v232 op_sel_hi:[1,1,0]
v_add_u32_e64 v222, s83, v247
v_mov_b32 v223, 0
s_branch Law4
Lax4:
s_sleep 2
Law4:
ds_read_b32 v223, v222 offset:20
s_sub_u32 s76, s76, 1
s_cselect_b32 s44, 4, 0
s_cselect_b32 s76, 0, s76
s_waitcnt lgkmcnt(0)
v_readfirstlane_b32 s43, v223
s_nop 1
s_max_u32 s43, s43, s44
s_cmp_lt_u32 s43, 4
s_cbranch_scc1 Lax4
v_mfma_f32_32x32x16_bf16 v[128:143], v[12:15], v[180:183], v[128:143]
s_add_u32 s81, s81, 6592
s_cmp_eq_u32 s81, 65920
s_cselect_b32 s81, 0, s81
s_add_u32 s43, s81, s67
s_add_u32 m0, s43, 16
s_add_u32 s66, s66, 98304
buffer_load_dwordx4 v236, s[4:7], s66 offen lds
s_add_u32 m0, s43, 912
s_nop 0
buffer_load_dwordx4 v237, s[4:7], s66 offen lds
v_fma_mix_f32 v232, v110, v110, v232 op_sel_hi:[1,1,0]
v_cvt_pkrtz_f16_f32 v113, v112, v113
v_fma_mix_f32 v232, v108, v108, v232 op_sel:[1,1,0] op_sel_hi:[1,1,0]
v_and_b32_e64 v113, s49, v113
v_fma_mix_f32 v232, v110, v110, v232 op_sel:[1,1,0] op_sel_hi:[1,1,0]
v_bfe_u32 v112, v113, 2, 14
v_fma_mix_f32 v232, v96, v96, v232 op_sel_hi:[1,1,0]
v_lshrrev_b32_e64 v113, 18, v113
v_fma_mix_f32 v232, v97, v97, v232 op_sel_hi:[1,1,0]
v_cvt_pk_f16_f32 v124, v124, v125
v_fma_mix_f32 v232, v98, v98, v232 op_sel_hi:[1,1,0]
v_cvt_pk_f16_f32 v126, v126, v127
v_fma_mix_f32 v232, v99, v99, v232 op_sel_hi:[1,1,0]
v_pk_fma_f16 v125, v124, v124, s48
v_mfma_f32_32x32x16_bf16 v[144:159], v[36:39], v[180:183], v[144:159]
ds_read_u16 v112, v112
ds_read_u16 v113, v113
v_fma_mix_f32 v232, v100, v100, v232 op_sel_hi:[1,1,0]
v_cvt_pkrtz_f16_f32 v115, v114, v115
v_fma_mix_f32 v232, v101, v101, v232 op_sel_hi:[1,1,0]
v_and_b32_e64 v115, s49, v115
v_bfe_u32 v114, v115, 2, 14
v_lshrrev_b32_e64 v115, 18, v115
v_pk_fma_f16 v127, v126, v126, s48
v_pk_mul_f16 v125, v124, v125
v_pk_mul_f16 v127, v126, v127
v_fma_mix_f32 v232, v102, v102, v232 op_sel_hi:[1,1,0]
v_cvt_pkrtz_f16_f32 v117, v116, v117
v_fma_mix_f32 v232, v103, v103, v232 op_sel_hi:[1,1,0]
ds_read_u16 v114, v114
ds_read_u16 v115, v115
ds_read_b128 v[176:179], v250 offset:61440
v_and_b32_e64 v117, s49, v117
v_bfe_u32 v116, v117, 2, 14
v_lshrrev_b32_e64 v117, 18, v117
v_exp_f16_sdwa v125, v125 dst_sel:WORD_0 dst_unused:UNUSED_PRESERVE src0_sel:WORD_0
v_mfma_f32_32x32x16_bf16 v[128:143], v[16:19], v[184:187], v[128:143]
ds_read_u16 v116, v116
ds_read_u16 v117, v117
s_add_u32 s81, s81, 6592
s_cmp_eq_u32 s81, 65920
s_cselect_b32 s81, 0, s81
s_add_u32 s43, s81, s67
s_add_u32 m0, s43, 16
s_add_u32 s66, s66, 98304
buffer_load_dwordx4 v236, s[4:7], s66 offen lds
s_add_u32 m0, s43, 912
s_nop 0
buffer_load_dwordx4 v237, s[4:7], s66 offen lds
v_fma_mix_f32 v232, v104, v104, v232 op_sel_hi:[1,1,0]
v_exp_f16_sdwa v127, v127 dst_sel:WORD_0 dst_unused:UNUSED_PRESERVE src0_sel:WORD_0
v_fma_mix_f32 v232, v105, v105, v232 op_sel_hi:[1,1,0]
v_cvt_pkrtz_f16_f32 v119, v118, v119
v_and_b32_e64 v119, s49, v119
v_bfe_u32 v118, v119, 2, 14
v_lshrrev_b32_e64 v119, 18, v119
v_exp_f16_sdwa v125, v125 dst_sel:WORD_1 dst_unused:UNUSED_PRESERVE src0_sel:WORD_1
v_fma_mix_f32 v232, v106, v106, v232 op_sel_hi:[1,1,0]
v_cvt_pkrtz_f16_f32 v121, v120, v121
v_fma_mix_f32 v232, v107, v107, v232 op_sel_hi:[1,1,0]
v_and_b32_e64 v121, s49, v121
v_bfe_u32 v120, v121, 2, 14
ds_read_u16 v118, v118
ds_read_u16 v119, v119
v_lshrrev_b32_e64 v121, 18, v121
v_exp_f16_sdwa v127, v127 dst_sel:WORD_1 dst_unused:UNUSED_PRESERVE src0_sel:WORD_1
v_mfma_f32_32x32x16_bf16 v[144:159], v[40:43], v[184:187], v[144:159]
ds_read_u16 v120, v120
ds_read_u16 v121, v121
ds_read_b128 v[180:183], v250 offset:62464
v_cvt_pkrtz_f16_f32 v123, v122, v123
v_and_b32_e64 v123, s49, v123
v_bfe_u32 v122, v123, 2, 14
v_lshrrev_b32_e64 v123, 18, v123
v_pk_add_f16 v125, v125, 1.0 op_sel_hi:[1,0]
v_pk_add_f16 v127, v127, 1.0 op_sel_hi:[1,0]
v_rcp_f16_sdwa v125, v125 dst_sel:WORD_0 dst_unused:UNUSED_PRESERVE src0_sel:WORD_0
v_mfma_f32_32x32x16_bf16 v[128:143], v[20:23], v[188:191], v[128:143]
ds_read_u16 v122, v122
ds_read_u16 v123, v123
s_add_u32 s81, s81, 6592
s_cmp_eq_u32 s81, 65920
s_cselect_b32 s81, 0, s81
s_add_u32 s43, s81, s67
s_add_u32 m0, s43, 32
s_add_u32 s66, s66, 98304
buffer_load_dwordx4 v236, s[4:7], s66 offen lds
s_add_u32 m0, s43, 928
s_nop 0
buffer_load_dwordx4 v237, s[4:7], s66 offen lds
v_rcp_f16_sdwa v127, v127 dst_sel:WORD_0 dst_unused:UNUSED_PRESERVE src0_sel:WORD_0
v_rcp_f16_sdwa v125, v125 dst_sel:WORD_1 dst_unused:UNUSED_PRESERVE src0_sel:WORD_1
v_rcp_f16_sdwa v127, v127 dst_sel:WORD_1 dst_unused:UNUSED_PRESERVE src0_sel:WORD_1
v_mfma_f32_32x32x16_bf16 v[144:159], v[44:47], v[188:191], v[144:159]
ds_read_b128 v[184:187], v250 offset:63488
v_pk_mul_f16 v124, v124, v125
v_pk_mul_f16 v126, v126, v127
s_add_u32 s81, s81, 6592
s_cmp_eq_u32 s81, 65920
s_cselect_b32 s81, 0, s81
s_add_u32 s43, s81, s67
s_add_u32 m0, s43, 32
s_add_u32 s66, s66, 98304
buffer_load_dwordx4 v236, s[4:7], s66 offen lds
s_add_u32 m0, s43, 928
s_nop 0
buffer_load_dwordx4 v237, s[4:7], s66 offen lds
v_fma_mix_f32 v232, v124, v124, v232 op_sel_hi:[1,1,0]
v_cvt_pkrtz_f16_f32 v129, v128, v129
s_waitcnt lgkmcnt(7)
v_mfma_f32_32x32x16_bf16 v[160:175], v[0:3], v[176:179], 0
v_fma_mix_f32 v232, v126, v126, v232 op_sel_hi:[1,1,0]
v_and_b32 v129, s49, v129
v_fma_mix_f32 v232, v124, v124, v232 op_sel:[1,1,0] op_sel_hi:[1,1,0]
v_bfe_u32 v128, v129, 2, 14
v_fma_mix_f32 v232, v126, v126, v232 op_sel:[1,1,0] op_sel_hi:[1,1,0]
v_lshrrev_b32_e64 v129, 18, v129
v_fma_mix_f32 v232, v112, v112, v232 op_sel_hi:[1,1,0]
v_cvt_pk_f16_f32 v140, v140, v141
v_fma_mix_f32 v232, v113, v113, v232 op_sel_hi:[1,1,0]
v_cvt_pk_f16_f32 v142, v142, v143
v_fma_mix_f32 v232, v114, v114, v232 op_sel_hi:[1,1,0]
v_pk_fma_f16 v141, v140, v140, s48
v_fma_mix_f32 v232, v115, v115, v232 op_sel_hi:[1,1,0]
v_mfma_f32_32x32x16_bf16 v[96:111], v[24:27], v[176:179], 0
ds_read_u16 v128, v128
ds_read_u16 v129, v129
v_fma_mix_f32 v232, v116, v116, v232 op_sel_hi:[1,1,0]
v_cvt_pkrtz_f16_f32 v131, v130, v131
v_fma_mix_f32 v232, v117, v117, v232 op_sel_hi:[1,1,0]
v_and_b32_e64 v131, s49, v131
v_bfe_u32 v130, v131, 2, 14
v_lshrrev_b32_e64 v131, 18, v131
v_pk_fma_f16 v143, v142, v142, s48
v_pk_mul_f16 v141, v140, v141
v_pk_mul_f16 v143, v142, v143
v_fma_mix_f32 v232, v118, v118, v232 op_sel_hi:[1,1,0]
v_cvt_pkrtz_f16_f32 v133, v132, v133
s_waitcnt lgkmcnt(3)
v_fma_mix_f32 v232, v119, v119, v232 op_sel_hi:[1,1,0]
ds_read_u16 v130, v130
ds_read_u16 v131, v131
ds_read_b128 v[188:191], v250 offset:64512
s_add_u32 s81, s81, 6592
s_cmp_eq_u32 s81, 65920
s_cselect_b32 s81, 0, s81
s_add_u32 s43, s81, s67
s_add_u32 m0, s43, 48
s_add_u32 s66, s66, 98304
buffer_load_dwordx4 v236, s[4:7], s66 offen lds
s_add_u32 m0, s43, 944
s_nop 0
buffer_load_dwordx4 v237, s[4:7], s66 offen lds
v_and_b32 v133, s49, v133
v_bfe_u32 v132, v133, 2, 14
v_lshrrev_b32_e64 v133, 18, v133
v_exp_f16_sdwa v141, v141 dst_sel:WORD_0 dst_unused:UNUSED_PRESERVE src0_sel:WORD_0
v_mfma_f32_32x32x16_bf16 v[160:175], v[4:7], v[180:183], v[160:175]
ds_read_u16 v132, v132
ds_read_u16 v133, v133
v_fma_mix_f32 v232, v120, v120, v232 op_sel_hi:[1,1,0]
v_exp_f16_sdwa v143, v143 dst_sel:WORD_0 dst_unused:UNUSED_PRESERVE src0_sel:WORD_0
v_fma_mix_f32 v232, v121, v121, v232 op_sel_hi:[1,1,0]
v_cvt_pkrtz_f16_f32 v135, v134, v135
v_and_b32_e64 v135, s49, v135
v_bfe_u32 v134, v135, 2, 14
v_lshrrev_b32_e64 v135, 18, v135
v_exp_f16_sdwa v141, v141 dst_sel:WORD_1 dst_unused:UNUSED_PRESERVE src0_sel:WORD_1
v_fma_mix_f32 v232, v122, v122, v232 op_sel_hi:[1,1,0]
v_cvt_pkrtz_f16_f32 v137, v136, v137
v_fma_mix_f32 v232, v123, v123, v232 op_sel_hi:[1,1,0]
v_and_b32_e64 v137, s49, v137
v_bfe_u32 v136, v137, 2, 14
ds_read_u16 v134, v134
ds_read_u16 v135, v135
v_lshrrev_b32_e64 v137, 18, v137
v_exp_f16_sdwa v143, v143 dst_sel:WORD_1 dst_unused:UNUSED_PRESERVE src0_sel:WORD_1
v_mfma_f32_32x32x16_bf16 v[96:111], v[28:31], v[180:183], v[96:111]
ds_read_u16 v136, v136
ds_read_u16 v137, v137
ds_read_b128 v[176:179], v251
v_cvt_pkrtz_f16_f32 v139, v138, v139
v_and_b32_e64 v139, s49, v139
v_bfe_u32 v138, v139, 2, 14
v_lshrrev_b32 v139, 18, v139
v_pk_add_f16 v141, v141, 1.0 op_sel_hi:[1,0]
v_pk_add_f16 v143, v143, 1.0 op_sel_hi:[1,0]
v_rcp_f16_sdwa v141, v141 dst_sel:WORD_0 dst_unused:UNUSED_PRESERVE src0_sel:WORD_0
s_waitcnt lgkmcnt(7)
v_mfma_f32_32x32x16_bf16 v[160:175], v[8:11], v[184:187], v[160:175]
ds_read_u16 v138, v138
ds_read_u16 v139, v139
s_add_u32 s81, s81, 6592
s_cmp_eq_u32 s81, 65920
s_cselect_b32 s81, 0, s81
s_add_u32 s43, s81, s67
s_add_u32 m0, s43, 48
s_add_u32 s66, s66, 98304
buffer_load_dwordx4 v236, s[4:7], s66 offen lds
s_add_u32 m0, s43, 944
s_nop 0
buffer_load_dwordx4 v237, s[4:7], s66 offen lds
v_rcp_f16_sdwa v143, v143 dst_sel:WORD_0 dst_unused:UNUSED_PRESERVE src0_sel:WORD_0
v_rcp_f16_sdwa v141, v141 dst_sel:WORD_1 dst_unused:UNUSED_PRESERVE src0_sel:WORD_1
v_rcp_f16_sdwa v143, v143 dst_sel:WORD_1 dst_unused:UNUSED_PRESERVE src0_sel:WORD_1
v_mfma_f32_32x32x16_bf16 v[96:111], v[32:35], v[184:187], v[96:111]
ds_read_b128 v[180:183], v251 offset:1024
s_add_u32 s81, s81, 6592
s_cmp_eq_u32 s81, 65920
s_cselect_b32 s81, 0, s81
s_add_u32 s43, s81, s67
s_add_u32 m0, s43, 0
s_add_u32 s66, s66, 98304
buffer_load_dwordx4 v236, s[4:7], s66 offen lds
s_add_u32 m0, s43, 896
s_nop 0
buffer_load_dwordx4 v237, s[4:7], s66 offen lds
v_pk_mul_f16 v140, v140, v141
v_pk_mul_f16 v142, v142, v143
v_fma_mix_f32 v233, v140, v140, v233 op_sel_hi:[1,1,0]
v_cvt_pkrtz_f16_f32 v145, v144, v145
v_mfma_f32_32x32x16_bf16 v[160:175], v[12:15], v[188:191], v[160:175]
v_fma_mix_f32 v233, v142, v142, v233 op_sel_hi:[1,1,0]
v_and_b32_e64 v145, s49, v145
v_fma_mix_f32 v233, v140, v140, v233 op_sel:[1,1,0] op_sel_hi:[1,1,0]
v_bfe_u32 v144, v145, 2, 14
v_fma_mix_f32 v233, v142, v142, v233 op_sel:[1,1,0] op_sel_hi:[1,1,0]
v_lshrrev_b32_e64 v145, 18, v145
v_fma_mix_f32 v233, v128, v128, v233 op_sel_hi:[1,1,0]
v_cvt_pk_f16_f32 v156, v156, v157
v_fma_mix_f32 v233, v129, v129, v233 op_sel_hi:[1,1,0]
v_cvt_pk_f16_f32 v158, v158, v159
v_fma_mix_f32 v233, v130, v130, v233 op_sel_hi:[1,1,0]
v_pk_fma_f16 v157, v156, v156, s48
v_fma_mix_f32 v233, v131, v131, v233 op_sel_hi:[1,1,0]
v_mfma_f32_32x32x16_bf16 v[96:111], v[36:39], v[188:191], v[96:111]
ds_read_u16 v144, v144
ds_read_u16 v145, v145
s_waitcnt lgkmcnt(5)
v_fma_mix_f32 v233, v132, v132, v233 op_sel_hi:[1,1,0]
v_cvt_pkrtz_f16_f32 v147, v146, v147
v_fma_mix_f32 v233, v133, v133, v233 op_sel_hi:[1,1,0]
s_add_u32 s81, s81, 6592
s_cmp_eq_u32 s81, 65920
s_cselect_b32 s81, 0, s81
s_add_u32 s43, s81, s67
s_add_u32 m0, s43, 0
s_add_u32 s66, s66, 98304
buffer_load_dwordx4 v236, s[4:7], s66 offen lds
s_add_u32 m0, s43, 896
s_nop 0
buffer_load_dwordx4 v237, s[4:7], s66 offen lds
v_and_b32 v147, s49, v147
v_bfe_u32 v146, v147, 2, 14
v_lshrrev_b32_e64 v147, 18, v147
v_pk_fma_f16 v159, v158, v158, s48
v_pk_mul_f16 v157, v156, v157
v_pk_mul_f16 v159, v158, v159
v_fma_mix_f32 v233, v134, v134, v233 op_sel_hi:[1,1,0]
v_cvt_pkrtz_f16_f32 v149, v148, v149
v_fma_mix_f32 v233, v135, v135, v233 op_sel_hi:[1,1,0]
ds_read_u16 v146, v146
ds_read_u16 v147, v147
ds_read_b128 v[184:187], v251 offset:2048
v_and_b32_e64 v149, s49, v149
v_bfe_u32 v148, v149, 2, 14
v_lshrrev_b32_e64 v149, 18, v149
v_exp_f16_sdwa v157, v157 dst_sel:WORD_0 dst_unused:UNUSED_PRESERVE src0_sel:WORD_0
v_mfma_f32_32x32x16_bf16 v[160:175], v[16:19], v[176:179], v[160:175]
ds_read_u16 v148, v148
ds_read_u16 v149, v149
v_fma_mix_f32 v233, v136, v136, v233 op_sel_hi:[1,1,0]
v_exp_f16_sdwa v159, v159 dst_sel:WORD_0 dst_unused:UNUSED_PRESERVE src0_sel:WORD_0
v_fma_mix_f32 v233, v137, v137, v233 op_sel_hi:[1,1,0]
v_cvt_pkrtz_f16_f32 v151, v150, v151
v_and_b32_e64 v151, s49, v151
v_bfe_u32 v150, v151, 2, 14
v_lshrrev_b32 v151, 18, v151
v_exp_f16_sdwa v157, v157 dst_sel:WORD_1 dst_unused:UNUSED_PRESERVE src0_sel:WORD_1
s_waitcnt lgkmcnt(6)
v_fma_mix_f32 v233, v138, v138, v233 op_sel_hi:[1,1,0]
v_cvt_pkrtz_f16_f32 v153, v152, v153
v_fma_mix_f32 v233, v139, v139, v233 op_sel_hi:[1,1,0]
v_and_b32_e64 v153, s49, v153
v_bfe_u32 v152, v153, 2, 14
ds_read_u16 v150, v150
ds_read_u16 v151, v151
v_lshrrev_b32_e64 v153, 18, v153
v_exp_f16_sdwa v159, v159 dst_sel:WORD_1 dst_unused:UNUSED_PRESERVE src0_sel:WORD_1
v_mfma_f32_32x32x16_bf16 v[96:111], v[40:43], v[176:179], v[96:111]
ds_read_u16 v152, v152
ds_read_u16 v153, v153
ds_read_b128 v[188:191], v251 offset:3072
v_cvt_pkrtz_f16_f32 v155, v154, v155
v_and_b32_e64 v155, s49, v155
v_bfe_u32 v154, v155, 2, 14
v_lshrrev_b32_e64 v155, 18, v155
v_pk_add_f16 v157, v157, 1.0 op_sel_hi:[1,0]
v_pk_add_f16 v159, v159, 1.0 op_sel_hi:[1,0]
v_rcp_f16_sdwa v157, v157 dst_sel:WORD_0 dst_unused:UNUSED_PRESERVE src0_sel:WORD_0
v_mfma_f32_32x32x16_bf16 v[160:175], v[20:23], v[180:183], v[160:175]
ds_read_u16 v154, v154
ds_read_u16 v155, v155
v_rcp_f16_sdwa v159, v159 dst_sel:WORD_0 dst_unused:UNUSED_PRESERVE src0_sel:WORD_0
v_rcp_f16_sdwa v157, v157 dst_sel:WORD_1 dst_unused:UNUSED_PRESERVE src0_sel:WORD_1
v_rcp_f16_sdwa v159, v159 dst_sel:WORD_1 dst_unused:UNUSED_PRESERVE src0_sel:WORD_1
v_mfma_f32_32x32x16_bf16 v[96:111], v[44:47], v[180:183], v[96:111]
ds_read_b128 v[176:179], v251 offset:4096
v_pk_mul_f16 v156, v156, v157
v_pk_mul_f16 v158, v158, v159
v_fma_mix_f32 v233, v156, v156, v233 op_sel_hi:[1,1,0]
s_nop 1
v_cvt_pkrtz_f16_f32 v161, v160, v161
v_fma_mix_f32 v233, v158, v158, v233 op_sel_hi:[1,1,0]
s_waitcnt lgkmcnt(7)
v_mfma_f32_32x32x16_bf16 v[112:127], v[0:3], v[184:187], 0
v_fma_mix_f32 v233, v156, v156, v233 op_sel:[1,1,0] op_sel_hi:[1,1,0]
v_and_b32_e64 v161, s49, v161
v_fma_mix_f32 v233, v158, v158, v233 op_sel:[1,1,0] op_sel_hi:[1,1,0]
v_bfe_u32 v160, v161, 2, 14
v_fma_mix_f32 v233, v144, v144, v233 op_sel_hi:[1,1,0]
v_lshrrev_b32_e64 v161, 18, v161
v_fma_mix_f32 v233, v145, v145, v233 op_sel_hi:[1,1,0]
v_cvt_pk_f16_f32 v172, v172, v173
v_fma_mix_f32 v233, v146, v146, v233 op_sel_hi:[1,1,0]
v_cvt_pk_f16_f32 v174, v174, v175
v_fma_mix_f32 v233, v147, v147, v233 op_sel_hi:[1,1,0]
v_pk_fma_f16 v173, v172, v172, s48
v_mfma_f32_32x32x16_bf16 v[128:143], v[24:27], v[184:187], 0
ds_read_u16 v160, v160
ds_read_u16 v161, v161
v_fma_mix_f32 v233, v148, v148, v233 op_sel_hi:[1,1,0]
v_cvt_pkrtz_f16_f32 v163, v162, v163
v_fma_mix_f32 v233, v149, v149, v233 op_sel_hi:[1,1,0]
v_and_b32_e64 v163, s49, v163
v_bfe_u32 v162, v163, 2, 14
v_lshrrev_b32_e64 v163, 18, v163
v_pk_fma_f16 v175, v174, v174, s48
v_pk_mul_f16 v173, v172, v173
v_pk_mul_f16 v175, v174, v175
v_fma_mix_f32 v233, v150, v150, v233 op_sel_hi:[1,1,0]
v_cvt_pkrtz_f16_f32 v165, v164, v165
s_waitcnt lgkmcnt(3)
v_fma_mix_f32 v233, v151, v151, v233 op_sel_hi:[1,1,0]
ds_read_u16 v162, v162
ds_read_u16 v163, v163
ds_read_b128 v[180:183], v251 offset:5120
v_and_b32 v165, s49, v165
v_bfe_u32 v164, v165, 2, 14
v_lshrrev_b32_e64 v165, 18, v165
v_exp_f16_sdwa v173, v173 dst_sel:WORD_0 dst_unused:UNUSED_PRESERVE src0_sel:WORD_0
v_mfma_f32_32x32x16_bf16 v[112:127], v[4:7], v[188:191], v[112:127]
ds_read_u16 v164, v164
ds_read_u16 v165, v165
v_fma_mix_f32 v233, v152, v152, v233 op_sel_hi:[1,1,0]
v_exp_f16_sdwa v175, v175 dst_sel:WORD_0 dst_unused:UNUSED_PRESERVE src0_sel:WORD_0
v_fma_mix_f32 v233, v153, v153, v233 op_sel_hi:[1,1,0]
v_cvt_pkrtz_f16_f32 v167, v166, v167
v_and_b32_e64 v167, s49, v167
v_bfe_u32 v166, v167, 2, 14
v_lshrrev_b32_e64 v167, 18, v167
v_exp_f16_sdwa v173, v173 dst_sel:WORD_1 dst_unused:UNUSED_PRESERVE src0_sel:WORD_1
v_fma_mix_f32 v233, v154, v154, v233 op_sel_hi:[1,1,0]
v_cvt_pkrtz_f16_f32 v169, v168, v169
v_fma_mix_f32 v233, v155, v155, v233 op_sel_hi:[1,1,0]
v_and_b32_e64 v169, s49, v169
v_bfe_u32 v168, v169, 2, 14
ds_read_u16 v166, v166
ds_read_u16 v167, v167
v_lshrrev_b32_e64 v169, 18, v169
v_exp_f16_sdwa v175, v175 dst_sel:WORD_1 dst_unused:UNUSED_PRESERVE src0_sel:WORD_1
v_mfma_f32_32x32x16_bf16 v[128:143], v[28:31], v[188:191], v[128:143]
ds_read_u16 v168, v168
ds_read_u16 v169, v169
ds_read_b128 v[184:187], v251 offset:6144
v_cvt_pkrtz_f16_f32 v171, v170, v171
v_and_b32_e64 v171, s49, v171
v_bfe_u32 v170, v171, 2, 14
v_lshrrev_b32 v171, 18, v171
v_pk_add_f16 v173, v173, 1.0 op_sel_hi:[1,0]
v_pk_add_f16 v175, v175, 1.0 op_sel_hi:[1,0]
v_rcp_f16_sdwa v173, v173 dst_sel:WORD_0 dst_unused:UNUSED_PRESERVE src0_sel:WORD_0
s_waitcnt lgkmcnt(7)
v_mfma_f32_32x32x16_bf16 v[112:127], v[8:11], v[176:179], v[112:127]
ds_read_u16 v170, v170
ds_read_u16 v171, v171
v_rcp_f16_sdwa v175, v175 dst_sel:WORD_0 dst_unused:UNUSED_PRESERVE src0_sel:WORD_0
v_rcp_f16_sdwa v173, v173 dst_sel:WORD_1 dst_unused:UNUSED_PRESERVE src0_sel:WORD_1
v_rcp_f16_sdwa v175, v175 dst_sel:WORD_1 dst_unused:UNUSED_PRESERVE src0_sel:WORD_1
v_mfma_f32_32x32x16_bf16 v[128:143], v[32:35], v[176:179], v[128:143]
ds_read_b128 v[188:191], v251 offset:7168
v_pk_mul_f16 v172, v172, v173
v_pk_mul_f16 v174, v174, v175
v_fma_mix_f32 v234, v172, v172, v234 op_sel_hi:[1,1,0]
v_cvt_pkrtz_f16_f32 v97, v96, v97
v_fma_mix_f32 v234, v174, v174, v234 op_sel_hi:[1,1,0]
v_mfma_f32_32x32x16_bf16 v[112:127], v[12:15], v[180:183], v[112:127]
v_fma_mix_f32 v234, v172, v172, v234 op_sel:[1,1,0] op_sel_hi:[1,1,0]
v_and_b32_e64 v97, s49, v97
v_fma_mix_f32 v234, v174, v174, v234 op_sel:[1,1,0] op_sel_hi:[1,1,0]
v_bfe_u32 v96, v97, 2, 14
v_fma_mix_f32 v234, v160, v160, v234 op_sel_hi:[1,1,0]
v_lshrrev_b32_e64 v97, 18, v97
v_fma_mix_f32 v234, v161, v161, v234 op_sel_hi:[1,1,0]
v_cvt_pk_f16_f32 v108, v108, v109
v_fma_mix_f32 v234, v162, v162, v234 op_sel_hi:[1,1,0]
v_cvt_pk_f16_f32 v110, v110, v111
v_fma_mix_f32 v234, v163, v163, v234 op_sel_hi:[1,1,0]
v_pk_fma_f16 v109, v108, v108, s48
v_mfma_f32_32x32x16_bf16 v[128:143], v[36:39], v[180:183], v[128:143]
ds_read_u16 v96, v96
ds_read_u16 v97, v97
s_waitcnt lgkmcnt(5)
v_fma_mix_f32 v234, v164, v164, v234 op_sel_hi:[1,1,0]
v_cvt_pkrtz_f16_f32 v99, v98, v99
v_fma_mix_f32 v234, v165, v165, v234 op_sel_hi:[1,1,0]
v_and_b32 v99, s49, v99
v_bfe_u32 v98, v99, 2, 14
v_lshrrev_b32_e64 v99, 18, v99
v_pk_fma_f16 v111, v110, v110, s48
v_pk_mul_f16 v109, v108, v109
v_pk_mul_f16 v111, v110, v111
v_fma_mix_f32 v234, v166, v166, v234 op_sel_hi:[1,1,0]
v_cvt_pkrtz_f16_f32 v101, v100, v101
v_fma_mix_f32 v234, v167, v167, v234 op_sel_hi:[1,1,0]
ds_read_u16 v98, v98
ds_read_u16 v99, v99
v_and_b32_e64 v101, s49, v101
v_bfe_u32 v100, v101, 2, 14
v_lshrrev_b32_e64 v101, 18, v101
v_exp_f16_sdwa v109, v109 dst_sel:WORD_0 dst_unused:UNUSED_PRESERVE src0_sel:WORD_0
v_mfma_f32_32x32x16_bf16 v[112:127], v[16:19], v[184:187], v[112:127]
ds_read_u16 v100, v100
ds_read_u16 v101, v101
v_fma_mix_f32 v234, v168, v168, v234 op_sel_hi:[1,1,0]
v_exp_f16_sdwa v111, v111 dst_sel:WORD_0 dst_unused:UNUSED_PRESERVE src0_sel:WORD_0
v_fma_mix_f32 v234, v169, v169, v234 op_sel_hi:[1,1,0]
v_cvt_pkrtz_f16_f32 v103, v102, v103
v_and_b32_e64 v103, s49, v103
v_bfe_u32 v102, v103, 2, 14
v_lshrrev_b32 v103, 18, v103
v_exp_f16_sdwa v109, v109 dst_sel:WORD_1 dst_unused:UNUSED_PRESERVE src0_sel:WORD_1
s_waitcnt lgkmcnt(5)
v_fma_mix_f32 v234, v170, v170, v234 op_sel_hi:[1,1,0]
v_cvt_pkrtz_f16_f32 v105, v104, v105
v_fma_mix_f32 v234, v171, v171, v234 op_sel_hi:[1,1,0]
v_and_b32_e64 v105, s49, v105
v_bfe_u32 v104, v105, 2, 14
ds_read_u16 v102, v102
ds_read_u16 v103, v103
v_lshrrev_b32_e64 v105, 18, v105
v_exp_f16_sdwa v111, v111 dst_sel:WORD_1 dst_unused:UNUSED_PRESERVE src0_sel:WORD_1
v_mfma_f32_32x32x16_bf16 v[128:143], v[40:43], v[184:187], v[128:143]
ds_read_u16 v104, v104
ds_read_u16 v105, v105
v_cvt_pkrtz_f16_f32 v107, v106, v107
v_and_b32_e64 v107, s49, v107
v_bfe_u32 v106, v107, 2, 14
v_lshrrev_b32_e64 v107, 18, v107
v_pk_add_f16 v109, v109, 1.0 op_sel_hi:[1,0]
v_pk_add_f16 v111, v111, 1.0 op_sel_hi:[1,0]
v_rcp_f16_sdwa v109, v109 dst_sel:WORD_0 dst_unused:UNUSED_PRESERVE src0_sel:WORD_0
v_mfma_f32_32x32x16_bf16 v[112:127], v[20:23], v[188:191], v[112:127]
ds_read_u16 v106, v106
ds_read_u16 v107, v107
v_rcp_f16_sdwa v111, v111 dst_sel:WORD_0 dst_unused:UNUSED_PRESERVE src0_sel:WORD_0
v_rcp_f16_sdwa v109, v109 dst_sel:WORD_1 dst_unused:UNUSED_PRESERVE src0_sel:WORD_1
v_rcp_f16_sdwa v111, v111 dst_sel:WORD_1 dst_unused:UNUSED_PRESERVE src0_sel:WORD_1
v_mfma_f32_32x32x16_bf16 v[128:143], v[44:47], v[188:191], v[128:143]
v_pk_mul_f16 v108, v108, v109
v_pk_mul_f16 v110, v110, v111
v_fma_mix_f32 v234, v108, v108, v234 op_sel_hi:[1,1,0]
s_nop 2
v_cvt_pkrtz_f16_f32 v113, v112, v113
v_fma_mix_f32 v234, v110, v110, v234 op_sel_hi:[1,1,0]
v_and_b32 v113, s49, v113
v_fma_mix_f32 v234, v108, v108, v234 op_sel:[1,1,0] op_sel_hi:[1,1,0]
v_bfe_u32 v112, v113, 2, 14
v_fma_mix_f32 v234, v110, v110, v234 op_sel:[1,1,0] op_sel_hi:[1,1,0]
v_lshrrev_b32 v113, 18, v113
v_fma_mix_f32 v234, v96, v96, v234 op_sel_hi:[1,1,0]
v_cvt_pk_f16_f32 v124, v124, v125
s_waitcnt lgkmcnt(4)
v_fma_mix_f32 v234, v97, v97, v234 op_sel_hi:[1,1,0]
v_cvt_pk_f16_f32 v126, v126, v127
v_fma_mix_f32 v234, v98, v98, v234 op_sel_hi:[1,1,0]
v_pk_fma_f16 v125, v124, v124, s48
v_fma_mix_f32 v234, v99, v99, v234 op_sel_hi:[1,1,0]
v_cvt_pkrtz_f16_f32 v115, v114, v115
v_fma_mix_f32 v234, v100, v100, v234 op_sel_hi:[1,1,0]
v_and_b32_e64 v115, s49, v115
v_fma_mix_f32 v234, v101, v101, v234 op_sel_hi:[1,1,0]
v_bfe_u32 v114, v115, 2, 14
v_lshrrev_b32_e64 v115, 18, v115
ds_read_u16 v112, v112
ds_read_u16 v113, v113
ds_read_u16 v114, v114
ds_read_u16 v115, v115
s_add_u32 s43, s81, 6592
v_add_u32_e64 v212, s43, v246
v_subrev_u32 v222, 65920, v212
v_min_u32_e64 v212, v212, v222
v_add_u32 v212, 90112, v212
v_add_u32_e64 v213, s43, v246
v_add_u32 v213, 6592, v213
v_subrev_u32 v222, 65920, v213
v_min_u32_e64 v213, v213, v222
v_add_u32 v213, 90112, v213
v_add_u32_e64 v214, s43, v246
v_add_u32 v214, 13184, v214
v_add_u32_e64 v222, 16, v214
v_bfi_b32 v214, 48, v222, v214
v_subrev_u32 v222, 65920, v214
v_min_u32_e64 v214, v214, v222
v_add_u32 v214, 90112, v214
v_add_u32_e64 v215, s43, v246
v_add_u32 v215, 19776, v215
v_add_u32_e64 v222, 16, v215
v_bfi_b32 v215, 48, v222, v215
v_subrev_u32 v222, 65920, v215
v_min_u32_e64 v215, v215, v222
v_add_u32 v215, 90112, v215
v_pk_fma_f16 v127, v126, v126, s48
v_pk_mul_f16 v125, v124, v125
v_pk_mul_f16 v127, v126, v127
v_fma_mix_f32 v234, v102, v102, v234 op_sel_hi:[1,1,0]
v_cvt_pkrtz_f16_f32 v117, v116, v117
v_fma_mix_f32 v234, v103, v103, v234 op_sel_hi:[1,1,0]
v_and_b32_e64 v117, s49, v117
v_bfe_u32 v116, v117, 2, 14
v_lshrrev_b32 v117, 18, v117
v_exp_f16_sdwa v125, v125 dst_sel:WORD_0 dst_unused:UNUSED_PRESERVE src0_sel:WORD_0
s_waitcnt lgkmcnt(2)
v_fma_mix_f32 v234, v104, v104, v234 op_sel_hi:[1,1,0]
v_exp_f16_sdwa v127, v127 dst_sel:WORD_0 dst_unused:UNUSED_PRESERVE src0_sel:WORD_0
v_fma_mix_f32 v234, v105, v105, v234 op_sel_hi:[1,1,0]
v_cvt_pkrtz_f16_f32 v119, v118, v119
v_and_b32_e64 v119, s49, v119
ds_read_u16 v116, v116
ds_read_u16 v117, v117
v_bfe_u32 v118, v119, 2, 14
v_lshrrev_b32_e64 v119, 18, v119
v_exp_f16_sdwa v125, v125 dst_sel:WORD_1 dst_unused:UNUSED_PRESERVE src0_sel:WORD_1
v_fma_mix_f32 v234, v106, v106, v234 op_sel_hi:[1,1,0]
v_cvt_pkrtz_f16_f32 v121, v120, v121
v_fma_mix_f32 v234, v107, v107, v234 op_sel_hi:[1,1,0]
v_and_b32 v121, s49, v121
v_bfe_u32 v120, v121, 2, 14
ds_read_u16 v118, v118
ds_read_u16 v119, v119
s_waitcnt vmcnt(0)
ds_read_b128 v[144:147], v212
ds_read_b64 v[196:197], v238
ds_read_b64 v[198:199], v239
v_lshrrev_b32_e64 v121, 18, v121
v_exp_f16_sdwa v127, v127 dst_sel:WORD_1 dst_unused:UNUSED_PRESERVE src0_sel:WORD_1
v_cvt_pkrtz_f16_f32 v123, v122, v123
v_and_b32_e64 v123, s49, v123
v_bfe_u32 v122, v123, 2, 14
v_lshrrev_b32_e64 v123, 18, v123
v_pk_add_f16 v125, v125, 1.0 op_sel_hi:[1,0]
ds_read_u16 v120, v120
ds_read_u16 v121, v121
ds_read_b128 v[148:151], v213
ds_read_b128 v[152:155], v214
ds_read_b64 v[200:201], v238 offset:2400
ds_read_b64 v[202:203], v239 offset:2400
s_waitcnt lgkmcnt(13)
ds_read_b128 v[156:159], v215
ds_read_u16 v122, v122
s_waitcnt lgkmcnt(14)
ds_read_u16 v123, v123
v_pk_add_f16 v127, v127, 1.0 op_sel_hi:[1,0]
v_rcp_f16_sdwa v125, v125 dst_sel:WORD_0 dst_unused:UNUSED_PRESERVE src0_sel:WORD_0
v_rcp_f16_sdwa v127, v127 dst_sel:WORD_0 dst_unused:UNUSED_PRESERVE src0_sel:WORD_0
v_rcp_f16_sdwa v125, v125 dst_sel:WORD_1 dst_unused:UNUSED_PRESERVE src0_sel:WORD_1
v_rcp_f16_sdwa v127, v127 dst_sel:WORD_1 dst_unused:UNUSED_PRESERVE src0_sel:WORD_1
v_pk_mul_f16 v124, v124, v125
v_pk_mul_f16 v126, v126, v127
v_fma_mix_f32 v235, v124, v124, v235 op_sel_hi:[1,1,0]
s_waitcnt lgkmcnt(13)
ds_read_b64 v[204:205], v238 offset:4800
ds_read_b64 v[206:207], v239 offset:4800
s_waitcnt lgkmcnt(14)
ds_read_b128 v[160:163], v212 offset:16
v_fma_mix_f32 v235, v126, v126, v235 op_sel_hi:[1,1,0]
v_cvt_pkrtz_f16_f32 v129, v128, v129
v_fma_mix_f32 v235, v124, v124, v235 op_sel:[1,1,0] op_sel_hi:[1,1,0]
s_waitcnt lgkmcnt(12)
v_mfma_f32_16x16x32_bf16 v[48:51], v[196:199], v[144:147], 0
ds_read_b64 v[208:209], v238 offset:200
ds_read_b64 v[210:211], v239 offset:200
v_fma_mix_f32 v235, v126, v126, v235 op_sel:[1,1,0] op_sel_hi:[1,1,0]
v_and_b32 v129, s49, v129
v_fma_mix_f32 v235, v112, v112, v235 op_sel_hi:[1,1,0]
v_bfe_u32 v128, v129, 2, 14
v_fma_mix_f32 v235, v113, v113, v235 op_sel_hi:[1,1,0]
v_lshrrev_b32 v129, 18, v129
v_fma_mix_f32 v235, v114, v114, v235 op_sel_hi:[1,1,0]
v_cvt_pk_f16_f32 v140, v140, v141
ds_read_b128 v[164:167], v213 offset:16
s_waitcnt lgkmcnt(14)
ds_read_b128 v[168:171], v214 offset:16
v_fma_mix_f32 v235, v115, v115, v235 op_sel_hi:[1,1,0]
v_cvt_pk_f16_f32 v142, v142, v143
s_waitcnt lgkmcnt(13)
v_mfma_f32_16x16x32_bf16 v[96:99], v[196:199], v[148:151], 0
ds_read_b64 v[192:193], v238 offset:2600
ds_read_b64 v[194:195], v239 offset:2600
v_pk_fma_f16 v141, v140, v140, s48
v_fma_mix_f32 v235, v116, v116, v235 op_sel_hi:[1,1,0]
v_cvt_pkrtz_f16_f32 v131, v130, v131
s_waitcnt lgkmcnt(12)
v_mfma_f32_16x16x32_bf16 v[48:51], v[200:203], v[148:151], v[48:51]
ds_read_b128 v[172:175], v215 offset:16
ds_read_b64 v[196:197], v238 offset:5000
ds_read_b64 v[198:199], v239 offset:5000
v_mfma_f32_16x16x32_bf16 v[96:99], v[200:203], v[152:155], v[96:99]
v_fma_mix_f32 v235, v117, v117, v235 op_sel_hi:[1,1,0]
v_and_b32_e64 v131, s49, v131
v_bfe_u32 v130, v131, 2, 14
v_lshrrev_b32_e64 v131, 18, v131
v_pk_fma_f16 v143, v142, v142, s48
v_pk_mul_f16 v141, v140, v141
v_pk_mul_f16 v143, v142, v143
v_fma_mix_f32 v235, v118, v118, v235 op_sel_hi:[1,1,0]
v_cvt_pkrtz_f16_f32 v133, v132, v133
s_waitcnt lgkmcnt(14)
ds_read_b128 v[144:147], v212 offset:32
s_waitcnt lgkmcnt(14)
ds_read_b64 v[200:201], v238 offset:400
s_waitcnt lgkmcnt(14)
ds_read_b64 v[202:203], v239 offset:400
v_fma_mix_f32 v235, v119, v119, v235 op_sel_hi:[1,1,0]
s_waitcnt lgkmcnt(13)
v_mfma_f32_16x16x32_bf16 v[48:51], v[204:207], v[152:155], v[48:51]
ds_read_b128 v[148:151], v213 offset:32
ds_read_b128 v[152:155], v214 offset:32
v_mfma_f32_16x16x32_bf16 v[96:99], v[204:207], v[156:159], v[96:99]
s_waitcnt lgkmcnt(14)
ds_read_b64 v[204:205], v238 offset:2800
s_waitcnt lgkmcnt(14)
ds_read_b64 v[206:207], v239 offset:2800
s_waitcnt lgkmcnt(14)
v_mfma_f32_16x16x32_bf16 v[52:55], v[208:211], v[160:163], 0
v_and_b32_e64 v133, s49, v133
v_bfe_u32 v132, v133, 2, 14
s_waitcnt lgkmcnt(13)
v_mfma_f32_16x16x32_bf16 v[100:103], v[208:211], v[164:167], 0
ds_read_b128 v[156:159], v215 offset:32
ds_read_b64 v[208:209], v238 offset:5200
v_lshrrev_b32 v133, 18, v133
v_exp_f16_sdwa v141, v141 dst_sel:WORD_0 dst_unused:UNUSED_PRESERVE src0_sel:WORD_0
s_waitcnt lgkmcnt(12)
v_mfma_f32_16x16x32_bf16 v[52:55], v[192:195], v[164:167], v[52:55]
ds_read_b64 v[210:211], v239 offset:5200
ds_read_b128 v[160:163], v212 offset:48
v_mfma_f32_16x16x32_bf16 v[100:103], v[192:195], v[168:171], v[100:103]
ds_read_b64 v[192:193], v238 offset:600
s_waitcnt lgkmcnt(14)
ds_read_b64 v[194:195], v239 offset:600
s_waitcnt lgkmcnt(13)
v_mfma_f32_16x16x32_bf16 v[52:55], v[196:199], v[168:171], v[52:55]
ds_read_u16 v128, v128
ds_read_u16 v129, v129
v_mfma_f32_16x16x32_bf16 v[100:103], v[196:199], v[172:175], v[100:103]
s_waitcnt lgkmcnt(14)
ds_read_b128 v[164:167], v213 offset:48
s_waitcnt lgkmcnt(14)
ds_read_b128 v[168:171], v214 offset:48
s_waitcnt lgkmcnt(14)
v_mfma_f32_16x16x32_bf16 v[56:59], v[200:203], v[144:147], 0
ds_read_b64 v[196:197], v238 offset:3000
v_fma_mix_f32 v235, v120, v120, v235 op_sel_hi:[1,1,0]
s_waitcnt lgkmcnt(14)
v_mfma_f32_16x16x32_bf16 v[104:107], v[200:203], v[148:151], 0
ds_read_b64 v[198:199], v239 offset:3000
v_fma_mix_f32 v235, v121, v121, v235 op_sel_hi:[1,1,0]
v_exp_f16_sdwa v143, v143 dst_sel:WORD_0 dst_unused:UNUSED_PRESERVE src0_sel:WORD_0
s_waitcnt lgkmcnt(12)
v_mfma_f32_16x16x32_bf16 v[56:59], v[204:207], v[148:151], v[56:59]
ds_read_u16 v130, v130
ds_read_u16 v131, v131
ds_read_b128 v[172:175], v215 offset:48
v_mfma_f32_16x16x32_bf16 v[104:107], v[204:207], v[152:155], v[104:107]
s_waitcnt lgkmcnt(14)
ds_read_b64 v[200:201], v238 offset:5400
s_waitcnt lgkmcnt(14)
ds_read_b64 v[202:203], v239 offset:5400
s_waitcnt lgkmcnt(14)
v_mfma_f32_16x16x32_bf16 v[56:59], v[208:211], v[152:155], v[56:59]
ds_read_u16 v132, v132
v_cvt_pkrtz_f16_f32 v135, v134, v135
v_mfma_f32_16x16x32_bf16 v[104:107], v[208:211], v[156:159], v[104:107]
s_waitcnt lgkmcnt(14)
ds_read_u16 v133, v133
s_waitcnt lgkmcnt(14)
ds_read_b128 v[144:147], v212 offset:64
s_waitcnt lgkmcnt(14)
v_mfma_f32_16x16x32_bf16 v[60:63], v[192:195], v[160:163], 0
v_and_b32 v135, s49, v135
v_bfe_u32 v134, v135, 2, 14
v_lshrrev_b32_e64 v135, 18, v135
v_exp_f16_sdwa v141, v141 dst_sel:WORD_1 dst_unused:UNUSED_PRESERVE src0_sel:WORD_1
v_fma_mix_f32 v235, v122, v122, v235 op_sel_hi:[1,1,0]
v_cvt_pkrtz_f16_f32 v137, v136, v137
v_fma_mix_f32 v235, v123, v123, v235 op_sel_hi:[1,1,0]
v_and_b32 v137, s49, v137
ds_read_b64 v[204:205], v238 offset:800
s_waitcnt lgkmcnt(14)
ds_read_b64 v[206:207], v239 offset:800
s_waitcnt lgkmcnt(14)
ds_read_b128 v[148:151], v213 offset:64
s_waitcnt lgkmcnt(14)
v_mfma_f32_16x16x32_bf16 v[108:111], v[192:195], v[164:167], 0
v_bfe_u32 v136, v137, 2, 14
v_lshrrev_b32 v137, 18, v137
v_exp_f16_sdwa v143, v143 dst_sel:WORD_1 dst_unused:UNUSED_PRESERVE src0_sel:WORD_1
v_cvt_pkrtz_f16_f32 v139, v138, v139
s_waitcnt lgkmcnt(11)
v_mfma_f32_16x16x32_bf16 v[60:63], v[196:199], v[164:167], v[60:63]
ds_read_u16 v134, v134
ds_read_u16 v135, v135
ds_read_b128 v[152:155], v214 offset:64
v_mfma_f32_16x16x32_bf16 v[108:111], v[196:199], v[168:171], v[108:111]
ds_read_b64 v[208:209], v238 offset:3200
v_and_b32_e64 v139, s49, v139
v_bfe_u32 v138, v139, 2, 14
v_lshrrev_b32 v139, 18, v139
v_pk_add_f16 v141, v141, 1.0 op_sel_hi:[1,0]
v_pk_add_f16 v143, v143, 1.0 op_sel_hi:[1,0]
v_rcp_f16_sdwa v141, v141 dst_sel:WORD_0 dst_unused:UNUSED_PRESERVE src0_sel:WORD_0
v_rcp_f16_sdwa v143, v143 dst_sel:WORD_0 dst_unused:UNUSED_PRESERVE src0_sel:WORD_0
v_rcp_f16_sdwa v141, v141 dst_sel:WORD_1 dst_unused:UNUSED_PRESERVE src0_sel:WORD_1
s_waitcnt lgkmcnt(10)
v_mfma_f32_16x16x32_bf16 v[60:63], v[200:203], v[168:171], v[60:63]
ds_read_b64 v[210:211], v239 offset:3200
ds_read_b128 v[156:159], v215 offset:64
ds_read_b64 v[192:193], v238 offset:5600
ds_read_b64 v[194:195], v239 offset:5600
v_mfma_f32_16x16x32_bf16 v[108:111], v[200:203], v[172:175], v[108:111]
ds_read_u16 v136, v136
v_rcp_f16_sdwa v143, v143 dst_sel:WORD_1 dst_unused:UNUSED_PRESERVE src0_sel:WORD_1
v_pk_mul_f16 v140, v140, v141
v_pk_mul_f16 v142, v142, v143
v_fma_mix_f32 v235, v140, v140, v235 op_sel_hi:[1,1,0]
s_waitcnt lgkmcnt(14)
ds_read_u16 v137, v137
v_fma_mix_f32 v235, v142, v142, v235 op_sel_hi:[1,1,0]
s_waitcnt lgkmcnt(14)
ds_read_b128 v[160:163], v212 offset:80
s_waitcnt lgkmcnt(14)
ds_read_b64 v[196:197], v238 offset:1000
s_waitcnt lgkmcnt(14)
ds_read_b64 v[198:199], v239 offset:1000
s_waitcnt lgkmcnt(14)
v_mfma_f32_16x16x32_bf16 v[64:67], v[204:207], v[144:147], 0
v_fma_mix_f32 v235, v140, v140, v235 op_sel:[1,1,0] op_sel_hi:[1,1,0]
ds_read_u16 v138, v138
s_waitcnt lgkmcnt(14)
v_mfma_f32_16x16x32_bf16 v[112:115], v[204:207], v[148:151], 0
ds_read_u16 v139, v139
s_waitcnt lgkmcnt(14)
ds_read_b128 v[164:167], v213 offset:80
v_fma_mix_f32 v235, v142, v142, v235 op_sel:[1,1,0] op_sel_hi:[1,1,0]
s_nop 0
v_fma_mix_f32 v235, v128, v128, v235 op_sel_hi:[1,1,0]
s_waitcnt lgkmcnt(14)
ds_read_b128 v[168:171], v214 offset:80
v_fma_mix_f32 v235, v129, v129, v235 op_sel_hi:[1,1,0]
s_waitcnt lgkmcnt(14)
ds_read_b64 v[200:201], v238 offset:3400
v_fma_mix_f32 v235, v130, v130, v235 op_sel_hi:[1,1,0]
s_waitcnt lgkmcnt(13)
v_mfma_f32_16x16x32_bf16 v[64:67], v[208:211], v[148:151], v[64:67]
ds_read_b64 v[202:203], v239 offset:3400
v_fma_mix_f32 v235, v131, v131, v235 op_sel_hi:[1,1,0]
v_mfma_f32_16x16x32_bf16 v[112:115], v[208:211], v[152:155], v[112:115]
ds_read_b128 v[172:175], v215 offset:80
s_waitcnt lgkmcnt(14)
ds_read_b64 v[204:205], v238 offset:5800
s_waitcnt lgkmcnt(14)
ds_read_b64 v[206:207], v239 offset:5800
s_waitcnt lgkmcnt(14)
v_mfma_f32_16x16x32_bf16 v[64:67], v[192:195], v[152:155], v[64:67]
v_fma_mix_f32 v235, v132, v132, v235 op_sel_hi:[1,1,0]
v_mfma_f32_16x16x32_bf16 v[112:115], v[192:195], v[156:159], v[112:115]
ds_read_b128 v[144:147], v212 offset:96
v_fma_mix_f32 v235, v133, v133, v235 op_sel_hi:[1,1,0]
s_waitcnt lgkmcnt(14)
ds_read_b64 v[208:209], v238 offset:1200
s_waitcnt lgkmcnt(14)
ds_read_b64 v[210:211], v239 offset:1200
v_fma_mix_f32 v235, v134, v134, v235 op_sel_hi:[1,1,0]
s_waitcnt lgkmcnt(14)
ds_read_b128 v[148:151], v213 offset:96
v_fma_mix_f32 v235, v135, v135, v235 op_sel_hi:[1,1,0]
s_waitcnt lgkmcnt(13)
v_mfma_f32_16x16x32_bf16 v[68:71], v[196:199], v[160:163], 0
ds_read_b128 v[152:155], v214 offset:96
ds_read_b64 v[192:193], v238 offset:3600
s_waitcnt lgkmcnt(14)
ds_read_b64 v[194:195], v239 offset:3600
s_waitcnt lgkmcnt(13)
v_mfma_f32_16x16x32_bf16 v[116:119], v[196:199], v[164:167], 0
ds_read_b128 v[156:159], v215 offset:96
ds_read_b64 v[196:197], v238 offset:6000
s_waitcnt lgkmcnt(14)
ds_read_b64 v[198:199], v239 offset:6000
s_waitcnt lgkmcnt(13)
v_mfma_f32_16x16x32_bf16 v[68:71], v[200:203], v[164:167], v[68:71]
ds_read_b128 v[160:163], v212 offset:112
v_fma_mix_f32 v235, v136, v136, v235 op_sel_hi:[1,1,0]
v_mfma_f32_16x16x32_bf16 v[116:119], v[200:203], v[168:171], v[116:119]
ds_read_b64 v[200:201], v238 offset:1400
s_waitcnt lgkmcnt(14)
ds_read_b64 v[202:203], v239 offset:1400
s_waitcnt lgkmcnt(13)
v_mfma_f32_16x16x32_bf16 v[68:71], v[204:207], v[168:171], v[68:71]
ds_read_b128 v[164:167], v213 offset:112
v_fma_mix_f32 v235, v137, v137, v235 op_sel_hi:[1,1,0]
v_mfma_f32_16x16x32_bf16 v[116:119], v[204:207], v[172:175], v[116:119]
ds_read_b128 v[168:171], v214 offset:112
s_waitcnt lgkmcnt(14)
ds_read_b64 v[204:205], v238 offset:3800
s_waitcnt lgkmcnt(13)
v_mfma_f32_16x16x32_bf16 v[72:75], v[208:211], v[144:147], 0
ds_read_b64 v[206:207], v239 offset:3800
ds_read_b128 v[172:175], v215 offset:112
s_waitcnt lgkmcnt(14)
v_mfma_f32_16x16x32_bf16 v[120:123], v[208:211], v[148:151], 0
v_fma_mix_f32 v235, v138, v138, v235 op_sel_hi:[1,1,0]
ds_read_b64 v[208:209], v238 offset:6200
v_fma_mix_f32 v235, v139, v139, v235 op_sel_hi:[1,1,0]
s_waitcnt lgkmcnt(14)
ds_read_b64 v[210:211], v239 offset:6200
s_waitcnt lgkmcnt(13)
v_mfma_f32_16x16x32_bf16 v[72:75], v[192:195], v[148:151], v[72:75]
ds_read_b128 v[144:147], v212 offset:128
ds_read_b128 v[148:151], v213 offset:128
v_mfma_f32_16x16x32_bf16 v[120:123], v[192:195], v[152:155], v[120:123]
s_waitcnt lgkmcnt(14)
ds_read_b64 v[192:193], v238 offset:1600
s_waitcnt lgkmcnt(14)
ds_read_b64 v[194:195], v239 offset:1600
s_waitcnt lgkmcnt(14)
v_mfma_f32_16x16x32_bf16 v[72:75], v[196:199], v[152:155], v[72:75]
ds_read_b128 v[152:155], v214 offset:128
v_mfma_f32_16x16x32_bf16 v[120:123], v[196:199], v[156:159], v[120:123]
s_waitcnt lgkmcnt(14)
ds_read_b64 v[196:197], v238 offset:4000
s_waitcnt lgkmcnt(14)
ds_read_b64 v[198:199], v239 offset:4000
s_waitcnt lgkmcnt(14)
v_mfma_f32_16x16x32_bf16 v[76:79], v[200:203], v[160:163], 0
ds_read_b128 v[156:159], v215 offset:128
s_waitcnt lgkmcnt(14)
v_mfma_f32_16x16x32_bf16 v[124:127], v[200:203], v[164:167], 0
ds_read_b64 v[200:201], v238 offset:6400
s_waitcnt lgkmcnt(14)
ds_read_b64 v[202:203], v239 offset:6400
s_waitcnt lgkmcnt(13)
v_mfma_f32_16x16x32_bf16 v[76:79], v[204:207], v[164:167], v[76:79]
ds_read_b128 v[160:163], v212 offset:144
ds_read_b128 v[164:167], v213 offset:144
v_mfma_f32_16x16x32_bf16 v[124:127], v[204:207], v[168:171], v[124:127]
s_waitcnt lgkmcnt(14)
ds_read_b64 v[204:205], v238 offset:1800
s_waitcnt lgkmcnt(14)
ds_read_b64 v[206:207], v239 offset:1800
s_waitcnt lgkmcnt(14)
v_mfma_f32_16x16x32_bf16 v[76:79], v[208:211], v[168:171], v[76:79]
ds_read_b128 v[168:171], v214 offset:144
v_mfma_f32_16x16x32_bf16 v[124:127], v[208:211], v[172:175], v[124:127]
s_waitcnt lgkmcnt(14)
ds_read_b64 v[208:209], v238 offset:4200
s_waitcnt lgkmcnt(14)
ds_read_b64 v[210:211], v239 offset:4200
s_waitcnt lgkmcnt(13)
v_mfma_f32_16x16x32_bf16 v[80:83], v[192:195], v[144:147], 0
ds_read_b128 v[172:175], v215 offset:144
ds_read_b128 v[144:147], v212 offset:160
v_mfma_f32_16x16x32_bf16 v[128:131], v[192:195], v[148:151], 0
s_waitcnt lgkmcnt(14)
ds_read_b64 v[192:193], v238 offset:6600
s_waitcnt lgkmcnt(14)
ds_read_b64 v[194:195], v239 offset:6600
s_waitcnt lgkmcnt(14)
v_mfma_f32_16x16x32_bf16 v[80:83], v[196:199], v[148:151], v[80:83]
ds_read_b128 v[148:151], v213 offset:160
v_mfma_f32_16x16x32_bf16 v[128:131], v[196:199], v[152:155], v[128:131]
s_waitcnt lgkmcnt(14)
ds_read_b64 v[196:197], v238 offset:2000
s_waitcnt lgkmcnt(14)
ds_read_b64 v[198:199], v239 offset:2000
s_waitcnt lgkmcnt(14)
v_mfma_f32_16x16x32_bf16 v[80:83], v[200:203], v[152:155], v[80:83]
ds_read_b128 v[152:155], v214 offset:160
v_mfma_f32_16x16x32_bf16 v[128:131], v[200:203], v[156:159], v[128:131]
s_waitcnt lgkmcnt(14)
ds_read_b64 v[200:201], v238 offset:4400
s_waitcnt lgkmcnt(14)
ds_read_b64 v[202:203], v239 offset:4400
s_waitcnt lgkmcnt(13)
v_mfma_f32_16x16x32_bf16 v[84:87], v[204:207], v[160:163], 0
ds_read_b128 v[156:159], v215 offset:160
ds_read_b128 v[160:163], v212 offset:176
v_mfma_f32_16x16x32_bf16 v[132:135], v[204:207], v[164:167], 0
s_waitcnt lgkmcnt(14)
ds_read_b64 v[204:205], v238 offset:6800
s_waitcnt lgkmcnt(14)
ds_read_b64 v[206:207], v239 offset:6800
s_waitcnt lgkmcnt(14)
v_mfma_f32_16x16x32_bf16 v[84:87], v[208:211], v[164:167], v[84:87]
ds_read_b128 v[164:167], v213 offset:176
v_mfma_f32_16x16x32_bf16 v[132:135], v[208:211], v[168:171], v[132:135]
s_waitcnt lgkmcnt(14)
ds_read_b64 v[208:209], v238 offset:2200
s_waitcnt lgkmcnt(14)
ds_read_b64 v[210:211], v239 offset:2200
s_waitcnt lgkmcnt(13)
v_mfma_f32_16x16x32_bf16 v[84:87], v[192:195], v[168:171], v[84:87]
ds_read_b128 v[168:171], v214 offset:176
v_mfma_f32_16x16x32_bf16 v[132:135], v[192:195], v[172:175], v[132:135]
ds_read_b64 v[192:193], v238 offset:4600
s_waitcnt lgkmcnt(14)
ds_read_b64 v[194:195], v239 offset:4600
s_waitcnt lgkmcnt(13)
v_mfma_f32_16x16x32_bf16 v[88:91], v[196:199], v[144:147], 0
ds_read_b128 v[172:175], v215 offset:176
v_mfma_f32_16x16x32_bf16 v[136:139], v[196:199], v[148:151], 0
ds_read_b64 v[196:197], v238 offset:7000
s_waitcnt lgkmcnt(14)
ds_read_b64 v[198:199], v239 offset:7000
s_waitcnt lgkmcnt(13)
v_mfma_f32_16x16x32_bf16 v[88:91], v[200:203], v[148:151], v[88:91]
v_mfma_f32_16x16x32_bf16 v[136:139], v[200:203], v[152:155], v[136:139]
s_waitcnt lgkmcnt(9)
v_mfma_f32_16x16x32_bf16 v[88:91], v[204:207], v[152:155], v[88:91]
v_mfma_f32_16x16x32_bf16 v[136:139], v[204:207], v[156:159], v[136:139]
s_waitcnt lgkmcnt(6)
v_mfma_f32_16x16x32_bf16 v[92:95], v[208:211], v[160:163], 0
v_mfma_f32_16x16x32_bf16 v[140:143], v[208:211], v[164:167], 0
s_waitcnt lgkmcnt(3)
v_mfma_f32_16x16x32_bf16 v[92:95], v[192:195], v[164:167], v[92:95]
v_mfma_f32_16x16x32_bf16 v[140:143], v[192:195], v[168:171], v[140:143]
s_waitcnt lgkmcnt(0)
v_mfma_f32_16x16x32_bf16 v[92:95], v[196:199], v[168:171], v[92:95]
v_mfma_f32_16x16x32_bf16 v[140:143], v[196:199], v[172:175], v[140:143]
v_mov_b32 v223, 1
v_add_u32 v222, s83, v247
s_nop 7
s_mov_b64 exec, 1
ds_add_u32 v222, v223 offset:24
s_mov_b64 exec, -1
v_pk_mul_f32 v[242:243], v[48:49], v[48:49]
v_pk_add_f32 v[240:241], v[48:49], v[50:51]
v_pk_fma_f32 v[242:243], v[50:51], v[50:51], v[242:243]
v_pk_mul_f32 v[218:219], v[96:97], v[96:97]
v_pk_add_f32 v[216:217], v[96:97], v[98:99]
v_pk_fma_f32 v[218:219], v[98:99], v[98:99], v[218:219]
v_pk_fma_f32 v[242:243], v[52:53], v[52:53], v[242:243]
v_pk_add_f32 v[240:241], v[240:241], v[52:53]
v_pk_fma_f32 v[242:243], v[54:55], v[54:55], v[242:243]
v_pk_add_f32 v[240:241], v[240:241], v[54:55]
v_pk_fma_f32 v[218:219], v[100:101], v[100:101], v[218:219]
v_pk_add_f32 v[216:217], v[216:217], v[100:101]
v_pk_fma_f32 v[218:219], v[102:103], v[102:103], v[218:219]
v_pk_add_f32 v[216:217], v[216:217], v[102:103]
v_pk_fma_f32 v[242:243], v[56:57], v[56:57], v[242:243]
v_pk_add_f32 v[240:241], v[240:241], v[56:57]
v_pk_fma_f32 v[242:243], v[58:59], v[58:59], v[242:243]
v_pk_add_f32 v[240:241], v[240:241], v[58:59]
v_pk_fma_f32 v[218:219], v[104:105], v[104:105], v[218:219]
v_pk_add_f32 v[216:217], v[216:217], v[104:105]
v_pk_fma_f32 v[218:219], v[106:107], v[106:107], v[218:219]
v_pk_add_f32 v[216:217], v[216:217], v[106:107]
v_pk_fma_f32 v[242:243], v[60:61], v[60:61], v[242:243]
v_pk_add_f32 v[240:241], v[240:241], v[60:61]
v_pk_fma_f32 v[242:243], v[62:63], v[62:63], v[242:243]
v_pk_add_f32 v[240:241], v[240:241], v[62:63]
v_pk_fma_f32 v[218:219], v[108:109], v[108:109], v[218:219]
v_pk_add_f32 v[216:217], v[216:217], v[108:109]
v_pk_fma_f32 v[218:219], v[110:111], v[110:111], v[218:219]
v_pk_add_f32 v[216:217], v[216:217], v[110:111]
v_pk_fma_f32 v[242:243], v[64:65], v[64:65], v[242:243]
v_pk_add_f32 v[240:241], v[240:241], v[64:65]
v_pk_fma_f32 v[242:243], v[66:67], v[66:67], v[242:243]
v_pk_add_f32 v[240:241], v[240:241], v[66:67]
v_pk_fma_f32 v[218:219], v[112:113], v[112:113], v[218:219]
v_pk_add_f32 v[216:217], v[216:217], v[112:113]
v_pk_fma_f32 v[218:219], v[114:115], v[114:115], v[218:219]
v_pk_add_f32 v[216:217], v[216:217], v[114:115]
v_pk_fma_f32 v[242:243], v[68:69], v[68:69], v[242:243]
v_pk_add_f32 v[240:241], v[240:241], v[68:69]
v_pk_fma_f32 v[242:243], v[70:71], v[70:71], v[242:243]
v_pk_add_f32 v[240:241], v[240:241], v[70:71]
v_pk_fma_f32 v[218:219], v[116:117], v[116:117], v[218:219]
v_pk_add_f32 v[216:217], v[216:217], v[116:117]
v_pk_fma_f32 v[218:219], v[118:119], v[118:119], v[218:219]
v_pk_add_f32 v[216:217], v[216:217], v[118:119]
v_pk_fma_f32 v[242:243], v[72:73], v[72:73], v[242:243]
v_pk_add_f32 v[240:241], v[240:241], v[72:73]
v_pk_fma_f32 v[242:243], v[74:75], v[74:75], v[242:243]
v_pk_add_f32 v[240:241], v[240:241], v[74:75]
v_pk_fma_f32 v[218:219], v[120:121], v[120:121], v[218:219]
v_pk_add_f32 v[216:217], v[216:217], v[120:121]
v_pk_fma_f32 v[218:219], v[122:123], v[122:123], v[218:219]
v_pk_add_f32 v[216:217], v[216:217], v[122:123]
v_pk_fma_f32 v[242:243], v[76:77], v[76:77], v[242:243]
v_pk_add_f32 v[240:241], v[240:241], v[76:77]
v_pk_fma_f32 v[242:243], v[78:79], v[78:79], v[242:243]
v_pk_add_f32 v[240:241], v[240:241], v[78:79]
v_pk_fma_f32 v[218:219], v[124:125], v[124:125], v[218:219]
v_pk_add_f32 v[216:217], v[216:217], v[124:125]
v_pk_fma_f32 v[218:219], v[126:127], v[126:127], v[218:219]
v_pk_add_f32 v[216:217], v[216:217], v[126:127]
v_pk_fma_f32 v[242:243], v[80:81], v[80:81], v[242:243]
v_pk_add_f32 v[240:241], v[240:241], v[80:81]
v_pk_fma_f32 v[242:243], v[82:83], v[82:83], v[242:243]
v_pk_add_f32 v[240:241], v[240:241], v[82:83]
v_pk_fma_f32 v[218:219], v[128:129], v[128:129], v[218:219]
v_pk_add_f32 v[216:217], v[216:217], v[128:129]
v_pk_fma_f32 v[218:219], v[130:131], v[130:131], v[218:219]
v_pk_add_f32 v[216:217], v[216:217], v[130:131]
v_pk_fma_f32 v[242:243], v[84:85], v[84:85], v[242:243]
v_pk_add_f32 v[240:241], v[240:241], v[84:85]
v_pk_fma_f32 v[242:243], v[86:87], v[86:87], v[242:243]
v_pk_add_f32 v[240:241], v[240:241], v[86:87]
v_pk_fma_f32 v[218:219], v[132:133], v[132:133], v[218:219]
v_pk_add_f32 v[216:217], v[216:217], v[132:133]
v_pk_fma_f32 v[218:219], v[134:135], v[134:135], v[218:219]
v_pk_add_f32 v[216:217], v[216:217], v[134:135]
v_pk_fma_f32 v[242:243], v[88:89], v[88:89], v[242:243]
v_pk_add_f32 v[240:241], v[240:241], v[88:89]
v_pk_fma_f32 v[242:243], v[90:91], v[90:91], v[242:243]
v_pk_add_f32 v[240:241], v[240:241], v[90:91]
v_pk_fma_f32 v[218:219], v[136:137], v[136:137], v[218:219]
v_pk_add_f32 v[216:217], v[216:217], v[136:137]
v_pk_fma_f32 v[218:219], v[138:139], v[138:139], v[218:219]
v_pk_add_f32 v[216:217], v[216:217], v[138:139]
v_pk_fma_f32 v[242:243], v[92:93], v[92:93], v[242:243]
v_pk_add_f32 v[240:241], v[240:241], v[92:93]
v_pk_fma_f32 v[242:243], v[94:95], v[94:95], v[242:243]
v_pk_add_f32 v[240:241], v[240:241], v[94:95]
v_pk_fma_f32 v[218:219], v[140:141], v[140:141], v[218:219]
v_pk_add_f32 v[216:217], v[216:217], v[140:141]
v_pk_fma_f32 v[218:219], v[142:143], v[142:143], v[218:219]
v_pk_add_f32 v[216:217], v[216:217], v[142:143]
v_add_f32 v218, v218, v219
v_add_f32 v216, v216, v217
s_nop 1
v_permlane32_swap_b32 v216, v218
v_add_f32_e64 v216, v216, v218
v_mul_f32 v216, 1009429163, v216
v_mov_b32_e64 v218, v216
s_nop 1
v_permlane32_swap_b32 v216, v218
v_fma_f32 v218, -v216, v216, v218
v_max_f32_e64 v218, 0, v218
v_add_f32 v218, 925353388, v218
v_rsq_f32 v218, v218
v_add_f32 v240, v240, v241
v_mul_f32 v220, 3203396952, v218
v_mul_f32 v221, 3203396952, v218
v_mul_f32 v218, v216, v220
v_mul_f32 v219, v216, v220
v_add_f32 v242, v242, v243
s_nop 1
v_permlane32_swap_b32 v240, v242
v_add_f32 v240, v240, v242
v_mul_f32 v240, 1009429163, v240
v_mov_b32_e64 v242, v240
s_nop 1
v_permlane32_swap_b32 v240, v242
v_fma_f32 v242, -v240, v240, v242
v_max_f32_e64 v242, 0, v242
v_add_f32 v242, 925353388, v242
v_rsq_f32 v242, v242
s_nop 0
v_mul_f32 v244, 3203396952, v242
v_mul_f32 v245, 3203396952, v242
v_mul_f32 v242, v240, v244
v_mul_f32 v243, v240, v244
v_pk_fma_f32 v[48:49], v[48:49], v[244:245], v[242:243] neg_lo:[0,0,1] neg_hi:[0,0,1]
v_pk_fma_f32 v[50:51], v[50:51], v[244:245], v[242:243] neg_lo:[0,0,1] neg_hi:[0,0,1]
v_cvt_pk_bf16_f32 v48, v48, v49
v_cvt_pk_bf16_f32 v49, v50, v51
v_pk_fma_f32 v[52:53], v[52:53], v[244:245], v[242:243] neg_lo:[0,0,1] neg_hi:[0,0,1]
v_pk_fma_f32 v[54:55], v[54:55], v[244:245], v[242:243] neg_lo:[0,0,1] neg_hi:[0,0,1]
v_cvt_pk_bf16_f32 v50, v52, v53
v_cvt_pk_bf16_f32 v51, v54, v55
v_pk_fma_f32 v[56:57], v[56:57], v[244:245], v[242:243] neg_lo:[0,0,1] neg_hi:[0,0,1]
v_pk_fma_f32 v[58:59], v[58:59], v[244:245], v[242:243] neg_lo:[0,0,1] neg_hi:[0,0,1]
v_cvt_pk_bf16_f32 v52, v56, v57
v_cvt_pk_bf16_f32 v53, v58, v59
v_pk_fma_f32 v[60:61], v[60:61], v[244:245], v[242:243] neg_lo:[0,0,1] neg_hi:[0,0,1]
v_pk_fma_f32 v[62:63], v[62:63], v[244:245], v[242:243] neg_lo:[0,0,1] neg_hi:[0,0,1]
v_cvt_pk_bf16_f32 v54, v60, v61
v_cvt_pk_bf16_f32 v55, v62, v63
v_pk_fma_f32 v[64:65], v[64:65], v[244:245], v[242:243] neg_lo:[0,0,1] neg_hi:[0,0,1]
v_pk_fma_f32 v[66:67], v[66:67], v[244:245], v[242:243] neg_lo:[0,0,1] neg_hi:[0,0,1]
v_cvt_pk_bf16_f32 v56, v64, v65
v_cvt_pk_bf16_f32 v57, v66, v67
v_pk_fma_f32 v[68:69], v[68:69], v[244:245], v[242:243] neg_lo:[0,0,1] neg_hi:[0,0,1]
v_pk_fma_f32 v[70:71], v[70:71], v[244:245], v[242:243] neg_lo:[0,0,1] neg_hi:[0,0,1]
v_cvt_pk_bf16_f32 v58, v68, v69
v_cvt_pk_bf16_f32 v59, v70, v71
v_pk_fma_f32 v[72:73], v[72:73], v[244:245], v[242:243] neg_lo:[0,0,1] neg_hi:[0,0,1]
v_pk_fma_f32 v[74:75], v[74:75], v[244:245], v[242:243] neg_lo:[0,0,1] neg_hi:[0,0,1]
v_cvt_pk_bf16_f32 v60, v72, v73
v_cvt_pk_bf16_f32 v61, v74, v75
v_pk_fma_f32 v[76:77], v[76:77], v[244:245], v[242:243] neg_lo:[0,0,1] neg_hi:[0,0,1]
v_pk_fma_f32 v[78:79], v[78:79], v[244:245], v[242:243] neg_lo:[0,0,1] neg_hi:[0,0,1]
v_cvt_pk_bf16_f32 v62, v76, v77
v_cvt_pk_bf16_f32 v63, v78, v79
v_pk_fma_f32 v[80:81], v[80:81], v[244:245], v[242:243] neg_lo:[0,0,1] neg_hi:[0,0,1]
v_pk_fma_f32 v[82:83], v[82:83], v[244:245], v[242:243] neg_lo:[0,0,1] neg_hi:[0,0,1]
v_cvt_pk_bf16_f32 v64, v80, v81
v_cvt_pk_bf16_f32 v65, v82, v83
v_pk_fma_f32 v[84:85], v[84:85], v[244:245], v[242:243] neg_lo:[0,0,1] neg_hi:[0,0,1]
v_pk_fma_f32 v[86:87], v[86:87], v[244:245], v[242:243] neg_lo:[0,0,1] neg_hi:[0,0,1]
v_cvt_pk_bf16_f32 v66, v84, v85
v_cvt_pk_bf16_f32 v67, v86, v87
v_pk_fma_f32 v[88:89], v[88:89], v[244:245], v[242:243] neg_lo:[0,0,1] neg_hi:[0,0,1]
v_pk_fma_f32 v[90:91], v[90:91], v[244:245], v[242:243] neg_lo:[0,0,1] neg_hi:[0,0,1]
v_cvt_pk_bf16_f32 v68, v88, v89
v_cvt_pk_bf16_f32 v69, v90, v91
v_pk_fma_f32 v[92:93], v[92:93], v[244:245], v[242:243] neg_lo:[0,0,1] neg_hi:[0,0,1]
v_pk_fma_f32 v[94:95], v[94:95], v[244:245], v[242:243] neg_lo:[0,0,1] neg_hi:[0,0,1]
v_cvt_pk_bf16_f32 v70, v92, v93
v_cvt_pk_bf16_f32 v71, v94, v95
v_pk_fma_f32 v[96:97], v[96:97], v[220:221], v[218:219] neg_lo:[0,0,1] neg_hi:[0,0,1]
ds_read_b128 v[176:179], v250
v_cvt_pk_bf16_f32 v72, v96, v97
v_pk_fma_f32 v[98:99], v[98:99], v[220:221], v[218:219] neg_lo:[0,0,1] neg_hi:[0,0,1]
v_pk_fma_f32 v[100:101], v[100:101], v[220:221], v[218:219] neg_lo:[0,0,1] neg_hi:[0,0,1]
v_cvt_pk_bf16_f32 v73, v98, v99
v_cvt_pk_bf16_f32 v74, v100, v101
v_pk_fma_f32 v[102:103], v[102:103], v[220:221], v[218:219] neg_lo:[0,0,1] neg_hi:[0,0,1]
v_pk_fma_f32 v[104:105], v[104:105], v[220:221], v[218:219] neg_lo:[0,0,1] neg_hi:[0,0,1]
v_cvt_pk_bf16_f32 v75, v102, v103
v_cvt_pk_bf16_f32 v76, v104, v105
v_pk_fma_f32 v[106:107], v[106:107], v[220:221], v[218:219] neg_lo:[0,0,1] neg_hi:[0,0,1]
v_pk_fma_f32 v[108:109], v[108:109], v[220:221], v[218:219] neg_lo:[0,0,1] neg_hi:[0,0,1]
v_cvt_pk_bf16_f32 v77, v106, v107
v_cvt_pk_bf16_f32 v78, v108, v109
v_pk_fma_f32 v[110:111], v[110:111], v[220:221], v[218:219] neg_lo:[0,0,1] neg_hi:[0,0,1]
v_pk_fma_f32 v[112:113], v[112:113], v[220:221], v[218:219] neg_lo:[0,0,1] neg_hi:[0,0,1]
v_cvt_pk_bf16_f32 v79, v110, v111
v_cvt_pk_bf16_f32 v80, v112, v113
v_pk_fma_f32 v[114:115], v[114:115], v[220:221], v[218:219] neg_lo:[0,0,1] neg_hi:[0,0,1]
v_pk_fma_f32 v[116:117], v[116:117], v[220:221], v[218:219] neg_lo:[0,0,1] neg_hi:[0,0,1]
v_cvt_pk_bf16_f32 v81, v114, v115
v_cvt_pk_bf16_f32 v82, v116, v117
v_pk_fma_f32 v[118:119], v[118:119], v[220:221], v[218:219] neg_lo:[0,0,1] neg_hi:[0,0,1]
v_pk_fma_f32 v[120:121], v[120:121], v[220:221], v[218:219] neg_lo:[0,0,1] neg_hi:[0,0,1]
ds_read_b128 v[180:183], v250 offset:1024
v_cvt_pk_bf16_f32 v83, v118, v119
v_cvt_pk_bf16_f32 v84, v120, v121
v_pk_fma_f32 v[122:123], v[122:123], v[220:221], v[218:219] neg_lo:[0,0,1] neg_hi:[0,0,1]
v_pk_fma_f32 v[124:125], v[124:125], v[220:221], v[218:219] neg_lo:[0,0,1] neg_hi:[0,0,1]
v_cvt_pk_bf16_f32 v85, v122, v123
v_cvt_pk_bf16_f32 v86, v124, v125
v_pk_fma_f32 v[126:127], v[126:127], v[220:221], v[218:219] neg_lo:[0,0,1] neg_hi:[0,0,1]
v_pk_fma_f32 v[128:129], v[128:129], v[220:221], v[218:219] neg_lo:[0,0,1] neg_hi:[0,0,1]
v_cvt_pk_bf16_f32 v87, v126, v127
v_cvt_pk_bf16_f32 v88, v128, v129
v_pk_fma_f32 v[130:131], v[130:131], v[220:221], v[218:219] neg_lo:[0,0,1] neg_hi:[0,0,1]
v_pk_fma_f32 v[132:133], v[132:133], v[220:221], v[218:219] neg_lo:[0,0,1] neg_hi:[0,0,1]
v_cvt_pk_bf16_f32 v89, v130, v131
v_cvt_pk_bf16_f32 v90, v132, v133
v_pk_fma_f32 v[134:135], v[134:135], v[220:221], v[218:219] neg_lo:[0,0,1] neg_hi:[0,0,1]
v_pk_fma_f32 v[136:137], v[136:137], v[220:221], v[218:219] neg_lo:[0,0,1] neg_hi:[0,0,1]
v_cvt_pk_bf16_f32 v91, v134, v135
v_cvt_pk_bf16_f32 v92, v136, v137
v_pk_fma_f32 v[138:139], v[138:139], v[220:221], v[218:219] neg_lo:[0,0,1] neg_hi:[0,0,1]
v_pk_fma_f32 v[140:141], v[140:141], v[220:221], v[218:219] neg_lo:[0,0,1] neg_hi:[0,0,1]
v_cvt_pk_bf16_f32 v93, v138, v139
v_cvt_pk_bf16_f32 v94, v140, v141
v_pk_fma_f32 v[142:143], v[142:143], v[220:221], v[218:219] neg_lo:[0,0,1] neg_hi:[0,0,1]
ds_read_b128 v[184:187], v250 offset:2048
v_cvt_pk_bf16_f32 v95, v142, v143
v_cndmask_b32 v216, 0, v255, s[50:51]
v_and_b32 v216, 1006648320, v216
v_cndmask_b32 v217, 0, v255, s[52:53]
v_and_b32 v217, 1006648320, v217
v_cndmask_b32 v218, 0, v255, s[54:55]
v_and_b32 v218, 1006648320, v218
v_cndmask_b32 v219, 0, v255, s[56:57]
v_and_b32 v219, 1006648320, v219
v_cndmask_b32 v220, 0, v255, s[58:59]
v_and_b32 v220, 1006648320, v220
v_cndmask_b32 v221, 0, v255, s[60:61]
v_and_b32 v221, 1006648320, v221
v_cndmask_b32 v222, 0, v255, s[62:63]
v_and_b32 v222, 1006648320, v222
v_cndmask_b32 v223, 0, v255, s[64:65]
v_and_b32 v223, 1006648320, v223
s_waitcnt lgkmcnt(1)
v_mfma_f32_32x32x16_bf16 v[144:159], v[48:51], v[176:179], 0
s_cmp_lt_u32 s40, 4
s_cbranch_scc0 Lbk
s_setprio 2
Lbk:
ds_read_b128 v[188:191], v250 offset:3072
v_mfma_f32_32x32x16_bf16 v[160:175], v[72:75], v[176:179], 0
ds_read_b128 v[176:179], v250 offset:4096
v_mfma_f32_32x32x16_bf16 v[144:159], v[52:55], v[180:183], v[144:159]
v_mfma_f32_32x32x16_bf16 v[160:175], v[76:79], v[180:183], v[160:175]
ds_read_b128 v[180:183], v250 offset:5120
s_waitcnt lgkmcnt(3)
v_mfma_f32_32x32x16_bf16 v[144:159], v[56:59], v[184:187], v[144:159]
v_mfma_f32_32x32x16_bf16 v[160:175], v[80:83], v[184:187], v[160:175]
ds_read_b128 v[184:187], v250 offset:6144
s_waitcnt lgkmcnt(2)
v_mfma_f32_32x32x16_bf16 v[144:159], v[60:63], v[188:191], v[144:159]
v_mfma_f32_32x32x16_bf16 v[160:175], v[84:87], v[188:191], v[160:175]
ds_read_b128 v[188:191], v250 offset:7168
v_mfma_f32_32x32x16_bf16 v[144:159], v[64:67], v[176:179], v[144:159]
v_mfma_f32_32x32x16_bf16 v[160:175], v[88:91], v[176:179], v[160:175]
ds_read_b128 v[176:179], v250 offset:8192
s_waitcnt lgkmcnt(2)
v_mfma_f32_32x32x16_bf16 v[144:159], v[68:71], v[180:183], v[144:159]
v_mfma_f32_32x32x16_bf16 v[160:175], v[92:95], v[180:183], v[160:175]
ds_read_b128 v[180:183], v250 offset:9216
s_nop 9
v_cvt_pkrtz_f16_f32 v145, v144, v145
v_mfma_f32_32x32x16_bf16 v[112:127], v[48:51], v[184:187], 0
v_and_b32_e64 v145, s49, v145
v_bfe_u32 v144, v145, 2, 14
v_lshrrev_b32_e64 v145, 18, v145
v_cvt_pk_f16_f32 v156, v156, v157
v_cvt_pk_f16_f32 v158, v158, v159
v_mfma_f32_32x32x16_bf16 v[128:143], v[72:75], v[184:187], 0
ds_read_u16 v144, v144
ds_read_u16 v145, v145
v_pk_fma_f16 v157, v156, v156, s48
v_cvt_pkrtz_f16_f32 v147, v146, v147
v_and_b32_e64 v147, s49, v147
v_bfe_u32 v146, v147, 2, 14
v_lshrrev_b32_e64 v147, 18, v147
v_pk_fma_f16 v159, v158, v158, s48
v_pk_mul_f16 v157, v156, v157
v_pk_mul_f16 v159, v158, v159
v_cvt_pkrtz_f16_f32 v149, v148, v149
v_and_b32_e64 v149, s49, v149
v_bfe_u32 v148, v149, 2, 14
ds_read_u16 v146, v146
ds_read_u16 v147, v147
v_lshrrev_b32 v149, 18, v149
v_exp_f16_sdwa v157, v157 dst_sel:WORD_0 dst_unused:UNUSED_PRESERVE src0_sel:WORD_0
s_waitcnt lgkmcnt(4)
v_mfma_f32_32x32x16_bf16 v[112:127], v[52:55], v[188:191], v[112:127]
ds_read_u16 v148, v148
ds_read_u16 v149, v149
v_exp_f16_sdwa v159, v159 dst_sel:WORD_0 dst_unused:UNUSED_PRESERVE src0_sel:WORD_0
v_cvt_pkrtz_f16_f32 v151, v150, v151
v_and_b32_e64 v151, s49, v151
v_bfe_u32 v150, v151, 2, 14
v_lshrrev_b32_e64 v151, 18, v151
v_exp_f16_sdwa v157, v157 dst_sel:WORD_1 dst_unused:UNUSED_PRESERVE src0_sel:WORD_1
v_cvt_pkrtz_f16_f32 v153, v152, v153
v_and_b32_e64 v153, s49, v153
v_bfe_u32 v152, v153, 2, 14
v_lshrrev_b32_e64 v153, 18, v153
v_mfma_f32_32x32x16_bf16 v[128:143], v[76:79], v[188:191], v[128:143]
ds_read_u16 v150, v150
ds_read_u16 v151, v151
ds_read_u16 v152, v152
ds_read_u16 v153, v153
v_exp_f16_sdwa v159, v159 dst_sel:WORD_1 dst_unused:UNUSED_PRESERVE src0_sel:WORD_1
v_cvt_pkrtz_f16_f32 v155, v154, v155
v_and_b32_e64 v155, s49, v155
v_bfe_u32 v154, v155, 2, 14
v_lshrrev_b32_e64 v155, 18, v155
v_pk_add_f16 v157, v157, 1.0 op_sel_hi:[1,0]
v_pk_add_f16 v159, v159, 1.0 op_sel_hi:[1,0]
ds_read_b128 v[184:187], v250 offset:10240
ds_read_u16 v154, v154
ds_read_u16 v155, v155
v_rcp_f16_sdwa v157, v157 dst_sel:WORD_0 dst_unused:UNUSED_PRESERVE src0_sel:WORD_0
v_mfma_f32_32x32x16_bf16 v[112:127], v[56:59], v[176:179], v[112:127]
v_rcp_f16_sdwa v159, v159 dst_sel:WORD_0 dst_unused:UNUSED_PRESERVE src0_sel:WORD_0
v_rcp_f16_sdwa v157, v157 dst_sel:WORD_1 dst_unused:UNUSED_PRESERVE src0_sel:WORD_1
v_rcp_f16_sdwa v159, v159 dst_sel:WORD_1 dst_unused:UNUSED_PRESERVE src0_sel:WORD_1
v_mfma_f32_32x32x16_bf16 v[128:143], v[80:83], v[176:179], v[128:143]
ds_read_b128 v[188:191], v250 offset:11264
v_pk_mul_f16 v156, v156, v157
v_pk_mul_f16 v158, v158, v159
v_fma_mix_f32 v224, v156, v156, v224 op_sel_hi:[1,1,0]
v_cvt_pkrtz_f16_f32 v161, v160, v161
v_fma_mix_f32 v224, v158, v158, v224 op_sel_hi:[1,1,0]
v_mfma_f32_32x32x16_bf16 v[112:127], v[60:63], v[180:183], v[112:127]
v_fma_mix_f32 v224, v156, v156, v224 op_sel:[1,1,0] op_sel_hi:[1,1,0]
v_and_b32_e64 v161, s49, v161
v_fma_mix_f32 v224, v158, v158, v224 op_sel:[1,1,0] op_sel_hi:[1,1,0]
v_bfe_u32 v160, v161, 2, 14
s_waitcnt lgkmcnt(6)
v_fma_mix_f32 v224, v144, v144, v224 op_sel_hi:[1,1,0]
v_lshrrev_b32 v161, 18, v161
v_fma_mix_f32 v224, v145, v145, v224 op_sel_hi:[1,1,0]
v_cvt_pk_f16_f32 v172, v172, v173
v_fma_mix_f32 v224, v146, v146, v224 op_sel_hi:[1,1,0]
v_cvt_pk_f16_f32 v174, v174, v175
v_fma_mix_f32 v224, v147, v147, v224 op_sel_hi:[1,1,0]
v_mfma_f32_32x32x16_bf16 v[128:143], v[84:87], v[180:183], v[128:143]
ds_read_u16 v160, v160
ds_read_u16 v161, v161
v_pk_fma_f16 v173, v172, v172, s48
v_fma_mix_f32 v224, v148, v148, v224 op_sel_hi:[1,1,0]
v_cvt_pkrtz_f16_f32 v163, v162, v163
v_fma_mix_f32 v224, v149, v149, v224 op_sel_hi:[1,1,0]
v_and_b32_e64 v163, s49, v163
v_bfe_u32 v162, v163, 2, 14
v_lshrrev_b32_e64 v163, 18, v163
v_pk_fma_f16 v175, v174, v174, s48
v_pk_mul_f16 v173, v172, v173
v_pk_mul_f16 v175, v174, v175
v_fma_mix_f32 v224, v150, v150, v224 op_sel_hi:[1,1,0]
v_cvt_pkrtz_f16_f32 v165, v164, v165
v_fma_mix_f32 v224, v151, v151, v224 op_sel_hi:[1,1,0]
ds_read_u16 v162, v162
ds_read_u16 v163, v163
ds_read_b128 v[176:179], v250 offset:12288
v_and_b32_e64 v165, s49, v165
v_bfe_u32 v164, v165, 2, 14
v_lshrrev_b32 v165, 18, v165
v_exp_f16_sdwa v173, v173 dst_sel:WORD_0 dst_unused:UNUSED_PRESERVE src0_sel:WORD_0
s_waitcnt lgkmcnt(5)
v_mfma_f32_32x32x16_bf16 v[112:127], v[64:67], v[184:187], v[112:127]
ds_read_u16 v164, v164
ds_read_u16 v165, v165
v_fma_mix_f32 v224, v152, v152, v224 op_sel_hi:[1,1,0]
v_exp_f16_sdwa v175, v175 dst_sel:WORD_0 dst_unused:UNUSED_PRESERVE src0_sel:WORD_0
v_fma_mix_f32 v224, v153, v153, v224 op_sel_hi:[1,1,0]
v_cvt_pkrtz_f16_f32 v167, v166, v167
v_and_b32_e64 v167, s49, v167
v_bfe_u32 v166, v167, 2, 14
v_lshrrev_b32_e64 v167, 18, v167
v_exp_f16_sdwa v173, v173 dst_sel:WORD_1 dst_unused:UNUSED_PRESERVE src0_sel:WORD_1
v_fma_mix_f32 v224, v154, v154, v224 op_sel_hi:[1,1,0]
v_cvt_pkrtz_f16_f32 v169, v168, v169
v_fma_mix_f32 v224, v155, v155, v224 op_sel_hi:[1,1,0]
v_and_b32_e64 v169, s49, v169
v_bfe_u32 v168, v169, 2, 14
ds_read_u16 v166, v166
ds_read_u16 v167, v167
v_lshrrev_b32_e64 v169, 18, v169
v_mfma_f32_32x32x16_bf16 v[128:143], v[88:91], v[184:187], v[128:143]
ds_read_u16 v168, v168
ds_read_u16 v169, v169
v_exp_f16_sdwa v175, v175 dst_sel:WORD_1 dst_unused:UNUSED_PRESERVE src0_sel:WORD_1
v_cvt_pkrtz_f16_f32 v171, v170, v171
v_and_b32_e64 v171, s49, v171
v_bfe_u32 v170, v171, 2, 14
v_lshrrev_b32_e64 v171, 18, v171
v_pk_add_f16 v173, v173, 1.0 op_sel_hi:[1,0]
v_pk_add_f16 v175, v175, 1.0 op_sel_hi:[1,0]
ds_read_b128 v[180:183], v250 offset:13312
ds_read_u16 v170, v170
ds_read_u16 v171, v171
v_rcp_f16_sdwa v173, v173 dst_sel:WORD_0 dst_unused:UNUSED_PRESERVE src0_sel:WORD_0
v_mfma_f32_32x32x16_bf16 v[112:127], v[68:71], v[188:191], v[112:127]
v_rcp_f16_sdwa v175, v175 dst_sel:WORD_0 dst_unused:UNUSED_PRESERVE src0_sel:WORD_0
v_rcp_f16_sdwa v173, v173 dst_sel:WORD_1 dst_unused:UNUSED_PRESERVE src0_sel:WORD_1
v_rcp_f16_sdwa v175, v175 dst_sel:WORD_1 dst_unused:UNUSED_PRESERVE src0_sel:WORD_1
v_mfma_f32_32x32x16_bf16 v[128:143], v[92:95], v[188:191], v[128:143]
ds_read_b128 v[184:187], v250 offset:14336
v_pk_mul_f16 v172, v172, v173
v_pk_mul_f16 v174, v174, v175
v_fma_mix_f32 v224, v172, v172, v224 op_sel_hi:[1,1,0]
s_nop 3
v_cvt_pkrtz_f16_f32 v113, v112, v113
v_fma_mix_f32 v224, v174, v174, v224 op_sel_hi:[1,1,0]
s_waitcnt lgkmcnt(7)
v_mfma_f32_32x32x16_bf16 v[96:111], v[48:51], v[176:179], 0
v_fma_mix_f32 v224, v172, v172, v224 op_sel:[1,1,0] op_sel_hi:[1,1,0]
v_and_b32_e64 v113, s49, v113
v_fma_mix_f32 v224, v174, v174, v224 op_sel:[1,1,0] op_sel_hi:[1,1,0]
v_bfe_u32 v112, v113, 2, 14
v_fma_mix_f32 v224, v160, v160, v224 op_sel_hi:[1,1,0]
v_lshrrev_b32_e64 v113, 18, v113
v_fma_mix_f32 v224, v161, v161, v224 op_sel_hi:[1,1,0]
v_cvt_pk_f16_f32 v124, v124, v125
v_fma_mix_f32 v224, v162, v162, v224 op_sel_hi:[1,1,0]
v_cvt_pk_f16_f32 v126, v126, v127
v_fma_mix_f32 v224, v163, v163, v224 op_sel_hi:[1,1,0]
v_mfma_f32_32x32x16_bf16 v[144:159], v[176:179], v[72:75], 0
ds_read_u16 v112, v112
ds_read_u16 v113, v113
v_pk_fma_f16 v125, v124, v124, s48
v_fma_mix_f32 v224, v164, v164, v224 op_sel_hi:[1,1,0]
v_cvt_pkrtz_f16_f32 v115, v114, v115
v_fma_mix_f32 v224, v165, v165, v224 op_sel_hi:[1,1,0]
v_and_b32_e64 v115, s49, v115
v_bfe_u32 v114, v115, 2, 14
v_lshrrev_b32_e64 v115, 18, v115
v_pk_fma_f16 v127, v126, v126, s48
v_pk_mul_f16 v125, v124, v125
v_pk_mul_f16 v127, v126, v127
v_fma_mix_f32 v224, v166, v166, v224 op_sel_hi:[1,1,0]
v_cvt_pkrtz_f16_f32 v117, v116, v117
s_waitcnt lgkmcnt(3)
v_fma_mix_f32 v224, v167, v167, v224 op_sel_hi:[1,1,0]
ds_read_u16 v114, v114
ds_read_u16 v115, v115
ds_read_b128 v[188:191], v250 offset:15360
v_and_b32 v117, s49, v117
v_bfe_u32 v116, v117, 2, 14
v_lshrrev_b32_e64 v117, 18, v117
v_exp_f16_sdwa v125, v125 dst_sel:WORD_0 dst_unused:UNUSED_PRESERVE src0_sel:WORD_0
v_mfma_f32_32x32x16_bf16 v[96:111], v[52:55], v[180:183], v[96:111]
ds_read_u16 v116, v116
ds_read_u16 v117, v117
v_fma_mix_f32 v224, v168, v168, v224 op_sel_hi:[1,1,0]
v_exp_f16_sdwa v127, v127 dst_sel:WORD_0 dst_unused:UNUSED_PRESERVE src0_sel:WORD_0
v_fma_mix_f32 v224, v169, v169, v224 op_sel_hi:[1,1,0]
v_cvt_pkrtz_f16_f32 v119, v118, v119
v_and_b32_e64 v119, s49, v119
v_bfe_u32 v118, v119, 2, 14
v_lshrrev_b32_e64 v119, 18, v119
v_exp_f16_sdwa v125, v125 dst_sel:WORD_1 dst_unused:UNUSED_PRESERVE src0_sel:WORD_1
v_fma_mix_f32 v224, v170, v170, v224 op_sel_hi:[1,1,0]
v_cvt_pkrtz_f16_f32 v121, v120, v121
v_fma_mix_f32 v224, v171, v171, v224 op_sel_hi:[1,1,0]
v_and_b32_e64 v121, s49, v121
v_bfe_u32 v120, v121, 2, 14
ds_read_u16 v118, v118
ds_read_u16 v119, v119
v_lshrrev_b32_e64 v121, 18, v121
v_mfma_f32_32x32x16_bf16 v[144:159], v[180:183], v[76:79], v[144:159]
ds_read_u16 v120, v120
ds_read_u16 v121, v121
v_exp_f16_sdwa v127, v127 dst_sel:WORD_1 dst_unused:UNUSED_PRESERVE src0_sel:WORD_1
v_cvt_pkrtz_f16_f32 v123, v122, v123
v_and_b32_e64 v123, s49, v123
v_bfe_u32 v122, v123, 2, 14
v_lshrrev_b32 v123, 18, v123
v_pk_add_f16 v125, v125, 1.0 op_sel_hi:[1,0]
v_pk_add_f16 v127, v127, 1.0 op_sel_hi:[1,0]
ds_read_b128 v[176:179], v250 offset:16384
ds_read_u16 v122, v122
ds_read_u16 v123, v123
v_rcp_f16_sdwa v125, v125 dst_sel:WORD_0 dst_unused:UNUSED_PRESERVE src0_sel:WORD_0
s_waitcnt lgkmcnt(9)
v_mfma_f32_32x32x16_bf16 v[96:111], v[56:59], v[184:187], v[96:111]
v_rcp_f16_sdwa v127, v127 dst_sel:WORD_0 dst_unused:UNUSED_PRESERVE src0_sel:WORD_0
v_rcp_f16_sdwa v125, v125 dst_sel:WORD_1 dst_unused:UNUSED_PRESERVE src0_sel:WORD_1
v_rcp_f16_sdwa v127, v127 dst_sel:WORD_1 dst_unused:UNUSED_PRESERVE src0_sel:WORD_1
v_mfma_f32_32x32x16_bf16 v[144:159], v[184:187], v[80:83], v[144:159]
ds_read_b128 v[180:183], v250 offset:17408
v_pk_mul_f16 v124, v124, v125
v_pk_mul_f16 v126, v126, v127
v_fma_mix_f32 v225, v124, v124, v225 op_sel_hi:[1,1,0]
v_cvt_pkrtz_f16_f32 v129, v128, v129
v_fma_mix_f32 v225, v126, v126, v225 op_sel_hi:[1,1,0]
v_mfma_f32_32x32x16_bf16 v[96:111], v[60:63], v[188:191], v[96:111]
v_fma_mix_f32 v225, v124, v124, v225 op_sel:[1,1,0] op_sel_hi:[1,1,0]
v_and_b32_e64 v129, s49, v129
v_fma_mix_f32 v225, v126, v126, v225 op_sel:[1,1,0] op_sel_hi:[1,1,0]
v_bfe_u32 v128, v129, 2, 14
v_fma_mix_f32 v225, v112, v112, v225 op_sel_hi:[1,1,0]
v_lshrrev_b32_e64 v129, 18, v129
v_fma_mix_f32 v225, v113, v113, v225 op_sel_hi:[1,1,0]
v_cvt_pk_f16_f32 v140, v140, v141
v_fma_mix_f32 v225, v114, v114, v225 op_sel_hi:[1,1,0]
v_cvt_pk_f16_f32 v142, v142, v143
v_fma_mix_f32 v225, v115, v115, v225 op_sel_hi:[1,1,0]
v_mfma_f32_32x32x16_bf16 v[144:159], v[188:191], v[84:87], v[144:159]
ds_read_u16 v128, v128
ds_read_u16 v129, v129
v_pk_fma_f16 v141, v140, v140, s48
s_waitcnt lgkmcnt(5)
v_fma_mix_f32 v225, v116, v116, v225 op_sel_hi:[1,1,0]
v_cvt_pkrtz_f16_f32 v131, v130, v131
v_fma_mix_f32 v225, v117, v117, v225 op_sel_hi:[1,1,0]
v_and_b32 v131, s49, v131
v_bfe_u32 v130, v131, 2, 14
v_lshrrev_b32_e64 v131, 18, v131
v_pk_fma_f16 v143, v142, v142, s48
v_pk_mul_f16 v141, v140, v141
v_pk_mul_f16 v143, v142, v143
v_fma_mix_f32 v225, v118, v118, v225 op_sel_hi:[1,1,0]
v_cvt_pkrtz_f16_f32 v133, v132, v133
v_fma_mix_f32 v225, v119, v119, v225 op_sel_hi:[1,1,0]
ds_read_u16 v130, v130
ds_read_u16 v131, v131
ds_read_b128 v[184:187], v250 offset:18432
v_and_b32_e64 v133, s49, v133
v_bfe_u32 v132, v133, 2, 14
v_lshrrev_b32_e64 v133, 18, v133
v_exp_f16_sdwa v141, v141 dst_sel:WORD_0 dst_unused:UNUSED_PRESERVE src0_sel:WORD_0
v_mfma_f32_32x32x16_bf16 v[96:111], v[64:67], v[176:179], v[96:111]
ds_read_u16 v132, v132
ds_read_u16 v133, v133
v_fma_mix_f32 v225, v120, v120, v225 op_sel_hi:[1,1,0]
v_exp_f16_sdwa v143, v143 dst_sel:WORD_0 dst_unused:UNUSED_PRESERVE src0_sel:WORD_0
v_fma_mix_f32 v225, v121, v121, v225 op_sel_hi:[1,1,0]
v_cvt_pkrtz_f16_f32 v135, v134, v135
v_and_b32_e64 v135, s49, v135
v_bfe_u32 v134, v135, 2, 14
v_lshrrev_b32 v135, 18, v135
v_exp_f16_sdwa v141, v141 dst_sel:WORD_1 dst_unused:UNUSED_PRESERVE src0_sel:WORD_1
s_waitcnt lgkmcnt(5)
v_fma_mix_f32 v225, v122, v122, v225 op_sel_hi:[1,1,0]
v_cvt_pkrtz_f16_f32 v137, v136, v137
v_fma_mix_f32 v225, v123, v123, v225 op_sel_hi:[1,1,0]
v_and_b32_e64 v137, s49, v137
v_bfe_u32 v136, v137, 2, 14
ds_read_u16 v134, v134
ds_read_u16 v135, v135
v_lshrrev_b32_e64 v137, 18, v137
v_mfma_f32_32x32x16_bf16 v[144:159], v[176:179], v[88:91], v[144:159]
ds_read_u16 v136, v136
ds_read_u16 v137, v137
v_exp_f16_sdwa v143, v143 dst_sel:WORD_1 dst_unused:UNUSED_PRESERVE src0_sel:WORD_1
v_cvt_pkrtz_f16_f32 v139, v138, v139
v_and_b32_e64 v139, s49, v139
v_bfe_u32 v138, v139, 2, 14
v_lshrrev_b32_e64 v139, 18, v139
v_pk_add_f16 v141, v141, 1.0 op_sel_hi:[1,0]
v_pk_add_f16 v143, v143, 1.0 op_sel_hi:[1,0]
ds_read_b128 v[188:191], v250 offset:19456
ds_read_u16 v138, v138
ds_read_u16 v139, v139
v_rcp_f16_sdwa v141, v141 dst_sel:WORD_0 dst_unused:UNUSED_PRESERVE src0_sel:WORD_0
v_mfma_f32_32x32x16_bf16 v[96:111], v[68:71], v[180:183], v[96:111]
v_rcp_f16_sdwa v143, v143 dst_sel:WORD_0 dst_unused:UNUSED_PRESERVE src0_sel:WORD_0
v_rcp_f16_sdwa v141, v141 dst_sel:WORD_1 dst_unused:UNUSED_PRESERVE src0_sel:WORD_1
v_rcp_f16_sdwa v143, v143 dst_sel:WORD_1 dst_unused:UNUSED_PRESERVE src0_sel:WORD_1
v_mfma_f32_32x32x16_bf16 v[144:159], v[180:183], v[92:95], v[144:159]
ds_read_b128 v[176:179], v250 offset:20480
v_pk_mul_f16 v140, v140, v141
v_pk_mul_f16 v142, v142, v143
v_fma_mix_f32 v225, v140, v140, v225 op_sel_hi:[1,1,0]
s_nop 3
v_cvt_pkrtz_f16_f32 v97, v96, v97
v_fma_mix_f32 v225, v142, v142, v225 op_sel_hi:[1,1,0]
s_waitcnt lgkmcnt(7)
v_mfma_f32_32x32x16_bf16 v[160:175], v[48:51], v[184:187], 0
v_fma_mix_f32 v225, v140, v140, v225 op_sel:[1,1,0] op_sel_hi:[1,1,0]
v_and_b32_e64 v97, s49, v97
v_fma_mix_f32 v225, v142, v142, v225 op_sel:[1,1,0] op_sel_hi:[1,1,0]
v_bfe_u32 v96, v97, 2, 14
v_fma_mix_f32 v225, v128, v128, v225 op_sel_hi:[1,1,0]
v_lshrrev_b32_e64 v97, 18, v97
v_fma_mix_f32 v225, v129, v129, v225 op_sel_hi:[1,1,0]
v_cvt_pk_f16_f32 v108, v108, v109
v_fma_mix_f32 v225, v130, v130, v225 op_sel_hi:[1,1,0]
v_cvt_pk_f16_f32 v110, v110, v111
v_fma_mix_f32 v225, v131, v131, v225 op_sel_hi:[1,1,0]
v_mfma_f32_32x32x16_bf16 v[112:127], v[184:187], v[72:75], 0
ds_read_u16 v96, v96
ds_read_u16 v97, v97
v_pk_fma_f16 v109, v108, v108, s48
v_fma_mix_f32 v225, v132, v132, v225 op_sel_hi:[1,1,0]
v_cvt_pkrtz_f16_f32 v99, v98, v99
v_fma_mix_f32 v225, v133, v133, v225 op_sel_hi:[1,1,0]
v_and_b32_e64 v99, s49, v99
v_bfe_u32 v98, v99, 2, 14
v_lshrrev_b32_e64 v99, 18, v99
v_pk_fma_f16 v111, v110, v110, s48
v_pk_mul_f16 v109, v108, v109
v_pk_mul_f16 v111, v110, v111
v_fma_mix_f32 v225, v134, v134, v225 op_sel_hi:[1,1,0]
v_cvt_pkrtz_f16_f32 v101, v100, v101
s_waitcnt lgkmcnt(3)
v_fma_mix_f32 v225, v135, v135, v225 op_sel_hi:[1,1,0]
ds_read_u16 v98, v98
ds_read_u16 v99, v99
ds_read_b128 v[180:183], v250 offset:21504
v_and_b32 v101, s49, v101
v_bfe_u32 v100, v101, 2, 14
v_lshrrev_b32_e64 v101, 18, v101
v_exp_f16_sdwa v109, v109 dst_sel:WORD_0 dst_unused:UNUSED_PRESERVE src0_sel:WORD_0
v_mfma_f32_32x32x16_bf16 v[160:175], v[52:55], v[188:191], v[160:175]
ds_read_u16 v100, v100
ds_read_u16 v101, v101
v_fma_mix_f32 v225, v136, v136, v225 op_sel_hi:[1,1,0]
v_exp_f16_sdwa v111, v111 dst_sel:WORD_0 dst_unused:UNUSED_PRESERVE src0_sel:WORD_0
v_fma_mix_f32 v225, v137, v137, v225 op_sel_hi:[1,1,0]
v_cvt_pkrtz_f16_f32 v103, v102, v103
v_and_b32_e64 v103, s49, v103
v_bfe_u32 v102, v103, 2, 14
v_lshrrev_b32_e64 v103, 18, v103
v_exp_f16_sdwa v109, v109 dst_sel:WORD_1 dst_unused:UNUSED_PRESERVE src0_sel:WORD_1
v_fma_mix_f32 v225, v138, v138, v225 op_sel_hi:[1,1,0]
v_cvt_pkrtz_f16_f32 v105, v104, v105
v_fma_mix_f32 v225, v139, v139, v225 op_sel_hi:[1,1,0]
v_and_b32_e64 v105, s49, v105
v_bfe_u32 v104, v105, 2, 14
ds_read_u16 v102, v102
ds_read_u16 v103, v103
v_lshrrev_b32_e64 v105, 18, v105
v_mfma_f32_32x32x16_bf16 v[112:127], v[188:191], v[76:79], v[112:127]
ds_read_u16 v104, v104
ds_read_u16 v105, v105
v_exp_f16_sdwa v111, v111 dst_sel:WORD_1 dst_unused:UNUSED_PRESERVE src0_sel:WORD_1
v_cvt_pkrtz_f16_f32 v107, v106, v107
v_and_b32_e64 v107, s49, v107
v_bfe_u32 v106, v107, 2, 14
v_lshrrev_b32 v107, 18, v107
v_pk_add_f16 v109, v109, 1.0 op_sel_hi:[1,0]
v_pk_add_f16 v111, v111, 1.0 op_sel_hi:[1,0]
ds_read_b128 v[184:187], v250 offset:22528
ds_read_u16 v106, v106
ds_read_u16 v107, v107
v_rcp_f16_sdwa v109, v109 dst_sel:WORD_0 dst_unused:UNUSED_PRESERVE src0_sel:WORD_0
s_waitcnt lgkmcnt(9)
v_mfma_f32_32x32x16_bf16 v[160:175], v[56:59], v[176:179], v[160:175]
v_rcp_f16_sdwa v111, v111 dst_sel:WORD_0 dst_unused:UNUSED_PRESERVE src0_sel:WORD_0
v_rcp_f16_sdwa v109, v109 dst_sel:WORD_1 dst_unused:UNUSED_PRESERVE src0_sel:WORD_1
v_rcp_f16_sdwa v111, v111 dst_sel:WORD_1 dst_unused:UNUSED_PRESERVE src0_sel:WORD_1
v_mfma_f32_32x32x16_bf16 v[112:127], v[176:179], v[80:83], v[112:127]
ds_read_b128 v[188:191], v250 offset:23552
v_pk_mul_f16 v108, v108, v109
v_pk_mul_f16 v110, v110, v111
v_fma_mix_f32 v226, v108, v108, v226 op_sel_hi:[1,1,0]
v_cvt_pkrtz_f16_f32 v145, v144, v145
v_fma_mix_f32 v226, v110, v110, v226 op_sel_hi:[1,1,0]
v_mfma_f32_32x32x16_bf16 v[160:175], v[60:63], v[180:183], v[160:175]
v_fma_mix_f32 v226, v108, v108, v226 op_sel:[1,1,0] op_sel_hi:[1,1,0]
v_and_b32_e64 v145, s49, v145
v_fma_mix_f32 v226, v110, v110, v226 op_sel:[1,1,0] op_sel_hi:[1,1,0]
v_bfe_u32 v144, v145, 2, 14
v_fma_mix_f32 v226, v96, v96, v226 op_sel_hi:[1,1,0]
v_lshrrev_b32_e64 v145, 18, v145
v_fma_mix_f32 v226, v97, v97, v226 op_sel_hi:[1,1,0]
v_cvt_pk_f16_f32 v156, v156, v157
v_fma_mix_f32 v226, v98, v98, v226 op_sel_hi:[1,1,0]
v_cvt_pk_f16_f32 v158, v158, v159
v_fma_mix_f32 v226, v99, v99, v226 op_sel_hi:[1,1,0]
v_mfma_f32_32x32x16_bf16 v[112:127], v[180:183], v[84:87], v[112:127]
ds_read_u16 v144, v144
ds_read_u16_d16_hi v145, v145
v_pk_fma_f16 v157, v156, v156, s48
s_waitcnt lgkmcnt(5)
v_fma_mix_f32 v226, v100, v100, v226 op_sel_hi:[1,1,0]
v_cvt_pkrtz_f16_f32 v147, v146, v147
v_fma_mix_f32 v226, v101, v101, v226 op_sel_hi:[1,1,0]
v_and_b32 v147, s49, v147
v_bfe_u32 v146, v147, 2, 14
v_lshrrev_b32_e64 v147, 18, v147
v_pk_fma_f16 v159, v158, v158, s48
v_pk_mul_f16 v157, v156, v157
v_fma_mix_f32 v226, v102, v102, v226 op_sel_hi:[1,1,0]
v_cvt_pkrtz_f16_f32 v149, v148, v149
v_fma_mix_f32 v226, v103, v103, v226 op_sel_hi:[1,1,0]
v_and_b32_e64 v149, s49, v149
ds_read_u16 v146, v146
ds_read_u16_d16_hi v147, v147
ds_read_b128 v[176:179], v250 offset:24576
v_bfe_u32 v148, v149, 2, 14
v_lshrrev_b32_e64 v149, 18, v149
v_pk_mul_f16 v159, v158, v159
v_exp_f16_sdwa v157, v157 dst_sel:WORD_0 dst_unused:UNUSED_PRESERVE src0_sel:WORD_0
v_mfma_f32_32x32x16_bf16 v[160:175], v[64:67], v[184:187], v[160:175]
ds_read_u16 v148, v148
ds_read_u16_d16_hi v149, v149
v_fma_mix_f32 v226, v104, v104, v226 op_sel_hi:[1,1,0]
v_cvt_pkrtz_f16_f32 v151, v150, v151
v_fma_mix_f32 v226, v105, v105, v226 op_sel_hi:[1,1,0]
v_and_b32_e64 v151, s49, v151
v_bfe_u32 v150, v151, 2, 14
v_lshrrev_b32 v151, 18, v151
v_exp_f16_sdwa v159, v159 dst_sel:WORD_0 dst_unused:UNUSED_PRESERVE src0_sel:WORD_0
s_waitcnt lgkmcnt(6)
v_fma_mix_f32 v226, v106, v106, v226 op_sel_hi:[1,1,0]
v_cvt_pkrtz_f16_f32 v153, v152, v153
v_fma_mix_f32 v226, v107, v107, v226 op_sel_hi:[1,1,0]
v_and_b32_e64 v153, s49, v153
v_bfe_u32 v152, v153, 2, 14
ds_read_u16 v150, v150
ds_read_u16_d16_hi v151, v151
v_lshrrev_b32_e64 v153, 18, v153
v_exp_f16_sdwa v157, v157 dst_sel:WORD_1 dst_unused:UNUSED_PRESERVE src0_sel:WORD_1
v_mfma_f32_32x32x16_bf16 v[112:127], v[184:187], v[88:91], v[112:127]
ds_read_u16 v152, v152
ds_read_u16_d16_hi v153, v153
ds_read_b128 v[180:183], v250 offset:25600
v_cvt_pkrtz_f16_f32 v155, v154, v155
v_and_b32_e64 v155, s49, v155
v_bfe_u32 v154, v155, 2, 14
v_lshrrev_b32_e64 v155, 18, v155
v_exp_f16_sdwa v159, v159 dst_sel:WORD_1 dst_unused:UNUSED_PRESERVE src0_sel:WORD_1
v_pk_add_f16 v157, v157, 1.0 op_sel_hi:[1,0]
v_mfma_f32_32x32x16_bf16 v[160:175], v[68:71], v[188:191], v[160:175]
ds_read_u16 v154, v154
ds_read_u16_d16_hi v155, v155
v_pk_add_f16 v159, v159, 1.0 op_sel_hi:[1,0]
v_rcp_f16_sdwa v157, v157 dst_sel:WORD_0 dst_unused:UNUSED_PRESERVE src0_sel:WORD_0
v_rcp_f16_sdwa v159, v159 dst_sel:WORD_0 dst_unused:UNUSED_PRESERVE src0_sel:WORD_0
v_mfma_f32_32x32x16_bf16 v[112:127], v[188:191], v[92:95], v[112:127]
ds_read_b128 v[184:187], v250 offset:26624
v_rcp_f16_sdwa v157, v157 dst_sel:WORD_1 dst_unused:UNUSED_PRESERVE src0_sel:WORD_1
v_rcp_f16_sdwa v159, v159 dst_sel:WORD_1 dst_unused:UNUSED_PRESERVE src0_sel:WORD_1
s_waitcnt lgkmcnt(8)
v_or_b32 v0, v144, v145
v_mfma_f32_32x32x16_bf16 v[128:143], v[48:51], v[176:179], 0
v_pk_mul_f16 v6, v156, v157
v_pk_mul_f16 v7, v158, v159
v_or_b32_e64 v1, v146, v147
v_cvt_pkrtz_f16_f32 v161, v160, v161
v_and_b32_e64 v161, s49, v161
v_bfe_u32 v160, v161, 2, 14
v_lshrrev_b32_e64 v161, 18, v161
v_cvt_pk_f16_f32 v172, v172, v173
v_cvt_pk_f16_f32 v174, v174, v175
v_mfma_f32_32x32x16_bf16 v[96:111], v[176:179], v[72:75], 0
ds_read_u16 v160, v160
ds_read_u16 v161, v161
v_pk_fma_f16 v173, v172, v172, s48
v_or_b32_e64 v4, v148, v149
v_cvt_pkrtz_f16_f32 v163, v162, v163
v_and_b32_e64 v163, s49, v163
v_bfe_u32 v162, v163, 2, 14
v_lshrrev_b32_e64 v163, 18, v163
v_pk_fma_f16 v175, v174, v174, s48
v_pk_mul_f16 v173, v172, v173
v_pk_mul_f16 v175, v174, v175
s_waitcnt lgkmcnt(5)
v_or_b32 v5, v150, v151
v_cvt_pkrtz_f16_f32 v165, v164, v165
v_and_b32_e64 v165, s49, v165
ds_read_u16 v162, v162
ds_read_u16 v163, v163
ds_read_b128 v[188:191], v250 offset:27648
v_bfe_u32 v164, v165, 2, 14
v_lshrrev_b32_e64 v165, 18, v165
v_exp_f16_sdwa v173, v173 dst_sel:WORD_0 dst_unused:UNUSED_PRESERVE src0_sel:WORD_0
v_mfma_f32_32x32x16_bf16 v[128:143], v[52:55], v[180:183], v[128:143]
ds_read_u16 v164, v164
ds_read_u16 v165, v165
v_or_b32_e64 v2, v152, v153
v_exp_f16_sdwa v175, v175 dst_sel:WORD_0 dst_unused:UNUSED_PRESERVE src0_sel:WORD_0
v_cvt_pkrtz_f16_f32 v167, v166, v167
v_and_b32_e64 v167, s49, v167
v_bfe_u32 v166, v167, 2, 14
v_lshrrev_b32_e64 v167, 18, v167
v_exp_f16_sdwa v173, v173 dst_sel:WORD_1 dst_unused:UNUSED_PRESERVE src0_sel:WORD_1
s_waitcnt lgkmcnt(6)
v_or_b32 v3, v154, v155
v_cvt_pkrtz_f16_f32 v169, v168, v169
v_and_b32_e64 v169, s49, v169
v_bfe_u32 v168, v169, 2, 14
v_lshrrev_b32_e64 v169, 18, v169
ds_read_u16 v166, v166
ds_read_u16 v167, v167
ds_read_u16 v168, v168
ds_read_u16 v169, v169
v_mfma_f32_32x32x16_bf16 v[96:111], v[180:183], v[76:79], v[96:111]
v_exp_f16_sdwa v175, v175 dst_sel:WORD_1 dst_unused:UNUSED_PRESERVE src0_sel:WORD_1
v_cvt_pkrtz_f16_f32 v171, v170, v171
v_and_b32_e64 v171, s49, v171
v_bfe_u32 v170, v171, 2, 14
v_mfma_f32_32x32x16_f16 v[144:159], v[0:3], v[216:219], 0
ds_read_b128 v[176:179], v250 offset:28672
v_lshrrev_b32_e64 v171, 18, v171
v_pk_add_f16 v173, v173, 1.0 op_sel_hi:[1,0]
v_pk_add_f16 v175, v175, 1.0 op_sel_hi:[1,0]
v_rcp_f16_sdwa v173, v173 dst_sel:WORD_0 dst_unused:UNUSED_PRESERVE src0_sel:WORD_0
v_mfma_f32_32x32x16_f16 v[144:159], v[4:7], v[220:223], v[144:159]
ds_read_u16 v170, v170
ds_read_u16 v171, v171
v_permlane16_swap_b32 v0, v4
v_permlane16_swap_b32 v1, v5
v_permlane16_swap_b32 v2, v6
v_permlane16_swap_b32 v3, v7
v_mfma_f32_32x32x16_bf16 v[128:143], v[56:59], v[184:187], v[128:143]
v_rcp_f16_sdwa v175, v175 dst_sel:WORD_0 dst_unused:UNUSED_PRESERVE src0_sel:WORD_0
v_rcp_f16_sdwa v173, v173 dst_sel:WORD_1 dst_unused:UNUSED_PRESERVE src0_sel:WORD_1
v_rcp_f16_sdwa v175, v175 dst_sel:WORD_1 dst_unused:UNUSED_PRESERVE src0_sel:WORD_1
v_mfma_f32_32x32x16_bf16 v[96:111], v[184:187], v[80:83], v[96:111]
ds_read_b128 v[180:183], v250 offset:29696
v_fmac_f32_e64 v226, v144, v144
v_pk_mul_f16 v172, v172, v173
v_fmac_f32_e64 v226, v145, v145
v_pk_mul_f16 v174, v174, v175
v_fmac_f32 v226, v146, v146
v_fmac_f32 v226, v147, v147
v_fma_mix_f32 v227, v172, v172, v227 op_sel_hi:[1,1,0]
v_fmac_f32 v226, v148, v148
v_fmac_f32 v226, v149, v149
v_fma_mix_f32 v227, v174, v174, v227 op_sel_hi:[1,1,0]
s_waitcnt lgkmcnt(5)
v_mfma_f32_32x32x16_bf16 v[128:143], v[60:63], v[188:191], v[128:143]
v_fmac_f32 v226, v150, v150
v_fma_mix_f32 v227, v172, v172, v227 op_sel:[1,1,0] op_sel_hi:[1,1,0]
v_fmac_f32 v226, v151, v151
v_fmac_f32 v226, v152, v152
v_fma_mix_f32 v227, v174, v174, v227 op_sel:[1,1,0] op_sel_hi:[1,1,0]
v_fmac_f32_e64 v226, v153, v153
v_fma_mix_f32 v227, v160, v160, v227 op_sel_hi:[1,1,0]
v_fmac_f32_e64 v226, v154, v154
v_fma_mix_f32 v227, v161, v161, v227 op_sel_hi:[1,1,0]
v_cvt_pkrtz_f16_f32 v113, v112, v113
v_fma_mix_f32 v227, v162, v162, v227 op_sel_hi:[1,1,0]
v_and_b32_e64 v113, s49, v113
v_fma_mix_f32 v227, v163, v163, v227 op_sel_hi:[1,1,0]
v_bfe_u32 v112, v113, 2, 14
v_lshrrev_b32_e64 v113, 18, v113
v_cvt_pk_f16_f32 v124, v124, v125
v_fmac_f32_e64 v226, v155, v155
v_cvt_pk_f16_f32 v126, v126, v127
v_fmac_f32 v226, v156, v156
v_fmac_f32 v226, v157, v157
v_mfma_f32_32x32x16_bf16 v[96:111], v[188:191], v[84:87], v[96:111]
ds_read_u16 v112, v112
ds_read_u16_d16_hi v113, v113
v_pk_fma_f16 v125, v124, v124, s48
v_fmac_f32_e64 v226, v158, v158
v_fma_mix_f32 v227, v164, v164, v227 op_sel_hi:[1,1,0]
v_cvt_pkrtz_f16_f32 v115, v114, v115
v_fma_mix_f32 v227, v165, v165, v227 op_sel_hi:[1,1,0]
v_and_b32_e64 v115, s49, v115
v_bfe_u32 v114, v115, 2, 14
v_lshrrev_b32 v115, 18, v115
v_fmac_f32 v226, v159, v159
v_pk_fma_f16 v127, v126, v126, s48
v_pk_mul_f16 v125, v124, v125
v_fma_mix_f32 v227, v166, v166, v227 op_sel_hi:[1,1,0]
v_cvt_pkrtz_f16_f32 v117, v116, v117
v_fma_mix_f32 v227, v167, v167, v227 op_sel_hi:[1,1,0]
ds_read_u16 v114, v114
ds_read_u16_d16_hi v115, v115
ds_read_b128 v[184:187], v250 offset:30720
v_and_b32_e64 v117, s49, v117
v_bfe_u32 v116, v117, 2, 14
v_lshrrev_b32 v117, 18, v117
v_pk_mul_f16 v127, v126, v127
v_exp_f16_sdwa v125, v125 dst_sel:WORD_0 dst_unused:UNUSED_PRESERVE src0_sel:WORD_0
s_waitcnt lgkmcnt(5)
v_mfma_f32_32x32x16_bf16 v[128:143], v[64:67], v[176:179], v[128:143]
ds_read_u16 v116, v116
ds_read_u16_d16_hi v117, v117
v_fma_mix_f32 v227, v168, v168, v227 op_sel_hi:[1,1,0]
v_cvt_pkrtz_f16_f32 v119, v118, v119
v_fma_mix_f32 v227, v169, v169, v227 op_sel_hi:[1,1,0]
v_and_b32_e64 v119, s49, v119
v_bfe_u32 v118, v119, 2, 14
v_lshrrev_b32_e64 v119, 18, v119
v_exp_f16_sdwa v127, v127 dst_sel:WORD_0 dst_unused:UNUSED_PRESERVE src0_sel:WORD_0
v_fma_mix_f32 v227, v170, v170, v227 op_sel_hi:[1,1,0]
v_cvt_pkrtz_f16_f32 v121, v120, v121
v_fma_mix_f32 v227, v171, v171, v227 op_sel_hi:[1,1,0]
v_and_b32_e64 v121, s49, v121
v_bfe_u32 v120, v121, 2, 14
ds_read_u16 v118, v118
ds_read_u16_d16_hi v119, v119
v_lshrrev_b32_e64 v121, 18, v121
v_exp_f16_sdwa v125, v125 dst_sel:WORD_1 dst_unused:UNUSED_PRESERVE src0_sel:WORD_1
v_mfma_f32_32x32x16_bf16 v[96:111], v[176:179], v[88:91], v[96:111]
ds_read_u16 v120, v120
ds_read_u16_d16_hi v121, v121
ds_read_b128 v[188:191], v250 offset:31744
v_cvt_pkrtz_f16_f32 v123, v122, v123
v_and_b32_e64 v123, s49, v123
v_bfe_u32 v122, v123, 2, 14
v_lshrrev_b32_e64 v123, 18, v123
v_exp_f16_sdwa v127, v127 dst_sel:WORD_1 dst_unused:UNUSED_PRESERVE src0_sel:WORD_1
v_pk_add_f16 v125, v125, 1.0 op_sel_hi:[1,0]
v_mfma_f32_32x32x16_bf16 v[128:143], v[68:71], v[180:183], v[128:143]
ds_read_u16 v122, v122
ds_read_u16_d16_hi v123, v123
v_pk_add_f16 v127, v127, 1.0 op_sel_hi:[1,0]
v_rcp_f16_sdwa v125, v125 dst_sel:WORD_0 dst_unused:UNUSED_PRESERVE src0_sel:WORD_0
v_rcp_f16_sdwa v127, v127 dst_sel:WORD_0 dst_unused:UNUSED_PRESERVE src0_sel:WORD_0
v_mfma_f32_32x32x16_bf16 v[96:111], v[180:183], v[92:95], v[96:111]
ds_read_b128 v[176:179], v250 offset:32768
v_rcp_f16_sdwa v125, v125 dst_sel:WORD_1 dst_unused:UNUSED_PRESERVE src0_sel:WORD_1
v_rcp_f16_sdwa v127, v127 dst_sel:WORD_1 dst_unused:UNUSED_PRESERVE src0_sel:WORD_1
s_waitcnt lgkmcnt(7)
v_or_b32 v8, v112, v113
v_mfma_f32_32x32x16_bf16 v[144:159], v[48:51], v[184:187], 0
s_cmp_lg_u32 s40, 0
s_cbranch_scc1 Lpix
v_and_b32 v244, 0x3ff, v250
buffer_load_dword v245, v244, s[28:31], 0 offen
buffer_load_dword v245, v244, s[24:27], 0 offen
v_mov_b32_e64 v244, 0
Lpi:
buffer_load_dword v245, v244, s[36:39], 0 offen sc1
s_waitcnt vmcnt(0)
v_readfirstlane_b32 s43, v245
s_cmp_eq_u32 s76, 0
s_cbranch_scc1 Lpix
s_sub_u32 s76, s76, 1
s_cmp_lt_u32 s43, 256
s_cbranch_scc1 Lpi
Lpix:
v_pk_mul_f16 v14, v124, v125
v_pk_mul_f16 v15, v126, v127
v_or_b32_e64 v9, v114, v115
v_cvt_pkrtz_f16_f32 v129, v128, v129
v_and_b32_e64 v129, s49, v129
v_bfe_u32 v128, v129, 2, 14
v_lshrrev_b32_e64 v129, 18, v129
v_cvt_pk_f16_f32 v140, v140, v141
v_cvt_pk_f16_f32 v142, v142, v143
v_mfma_f32_32x32x16_bf16 v[160:175], v[184:187], v[72:75], 0
ds_read_u16 v128, v128
ds_read_u16 v129, v129
v_pk_fma_f16 v141, v140, v140, s48
v_or_b32_e64 v12, v116, v117
v_cvt_pkrtz_f16_f32 v131, v130, v131
v_and_b32_e64 v131, s49, v131
v_bfe_u32 v130, v131, 2, 14
v_lshrrev_b32_e64 v131, 18, v131
v_pk_fma_f16 v143, v142, v142, s48
v_pk_mul_f16 v141, v140, v141
v_pk_mul_f16 v143, v142, v143
s_waitcnt lgkmcnt(5)
v_or_b32 v13, v118, v119
v_cvt_pkrtz_f16_f32 v133, v132, v133
v_and_b32_e64 v133, s49, v133
ds_read_u16 v130, v130
ds_read_u16 v131, v131
ds_read_b128 v[180:183], v250 offset:33792
v_bfe_u32 v132, v133, 2, 14
v_lshrrev_b32_e64 v133, 18, v133
v_exp_f16_sdwa v141, v141 dst_sel:WORD_0 dst_unused:UNUSED_PRESERVE src0_sel:WORD_0
v_mfma_f32_32x32x16_bf16 v[144:159], v[52:55], v[188:191], v[144:159]
ds_read_u16 v132, v132
ds_read_u16 v133, v133
v_or_b32_e64 v10, v120, v121
v_exp_f16_sdwa v143, v143 dst_sel:WORD_0 dst_unused:UNUSED_PRESERVE src0_sel:WORD_0
v_cvt_pkrtz_f16_f32 v135, v134, v135
v_and_b32_e64 v135, s49, v135
v_bfe_u32 v134, v135, 2, 14
v_lshrrev_b32_e64 v135, 18, v135
v_exp_f16_sdwa v141, v141 dst_sel:WORD_1 dst_unused:UNUSED_PRESERVE src0_sel:WORD_1
s_waitcnt lgkmcnt(6)
v_or_b32 v11, v122, v123
v_cvt_pkrtz_f16_f32 v137, v136, v137
v_and_b32_e64 v137, s49, v137
v_bfe_u32 v136, v137, 2, 14
v_lshrrev_b32_e64 v137, 18, v137
ds_read_u16 v134, v134
ds_read_u16 v135, v135
ds_read_u16 v136, v136
ds_read_u16 v137, v137
v_mfma_f32_32x32x16_bf16 v[160:175], v[188:191], v[76:79], v[160:175]
v_exp_f16_sdwa v143, v143 dst_sel:WORD_1 dst_unused:UNUSED_PRESERVE src0_sel:WORD_1
v_cvt_pkrtz_f16_f32 v139, v138, v139
v_and_b32_e64 v139, s49, v139
v_bfe_u32 v138, v139, 2, 14
v_mfma_f32_32x32x16_f16 v[112:127], v[8:11], v[216:219], 0
ds_read_b128 v[184:187], v250 offset:34816
v_lshrrev_b32_e64 v139, 18, v139
v_pk_add_f16 v141, v141, 1.0 op_sel_hi:[1,0]
v_pk_add_f16 v143, v143, 1.0 op_sel_hi:[1,0]
v_rcp_f16_sdwa v141, v141 dst_sel:WORD_0 dst_unused:UNUSED_PRESERVE src0_sel:WORD_0
v_mfma_f32_32x32x16_f16 v[112:127], v[12:15], v[220:223], v[112:127]
ds_read_u16 v138, v138
ds_read_u16 v139, v139
v_permlane16_swap_b32 v8, v12
v_permlane16_swap_b32 v9, v13
v_permlane16_swap_b32 v10, v14
v_permlane16_swap_b32 v11, v15
v_mfma_f32_32x32x16_bf16 v[144:159], v[56:59], v[176:179], v[144:159]
v_rcp_f16_sdwa v143, v143 dst_sel:WORD_0 dst_unused:UNUSED_PRESERVE src0_sel:WORD_0
v_rcp_f16_sdwa v141, v141 dst_sel:WORD_1 dst_unused:UNUSED_PRESERVE src0_sel:WORD_1
v_rcp_f16_sdwa v143, v143 dst_sel:WORD_1 dst_unused:UNUSED_PRESERVE src0_sel:WORD_1
v_mfma_f32_32x32x16_bf16 v[160:175], v[176:179], v[80:83], v[160:175]
ds_read_b128 v[188:191], v250 offset:35840
v_fmac_f32_e64 v227, v112, v112
v_pk_mul_f16 v140, v140, v141
v_fmac_f32_e64 v227, v113, v113
v_pk_mul_f16 v142, v142, v143
v_fmac_f32 v227, v114, v114
v_fmac_f32 v227, v115, v115
v_fma_mix_f32 v228, v140, v140, v228 op_sel_hi:[1,1,0]
v_fmac_f32 v227, v116, v116
v_fmac_f32 v227, v117, v117
v_fma_mix_f32 v228, v142, v142, v228 op_sel_hi:[1,1,0]
s_waitcnt lgkmcnt(5)
v_mfma_f32_32x32x16_bf16 v[144:159], v[60:63], v[180:183], v[144:159]
v_fmac_f32 v227, v118, v118
v_fma_mix_f32 v228, v140, v140, v228 op_sel:[1,1,0] op_sel_hi:[1,1,0]
v_fmac_f32 v227, v119, v119
v_fmac_f32 v227, v120, v120
v_fma_mix_f32 v228, v142, v142, v228 op_sel:[1,1,0] op_sel_hi:[1,1,0]
v_fmac_f32_e64 v227, v121, v121
v_fma_mix_f32 v228, v128, v128, v228 op_sel_hi:[1,1,0]
v_fmac_f32_e64 v227, v122, v122
v_fma_mix_f32 v228, v129, v129, v228 op_sel_hi:[1,1,0]
v_cvt_pkrtz_f16_f32 v97, v96, v97
v_fma_mix_f32 v228, v130, v130, v228 op_sel_hi:[1,1,0]
v_and_b32_e64 v97, s49, v97
v_fma_mix_f32 v228, v131, v131, v228 op_sel_hi:[1,1,0]
v_bfe_u32 v96, v97, 2, 14
v_lshrrev_b32_e64 v97, 18, v97
v_cvt_pk_f16_f32 v108, v108, v109
v_fmac_f32_e64 v227, v123, v123
v_cvt_pk_f16_f32 v110, v110, v111
v_fmac_f32 v227, v124, v124
v_fmac_f32 v227, v125, v125
v_mfma_f32_32x32x16_bf16 v[160:175], v[180:183], v[84:87], v[160:175]
ds_read_u16 v96, v96
ds_read_u16_d16_hi v97, v97
v_pk_fma_f16 v109, v108, v108, s48
v_fmac_f32_e64 v227, v126, v126
v_fma_mix_f32 v228, v132, v132, v228 op_sel_hi:[1,1,0]
v_cvt_pkrtz_f16_f32 v99, v98, v99
v_fma_mix_f32 v228, v133, v133, v228 op_sel_hi:[1,1,0]
v_and_b32_e64 v99, s49, v99
v_bfe_u32 v98, v99, 2, 14
v_lshrrev_b32 v99, 18, v99
v_fmac_f32 v227, v127, v127
v_pk_fma_f16 v111, v110, v110, s48
v_pk_mul_f16 v109, v108, v109
v_fma_mix_f32 v228, v134, v134, v228 op_sel_hi:[1,1,0]
v_cvt_pkrtz_f16_f32 v101, v100, v101
v_fma_mix_f32 v228, v135, v135, v228 op_sel_hi:[1,1,0]
ds_read_u16 v98, v98
ds_read_u16_d16_hi v99, v99
ds_read_b128 v[176:179], v250 offset:36864
v_and_b32_e64 v101, s49, v101
v_bfe_u32 v100, v101, 2, 14
v_lshrrev_b32 v101, 18, v101
v_pk_mul_f16 v111, v110, v111
v_exp_f16_sdwa v109, v109 dst_sel:WORD_0 dst_unused:UNUSED_PRESERVE src0_sel:WORD_0
s_waitcnt lgkmcnt(5)
v_mfma_f32_32x32x16_bf16 v[144:159], v[64:67], v[184:187], v[144:159]
ds_read_u16 v100, v100
ds_read_u16_d16_hi v101, v101
v_fma_mix_f32 v228, v136, v136, v228 op_sel_hi:[1,1,0]
v_cvt_pkrtz_f16_f32 v103, v102, v103
v_fma_mix_f32 v228, v137, v137, v228 op_sel_hi:[1,1,0]
v_and_b32_e64 v103, s49, v103
v_bfe_u32 v102, v103, 2, 14
v_lshrrev_b32_e64 v103, 18, v103
v_exp_f16_sdwa v111, v111 dst_sel:WORD_0 dst_unused:UNUSED_PRESERVE src0_sel:WORD_0
v_fma_mix_f32 v228, v138, v138, v228 op_sel_hi:[1,1,0]
v_cvt_pkrtz_f16_f32 v105, v104, v105
v_fma_mix_f32 v228, v139, v139, v228 op_sel_hi:[1,1,0]
v_and_b32_e64 v105, s49, v105
v_bfe_u32 v104, v105, 2, 14
ds_read_u16 v102, v102
ds_read_u16_d16_hi v103, v103
v_lshrrev_b32_e64 v105, 18, v105
v_exp_f16_sdwa v109, v109 dst_sel:WORD_1 dst_unused:UNUSED_PRESERVE src0_sel:WORD_1
v_mfma_f32_32x32x16_bf16 v[160:175], v[184:187], v[88:91], v[160:175]
ds_read_u16 v104, v104
ds_read_u16_d16_hi v105, v105
ds_read_b128 v[180:183], v250 offset:37888
v_cvt_pkrtz_f16_f32 v107, v106, v107
v_and_b32_e64 v107, s49, v107
v_bfe_u32 v106, v107, 2, 14
v_lshrrev_b32_e64 v107, 18, v107
v_exp_f16_sdwa v111, v111 dst_sel:WORD_1 dst_unused:UNUSED_PRESERVE src0_sel:WORD_1
v_pk_add_f16 v109, v109, 1.0 op_sel_hi:[1,0]
v_mfma_f32_32x32x16_bf16 v[144:159], v[68:71], v[188:191], v[144:159]
ds_read_u16 v106, v106
ds_read_u16_d16_hi v107, v107
v_pk_add_f16 v111, v111, 1.0 op_sel_hi:[1,0]
v_rcp_f16_sdwa v109, v109 dst_sel:WORD_0 dst_unused:UNUSED_PRESERVE src0_sel:WORD_0
v_rcp_f16_sdwa v111, v111 dst_sel:WORD_0 dst_unused:UNUSED_PRESERVE src0_sel:WORD_0
v_mfma_f32_32x32x16_bf16 v[160:175], v[188:191], v[92:95], v[160:175]
ds_read_b128 v[184:187], v250 offset:38912
v_rcp_f16_sdwa v109, v109 dst_sel:WORD_1 dst_unused:UNUSED_PRESERVE src0_sel:WORD_1
v_rcp_f16_sdwa v111, v111 dst_sel:WORD_1 dst_unused:UNUSED_PRESERVE src0_sel:WORD_1
s_waitcnt lgkmcnt(7)
v_or_b32 v16, v96, v97
v_mfma_f32_32x32x16_bf16 v[112:127], v[48:51], v[176:179], 0
v_pk_mul_f16 v22, v108, v109
v_pk_mul_f16 v23, v110, v111
v_or_b32_e64 v17, v98, v99
v_cvt_pkrtz_f16_f32 v145, v144, v145
v_and_b32_e64 v145, s49, v145
v_bfe_u32 v144, v145, 2, 14
v_lshrrev_b32_e64 v145, 18, v145
v_cvt_pk_f16_f32 v156, v156, v157
v_cvt_pk_f16_f32 v158, v158, v159
v_mfma_f32_32x32x16_bf16 v[128:143], v[176:179], v[72:75], 0
ds_read_u16 v144, v144
ds_read_u16 v145, v145
v_pk_fma_f16 v157, v156, v156, s48
v_or_b32_e64 v20, v100, v101
v_cvt_pkrtz_f16_f32 v147, v146, v147
v_and_b32_e64 v147, s49, v147
v_bfe_u32 v146, v147, 2, 14
v_lshrrev_b32_e64 v147, 18, v147
v_pk_fma_f16 v159, v158, v158, s48
v_pk_mul_f16 v157, v156, v157
v_pk_mul_f16 v159, v158, v159
s_waitcnt lgkmcnt(5)
v_or_b32 v21, v102, v103
v_cvt_pkrtz_f16_f32 v149, v148, v149
v_and_b32_e64 v149, s49, v149
ds_read_u16 v146, v146
ds_read_u16 v147, v147
ds_read_b128 v[188:191], v250 offset:39936
v_bfe_u32 v148, v149, 2, 14
v_lshrrev_b32_e64 v149, 18, v149
v_exp_f16_sdwa v157, v157 dst_sel:WORD_0 dst_unused:UNUSED_PRESERVE src0_sel:WORD_0
v_mfma_f32_32x32x16_bf16 v[112:127], v[52:55], v[180:183], v[112:127]
ds_read_u16 v148, v148
ds_read_u16 v149, v149
v_or_b32_e64 v18, v104, v105
v_exp_f16_sdwa v159, v159 dst_sel:WORD_0 dst_unused:UNUSED_PRESERVE src0_sel:WORD_0
v_cvt_pkrtz_f16_f32 v151, v150, v151
v_and_b32_e64 v151, s49, v151
v_bfe_u32 v150, v151, 2, 14
v_lshrrev_b32_e64 v151, 18, v151
v_exp_f16_sdwa v157, v157 dst_sel:WORD_1 dst_unused:UNUSED_PRESERVE src0_sel:WORD_1
s_waitcnt lgkmcnt(6)
v_or_b32 v19, v106, v107
v_cvt_pkrtz_f16_f32 v153, v152, v153
v_and_b32_e64 v153, s49, v153
v_bfe_u32 v152, v153, 2, 14
v_lshrrev_b32_e64 v153, 18, v153
ds_read_u16 v150, v150
ds_read_u16 v151, v151
ds_read_u16 v152, v152
ds_read_u16 v153, v153
v_mfma_f32_32x32x16_bf16 v[128:143], v[180:183], v[76:79], v[128:143]
v_exp_f16_sdwa v159, v159 dst_sel:WORD_1 dst_unused:UNUSED_PRESERVE src0_sel:WORD_1
v_cvt_pkrtz_f16_f32 v155, v154, v155
v_and_b32_e64 v155, s49, v155
v_bfe_u32 v154, v155, 2, 14
v_mfma_f32_32x32x16_f16 v[96:111], v[16:19], v[216:219], 0
ds_read_b128 v[176:179], v250 offset:40960
v_lshrrev_b32_e64 v155, 18, v155
v_pk_add_f16 v157, v157, 1.0 op_sel_hi:[1,0]
v_pk_add_f16 v159, v159, 1.0 op_sel_hi:[1,0]
v_rcp_f16_sdwa v157, v157 dst_sel:WORD_0 dst_unused:UNUSED_PRESERVE src0_sel:WORD_0
v_mfma_f32_32x32x16_f16 v[96:111], v[20:23], v[220:223], v[96:111]
ds_read_u16 v154, v154
ds_read_u16 v155, v155
v_permlane16_swap_b32 v16, v20
v_permlane16_swap_b32 v17, v21
v_permlane16_swap_b32 v18, v22
v_permlane16_swap_b32 v19, v23
v_mfma_f32_32x32x16_bf16 v[112:127], v[56:59], v[184:187], v[112:127]
v_rcp_f16_sdwa v159, v159 dst_sel:WORD_0 dst_unused:UNUSED_PRESERVE src0_sel:WORD_0
v_rcp_f16_sdwa v157, v157 dst_sel:WORD_1 dst_unused:UNUSED_PRESERVE src0_sel:WORD_1
v_rcp_f16_sdwa v159, v159 dst_sel:WORD_1 dst_unused:UNUSED_PRESERVE src0_sel:WORD_1
v_mfma_f32_32x32x16_bf16 v[128:143], v[184:187], v[80:83], v[128:143]
ds_read_b128 v[180:183], v250 offset:41984
v_fmac_f32_e64 v228, v96, v96
v_pk_mul_f16 v156, v156, v157
v_fmac_f32_e64 v228, v97, v97
v_pk_mul_f16 v158, v158, v159
v_fmac_f32 v228, v98, v98
v_fmac_f32 v228, v99, v99
v_fma_mix_f32 v229, v156, v156, v229 op_sel_hi:[1,1,0]
v_fmac_f32 v228, v100, v100
v_fmac_f32 v228, v101, v101
v_fma_mix_f32 v229, v158, v158, v229 op_sel_hi:[1,1,0]
s_waitcnt lgkmcnt(5)
v_mfma_f32_32x32x16_bf16 v[112:127], v[60:63], v[188:191], v[112:127]
v_fmac_f32 v228, v102, v102
v_fma_mix_f32 v229, v156, v156, v229 op_sel:[1,1,0] op_sel_hi:[1,1,0]
v_fmac_f32 v228, v103, v103
v_fmac_f32 v228, v104, v104
v_fma_mix_f32 v229, v158, v158, v229 op_sel:[1,1,0] op_sel_hi:[1,1,0]
v_fmac_f32_e64 v228, v105, v105
v_fma_mix_f32 v229, v144, v144, v229 op_sel_hi:[1,1,0]
v_fmac_f32_e64 v228, v106, v106
v_fma_mix_f32 v229, v145, v145, v229 op_sel_hi:[1,1,0]
v_cvt_pkrtz_f16_f32 v161, v160, v161
v_fma_mix_f32 v229, v146, v146, v229 op_sel_hi:[1,1,0]
v_and_b32_e64 v161, s49, v161
v_fma_mix_f32 v229, v147, v147, v229 op_sel_hi:[1,1,0]
v_bfe_u32 v160, v161, 2, 14
v_lshrrev_b32_e64 v161, 18, v161
v_cvt_pk_f16_f32 v172, v172, v173
v_fmac_f32_e64 v228, v107, v107
v_cvt_pk_f16_f32 v174, v174, v175
v_fmac_f32 v228, v108, v108
v_fmac_f32 v228, v109, v109
v_mfma_f32_32x32x16_bf16 v[128:143], v[188:191], v[84:87], v[128:143]
ds_read_u16 v160, v160
ds_read_u16_d16_hi v161, v161
v_pk_fma_f16 v173, v172, v172, s48
v_fmac_f32_e64 v228, v110, v110
v_fma_mix_f32 v229, v148, v148, v229 op_sel_hi:[1,1,0]
v_cvt_pkrtz_f16_f32 v163, v162, v163
v_fma_mix_f32 v229, v149, v149, v229 op_sel_hi:[1,1,0]
v_and_b32_e64 v163, s49, v163
v_bfe_u32 v162, v163, 2, 14
v_lshrrev_b32 v163, 18, v163
v_fmac_f32 v228, v111, v111
v_pk_fma_f16 v175, v174, v174, s48
v_pk_mul_f16 v173, v172, v173
v_fma_mix_f32 v229, v150, v150, v229 op_sel_hi:[1,1,0]
v_cvt_pkrtz_f16_f32 v165, v164, v165
v_fma_mix_f32 v229, v151, v151, v229 op_sel_hi:[1,1,0]
ds_read_u16 v162, v162
ds_read_u16_d16_hi v163, v163
ds_read_b128 v[184:187], v250 offset:43008
v_and_b32_e64 v165, s49, v165
v_bfe_u32 v164, v165, 2, 14
v_lshrrev_b32 v165, 18, v165
v_pk_mul_f16 v175, v174, v175
v_exp_f16_sdwa v173, v173 dst_sel:WORD_0 dst_unused:UNUSED_PRESERVE src0_sel:WORD_0
s_waitcnt lgkmcnt(5)
v_mfma_f32_32x32x16_bf16 v[112:127], v[64:67], v[176:179], v[112:127]
ds_read_u16 v164, v164
ds_read_u16_d16_hi v165, v165
v_fma_mix_f32 v229, v152, v152, v229 op_sel_hi:[1,1,0]
v_cvt_pkrtz_f16_f32 v167, v166, v167
v_fma_mix_f32 v229, v153, v153, v229 op_sel_hi:[1,1,0]
v_and_b32_e64 v167, s49, v167
v_bfe_u32 v166, v167, 2, 14
v_lshrrev_b32_e64 v167, 18, v167
v_exp_f16_sdwa v175, v175 dst_sel:WORD_0 dst_unused:UNUSED_PRESERVE src0_sel:WORD_0
v_fma_mix_f32 v229, v154, v154, v229 op_sel_hi:[1,1,0]
v_cvt_pkrtz_f16_f32 v169, v168, v169
v_fma_mix_f32 v229, v155, v155, v229 op_sel_hi:[1,1,0]
v_and_b32_e64 v169, s49, v169
v_bfe_u32 v168, v169, 2, 14
ds_read_u16 v166, v166
ds_read_u16_d16_hi v167, v167
v_lshrrev_b32_e64 v169, 18, v169
v_exp_f16_sdwa v173, v173 dst_sel:WORD_1 dst_unused:UNUSED_PRESERVE src0_sel:WORD_1
v_mfma_f32_32x32x16_bf16 v[128:143], v[176:179], v[88:91], v[128:143]
ds_read_u16 v168, v168
ds_read_u16_d16_hi v169, v169
ds_read_b128 v[188:191], v250 offset:44032
v_cvt_pkrtz_f16_f32 v171, v170, v171
v_and_b32_e64 v171, s49, v171
v_bfe_u32 v170, v171, 2, 14
v_lshrrev_b32_e64 v171, 18, v171
v_exp_f16_sdwa v175, v175 dst_sel:WORD_1 dst_unused:UNUSED_PRESERVE src0_sel:WORD_1
v_pk_add_f16 v173, v173, 1.0 op_sel_hi:[1,0]
v_mfma_f32_32x32x16_bf16 v[112:127], v[68:71], v[180:183], v[112:127]
ds_read_u16 v170, v170
ds_read_u16_d16_hi v171, v171
v_pk_add_f16 v175, v175, 1.0 op_sel_hi:[1,0]
v_rcp_f16_sdwa v173, v173 dst_sel:WORD_0 dst_unused:UNUSED_PRESERVE src0_sel:WORD_0
v_rcp_f16_sdwa v175, v175 dst_sel:WORD_0 dst_unused:UNUSED_PRESERVE src0_sel:WORD_0
v_mfma_f32_32x32x16_bf16 v[128:143], v[180:183], v[92:95], v[128:143]
ds_read_b128 v[176:179], v250 offset:45056
v_rcp_f16_sdwa v173, v173 dst_sel:WORD_1 dst_unused:UNUSED_PRESERVE src0_sel:WORD_1
v_rcp_f16_sdwa v175, v175 dst_sel:WORD_1 dst_unused:UNUSED_PRESERVE src0_sel:WORD_1
s_waitcnt lgkmcnt(7)
v_or_b32 v192, v160, v161
v_mfma_f32_32x32x16_bf16 v[96:111], v[48:51], v[184:187], 0
v_pk_mul_f16 v198, v172, v173
v_pk_mul_f16 v199, v174, v175
v_or_b32_e64 v193, v162, v163
v_cvt_pkrtz_f16_f32 v113, v112, v113
v_and_b32_e64 v113, s49, v113
v_bfe_u32 v112, v113, 2, 14
v_lshrrev_b32_e64 v113, 18, v113
v_cvt_pk_f16_f32 v124, v124, v125
v_cvt_pk_f16_f32 v126, v126, v127
v_mfma_f32_32x32x16_bf16 v[144:159], v[184:187], v[72:75], 0
ds_read_u16 v112, v112
ds_read_u16 v113, v113
v_pk_fma_f16 v125, v124, v124, s48
v_or_b32_e64 v196, v164, v165
v_cvt_pkrtz_f16_f32 v115, v114, v115
v_and_b32_e64 v115, s49, v115
v_bfe_u32 v114, v115, 2, 14
v_lshrrev_b32_e64 v115, 18, v115
v_pk_fma_f16 v127, v126, v126, s48
v_pk_mul_f16 v125, v124, v125
v_pk_mul_f16 v127, v126, v127
s_waitcnt lgkmcnt(5)
v_or_b32 v197, v166, v167
v_cvt_pkrtz_f16_f32 v117, v116, v117
v_and_b32_e64 v117, s49, v117
ds_read_u16 v114, v114
ds_read_u16 v115, v115
ds_read_b128 v[180:183], v250 offset:46080
v_bfe_u32 v116, v117, 2, 14
v_lshrrev_b32_e64 v117, 18, v117
v_exp_f16_sdwa v125, v125 dst_sel:WORD_0 dst_unused:UNUSED_PRESERVE src0_sel:WORD_0
v_mfma_f32_32x32x16_bf16 v[96:111], v[52:55], v[188:191], v[96:111]
ds_read_u16 v116, v116
ds_read_u16 v117, v117
v_or_b32_e64 v194, v168, v169
v_exp_f16_sdwa v127, v127 dst_sel:WORD_0 dst_unused:UNUSED_PRESERVE src0_sel:WORD_0
v_cvt_pkrtz_f16_f32 v119, v118, v119
v_and_b32_e64 v119, s49, v119
v_bfe_u32 v118, v119, 2, 14
v_lshrrev_b32_e64 v119, 18, v119
v_exp_f16_sdwa v125, v125 dst_sel:WORD_1 dst_unused:UNUSED_PRESERVE src0_sel:WORD_1
s_waitcnt lgkmcnt(6)
v_or_b32 v195, v170, v171
v_cvt_pkrtz_f16_f32 v121, v120, v121
v_and_b32_e64 v121, s49, v121
v_bfe_u32 v120, v121, 2, 14
v_lshrrev_b32_e64 v121, 18, v121
ds_read_u16 v118, v118
ds_read_u16 v119, v119
ds_read_u16 v120, v120
ds_read_u16 v121, v121
v_mfma_f32_32x32x16_bf16 v[144:159], v[188:191], v[76:79], v[144:159]
v_exp_f16_sdwa v127, v127 dst_sel:WORD_1 dst_unused:UNUSED_PRESERVE src0_sel:WORD_1
v_cvt_pkrtz_f16_f32 v123, v122, v123
v_and_b32_e64 v123, s49, v123
v_bfe_u32 v122, v123, 2, 14
v_mfma_f32_32x32x16_f16 v[160:175], v[192:195], v[216:219], 0
ds_read_b128 v[184:187], v250 offset:47104
v_lshrrev_b32_e64 v123, 18, v123
v_pk_add_f16 v125, v125, 1.0 op_sel_hi:[1,0]
v_pk_add_f16 v127, v127, 1.0 op_sel_hi:[1,0]
v_rcp_f16_sdwa v125, v125 dst_sel:WORD_0 dst_unused:UNUSED_PRESERVE src0_sel:WORD_0
v_mfma_f32_32x32x16_f16 v[160:175], v[196:199], v[220:223], v[160:175]
ds_read_u16 v122, v122
ds_read_u16 v123, v123
v_permlane16_swap_b32 v192, v196
v_permlane16_swap_b32 v193, v197
v_permlane16_swap_b32 v194, v198
v_permlane16_swap_b32 v195, v199
v_mfma_f32_32x32x16_bf16 v[96:111], v[56:59], v[176:179], v[96:111]
v_rcp_f16_sdwa v127, v127 dst_sel:WORD_0 dst_unused:UNUSED_PRESERVE src0_sel:WORD_0
v_rcp_f16_sdwa v125, v125 dst_sel:WORD_1 dst_unused:UNUSED_PRESERVE src0_sel:WORD_1
v_rcp_f16_sdwa v127, v127 dst_sel:WORD_1 dst_unused:UNUSED_PRESERVE src0_sel:WORD_1
v_mfma_f32_32x32x16_bf16 v[144:159], v[176:179], v[80:83], v[144:159]
ds_read_b128 v[188:191], v250 offset:48128
v_fmac_f32_e64 v229, v160, v160
v_pk_mul_f16 v124, v124, v125
v_fmac_f32_e64 v229, v161, v161
v_pk_mul_f16 v126, v126, v127
v_fmac_f32 v229, v162, v162
v_fmac_f32 v229, v163, v163
v_fma_mix_f32 v230, v124, v124, v230 op_sel_hi:[1,1,0]
v_fmac_f32 v229, v164, v164
v_fmac_f32 v229, v165, v165
v_fma_mix_f32 v230, v126, v126, v230 op_sel_hi:[1,1,0]
s_waitcnt lgkmcnt(5)
v_mfma_f32_32x32x16_bf16 v[96:111], v[60:63], v[180:183], v[96:111]
v_fmac_f32 v229, v166, v166
v_fma_mix_f32 v230, v124, v124, v230 op_sel:[1,1,0] op_sel_hi:[1,1,0]
v_fmac_f32 v229, v167, v167
v_fmac_f32 v229, v168, v168
v_fma_mix_f32 v230, v126, v126, v230 op_sel:[1,1,0] op_sel_hi:[1,1,0]
v_fmac_f32_e64 v229, v169, v169
v_fma_mix_f32 v230, v112, v112, v230 op_sel_hi:[1,1,0]
v_fmac_f32_e64 v229, v170, v170
v_fma_mix_f32 v230, v113, v113, v230 op_sel_hi:[1,1,0]
v_cvt_pkrtz_f16_f32 v129, v128, v129
v_fma_mix_f32 v230, v114, v114, v230 op_sel_hi:[1,1,0]
v_and_b32_e64 v129, s49, v129
v_fma_mix_f32 v230, v115, v115, v230 op_sel_hi:[1,1,0]
v_bfe_u32 v128, v129, 2, 14
v_lshrrev_b32_e64 v129, 18, v129
v_cvt_pk_f16_f32 v140, v140, v141
v_fmac_f32_e64 v229, v171, v171
v_cvt_pk_f16_f32 v142, v142, v143
v_fmac_f32 v229, v172, v172
v_fmac_f32 v229, v173, v173
v_mfma_f32_32x32x16_bf16 v[144:159], v[180:183], v[84:87], v[144:159]
ds_read_u16 v128, v128
ds_read_u16_d16_hi v129, v129
v_pk_fma_f16 v141, v140, v140, s48
v_fmac_f32_e64 v229, v174, v174
v_fma_mix_f32 v230, v116, v116, v230 op_sel_hi:[1,1,0]
v_cvt_pkrtz_f16_f32 v131, v130, v131
v_fma_mix_f32 v230, v117, v117, v230 op_sel_hi:[1,1,0]
v_and_b32_e64 v131, s49, v131
v_bfe_u32 v130, v131, 2, 14
v_lshrrev_b32 v131, 18, v131
v_fmac_f32 v229, v175, v175
v_pk_fma_f16 v143, v142, v142, s48
v_pk_mul_f16 v141, v140, v141
v_fma_mix_f32 v230, v118, v118, v230 op_sel_hi:[1,1,0]
v_cvt_pkrtz_f16_f32 v133, v132, v133
v_fma_mix_f32 v230, v119, v119, v230 op_sel_hi:[1,1,0]
ds_read_u16 v130, v130
ds_read_u16_d16_hi v131, v131
ds_read_b128 v[176:179], v250 offset:49152
v_and_b32_e64 v133, s49, v133
v_bfe_u32 v132, v133, 2, 14
v_lshrrev_b32 v133, 18, v133
v_pk_mul_f16 v143, v142, v143
v_exp_f16_sdwa v141, v141 dst_sel:WORD_0 dst_unused:UNUSED_PRESERVE src0_sel:WORD_0
s_waitcnt lgkmcnt(5)
v_mfma_f32_32x32x16_bf16 v[96:111], v[64:67], v[184:187], v[96:111]
ds_read_u16 v132, v132
ds_read_u16_d16_hi v133, v133
v_fma_mix_f32 v230, v120, v120, v230 op_sel_hi:[1,1,0]
v_cvt_pkrtz_f16_f32 v135, v134, v135
v_fma_mix_f32 v230, v121, v121, v230 op_sel_hi:[1,1,0]
v_and_b32_e64 v135, s49, v135
v_bfe_u32 v134, v135, 2, 14
v_lshrrev_b32_e64 v135, 18, v135
v_exp_f16_sdwa v143, v143 dst_sel:WORD_0 dst_unused:UNUSED_PRESERVE src0_sel:WORD_0
v_fma_mix_f32 v230, v122, v122, v230 op_sel_hi:[1,1,0]
v_cvt_pkrtz_f16_f32 v137, v136, v137
v_fma_mix_f32 v230, v123, v123, v230 op_sel_hi:[1,1,0]
v_and_b32_e64 v137, s49, v137
v_bfe_u32 v136, v137, 2, 14
ds_read_u16 v134, v134
ds_read_u16_d16_hi v135, v135
v_lshrrev_b32_e64 v137, 18, v137
v_exp_f16_sdwa v141, v141 dst_sel:WORD_1 dst_unused:UNUSED_PRESERVE src0_sel:WORD_1
v_mfma_f32_32x32x16_bf16 v[144:159], v[184:187], v[88:91], v[144:159]
ds_read_u16 v136, v136
ds_read_u16_d16_hi v137, v137
ds_read_b128 v[180:183], v250 offset:50176
v_cvt_pkrtz_f16_f32 v139, v138, v139
v_and_b32_e64 v139, s49, v139
v_bfe_u32 v138, v139, 2, 14
v_lshrrev_b32_e64 v139, 18, v139
v_exp_f16_sdwa v143, v143 dst_sel:WORD_1 dst_unused:UNUSED_PRESERVE src0_sel:WORD_1
v_pk_add_f16 v141, v141, 1.0 op_sel_hi:[1,0]
v_mfma_f32_32x32x16_bf16 v[96:111], v[68:71], v[188:191], v[96:111]
ds_read_u16 v138, v138
ds_read_u16_d16_hi v139, v139
v_pk_add_f16 v143, v143, 1.0 op_sel_hi:[1,0]
v_rcp_f16_sdwa v141, v141 dst_sel:WORD_0 dst_unused:UNUSED_PRESERVE src0_sel:WORD_0
v_rcp_f16_sdwa v143, v143 dst_sel:WORD_0 dst_unused:UNUSED_PRESERVE src0_sel:WORD_0
v_mfma_f32_32x32x16_bf16 v[144:159], v[188:191], v[92:95], v[144:159]
ds_read_b128 v[184:187], v250 offset:51200
v_rcp_f16_sdwa v141, v141 dst_sel:WORD_1 dst_unused:UNUSED_PRESERVE src0_sel:WORD_1
v_rcp_f16_sdwa v143, v143 dst_sel:WORD_1 dst_unused:UNUSED_PRESERVE src0_sel:WORD_1
s_waitcnt lgkmcnt(7)
v_or_b32 v200, v128, v129
v_mfma_f32_32x32x16_bf16 v[160:175], v[48:51], v[176:179], 0
v_mov_b32 v239, 0
s_branch Law5
Lax5:
s_sleep 2
Law5:
ds_read_b32 v239, v247 offset:28
s_sub_u32 s76, s76, 1
s_cselect_b32 s44, 4, 0
s_cselect_b32 s76, 0, s76
s_waitcnt lgkmcnt(0)
v_readfirstlane_b32 s43, v239
s_nop 1
s_max_u32 s43, s43, s44
s_cmp_lt_u32 s43, 4
s_cbranch_scc1 Lax5
v_bfe_u32 v237, v250, 4, 6
v_lshrrev_b32_e64 v246, 2, v237
v_mul_u32_u24 v246, 192, v246
v_and_b32_e64 v237, 3, v237
v_lshl_add_u32 v246, v237, 4, v246
v_permlane32_swap_b32 v224, v225
v_add_f32 v224, v224, v225
v_permlane32_swap_b32 v226, v227
v_add_f32 v226, v226, v227
v_permlane32_swap_b32 v228, v229
v_add_f32 v228, v228, v229
v_pk_mul_f16 v206, v140, v141
v_pk_mul_f16 v207, v142, v143
ds_write_b32 v248, v224 offset:5120
ds_write_b32 v248, v226 offset:5376
ds_write_b32 v248, v228 offset:5632
v_or_b32_e64 v201, v130, v131
v_cvt_pkrtz_f16_f32 v97, v96, v97
v_and_b32_e64 v97, s49, v97
v_bfe_u32 v96, v97, 2, 14
v_lshrrev_b32_e64 v97, 18, v97
v_cvt_pk_f16_f32 v108, v108, v109
v_cvt_pk_f16_f32 v110, v110, v111
v_mfma_f32_32x32x16_bf16 v[112:127], v[176:179], v[72:75], 0
ds_read_u16 v96, v96
ds_read_u16 v97, v97
v_pk_fma_f16 v109, v108, v108, s48
v_or_b32_e64 v204, v132, v133
v_cvt_pkrtz_f16_f32 v99, v98, v99
v_and_b32_e64 v99, s49, v99
v_bfe_u32 v98, v99, 2, 14
v_lshrrev_b32_e64 v99, 18, v99
v_pk_fma_f16 v111, v110, v110, s48
v_pk_mul_f16 v109, v108, v109
v_pk_mul_f16 v111, v110, v111
v_or_b32_e64 v205, v134, v135
v_cvt_pkrtz_f16_f32 v101, v100, v101
v_and_b32_e64 v101, s49, v101
ds_read_u16 v98, v98
ds_read_u16 v99, v99
ds_read_b128 v[188:191], v250 offset:52224
v_bfe_u32 v100, v101, 2, 14
v_lshrrev_b32_e64 v101, 18, v101
v_exp_f16_sdwa v109, v109 dst_sel:WORD_0 dst_unused:UNUSED_PRESERVE src0_sel:WORD_0
v_mfma_f32_32x32x16_bf16 v[160:175], v[52:55], v[180:183], v[160:175]
ds_read_u16 v100, v100
ds_read_u16 v101, v101
s_add_u32 m0, s72, 0
s_add_u32 s43, s82, 0
buffer_load_dwordx4 v246, s[16:19], s43 offen lds
v_or_b32_e64 v202, v136, v137
v_exp_f16_sdwa v111, v111 dst_sel:WORD_0 dst_unused:UNUSED_PRESERVE src0_sel:WORD_0
v_cvt_pkrtz_f16_f32 v103, v102, v103
v_and_b32_e64 v103, s49, v103
v_bfe_u32 v102, v103, 2, 14
v_lshrrev_b32_e64 v103, 18, v103
v_exp_f16_sdwa v109, v109 dst_sel:WORD_1 dst_unused:UNUSED_PRESERVE src0_sel:WORD_1
v_or_b32_e64 v203, v138, v139
v_cvt_pkrtz_f16_f32 v105, v104, v105
v_and_b32_e64 v105, s49, v105
v_bfe_u32 v104, v105, 2, 14
v_lshrrev_b32_e64 v105, 18, v105
ds_read_u16 v102, v102
ds_read_u16 v103, v103
ds_read_u16 v104, v104
ds_read_u16 v105, v105
v_mfma_f32_32x32x16_bf16 v[112:127], v[180:183], v[76:79], v[112:127]
v_exp_f16_sdwa v111, v111 dst_sel:WORD_1 dst_unused:UNUSED_PRESERVE src0_sel:WORD_1
v_cvt_pkrtz_f16_f32 v107, v106, v107
v_and_b32_e64 v107, s49, v107
v_bfe_u32 v106, v107, 2, 14
v_mfma_f32_32x32x16_f16 v[128:143], v[200:203], v[216:219], 0
ds_read_b128 v[176:179], v250 offset:53248
v_lshrrev_b32_e64 v107, 18, v107
v_pk_add_f16 v109, v109, 1.0 op_sel_hi:[1,0]
v_pk_add_f16 v111, v111, 1.0 op_sel_hi:[1,0]
v_rcp_f16_sdwa v109, v109 dst_sel:WORD_0 dst_unused:UNUSED_PRESERVE src0_sel:WORD_0
v_mfma_f32_32x32x16_f16 v[128:143], v[204:207], v[220:223], v[128:143]
s_waitcnt lgkmcnt(7)
ds_read_u16 v106, v106
ds_read_u16 v107, v107
v_permlane16_swap_b32 v200, v204
v_permlane16_swap_b32 v201, v205
v_permlane16_swap_b32 v202, v206
v_permlane16_swap_b32 v203, v207
v_mfma_f32_32x32x16_bf16 v[160:175], v[56:59], v[184:187], v[160:175]
v_rcp_f16_sdwa v111, v111 dst_sel:WORD_0 dst_unused:UNUSED_PRESERVE src0_sel:WORD_0
v_rcp_f16_sdwa v109, v109 dst_sel:WORD_1 dst_unused:UNUSED_PRESERVE src0_sel:WORD_1
s_add_u32 m0, s72, 1024
s_add_u32 s43, s82, 64
buffer_load_dwordx4 v246, s[16:19], s43 offen lds
v_rcp_f16_sdwa v111, v111 dst_sel:WORD_1 dst_unused:UNUSED_PRESERVE src0_sel:WORD_1
v_mfma_f32_32x32x16_bf16 v[112:127], v[184:187], v[80:83], v[112:127]
ds_read_b128 v[180:183], v250 offset:54272
v_fmac_f32_e64 v230, v128, v128
v_pk_mul_f16 v108, v108, v109
v_fmac_f32_e64 v230, v129, v129
v_pk_mul_f16 v110, v110, v111
v_fmac_f32 v230, v130, v130
v_fmac_f32 v230, v131, v131
v_fma_mix_f32 v231, v108, v108, v231 op_sel_hi:[1,1,0]
v_fmac_f32 v230, v132, v132
v_fmac_f32 v230, v133, v133
v_fma_mix_f32 v231, v110, v110, v231 op_sel_hi:[1,1,0]
v_mfma_f32_32x32x16_bf16 v[160:175], v[60:63], v[188:191], v[160:175]
v_fmac_f32_e64 v230, v134, v134
v_fma_mix_f32 v231, v108, v108, v231 op_sel:[1,1,0] op_sel_hi:[1,1,0]
v_fmac_f32 v230, v135, v135
v_fmac_f32 v230, v136, v136
v_fma_mix_f32 v231, v110, v110, v231 op_sel:[1,1,0] op_sel_hi:[1,1,0]
v_fmac_f32_e64 v230, v137, v137
v_fma_mix_f32 v231, v96, v96, v231 op_sel_hi:[1,1,0]
v_fmac_f32_e64 v230, v138, v138
v_fma_mix_f32 v231, v97, v97, v231 op_sel_hi:[1,1,0]
v_cvt_pkrtz_f16_f32 v145, v144, v145
v_fma_mix_f32 v231, v98, v98, v231 op_sel_hi:[1,1,0]
v_and_b32_e64 v145, s49, v145
v_fma_mix_f32 v231, v99, v99, v231 op_sel_hi:[1,1,0]
v_bfe_u32 v144, v145, 2, 14
v_lshrrev_b32_e64 v145, 18, v145
v_cvt_pk_f16_f32 v156, v156, v157
v_fmac_f32_e64 v230, v139, v139
v_cvt_pk_f16_f32 v158, v158, v159
v_fmac_f32 v230, v140, v140
v_fmac_f32 v230, v141, v141
v_mfma_f32_32x32x16_bf16 v[112:127], v[188:191], v[84:87], v[112:127]
ds_read_u16 v144, v144
ds_read_u16_d16_hi v145, v145
v_pk_fma_f16 v157, v156, v156, s48
v_fmac_f32 v230, v142, v142
s_waitcnt lgkmcnt(2)
v_fma_mix_f32 v231, v100, v100, v231 op_sel_hi:[1,1,0]
v_cvt_pkrtz_f16_f32 v147, v146, v147
v_fma_mix_f32 v231, v101, v101, v231 op_sel_hi:[1,1,0]
v_and_b32_e64 v147, s49, v147
v_bfe_u32 v146, v147, 2, 14
v_lshrrev_b32 v147, 18, v147
v_fmac_f32 v230, v143, v143
v_pk_fma_f16 v159, v158, v158, s48
v_pk_mul_f16 v157, v156, v157
v_fma_mix_f32 v231, v102, v102, v231 op_sel_hi:[1,1,0]
v_cvt_pkrtz_f16_f32 v149, v148, v149
v_fma_mix_f32 v231, v103, v103, v231 op_sel_hi:[1,1,0]
ds_read_u16 v146, v146
ds_read_u16_d16_hi v147, v147
ds_read_b128 v[184:187], v250 offset:55296
v_and_b32_e64 v149, s49, v149
v_bfe_u32 v148, v149, 2, 14
v_lshrrev_b32_e64 v149, 18, v149
v_pk_mul_f16 v159, v158, v159
v_exp_f16_sdwa v157, v157 dst_sel:WORD_0 dst_unused:UNUSED_PRESERVE src0_sel:WORD_0
v_mfma_f32_32x32x16_bf16 v[160:175], v[64:67], v[176:179], v[160:175]
ds_read_u16 v148, v148
ds_read_u16_d16_hi v149, v149
s_add_u32 m0, s72, 2048
s_add_u32 s43, s82, 128
buffer_load_dwordx4 v246, s[16:19], s43 offen lds
v_fma_mix_f32 v231, v104, v104, v231 op_sel_hi:[1,1,0]
v_cvt_pkrtz_f16_f32 v151, v150, v151
v_fma_mix_f32 v231, v105, v105, v231 op_sel_hi:[1,1,0]
v_and_b32_e64 v151, s49, v151
v_bfe_u32 v150, v151, 2, 14
v_lshrrev_b32_e64 v151, 18, v151
v_exp_f16_sdwa v159, v159 dst_sel:WORD_0 dst_unused:UNUSED_PRESERVE src0_sel:WORD_0
v_fma_mix_f32 v231, v106, v106, v231 op_sel_hi:[1,1,0]
v_cvt_pkrtz_f16_f32 v153, v152, v153
v_fma_mix_f32 v231, v107, v107, v231 op_sel_hi:[1,1,0]
v_and_b32_e64 v153, s49, v153
v_bfe_u32 v152, v153, 2, 14
ds_read_u16 v150, v150
ds_read_u16_d16_hi v151, v151
v_lshrrev_b32_e64 v153, 18, v153
v_exp_f16_sdwa v157, v157 dst_sel:WORD_1 dst_unused:UNUSED_PRESERVE src0_sel:WORD_1
v_mfma_f32_32x32x16_bf16 v[112:127], v[176:179], v[88:91], v[112:127]
ds_read_u16 v152, v152
ds_read_u16_d16_hi v153, v153
ds_read_b128 v[188:191], v250 offset:56320
v_cvt_pkrtz_f16_f32 v155, v154, v155
v_and_b32_e64 v155, s49, v155
v_bfe_u32 v154, v155, 2, 14
v_lshrrev_b32_e64 v155, 18, v155
v_exp_f16_sdwa v159, v159 dst_sel:WORD_1 dst_unused:UNUSED_PRESERVE src0_sel:WORD_1
v_pk_add_f16 v157, v157, 1.0 op_sel_hi:[1,0]
v_mfma_f32_32x32x16_bf16 v[160:175], v[68:71], v[180:183], v[160:175]
ds_read_u16 v154, v154
ds_read_u16_d16_hi v155, v155
v_pk_add_f16 v159, v159, 1.0 op_sel_hi:[1,0]
v_rcp_f16_sdwa v157, v157 dst_sel:WORD_0 dst_unused:UNUSED_PRESERVE src0_sel:WORD_0
v_rcp_f16_sdwa v159, v159 dst_sel:WORD_0 dst_unused:UNUSED_PRESERVE src0_sel:WORD_0
s_add_u32 m0, s72, 3072
s_add_u32 s43, s82, 3072
buffer_load_dwordx4 v246, s[16:19], s43 offen lds
v_mfma_f32_32x32x16_bf16 v[112:127], v[180:183], v[92:95], v[112:127]
ds_read_b128 v[176:179], v250 offset:57344
v_rcp_f16_sdwa v157, v157 dst_sel:WORD_1 dst_unused:UNUSED_PRESERVE src0_sel:WORD_1
v_rcp_f16_sdwa v159, v159 dst_sel:WORD_1 dst_unused:UNUSED_PRESERVE src0_sel:WORD_1
s_waitcnt lgkmcnt(7)
v_or_b32 v208, v144, v145
v_mfma_f32_32x32x16_bf16 v[128:143], v[48:51], v[184:187], 0
v_pk_mul_f16 v214, v156, v157
v_pk_mul_f16 v215, v158, v159
v_or_b32_e64 v209, v146, v147
v_cvt_pkrtz_f16_f32 v161, v160, v161
v_and_b32_e64 v161, s49, v161
v_bfe_u32 v160, v161, 2, 14
v_lshrrev_b32_e64 v161, 18, v161
v_cvt_pk_f16_f32 v172, v172, v173
v_cvt_pk_f16_f32 v174, v174, v175
v_mfma_f32_32x32x16_bf16 v[96:111], v[72:75], v[184:187], 0
ds_read_u16 v160, v160
ds_read_u16 v161, v161
v_pk_fma_f16 v173, v172, v172, s48
v_or_b32_e64 v212, v148, v149
v_cvt_pkrtz_f16_f32 v163, v162, v163
v_and_b32_e64 v163, s49, v163
v_bfe_u32 v162, v163, 2, 14
v_lshrrev_b32_e64 v163, 18, v163
v_pk_fma_f16 v175, v174, v174, s48
v_pk_mul_f16 v173, v172, v173
v_pk_mul_f16 v175, v174, v175
s_waitcnt lgkmcnt(5)
v_or_b32 v213, v150, v151
v_cvt_pkrtz_f16_f32 v165, v164, v165
v_and_b32_e64 v165, s49, v165
ds_read_u16 v162, v162
ds_read_u16 v163, v163
ds_read_b128 v[180:183], v250 offset:58368
v_bfe_u32 v164, v165, 2, 14
v_lshrrev_b32_e64 v165, 18, v165
v_exp_f16_sdwa v173, v173 dst_sel:WORD_0 dst_unused:UNUSED_PRESERVE src0_sel:WORD_0
v_mfma_f32_32x32x16_bf16 v[128:143], v[52:55], v[188:191], v[128:143]
ds_read_u16 v164, v164
ds_read_u16 v165, v165
s_add_u32 m0, s72, 4096
s_add_u32 s43, s82, 3136
buffer_load_dwordx4 v246, s[16:19], s43 offen lds
v_or_b32_e64 v210, v152, v153
v_exp_f16_sdwa v175, v175 dst_sel:WORD_0 dst_unused:UNUSED_PRESERVE src0_sel:WORD_0
v_cvt_pkrtz_f16_f32 v167, v166, v167
v_and_b32_e64 v167, s49, v167
v_bfe_u32 v166, v167, 2, 14
v_lshrrev_b32_e64 v167, 18, v167
v_exp_f16_sdwa v173, v173 dst_sel:WORD_1 dst_unused:UNUSED_PRESERVE src0_sel:WORD_1
s_waitcnt lgkmcnt(6)
v_or_b32 v211, v154, v155
v_cvt_pkrtz_f16_f32 v169, v168, v169
v_and_b32_e64 v169, s49, v169
v_bfe_u32 v168, v169, 2, 14
v_lshrrev_b32_e64 v169, 18, v169
ds_read_u16 v166, v166
ds_read_u16 v167, v167
ds_read_u16 v168, v168
ds_read_u16 v169, v169
v_mfma_f32_32x32x16_bf16 v[96:111], v[76:79], v[188:191], v[96:111]
v_exp_f16_sdwa v175, v175 dst_sel:WORD_1 dst_unused:UNUSED_PRESERVE src0_sel:WORD_1
v_cvt_pkrtz_f16_f32 v171, v170, v171
v_and_b32_e64 v171, s49, v171
v_bfe_u32 v170, v171, 2, 14
v_mfma_f32_32x32x16_f16 v[144:159], v[208:211], v[216:219], 0
ds_read_b128 v[184:187], v250 offset:59392
v_lshrrev_b32_e64 v171, 18, v171
v_pk_add_f16 v173, v173, 1.0 op_sel_hi:[1,0]
v_pk_add_f16 v175, v175, 1.0 op_sel_hi:[1,0]
v_rcp_f16_sdwa v173, v173 dst_sel:WORD_0 dst_unused:UNUSED_PRESERVE src0_sel:WORD_0
v_mfma_f32_32x32x16_f16 v[144:159], v[212:215], v[220:223], v[144:159]
ds_read_u16 v170, v170
ds_read_u16 v171, v171
v_permlane16_swap_b32 v208, v212
v_permlane16_swap_b32 v209, v213
v_permlane16_swap_b32 v210, v214
v_permlane16_swap_b32 v211, v215
v_mfma_f32_32x32x16_bf16 v[128:143], v[56:59], v[176:179], v[128:143]
v_rcp_f16_sdwa v175, v175 dst_sel:WORD_0 dst_unused:UNUSED_PRESERVE src0_sel:WORD_0
v_rcp_f16_sdwa v173, v173 dst_sel:WORD_1 dst_unused:UNUSED_PRESERVE src0_sel:WORD_1
s_add_u32 m0, s72, 6144
s_add_u32 s43, s82, 6144
buffer_load_dwordx4 v246, s[16:19], s43 offen lds
v_rcp_f16_sdwa v175, v175 dst_sel:WORD_1 dst_unused:UNUSED_PRESERVE src0_sel:WORD_1
v_mfma_f32_32x32x16_bf16 v[96:111], v[80:83], v[176:179], v[96:111]
ds_read_b128 v[188:191], v250 offset:60416
v_fmac_f32_e64 v231, v144, v144
v_pk_mul_f16 v172, v172, v173
v_fmac_f32_e64 v231, v145, v145
v_pk_mul_f16 v174, v174, v175
v_fmac_f32 v231, v146, v146
v_fmac_f32 v231, v147, v147
v_fma_mix_f32 v232, v172, v172, v232 op_sel_hi:[1,1,0]
v_fmac_f32 v231, v148, v148
v_fmac_f32 v231, v149, v149
v_fma_mix_f32 v232, v174, v174, v232 op_sel_hi:[1,1,0]
s_waitcnt lgkmcnt(5)
v_mfma_f32_32x32x16_bf16 v[128:143], v[60:63], v[180:183], v[128:143]
v_fmac_f32 v231, v150, v150
v_fma_mix_f32 v232, v172, v172, v232 op_sel:[1,1,0] op_sel_hi:[1,1,0]
v_fmac_f32 v231, v151, v151
v_fmac_f32 v231, v152, v152
v_fma_mix_f32 v232, v174, v174, v232 op_sel:[1,1,0] op_sel_hi:[1,1,0]
v_fmac_f32_e64 v231, v153, v153
v_fma_mix_f32 v232, v160, v160, v232 op_sel_hi:[1,1,0]
v_fmac_f32_e64 v231, v154, v154
v_fma_mix_f32 v232, v161, v161, v232 op_sel_hi:[1,1,0]
v_cvt_pkrtz_f16_f32 v113, v112, v113
v_fma_mix_f32 v232, v162, v162, v232 op_sel_hi:[1,1,0]
v_and_b32_e64 v113, s49, v113
v_fma_mix_f32 v232, v163, v163, v232 op_sel_hi:[1,1,0]
v_bfe_u32 v112, v113, 2, 14
v_lshrrev_b32_e64 v113, 18, v113
v_cvt_pk_f16_f32 v124, v124, v125
v_fmac_f32_e64 v231, v155, v155
v_cvt_pk_f16_f32 v126, v126, v127
v_fmac_f32 v231, v156, v156
v_fmac_f32 v231, v157, v157
v_mfma_f32_32x32x16_bf16 v[96:111], v[84:87], v[180:183], v[96:111]
ds_read_u16 v112, v112
ds_read_u16_d16_hi v113, v113
v_pk_fma_f16 v125, v124, v124, s48
v_fmac_f32_e64 v231, v158, v158
v_fma_mix_f32 v232, v164, v164, v232 op_sel_hi:[1,1,0]
v_cvt_pkrtz_f16_f32 v115, v114, v115
v_fma_mix_f32 v232, v165, v165, v232 op_sel_hi:[1,1,0]
v_and_b32_e64 v115, s49, v115
v_bfe_u32 v114, v115, 2, 14
v_lshrrev_b32 v115, 18, v115
v_fmac_f32 v231, v159, v159
s_nop 1
v_permlane32_swap_b32 v230, v231
v_add_f32_e64 v230, v230, v231
v_pk_fma_f16 v127, v126, v126, s48
v_pk_mul_f16 v125, v124, v125
v_fma_mix_f32 v232, v166, v166, v232 op_sel_hi:[1,1,0]
ds_read_u16 v114, v114
ds_read_u16_d16_hi v115, v115
ds_write_b32 v248, v230 offset:8192
ds_read_b128 v[176:179], v250 offset:61440
v_fma_mix_f32 v232, v167, v167, v232 op_sel_hi:[1,1,0]
v_cvt_pkrtz_f16_f32 v117, v116, v117
v_and_b32_e64 v117, s49, v117
v_bfe_u32 v116, v117, 2, 14
v_lshrrev_b32 v117, 18, v117
v_pk_mul_f16 v127, v126, v127
v_exp_f16_sdwa v125, v125 dst_sel:WORD_0 dst_unused:UNUSED_PRESERVE src0_sel:WORD_0
s_waitcnt lgkmcnt(6)
v_mfma_f32_32x32x16_bf16 v[128:143], v[64:67], v[184:187], v[128:143]
ds_read_u16 v116, v116
ds_read_u16_d16_hi v117, v117
s_add_u32 m0, s72, 7168
s_add_u32 s43, s82, 6208
buffer_load_dwordx4 v246, s[16:19], s43 offen lds
v_fma_mix_f32 v232, v168, v168, v232 op_sel_hi:[1,1,0]
v_cvt_pkrtz_f16_f32 v119, v118, v119
v_fma_mix_f32 v232, v169, v169, v232 op_sel_hi:[1,1,0]
v_and_b32_e64 v119, s49, v119
v_bfe_u32 v118, v119, 2, 14
v_lshrrev_b32_e64 v119, 18, v119
v_exp_f16_sdwa v127, v127 dst_sel:WORD_0 dst_unused:UNUSED_PRESERVE src0_sel:WORD_0
v_fma_mix_f32 v232, v170, v170, v232 op_sel_hi:[1,1,0]
v_cvt_pkrtz_f16_f32 v121, v120, v121
v_fma_mix_f32 v232, v171, v171, v232 op_sel_hi:[1,1,0]
v_and_b32_e64 v121, s49, v121
v_bfe_u32 v120, v121, 2, 14
ds_read_u16 v118, v118
ds_read_u16_d16_hi v119, v119
v_lshrrev_b32_e64 v121, 18, v121
v_exp_f16_sdwa v125, v125 dst_sel:WORD_1 dst_unused:UNUSED_PRESERVE src0_sel:WORD_1
v_mfma_f32_32x32x16_bf16 v[96:111], v[88:91], v[184:187], v[96:111]
ds_read_u16 v120, v120
ds_read_u16_d16_hi v121, v121
ds_read_b128 v[180:183], v250 offset:62464
v_cvt_pkrtz_f16_f32 v123, v122, v123
v_and_b32_e64 v123, s49, v123
v_bfe_u32 v122, v123, 2, 14
v_lshrrev_b32_e64 v123, 18, v123
v_exp_f16_sdwa v127, v127 dst_sel:WORD_1 dst_unused:UNUSED_PRESERVE src0_sel:WORD_1
v_pk_add_f16 v125, v125, 1.0 op_sel_hi:[1,0]
v_mfma_f32_32x32x16_bf16 v[128:143], v[68:71], v[188:191], v[128:143]
ds_read_u16 v122, v122
ds_read_u16_d16_hi v123, v123
v_pk_add_f16 v127, v127, 1.0 op_sel_hi:[1,0]
v_rcp_f16_sdwa v125, v125 dst_sel:WORD_0 dst_unused:UNUSED_PRESERVE src0_sel:WORD_0
v_rcp_f16_sdwa v127, v127 dst_sel:WORD_0 dst_unused:UNUSED_PRESERVE src0_sel:WORD_0
v_mfma_f32_32x32x16_bf16 v[96:111], v[92:95], v[188:191], v[96:111]
s_waitcnt lgkmcnt(7)
ds_read_b128 v[184:187], v250 offset:63488
v_rcp_f16_sdwa v125, v125 dst_sel:WORD_1 dst_unused:UNUSED_PRESERVE src0_sel:WORD_1
v_rcp_f16_sdwa v127, v127 dst_sel:WORD_1 dst_unused:UNUSED_PRESERVE src0_sel:WORD_1
v_or_b32 v224, v112, v113
v_mfma_f32_32x32x16_bf16 v[144:159], v[48:51], v[176:179], 0
v_pk_mul_f16 v230, v124, v125
v_pk_mul_f16 v231, v126, v127
v_or_b32_e64 v225, v114, v115
v_cvt_pkrtz_f16_f32 v129, v128, v129
v_and_b32_e64 v129, s49, v129
v_bfe_u32 v128, v129, 2, 14
v_lshrrev_b32_e64 v129, 18, v129
v_cvt_pk_f16_f32 v140, v140, v141
v_cvt_pk_f16_f32 v142, v142, v143
v_mfma_f32_32x32x16_bf16 v[160:175], v[176:179], v[72:75], 0
ds_read_u16 v128, v128
ds_read_u16 v129, v129
v_pk_fma_f16 v141, v140, v140, s48
v_or_b32_e64 v228, v116, v117
v_cvt_pkrtz_f16_f32 v131, v130, v131
v_and_b32_e64 v131, s49, v131
v_bfe_u32 v130, v131, 2, 14
v_lshrrev_b32_e64 v131, 18, v131
v_pk_fma_f16 v143, v142, v142, s48
v_pk_mul_f16 v141, v140, v141
v_pk_mul_f16 v143, v142, v143
s_waitcnt lgkmcnt(5)
v_or_b32 v229, v118, v119
v_cvt_pkrtz_f16_f32 v133, v132, v133
v_and_b32_e64 v133, s49, v133
ds_read_u16 v130, v130
ds_read_u16 v131, v131
ds_read_b128 v[188:191], v250 offset:64512
v_bfe_u32 v132, v133, 2, 14
v_lshrrev_b32_e64 v133, 18, v133
v_exp_f16_sdwa v141, v141 dst_sel:WORD_0 dst_unused:UNUSED_PRESERVE src0_sel:WORD_0
v_mfma_f32_32x32x16_bf16 v[144:159], v[52:55], v[180:183], v[144:159]
ds_read_u16 v132, v132
ds_read_u16 v133, v133
v_or_b32_e64 v226, v120, v121
v_exp_f16_sdwa v143, v143 dst_sel:WORD_0 dst_unused:UNUSED_PRESERVE src0_sel:WORD_0
v_cvt_pkrtz_f16_f32 v135, v134, v135
v_and_b32_e64 v135, s49, v135
v_bfe_u32 v134, v135, 2, 14
v_lshrrev_b32_e64 v135, 18, v135
v_exp_f16_sdwa v141, v141 dst_sel:WORD_1 dst_unused:UNUSED_PRESERVE src0_sel:WORD_1
s_waitcnt lgkmcnt(6)
v_or_b32 v227, v122, v123
v_cvt_pkrtz_f16_f32 v137, v136, v137
v_and_b32_e64 v137, s49, v137
v_bfe_u32 v136, v137, 2, 14
v_lshrrev_b32_e64 v137, 18, v137
ds_read_u16 v134, v134
ds_read_u16 v135, v135
ds_read_u16 v136, v136
ds_read_u16 v137, v137
v_mfma_f32_32x32x16_bf16 v[160:175], v[180:183], v[76:79], v[160:175]
v_exp_f16_sdwa v143, v143 dst_sel:WORD_1 dst_unused:UNUSED_PRESERVE src0_sel:WORD_1
v_cvt_pkrtz_f16_f32 v139, v138, v139
v_and_b32_e64 v139, s49, v139
v_bfe_u32 v138, v139, 2, 14
v_mfma_f32_32x32x16_f16 v[112:127], v[224:227], v[216:219], 0
ds_read_b128 v[176:179], v251
v_lshrrev_b32_e64 v139, 18, v139
v_pk_add_f16 v141, v141, 1.0 op_sel_hi:[1,0]
v_pk_add_f16 v143, v143, 1.0 op_sel_hi:[1,0]
v_rcp_f16_sdwa v141, v141 dst_sel:WORD_0 dst_unused:UNUSED_PRESERVE src0_sel:WORD_0
v_mfma_f32_32x32x16_f16 v[112:127], v[228:231], v[220:223], v[112:127]
ds_read_u16 v138, v138
ds_read_u16 v139, v139
v_permlane16_swap_b32 v224, v228
v_permlane16_swap_b32 v225, v229
v_permlane16_swap_b32 v226, v230
v_permlane16_swap_b32 v227, v231
v_mfma_f32_32x32x16_bf16 v[144:159], v[56:59], v[184:187], v[144:159]
v_rcp_f16_sdwa v143, v143 dst_sel:WORD_0 dst_unused:UNUSED_PRESERVE src0_sel:WORD_0
v_rcp_f16_sdwa v141, v141 dst_sel:WORD_1 dst_unused:UNUSED_PRESERVE src0_sel:WORD_1
v_rcp_f16_sdwa v143, v143 dst_sel:WORD_1 dst_unused:UNUSED_PRESERVE src0_sel:WORD_1
v_mfma_f32_32x32x16_bf16 v[160:175], v[184:187], v[80:83], v[160:175]
ds_read_b128 v[180:183], v251 offset:1024
v_fmac_f32_e64 v232, v112, v112
v_pk_mul_f16 v140, v140, v141
v_fmac_f32_e64 v232, v113, v113
v_pk_mul_f16 v142, v142, v143
v_fmac_f32 v232, v114, v114
v_fmac_f32 v232, v115, v115
v_fma_mix_f32 v233, v140, v140, v233 op_sel_hi:[1,1,0]
v_fmac_f32 v232, v116, v116
v_fmac_f32 v232, v117, v117
v_fma_mix_f32 v233, v142, v142, v233 op_sel_hi:[1,1,0]
s_waitcnt lgkmcnt(5)
v_mfma_f32_32x32x16_bf16 v[144:159], v[60:63], v[188:191], v[144:159]
v_fmac_f32 v232, v118, v118
v_fma_mix_f32 v233, v140, v140, v233 op_sel:[1,1,0] op_sel_hi:[1,1,0]
v_fmac_f32 v232, v119, v119
v_fmac_f32 v232, v120, v120
v_fma_mix_f32 v233, v142, v142, v233 op_sel:[1,1,0] op_sel_hi:[1,1,0]
v_fmac_f32_e64 v232, v121, v121
v_fma_mix_f32 v233, v128, v128, v233 op_sel_hi:[1,1,0]
v_fmac_f32_e64 v232, v122, v122
v_fma_mix_f32 v233, v129, v129, v233 op_sel_hi:[1,1,0]
v_cvt_pkrtz_f16_f32 v97, v96, v97
v_fma_mix_f32 v233, v130, v130, v233 op_sel_hi:[1,1,0]
v_and_b32_e64 v97, s49, v97
v_fma_mix_f32 v233, v131, v131, v233 op_sel_hi:[1,1,0]
v_bfe_u32 v96, v97, 2, 14
v_lshrrev_b32_e64 v97, 18, v97
v_cvt_pk_f16_f32 v108, v108, v109
v_fmac_f32_e64 v232, v123, v123
v_cvt_pk_f16_f32 v110, v110, v111
v_fmac_f32 v232, v124, v124
v_fmac_f32 v232, v125, v125
v_mfma_f32_32x32x16_bf16 v[160:175], v[188:191], v[84:87], v[160:175]
ds_read_u16 v96, v96
ds_read_u16 v97, v97
v_pk_fma_f16 v109, v108, v108, s48
v_fmac_f32_e64 v232, v126, v126
v_fma_mix_f32 v233, v132, v132, v233 op_sel_hi:[1,1,0]
v_cvt_pkrtz_f16_f32 v99, v98, v99
v_fma_mix_f32 v233, v133, v133, v233 op_sel_hi:[1,1,0]
v_and_b32_e64 v99, s49, v99
v_bfe_u32 v98, v99, 2, 14
v_lshrrev_b32 v99, 18, v99
v_fmac_f32 v232, v127, v127
v_pk_fma_f16 v111, v110, v110, s48
v_pk_mul_f16 v109, v108, v109
v_pk_mul_f16 v111, v110, v111
v_fma_mix_f32 v233, v134, v134, v233 op_sel_hi:[1,1,0]
v_cvt_pkrtz_f16_f32 v101, v100, v101
ds_read_u16 v98, v98
ds_read_u16 v99, v99
ds_read_b128 v[184:187], v251 offset:2048
v_fma_mix_f32 v233, v135, v135, v233 op_sel_hi:[1,1,0]
v_and_b32_e64 v101, s49, v101
v_bfe_u32 v100, v101, 2, 14
v_lshrrev_b32 v101, 18, v101
v_exp_f16_sdwa v109, v109 dst_sel:WORD_0 dst_unused:UNUSED_PRESERVE src0_sel:WORD_0
s_waitcnt lgkmcnt(5)
v_mfma_f32_32x32x16_bf16 v[144:159], v[64:67], v[176:179], v[144:159]
ds_read_u16 v100, v100
ds_read_u16 v101, v101
v_fma_mix_f32 v233, v136, v136, v233 op_sel_hi:[1,1,0]
v_exp_f16_sdwa v111, v111 dst_sel:WORD_0 dst_unused:UNUSED_PRESERVE src0_sel:WORD_0
v_fma_mix_f32 v233, v137, v137, v233 op_sel_hi:[1,1,0]
v_cvt_pkrtz_f16_f32 v103, v102, v103
v_and_b32_e64 v103, s49, v103
v_bfe_u32 v102, v103, 2, 14
v_lshrrev_b32_e64 v103, 18, v103
v_exp_f16_sdwa v109, v109 dst_sel:WORD_1 dst_unused:UNUSED_PRESERVE src0_sel:WORD_1
v_fma_mix_f32 v233, v138, v138, v233 op_sel_hi:[1,1,0]
v_cvt_pkrtz_f16_f32 v105, v104, v105
v_fma_mix_f32 v233, v139, v139, v233 op_sel_hi:[1,1,0]
v_and_b32_e64 v105, s49, v105
v_bfe_u32 v104, v105, 2, 14
ds_read_u16 v102, v102
ds_read_u16 v103, v103
v_lshrrev_b32_e64 v105, 18, v105
v_mfma_f32_32x32x16_bf16 v[160:175], v[176:179], v[88:91], v[160:175]
ds_read_u16 v104, v104
ds_read_u16 v105, v105
v_exp_f16_sdwa v111, v111 dst_sel:WORD_1 dst_unused:UNUSED_PRESERVE src0_sel:WORD_1
v_cvt_pkrtz_f16_f32 v107, v106, v107
v_and_b32_e64 v107, s49, v107
v_bfe_u32 v106, v107, 2, 14
v_lshrrev_b32_e64 v107, 18, v107
v_pk_add_f16 v109, v109, 1.0 op_sel_hi:[1,0]
v_pk_add_f16 v111, v111, 1.0 op_sel_hi:[1,0]
ds_read_b128 v[188:191], v251 offset:3072
ds_read_u16 v106, v106
ds_read_u16 v107, v107
v_rcp_f16_sdwa v109, v109 dst_sel:WORD_0 dst_unused:UNUSED_PRESERVE src0_sel:WORD_0
v_mfma_f32_32x32x16_bf16 v[144:159], v[68:71], v[180:183], v[144:159]
v_rcp_f16_sdwa v111, v111 dst_sel:WORD_0 dst_unused:UNUSED_PRESERVE src0_sel:WORD_0
v_rcp_f16_sdwa v109, v109 dst_sel:WORD_1 dst_unused:UNUSED_PRESERVE src0_sel:WORD_1
v_rcp_f16_sdwa v111, v111 dst_sel:WORD_1 dst_unused:UNUSED_PRESERVE src0_sel:WORD_1
v_mfma_f32_32x32x16_bf16 v[160:175], v[180:183], v[92:95], v[160:175]
ds_read_b128 v[176:179], v251 offset:4096
v_pk_mul_f16 v108, v108, v109
v_pk_mul_f16 v110, v110, v111
v_fma_mix_f32 v233, v108, v108, v233 op_sel_hi:[1,1,0]
v_bfe_u32 v237, v250, 4, 6
v_min_u32 v237, 47, v237
v_lshlrev_b32 v244, 5, v237
v_add_u32 v244, 95232, v244
v_add_u32 v245, 2304, v244
v_cmp_gt_u32 vcc, 24, v237
s_nop 1
v_cndmask_b32 v244, v245, v244, vcc
v_lshlrev_b32_e64 v237, 13, v237
v_add_u32 v245, 4096, v237
v_fma_mix_f32 v233, v110, v110, v233 op_sel_hi:[1,1,0]
s_waitcnt lgkmcnt(5)
v_mfma_f32_32x32x16_bf16 v[112:127], v[48:51], v[184:187], 0
v_fma_mix_f32 v233, v108, v108, v233 op_sel:[1,1,0] op_sel_hi:[1,1,0]
v_cvt_pkrtz_f16_f32 v145, v144, v145
v_fma_mix_f32 v233, v110, v110, v233 op_sel:[1,1,0] op_sel_hi:[1,1,0]
v_and_b32_e64 v145, s49, v145
v_fma_mix_f32 v233, v96, v96, v233 op_sel_hi:[1,1,0]
v_bfe_u32 v144, v145, 2, 14
v_fma_mix_f32 v233, v97, v97, v233 op_sel_hi:[1,1,0]
v_lshrrev_b32_e64 v145, 18, v145
v_fma_mix_f32 v233, v98, v98, v233 op_sel_hi:[1,1,0]
v_cvt_pk_f16_f32 v156, v156, v157
v_fma_mix_f32 v233, v99, v99, v233 op_sel_hi:[1,1,0]
v_cvt_pk_f16_f32 v158, v158, v159
v_mfma_f32_32x32x16_bf16 v[128:143], v[184:187], v[72:75], 0
ds_read_u16 v144, v144
ds_read_u16 v145, v145
v_pk_fma_f16 v157, v156, v156, s48
v_fma_mix_f32 v233, v100, v100, v233 op_sel_hi:[1,1,0]
v_cvt_pkrtz_f16_f32 v147, v146, v147
v_fma_mix_f32 v233, v101, v101, v233 op_sel_hi:[1,1,0]
v_and_b32_e64 v147, s49, v147
v_bfe_u32 v146, v147, 2, 14
v_lshrrev_b32_e64 v147, 18, v147
v_pk_fma_f16 v159, v158, v158, s48
v_pk_mul_f16 v157, v156, v157
v_pk_mul_f16 v159, v158, v159
v_fma_mix_f32 v233, v102, v102, v233 op_sel_hi:[1,1,0]
v_cvt_pkrtz_f16_f32 v149, v148, v149
v_fma_mix_f32 v233, v103, v103, v233 op_sel_hi:[1,1,0]
ds_read_u16 v146, v146
ds_read_u16 v147, v147
ds_read_b128 v[180:183], v251 offset:5120
v_and_b32_e64 v149, s49, v149
v_bfe_u32 v148, v149, 2, 14
v_lshrrev_b32 v149, 18, v149
v_exp_f16_sdwa v157, v157 dst_sel:WORD_0 dst_unused:UNUSED_PRESERVE src0_sel:WORD_0
s_waitcnt lgkmcnt(5)
v_mfma_f32_32x32x16_bf16 v[112:127], v[52:55], v[188:191], v[112:127]
ds_read_u16 v148, v148
ds_read_u16 v149, v149
v_fma_mix_f32 v233, v104, v104, v233 op_sel_hi:[1,1,0]
v_exp_f16_sdwa v159, v159 dst_sel:WORD_0 dst_unused:UNUSED_PRESERVE src0_sel:WORD_0
v_fma_mix_f32 v233, v105, v105, v233 op_sel_hi:[1,1,0]
v_cvt_pkrtz_f16_f32 v151, v150, v151
v_and_b32_e64 v151, s49, v151
v_bfe_u32 v150, v151, 2, 14
v_lshrrev_b32_e64 v151, 18, v151
v_exp_f16_sdwa v157, v157 dst_sel:WORD_1 dst_unused:UNUSED_PRESERVE src0_sel:WORD_1
v_fma_mix_f32 v233, v106, v106, v233 op_sel_hi:[1,1,0]
v_cvt_pkrtz_f16_f32 v153, v152, v153
v_fma_mix_f32 v233, v107, v107, v233 op_sel_hi:[1,1,0]
v_and_b32_e64 v153, s49, v153
v_bfe_u32 v152, v153, 2, 14
ds_read_u16 v150, v150
ds_read_u16 v151, v151
v_lshrrev_b32_e64 v153, 18, v153
v_mfma_f32_32x32x16_bf16 v[128:143], v[188:191], v[76:79], v[128:143]
ds_read_u16 v152, v152
ds_read_u16 v153, v153
v_exp_f16_sdwa v159, v159 dst_sel:WORD_1 dst_unused:UNUSED_PRESERVE src0_sel:WORD_1
v_cvt_pkrtz_f16_f32 v155, v154, v155
v_and_b32_e64 v155, s49, v155
v_bfe_u32 v154, v155, 2, 14
v_lshrrev_b32_e64 v155, 18, v155
v_pk_add_f16 v157, v157, 1.0 op_sel_hi:[1,0]
v_pk_add_f16 v159, v159, 1.0 op_sel_hi:[1,0]
ds_read_b128 v[184:187], v251 offset:6144
ds_read_u16 v154, v154
ds_read_u16 v155, v155
v_rcp_f16_sdwa v157, v157 dst_sel:WORD_0 dst_unused:UNUSED_PRESERVE src0_sel:WORD_0
v_mfma_f32_32x32x16_bf16 v[112:127], v[56:59], v[176:179], v[112:127]
v_rcp_f16_sdwa v159, v159 dst_sel:WORD_0 dst_unused:UNUSED_PRESERVE src0_sel:WORD_0
v_rcp_f16_sdwa v157, v157 dst_sel:WORD_1 dst_unused:UNUSED_PRESERVE src0_sel:WORD_1
v_rcp_f16_sdwa v159, v159 dst_sel:WORD_1 dst_unused:UNUSED_PRESERVE src0_sel:WORD_1
v_mfma_f32_32x32x16_bf16 v[128:143], v[176:179], v[80:83], v[128:143]
ds_read_b128 v[188:191], v251 offset:7168
v_pk_mul_f16 v156, v156, v157
v_pk_mul_f16 v158, v158, v159
v_fma_mix_f32 v234, v156, v156, v234 op_sel_hi:[1,1,0]
v_permlane32_swap_b32 v232, v233
v_fma_mix_f32 v234, v158, v158, v234 op_sel_hi:[1,1,0]
s_waitcnt lgkmcnt(7)
v_mfma_f32_32x32x16_bf16 v[112:127], v[60:63], v[180:183], v[112:127]
v_add_f32 v232, v232, v233
s_setprio 1
ds_write_b32 v248, v232 offset:8448
v_fma_mix_f32 v234, v156, v156, v234 op_sel:[1,1,0] op_sel_hi:[1,1,0]
v_cvt_pkrtz_f16_f32 v161, v160, v161
v_fma_mix_f32 v234, v158, v158, v234 op_sel:[1,1,0] op_sel_hi:[1,1,0]
v_and_b32_e64 v161, s49, v161
v_fma_mix_f32 v234, v144, v144, v234 op_sel_hi:[1,1,0]
v_bfe_u32 v160, v161, 2, 14
v_fma_mix_f32 v234, v145, v145, v234 op_sel_hi:[1,1,0]
v_lshrrev_b32_e64 v161, 18, v161
v_fma_mix_f32 v234, v146, v146, v234 op_sel_hi:[1,1,0]
v_cvt_pk_f16_f32 v172, v172, v173
v_fma_mix_f32 v234, v147, v147, v234 op_sel_hi:[1,1,0]
v_cvt_pk_f16_f32 v174, v174, v175
v_mfma_f32_32x32x16_bf16 v[128:143], v[180:183], v[84:87], v[128:143]
ds_read_u16 v160, v160
ds_read_u16_d16_hi v161, v161
v_pk_fma_f16 v173, v172, v172, s48
v_fma_mix_f32 v234, v148, v148, v234 op_sel_hi:[1,1,0]
v_cvt_pkrtz_f16_f32 v163, v162, v163
v_fma_mix_f32 v234, v149, v149, v234 op_sel_hi:[1,1,0]
v_and_b32_e64 v163, s49, v163
v_bfe_u32 v162, v163, 2, 14
v_lshrrev_b32_e64 v163, 18, v163
v_pk_fma_f16 v175, v174, v174, s48
v_pk_mul_f16 v173, v172, v173
v_fma_mix_f32 v234, v150, v150, v234 op_sel_hi:[1,1,0]
v_cvt_pkrtz_f16_f32 v165, v164, v165
s_waitcnt lgkmcnt(4)
v_fma_mix_f32 v234, v151, v151, v234 op_sel_hi:[1,1,0]
v_and_b32 v165, s49, v165
ds_read_u16 v162, v162
ds_read_u16_d16_hi v163, v163
v_bfe_u32 v164, v165, 2, 14
v_lshrrev_b32_e64 v165, 18, v165
v_pk_mul_f16 v175, v174, v175
v_exp_f16_sdwa v173, v173 dst_sel:WORD_0 dst_unused:UNUSED_PRESERVE src0_sel:WORD_0
v_mfma_f32_32x32x16_bf16 v[112:127], v[64:67], v[184:187], v[112:127]
ds_read_u16 v164, v164
ds_read_u16_d16_hi v165, v165
v_fma_mix_f32 v234, v152, v152, v234 op_sel_hi:[1,1,0]
v_cvt_pkrtz_f16_f32 v167, v166, v167
v_fma_mix_f32 v234, v153, v153, v234 op_sel_hi:[1,1,0]
v_and_b32_e64 v167, s49, v167
v_bfe_u32 v166, v167, 2, 14
v_lshrrev_b32_e64 v167, 18, v167
v_exp_f16_sdwa v175, v175 dst_sel:WORD_0 dst_unused:UNUSED_PRESERVE src0_sel:WORD_0
v_fma_mix_f32 v234, v154, v154, v234 op_sel_hi:[1,1,0]
v_cvt_pkrtz_f16_f32 v169, v168, v169
v_fma_mix_f32 v234, v155, v155, v234 op_sel_hi:[1,1,0]
v_and_b32_e64 v169, s49, v169
v_bfe_u32 v168, v169, 2, 14
ds_read_u16 v166, v166
ds_read_u16_d16_hi v167, v167
v_lshrrev_b32_e64 v169, 18, v169
v_exp_f16_sdwa v173, v173 dst_sel:WORD_1 dst_unused:UNUSED_PRESERVE src0_sel:WORD_1
v_mfma_f32_32x32x16_bf16 v[128:143], v[184:187], v[88:91], v[128:143]
ds_read_u16 v168, v168
ds_read_u16_d16_hi v169, v169
v_cvt_pkrtz_f16_f32 v171, v170, v171
v_and_b32_e64 v171, s49, v171
v_bfe_u32 v170, v171, 2, 14
v_lshrrev_b32 v171, 18, v171
v_exp_f16_sdwa v175, v175 dst_sel:WORD_1 dst_unused:UNUSED_PRESERVE src0_sel:WORD_1
v_pk_add_f16 v173, v173, 1.0 op_sel_hi:[1,0]
s_waitcnt lgkmcnt(6)
v_mfma_f32_32x32x16_bf16 v[112:127], v[68:71], v[188:191], v[112:127]
ds_read_u16 v170, v170
ds_read_u16_d16_hi v171, v171
v_pk_add_f16 v175, v175, 1.0 op_sel_hi:[1,0]
v_rcp_f16_sdwa v173, v173 dst_sel:WORD_0 dst_unused:UNUSED_PRESERVE src0_sel:WORD_0
v_rcp_f16_sdwa v175, v175 dst_sel:WORD_0 dst_unused:UNUSED_PRESERVE src0_sel:WORD_0
v_mfma_f32_32x32x16_bf16 v[128:143], v[188:191], v[92:95], v[128:143]
v_rcp_f16_sdwa v173, v173 dst_sel:WORD_1 dst_unused:UNUSED_PRESERVE src0_sel:WORD_1
v_rcp_f16_sdwa v175, v175 dst_sel:WORD_1 dst_unused:UNUSED_PRESERVE src0_sel:WORD_1
v_or_b32_e64 v96, v160, v161
v_pk_mul_f16 v102, v172, v173
v_pk_mul_f16 v103, v174, v175
v_or_b32 v97, v162, v163
s_waitcnt lgkmcnt(5)
v_or_b32 v100, v164, v165
s_waitcnt lgkmcnt(4)
v_or_b32_e64 v101, v166, v167
ds_read_b128 v[176:179], v250
ds_read_b128 v[180:183], v250 offset:1024
ds_read_b128 v[184:187], v250 offset:2048
v_cvt_pkrtz_f16_f32 v129, v128, v129
v_and_b32_e64 v129, s49, v129
v_bfe_u32 v128, v129, 2, 14
v_lshrrev_b32_e64 v129, 18, v129
v_cvt_pk_f16_f32 v140, v140, v141
v_cvt_pk_f16_f32 v142, v142, v143
v_pk_fma_f16 v141, v140, v140, s48
v_cvt_pkrtz_f16_f32 v131, v130, v131
v_and_b32_e64 v131, s49, v131
v_bfe_u32 v130, v131, 2, 14
ds_read_u16 v128, v128
ds_read_u16_d16_hi v129, v129
v_lshrrev_b32_e64 v131, 18, v131
v_pk_fma_f16 v143, v142, v142, s48
v_pk_mul_f16 v141, v140, v141
v_cvt_pkrtz_f16_f32 v133, v132, v133
v_and_b32_e64 v133, s49, v133
v_bfe_u32 v132, v133, 2, 14
v_lshrrev_b32_e64 v133, 18, v133
ds_read_u16 v130, v130
ds_read_u16_d16_hi v131, v131
ds_read_u16 v132, v132
ds_read_u16_d16_hi v133, v133
v_pk_mul_f16 v143, v142, v143
v_exp_f16_sdwa v141, v141 dst_sel:WORD_0 dst_unused:UNUSED_PRESERVE src0_sel:WORD_0
s_waitcnt lgkmcnt(9)
v_or_b32 v98, v168, v169
v_cvt_pkrtz_f16_f32 v135, v134, v135
v_and_b32_e64 v135, s49, v135
v_bfe_u32 v134, v135, 2, 14
v_lshrrev_b32_e64 v135, 18, v135
v_exp_f16_sdwa v143, v143 dst_sel:WORD_0 dst_unused:UNUSED_PRESERVE src0_sel:WORD_0
v_or_b32_e64 v99, v170, v171
v_cvt_pkrtz_f16_f32 v137, v136, v137
v_and_b32_e64 v137, s49, v137
v_bfe_u32 v136, v137, 2, 14
v_lshrrev_b32_e64 v137, 18, v137
ds_read_u16 v134, v134
ds_read_u16_d16_hi v135, v135
ds_read_u16 v136, v136
ds_read_u16_d16_hi v137, v137
v_exp_f16_sdwa v141, v141 dst_sel:WORD_1 dst_unused:UNUSED_PRESERVE src0_sel:WORD_1
v_mfma_f32_32x32x16_f16 v[160:175], v[96:99], v[216:219], 0
v_cvt_pkrtz_f16_f32 v139, v138, v139
v_and_b32_e64 v139, s49, v139
v_bfe_u32 v138, v139, 2, 14
v_lshrrev_b32_e64 v139, 18, v139
v_exp_f16_sdwa v143, v143 dst_sel:WORD_1 dst_unused:UNUSED_PRESERVE src0_sel:WORD_1
v_pk_add_f16 v141, v141, 1.0 op_sel_hi:[1,0]
v_mfma_f32_32x32x16_f16 v[160:175], v[100:103], v[220:223], v[160:175]
ds_read_u16 v138, v138
ds_read_u16_d16_hi v139, v139
v_pk_add_f16 v143, v143, 1.0 op_sel_hi:[1,0]
v_permlane16_swap_b32 v96, v100
v_permlane16_swap_b32 v97, v101
v_permlane16_swap_b32 v98, v102
v_permlane16_swap_b32 v99, v103
v_rcp_f16_sdwa v141, v141 dst_sel:WORD_0 dst_unused:UNUSED_PRESERVE src0_sel:WORD_0
v_rcp_f16_sdwa v143, v143 dst_sel:WORD_0 dst_unused:UNUSED_PRESERVE src0_sel:WORD_0
v_rcp_f16_sdwa v141, v141 dst_sel:WORD_1 dst_unused:UNUSED_PRESERVE src0_sel:WORD_1
s_nop 1
v_fmac_f32 v234, v160, v160
v_fmac_f32_e64 v234, v161, v161
v_fmac_f32 v234, v162, v162
s_waitcnt lgkmcnt(6)
ds_read_b128 v[188:191], v250 offset:3072
v_rcp_f16_sdwa v143, v143 dst_sel:WORD_1 dst_unused:UNUSED_PRESERVE src0_sel:WORD_1
v_fmac_f32 v234, v163, v163
v_fmac_f32 v234, v164, v164
v_fmac_f32 v234, v165, v165
v_or_b32 v104, v128, v129
v_mfma_f32_32x32x16_bf16 v[144:159], v[176:179], v[72:75], 0
ds_read_b128 v[176:179], v250 offset:4096
v_fmac_f32_e64 v234, v166, v166
v_pk_mul_f16 v110, v140, v141
v_fmac_f32 v234, v167, v167
v_fmac_f32 v234, v168, v168
v_pk_mul_f16 v111, v142, v143
v_fmac_f32 v234, v169, v169
v_or_b32 v105, v130, v131
v_fmac_f32_e64 v234, v170, v170
v_cvt_pkrtz_f16_f32 v113, v112, v113
v_and_b32_e64 v113, s49, v113
v_bfe_u32 v112, v113, 2, 14
v_lshrrev_b32_e64 v113, 18, v113
v_cvt_pk_f16_f32 v124, v124, v125
v_fmac_f32_e64 v234, v171, v171
v_cvt_pk_f16_f32 v126, v126, v127
v_fmac_f32 v234, v172, v172
v_fmac_f32 v234, v173, v173
v_mfma_f32_32x32x16_bf16 v[144:159], v[180:183], v[76:79], v[144:159]
ds_read_u16 v112, v112
ds_read_u16 v113, v113
ds_read_b128 v[180:183], v250 offset:5120
v_pk_fma_f16 v125, v124, v124, s48
v_fmac_f32 v234, v174, v174
v_or_b32 v108, v132, v133
v_cvt_pkrtz_f16_f32 v115, v114, v115
v_and_b32_e64 v115, s49, v115
v_bfe_u32 v114, v115, 2, 14
v_lshrrev_b32 v115, 18, v115
v_fmac_f32 v234, v175, v175
v_pk_fma_f16 v127, v126, v126, s48
v_pk_mul_f16 v125, v124, v125
v_pk_mul_f16 v127, v126, v127
s_waitcnt lgkmcnt(3)
v_or_b32 v109, v134, v135
v_cvt_pkrtz_f16_f32 v117, v116, v117
ds_read_u16 v114, v114
ds_read_u16 v115, v115
v_and_b32_e64 v117, s49, v117
v_bfe_u32 v116, v117, 2, 14
v_lshrrev_b32_e64 v117, 18, v117
v_exp_f16_sdwa v125, v125 dst_sel:WORD_0 dst_unused:UNUSED_PRESERVE src0_sel:WORD_0
v_mfma_f32_32x32x16_bf16 v[144:159], v[184:187], v[80:83], v[144:159]
ds_read_u16 v116, v116
ds_read_u16 v117, v117
ds_read_b128 v[184:187], v250 offset:6144
v_or_b32_e64 v106, v136, v137
v_exp_f16_sdwa v127, v127 dst_sel:WORD_0 dst_unused:UNUSED_PRESERVE src0_sel:WORD_0
v_cvt_pkrtz_f16_f32 v119, v118, v119
v_and_b32_e64 v119, s49, v119
v_bfe_u32 v118, v119, 2, 14
v_lshrrev_b32_e64 v119, 18, v119
v_exp_f16_sdwa v125, v125 dst_sel:WORD_1 dst_unused:UNUSED_PRESERVE src0_sel:WORD_1
v_or_b32_e64 v107, v138, v139
v_cvt_pkrtz_f16_f32 v121, v120, v121
v_and_b32_e64 v121, s49, v121
v_bfe_u32 v120, v121, 2, 14
v_lshrrev_b32_e64 v121, 18, v121
ds_read_u16 v118, v118
ds_read_u16 v119, v119
ds_read_u16 v120, v120
ds_read_u16 v121, v121
v_mfma_f32_32x32x16_bf16 v[144:159], v[188:191], v[84:87], v[144:159]
ds_read_b128 v[188:191], v250 offset:7168
s_waitcnt vmcnt(0)
v_exp_f16_sdwa v127, v127 dst_sel:WORD_1 dst_unused:UNUSED_PRESERVE src0_sel:WORD_1
v_cvt_pkrtz_f16_f32 v123, v122, v123
v_and_b32 v123, s49, v123
v_mfma_f32_32x32x16_f16 v[128:143], v[104:107], v[216:219], 0
v_bfe_u32 v122, v123, 2, 14
v_lshrrev_b32_e64 v123, 18, v123
v_pk_add_f16 v125, v125, 1.0 op_sel_hi:[1,0]
v_pk_add_f16 v127, v127, 1.0 op_sel_hi:[1,0]
v_rcp_f16_sdwa v125, v125 dst_sel:WORD_0 dst_unused:UNUSED_PRESERVE src0_sel:WORD_0
v_mfma_f32_32x32x16_f16 v[128:143], v[108:111], v[220:223], v[128:143]
ds_read_u16 v122, v122
ds_read_u16 v123, v123
v_permlane16_swap_b32 v104, v108
v_permlane16_swap_b32 v105, v109
v_permlane16_swap_b32 v106, v110
v_permlane16_swap_b32 v107, v111
v_mfma_f32_32x32x16_bf16 v[144:159], v[176:179], v[88:91], v[144:159]
s_waitcnt lgkmcnt(7)
ds_read_b128 v[176:179], v250 offset:8192
v_rcp_f16_sdwa v127, v127 dst_sel:WORD_0 dst_unused:UNUSED_PRESERVE src0_sel:WORD_0
v_rcp_f16_sdwa v125, v125 dst_sel:WORD_1 dst_unused:UNUSED_PRESERVE src0_sel:WORD_1
v_rcp_f16_sdwa v127, v127 dst_sel:WORD_1 dst_unused:UNUSED_PRESERVE src0_sel:WORD_1
v_mfma_f32_32x32x16_bf16 v[144:159], v[180:183], v[92:95], v[144:159]
ds_read_b128 v[180:183], v250 offset:9216
v_fmac_f32 v235, v128, v128
v_pk_mul_f16 v124, v124, v125
v_fmac_f32_e64 v235, v129, v129
v_pk_mul_f16 v126, v126, v127
v_fmac_f32 v235, v130, v130
v_fmac_f32 v235, v131, v131
v_fmac_f32 v235, v132, v132
v_fmac_f32 v235, v133, v133
v_mfma_f32_32x32x16_bf16 v[160:175], v[184:187], v[72:75], 0
ds_read_b128 v[184:187], v250 offset:10240
v_permlane16_swap_b32 v48, v52
v_permlane16_swap_b32 v49, v53
v_permlane16_swap_b32 v50, v54
v_permlane16_swap_b32 v51, v55
v_permlane16_swap_b32 v56, v60
v_permlane16_swap_b32 v57, v61
v_permlane16_swap_b32 v58, v62
v_permlane16_swap_b32 v59, v63
v_permlane16_swap_b32 v64, v68
v_permlane16_swap_b32 v65, v69
v_permlane16_swap_b32 v66, v70
v_permlane16_swap_b32 v67, v71
v_permlane16_swap_b32 v24, v28
v_permlane16_swap_b32 v25, v29
v_permlane16_swap_b32 v26, v30
v_permlane16_swap_b32 v27, v31
v_permlane16_swap_b32 v32, v36
v_permlane16_swap_b32 v33, v37
v_permlane16_swap_b32 v34, v38
v_permlane16_swap_b32 v35, v39
v_permlane16_swap_b32 v40, v44
v_permlane16_swap_b32 v41, v45
v_permlane16_swap_b32 v42, v46
v_permlane16_swap_b32 v43, v47
v_fmac_f32 v235, v134, v134
v_fmac_f32 v235, v135, v135
v_fmac_f32 v235, v136, v136
v_fmac_f32 v235, v137, v137
v_fmac_f32_e64 v235, v138, v138
v_cvt_pkrtz_f16_f32 v145, v144, v145
v_and_b32_e64 v145, s49, v145
v_bfe_u32 v144, v145, 2, 14
v_lshrrev_b32_e64 v145, 18, v145
v_cvt_pk_f16_f32 v154, v154, v155
v_fmac_f32_e64 v235, v139, v139
v_cvt_pk_f16_f32 v156, v156, v157
v_fmac_f32_e64 v235, v140, v140
v_cvt_pk_f16_f32 v158, v158, v159
v_fmac_f32 v235, v141, v141
ds_read_u16 v144, v144
ds_read_u16_d16_hi v145, v145
s_waitcnt lgkmcnt(2)
v_mfma_f32_32x32x16_bf16 v[160:175], v[188:191], v[76:79], v[160:175]
ds_read_b128 v[188:191], v250 offset:11264
v_pk_fma_f16 v155, v154, v154, s48
v_fmac_f32 v235, v142, v142
v_fmac_f32 v235, v143, v143
v_fma_mix_f32 v235, v124, v124, v235 op_sel_hi:[1,1,0]
v_pk_fma_f16 v157, v156, v156, s48
v_fma_mix_f32 v235, v126, v126, v235 op_sel_hi:[1,1,0]
v_cvt_pkrtz_f16_f32 v147, v146, v147
v_fma_mix_f32 v235, v124, v124, v235 op_sel:[1,1,0] op_sel_hi:[1,1,0]
v_and_b32_e64 v147, s49, v147
v_fma_mix_f32 v235, v126, v126, v235 op_sel:[1,1,0] op_sel_hi:[1,1,0]
v_bfe_u32 v146, v147, 2, 14
v_fma_mix_f32 v235, v112, v112, v235 op_sel_hi:[1,1,0]
v_lshrrev_b32_e64 v147, 18, v147
v_fma_mix_f32 v235, v113, v113, v235 op_sel_hi:[1,1,0]
v_pk_fma_f16 v159, v158, v158, s48
v_fma_mix_f32 v235, v114, v114, v235 op_sel_hi:[1,1,0]
v_pk_mul_f16 v155, v154, v155
v_fma_mix_f32 v235, v115, v115, v235 op_sel_hi:[1,1,0]
v_pk_mul_f16 v157, v156, v157
v_fma_mix_f32 v235, v116, v116, v235 op_sel_hi:[1,1,0]
v_pk_mul_f16 v159, v158, v159
v_fma_mix_f32 v235, v117, v117, v235 op_sel_hi:[1,1,0]
v_cvt_pkrtz_f16_f32 v149, v148, v149
v_fma_mix_f32 v235, v118, v118, v235 op_sel_hi:[1,1,0]
v_and_b32_e64 v149, s49, v149
v_fma_mix_f32 v235, v119, v119, v235 op_sel_hi:[1,1,0]
v_bfe_u32 v148, v149, 2, 14
v_lshrrev_b32_e64 v149, 18, v149
ds_read_u16 v146, v146
ds_read_u16_d16_hi v147, v147
ds_read_u16 v148, v148
ds_read_u16_d16_hi v149, v149
v_exp_f16_sdwa v155, v155 dst_sel:WORD_0 dst_unused:UNUSED_PRESERVE src0_sel:WORD_0
v_mfma_f32_32x32x16_bf16 v[160:175], v[176:179], v[80:83], v[160:175]
v_fma_mix_f32 v235, v120, v120, v235 op_sel_hi:[1,1,0]
v_exp_f16_sdwa v157, v157 dst_sel:WORD_0 dst_unused:UNUSED_PRESERVE src0_sel:WORD_0
v_fma_mix_f32 v235, v121, v121, v235 op_sel_hi:[1,1,0]
v_cvt_pkrtz_f16_f32 v151, v150, v151
v_and_b32_e64 v151, s49, v151
v_bfe_u32 v150, v151, 2, 14
v_lshrrev_b32_e64 v151, 18, v151
v_exp_f16_sdwa v159, v159 dst_sel:WORD_0 dst_unused:UNUSED_PRESERVE src0_sel:WORD_0
v_fma_mix_f32 v235, v122, v122, v235 op_sel_hi:[1,1,0]
v_exp_f16_sdwa v155, v155 dst_sel:WORD_1 dst_unused:UNUSED_PRESERVE src0_sel:WORD_1
v_fma_mix_f32 v235, v123, v123, v235 op_sel_hi:[1,1,0]
v_mfma_f32_32x32x16_bf16 v[160:175], v[180:183], v[84:87], v[160:175]
ds_read_u16 v150, v150
ds_read_u16_d16_hi v151, v151
v_permlane32_swap_b32 v234, v235
v_add_f32 v234, v234, v235
v_exp_f16_sdwa v157, v157 dst_sel:WORD_1 dst_unused:UNUSED_PRESERVE src0_sel:WORD_1
v_cvt_pkrtz_f16_f32 v153, v152, v153
v_and_b32_e64 v153, s49, v153
v_bfe_u32 v152, v153, 2, 14
v_lshrrev_b32_e64 v153, 18, v153
v_exp_f16_sdwa v159, v159 dst_sel:WORD_1 dst_unused:UNUSED_PRESERVE src0_sel:WORD_1
ds_write_b32 v248, v234 offset:8704
s_setprio 3
v_mov_b32 v238, 1
s_waitcnt lgkmcnt(0)
s_mov_b64 exec, 1
ds_add_rtn_u32 v239, v247, v238 offset:0
s_mov_b64 exec, -1
s_waitcnt lgkmcnt(0)
v_readfirstlane_b32 s43, v239
s_nop 1
s_cmp_lg_u32 s43, 7
s_cbranch_scc1 Lnopub
ds_read_b128 v[128:131], v244
ds_read_b128 v[132:135], v244 offset:16
ds_read_b128 v[136:139], v244 offset:9216
ds_read_b128 v[140:143], v244 offset:9232
ds_read_b128 v[112:115], v244 offset:18432
ds_read_b128 v[116:119], v244 offset:18448
ds_read_b128 v[120:123], v244 offset:27648
ds_read_b128 v[124:127], v244 offset:27664
ds_read_b128 v[216:219], v244 offset:36864
ds_read_b128 v[220:223], v244 offset:36880
s_waitcnt lgkmcnt(7)
v_add_f32 v128, v128, v136
v_add_f32 v129, v129, v137
v_add_f32 v130, v130, v138
v_add_f32 v131, v131, v139
s_waitcnt lgkmcnt(6)
v_add_f32 v132, v132, v140
v_add_f32 v133, v133, v141
v_add_f32 v134, v134, v142
v_add_f32 v135, v135, v143
ds_read_b128 v[136:139], v244 offset:46080
ds_read_b128 v[140:143], v244 offset:46096
s_waitcnt lgkmcnt(7)
v_add_f32 v128, v128, v112
v_add_f32 v129, v129, v113
v_add_f32 v130, v130, v114
v_add_f32 v131, v131, v115
s_waitcnt lgkmcnt(6)
v_add_f32 v132, v132, v116
v_add_f32 v133, v133, v117
v_add_f32 v134, v134, v118
v_add_f32 v135, v135, v119
ds_read_b128 v[112:115], v244 offset:55296
ds_read_b128 v[116:119], v244 offset:55312
s_waitcnt lgkmcnt(7)
v_add_f32 v128, v128, v120
v_add_f32 v129, v129, v121
v_add_f32 v130, v130, v122
v_add_f32 v131, v131, v123
s_waitcnt lgkmcnt(6)
v_add_f32 v132, v132, v124
v_add_f32 v133, v133, v125
v_add_f32 v134, v134, v126
v_add_f32 v135, v135, v127
ds_read_b128 v[120:123], v244 offset:64512
ds_read_b128 v[124:127], v244 offset:64528
s_waitcnt lgkmcnt(7)
v_add_f32 v128, v128, v216
v_add_f32 v129, v129, v217
v_add_f32 v130, v130, v218
v_add_f32 v131, v131, v219
s_waitcnt lgkmcnt(6)
v_add_f32 v132, v132, v220
v_add_f32 v133, v133, v221
v_add_f32 v134, v134, v222
v_add_f32 v135, v135, v223
s_waitcnt lgkmcnt(5)
v_add_f32 v128, v128, v136
v_add_f32 v129, v129, v137
v_add_f32 v130, v130, v138
v_add_f32 v131, v131, v139
s_waitcnt lgkmcnt(4)
v_add_f32 v132, v132, v140
v_add_f32 v133, v133, v141
v_add_f32 v134, v134, v142
v_add_f32 v135, v135, v143
s_waitcnt lgkmcnt(3)
v_add_f32 v128, v128, v112
v_add_f32 v129, v129, v113
v_add_f32 v130, v130, v114
v_add_f32 v131, v131, v115
s_waitcnt lgkmcnt(2)
v_add_f32 v132, v132, v116
v_add_f32 v133, v133, v117
v_add_f32 v134, v134, v118
v_add_f32 v135, v135, v119
s_waitcnt lgkmcnt(1)
v_add_f32 v128, v128, v120
v_add_f32 v129, v129, v121
v_add_f32 v130, v130, v122
v_add_f32 v131, v131, v123
s_waitcnt lgkmcnt(0)
v_add_f32 v132, v132, v124
v_add_f32 v133, v133, v125
v_add_f32 v134, v134, v126
v_add_f32 v135, v135, v127
v_min_u32 v216, -2, v128
v_min_u32 v217, -2, v129
v_min_u32 v218, -2, v130
v_min_u32 v219, -2, v131
v_min_u32 v220, -2, v132
v_min_u32 v221, -2, v133
v_min_u32_e64 v222, -2, v134
v_min_u32 v223, -2, v135
s_lshl_b32 s43, s2, 4
buffer_store_dwordx4 v[216:219], v237, s[32:35], s43 offen sc1
buffer_store_dwordx4 v[220:223], v245, s[32:35], s43 offen sc1
ds_write_b32 v247, v238 offset:4
s_waitcnt lgkmcnt(0)
s_nop 1
Lnopub:
s_mov_b32 s77, 0
v_bfe_u32 v244, v250, 8, 2
v_lshlrev_b32 v244, 3, v244
s_cmp_lg_u32 s40, 0
s_cbranch_scc1 Lnorole
v_subrev_u32 v245, 16384, v250
v_lshrrev_b32_e64 v240, 1, v245
v_add_u32 v240, v240, v245
s_cmp_lt_u32 s2, 96
s_cselect_b32 s77, 1, 2
s_cbranch_scc1 Lred
s_and_b32 s44, s2, 7
s_lshl_b32 s44, s44, 11
s_add_u32 s44, s44, 393216
s_waitcnt lgkmcnt(0)
buffer_load_dwordx2 v[128:129], v240, s[32:35], s44 offen sc1
buffer_load_dwordx2 v[130:131], v240, s[32:35], s44 offen offset:8 sc1
buffer_load_dwordx2 v[132:133], v240, s[32:35], s44 offen offset:16 sc1
v_lshrrev_b32_e64 v241, 1, v240
buffer_load_dword v135, v241, s[24:27], 0 offen
buffer_load_dword v137, v241, s[24:27], 0 offen offset:4
buffer_load_dword v139, v241, s[24:27], 0 offen offset:8
s_branch Lnorole
Lred:
s_lshl_b32 s44, s2, 12
s_waitcnt vmcnt(4)
buffer_load_dwordx4 v[128:131], v245, s[32:35], s44 offen sc1
s_waitcnt vmcnt(3)
buffer_load_dwordx4 v[132:135], v245, s[32:35], s44 offen offset:1024 sc1
s_waitcnt vmcnt(2)
buffer_load_dwordx4 v[136:139], v245, s[32:35], s44 offen offset:2048 sc1
buffer_load_dwordx4 v[140:143], v245, s[32:35], s44 offen offset:3072 sc1
Lnorole:
s_setprio 0
ds_read_u16 v152, v152
ds_read_u16_d16_hi v153, v153
v_pk_add_f16 v155, v155, 1.0 op_sel_hi:[1,0]
v_pk_add_f16 v157, v157, 1.0 op_sel_hi:[1,0]
v_mfma_f32_32x32x16_bf16 v[160:175], v[184:187], v[88:91], v[160:175]
v_pk_add_f16 v159, v159, 1.0 op_sel_hi:[1,0]
v_rcp_f16_sdwa v155, v155 dst_sel:WORD_0 dst_unused:UNUSED_PRESERVE src0_sel:WORD_0
v_rcp_f16_sdwa v157, v157 dst_sel:WORD_0 dst_unused:UNUSED_PRESERVE src0_sel:WORD_0
v_rcp_f16_sdwa v159, v159 dst_sel:WORD_0 dst_unused:UNUSED_PRESERVE src0_sel:WORD_0
v_mfma_f32_32x32x16_bf16 v[160:175], v[188:191], v[92:95], v[160:175]
ds_read_b128 v[176:179], v250 offset:55296
ds_read_b128 v[180:183], v250 offset:56320
ds_read_b128 v[184:187], v250 offset:57344
v_rcp_f16_sdwa v155, v155 dst_sel:WORD_1 dst_unused:UNUSED_PRESERVE src0_sel:WORD_1
v_rcp_f16_sdwa v157, v157 dst_sel:WORD_1 dst_unused:UNUSED_PRESERVE src0_sel:WORD_1
v_rcp_f16_sdwa v159, v159 dst_sel:WORD_1 dst_unused:UNUSED_PRESERVE src0_sel:WORD_1
s_waitcnt lgkmcnt(5)
v_or_b32 v112, v144, v145
v_pk_mul_f16 v115, v154, v155
v_pk_mul_f16 v118, v156, v157
v_pk_mul_f16 v119, v158, v159
s_nop 0
v_cvt_pkrtz_f16_f32 v161, v160, v161
ds_read_b128 v[188:191], v250 offset:58368
v_and_b32 v161, s49, v161
v_bfe_u32 v160, v161, 2, 14
v_lshrrev_b32_e64 v161, 18, v161
v_cvt_pk_f16_f32 v170, v170, v171
v_or_b32_e64 v113, v146, v147
v_cvt_pk_f16_f32 v172, v172, v173
v_cvt_pk_f16_f32 v174, v174, v175
v_pk_fma_f16 v171, v170, v170, s48
v_pk_fma_f16 v173, v172, v172, s48
ds_read_u16 v160, v160
ds_read_u16_d16_hi v161, v161
v_cvt_pkrtz_f16_f32 v163, v162, v163
v_and_b32_e64 v163, s49, v163
v_bfe_u32 v162, v163, 2, 14
v_lshrrev_b32 v163, 18, v163
v_or_b32 v116, v148, v149
v_pk_fma_f16 v175, v174, v174, s48
v_pk_mul_f16 v171, v170, v171
v_pk_mul_f16 v173, v172, v173
v_pk_mul_f16 v175, v174, v175
v_cvt_pkrtz_f16_f32 v165, v164, v165
ds_read_u16 v162, v162
ds_read_u16_d16_hi v163, v163
s_cmp_eq_u32 s77, 0
s_cbranch_scc1 Lpp1
s_call_b64 s[78:79], Lpolln
Lpp1:
v_and_b32 v165, s49, v165
v_bfe_u32 v164, v165, 2, 14
v_lshrrev_b32 v165, 18, v165
v_or_b32 v117, v150, v151
v_exp_f16_sdwa v171, v171 dst_sel:WORD_0 dst_unused:UNUSED_PRESERVE src0_sel:WORD_0
v_exp_f16_sdwa v173, v173 dst_sel:WORD_0 dst_unused:UNUSED_PRESERVE src0_sel:WORD_0
v_cvt_pkrtz_f16_f32 v167, v166, v167
v_and_b32_e64 v167, s49, v167
v_bfe_u32 v166, v167, 2, 14
ds_read_u16 v164, v164
ds_read_u16_d16_hi v165, v165
v_lshrrev_b32_e64 v167, 18, v167
v_exp_f16_sdwa v175, v175 dst_sel:WORD_0 dst_unused:UNUSED_PRESERVE src0_sel:WORD_0
s_waitcnt lgkmcnt(6)
v_or_b32 v114, v152, v153
v_exp_f16_sdwa v171, v171 dst_sel:WORD_1 dst_unused:UNUSED_PRESERVE src0_sel:WORD_1
v_mfma_f32_32x32x16_bf16 v[144:159], v[176:179], v[72:75], 0
ds_read_u16 v166, v166
ds_read_u16_d16_hi v167, v167
ds_read_b128 v[176:179], v250 offset:59392
v_exp_f16_sdwa v173, v173 dst_sel:WORD_1 dst_unused:UNUSED_PRESERVE src0_sel:WORD_1
v_cvt_pkrtz_f16_f32 v169, v168, v169
v_and_b32_e64 v169, s49, v169
v_bfe_u32 v168, v169, 2, 14
v_lshrrev_b32_e64 v169, 18, v169
v_permlane16_swap_b32 v112, v116
v_permlane16_swap_b32 v113, v117
v_permlane16_swap_b32 v114, v118
v_permlane16_swap_b32 v115, v119
v_mfma_f32_32x32x16_bf16 v[144:159], v[180:183], v[76:79], v[144:159]
ds_read_u16 v168, v168
ds_read_u16_d16_hi v169, v169
s_cmp_eq_u32 s77, 0
s_cbranch_scc1 Lpp2
s_nop 9
s_call_b64 s[78:79], Lpolln
Lpp2:
ds_read_b128 v[180:183], v250 offset:60416
v_exp_f16_sdwa v175, v175 dst_sel:WORD_1 dst_unused:UNUSED_PRESERVE src0_sel:WORD_1
v_pk_add_f16 v171, v171, 1.0 op_sel_hi:[1,0]
v_pk_add_f16 v173, v173, 1.0 op_sel_hi:[1,0]
v_mfma_f32_32x32x16_bf16 v[144:159], v[184:187], v[80:83], v[144:159]
v_pk_add_f16 v175, v175, 1.0 op_sel_hi:[1,0]
v_rcp_f16_sdwa v171, v171 dst_sel:WORD_0 dst_unused:UNUSED_PRESERVE src0_sel:WORD_0
v_rcp_f16_sdwa v173, v173 dst_sel:WORD_0 dst_unused:UNUSED_PRESERVE src0_sel:WORD_0
v_mfma_f32_32x32x16_bf16 v[144:159], v[188:191], v[84:87], v[144:159]
v_rcp_f16_sdwa v175, v175 dst_sel:WORD_0 dst_unused:UNUSED_PRESERVE src0_sel:WORD_0
v_rcp_f16_sdwa v171, v171 dst_sel:WORD_1 dst_unused:UNUSED_PRESERVE src0_sel:WORD_1
v_rcp_f16_sdwa v173, v173 dst_sel:WORD_1 dst_unused:UNUSED_PRESERVE src0_sel:WORD_1
s_waitcnt lgkmcnt(3)
v_mfma_f32_32x32x16_bf16 v[144:159], v[176:179], v[88:91], v[144:159]
s_cmp_eq_u32 s77, 0
s_cbranch_scc1 Lpp3
s_nop 11
s_call_b64 s[78:79], Lpolln
Lpp3:
v_rcp_f16_sdwa v175, v175 dst_sel:WORD_1 dst_unused:UNUSED_PRESERVE src0_sel:WORD_1
v_or_b32 v216, v160, v161
v_pk_mul_f16 v219, v170, v171
v_pk_mul_f16 v222, v172, v173
v_pk_mul_f16 v223, v174, v175
v_or_b32 v217, v162, v163
v_or_b32 v220, v164, v165
v_or_b32 v221, v166, v167
s_waitcnt lgkmcnt(0)
v_mfma_f32_32x32x16_bf16 v[144:159], v[180:183], v[92:95], v[144:159]
s_mul_i32 s43, s40, 96
buffer_load_dwordx2 v[176:177], v244, s[28:31], s43 offen
buffer_load_dwordx2 v[178:179], v244, s[28:31], s43 offen offset:32
buffer_load_dwordx2 v[180:181], v244, s[28:31], s43 offen offset:64
v_mov_b32 v249, 0
s_branch Law6
Lax6:
s_sleep 2
Law6:
ds_read_b32 v249, v247 offset:4
s_sub_u32 s76, s76, 1
s_cselect_b32 s44, 1, 0
s_cselect_b32 s76, 0, s76
s_waitcnt lgkmcnt(0)
v_readfirstlane_b32 s43, v249
s_nop 1
s_max_u32 s43, s43, s44
s_cmp_lt_u32 s43, 1
s_cbranch_scc1 Lax6
s_add_u32 m0, s72, 5120
s_add_u32 s43, s82, 3200
buffer_load_dwordx4 v246, s[16:19], s43 offen lds
s_add_u32 m0, s72, 8192
s_add_u32 s43, s82, 6272
buffer_load_dwordx4 v246, s[16:19], s43 offen lds
v_or_b32_e64 v218, v168, v169
v_cvt_pkrtz_f16_f32 v145, v144, v145
v_and_b32_e64 v145, s49, v145
v_bfe_u32 v144, v145, 2, 14
v_lshrrev_b32_e64 v145, 18, v145
v_cvt_pk_f16_f32 v154, v154, v155
v_cvt_pk_f16_f32 v156, v156, v157
v_cvt_pk_f16_f32 v158, v158, v159
v_pk_fma_f16 v155, v154, v154, s48
v_pk_fma_f16 v157, v156, v156, s48
v_cvt_pkrtz_f16_f32 v147, v146, v147
ds_read_u16 v144, v144
ds_read_u16_d16_hi v145, v145
s_cmp_eq_u32 s77, 0
s_cbranch_scc1 Lpp4
s_call_b64 s[78:79], Lpolln
Lpp4:
v_and_b32 v147, s49, v147
v_bfe_u32 v146, v147, 2, 14
v_lshrrev_b32_e64 v147, 18, v147
v_pk_fma_f16 v159, v158, v158, s48
v_pk_mul_f16 v155, v154, v155
v_pk_mul_f16 v157, v156, v157
v_pk_mul_f16 v159, v158, v159
v_cvt_pkrtz_f16_f32 v149, v148, v149
v_and_b32_e64 v149, s49, v149
ds_read_u16 v146, v146
ds_read_u16_d16_hi v147, v147
v_bfe_u32 v148, v149, 2, 14
v_lshrrev_b32_e64 v149, 18, v149
v_exp_f16_sdwa v155, v155 dst_sel:WORD_0 dst_unused:UNUSED_PRESERVE src0_sel:WORD_0
v_exp_f16_sdwa v157, v157 dst_sel:WORD_0 dst_unused:UNUSED_PRESERVE src0_sel:WORD_0
v_cvt_pkrtz_f16_f32 v151, v150, v151
v_and_b32_e64 v151, s49, v151
v_bfe_u32 v150, v151, 2, 14
v_lshrrev_b32_e64 v151, 18, v151
ds_read_u16 v148, v148
ds_read_u16_d16_hi v149, v149
ds_read_u16 v150, v150
ds_read_u16_d16_hi v151, v151
v_exp_f16_sdwa v159, v159 dst_sel:WORD_0 dst_unused:UNUSED_PRESERVE src0_sel:WORD_0
s_cmp_eq_u32 s77, 0
s_cbranch_scc1 Lpp5
s_call_b64 s[78:79], Lpolln
Lpp5:
s_setprio 3
v_exp_f16_sdwa v155, v155 dst_sel:WORD_1 dst_unused:UNUSED_PRESERVE src0_sel:WORD_1
v_exp_f16_sdwa v157, v157 dst_sel:WORD_1 dst_unused:UNUSED_PRESERVE src0_sel:WORD_1
v_cvt_pkrtz_f16_f32 v153, v152, v153
v_and_b32_e64 v153, s49, v153
v_bfe_u32 v152, v153, 2, 14
v_lshrrev_b32_e64 v153, 18, v153
v_permlane16_swap_b32 v216, v220
v_permlane16_swap_b32 v217, v221
v_permlane16_swap_b32 v218, v222
v_permlane16_swap_b32 v219, v223
v_exp_f16_sdwa v159, v159 dst_sel:WORD_1 dst_unused:UNUSED_PRESERVE src0_sel:WORD_1
v_pk_add_f16 v155, v155, 1.0 op_sel_hi:[1,0]
ds_read_u16 v152, v152
ds_read_u16_d16_hi v153, v153
v_bfe_u32 v190, v250, 4, 6
v_lshl_add_u32 v186, v190, 4, s72
s_mul_i32 s43, s40, 3
s_add_u32 s43, s43, 0
s_and_b32 s44, s43, 1
s_mul_i32 s44, s44, 3064
s_mul_i32 s43, s43, 3072
s_sub_u32 s43, s43, s44
s_add_u32 s43, s43, 90112
v_lshl_add_u32 v173, v190, 4, s43
s_mul_i32 s43, s40, 3
s_add_u32 s43, s43, 1
s_and_b32 s44, s43, 1
s_mul_i32 s44, s44, 3064
s_mul_i32 s43, s43, 3072
s_sub_u32 s43, s43, s44
s_add_u32 s43, s43, 90112
v_lshl_add_u32 v174, v190, 4, s43
s_mul_i32 s43, s40, 3
s_add_u32 s43, s43, 2
s_and_b32 s44, s43, 1
s_mul_i32 s44, s44, 3064
s_mul_i32 s43, s43, 3072
s_sub_u32 s43, s43, s44
s_add_u32 s43, s43, 90112
v_lshl_add_u32 v175, v190, 4, s43
v_lshl_add_u32 v187, v244, 2, s72
v_and_b32_e64 v189, 3, v190
v_bfe_u32 v191, v190, 2, 1
v_lshl_add_u32 v189, v191, 3, v189
v_bfe_u32 v191, v190, 3, 1
v_lshl_add_u32 v189, v191, 2, v189
v_bfe_u32 v191, v190, 4, 1
v_lshl_add_u32 v189, v191, 6, v189
v_bfe_u32 v191, v190, 5, 1
v_lshl_add_u32 v189, v191, 5, v189
v_lshlrev_b32_e64 v189, 4, v189
v_add_u32 v248, 16384, v189
v_add_u32 v249, 53248, v189
v_min_u32 v189, 11, v190
s_mul_i32 s43, s40, 12
v_add_u32 v189, s43, v189
v_cmp_gt_u32 vcc, 64, v189
v_lshlrev_b32_e64 v189, 2, v189
v_add_u32 v172, 93312, v189
v_add_u32 v191, 16128, v189
v_add_u32 v189, 7680, v189
v_cndmask_b32 v189, v189, v191, vcc
v_add_u32 v188, s72, v244
v_lshrrev_b32_e64 v191, 3, v190
v_mul_u32_u24 v191, 9120, v191
v_mul_u32_u24 v190, 12, v190
v_add_u32 v191, v191, v190
v_add_u32 v191, 93184, v191
ds_read_b64_tr_b16 v[72:73], v186
ds_read_b64_tr_b16 v[74:75], v186 offset:8
ds_read_b64_tr_b16 v[84:85], v186 offset:3072
ds_read_b64_tr_b16 v[86:87], v186 offset:3080
ds_read_b64_tr_b16 v[160:161], v186 offset:6144
s_waitcnt lgkmcnt(6)
ds_read_b64_tr_b16 v[162:163], v186 offset:6152
v_pk_add_f16 v157, v157, 1.0 op_sel_hi:[1,0]
v_pk_add_f16 v159, v159, 1.0 op_sel_hi:[1,0]
v_rcp_f16_sdwa v155, v155 dst_sel:WORD_0 dst_unused:UNUSED_PRESERVE src0_sel:WORD_0
s_cmp_eq_u32 s77, 0
s_cbranch_scc1 Lpp6
s_call_b64 s[78:79], Lpolln
Lpp6:
v_rcp_f16_sdwa v157, v157 dst_sel:WORD_0 dst_unused:UNUSED_PRESERVE src0_sel:WORD_0
v_rcp_f16_sdwa v159, v159 dst_sel:WORD_0 dst_unused:UNUSED_PRESERVE src0_sel:WORD_0
v_rcp_f16_sdwa v155, v155 dst_sel:WORD_1 dst_unused:UNUSED_PRESERVE src0_sel:WORD_1
v_rcp_f16_sdwa v157, v157 dst_sel:WORD_1 dst_unused:UNUSED_PRESERVE src0_sel:WORD_1
v_rcp_f16_sdwa v159, v159 dst_sel:WORD_1 dst_unused:UNUSED_PRESERVE src0_sel:WORD_1
s_waitcnt vmcnt(4) lgkmcnt(5)
v_mfma_f32_16x16x16_bf16 v[120:123], v[72:73], v[176:177], 0
ds_read_b64_tr_b16 v[76:77], v186 offset:1024
ds_read_b64_tr_b16 v[78:79], v186 offset:1032
ds_read_b64_tr_b16 v[88:89], v186 offset:4096
ds_read_b64_tr_b16 v[90:91], v186 offset:4104
ds_read_b64_tr_b16 v[164:165], v186 offset:7168
ds_read_b64_tr_b16 v[166:167], v186 offset:7176
s_waitcnt lgkmcnt(10)
v_mfma_f32_16x16x16_bf16 v[124:127], v[74:75], v[176:177], 0
v_lshlrev_b32 v182, 16, v72
v_and_b32 v183, 4294901760, v72
s_waitcnt vmcnt(3) lgkmcnt(9)
v_mfma_f32_16x16x16_bf16 v[120:123], v[84:85], v[178:179], v[120:123]
v_cvt_pk_f16_f32 v72, v182, v183
v_lshlrev_b32 v184, 16, v73
s_waitcnt lgkmcnt(7)
v_mfma_f32_16x16x16_bf16 v[124:127], v[86:87], v[178:179], v[124:127]
v_and_b32 v185, 4294901760, v73
v_cvt_pk_f16_f32 v73, v184, v185
s_waitcnt vmcnt(2)
v_mfma_f32_16x16x16_bf16 v[120:123], v[160:161], v[180:181], v[120:123]
v_or_b32 v232, v144, v145
v_pk_mul_f16 v235, v154, v155
s_waitcnt lgkmcnt(6)
v_mfma_f32_16x16x16_bf16 v[124:127], v[162:163], v[180:181], v[124:127]
s_setprio 2
v_lshlrev_b32_e64 v182, 16, v74
v_and_b32 v183, 4294901760, v74
v_cvt_pk_f16_f32 v74, v182, v183
v_pk_mul_f16 v238, v156, v157
s_cmp_eq_u32 s77, 0
s_cbranch_scc1 Lpp7
s_nop 2
s_call_b64 s[78:79], Lpolln
Lpp7:
v_lshlrev_b32_e64 v184, 16, v75
v_and_b32 v185, 4294901760, v75
v_cvt_pk_f16_f32 v75, v184, v185
v_pk_mul_f16 v239, v158, v159
v_lshlrev_b32_e64 v182, 16, v84
v_and_b32 v183, 4294901760, v84
v_or_b32_e64 v233, v146, v147
s_mov_b32 exec_lo, 65537
s_mov_b32 exec_hi, 65537
ds_write_b128 v187, v[120:123] offset:3200
ds_write_b128 v187, v[124:127] offset:3216
s_mov_b64 exec, -1
v_cvt_pk_f16_f32 v84, v182, v183
v_lshlrev_b32 v184, 16, v85
v_and_b32 v185, 4294901760, v85
v_cvt_pk_f16_f32 v85, v184, v185
v_lshlrev_b32_e64 v182, 16, v86
v_and_b32 v183, 4294901760, v86
v_cvt_pk_f16_f32 v86, v182, v183
v_or_b32 v236, v148, v149
v_lshlrev_b32 v184, 16, v87
v_and_b32 v185, 4294901760, v87
v_cvt_pk_f16_f32 v87, v184, v185
v_lshlrev_b32_e64 v182, 16, v160
v_and_b32 v183, 4294901760, v160
ds_read_b64_tr_b16 v[80:81], v186 offset:2048
ds_read_b64_tr_b16 v[82:83], v186 offset:2056
v_cvt_pk_f16_f32 v160, v182, v183
v_lshlrev_b32_e64 v184, 16, v161
v_and_b32 v185, 4294901760, v161
v_cvt_pk_f16_f32 v161, v184, v185
v_or_b32 v237, v150, v151
v_lshlrev_b32 v182, 16, v162
v_and_b32 v183, 4294901760, v162
v_cvt_pk_f16_f32 v162, v182, v183
s_cmp_eq_u32 s77, 0
s_cbranch_scc1 Lpp8
s_call_b64 s[78:79], Lpolln
Lpp8:
v_lshlrev_b32 v184, 16, v163
v_and_b32 v185, 4294901760, v163
v_cvt_pk_f16_f32 v163, v184, v185
s_waitcnt lgkmcnt(9)
v_mfma_f32_16x16x16_bf16 v[120:123], v[76:77], v[176:177], 0
v_or_b32 v234, v152, v153
v_lshlrev_b32 v182, 16, v76
s_waitcnt lgkmcnt(8)
v_mfma_f32_16x16x16_bf16 v[124:127], v[78:79], v[176:177], 0
v_and_b32 v183, 4294901760, v76
v_cvt_pk_f16_f32 v76, v182, v183
s_waitcnt lgkmcnt(7)
v_mfma_f32_16x16x16_bf16 v[120:123], v[88:89], v[178:179], v[120:123]
v_lshlrev_b32_e64 v184, 16, v77
v_and_b32 v185, 4294901760, v77
s_waitcnt lgkmcnt(6)
v_mfma_f32_16x16x16_bf16 v[124:127], v[90:91], v[178:179], v[124:127]
v_cvt_pk_f16_f32 v77, v184, v185
v_lshlrev_b32 v182, 16, v78
s_waitcnt lgkmcnt(0)
v_mfma_f32_16x16x16_bf16 v[120:123], v[164:165], v[180:181], v[120:123]
v_and_b32 v183, 4294901760, v78
v_cvt_pk_f16_f32 v78, v182, v183
v_mfma_f32_16x16x16_bf16 v[124:127], v[166:167], v[180:181], v[124:127]
s_setprio 1
v_permlane16_swap_b32 v232, v236
v_permlane16_swap_b32 v233, v237
v_permlane16_swap_b32 v234, v238
v_permlane16_swap_b32 v235, v239
v_lshlrev_b32 v184, 16, v79
v_and_b32 v185, 4294901760, v79
v_cvt_pk_f16_f32 v79, v184, v185
v_lshlrev_b32_e64 v182, 16, v88
v_and_b32 v183, 4294901760, v88
v_cvt_pk_f16_f32 v88, v182, v183
s_mov_b32 exec_lo, 65537
s_mov_b32 exec_hi, 65537
ds_write_b128 v187, v[120:123] offset:3328
ds_write_b128 v187, v[124:127] offset:3344
s_mov_b64 exec, -1
v_lshlrev_b32 v184, 16, v89
v_and_b32 v185, 4294901760, v89
v_cvt_pk_f16_f32 v89, v184, v185
s_cmp_eq_u32 s77, 0
s_cbranch_scc1 Lpp9
s_call_b64 s[78:79], Lpolln
Lpp9:
v_lshlrev_b32_e64 v182, 16, v90
v_and_b32 v183, 4294901760, v90
v_cvt_pk_f16_f32 v90, v182, v183
s_waitcnt vmcnt(0)
ds_read_b64_tr_b16 v[92:93], v186 offset:5120
ds_read_b64_tr_b16 v[94:95], v186 offset:5128
ds_read_b64_tr_b16 v[168:169], v186 offset:8192
ds_read_b64_tr_b16 v[170:171], v186 offset:8200
v_lshlrev_b32_e64 v184, 16, v91
v_and_b32 v185, 4294901760, v91
v_cvt_pk_f16_f32 v91, v184, v185
v_lshlrev_b32_e64 v182, 16, v164
v_and_b32 v183, 4294901760, v164
v_cvt_pk_f16_f32 v164, v182, v183
v_lshlrev_b32_e64 v184, 16, v165
v_and_b32 v185, 4294901760, v165
v_cvt_pk_f16_f32 v165, v184, v185
v_lshlrev_b32_e64 v182, 16, v166
v_and_b32 v183, 4294901760, v166
v_cvt_pk_f16_f32 v166, v182, v183
v_lshlrev_b32_e64 v184, 16, v167
v_and_b32 v185, 4294901760, v167
v_cvt_pk_f16_f32 v167, v184, v185
v_mfma_f32_16x16x16_bf16 v[120:123], v[80:81], v[176:177], 0
v_lshlrev_b32_e64 v182, 16, v80
v_and_b32 v183, 4294901760, v80
v_mfma_f32_16x16x16_bf16 v[124:127], v[82:83], v[176:177], 0
v_cvt_pk_f16_f32 v80, v182, v183
v_lshlrev_b32 v184, 16, v81
s_waitcnt lgkmcnt(3)
v_mfma_f32_16x16x16_bf16 v[120:123], v[92:93], v[178:179], v[120:123]
v_and_b32 v185, 4294901760, v81
v_cvt_pk_f16_f32 v81, v184, v185
s_waitcnt lgkmcnt(1)
v_mfma_f32_16x16x16_bf16 v[124:127], v[94:95], v[178:179], v[124:127]
v_lshlrev_b32 v182, 16, v82
v_and_b32 v183, 4294901760, v82
v_mfma_f32_16x16x16_bf16 v[120:123], v[168:169], v[180:181], v[120:123]
v_cvt_pk_f16_f32 v82, v182, v183
v_lshlrev_b32_e64 v184, 16, v83
s_waitcnt lgkmcnt(0)
v_mfma_f32_16x16x16_bf16 v[124:127], v[170:171], v[180:181], v[124:127]
s_cmp_eq_u32 s77, 0
s_cbranch_scc1 Lpp10
s_nop 7
s_call_b64 s[78:79], Lpolln
Lpp10:
s_setprio 0
v_and_b32 v185, 4294901760, v83
v_cvt_pk_f16_f32 v83, v184, v185
v_lshlrev_b32_e64 v182, 16, v92
v_and_b32 v183, 4294901760, v92
v_cvt_pk_f16_f32 v92, v182, v183
v_lshlrev_b32_e64 v184, 16, v93
v_and_b32 v185, 4294901760, v93
v_cvt_pk_f16_f32 v93, v184, v185
s_mov_b32 exec_lo, 65537
s_mov_b32 exec_hi, 65537
ds_write_b128 v187, v[120:123] offset:3456
ds_write_b128 v187, v[124:127] offset:3472
s_mov_b64 exec, -1
ds_read_b128 v[120:123], v248
ds_read_b128 v[124:127], v248 offset:2048
v_lshlrev_b32 v182, 16, v94
v_and_b32 v183, 4294901760, v94
v_cvt_pk_f16_f32 v94, v182, v183
v_lshlrev_b32_e64 v184, 16, v95
v_and_b32 v185, 4294901760, v95
v_cvt_pk_f16_f32 v95, v184, v185
s_cmp_eq_u32 s77, 0
s_cbranch_scc1 Lpp11
s_call_b64 s[78:79], Lpolln
Lpp11:
v_lshlrev_b32 v182, 16, v168
v_and_b32 v183, 4294901760, v168
v_cvt_pk_f16_f32 v168, v182, v183
v_lshlrev_b32_e64 v184, 16, v169
v_and_b32 v185, 4294901760, v169
v_cvt_pk_f16_f32 v169, v184, v185
v_lshlrev_b32_e64 v182, 16, v170
v_and_b32 v183, 4294901760, v170
v_cvt_pk_f16_f32 v170, v182, v183
v_lshlrev_b32_e64 v184, 16, v171
v_and_b32 v185, 4294901760, v171
v_cvt_pk_f16_f32 v171, v184, v185
s_cmp_eq_u32 s77, 0
s_cbranch_scc1 Lpp12
s_call_b64 s[78:79], Lpolln
Lpp12:
s_waitcnt lgkmcnt(0)
s_barrier
s_setprio 2
ds_read_b32 v176, v172
ds_read_b32 v177, v172 offset:9216
ds_read_b32 v178, v172 offset:18432
ds_read_b32 v179, v172 offset:27648
ds_read_b32 v180, v172 offset:36864
ds_read_b32 v181, v172 offset:46080
ds_read_b32 v182, v172 offset:55296
ds_read_b32 v183, v172 offset:64512
v_mfma_f32_16x16x32_bf16 v[144:147], v[120:123], v[48:51], 0
s_cmp_eq_u32 s77, 0
s_cbranch_scc1 Lpp13
s_nop 7
s_call_b64 s[78:79], Lpolln
Lpp13:
v_mfma_f32_16x16x32_bf16 v[148:151], v[120:123], v[52:55], 0
v_mfma_f32_16x16x32_bf16 v[152:155], v[120:123], v[24:27], 0
ds_read_b128 v[120:123], v248 offset:4096
v_mfma_f32_16x16x32_bf16 v[144:147], v[124:127], v[56:59], v[144:147]
s_waitcnt lgkmcnt(7)
v_add_f32 v176, v176, v177
v_mfma_f32_16x16x32_bf16 v[148:151], v[124:127], v[60:63], v[148:151]
s_waitcnt lgkmcnt(6)
v_add_f32 v176, v176, v178
s_waitcnt lgkmcnt(5)
v_add_f32 v176, v176, v179
s_cmp_eq_u32 s77, 0
s_cbranch_scc1 Lpp14
s_nop 3
s_call_b64 s[78:79], Lpolln
Lpp14:
s_waitcnt lgkmcnt(4)
v_add_f32 v176, v176, v180
s_waitcnt lgkmcnt(3)
v_add_f32 v176, v176, v181
s_waitcnt lgkmcnt(2)
v_add_f32 v176, v176, v182
s_waitcnt lgkmcnt(1)
v_add_f32 v176, v176, v183
ds_write_b32 v189, v176
v_mfma_f32_16x16x32_bf16 v[152:155], v[124:127], v[32:35], v[152:155]
ds_read_b128 v[124:127], v248 offset:256
s_waitcnt lgkmcnt(2)
v_mfma_f32_16x16x32_bf16 v[144:147], v[120:123], v[64:67], v[144:147]
v_mfma_f32_16x16x32_bf16 v[148:151], v[120:123], v[68:71], v[148:151]
s_cmp_eq_u32 s77, 0
s_cbranch_scc1 Lpp15
s_nop 7
s_call_b64 s[78:79], Lpolln
Lpp15:
v_mfma_f32_16x16x32_bf16 v[152:155], v[120:123], v[40:43], v[152:155]
ds_read_b128 v[120:123], v248 offset:2304
s_nop 2
v_cvt_pk_f16_f32 v144, v144, v145
v_pk_fma_f16 v145, v144, v144, s48
v_cvt_pkrtz_f16_f32 v147, v146, v147
v_pk_mul_f16 v145, v144, v145
v_cvt_pkrtz_f16_f32 v149, v148, v149
v_and_b32_e64 v149, s49, v149
v_bfe_u32 v148, v149, 2, 14
v_lshrrev_b32 v149, 18, v149
v_cvt_pkrtz_f16_f32 v153, v152, v153
s_waitcnt lgkmcnt(1)
v_mfma_f32_16x16x32_bf16 v[156:159], v[124:127], v[48:51], 0
ds_read_u16 v148, v148
ds_read_u16_d16_hi v149, v149
v_mfma_f32_16x16x32_bf16 v[176:179], v[124:127], v[52:55], 0
s_cmp_eq_u32 s77, 0
s_cbranch_scc1 Lpp16
s_nop 7
s_call_b64 s[78:79], Lpolln
Lpp16:
v_and_b32_e64 v153, s49, v153
v_bfe_u32 v152, v153, 2, 14
v_mfma_f32_16x16x32_bf16 v[180:183], v[124:127], v[24:27], 0
ds_read_b128 v[124:127], v248 offset:4352
v_lshrrev_b32 v153, 18, v153
s_waitcnt lgkmcnt(3)
v_mfma_f32_16x16x32_bf16 v[156:159], v[120:123], v[56:59], v[156:159]
ds_read_u16 v152, v152
ds_read_u16_d16_hi v153, v153
v_and_b32_e64 v147, s49, v147
v_bfe_u32 v146, v147, 2, 14
v_lshrrev_b32_e64 v147, 18, v147
v_mfma_f32_16x16x32_bf16 v[176:179], v[120:123], v[60:63], v[176:179]
ds_read_u16 v146, v146
ds_read_u16_d16_hi v147, v147
v_exp_f16_sdwa v145, v145 dst_sel:WORD_0 dst_unused:UNUSED_PRESERVE src0_sel:WORD_0
v_cvt_pkrtz_f16_f32 v151, v150, v151
v_and_b32_e64 v151, s49, v151
v_bfe_u32 v150, v151, 2, 14
v_lshrrev_b32_e64 v151, 18, v151
v_mfma_f32_16x16x32_bf16 v[180:183], v[120:123], v[32:35], v[180:183]
ds_read_u16 v150, v150
ds_read_u16_d16_hi v151, v151
s_cmp_eq_u32 s77, 0
s_cbranch_scc1 Lpp17
s_nop 5
s_call_b64 s[78:79], Lpolln
Lpp17:
v_cvt_pkrtz_f16_f32 v155, v154, v155
v_and_b32_e64 v155, s49, v155
v_bfe_u32 v154, v155, 2, 14
v_lshrrev_b32 v155, 18, v155
s_waitcnt lgkmcnt(6)
v_mfma_f32_16x16x32_bf16 v[156:159], v[124:127], v[64:67], v[156:159]
ds_read_u16 v154, v154
ds_read_u16_d16_hi v155, v155
v_exp_f16_sdwa v145, v145 dst_sel:WORD_1 dst_unused:UNUSED_PRESERVE src0_sel:WORD_1
v_mfma_f32_16x16x32_bf16 v[176:179], v[124:127], v[68:71], v[176:179]
v_pk_add_f16 v145, v145, 1.0 op_sel_hi:[1,0]
v_or_b32_e64 v148, v148, v149
v_mfma_f32_16x16x32_bf16 v[180:183], v[124:127], v[40:43], v[180:183]
s_cmp_eq_u32 s77, 0
s_cbranch_scc1 Lpp18
s_nop 7
s_call_b64 s[78:79], Lpolln
Lpp18:
v_rcp_f16_sdwa v145, v145 dst_sel:WORD_0 dst_unused:UNUSED_PRESERVE src0_sel:WORD_0
v_cvt_pk_f16_f32 v156, v156, v157
v_rcp_f16_sdwa v145, v145 dst_sel:WORD_1 dst_unused:UNUSED_PRESERVE src0_sel:WORD_1
v_cvt_pkrtz_f16_f32 v177, v176, v177
v_and_b32_e64 v177, s49, v177
v_bfe_u32 v176, v177, 2, 14
v_lshrrev_b32_e64 v177, 18, v177
v_pk_fma_f16 v157, v156, v156, s48
v_cvt_pkrtz_f16_f32 v181, v180, v181
v_and_b32_e64 v181, s49, v181
v_bfe_u32 v180, v181, 2, 14
v_lshrrev_b32_e64 v181, 18, v181
v_pk_mul_f16 v157, v156, v157
ds_read_u16 v176, v176
ds_read_u16_d16_hi v177, v177
ds_read_u16 v180, v180
ds_read_u16_d16_hi v181, v181
s_cmp_eq_u32 s77, 0
s_cbranch_scc1 Lpp19
s_call_b64 s[78:79], Lpolln
Lpp19:
v_cvt_pkrtz_f16_f32 v159, v158, v159
v_and_b32 v159, s49, v159
v_bfe_u32 v158, v159, 2, 14
v_lshrrev_b32_e64 v159, 18, v159
v_pk_mul_f16 v144, v144, v145
v_exp_f16_sdwa v157, v157 dst_sel:WORD_0 dst_unused:UNUSED_PRESERVE src0_sel:WORD_0
s_waitcnt lgkmcnt(7)
v_or_b32 v152, v152, v153
v_cvt_pkrtz_f16_f32 v179, v178, v179
v_and_b32_e64 v179, s49, v179
v_bfe_u32 v178, v179, 2, 14
ds_read_u16 v158, v158
ds_read_u16_d16_hi v159, v159
v_lshrrev_b32 v179, 18, v179
v_or_b32 v145, v146, v147
v_cvt_pkrtz_f16_f32 v183, v182, v183
v_and_b32_e64 v183, s49, v183
v_bfe_u32 v182, v183, 2, 14
v_lshrrev_b32_e64 v183, 18, v183
v_exp_f16_sdwa v157, v157 dst_sel:WORD_1 dst_unused:UNUSED_PRESERVE src0_sel:WORD_1
ds_read_u16 v178, v178
ds_read_u16_d16_hi v179, v179
ds_read_u16 v182, v182
ds_read_u16_d16_hi v183, v183
s_waitcnt lgkmcnt(10)
v_or_b32 v149, v150, v151
s_cmp_eq_u32 s77, 0
s_cbranch_scc1 Lpp20
s_call_b64 s[78:79], Lpolln
Lpp20:
v_or_b32 v153, v154, v155
v_pk_add_f16 v157, v157, 1.0 op_sel_hi:[1,0]
s_waitcnt lgkmcnt(8)
v_or_b32_e64 v150, v176, v177
v_rcp_f16_sdwa v157, v157 dst_sel:WORD_0 dst_unused:UNUSED_PRESERVE src0_sel:WORD_0
s_cmp_eq_u32 s77, 0
s_cbranch_scc1 Lpp21
s_call_b64 s[78:79], Lpolln
Lpp21:
ds_read_b128 v[120:123], v248 offset:6144
v_rcp_f16_sdwa v157, v157 dst_sel:WORD_1 dst_unused:UNUSED_PRESERVE src0_sel:WORD_1
s_nop 0
v_pk_mul_f16 v146, v156, v157
s_waitcnt lgkmcnt(7)
v_or_b32 v154, v180, v181
s_waitcnt lgkmcnt(5)
v_or_b32 v147, v158, v159
s_waitcnt lgkmcnt(3)
v_or_b32 v151, v178, v179
s_waitcnt lgkmcnt(1)
v_or_b32 v155, v182, v183
s_cmp_lg_u32 s40, 0
s_cbranch_scc1 Lspinx
s_setprio 3
Lspin:
s_cmp_eq_u32 s77, 0
s_cbranch_scc1 Lspiny
s_cmp_eq_u32 s76, 0
s_cbranch_scc1 Lspiny
s_sub_u32 s76, s76, 1
s_call_b64 s[78:79], Lpoll
s_branch Lspin
Lspiny:
ds_write_b32 v191, v128
ds_write_b32 v191, v129 offset:4
ds_write_b32 v191, v130 offset:8
s_waitcnt lgkmcnt(0)
Lspinx:
s_waitcnt lgkmcnt(0)
s_barrier
ds_read_b64 v[240:241], v188 offset:3072
ds_read_b64 v[242:243], v188 offset:3104
ds_read_b64 v[244:245], v188 offset:3136
ds_read_b128 v[128:131], v254 offset:8192
ds_read_b128 v[132:135], v254 offset:8208
ds_read_b128 v[136:139], v254 offset:8320
ds_read_b128 v[140:143], v254 offset:8336
s_waitcnt lgkmcnt(6)
v_pk_mul_f16 v72, v72, v240
v_pk_mul_f16 v73, v73, v241
v_and_b32 v72, s49, v72
v_and_b32 v73, s49, v73
s_waitcnt lgkmcnt(4)
v_pk_mul_f16 v74, v74, v240
v_pk_mul_f16 v75, v75, v241
v_and_b32 v74, s49, v74
v_and_b32 v75, s49, v75
v_pk_mul_f16 v76, v76, v240
v_pk_mul_f16 v77, v77, v241
v_and_b32 v76, s49, v76
v_and_b32 v77, s49, v77
v_pk_mul_f16 v78, v78, v240
v_pk_mul_f16 v79, v79, v241
ds_write_b64 v173, v[72:73]
ds_write_b64 v173, v[74:75] offset:3072
v_and_b32 v78, s49, v78
v_and_b32 v79, s49, v79
v_pk_mul_f16 v80, v80, v240
v_pk_mul_f16 v81, v81, v241
v_and_b32 v80, s49, v80
v_and_b32 v81, s49, v81
v_pk_mul_f16 v82, v82, v240
v_pk_mul_f16 v83, v83, v241
ds_write_b64 v173, v[76:77] offset:1024
ds_write_b64 v173, v[78:79] offset:4096
v_and_b32 v82, s49, v82
v_and_b32 v83, s49, v83
v_pk_mul_f16 v84, v84, v242
v_pk_mul_f16 v85, v85, v243
v_and_b32 v84, s49, v84
v_and_b32 v85, s49, v85
v_pk_mul_f16 v86, v86, v242
v_pk_mul_f16 v87, v87, v243
ds_write_b64 v173, v[80:81] offset:2048
ds_write_b64 v173, v[82:83] offset:5120
v_and_b32 v86, s49, v86
v_and_b32 v87, s49, v87
v_pk_mul_f16 v88, v88, v242
v_pk_mul_f16 v89, v89, v243
v_and_b32 v88, s49, v88
v_and_b32 v89, s49, v89
v_pk_mul_f16 v90, v90, v242
v_pk_mul_f16 v91, v91, v243
ds_write_b64 v174, v[84:85]
ds_write_b64 v174, v[86:87] offset:3072
v_and_b32 v90, s49, v90
v_and_b32 v91, s49, v91
v_pk_mul_f16 v92, v92, v242
v_pk_mul_f16 v93, v93, v243
v_and_b32 v92, s49, v92
v_and_b32 v93, s49, v93
v_pk_mul_f16 v94, v94, v242
v_pk_mul_f16 v95, v95, v243
ds_write_b64 v174, v[88:89] offset:1024
ds_write_b64 v174, v[90:91] offset:4096
v_and_b32 v94, s49, v94
v_and_b32 v95, s49, v95
v_pk_mul_f16 v160, v160, v244
v_pk_mul_f16 v161, v161, v245
v_and_b32 v160, s49, v160
v_and_b32 v161, s49, v161
v_pk_mul_f16 v162, v162, v244
v_pk_mul_f16 v163, v163, v245
ds_write_b64 v174, v[92:93] offset:2048
s_waitcnt lgkmcnt(6)
ds_write_b64 v174, v[94:95] offset:5120
v_and_b32 v162, s49, v162
v_and_b32_e64 v163, s49, v163
v_pk_mul_f16 v164, v164, v244
v_pk_mul_f16 v165, v165, v245
v_and_b32 v164, s49, v164
v_and_b32 v165, s49, v165
v_pk_mul_f16 v166, v166, v244
v_pk_mul_f16 v167, v167, v245
ds_write_b64 v175, v[160:161]
ds_write_b64 v175, v[162:163] offset:3072
v_and_b32 v166, s49, v166
v_and_b32 v167, s49, v167
v_pk_mul_f16 v168, v168, v244
v_pk_mul_f16 v169, v169, v245
v_and_b32 v168, s49, v168
v_and_b32 v169, s49, v169
v_pk_mul_f16 v170, v170, v244
v_pk_mul_f16 v171, v171, v245
ds_write_b64 v175, v[164:165] offset:1024
ds_write_b64 v175, v[166:167] offset:4096
v_and_b32_e64 v170, s49, v170
v_and_b32 v171, s49, v171
ds_write_b64 v175, v[168:169] offset:2048
ds_write_b64 v175, v[170:171] offset:5120
ds_read_b128 v[240:243], v254
ds_read_b128 v[244:247], v254 offset:16
s_waitcnt lgkmcnt(0)
s_barrier
ds_read_b128 v[124:127], v251 offset:20480
ds_read_b128 v[184:187], v251 offset:23552
ds_read_b128 v[188:191], v251 offset:21504
ds_read_b128 v[160:163], v251 offset:24576
buffer_load_dwordx4 v[164:167], v253, s[4:7], s71 offen
buffer_load_dwordx4 v[168:171], v253, s[4:7], s71 offen offset:64
v_mfma_f32_16x16x32_bf16 v[172:175], v[120:123], v[48:51], 0
s_setprio 3
v_mfma_f32_16x16x32_bf16 v[156:159], v[120:123], v[52:55], 0
v_mfma_f32_16x16x32_bf16 v[176:179], v[120:123], v[24:27], 0
ds_read_b128 v[120:123], v251 offset:22528
s_waitcnt lgkmcnt(4)
v_mfma_f32_16x16x32_f16 v[72:75], v[124:127], v[4:7], v[128:131]
v_mfma_f32_16x16x32_f16 v[128:131], v[124:127], v[0:3], v[128:131]
ds_read_b128 v[124:127], v248 offset:8192
s_waitcnt lgkmcnt(4)
v_mfma_f32_16x16x32_f16 v[76:79], v[184:187], v[4:7], v[132:135]
v_mfma_f32_16x16x32_f16 v[132:135], v[184:187], v[0:3], v[132:135]
ds_read_b128 v[184:187], v251 offset:25600
s_waitcnt lgkmcnt(4)
v_mfma_f32_16x16x32_f16 v[80:83], v[188:191], v[4:7], v[136:139]
v_mfma_f32_16x16x32_f16 v[136:139], v[188:191], v[0:3], v[136:139]
ds_read_b128 v[188:191], v251 offset:26624
s_waitcnt lgkmcnt(4)
v_mfma_f32_16x16x32_f16 v[84:87], v[160:163], v[4:7], v[140:143]
v_mfma_f32_16x16x32_f16 v[140:143], v[160:163], v[0:3], v[140:143]
ds_read_b128 v[160:163], v251 offset:29696
s_waitcnt lgkmcnt(4)
v_mfma_f32_16x16x32_f16 v[88:91], v[120:123], v[4:7], v[240:243]
s_waitcnt lgkmcnt(3)
v_mfma_f32_16x16x32_bf16 v[172:175], v[124:127], v[56:59], v[172:175]
v_mfma_f32_16x16x32_f16 v[240:243], v[120:123], v[0:3], v[240:243]
ds_read_b128 v[120:123], v251 offset:27648
s_waitcnt lgkmcnt(3)
v_mfma_f32_16x16x32_f16 v[92:95], v[184:187], v[4:7], v[244:247]
v_mfma_f32_16x16x32_f16 v[244:247], v[184:187], v[0:3], v[244:247]
ds_read_b128 v[184:187], v251 offset:30720
v_mfma_f32_16x16x32_bf16 v[156:159], v[124:127], v[60:63], v[156:159]
s_waitcnt lgkmcnt(3)
v_mfma_f32_16x16x32_f16 v[72:75], v[188:191], v[12:15], v[72:75]
v_mfma_f32_16x16x32_f16 v[128:131], v[188:191], v[8:11], v[128:131]
ds_read_b128 v[188:191], v251 offset:28672
s_waitcnt lgkmcnt(3)
v_mfma_f32_16x16x32_f16 v[76:79], v[160:163], v[12:15], v[76:79]
v_mfma_f32_16x16x32_bf16 v[176:179], v[124:127], v[32:35], v[176:179]
ds_read_b128 v[124:127], v248 offset:10240
v_mfma_f32_16x16x32_f16 v[132:135], v[160:163], v[8:11], v[132:135]
ds_read_b128 v[160:163], v251 offset:31744
s_waitcnt lgkmcnt(4)
v_mfma_f32_16x16x32_f16 v[80:83], v[120:123], v[12:15], v[80:83]
v_mfma_f32_16x16x32_f16 v[136:139], v[120:123], v[8:11], v[136:139]
ds_read_b128 v[120:123], v251 offset:32768
s_setprio 2
s_waitcnt lgkmcnt(4)
v_mfma_f32_16x16x32_f16 v[84:87], v[184:187], v[12:15], v[84:87]
v_mfma_f32_16x16x32_f16 v[140:143], v[184:187], v[8:11], v[140:143]
ds_read_b128 v[184:187], v248 offset:6400
s_waitcnt lgkmcnt(4)
v_mfma_f32_16x16x32_f16 v[88:91], v[188:191], v[12:15], v[88:91]
s_waitcnt lgkmcnt(3)
v_mfma_f32_16x16x32_bf16 v[172:175], v[124:127], v[64:67], v[172:175]
v_mfma_f32_16x16x32_bf16 v[156:159], v[124:127], v[68:71], v[156:159]
v_mfma_f32_16x16x32_f16 v[240:243], v[188:191], v[8:11], v[240:243]
ds_read_b128 v[188:191], v251 offset:33792
s_nop 4
v_cvt_pk_f16_f32 v172, v172, v173
s_waitcnt lgkmcnt(3)
v_mfma_f32_16x16x32_f16 v[92:95], v[160:163], v[12:15], v[92:95]
v_pk_fma_f16 v173, v172, v172, s48
v_cvt_pkrtz_f16_f32 v157, v156, v157
v_mfma_f32_16x16x32_f16 v[244:247], v[160:163], v[8:11], v[244:247]
ds_read_b128 v[160:163], v251 offset:36864
v_and_b32_e64 v157, s49, v157
v_mfma_f32_16x16x32_bf16 v[176:179], v[124:127], v[40:43], v[176:179]
ds_read_b128 v[124:127], v251 offset:35840
v_bfe_u32 v156, v157, 2, 14
s_waitcnt lgkmcnt(3)
v_mfma_f32_16x16x32_f16 v[72:75], v[120:123], v[20:23], v[72:75]
v_lshrrev_b32 v157, 18, v157
v_pk_mul_f16 v173, v172, v173
v_mfma_f32_16x16x32_f16 v[128:131], v[120:123], v[16:19], v[128:131]
ds_read_b128 v[120:123], v251 offset:34816
ds_read_u16 v156, v156
v_mfma_f32_16x16x32_bf16 v[180:183], v[184:187], v[48:51], 0
ds_read_u16_d16_hi v157, v157
v_cvt_pkrtz_f16_f32 v177, v176, v177
s_waitcnt lgkmcnt(5)
v_mfma_f32_16x16x32_f16 v[80:83], v[188:191], v[20:23], v[80:83]
v_and_b32 v177, s49, v177
v_bfe_u32 v176, v177, 2, 14
v_mfma_f32_16x16x32_f16 v[136:139], v[188:191], v[16:19], v[136:139]
ds_read_b128 v[188:191], v252 offset:4096
v_lshrrev_b32 v177, 18, v177
s_waitcnt lgkmcnt(4)
v_mfma_f32_16x16x32_f16 v[76:79], v[124:127], v[20:23], v[76:79]
ds_read_u16 v176, v176
ds_read_u16_d16_hi v177, v177
v_mfma_f32_16x16x32_f16 v[132:135], v[124:127], v[16:19], v[132:135]
ds_read_b128 v[124:127], v251 offset:37888
v_cvt_pkrtz_f16_f32 v175, v174, v175
v_mfma_f32_16x16x32_bf16 v[0:3], v[184:187], v[52:55], 0
v_and_b32_e64 v175, s49, v175
v_bfe_u32 v174, v175, 2, 14
v_mfma_f32_16x16x32_f16 v[84:87], v[160:163], v[20:23], v[84:87]
v_lshrrev_b32 v175, 18, v175
v_exp_f16_sdwa v173, v173 dst_sel:WORD_0 dst_unused:UNUSED_PRESERVE src0_sel:WORD_0
v_mfma_f32_16x16x32_f16 v[140:143], v[160:163], v[16:19], v[140:143]
ds_read_b128 v[160:163], v252 offset:7168
ds_read_u16 v174, v174
s_waitcnt lgkmcnt(7)
v_mfma_f32_16x16x32_f16 v[88:91], v[120:123], v[20:23], v[88:91]
ds_read_u16_d16_hi v175, v175
v_cvt_pkrtz_f16_f32 v159, v158, v159
v_mfma_f32_16x16x32_bf16 v[4:7], v[184:187], v[24:27], 0
ds_read_b128 v[184:187], v248 offset:8448
v_and_b32_e64 v159, s49, v159
v_mfma_f32_16x16x32_f16 v[240:243], v[120:123], v[16:19], v[240:243]
ds_read_b128 v[120:123], v252 offset:5120
v_bfe_u32 v158, v159, 2, 14
s_waitcnt lgkmcnt(8)
v_mfma_f32_16x16x32_f16 v[72:75], v[188:191], v[100:103], v[72:75]
s_setprio 1
v_lshrrev_b32_e64 v159, 18, v159
v_cvt_pkrtz_f16_f32 v179, v178, v179
v_mfma_f32_16x16x32_f16 v[128:131], v[188:191], v[96:99], v[128:131]
ds_read_b128 v[188:191], v252 offset:6144
ds_read_u16 v158, v158
s_waitcnt lgkmcnt(7)
v_mfma_f32_16x16x32_f16 v[92:95], v[124:127], v[20:23], v[92:95]
v_mov_b32 v20, 0
v_mov_b32_e64 v21, 0
v_mfma_f32_16x16x32_f16 v[244:247], v[124:127], v[16:19], v[244:247]
ds_read_b128 v[124:127], v252 offset:8192
v_mov_b32 v16, 0
v_mov_b32 v17, 0
v_cndmask_b32 v18, 0, v255, s[88:89]
v_cndmask_b32 v19, 0, v255, s[90:91]
s_waitcnt lgkmcnt(7)
v_mfma_f32_16x16x32_f16 v[76:79], v[160:163], v[100:103], v[76:79]
ds_read_u16_d16_hi v159, v159
v_and_b32 v179, s49, v179
v_mfma_f32_16x16x32_f16 v[132:135], v[160:163], v[96:99], v[132:135]
ds_read_b128 v[160:163], v252 offset:9216
v_bfe_u32 v178, v179, 2, 14
s_waitcnt lgkmcnt(6)
v_mfma_f32_16x16x32_bf16 v[180:183], v[184:187], v[56:59], v[180:183]
v_lshrrev_b32 v179, 18, v179
v_exp_f16_sdwa v173, v173 dst_sel:WORD_1 dst_unused:UNUSED_PRESERVE src0_sel:WORD_1
v_mfma_f32_16x16x32_bf16 v[0:3], v[184:187], v[60:63], v[0:3]
ds_read_u16 v178, v178
ds_read_u16_d16_hi v179, v179
s_waitcnt lgkmcnt(7)
v_mfma_f32_16x16x32_f16 v[80:83], v[120:123], v[100:103], v[80:83]
v_pk_add_f16 v173, v173, 1.0 op_sel_hi:[1,0]
v_mfma_f32_16x16x32_bf16 v[4:7], v[184:187], v[32:35], v[4:7]
ds_read_b128 v[184:187], v248 offset:10496
v_rcp_f16_sdwa v173, v173 dst_sel:WORD_0 dst_unused:UNUSED_PRESERVE src0_sel:WORD_0
v_mfma_f32_16x16x32_f16 v[136:139], v[120:123], v[96:99], v[136:139]
ds_read_b128 v[120:123], v252 offset:10240
v_rcp_f16_sdwa v173, v173 dst_sel:WORD_1 dst_unused:UNUSED_PRESERVE src0_sel:WORD_1
s_waitcnt lgkmcnt(6)
v_mfma_f32_16x16x32_f16 v[84:87], v[124:127], v[100:103], v[84:87]
v_mfma_f32_16x16x32_f16 v[140:143], v[124:127], v[96:99], v[140:143]
ds_read_b128 v[124:127], v252 offset:13312
v_mfma_f32_16x16x32_f16 v[88:91], v[188:191], v[100:103], v[88:91]
v_mfma_f32_16x16x32_f16 v[240:243], v[188:191], v[96:99], v[240:243]
ds_read_b128 v[188:191], v248 offset:12288
s_waitcnt lgkmcnt(6)
v_mfma_f32_16x16x32_f16 v[92:95], v[160:163], v[100:103], v[92:95]
s_waitcnt lgkmcnt(3)
v_mfma_f32_16x16x32_bf16 v[180:183], v[184:187], v[64:67], v[180:183]
v_or_b32_e64 v156, v156, v157
v_pk_mul_f16 v172, v172, v173
v_mfma_f32_16x16x32_bf16 v[0:3], v[184:187], v[68:71], v[0:3]
v_mfma_f32_16x16x32_f16 v[244:247], v[160:163], v[96:99], v[244:247]
ds_read_b128 v[160:163], v252 offset:14336
s_nop 2
v_cvt_pk_f16_f32 v180, v180, v181
s_waitcnt lgkmcnt(3)
v_mfma_f32_16x16x32_f16 v[72:75], v[120:123], v[108:111], v[72:75]
v_pk_fma_f16 v181, v180, v180, s48
v_cvt_pkrtz_f16_f32 v1, v0, v1
v_mfma_f32_16x16x32_f16 v[128:131], v[120:123], v[104:107], v[128:131]
ds_read_b128 v[120:123], v252 offset:12288
v_and_b32_e64 v1, s49, v1
v_mfma_f32_16x16x32_bf16 v[4:7], v[184:187], v[40:43], v[4:7]
ds_read_b128 v[184:187], v252 offset:11264
v_bfe_u32 v0, v1, 2, 14
s_waitcnt lgkmcnt(3)
v_mfma_f32_16x16x32_f16 v[76:79], v[124:127], v[108:111], v[76:79]
v_lshrrev_b32 v1, 18, v1
v_pk_mul_f16 v181, v180, v181
v_mfma_f32_16x16x32_f16 v[132:135], v[124:127], v[104:107], v[132:135]
ds_read_b128 v[124:127], v252 offset:15360
s_setprio 0
ds_read_u16 v0, v0
v_mfma_f32_16x16x32_bf16 v[8:11], v[188:191], v[48:51], 0
ds_read_u16_d16_hi v1, v1
v_cvt_pkrtz_f16_f32 v5, v4, v5
s_waitcnt lgkmcnt(5)
v_mfma_f32_16x16x32_f16 v[84:87], v[160:163], v[108:111], v[84:87]
v_and_b32_e64 v5, s49, v5
v_bfe_u32 v4, v5, 2, 14
v_mfma_f32_16x16x32_f16 v[140:143], v[160:163], v[104:107], v[140:143]
ds_read_b128 v[160:163], v251 offset:41984
v_lshrrev_b32 v5, 18, v5
s_waitcnt lgkmcnt(4)
v_mfma_f32_16x16x32_f16 v[80:83], v[184:187], v[108:111], v[80:83]
ds_read_u16 v4, v4
ds_read_u16_d16_hi v5, v5
v_mfma_f32_16x16x32_f16 v[136:139], v[184:187], v[104:107], v[136:139]
ds_read_b128 v[184:187], v251 offset:38912
v_cvt_pkrtz_f16_f32 v183, v182, v183
v_mfma_f32_16x16x32_bf16 v[12:15], v[188:191], v[52:55], 0
v_and_b32_e64 v183, s49, v183
v_bfe_u32 v182, v183, 2, 14
v_mfma_f32_16x16x32_f16 v[88:91], v[120:123], v[108:111], v[88:91]
v_lshrrev_b32_e64 v183, 18, v183
v_exp_f16_sdwa v181, v181 dst_sel:WORD_0 dst_unused:UNUSED_PRESERVE src0_sel:WORD_0
v_mfma_f32_16x16x32_f16 v[240:243], v[120:123], v[104:107], v[240:243]
ds_read_b128 v[120:123], v251 offset:39936
ds_read_u16 v182, v182
s_waitcnt lgkmcnt(7)
v_mfma_f32_16x16x32_f16 v[92:95], v[124:127], v[108:111], v[92:95]
ds_read_u16_d16_hi v183, v183
v_or_b32 v176, v176, v177
v_mfma_f32_16x16x32_bf16 v[96:99], v[188:191], v[24:27], 0
ds_read_b128 v[188:191], v248 offset:14336
v_cvt_pkrtz_f16_f32 v3, v2, v3
v_mfma_f32_16x16x32_f16 v[244:247], v[124:127], v[104:107], v[244:247]
ds_read_b128 v[124:127], v251 offset:43008
buffer_load_dwordx4 v[100:103], v253, s[4:7], s71 offen offset:128
buffer_load_dwordx4 v[104:107], v253, s[4:7], s71 offen offset:192
s_waitcnt lgkmcnt(8)
v_mfma_f32_16x16x32_f16 v[76:79], v[160:163], v[196:199], v[76:79]
v_and_b32 v3, s49, v3
v_bfe_u32 v2, v3, 2, 14
v_mfma_f32_16x16x32_f16 v[132:135], v[160:163], v[192:195], v[132:135]
ds_read_b128 v[160:163], v251 offset:44032
v_lshrrev_b32 v3, 18, v3
s_waitcnt lgkmcnt(6)
v_mfma_f32_16x16x32_f16 v[72:75], v[184:187], v[196:199], v[72:75]
ds_read_u16 v2, v2
ds_read_u16_d16_hi v3, v3
v_mfma_f32_16x16x32_f16 v[128:131], v[184:187], v[192:195], v[128:131]
ds_read_b128 v[184:187], v251 offset:40960
v_or_b32 v173, v174, v175
s_waitcnt lgkmcnt(8)
v_mfma_f32_16x16x32_f16 v[80:83], v[120:123], v[196:199], v[80:83]
v_cvt_pkrtz_f16_f32 v7, v6, v7
v_and_b32_e64 v7, s49, v7
v_mfma_f32_16x16x32_f16 v[136:139], v[120:123], v[192:195], v[136:139]
ds_read_b128 v[120:123], v251 offset:45056
v_bfe_u32 v6, v7, 2, 14
v_lshrrev_b32 v7, 18, v7
s_waitcnt lgkmcnt(6)
v_mfma_f32_16x16x32_bf16 v[8:11], v[188:191], v[56:59], v[8:11]
ds_read_u16 v6, v6
ds_read_u16_d16_hi v7, v7
v_mfma_f32_16x16x32_bf16 v[12:15], v[188:191], v[60:63], v[12:15]
v_exp_f16_sdwa v181, v181 dst_sel:WORD_1 dst_unused:UNUSED_PRESERVE src0_sel:WORD_1
s_waitcnt lgkmcnt(7)
v_mfma_f32_16x16x32_f16 v[84:87], v[124:127], v[196:199], v[84:87]
v_or_b32 v157, v158, v159
v_or_b32_e64 v177, v178, v179
v_mfma_f32_16x16x32_f16 v[140:143], v[124:127], v[192:195], v[140:143]
ds_read_b128 v[124:127], v251 offset:48128
v_pk_add_f16 v181, v181, 1.0 op_sel_hi:[1,0]
v_mfma_f32_16x16x32_bf16 v[96:99], v[188:191], v[32:35], v[96:99]
ds_read_b128 v[188:191], v248 offset:16384
v_rcp_f16_sdwa v181, v181 dst_sel:WORD_0 dst_unused:UNUSED_PRESERVE src0_sel:WORD_0
s_waitcnt lgkmcnt(7)
v_mfma_f32_16x16x32_f16 v[92:95], v[160:163], v[196:199], v[92:95]
s_setprio 3
v_rcp_f16_sdwa v181, v181 dst_sel:WORD_1 dst_unused:UNUSED_PRESERVE src0_sel:WORD_1
s_waitcnt lgkmcnt(5)
v_mfma_f32_16x16x32_f16 v[88:91], v[184:187], v[196:199], v[88:91]
v_mfma_f32_16x16x32_f16 v[240:243], v[184:187], v[192:195], v[240:243]
ds_read_b128 v[184:187], v251 offset:46080
v_mfma_f32_16x16x32_f16 v[244:247], v[160:163], v[192:195], v[244:247]
ds_read_b128 v[160:163], v248 offset:12544
s_waitcnt lgkmcnt(6)
v_mfma_f32_16x16x32_f16 v[72:75], v[120:123], v[204:207], v[72:75]
v_mfma_f32_16x16x32_f16 v[128:131], v[120:123], v[200:203], v[128:131]
ds_read_b128 v[120:123], v251 offset:47104
s_waitcnt lgkmcnt(4)
v_mfma_f32_16x16x32_f16 v[76:79], v[124:127], v[204:207], v[76:79]
s_waitcnt lgkmcnt(3)
v_mfma_f32_16x16x32_bf16 v[8:11], v[188:191], v[64:67], v[8:11]
v_or_b32_e64 v158, v0, v1
v_pk_mul_f16 v174, v180, v181
v_mfma_f32_16x16x32_bf16 v[12:15], v[188:191], v[68:71], v[12:15]
v_or_b32 v178, v4, v5
v_mfma_f32_16x16x32_f16 v[132:135], v[124:127], v[200:203], v[132:135]
ds_read_b128 v[124:127], v251 offset:50176
s_nop 1
v_cvt_pk_f16_f32 v8, v8, v9
v_mfma_f32_16x16x32_bf16 v[96:99], v[188:191], v[40:43], v[96:99]
ds_read_b128 v[188:191], v251 offset:49152
v_cvt_pkrtz_f16_f32 v13, v12, v13
s_waitcnt lgkmcnt(3)
v_mfma_f32_16x16x32_f16 v[80:83], v[184:187], v[204:207], v[80:83]
v_and_b32 v13, s49, v13
v_bfe_u32 v12, v13, 2, 14
v_mfma_f32_16x16x32_f16 v[136:139], v[184:187], v[200:203], v[136:139]
ds_read_b128 v[184:187], v251 offset:51200
v_lshrrev_b32 v13, 18, v13
v_mfma_f32_16x16x32_bf16 v[108:111], v[160:163], v[48:51], 0
ds_read_u16 v12, v12
ds_read_u16_d16_hi v13, v13
s_waitcnt lgkmcnt(5)
v_mfma_f32_16x16x32_f16 v[88:91], v[120:123], v[204:207], v[88:91]
v_pk_fma_f16 v9, v8, v8, s48
v_cvt_pkrtz_f16_f32 v97, v96, v97
v_mfma_f32_16x16x32_f16 v[240:243], v[120:123], v[200:203], v[240:243]
ds_read_b128 v[120:123], v251 offset:52224
v_and_b32 v97, s49, v97
s_waitcnt lgkmcnt(4)
v_mfma_f32_16x16x32_f16 v[84:87], v[188:191], v[204:207], v[84:87]
v_bfe_u32 v96, v97, 2, 14
v_lshrrev_b32_e64 v97, 18, v97
v_mfma_f32_16x16x32_f16 v[140:143], v[188:191], v[200:203], v[140:143]
ds_read_b128 v[188:191], v251 offset:54272
ds_read_u16 v96, v96
v_mfma_f32_16x16x32_bf16 v[192:195], v[160:163], v[52:55], 0
ds_read_u16_d16_hi v97, v97
v_pk_mul_f16 v9, v8, v9
v_mfma_f32_16x16x32_f16 v[92:95], v[124:127], v[204:207], v[92:95]
v_cvt_pkrtz_f16_f32 v11, v10, v11
v_and_b32_e64 v11, s49, v11
v_mfma_f32_16x16x32_f16 v[244:247], v[124:127], v[200:203], v[244:247]
ds_read_b128 v[124:127], v251 offset:55296
buffer_load_dwordx4 v[200:203], v253, s[4:7], s71 offen offset:256
buffer_load_dwordx4 v[204:207], v253, s[4:7], s71 offen offset:320
s_waitcnt lgkmcnt(7)
v_mfma_f32_16x16x32_f16 v[72:75], v[184:187], v[212:215], v[72:75]
v_bfe_u32 v10, v11, 2, 14
v_lshrrev_b32 v11, 18, v11
v_mfma_f32_16x16x32_bf16 v[196:199], v[160:163], v[24:27], 0
ds_read_b128 v[160:163], v248 offset:14592
ds_read_u16 v10, v10
v_mfma_f32_16x16x32_f16 v[128:131], v[184:187], v[208:211], v[128:131]
ds_read_b128 v[184:187], v248 offset:16640
s_setprio 2
ds_read_u16_d16_hi v11, v11
s_waitcnt lgkmcnt(7)
v_mfma_f32_16x16x32_f16 v[76:79], v[188:191], v[212:215], v[76:79]
v_exp_f16_sdwa v9, v9 dst_sel:WORD_0 dst_unused:UNUSED_PRESERVE src0_sel:WORD_0
v_mfma_f32_16x16x32_f16 v[132:135], v[188:191], v[208:211], v[132:135]
ds_read_b128 v[188:191], v251 offset:53248
v_cvt_pkrtz_f16_f32 v15, v14, v15
v_mfma_f32_16x16x32_f16 v[80:83], v[120:123], v[212:215], v[80:83]
v_and_b32_e64 v15, s49, v15
v_bfe_u32 v14, v15, 2, 14
v_mfma_f32_16x16x32_f16 v[136:139], v[120:123], v[208:211], v[136:139]
ds_read_b128 v[120:123], v251 offset:57344
v_lshrrev_b32 v15, 18, v15
s_waitcnt lgkmcnt(5)
v_mfma_f32_16x16x32_bf16 v[108:111], v[160:163], v[56:59], v[108:111]
ds_read_u16 v14, v14
ds_read_u16_d16_hi v15, v15
v_mfma_f32_16x16x32_bf16 v[192:195], v[160:163], v[60:63], v[192:195]
v_or_b32_e64 v175, v182, v183
v_cvt_pkrtz_f16_f32 v99, v98, v99
v_mfma_f32_16x16x32_bf16 v[196:199], v[160:163], v[32:35], v[196:199]
ds_read_b128 v[160:163], v251 offset:56320
v_and_b32_e64 v99, s49, v99
v_mfma_f32_16x16x32_f16 v[84:87], v[124:127], v[212:215], v[84:87]
v_bfe_u32 v98, v99, 2, 14
v_lshrrev_b32_e64 v99, 18, v99
v_mfma_f32_16x16x32_f16 v[140:143], v[124:127], v[208:211], v[140:143]
ds_read_b128 v[124:127], v248 offset:18432
ds_read_u16 v98, v98
ds_read_u16_d16_hi v99, v99
s_waitcnt lgkmcnt(9)
v_mfma_f32_16x16x32_bf16 v[108:111], v[184:187], v[64:67], v[108:111]
v_exp_f16_sdwa v9, v9 dst_sel:WORD_1 dst_unused:UNUSED_PRESERVE src0_sel:WORD_1
s_waitcnt lgkmcnt(7)
v_mfma_f32_16x16x32_f16 v[88:91], v[188:191], v[212:215], v[88:91]
v_or_b32 v159, v2, v3
v_or_b32 v179, v6, v7
v_mfma_f32_16x16x32_f16 v[240:243], v[188:191], v[208:211], v[240:243]
ds_read_b128 v[188:191], v251 offset:58368
v_pk_add_f16 v9, v9, 1.0 op_sel_hi:[1,0]
v_mfma_f32_16x16x32_bf16 v[192:195], v[184:187], v[68:71], v[192:195]
v_rcp_f16_sdwa v9, v9 dst_sel:WORD_0 dst_unused:UNUSED_PRESERVE src0_sel:WORD_0
s_waitcnt lgkmcnt(4)
v_mfma_f32_16x16x32_f16 v[92:95], v[160:163], v[212:215], v[92:95]
v_cvt_pk_f16_f32 v108, v108, v109
v_rcp_f16_sdwa v9, v9 dst_sel:WORD_1 dst_unused:UNUSED_PRESERVE src0_sel:WORD_1
v_mfma_f32_16x16x32_f16 v[244:247], v[160:163], v[208:211], v[244:247]
ds_read_b128 v[160:163], v251 offset:61440
s_nop 0
v_cvt_pkrtz_f16_f32 v193, v192, v193
v_mfma_f32_16x16x32_bf16 v[196:199], v[184:187], v[40:43], v[196:199]
ds_read_b128 v[184:187], v251 offset:60416
s_setprio 1
v_and_b32 v193, s49, v193
v_mfma_f32_16x16x32_f16 v[72:75], v[120:123], v[228:231], v[72:75]
v_bfe_u32 v192, v193, 2, 14
v_lshrrev_b32 v193, 18, v193
s_waitcnt lgkmcnt(4)
v_mfma_f32_16x16x32_bf16 v[208:211], v[124:127], v[48:51], 0
ds_read_u16 v192, v192
ds_read_u16_d16_hi v193, v193
v_mfma_f32_16x16x32_f16 v[128:131], v[120:123], v[224:227], v[128:131]
ds_read_b128 v[120:123], v248 offset:20480
v_pk_fma_f16 v109, v108, v108, s48
v_mfma_f32_16x16x32_bf16 v[212:215], v[124:127], v[52:55], 0
v_cvt_pkrtz_f16_f32 v197, v196, v197
v_and_b32 v197, s49, v197
s_waitcnt lgkmcnt(5)
v_mfma_f32_16x16x32_f16 v[80:83], v[188:191], v[228:231], v[80:83]
v_bfe_u32 v196, v197, 2, 14
v_lshrrev_b32 v197, 18, v197
s_waitcnt lgkmcnt(3)
v_mfma_f32_16x16x32_f16 v[76:79], v[184:187], v[228:231], v[76:79]
ds_read_u16 v196, v196
ds_read_u16_d16_hi v197, v197
v_mfma_f32_16x16x32_f16 v[132:135], v[184:187], v[224:227], v[132:135]
ds_read_b128 v[184:187], v251 offset:62464
v_or_b32_e64 v12, v12, v13
v_mfma_f32_16x16x32_bf16 v[180:183], v[124:127], v[24:27], 0
ds_read_b128 v[124:127], v251 offset:59392
v_pk_mul_f16 v109, v108, v109
v_mfma_f32_16x16x32_f16 v[136:139], v[188:191], v[224:227], v[136:139]
ds_read_b128 v[188:191], v248 offset:22528
v_cvt_pkrtz_f16_f32 v111, v110, v111
v_mfma_f32_16x16x32_f16 v[84:87], v[160:163], v[228:231], v[84:87]
v_and_b32 v111, s49, v111
v_bfe_u32 v110, v111, 2, 14
s_waitcnt lgkmcnt(5)
v_mfma_f32_16x16x32_bf16 v[208:211], v[120:123], v[56:59], v[208:211]
v_lshrrev_b32_e64 v111, 18, v111
v_pk_mul_f16 v8, v8, v9
v_mfma_f32_16x16x32_f16 v[140:143], v[160:163], v[224:227], v[140:143]
ds_read_b128 v[160:163], v251 offset:8192
ds_read_u16 v110, v110
ds_read_u16_d16_hi v111, v111
v_mfma_f32_16x16x32_bf16 v[212:215], v[120:123], v[60:63], v[212:215]
v_exp_f16_sdwa v109, v109 dst_sel:WORD_0 dst_unused:UNUSED_PRESERVE src0_sel:WORD_0
v_or_b32_e64 v96, v96, v97
v_cvt_pkrtz_f16_f32 v195, v194, v195
v_and_b32_e64 v195, s49, v195
v_bfe_u32 v194, v195, 2, 14
v_lshrrev_b32_e64 v195, 18, v195
v_mfma_f32_16x16x32_bf16 v[180:183], v[120:123], v[32:35], v[180:183]
ds_read_u16 v194, v194
ds_read_u16_d16_hi v195, v195
s_waitcnt lgkmcnt(6)
v_mfma_f32_16x16x32_f16 v[88:91], v[124:127], v[228:231], v[88:91]
ds_read_b128 v[120:123], v251 offset:11264
v_or_b32 v9, v10, v11
v_mfma_f32_16x16x32_f16 v[240:243], v[124:127], v[224:227], v[240:243]
ds_read_b128 v[124:127], v251 offset:9216
s_setprio 0
v_cvt_pkrtz_f16_f32 v199, v198, v199
v_mfma_f32_16x16x32_f16 v[92:95], v[184:187], v[228:231], v[92:95]
v_and_b32 v199, s49, v199
v_bfe_u32 v198, v199, 2, 14
v_mfma_f32_16x16x32_f16 v[244:247], v[184:187], v[224:227], v[244:247]
ds_read_b128 v[184:187], v248 offset:18688
v_lshrrev_b32 v199, 18, v199
s_waitcnt lgkmcnt(7)
v_mfma_f32_16x16x32_bf16 v[208:211], v[188:191], v[64:67], v[208:211]
ds_read_u16 v198, v198
ds_read_u16_d16_hi v199, v199
v_mfma_f32_16x16x32_f16 v[72:75], v[160:163], v[116:119], v[72:75]
v_exp_f16_sdwa v109, v109 dst_sel:WORD_1 dst_unused:UNUSED_PRESERVE src0_sel:WORD_1
v_or_b32_e64 v13, v14, v15
v_mfma_f32_16x16x32_f16 v[128:131], v[160:163], v[112:115], v[128:131]
ds_read_b128 v[160:163], v251 offset:10240
v_or_b32_e64 v97, v98, v99
v_mfma_f32_16x16x32_bf16 v[212:215], v[188:191], v[68:71], v[212:215]
v_pk_add_f16 v109, v109, 1.0 op_sel_hi:[1,0]
v_cvt_pk_f16_f32 v208, v208, v209
s_waitcnt lgkmcnt(5)
v_mfma_f32_16x16x32_f16 v[76:79], v[120:123], v[116:119], v[76:79]
v_rcp_f16_sdwa v109, v109 dst_sel:WORD_0 dst_unused:UNUSED_PRESERVE src0_sel:WORD_0
v_mfma_f32_16x16x32_f16 v[132:135], v[120:123], v[112:115], v[132:135]
ds_read_b128 v[120:123], v251 offset:13312
s_nop 0
v_cvt_pkrtz_f16_f32 v213, v212, v213
v_mfma_f32_16x16x32_bf16 v[180:183], v[188:191], v[40:43], v[180:183]
ds_read_b128 v[188:191], v251 offset:12288
v_and_b32 v213, s49, v213
s_waitcnt lgkmcnt(6)
v_mfma_f32_16x16x32_f16 v[80:83], v[124:127], v[116:119], v[80:83]
v_bfe_u32 v212, v213, 2, 14
v_lshrrev_b32 v213, 18, v213
s_waitcnt lgkmcnt(5)
v_mfma_f32_16x16x32_bf16 v[0:3], v[184:187], v[48:51], 0
ds_read_u16 v212, v212
ds_read_u16_d16_hi v213, v213
v_mfma_f32_16x16x32_f16 v[136:139], v[124:127], v[112:115], v[136:139]
ds_read_b128 v[124:127], v248 offset:20736
v_rcp_f16_sdwa v109, v109 dst_sel:WORD_1 dst_unused:UNUSED_PRESERVE src0_sel:WORD_1
v_mfma_f32_16x16x32_bf16 v[4:7], v[184:187], v[52:55], 0
v_pk_fma_f16 v209, v208, v208, s48
v_cvt_pkrtz_f16_f32 v181, v180, v181
s_waitcnt lgkmcnt(5)
v_mfma_f32_16x16x32_f16 v[88:91], v[160:163], v[116:119], v[88:91]
v_and_b32 v181, s49, v181
v_bfe_u32 v180, v181, 2, 14
s_waitcnt lgkmcnt(3)
v_mfma_f32_16x16x32_f16 v[84:87], v[188:191], v[116:119], v[84:87]
v_lshrrev_b32 v181, 18, v181
v_or_b32 v14, v192, v193
v_mfma_f32_16x16x32_f16 v[140:143], v[188:191], v[112:115], v[140:143]
ds_read_b128 v[188:191], v251 offset:17408
s_setprio 3
ds_read_u16 v180, v180
v_mfma_f32_16x16x32_bf16 v[224:227], v[184:187], v[24:27], 0
ds_read_b128 v[184:187], v251 offset:14336
ds_read_u16_d16_hi v181, v181
v_mfma_f32_16x16x32_f16 v[240:243], v[160:163], v[112:115], v[240:243]
ds_read_b128 v[160:163], v248 offset:22784
v_pk_mul_f16 v209, v208, v209
v_mfma_f32_16x16x32_f16 v[92:95], v[120:123], v[116:119], v[92:95]
v_cvt_pkrtz_f16_f32 v211, v210, v211
v_and_b32 v211, s49, v211
s_waitcnt lgkmcnt(5)
v_mfma_f32_16x16x32_bf16 v[0:3], v[124:127], v[56:59], v[0:3]
v_bfe_u32 v210, v211, 2, 14
v_lshrrev_b32 v211, 18, v211
v_mfma_f32_16x16x32_f16 v[244:247], v[120:123], v[112:115], v[244:247]
ds_read_b128 v[120:123], v251 offset:15360
ds_read_u16 v210, v210
ds_read_u16_d16_hi v211, v211
s_waitcnt vmcnt(5)
v_mfma_f32_16x16x32_bf16 v[128:131], v[18:21], v[164:167], v[128:131]
v_pk_mul_f16 v10, v108, v109
v_exp_f16_sdwa v209, v209 dst_sel:WORD_0 dst_unused:UNUSED_PRESERVE src0_sel:WORD_0
v_mfma_f32_16x16x32_bf16 v[132:135], v[16:19], v[164:167], v[132:135]
v_or_b32 v98, v196, v197
v_cvt_pkrtz_f16_f32 v215, v214, v215
s_waitcnt vmcnt(4)
v_mfma_f32_16x16x32_bf16 v[136:139], v[18:21], v[168:171], v[136:139]
v_and_b32_e64 v215, s49, v215
v_bfe_u32 v214, v215, 2, 14
v_mfma_f32_16x16x32_bf16 v[140:143], v[16:19], v[168:171], v[140:143]
v_lshrrev_b32_e64 v215, 18, v215
v_or_b32 v11, v110, v111
s_waitcnt lgkmcnt(5)
v_mfma_f32_16x16x32_f16 v[72:75], v[184:187], v[220:223], v[72:75]
ds_read_u16 v214, v214
ds_read_u16_d16_hi v215, v215
v_mfma_f32_16x16x32_bf16 v[4:7], v[124:127], v[60:63], v[4:7]
v_cvt_pkrtz_f16_f32 v183, v182, v183
v_and_b32_e64 v183, s49, v183
v_mfma_f32_16x16x32_f16 v[128:131], v[184:187], v[216:219], v[128:131]
ds_read_b128 v[184:187], v251 offset:16384
v_bfe_u32 v182, v183, 2, 14
v_mfma_f32_16x16x32_bf16 v[224:227], v[124:127], v[32:35], v[224:227]
ds_read_b128 v[124:127], v251 offset:18432
v_lshrrev_b32_e64 v183, 18, v183
v_mfma_f32_16x16x32_f16 v[76:79], v[188:191], v[220:223], v[76:79]
ds_read_u16 v182, v182
ds_read_u16_d16_hi v183, v183
v_mfma_f32_16x16x32_f16 v[132:135], v[188:191], v[216:219], v[132:135]
ds_read_b128 v[188:191], v248 offset:24576
v_exp_f16_sdwa v209, v209 dst_sel:WORD_1 dst_unused:UNUSED_PRESERVE src0_sel:WORD_1
s_waitcnt lgkmcnt(7)
v_mfma_f32_16x16x32_bf16 v[0:3], v[160:163], v[64:67], v[0:3]
v_or_b32 v15, v194, v195
v_or_b32_e64 v99, v198, v199
v_mfma_f32_16x16x32_f16 v[80:83], v[120:123], v[220:223], v[80:83]
v_pk_add_f16 v209, v209, 1.0 op_sel_hi:[1,0]
v_or_b32_e64 v212, v212, v213
v_mfma_f32_16x16x32_f16 v[136:139], v[120:123], v[216:219], v[136:139]
ds_read_b128 v[120:123], v251 offset:63488
v_rcp_f16_sdwa v209, v209 dst_sel:WORD_0 dst_unused:UNUSED_PRESERVE src0_sel:WORD_0
v_mfma_f32_16x16x32_bf16 v[4:7], v[160:163], v[68:71], v[4:7]
v_cvt_pk_f16_f32 v0, v0, v1
v_rcp_f16_sdwa v209, v209 dst_sel:WORD_1 dst_unused:UNUSED_PRESERVE src0_sel:WORD_1
s_waitcnt lgkmcnt(4)
v_mfma_f32_16x16x32_f16 v[84:87], v[124:127], v[220:223], v[84:87]
s_setprio 2
v_pk_fma_f16 v1, v0, v0, s48
v_cvt_pkrtz_f16_f32 v3, v2, v3
v_mfma_f32_16x16x32_f16 v[140:143], v[124:127], v[216:219], v[140:143]
ds_read_b128 v[124:127], v252 offset:1024
v_cvt_pkrtz_f16_f32 v5, v4, v5
v_mfma_f32_16x16x32_bf16 v[224:227], v[160:163], v[40:43], v[224:227]
ds_read_b128 v[160:163], v251 offset:19456
v_and_b32_e64 v5, s49, v5
v_mfma_f32_16x16x32_f16 v[88:91], v[184:187], v[220:223], v[88:91]
v_bfe_u32 v4, v5, 2, 14
v_lshrrev_b32 v5, 18, v5
v_mfma_f32_16x16x32_f16 v[240:243], v[184:187], v[216:219], v[240:243]
ds_read_b128 v[184:187], v248 offset:26624
ds_read_u16 v4, v4
s_waitcnt lgkmcnt(5)
v_mfma_f32_16x16x32_bf16 v[228:231], v[188:191], v[48:51], 0
ds_read_u16_d16_hi v5, v5
v_cvt_pkrtz_f16_f32 v225, v224, v225
v_mfma_f32_16x16x32_bf16 v[112:115], v[188:191], v[52:55], 0
v_and_b32 v225, s49, v225
v_bfe_u32 v224, v225, 2, 14
s_waitcnt vmcnt(3)
v_mfma_f32_16x16x32_bf16 v[240:243], v[18:21], v[100:103], v[240:243]
v_lshrrev_b32 v225, 18, v225
v_pk_mul_f16 v1, v0, v1
s_waitcnt lgkmcnt(3)
v_mfma_f32_16x16x32_f16 v[92:95], v[160:163], v[220:223], v[92:95]
ds_read_u16 v224, v224
ds_read_u16_d16_hi v225, v225
v_mfma_f32_16x16x32_f16 v[244:247], v[160:163], v[216:219], v[244:247]
ds_read_b128 v[160:163], v252 offset:2048
v_and_b32_e64 v3, s49, v3
v_mfma_f32_16x16x32_bf16 v[244:247], v[16:19], v[100:103], v[244:247]
v_bfe_u32 v2, v3, 2, 14
v_lshrrev_b32 v3, 18, v3
s_waitcnt vmcnt(2)
v_mfma_f32_16x16x32_bf16 v[72:75], v[18:21], v[104:107], v[72:75]
ds_read_u16 v2, v2
ds_read_u16_d16_hi v3, v3
v_mfma_f32_16x16x32_bf16 v[76:79], v[16:19], v[104:107], v[76:79]
v_pk_mul_f16 v208, v208, v209
v_exp_f16_sdwa v1, v1 dst_sel:WORD_0 dst_unused:UNUSED_PRESERVE src0_sel:WORD_0
v_mfma_f32_16x16x32_f16 v[72:75], v[120:123], v[236:239], v[72:75]
v_or_b32_e64 v180, v180, v181
v_cvt_pkrtz_f16_f32 v7, v6, v7
v_mfma_f32_16x16x32_bf16 v[116:119], v[188:191], v[24:27], 0
ds_read_b128 v[188:191], v251 offset:64512
v_and_b32 v7, s49, v7
v_mfma_f32_16x16x32_f16 v[128:131], v[120:123], v[232:235], v[128:131]
ds_read_b128 v[120:123], v248 offset:28672
s_nop 0
v_cvt_pk_bf16_f32 v72, v72, v73
v_mfma_f32_16x16x32_f16 v[76:79], v[124:127], v[236:239], v[76:79]
v_cvt_pk_bf16_f32 v73, v74, v75
v_bfe_u32 v6, v7, 2, 14
s_waitcnt lgkmcnt(6)
v_mfma_f32_16x16x32_bf16 v[228:231], v[184:187], v[56:59], v[228:231]
v_lshrrev_b32 v7, 18, v7
v_cvt_pk_bf16_f32 v128, v128, v129
v_mfma_f32_16x16x32_f16 v[132:135], v[124:127], v[232:235], v[132:135]
ds_read_b128 v[124:127], v252
v_cvt_pk_bf16_f32 v129, v130, v131
v_mfma_f32_16x16x32_bf16 v[112:115], v[184:187], v[60:63], v[112:115]
v_cvt_pk_bf16_f32 v74, v76, v77
v_cvt_pk_bf16_f32 v75, v78, v79
v_mfma_f32_16x16x32_bf16 v[116:119], v[184:187], v[32:35], v[116:119]
ds_read_b128 v[76:79], v254 offset:8208
s_nop 0
v_cvt_pk_bf16_f32 v130, v132, v133
s_waitcnt lgkmcnt(3)
v_mfma_f32_16x16x32_f16 v[80:83], v[188:191], v[236:239], v[80:83]
v_cvt_pk_bf16_f32 v131, v134, v135
s_setprio 1
ds_read_b128 v[132:135], v254 offset:8192
v_mfma_f32_16x16x32_f16 v[136:139], v[188:191], v[232:235], v[136:139]
ds_read_b128 v[188:191], v251 offset:8192
ds_read_u16 v6, v6
ds_read_u16_d16_hi v7, v7
ds_read_b128 v[184:187], v252 offset:3072
v_mfma_f32_16x16x32_f16 v[84:87], v[160:163], v[236:239], v[84:87]
v_or_b32 v209, v210, v211
v_cvt_pkrtz_f16_f32 v227, v226, v227
v_mfma_f32_16x16x32_f16 v[140:143], v[160:163], v[232:235], v[140:143]
v_cvt_pk_bf16_f32 v136, v136, v137
v_cvt_pk_bf16_f32 v137, v138, v139
v_and_b32_e64 v227, s49, v227
v_bfe_u32 v226, v227, 2, 14
v_lshrrev_b32 v227, 18, v227
s_waitcnt lgkmcnt(6)
v_mfma_f32_16x16x32_bf16 v[228:231], v[120:123], v[64:67], v[228:231]
ds_read_b128 v[160:163], v248 offset:24832
ds_read_u16 v226, v226
v_cvt_pk_bf16_f32 v138, v140, v141
v_cvt_pk_bf16_f32 v139, v142, v143
v_mfma_f32_16x16x32_f16 v[88:91], v[124:127], v[236:239], v[88:91]
ds_read_b128 v[140:143], v254 offset:8320
ds_read_u16_d16_hi v227, v227
v_exp_f16_sdwa v1, v1 dst_sel:WORD_1 dst_unused:UNUSED_PRESERVE src0_sel:WORD_1
v_or_b32_e64 v213, v214, v215
v_mfma_f32_16x16x32_f16 v[240:243], v[124:127], v[232:235], v[240:243]
ds_read_b128 v[124:127], v248 offset:26880
v_or_b32_e64 v181, v182, v183
v_mfma_f32_16x16x32_bf16 v[112:115], v[120:123], v[68:71], v[112:115]
v_pk_add_f16 v1, v1, 1.0 op_sel_hi:[1,0]
v_cvt_pk_f16_f32 v228, v228, v229
v_mfma_f32_16x16x32_bf16 v[116:119], v[120:123], v[40:43], v[116:119]
ds_read_b128 v[120:123], v251 offset:11264
s_nop 0
v_cvt_pk_bf16_f32 v240, v240, v241
v_cvt_pk_bf16_f32 v241, v242, v243
s_waitcnt lgkmcnt(6)
v_mfma_f32_16x16x32_f16 v[92:95], v[184:187], v[236:239], v[92:95]
v_rcp_f16_sdwa v1, v1 dst_sel:WORD_0 dst_unused:UNUSED_PRESERVE src0_sel:WORD_0
v_mfma_f32_16x16x32_f16 v[244:247], v[184:187], v[232:235], v[244:247]
ds_read_b128 v[184:187], v251 offset:9216
v_cvt_pkrtz_f16_f32 v113, v112, v113
s_waitcnt vmcnt(1)
v_mfma_f32_16x16x32_bf16 v[80:83], v[18:21], v[200:203], v[80:83]
v_and_b32 v113, s49, v113
v_bfe_u32 v112, v113, 2, 14
v_mfma_f32_16x16x32_bf16 v[84:87], v[16:19], v[200:203], v[84:87]
v_lshrrev_b32_e64 v113, 18, v113
v_cvt_pk_bf16_f32 v242, v244, v245
v_cvt_pk_bf16_f32 v243, v246, v247
s_waitcnt vmcnt(0)
v_mfma_f32_16x16x32_bf16 v[88:91], v[18:21], v[204:207], v[88:91]
ds_read_b128 v[244:247], v254
v_cvt_pk_bf16_f32 v80, v80, v81
v_mfma_f32_16x16x32_bf16 v[92:95], v[16:19], v[204:207], v[92:95]
v_cvt_pk_bf16_f32 v81, v82, v83
v_cvt_pk_bf16_f32 v82, v84, v85
v_cvt_pk_bf16_f32 v83, v86, v87
v_mfma_f32_16x16x32_f16 v[164:167], v[188:191], v[152:155], v[132:135]
ds_read_b128 v[84:87], v254 offset:8336
v_cvt_pk_bf16_f32 v88, v88, v89
v_cvt_pk_bf16_f32 v89, v90, v91
s_waitcnt lgkmcnt(3)
v_mfma_f32_16x16x32_bf16 v[108:111], v[160:163], v[48:51], 0
v_cvt_pk_bf16_f32 v90, v92, v93
v_cvt_pk_bf16_f32 v91, v94, v95
v_mfma_f32_16x16x32_f16 v[168:171], v[188:191], v[148:151], v[132:135]
ds_read_b128 v[92:95], v254 offset:16
buffer_store_dwordx4 v[128:131], v253, s[8:11], s71 offen sc1
buffer_store_dwordx4 v[136:139], v253, s[8:11], s71 offen offset:64 sc1
v_mfma_f32_16x16x32_f16 v[132:135], v[188:191], v[144:147], v[132:135]
ds_read_b128 v[188:191], v251 offset:12288
ds_read_u16 v112, v112
v_mfma_f32_16x16x32_bf16 v[192:195], v[160:163], v[52:55], 0
ds_read_u16_d16_hi v113, v113
v_rcp_f16_sdwa v1, v1 dst_sel:WORD_1 dst_unused:UNUSED_PRESERVE src0_sel:WORD_1
v_mfma_f32_16x16x32_f16 v[216:219], v[120:123], v[152:155], v[76:79]
s_setprio 0
v_pk_fma_f16 v229, v228, v228, s48
v_cvt_pkrtz_f16_f32 v117, v116, v117
v_mfma_f32_16x16x32_bf16 v[196:199], v[160:163], v[24:27], 0
ds_read_b128 v[160:163], v248 offset:28928
v_and_b32 v117, s49, v117
v_mfma_f32_16x16x32_f16 v[220:223], v[120:123], v[148:151], v[76:79]
v_bfe_u32 v116, v117, 2, 14
v_lshrrev_b32_e64 v117, 18, v117
v_mfma_f32_16x16x32_f16 v[76:79], v[120:123], v[144:147], v[76:79]
ds_read_b128 v[120:123], v251 offset:10240
ds_read_u16 v116, v116
ds_read_u16_d16_hi v117, v117
v_mfma_f32_16x16x32_bf16 v[108:111], v[124:127], v[56:59], v[108:111]
v_or_b32 v214, v4, v5
v_pk_mul_f16 v229, v228, v229
s_waitcnt lgkmcnt(7)
v_mfma_f32_16x16x32_f16 v[100:103], v[184:187], v[152:155], v[140:143]
v_cvt_pkrtz_f16_f32 v231, v230, v231
v_and_b32_e64 v231, s49, v231
v_bfe_u32 v230, v231, 2, 14
v_lshrrev_b32_e64 v231, 18, v231
v_pk_mul_f16 v210, v0, v1
v_mfma_f32_16x16x32_bf16 v[192:195], v[124:127], v[60:63], v[192:195]
ds_read_u16 v230, v230
ds_read_u16_d16_hi v231, v231
v_mfma_f32_16x16x32_f16 v[104:107], v[184:187], v[148:151], v[140:143]
v_exp_f16_sdwa v229, v229 dst_sel:WORD_0 dst_unused:UNUSED_PRESERVE src0_sel:WORD_0
v_or_b32_e64 v182, v224, v225
v_mfma_f32_16x16x32_f16 v[140:143], v[184:187], v[144:147], v[140:143]
ds_read_b128 v[184:187], v251 offset:13312
v_cvt_pkrtz_f16_f32 v115, v114, v115
v_and_b32_e64 v115, s49, v115
v_bfe_u32 v114, v115, 2, 14
v_lshrrev_b32_e64 v115, 18, v115
v_mfma_f32_16x16x32_bf16 v[196:199], v[124:127], v[32:35], v[196:199]
ds_read_u16 v114, v114
ds_read_u16_d16_hi v115, v115
ds_read_b128 v[124:127], v248 offset:30720
s_waitcnt lgkmcnt(7)
v_mfma_f32_16x16x32_f16 v[232:235], v[188:191], v[152:155], v[84:87]
v_or_b32 v211, v2, v3
v_cvt_pkrtz_f16_f32 v119, v118, v119
v_and_b32_e64 v119, s49, v119
v_bfe_u32 v118, v119, 2, 14
v_lshrrev_b32_e64 v119, 18, v119
v_mfma_f32_16x16x32_f16 v[236:239], v[188:191], v[148:151], v[84:87]
ds_read_u16 v118, v118
ds_read_u16_d16_hi v119, v119
v_mfma_f32_16x16x32_bf16 v[108:111], v[160:163], v[64:67], v[108:111]
v_exp_f16_sdwa v229, v229 dst_sel:WORD_1 dst_unused:UNUSED_PRESERVE src0_sel:WORD_1
v_or_b32_e64 v215, v6, v7
v_mfma_f32_16x16x32_f16 v[84:87], v[188:191], v[144:147], v[84:87]
ds_read_b128 v[188:191], v251 offset:14336
v_or_b32_e64 v183, v226, v227
v_mfma_f32_16x16x32_bf16 v[192:195], v[160:163], v[68:71], v[192:195]
v_pk_add_f16 v229, v229, 1.0 op_sel_hi:[1,0]
s_nop 0
v_cvt_pk_f16_f32 v108, v108, v109
v_mfma_f32_16x16x32_f16 v[200:203], v[120:123], v[152:155], v[244:247]
s_setprio 3
v_rcp_f16_sdwa v229, v229 dst_sel:WORD_0 dst_unused:UNUSED_PRESERVE src0_sel:WORD_0
v_mfma_f32_16x16x32_f16 v[204:207], v[120:123], v[148:151], v[244:247]
s_nop 0
v_cvt_pkrtz_f16_f32 v193, v192, v193
v_and_b32 v193, s49, v193
v_mfma_f32_16x16x32_bf16 v[196:199], v[160:163], v[40:43], v[196:199]
ds_read_b128 v[160:163], v248 offset:32768
v_bfe_u32 v192, v193, 2, 14
v_mfma_f32_16x16x32_f16 v[244:247], v[120:123], v[144:147], v[244:247]
ds_read_b128 v[120:123], v251 offset:17408
v_lshrrev_b32 v193, 18, v193
s_waitcnt lgkmcnt(5)
v_mfma_f32_16x16x32_bf16 v[128:131], v[124:127], v[48:51], 0
ds_read_u16 v192, v192
ds_read_u16_d16_hi v193, v193
v_mfma_f32_16x16x32_f16 v[4:7], v[184:187], v[152:155], v[92:95]
v_rcp_f16_sdwa v229, v229 dst_sel:WORD_1 dst_unused:UNUSED_PRESERVE src0_sel:WORD_1
v_mfma_f32_16x16x32_f16 v[224:227], v[184:187], v[148:151], v[92:95]
v_pk_fma_f16 v109, v108, v108, s48
v_cvt_pkrtz_f16_f32 v197, v196, v197
v_mfma_f32_16x16x32_bf16 v[136:139], v[124:127], v[52:55], 0
v_and_b32_e64 v197, s49, v197
v_bfe_u32 v196, v197, 2, 14
v_mfma_f32_16x16x32_f16 v[92:95], v[184:187], v[144:147], v[92:95]
ds_read_b128 v[184:187], v251 offset:15360
v_lshrrev_b32_e64 v197, 18, v197
v_mfma_f32_16x16x32_bf16 v[0:3], v[124:127], v[24:27], 0
ds_read_b128 v[124:127], v248 offset:34816
ds_read_u16 v196, v196
s_waitcnt lgkmcnt(6)
v_mfma_f32_16x16x32_f16 v[164:167], v[188:191], v[176:179], v[164:167]
ds_read_u16_d16_hi v197, v197
v_or_b32 v112, v112, v113
v_mfma_f32_16x16x32_f16 v[168:171], v[188:191], v[156:159], v[168:171]
v_pk_mul_f16 v109, v108, v109
v_cvt_pkrtz_f16_f32 v111, v110, v111
v_mfma_f32_16x16x32_bf16 v[128:131], v[160:163], v[56:59], v[128:131]
v_and_b32_e64 v111, s49, v111
v_bfe_u32 v110, v111, 2, 14
v_mfma_f32_16x16x32_f16 v[132:135], v[188:191], v[172:175], v[132:135]
ds_read_b128 v[188:191], v251 offset:18432
v_lshrrev_b32_e64 v111, 18, v111
v_pk_mul_f16 v228, v228, v229
v_mfma_f32_16x16x32_bf16 v[136:139], v[160:163], v[60:63], v[136:139]
ds_read_u16 v110, v110
ds_read_u16_d16_hi v111, v111
s_waitcnt lgkmcnt(7)
v_mfma_f32_16x16x32_f16 v[216:219], v[120:123], v[176:179], v[216:219]
s_setprio 2
v_exp_f16_sdwa v109, v109 dst_sel:WORD_0 dst_unused:UNUSED_PRESERVE src0_sel:WORD_0
v_or_b32_e64 v116, v116, v117
v_cvt_pkrtz_f16_f32 v195, v194, v195
v_and_b32_e64 v195, s49, v195
v_bfe_u32 v194, v195, 2, 14
v_lshrrev_b32_e64 v195, 18, v195
v_mfma_f32_16x16x32_f16 v[220:223], v[120:123], v[156:159], v[220:223]
ds_read_u16 v194, v194
ds_read_u16_d16_hi v195, v195
v_mfma_f32_16x16x32_bf16 v[0:3], v[160:163], v[32:35], v[0:3]
ds_read_b128 v[160:163], v248 offset:30976
v_or_b32_e64 v229, v230, v231
v_mfma_f32_16x16x32_f16 v[76:79], v[120:123], v[172:175], v[76:79]
ds_read_b128 v[120:123], v251 offset:16384
v_cvt_pkrtz_f16_f32 v199, v198, v199
v_and_b32_e64 v199, s49, v199
v_bfe_u32 v198, v199, 2, 14
v_lshrrev_b32 v199, 18, v199
s_waitcnt lgkmcnt(6)
v_mfma_f32_16x16x32_bf16 v[128:131], v[124:127], v[64:67], v[128:131]
ds_read_u16 v198, v198
ds_read_u16_d16_hi v199, v199
v_mfma_f32_16x16x32_f16 v[100:103], v[184:187], v[176:179], v[100:103]
v_exp_f16_sdwa v109, v109 dst_sel:WORD_1 dst_unused:UNUSED_PRESERVE src0_sel:WORD_1
v_or_b32_e64 v113, v114, v115
v_mfma_f32_16x16x32_f16 v[104:107], v[184:187], v[156:159], v[104:107]
v_or_b32_e64 v117, v118, v119
v_pk_add_f16 v109, v109, 1.0 op_sel_hi:[1,0]
v_mfma_f32_16x16x32_bf16 v[136:139], v[124:127], v[68:71], v[136:139]
v_rcp_f16_sdwa v109, v109 dst_sel:WORD_0 dst_unused:UNUSED_PRESERVE src0_sel:WORD_0
v_mfma_f32_16x16x32_f16 v[140:143], v[184:187], v[172:175], v[140:143]
ds_read_b128 v[184:187], v251 offset:19456
v_cvt_pk_f16_f32 v128, v128, v129
v_mfma_f32_16x16x32_bf16 v[0:3], v[124:127], v[40:43], v[0:3]
ds_read_b128 v[124:127], v248 offset:33024
s_nop 1
v_cvt_pkrtz_f16_f32 v137, v136, v137
v_mfma_f32_16x16x32_f16 v[232:235], v[188:191], v[176:179], v[232:235]
v_and_b32 v137, s49, v137
v_bfe_u32 v136, v137, 2, 14
v_mfma_f32_16x16x32_f16 v[236:239], v[188:191], v[156:159], v[236:239]
v_lshrrev_b32 v137, 18, v137
v_rcp_f16_sdwa v109, v109 dst_sel:WORD_1 dst_unused:UNUSED_PRESERVE src0_sel:WORD_1
s_waitcnt lgkmcnt(4)
v_mfma_f32_16x16x32_bf16 v[144:147], v[160:163], v[48:51], 0
ds_read_u16 v136, v136
ds_read_u16_d16_hi v137, v137
v_mfma_f32_16x16x32_f16 v[84:87], v[188:191], v[172:175], v[84:87]
ds_read_b128 v[188:191], v248 offset:35072
v_pk_fma_f16 v129, v128, v128, s48
v_mfma_f32_16x16x32_bf16 v[148:151], v[160:163], v[52:55], 0
v_cvt_pkrtz_f16_f32 v1, v0, v1
v_and_b32 v1, s49, v1
v_mfma_f32_16x16x32_f16 v[200:203], v[120:123], v[176:179], v[200:203]
s_setprio 1
buffer_store_dwordx4 v[240:243], v253, s[8:11], s71 offen offset:128 sc1
buffer_store_dwordx4 v[72:75], v253, s[8:11], s71 offen offset:192 sc1
v_bfe_u32 v0, v1, 2, 14
v_mfma_f32_16x16x32_f16 v[204:207], v[120:123], v[156:159], v[204:207]
v_lshrrev_b32 v1, 18, v1
v_or_b32 v114, v192, v193
v_mfma_f32_16x16x32_bf16 v[152:155], v[160:163], v[24:27], 0
ds_read_b128 v[160:163], v251 offset:23552
ds_read_u16 v0, v0
v_mfma_f32_16x16x32_f16 v[244:247], v[120:123], v[172:175], v[244:247]
ds_read_b128 v[120:123], v249
ds_read_u16_d16_hi v1, v1
buffer_load_dwordx4 v[240:243], v253, s[4:7], s70 offen
buffer_load_dwordx4 v[72:75], v253, s[4:7], s70 offen offset:64
s_waitcnt lgkmcnt(7)
v_mfma_f32_16x16x32_bf16 v[144:147], v[124:127], v[56:59], v[144:147]
v_pk_mul_f16 v129, v128, v129
v_cvt_pkrtz_f16_f32 v131, v130, v131
v_mfma_f32_16x16x32_f16 v[4:7], v[184:187], v[176:179], v[4:7]
ds_read_b128 v[176:179], v251 offset:20480
v_and_b32 v131, s49, v131
v_mfma_f32_16x16x32_f16 v[224:227], v[184:187], v[156:159], v[224:227]
v_bfe_u32 v130, v131, 2, 14
v_lshrrev_b32_e64 v131, 18, v131
v_pk_mul_f16 v230, v108, v109
v_mfma_f32_16x16x32_bf16 v[148:151], v[124:127], v[60:63], v[148:151]
ds_read_u16 v130, v130
ds_read_u16_d16_hi v131, v131
v_mfma_f32_16x16x32_f16 v[92:95], v[184:187], v[172:175], v[92:95]
ds_read_b128 v[184:187], v251 offset:24576
v_exp_f16_sdwa v129, v129 dst_sel:WORD_0 dst_unused:UNUSED_PRESERVE src0_sel:WORD_0
v_or_b32_e64 v118, v196, v197
v_cvt_pkrtz_f16_f32 v139, v138, v139
v_and_b32_e64 v139, s49, v139
v_bfe_u32 v138, v139, 2, 14
v_lshrrev_b32_e64 v139, 18, v139
v_mfma_f32_16x16x32_bf16 v[152:155], v[124:127], v[32:35], v[152:155]
ds_read_u16 v138, v138
ds_read_u16_d16_hi v139, v139
ds_read_b128 v[124:127], v251 offset:21504
buffer_load_dwordx4 v[172:175], v253, s[4:7], s70 offen offset:128
buffer_load_dwordx4 v[156:159], v253, s[4:7], s70 offen offset:192
v_or_b32 v231, v110, v111
s_waitcnt lgkmcnt(6)
v_mfma_f32_16x16x32_f16 v[164:167], v[176:179], v[96:99], v[164:167]
v_cvt_pkrtz_f16_f32 v3, v2, v3
v_and_b32_e64 v3, s49, v3
v_mfma_f32_16x16x32_f16 v[168:171], v[176:179], v[12:15], v[168:171]
v_bfe_u32 v2, v3, 2, 14
v_lshrrev_b32_e64 v3, 18, v3
v_mfma_f32_16x16x32_bf16 v[144:147], v[188:191], v[64:67], v[144:147]
ds_read_u16 v2, v2
ds_read_u16_d16_hi v3, v3
v_mfma_f32_16x16x32_f16 v[132:135], v[176:179], v[8:11], v[132:135]
ds_read_b128 v[176:179], v249 offset:2048
v_exp_f16_sdwa v129, v129 dst_sel:WORD_1 dst_unused:UNUSED_PRESERVE src0_sel:WORD_1
v_or_b32_e64 v115, v194, v195
v_mfma_f32_16x16x32_bf16 v[148:151], v[188:191], v[68:71], v[148:151]
v_or_b32_e64 v119, v198, v199
v_pk_add_f16 v129, v129, 1.0 op_sel_hi:[1,0]
v_mfma_f32_16x16x32_f16 v[216:219], v[160:163], v[96:99], v[216:219]
s_setprio 0
v_rcp_f16_sdwa v129, v129 dst_sel:WORD_0 dst_unused:UNUSED_PRESERVE src0_sel:WORD_0
v_mfma_f32_16x16x32_f16 v[220:223], v[160:163], v[12:15], v[220:223]
s_nop 1
v_cvt_pkrtz_f16_f32 v149, v148, v149
v_and_b32_e64 v149, s49, v149
v_mfma_f32_16x16x32_bf16 v[152:155], v[188:191], v[40:43], v[152:155]
ds_read_b128 v[188:191], v251 offset:22528
v_bfe_u32 v148, v149, 2, 14
v_mfma_f32_16x16x32_f16 v[76:79], v[160:163], v[8:11], v[76:79]
ds_read_b128 v[160:163], v251 offset:25600
v_lshrrev_b32 v149, 18, v149
v_mfma_f32_16x16x32_bf16 v[108:111], v[120:123], v[48:51], 0
ds_read_u16 v148, v148
ds_read_u16_d16_hi v149, v149
s_waitcnt lgkmcnt(7)
v_mfma_f32_16x16x32_f16 v[100:103], v[124:127], v[96:99], v[100:103]
v_cvt_pk_f16_f32 v144, v144, v145
v_rcp_f16_sdwa v129, v129 dst_sel:WORD_1 dst_unused:UNUSED_PRESERVE src0_sel:WORD_1
v_mfma_f32_16x16x32_f16 v[104:107], v[124:127], v[12:15], v[104:107]
v_pk_fma_f16 v145, v144, v144, s48
v_cvt_pkrtz_f16_f32 v153, v152, v153
v_mfma_f32_16x16x32_bf16 v[192:195], v[120:123], v[52:55], 0
v_and_b32_e64 v153, s49, v153
v_bfe_u32 v152, v153, 2, 14
v_mfma_f32_16x16x32_f16 v[140:143], v[124:127], v[8:11], v[140:143]
ds_read_b128 v[124:127], v251 offset:26624
v_lshrrev_b32_e64 v153, 18, v153
v_mfma_f32_16x16x32_f16 v[232:235], v[184:187], v[96:99], v[232:235]
ds_read_u16 v152, v152
ds_read_u16_d16_hi v153, v153
v_mfma_f32_16x16x32_bf16 v[196:199], v[120:123], v[24:27], 0
ds_read_b128 v[120:123], v249 offset:4096
v_or_b32_e64 v136, v136, v137
v_mfma_f32_16x16x32_f16 v[236:239], v[184:187], v[12:15], v[236:239]
v_pk_mul_f16 v145, v144, v145
v_cvt_pkrtz_f16_f32 v147, v146, v147
s_waitcnt lgkmcnt(5)
v_mfma_f32_16x16x32_bf16 v[108:111], v[176:179], v[56:59], v[108:111]
v_and_b32 v147, s49, v147
v_bfe_u32 v146, v147, 2, 14
v_mfma_f32_16x16x32_f16 v[84:87], v[184:187], v[8:11], v[84:87]
ds_read_b128 v[184:187], v249 offset:256
v_lshrrev_b32_e64 v147, 18, v147
v_pk_mul_f16 v128, v128, v129
v_mfma_f32_16x16x32_f16 v[200:203], v[188:191], v[96:99], v[200:203]
ds_read_u16 v146, v146
ds_read_u16_d16_hi v147, v147
s_setprio 3
v_mfma_f32_16x16x32_bf16 v[192:195], v[176:179], v[60:63], v[192:195]
v_exp_f16_sdwa v145, v145 dst_sel:WORD_0 dst_unused:UNUSED_PRESERVE src0_sel:WORD_0
v_or_b32 v0, v0, v1
v_mfma_f32_16x16x32_f16 v[204:207], v[188:191], v[12:15], v[204:207]
v_cvt_pkrtz_f16_f32 v151, v150, v151
v_and_b32_e64 v151, s49, v151
v_bfe_u32 v150, v151, 2, 14
v_lshrrev_b32_e64 v151, 18, v151
v_mfma_f32_16x16x32_bf16 v[196:199], v[176:179], v[32:35], v[196:199]
ds_read_u16 v150, v150
ds_read_u16_d16_hi v151, v151
ds_read_b128 v[176:179], v251 offset:29696
v_mfma_f32_16x16x32_f16 v[244:247], v[188:191], v[8:11], v[244:247]
ds_read_b128 v[188:191], v251 offset:27648
v_or_b32_e64 v129, v130, v131
v_cvt_pkrtz_f16_f32 v155, v154, v155
v_and_b32_e64 v155, s49, v155
v_bfe_u32 v154, v155, 2, 14
v_lshrrev_b32_e64 v155, 18, v155
v_mfma_f32_16x16x32_f16 v[4:7], v[160:163], v[96:99], v[4:7]
ds_read_u16 v154, v154
ds_read_u16_d16_hi v155, v155
s_waitcnt lgkmcnt(8)
v_mfma_f32_16x16x32_bf16 v[108:111], v[120:123], v[64:67], v[108:111]
v_exp_f16_sdwa v145, v145 dst_sel:WORD_1 dst_unused:UNUSED_PRESERVE src0_sel:WORD_1
v_or_b32 v137, v138, v139
v_mfma_f32_16x16x32_f16 v[224:227], v[160:163], v[12:15], v[224:227]
v_or_b32_e64 v1, v2, v3
v_pk_add_f16 v145, v145, 1.0 op_sel_hi:[1,0]
v_mfma_f32_16x16x32_bf16 v[192:195], v[120:123], v[68:71], v[192:195]
v_rcp_f16_sdwa v145, v145 dst_sel:WORD_0 dst_unused:UNUSED_PRESERVE src0_sel:WORD_0
v_mfma_f32_16x16x32_f16 v[92:95], v[160:163], v[8:11], v[92:95]
ds_read_b128 v[160:163], v249 offset:2304
v_cvt_pkrtz_f16_f32 v109, v108, v109
v_mfma_f32_16x16x32_f16 v[164:167], v[124:127], v[180:183], v[164:167]
v_and_b32_e64 v109, s49, v109
v_bfe_u32 v108, v109, 2, 14
v_mfma_f32_16x16x32_bf16 v[196:199], v[120:123], v[40:43], v[196:199]
ds_read_b128 v[120:123], v251 offset:30720
v_lshrrev_b32_e64 v109, 18, v109
v_mfma_f32_16x16x32_f16 v[168:171], v[124:127], v[212:215], v[168:171]
ds_read_u16 v108, v108
ds_read_u16_d16_hi v109, v109
v_mfma_f32_16x16x32_bf16 v[8:11], v[184:187], v[48:51], 0
v_rcp_f16_sdwa v145, v145 dst_sel:WORD_1 dst_unused:UNUSED_PRESERVE src0_sel:WORD_1
v_mfma_f32_16x16x32_f16 v[132:135], v[124:127], v[208:211], v[132:135]
ds_read_b128 v[124:127], v249 offset:4352
s_setprio 2
v_cvt_pkrtz_f16_f32 v193, v192, v193
s_waitcnt lgkmcnt(6)
v_mfma_f32_16x16x32_f16 v[216:219], v[176:179], v[180:183], v[216:219]
v_and_b32_e64 v193, s49, v193
v_bfe_u32 v192, v193, 2, 14
v_mfma_f32_16x16x32_bf16 v[12:15], v[184:187], v[52:55], 0
v_lshrrev_b32_e64 v193, 18, v193
v_cvt_pkrtz_f16_f32 v197, v196, v197
v_mfma_f32_16x16x32_f16 v[220:223], v[176:179], v[212:215], v[220:223]
ds_read_u16 v192, v192
ds_read_u16_d16_hi v193, v193
v_mfma_f32_16x16x32_bf16 v[96:99], v[184:187], v[24:27], 0
ds_read_b128 v[184:187], v251 offset:28672
v_and_b32_e64 v197, s49, v197
v_mfma_f32_16x16x32_f16 v[76:79], v[176:179], v[208:211], v[76:79]
ds_read_b128 v[176:179], v251 offset:31744
v_bfe_u32 v196, v197, 2, 14
v_mfma_f32_16x16x32_f16 v[100:103], v[188:191], v[180:183], v[100:103]
buffer_store_dwordx4 v[80:83], v253, s[8:11], s71 offen offset:256 sc1
buffer_store_dwordx4 v[88:91], v253, s[8:11], s71 offen offset:320 sc1
buffer_load_dwordx4 v[80:83], v253, s[4:7], s70 offen offset:256
buffer_load_dwordx4 v[88:91], v253, s[4:7], s70 offen offset:320
s_waitcnt lgkmcnt(6)
v_mfma_f32_16x16x32_bf16 v[8:11], v[160:163], v[56:59], v[8:11]
v_lshrrev_b32 v197, 18, v197
v_or_b32_e64 v138, v148, v149
v_mfma_f32_16x16x32_f16 v[104:107], v[188:191], v[212:215], v[104:107]
ds_read_u16 v196, v196
ds_read_u16_d16_hi v197, v197
v_pk_mul_f16 v130, v144, v145
v_mfma_f32_16x16x32_bf16 v[12:15], v[160:163], v[60:63], v[12:15]
v_cvt_pkrtz_f16_f32 v111, v110, v111
v_and_b32_e64 v111, s49, v111
v_mfma_f32_16x16x32_f16 v[140:143], v[188:191], v[208:211], v[140:143]
ds_read_b128 v[188:191], v249 offset:6144
v_bfe_u32 v110, v111, 2, 14
v_lshrrev_b32 v111, 18, v111
v_or_b32 v2, v152, v153
v_mfma_f32_16x16x32_f16 v[232:235], v[120:123], v[180:183], v[232:235]
ds_read_u16 v110, v110
ds_read_u16_d16_hi v111, v111
v_mfma_f32_16x16x32_bf16 v[96:99], v[160:163], v[32:35], v[96:99]
ds_read_b128 v[160:163], v251 offset:32768
v_cvt_pkrtz_f16_f32 v195, v194, v195
v_and_b32_e64 v195, s49, v195
v_bfe_u32 v194, v195, 2, 14
v_lshrrev_b32_e64 v195, 18, v195
v_mfma_f32_16x16x32_f16 v[236:239], v[120:123], v[212:215], v[236:239]
ds_read_u16 v194, v194
ds_read_u16_d16_hi v195, v195
v_or_b32_e64 v131, v146, v147
v_cvt_pkrtz_f16_f32 v199, v198, v199
v_and_b32_e64 v199, s49, v199
v_bfe_u32 v198, v199, 2, 14
v_lshrrev_b32 v199, 18, v199
s_waitcnt lgkmcnt(7)
v_mfma_f32_16x16x32_bf16 v[8:11], v[124:127], v[64:67], v[8:11]
ds_read_u16 v198, v198
ds_read_u16_d16_hi v199, v199
v_mfma_f32_16x16x32_f16 v[84:87], v[120:123], v[208:211], v[84:87]
ds_read_b128 v[120:123], v249 offset:8192
v_or_b32 v139, v150, v151
s_setprio 1
v_mfma_f32_16x16x32_f16 v[200:203], v[184:187], v[180:183], v[200:203]
v_or_b32_e64 v3, v154, v155
v_cvt_pk_f16_f32 v8, v8, v9
v_mfma_f32_16x16x32_bf16 v[12:15], v[124:127], v[68:71], v[12:15]
v_pk_fma_f16 v9, v8, v8, s48
v_or_b32_e64 v108, v108, v109
v_mfma_f32_16x16x32_f16 v[204:207], v[184:187], v[212:215], v[204:207]
v_pk_mul_f16 v9, v8, v9
v_cvt_pkrtz_f16_f32 v11, v10, v11
v_mfma_f32_16x16x32_bf16 v[96:99], v[124:127], v[40:43], v[96:99]
ds_read_b128 v[124:127], v251 offset:35840
s_nop 0
v_cvt_pkrtz_f16_f32 v13, v12, v13
v_mfma_f32_16x16x32_f16 v[244:247], v[184:187], v[208:211], v[244:247]
ds_read_b128 v[184:187], v251 offset:33792
v_and_b32 v13, s49, v13
v_mfma_f32_16x16x32_f16 v[4:7], v[176:179], v[180:183], v[4:7]
v_bfe_u32 v12, v13, 2, 14
v_lshrrev_b32 v13, 18, v13
s_waitcnt lgkmcnt(6)
v_mfma_f32_16x16x32_bf16 v[144:147], v[188:191], v[48:51], 0
ds_read_u16 v12, v12
ds_read_u16_d16_hi v13, v13
v_mfma_f32_16x16x32_f16 v[224:227], v[176:179], v[212:215], v[224:227]
v_cvt_pkrtz_f16_f32 v97, v96, v97
v_and_b32_e64 v97, s49, v97
v_mfma_f32_16x16x32_bf16 v[148:151], v[188:191], v[52:55], 0
v_bfe_u32 v96, v97, 2, 14
v_lshrrev_b32_e64 v97, 18, v97
v_mfma_f32_16x16x32_f16 v[92:95], v[176:179], v[208:211], v[92:95]
ds_read_b128 v[176:179], v249 offset:10240
ds_read_u16 v96, v96
v_mfma_f32_16x16x32_f16 v[164:167], v[160:163], v[116:119], v[164:167]
ds_read_u16_d16_hi v97, v97
v_and_b32_e64 v11, s49, v11
v_mfma_f32_16x16x32_bf16 v[152:155], v[188:191], v[24:27], 0
ds_read_b128 v[188:191], v251 offset:36864
v_bfe_u32 v10, v11, 2, 14
v_mfma_f32_16x16x32_f16 v[168:171], v[160:163], v[112:115], v[168:171]
v_lshrrev_b32_e64 v11, 18, v11
v_or_b32 v192, v192, v193
s_waitcnt lgkmcnt(6)
v_mfma_f32_16x16x32_bf16 v[144:147], v[120:123], v[56:59], v[144:147]
ds_read_u16 v10, v10
ds_read_u16_d16_hi v11, v11
v_mfma_f32_16x16x32_f16 v[132:135], v[160:163], v[228:231], v[132:135]
ds_read_b128 v[160:163], v249 offset:6400
s_setprio 0
v_exp_f16_sdwa v9, v9 dst_sel:WORD_0 dst_unused:UNUSED_PRESERVE src0_sel:WORD_0
v_mfma_f32_16x16x32_f16 v[216:219], v[124:127], v[116:119], v[216:219]
v_cvt_pkrtz_f16_f32 v15, v14, v15
v_and_b32 v15, s49, v15
v_mfma_f32_16x16x32_bf16 v[148:151], v[120:123], v[60:63], v[148:151]
v_bfe_u32 v14, v15, 2, 14
v_lshrrev_b32_e64 v15, 18, v15
v_mfma_f32_16x16x32_f16 v[220:223], v[124:127], v[112:115], v[220:223]
ds_read_u16 v14, v14
ds_read_u16_d16_hi v15, v15
v_mfma_f32_16x16x32_bf16 v[152:155], v[120:123], v[32:35], v[152:155]
ds_read_b128 v[120:123], v251 offset:34816
v_or_b32_e64 v196, v196, v197
v_mfma_f32_16x16x32_f16 v[76:79], v[124:127], v[228:231], v[76:79]
ds_read_b128 v[124:127], v251 offset:37888
v_cvt_pkrtz_f16_f32 v99, v98, v99
v_mfma_f32_16x16x32_f16 v[100:103], v[184:187], v[116:119], v[100:103]
v_and_b32_e64 v99, s49, v99
v_bfe_u32 v98, v99, 2, 14
v_lshrrev_b32 v99, 18, v99
s_waitcnt lgkmcnt(7)
v_mfma_f32_16x16x32_bf16 v[144:147], v[176:179], v[64:67], v[144:147]
ds_read_u16 v98, v98
ds_read_u16_d16_hi v99, v99
v_or_b32_e64 v109, v110, v111
v_mfma_f32_16x16x32_f16 v[104:107], v[184:187], v[112:115], v[104:107]
v_exp_f16_sdwa v9, v9 dst_sel:WORD_1 dst_unused:UNUSED_PRESERVE src0_sel:WORD_1
v_or_b32_e64 v193, v194, v195
v_mfma_f32_16x16x32_f16 v[140:143], v[184:187], v[228:231], v[140:143]
ds_read_b128 v[184:187], v249 offset:8448
v_or_b32_e64 v197, v198, v199
v_mfma_f32_16x16x32_bf16 v[148:151], v[176:179], v[68:71], v[148:151]
v_pk_add_f16 v9, v9, 1.0 op_sel_hi:[1,0]
v_cvt_pk_f16_f32 v144, v144, v145
v_mfma_f32_16x16x32_f16 v[232:235], v[188:191], v[116:119], v[232:235]
v_rcp_f16_sdwa v9, v9 dst_sel:WORD_0 dst_unused:UNUSED_PRESERVE src0_sel:WORD_0
v_mfma_f32_16x16x32_bf16 v[152:155], v[176:179], v[40:43], v[152:155]
ds_read_b128 v[176:179], v251 offset:38912
s_nop 1
v_cvt_pkrtz_f16_f32 v149, v148, v149
v_mfma_f32_16x16x32_f16 v[236:239], v[188:191], v[112:115], v[236:239]
v_and_b32 v149, s49, v149
v_bfe_u32 v148, v149, 2, 14
v_mfma_f32_16x16x32_f16 v[84:87], v[188:191], v[228:231], v[84:87]
ds_read_b128 v[188:191], v249 offset:10496
v_lshrrev_b32_e64 v149, 18, v149
s_waitcnt lgkmcnt(5)
v_mfma_f32_16x16x32_bf16 v[208:211], v[160:163], v[48:51], 0
s_setprio 3
ds_read_u16 v148, v148
ds_read_u16_d16_hi v149, v149
v_mfma_f32_16x16x32_f16 v[200:203], v[120:123], v[116:119], v[200:203]
v_rcp_f16_sdwa v9, v9 dst_sel:WORD_1 dst_unused:UNUSED_PRESERVE src0_sel:WORD_1
v_mfma_f32_16x16x32_bf16 v[212:215], v[160:163], v[52:55], 0
v_pk_fma_f16 v145, v144, v144, s48
v_cvt_pkrtz_f16_f32 v153, v152, v153
v_mfma_f32_16x16x32_f16 v[204:207], v[120:123], v[112:115], v[204:207]
v_and_b32_e64 v153, s49, v153
v_bfe_u32 v152, v153, 2, 14
v_mfma_f32_16x16x32_f16 v[244:247], v[120:123], v[228:231], v[244:247]
ds_read_b128 v[120:123], v251 offset:39936
v_lshrrev_b32_e64 v153, 18, v153
v_mfma_f32_16x16x32_bf16 v[180:183], v[160:163], v[24:27], 0
ds_read_b128 v[160:163], v251 offset:41984
ds_read_u16 v152, v152
v_mfma_f32_16x16x32_f16 v[4:7], v[124:127], v[116:119], v[4:7]
ds_read_u16_d16_hi v153, v153
v_or_b32 v194, v12, v13
s_waitcnt lgkmcnt(6)
v_mfma_f32_16x16x32_bf16 v[208:211], v[184:187], v[56:59], v[208:211]
v_pk_mul_f16 v145, v144, v145
v_cvt_pkrtz_f16_f32 v147, v146, v147
v_mfma_f32_16x16x32_f16 v[224:227], v[124:127], v[112:115], v[224:227]
v_and_b32_e64 v147, s49, v147
v_bfe_u32 v146, v147, 2, 14
v_lshrrev_b32_e64 v147, 18, v147
v_pk_mul_f16 v110, v8, v9
v_mfma_f32_16x16x32_f16 v[92:95], v[124:127], v[228:231], v[92:95]
ds_read_u16 v146, v146
ds_read_u16_d16_hi v147, v147
ds_read_b128 v[124:127], v249 offset:12288
v_mfma_f32_16x16x32_bf16 v[212:215], v[184:187], v[60:63], v[212:215]
v_exp_f16_sdwa v145, v145 dst_sel:WORD_0 dst_unused:UNUSED_PRESERVE src0_sel:WORD_0
s_waitcnt vmcnt(7)
v_mfma_f32_16x16x32_bf16 v[132:135], v[18:21], v[240:243], v[132:135]
v_or_b32 v198, v96, v97
v_cvt_pkrtz_f16_f32 v151, v150, v151
v_mfma_f32_16x16x32_bf16 v[76:79], v[16:19], v[240:243], v[76:79]
v_and_b32 v151, s49, v151
v_bfe_u32 v150, v151, 2, 14
s_waitcnt vmcnt(6)
v_mfma_f32_16x16x32_bf16 v[140:143], v[18:21], v[72:75], v[140:143]
v_lshrrev_b32 v151, 18, v151
v_or_b32 v111, v10, v11
v_mfma_f32_16x16x32_bf16 v[84:87], v[16:19], v[72:75], v[84:87]
buffer_load_dwordx4 v[228:231], v253, s[4:7], s69 offen
buffer_load_dwordx4 v[112:115], v253, s[4:7], s69 offen offset:64
ds_read_u16 v150, v150
v_mfma_f32_16x16x32_f16 v[164:167], v[176:179], v[0:3], v[164:167]
ds_read_u16_d16_hi v151, v151
v_cvt_pkrtz_f16_f32 v155, v154, v155
v_mfma_f32_16x16x32_bf16 v[180:183], v[184:187], v[32:35], v[180:183]
ds_read_b128 v[184:187], v251 offset:43008
v_and_b32_e64 v155, s49, v155
v_mfma_f32_16x16x32_f16 v[168:171], v[176:179], v[136:139], v[168:171]
v_bfe_u32 v154, v155, 2, 14
v_lshrrev_b32_e64 v155, 18, v155
v_mfma_f32_16x16x32_f16 v[132:135], v[176:179], v[128:131], v[132:135]
ds_read_u16 v154, v154
ds_read_u16_d16_hi v155, v155
ds_read_b128 v[176:179], v249 offset:14336
v_mfma_f32_16x16x32_bf16 v[208:211], v[188:191], v[64:67], v[208:211]
s_setprio 2
v_exp_f16_sdwa v145, v145 dst_sel:WORD_1 dst_unused:UNUSED_PRESERVE src0_sel:WORD_1
s_waitcnt lgkmcnt(6)
v_mfma_f32_16x16x32_f16 v[216:219], v[160:163], v[0:3], v[216:219]
v_or_b32 v195, v14, v15
v_or_b32 v199, v98, v99
v_mfma_f32_16x16x32_bf16 v[212:215], v[188:191], v[68:71], v[212:215]
v_pk_add_f16 v145, v145, 1.0 op_sel_hi:[1,0]
v_cvt_pk_f16_f32 v208, v208, v209
v_mfma_f32_16x16x32_f16 v[220:223], v[160:163], v[136:139], v[220:223]
v_rcp_f16_sdwa v145, v145 dst_sel:WORD_0 dst_unused:UNUSED_PRESERVE src0_sel:WORD_0
v_mfma_f32_16x16x32_f16 v[76:79], v[160:163], v[128:131], v[76:79]
ds_read_b128 v[160:163], v251 offset:44032
s_nop 1
v_cvt_pkrtz_f16_f32 v213, v212, v213
v_mfma_f32_16x16x32_bf16 v[180:183], v[188:191], v[40:43], v[180:183]
ds_read_b128 v[188:191], v251 offset:40960
v_and_b32 v213, s49, v213
v_mfma_f32_16x16x32_f16 v[100:103], v[120:123], v[0:3], v[100:103]
v_bfe_u32 v212, v213, 2, 14
v_lshrrev_b32_e64 v213, 18, v213
v_mfma_f32_16x16x32_bf16 v[116:119], v[124:127], v[48:51], 0
ds_read_u16 v212, v212
ds_read_u16_d16_hi v213, v213
v_mfma_f32_16x16x32_f16 v[104:107], v[120:123], v[136:139], v[104:107]
v_rcp_f16_sdwa v145, v145 dst_sel:WORD_1 dst_unused:UNUSED_PRESERVE src0_sel:WORD_1
v_mfma_f32_16x16x32_f16 v[140:143], v[120:123], v[128:131], v[140:143]
ds_read_b128 v[120:123], v249 offset:16384
v_pk_fma_f16 v209, v208, v208, s48
v_mfma_f32_16x16x32_bf16 v[240:243], v[124:127], v[52:55], 0
v_cvt_pkrtz_f16_f32 v181, v180, v181
v_and_b32 v181, s49, v181
s_waitcnt lgkmcnt(5)
v_mfma_f32_16x16x32_f16 v[232:235], v[184:187], v[0:3], v[232:235]
v_bfe_u32 v180, v181, 2, 14
v_lshrrev_b32_e64 v181, 18, v181
v_mfma_f32_16x16x32_bf16 v[72:75], v[124:127], v[24:27], 0
ds_read_b128 v[124:127], v251 offset:45056
ds_read_u16 v180, v180
v_mfma_f32_16x16x32_f16 v[236:239], v[184:187], v[136:139], v[236:239]
ds_read_u16_d16_hi v181, v181
v_or_b32_e64 v148, v148, v149
v_mfma_f32_16x16x32_f16 v[84:87], v[184:187], v[128:131], v[84:87]
ds_read_b128 v[184:187], v249 offset:12544
v_pk_mul_f16 v209, v208, v209
v_mfma_f32_16x16x32_bf16 v[116:119], v[176:179], v[56:59], v[116:119]
s_setprio 1
v_cvt_pkrtz_f16_f32 v211, v210, v211
v_and_b32_e64 v211, s49, v211
s_waitcnt lgkmcnt(6)
v_mfma_f32_16x16x32_f16 v[200:203], v[188:191], v[0:3], v[200:203]
v_bfe_u32 v210, v211, 2, 14
v_lshrrev_b32_e64 v211, 18, v211
v_pk_mul_f16 v144, v144, v145
v_mfma_f32_16x16x32_bf16 v[240:243], v[176:179], v[60:63], v[240:243]
ds_read_u16 v210, v210
ds_read_u16_d16_hi v211, v211
v_mfma_f32_16x16x32_f16 v[204:207], v[188:191], v[136:139], v[204:207]
v_exp_f16_sdwa v209, v209 dst_sel:WORD_0 dst_unused:UNUSED_PRESERVE src0_sel:WORD_0
v_or_b32_e64 v152, v152, v153
v_mfma_f32_16x16x32_f16 v[244:247], v[188:191], v[128:131], v[244:247]
ds_read_b128 v[188:191], v251 offset:46080
v_cvt_pkrtz_f16_f32 v215, v214, v215
v_and_b32_e64 v215, s49, v215
v_bfe_u32 v214, v215, 2, 14
v_lshrrev_b32_e64 v215, 18, v215
v_mfma_f32_16x16x32_bf16 v[72:75], v[176:179], v[32:35], v[72:75]
ds_read_u16 v214, v214
ds_read_u16_d16_hi v215, v215
ds_read_b128 v[176:179], v251 offset:48128
v_mfma_f32_16x16x32_f16 v[4:7], v[160:163], v[0:3], v[4:7]
v_or_b32_e64 v145, v146, v147
v_cvt_pkrtz_f16_f32 v183, v182, v183
v_and_b32_e64 v183, s49, v183
v_bfe_u32 v182, v183, 2, 14
v_lshrrev_b32 v183, 18, v183
s_waitcnt lgkmcnt(6)
v_mfma_f32_16x16x32_bf16 v[116:119], v[120:123], v[64:67], v[116:119]
ds_read_u16 v182, v182
ds_read_u16_d16_hi v183, v183
v_mfma_f32_16x16x32_f16 v[224:227], v[160:163], v[136:139], v[224:227]
v_exp_f16_sdwa v209, v209 dst_sel:WORD_1 dst_unused:UNUSED_PRESERVE src0_sel:WORD_1
v_or_b32_e64 v149, v150, v151
v_mfma_f32_16x16x32_f16 v[92:95], v[160:163], v[128:131], v[92:95]
ds_read_b128 v[160:163], v249 offset:14592
v_or_b32_e64 v153, v154, v155
v_mfma_f32_16x16x32_bf16 v[240:243], v[120:123], v[68:71], v[240:243]
v_pk_add_f16 v209, v209, 1.0 op_sel_hi:[1,0]
v_cvt_pk_f16_f32 v116, v116, v117
s_waitcnt vmcnt(7)
v_mfma_f32_16x16x32_bf16 v[244:247], v[18:21], v[172:175], v[244:247]
v_rcp_f16_sdwa v209, v209 dst_sel:WORD_0 dst_unused:UNUSED_PRESERVE src0_sel:WORD_0
v_mfma_f32_16x16x32_bf16 v[92:95], v[16:19], v[172:175], v[92:95]
s_nop 1
v_cvt_pkrtz_f16_f32 v241, v240, v241
v_and_b32 v241, s49, v241
s_waitcnt vmcnt(6)
v_mfma_f32_16x16x32_bf16 v[168:171], v[18:21], v[156:159], v[168:171]
v_bfe_u32 v240, v241, 2, 14
v_lshrrev_b32_e64 v241, 18, v241
v_mfma_f32_16x16x32_bf16 v[220:223], v[16:19], v[156:159], v[220:223]
ds_read_u16 v240, v240
ds_read_u16_d16_hi v241, v241
v_mfma_f32_16x16x32_f16 v[164:167], v[124:127], v[196:199], v[164:167]
v_rcp_f16_sdwa v209, v209 dst_sel:WORD_1 dst_unused:UNUSED_PRESERVE src0_sel:WORD_1
v_mfma_f32_16x16x32_bf16 v[72:75], v[120:123], v[40:43], v[72:75]
ds_read_b128 v[120:123], v251 offset:49152
v_pk_fma_f16 v117, v116, v116, s48
v_mfma_f32_16x16x32_f16 v[168:171], v[124:127], v[192:195], v[168:171]
v_or_b32_e64 v150, v212, v213
v_pk_mul_f16 v117, v116, v117
v_mfma_f32_16x16x32_f16 v[132:135], v[124:127], v[108:111], v[132:135]
ds_read_b128 v[124:127], v249 offset:16640
s_nop 0
v_cvt_pkrtz_f16_f32 v73, v72, v73
v_mfma_f32_16x16x32_bf16 v[8:11], v[184:187], v[48:51], 0
s_setprio 0
v_and_b32 v73, s49, v73
v_bfe_u32 v72, v73, 2, 14
s_waitcnt lgkmcnt(4)
v_mfma_f32_16x16x32_f16 v[216:219], v[176:179], v[196:199], v[216:219]
v_lshrrev_b32_e64 v73, 18, v73
v_cvt_pkrtz_f16_f32 v119, v118, v119
v_mfma_f32_16x16x32_bf16 v[12:15], v[184:187], v[52:55], 0
ds_read_u16 v72, v72
ds_read_u16_d16_hi v73, v73
v_mfma_f32_16x16x32_f16 v[220:223], v[176:179], v[192:195], v[220:223]
v_and_b32_e64 v119, s49, v119
v_bfe_u32 v118, v119, 2, 14
v_mfma_f32_16x16x32_f16 v[76:79], v[176:179], v[108:111], v[76:79]
ds_read_b128 v[176:179], v251 offset:50176
v_lshrrev_b32_e64 v119, 18, v119
v_mfma_f32_16x16x32_bf16 v[96:99], v[184:187], v[24:27], 0
ds_read_b128 v[184:187], v251 offset:47104
ds_read_u16 v118, v118
v_mfma_f32_16x16x32_f16 v[100:103], v[188:191], v[196:199], v[100:103]
ds_read_u16_d16_hi v119, v119
v_pk_mul_f16 v146, v208, v209
v_mfma_f32_16x16x32_f16 v[104:107], v[188:191], v[192:195], v[104:107]
v_exp_f16_sdwa v117, v117 dst_sel:WORD_0 dst_unused:UNUSED_PRESERVE src0_sel:WORD_0
v_mfma_f32_16x16x32_bf16 v[8:11], v[160:163], v[56:59], v[8:11]
v_or_b32_e64 v154, v180, v181
v_cvt_pkrtz_f16_f32 v243, v242, v243
v_mfma_f32_16x16x32_f16 v[140:143], v[188:191], v[108:111], v[140:143]
ds_read_b128 v[188:191], v249 offset:18432
v_and_b32_e64 v243, s49, v243
v_mfma_f32_16x16x32_bf16 v[12:15], v[160:163], v[60:63], v[12:15]
v_bfe_u32 v242, v243, 2, 14
v_lshrrev_b32 v243, 18, v243
s_waitcnt lgkmcnt(6)
v_mfma_f32_16x16x32_f16 v[232:235], v[120:123], v[196:199], v[232:235]
ds_read_u16 v242, v242
ds_read_u16_d16_hi v243, v243
v_mfma_f32_16x16x32_f16 v[236:239], v[120:123], v[192:195], v[236:239]
v_or_b32_e64 v147, v210, v211
v_cvt_pkrtz_f16_f32 v75, v74, v75
v_mfma_f32_16x16x32_bf16 v[96:99], v[160:163], v[32:35], v[96:99]
ds_read_b128 v[160:163], v251 offset:51200
v_and_b32_e64 v75, s49, v75
v_mfma_f32_16x16x32_f16 v[84:87], v[120:123], v[108:111], v[84:87]
ds_read_b128 v[120:123], v249 offset:20480
v_bfe_u32 v74, v75, 2, 14
v_lshrrev_b32_e64 v75, 18, v75
v_mfma_f32_16x16x32_bf16 v[8:11], v[124:127], v[64:67], v[8:11]
ds_read_u16 v74, v74
ds_read_u16_d16_hi v75, v75
s_setprio 3
s_waitcnt lgkmcnt(8)
v_mfma_f32_16x16x32_f16 v[200:203], v[184:187], v[196:199], v[200:203]
v_exp_f16_sdwa v117, v117 dst_sel:WORD_1 dst_unused:UNUSED_PRESERVE src0_sel:WORD_1
v_or_b32_e64 v151, v214, v215
v_mfma_f32_16x16x32_f16 v[204:207], v[184:187], v[192:195], v[204:207]
v_or_b32_e64 v155, v182, v183
v_pk_add_f16 v117, v117, 1.0 op_sel_hi:[1,0]
v_mfma_f32_16x16x32_bf16 v[12:15], v[124:127], v[68:71], v[12:15]
v_rcp_f16_sdwa v117, v117 dst_sel:WORD_0 dst_unused:UNUSED_PRESERVE src0_sel:WORD_0
v_mfma_f32_16x16x32_f16 v[244:247], v[184:187], v[108:111], v[244:247]
ds_read_b128 v[184:187], v249 offset:22528
v_cvt_pk_f16_f32 v8, v8, v9
v_mfma_f32_16x16x32_bf16 v[96:99], v[124:127], v[40:43], v[96:99]
ds_read_b128 v[124:127], v251 offset:54272
s_nop 1
v_cvt_pkrtz_f16_f32 v13, v12, v13
v_mfma_f32_16x16x32_f16 v[4:7], v[176:179], v[196:199], v[4:7]
v_and_b32 v13, s49, v13
v_bfe_u32 v12, v13, 2, 14
v_mfma_f32_16x16x32_f16 v[224:227], v[176:179], v[192:195], v[224:227]
buffer_load_dwordx4 v[128:131], v250, s[32:35], s80 offen
s_add_u32 s46, s80, 2097152
buffer_load_dwordx4 v[136:139], v250, s[32:35], s46 offen
v_lshrrev_b32 v13, 18, v13
s_waitcnt lgkmcnt(4)
v_mfma_f32_16x16x32_bf16 v[0:3], v[188:191], v[48:51], 0
ds_read_u16 v12, v12
ds_read_u16_d16_hi v13, v13
v_mfma_f32_16x16x32_f16 v[92:95], v[176:179], v[108:111], v[92:95]
ds_read_b128 v[176:179], v251 offset:52224
v_rcp_f16_sdwa v117, v117 dst_sel:WORD_1 dst_unused:UNUSED_PRESERVE src0_sel:WORD_1
v_mfma_f32_16x16x32_bf16 v[172:175], v[188:191], v[52:55], 0
v_pk_fma_f16 v9, v8, v8, s48
v_cvt_pkrtz_f16_f32 v97, v96, v97
v_mfma_f32_16x16x32_f16 v[164:167], v[160:163], v[152:155], v[164:167]
v_and_b32_e64 v97, s49, v97
v_bfe_u32 v96, v97, 2, 14
v_mfma_f32_16x16x32_bf16 v[156:159], v[188:191], v[24:27], 0
ds_read_b128 v[188:191], v249 offset:18688
v_lshrrev_b32_e64 v97, 18, v97
v_mfma_f32_16x16x32_f16 v[168:171], v[160:163], v[148:151], v[168:171]
ds_read_u16 v96, v96
ds_read_u16_d16_hi v97, v97
s_setprio 2
v_mfma_f32_16x16x32_bf16 v[0:3], v[120:123], v[56:59], v[0:3]
v_or_b32 v240, v240, v241
v_pk_mul_f16 v9, v8, v9
v_mfma_f32_16x16x32_f16 v[132:135], v[160:163], v[144:147], v[132:135]
ds_read_b128 v[160:163], v251 offset:55296
v_cvt_pkrtz_f16_f32 v11, v10, v11
v_and_b32_e64 v11, s49, v11
v_bfe_u32 v10, v11, 2, 14
v_lshrrev_b32_e64 v11, 18, v11
v_pk_mul_f16 v116, v116, v117
v_mfma_f32_16x16x32_bf16 v[172:175], v[120:123], v[60:63], v[172:175]
ds_read_u16 v10, v10
ds_read_u16_d16_hi v11, v11
s_waitcnt lgkmcnt(7)
v_mfma_f32_16x16x32_f16 v[216:219], v[124:127], v[152:155], v[216:219]
v_exp_f16_sdwa v9, v9 dst_sel:WORD_0 dst_unused:UNUSED_PRESERVE src0_sel:WORD_0
v_or_b32 v72, v72, v73
v_cvt_pkrtz_f16_f32 v15, v14, v15
v_and_b32_e64 v15, s49, v15
v_bfe_u32 v14, v15, 2, 14
v_lshrrev_b32_e64 v15, 18, v15
v_mfma_f32_16x16x32_bf16 v[156:159], v[120:123], v[32:35], v[156:159]
ds_read_u16 v14, v14
ds_read_u16_d16_hi v15, v15
ds_read_b128 v[120:123], v249 offset:20736
v_mfma_f32_16x16x32_f16 v[220:223], v[124:127], v[148:151], v[220:223]
v_or_b32_e64 v117, v118, v119
v_cvt_pkrtz_f16_f32 v99, v98, v99
v_and_b32_e64 v99, s49, v99
v_bfe_u32 v98, v99, 2, 14
v_lshrrev_b32_e64 v99, 18, v99
v_mfma_f32_16x16x32_bf16 v[0:3], v[184:187], v[64:67], v[0:3]
ds_read_u16 v98, v98
ds_read_u16_d16_hi v99, v99
v_mfma_f32_16x16x32_f16 v[76:79], v[124:127], v[144:147], v[76:79]
ds_read_b128 v[124:127], v251 offset:53248
v_exp_f16_sdwa v9, v9 dst_sel:WORD_1 dst_unused:UNUSED_PRESERVE src0_sel:WORD_1
v_or_b32_e64 v241, v242, v243
v_mfma_f32_16x16x32_bf16 v[172:175], v[184:187], v[68:71], v[172:175]
v_or_b32 v73, v74, v75
v_pk_add_f16 v9, v9, 1.0 op_sel_hi:[1,0]
s_waitcnt lgkmcnt(6)
v_mfma_f32_16x16x32_f16 v[100:103], v[176:179], v[152:155], v[100:103]
v_rcp_f16_sdwa v9, v9 dst_sel:WORD_0 dst_unused:UNUSED_PRESERVE src0_sel:WORD_0
v_mfma_f32_16x16x32_bf16 v[156:159], v[184:187], v[40:43], v[156:159]
ds_read_b128 v[184:187], v249 offset:22784
s_nop 0
v_cvt_pkrtz_f16_f32 v173, v172, v173
v_mfma_f32_16x16x32_f16 v[104:107], v[176:179], v[148:151], v[104:107]
s_setprio 1
v_and_b32_e64 v173, s49, v173
v_bfe_u32 v172, v173, 2, 14
v_mfma_f32_16x16x32_bf16 v[208:211], v[188:191], v[48:51], 0
v_lshrrev_b32_e64 v173, 18, v173
v_cvt_pk_f16_f32 v0, v0, v1
v_mfma_f32_16x16x32_f16 v[140:143], v[176:179], v[144:147], v[140:143]
ds_read_b128 v[176:179], v251 offset:56320
ds_read_u16 v172, v172
v_mfma_f32_16x16x32_bf16 v[212:215], v[188:191], v[52:55], 0
ds_read_u16_d16_hi v173, v173
v_rcp_f16_sdwa v9, v9 dst_sel:WORD_1 dst_unused:UNUSED_PRESERVE src0_sel:WORD_1
v_mfma_f32_16x16x32_f16 v[232:235], v[160:163], v[152:155], v[232:235]
v_pk_fma_f16 v1, v0, v0, s48
v_cvt_pkrtz_f16_f32 v157, v156, v157
v_mfma_f32_16x16x32_bf16 v[180:183], v[188:191], v[24:27], 0
ds_read_b128 v[188:191], v249 offset:24576
v_and_b32_e64 v157, s49, v157
v_mfma_f32_16x16x32_f16 v[236:239], v[160:163], v[148:151], v[236:239]
v_bfe_u32 v156, v157, 2, 14
v_lshrrev_b32 v157, 18, v157
s_waitcnt lgkmcnt(4)
v_mfma_f32_16x16x32_bf16 v[208:211], v[120:123], v[56:59], v[208:211]
ds_read_u16 v156, v156
ds_read_u16_d16_hi v157, v157
s_add_u32 s46, s80, 4194304
buffer_load_dwordx4 v[108:111], v250, s[32:35], s46 offen
s_add_u32 s46, s80, 6291456
buffer_load_dwordx4 v[192:195], v250, s[32:35], s46 offen
v_mfma_f32_16x16x32_f16 v[84:87], v[160:163], v[144:147], v[84:87]
ds_read_b128 v[160:163], v251 offset:57344
v_or_b32_e64 v242, v12, v13
v_pk_mul_f16 v1, v0, v1
v_cvt_pkrtz_f16_f32 v3, v2, v3
v_and_b32_e64 v3, s49, v3
v_bfe_u32 v2, v3, 2, 14
v_lshrrev_b32_e64 v3, 18, v3
v_pk_mul_f16 v118, v8, v9
v_mfma_f32_16x16x32_bf16 v[212:215], v[120:123], v[60:63], v[212:215]
ds_read_u16 v2, v2
ds_read_u16_d16_hi v3, v3
buffer_load_dwordx4 v[196:199], v253, s[4:7], s69 offen offset:128
v_mfma_f32_16x16x32_f16 v[200:203], v[124:127], v[152:155], v[200:203]
v_exp_f16_sdwa v1, v1 dst_sel:WORD_0 dst_unused:UNUSED_PRESERVE src0_sel:WORD_0
v_or_b32_e64 v74, v96, v97
v_cvt_pkrtz_f16_f32 v175, v174, v175
v_and_b32_e64 v175, s49, v175
v_bfe_u32 v174, v175, 2, 14
v_lshrrev_b32_e64 v175, 18, v175
v_mfma_f32_16x16x32_bf16 v[180:183], v[120:123], v[32:35], v[180:183]
ds_read_u16 v174, v174
ds_read_u16_d16_hi v175, v175
ds_read_b128 v[120:123], v249 offset:26624
v_mfma_f32_16x16x32_f16 v[204:207], v[124:127], v[148:151], v[204:207]
v_or_b32 v119, v10, v11
s_setprio 0
v_cvt_pkrtz_f16_f32 v159, v158, v159
v_and_b32_e64 v159, s49, v159
v_bfe_u32 v158, v159, 2, 14
v_lshrrev_b32_e64 v159, 18, v159
v_mfma_f32_16x16x32_bf16 v[208:211], v[184:187], v[64:67], v[208:211]
ds_read_u16 v158, v158
ds_read_u16_d16_hi v159, v159
v_mfma_f32_16x16x32_f16 v[244:247], v[124:127], v[144:147], v[244:247]
ds_read_b128 v[124:127], v251 offset:60416
v_exp_f16_sdwa v1, v1 dst_sel:WORD_1 dst_unused:UNUSED_PRESERVE src0_sel:WORD_1
v_or_b32_e64 v243, v14, v15
v_mfma_f32_16x16x32_bf16 v[212:215], v[184:187], v[68:71], v[212:215]
v_or_b32 v75, v98, v99
v_pk_add_f16 v1, v1, 1.0 op_sel_hi:[1,0]
s_waitcnt lgkmcnt(6)
v_mfma_f32_16x16x32_f16 v[4:7], v[176:179], v[152:155], v[4:7]
v_rcp_f16_sdwa v1, v1 dst_sel:WORD_0 dst_unused:UNUSED_PRESERVE src0_sel:WORD_0
v_mfma_f32_16x16x32_bf16 v[180:183], v[184:187], v[40:43], v[180:183]
ds_read_b128 v[184:187], v249 offset:28672
s_nop 0
v_cvt_pkrtz_f16_f32 v213, v212, v213
v_mfma_f32_16x16x32_f16 v[224:227], v[176:179], v[148:151], v[224:227]
v_and_b32 v213, s49, v213
v_bfe_u32 v212, v213, 2, 14
v_mfma_f32_16x16x32_bf16 v[8:11], v[188:191], v[48:51], 0
v_lshrrev_b32 v213, 18, v213
v_cvt_pk_f16_f32 v208, v208, v209
v_mfma_f32_16x16x32_f16 v[92:95], v[176:179], v[144:147], v[92:95]
ds_read_b128 v[176:179], v251 offset:58368
ds_read_u16 v212, v212
s_waitcnt vmcnt(8)
v_mfma_f32_16x16x32_bf16 v[104:107], v[18:21], v[80:83], v[104:107]
ds_read_u16_d16_hi v213, v213
v_rcp_f16_sdwa v1, v1 dst_sel:WORD_1 dst_unused:UNUSED_PRESERVE src0_sel:WORD_1
v_mfma_f32_16x16x32_bf16 v[236:239], v[16:19], v[80:83], v[236:239]
v_pk_fma_f16 v209, v208, v208, s48
v_cvt_pkrtz_f16_f32 v181, v180, v181
s_waitcnt vmcnt(7)
v_mfma_f32_16x16x32_bf16 v[204:207], v[18:21], v[88:91], v[204:207]
v_and_b32 v181, s49, v181
v_bfe_u32 v180, v181, 2, 14
v_mfma_f32_16x16x32_bf16 v[224:227], v[16:19], v[88:91], v[224:227]
v_lshrrev_b32 v181, 18, v181
v_or_b32 v172, v172, v173
v_mfma_f32_16x16x32_bf16 v[12:15], v[188:191], v[52:55], 0
ds_read_u16 v180, v180
ds_read_u16_d16_hi v181, v181
v_mfma_f32_16x16x32_f16 v[164:167], v[160:163], v[72:75], v[164:167]
v_pk_mul_f16 v209, v208, v209
v_cvt_pkrtz_f16_f32 v211, v210, v211
v_mfma_f32_16x16x32_bf16 v[96:99], v[188:191], v[24:27], 0
ds_read_b128 v[188:191], v249 offset:24832
v_and_b32 v211, s49, v211
v_mfma_f32_16x16x32_f16 v[168:171], v[160:163], v[240:243], v[168:171]
s_setprio 3
v_bfe_u32 v210, v211, 2, 14
v_lshrrev_b32 v211, 18, v211
s_waitcnt lgkmcnt(4)
v_mfma_f32_16x16x32_bf16 v[8:11], v[120:123], v[56:59], v[8:11]
ds_read_u16 v210, v210
ds_read_u16_d16_hi v211, v211
v_mfma_f32_16x16x32_f16 v[132:135], v[160:163], v[116:119], v[132:135]
ds_read_b128 v[160:163], v251 offset:61440
v_pk_mul_f16 v0, v0, v1
v_mfma_f32_16x16x32_bf16 v[12:15], v[120:123], v[60:63], v[12:15]
v_exp_f16_sdwa v209, v209 dst_sel:WORD_0 dst_unused:UNUSED_PRESERVE src0_sel:WORD_0
v_mfma_f32_16x16x32_f16 v[216:219], v[124:127], v[72:75], v[216:219]
v_or_b32_e64 v156, v156, v157
v_cvt_pkrtz_f16_f32 v215, v214, v215
v_and_b32_e64 v215, s49, v215
v_bfe_u32 v214, v215, 2, 14
v_lshrrev_b32_e64 v215, 18, v215
v_mfma_f32_16x16x32_bf16 v[96:99], v[120:123], v[32:35], v[96:99]
ds_read_u16 v214, v214
ds_read_u16_d16_hi v215, v215
ds_read_b128 v[120:123], v249 offset:26880
v_mfma_f32_16x16x32_f16 v[220:223], v[124:127], v[240:243], v[220:223]
v_or_b32_e64 v1, v2, v3
v_cvt_pkrtz_f16_f32 v183, v182, v183
v_and_b32_e64 v183, s49, v183
v_bfe_u32 v182, v183, 2, 14
v_lshrrev_b32_e64 v183, 18, v183
v_mfma_f32_16x16x32_bf16 v[8:11], v[184:187], v[64:67], v[8:11]
ds_read_u16 v182, v182
ds_read_u16_d16_hi v183, v183
s_add_u32 s46, s80, 8388608
buffer_load_dwordx4 v[144:147], v250, s[32:35], s46 offen
s_add_u32 s46, s80, 10485760
buffer_load_dwordx4 v[148:151], v250, s[32:35], s46 offen
v_mfma_f32_16x16x32_f16 v[76:79], v[124:127], v[116:119], v[76:79]
ds_read_b128 v[124:127], v251 offset:59392
v_exp_f16_sdwa v209, v209 dst_sel:WORD_1 dst_unused:UNUSED_PRESERVE src0_sel:WORD_1
v_or_b32_e64 v173, v174, v175
v_mfma_f32_16x16x32_bf16 v[12:15], v[184:187], v[68:71], v[12:15]
v_or_b32_e64 v157, v158, v159
v_pk_add_f16 v209, v209, 1.0 op_sel_hi:[1,0]
v_mfma_f32_16x16x32_f16 v[100:103], v[176:179], v[72:75], v[100:103]
v_rcp_f16_sdwa v209, v209 dst_sel:WORD_0 dst_unused:UNUSED_PRESERVE src0_sel:WORD_0
v_mfma_f32_16x16x32_bf16 v[96:99], v[184:187], v[40:43], v[96:99]
ds_read_b128 v[184:187], v249 offset:28928
s_nop 1
v_cvt_pkrtz_f16_f32 v13, v12, v13
v_mfma_f32_16x16x32_f16 v[104:107], v[176:179], v[240:243], v[104:107]
s_setprio 2
v_and_b32 v13, s49, v13
v_bfe_u32 v12, v13, 2, 14
s_waitcnt lgkmcnt(5)
v_mfma_f32_16x16x32_bf16 v[152:155], v[188:191], v[48:51], 0
v_lshrrev_b32_e64 v13, 18, v13
v_cvt_pk_f16_f32 v8, v8, v9
v_mfma_f32_16x16x32_f16 v[140:143], v[176:179], v[116:119], v[140:143]
ds_read_b128 v[176:179], v251 offset:62464
ds_read_u16 v12, v12
v_mfma_f32_16x16x32_bf16 v[80:83], v[188:191], v[52:55], 0
ds_read_u16_d16_hi v13, v13
v_rcp_f16_sdwa v209, v209 dst_sel:WORD_1 dst_unused:UNUSED_PRESERVE src0_sel:WORD_1
v_mfma_f32_16x16x32_f16 v[232:235], v[160:163], v[72:75], v[232:235]
v_pk_fma_f16 v9, v8, v8, s48
v_cvt_pkrtz_f16_f32 v97, v96, v97
v_mfma_f32_16x16x32_bf16 v[88:91], v[188:191], v[24:27], 0
ds_read_b128 v[188:191], v249 offset:30720
v_and_b32_e64 v97, s49, v97
v_mfma_f32_16x16x32_f16 v[236:239], v[160:163], v[240:243], v[236:239]
v_bfe_u32 v96, v97, 2, 14
v_lshrrev_b32 v97, 18, v97
s_waitcnt lgkmcnt(4)
v_mfma_f32_16x16x32_bf16 v[152:155], v[120:123], v[56:59], v[152:155]
ds_read_u16 v96, v96
ds_read_u16_d16_hi v97, v97
v_mfma_f32_16x16x32_f16 v[84:87], v[160:163], v[116:119], v[84:87]
ds_read_b128 v[160:163], v251 offset:63488
v_or_b32_e64 v174, v212, v213
v_pk_mul_f16 v9, v8, v9
v_cvt_pkrtz_f16_f32 v11, v10, v11
v_and_b32_e64 v11, s49, v11
v_bfe_u32 v10, v11, 2, 14
v_lshrrev_b32_e64 v11, 18, v11
v_pk_mul_f16 v2, v208, v209
v_mfma_f32_16x16x32_bf16 v[80:83], v[120:123], v[60:63], v[80:83]
ds_read_u16 v10, v10
ds_read_u16_d16_hi v11, v11
v_mfma_f32_16x16x32_f16 v[200:203], v[124:127], v[72:75], v[200:203]
v_exp_f16_sdwa v9, v9 dst_sel:WORD_0 dst_unused:UNUSED_PRESERVE src0_sel:WORD_0
v_or_b32_e64 v158, v180, v181
v_cvt_pkrtz_f16_f32 v15, v14, v15
v_and_b32_e64 v15, s49, v15
v_bfe_u32 v14, v15, 2, 14
v_lshrrev_b32_e64 v15, 18, v15
v_mfma_f32_16x16x32_bf16 v[88:91], v[120:123], v[32:35], v[88:91]
ds_read_u16 v14, v14
ds_read_u16_d16_hi v15, v15
ds_read_b128 v[120:123], v249 offset:32768
v_mfma_f32_16x16x32_f16 v[204:207], v[124:127], v[240:243], v[204:207]
s_setprio 1
v_or_b32 v3, v210, v211
v_cvt_pkrtz_f16_f32 v99, v98, v99
v_and_b32_e64 v99, s49, v99
v_bfe_u32 v98, v99, 2, 14
v_lshrrev_b32_e64 v99, 18, v99
v_mfma_f32_16x16x32_bf16 v[152:155], v[184:187], v[64:67], v[152:155]
ds_read_u16 v98, v98
ds_read_u16_d16_hi v99, v99
v_mfma_f32_16x16x32_f16 v[244:247], v[124:127], v[116:119], v[244:247]
ds_read_b128 v[124:127], v252 offset:1024
v_exp_f16_sdwa v9, v9 dst_sel:WORD_1 dst_unused:UNUSED_PRESERVE src0_sel:WORD_1
v_or_b32_e64 v175, v214, v215
v_mfma_f32_16x16x32_bf16 v[80:83], v[184:187], v[68:71], v[80:83]
v_or_b32 v159, v182, v183
v_pk_add_f16 v9, v9, 1.0 op_sel_hi:[1,0]
s_waitcnt lgkmcnt(7)
v_mfma_f32_16x16x32_f16 v[4:7], v[176:179], v[72:75], v[4:7]
v_rcp_f16_sdwa v9, v9 dst_sel:WORD_0 dst_unused:UNUSED_PRESERVE src0_sel:WORD_0
v_mfma_f32_16x16x32_bf16 v[88:91], v[184:187], v[40:43], v[88:91]
ds_read_b128 v[184:187], v249 offset:34816
s_nop 0
v_cvt_pkrtz_f16_f32 v81, v80, v81
v_mfma_f32_16x16x32_f16 v[224:227], v[176:179], v[240:243], v[224:227]
v_and_b32 v81, s49, v81
v_bfe_u32 v80, v81, 2, 14
v_mfma_f32_16x16x32_bf16 v[208:211], v[188:191], v[48:51], 0
v_lshrrev_b32_e64 v81, 18, v81
v_cvt_pk_f16_f32 v152, v152, v153
v_mfma_f32_16x16x32_f16 v[92:95], v[176:179], v[116:119], v[92:95]
ds_read_b128 v[176:179], v251 offset:64512
ds_read_u16 v80, v80
v_mfma_f32_16x16x32_bf16 v[212:215], v[188:191], v[52:55], 0
ds_read_u16_d16_hi v81, v81
v_rcp_f16_sdwa v9, v9 dst_sel:WORD_1 dst_unused:UNUSED_PRESERVE src0_sel:WORD_1
v_mfma_f32_16x16x32_f16 v[164:167], v[160:163], v[156:159], v[164:167]
v_pk_fma_f16 v153, v152, v152, s48
v_cvt_pkrtz_f16_f32 v89, v88, v89
v_mfma_f32_16x16x32_bf16 v[180:183], v[188:191], v[24:27], 0
ds_read_b128 v[188:191], v249 offset:30976
s_setprio 0
v_and_b32 v89, s49, v89
v_mfma_f32_16x16x32_f16 v[168:171], v[160:163], v[172:175], v[168:171]
v_bfe_u32 v88, v89, 2, 14
v_lshrrev_b32 v89, 18, v89
s_waitcnt lgkmcnt(4)
v_mfma_f32_16x16x32_bf16 v[208:211], v[120:123], v[56:59], v[208:211]
ds_read_u16 v88, v88
ds_read_u16_d16_hi v89, v89
v_mfma_f32_16x16x32_f16 v[132:135], v[160:163], v[0:3], v[132:135]
ds_read_b128 v[160:163], v252 offset:2048
v_or_b32_e64 v12, v12, v13
v_pk_mul_f16 v153, v152, v153
v_cvt_pkrtz_f16_f32 v155, v154, v155
v_and_b32_e64 v155, s49, v155
v_bfe_u32 v154, v155, 2, 14
v_lshrrev_b32_e64 v155, 18, v155
v_pk_mul_f16 v8, v8, v9
v_mfma_f32_16x16x32_bf16 v[212:215], v[120:123], v[60:63], v[212:215]
ds_read_u16 v154, v154
ds_read_u16_d16_hi v155, v155
v_mfma_f32_16x16x32_f16 v[216:219], v[124:127], v[156:159], v[216:219]
v_exp_f16_sdwa v153, v153 dst_sel:WORD_0 dst_unused:UNUSED_PRESERVE src0_sel:WORD_0
v_or_b32_e64 v96, v96, v97
v_cvt_pkrtz_f16_f32 v83, v82, v83
v_and_b32_e64 v83, s49, v83
v_bfe_u32 v82, v83, 2, 14
v_lshrrev_b32_e64 v83, 18, v83
v_mfma_f32_16x16x32_bf16 v[180:183], v[120:123], v[32:35], v[180:183]
ds_read_u16 v82, v82
ds_read_u16_d16_hi v83, v83
v_mfma_f32_16x16x32_f16 v[220:223], v[124:127], v[172:175], v[220:223]
ds_read_b128 v[120:123], v249 offset:35072
v_or_b32_e64 v9, v10, v11
v_cvt_pkrtz_f16_f32 v91, v90, v91
v_and_b32_e64 v91, s49, v91
v_bfe_u32 v90, v91, 2, 14
v_lshrrev_b32_e64 v91, 18, v91
v_mfma_f32_16x16x32_bf16 v[208:211], v[184:187], v[64:67], v[208:211]
ds_read_u16 v90, v90
ds_read_u16_d16_hi v91, v91
s_waitcnt vmcnt(5)
v_permlane16_swap_b32 v128, v136
v_permlane16_swap_b32 v129, v137
v_permlane16_swap_b32 v130, v138
v_permlane16_swap_b32 v131, v139
s_waitcnt vmcnt(3)
v_permlane16_swap_b32 v108, v192
v_permlane16_swap_b32 v109, v193
v_permlane16_swap_b32 v110, v194
v_permlane16_swap_b32 v111, v195
v_mfma_f32_16x16x32_f16 v[76:79], v[124:127], v[0:3], v[76:79]
v_exp_f16_sdwa v153, v153 dst_sel:WORD_1 dst_unused:UNUSED_PRESERVE src0_sel:WORD_1
v_or_b32_e64 v13, v14, v15
v_mfma_f32_16x16x32_bf16 v[212:215], v[184:187], v[68:71], v[212:215]
ds_read_b128 v[124:127], v252 offset:3072
v_or_b32 v97, v98, v99
s_waitcnt lgkmcnt(6)
v_mfma_f32_16x16x32_f16 v[100:103], v[176:179], v[156:159], v[100:103]
v_pk_add_f16 v153, v153, 1.0 op_sel_hi:[1,0]
v_cvt_pk_f16_f32 v208, v208, v209
v_mfma_f32_16x16x32_bf16 v[180:183], v[184:187], v[40:43], v[180:183]
s_setprio 3
ds_read_b128 v[184:187], v248
v_rcp_f16_sdwa v153, v153 dst_sel:WORD_0 dst_unused:UNUSED_PRESERVE src0_sel:WORD_0
v_mfma_f32_16x16x32_f16 v[104:107], v[176:179], v[172:175], v[104:107]
v_cvt_pkrtz_f16_f32 v213, v212, v213
v_and_b32 v213, s49, v213
v_mfma_f32_16x16x32_bf16 v[116:119], v[188:191], v[48:51], 0
ds_read_b128 v[48:51], v252
v_bfe_u32 v212, v213, 2, 14
v_mfma_f32_16x16x32_f16 v[140:143], v[176:179], v[0:3], v[140:143]
ds_read_b128 v[176:179], v252 offset:4096
v_lshrrev_b32_e64 v213, 18, v213
v_mfma_f32_16x16x32_bf16 v[240:243], v[188:191], v[52:55], 0
ds_read_b128 v[52:55], v249 offset:33024
ds_read_u16 v212, v212
v_mfma_f32_16x16x32_f16 v[232:235], v[160:163], v[156:159], v[232:235]
ds_read_u16_d16_hi v213, v213
v_rcp_f16_sdwa v153, v153 dst_sel:WORD_1 dst_unused:UNUSED_PRESERVE src0_sel:WORD_1
v_mfma_f32_16x16x32_bf16 v[72:75], v[188:191], v[24:27], 0
ds_read_b128 v[188:191], v248 offset:2048
v_pk_fma_f16 v209, v208, v208, s48
v_mfma_f32_16x16x32_f16 v[236:239], v[160:163], v[172:175], v[236:239]
v_cvt_pkrtz_f16_f32 v181, v180, v181
v_and_b32_e64 v181, s49, v181
v_bfe_u32 v180, v181, 2, 14
v_lshrrev_b32_e64 v181, 18, v181
ds_read_u16 v180, v180
ds_read_u16_d16_hi v181, v181
s_waitcnt lgkmcnt(5)
v_mfma_f32_16x16x32_bf16 v[116:119], v[52:55], v[56:59], v[116:119]
s_waitcnt vmcnt(0)
v_permlane16_swap_b32 v144, v148
v_permlane16_swap_b32 v145, v149
v_permlane16_swap_b32 v146, v150
v_permlane16_swap_b32 v147, v151
v_mfma_f32_16x16x32_f16 v[84:87], v[160:163], v[0:3], v[84:87]
v_or_b32_e64 v14, v80, v81
v_pk_mul_f16 v209, v208, v209
v_cvt_pkrtz_f16_f32 v211, v210, v211
v_and_b32_e64 v211, s49, v211
v_bfe_u32 v210, v211, 2, 14
v_lshrrev_b32_e64 v211, 18, v211
v_pk_mul_f16 v10, v152, v153
ds_read_b128 v[160:163], v252 offset:7168
ds_read_u16 v210, v210
ds_read_u16_d16_hi v211, v211
v_mfma_f32_16x16x32_bf16 v[240:243], v[52:55], v[60:63], v[240:243]
v_exp_f16_sdwa v209, v209 dst_sel:WORD_0 dst_unused:UNUSED_PRESERVE src0_sel:WORD_0
v_mfma_f32_16x16x32_f16 v[200:203], v[48:51], v[156:159], v[200:203]
v_or_b32_e64 v98, v88, v89
v_cvt_pkrtz_f16_f32 v215, v214, v215
v_and_b32_e64 v215, s49, v215
v_bfe_u32 v214, v215, 2, 14
v_lshrrev_b32_e64 v215, 18, v215
v_mfma_f32_16x16x32_bf16 v[72:75], v[52:55], v[32:35], v[72:75]
ds_read_u16 v214, v214
ds_read_u16_d16_hi v215, v215
s_setprio 2
v_mfma_f32_16x16x32_f16 v[204:207], v[48:51], v[172:175], v[204:207]
ds_read_b128 v[52:55], v248 offset:4096
v_or_b32 v11, v154, v155
v_cvt_pkrtz_f16_f32 v183, v182, v183
v_and_b32_e64 v183, s49, v183
v_bfe_u32 v182, v183, 2, 14
v_lshrrev_b32_e64 v183, 18, v183
v_mfma_f32_16x16x32_bf16 v[116:119], v[120:123], v[64:67], v[116:119]
ds_read_u16 v182, v182
ds_read_u16_d16_hi v183, v183
v_mfma_f32_16x16x32_f16 v[244:247], v[48:51], v[0:3], v[244:247]
v_exp_f16_sdwa v209, v209 dst_sel:WORD_1 dst_unused:UNUSED_PRESERVE src0_sel:WORD_1
v_or_b32_e64 v15, v82, v83
v_mfma_f32_16x16x32_bf16 v[240:243], v[120:123], v[68:71], v[240:243]
ds_read_b128 v[48:51], v252 offset:5120
v_or_b32_e64 v99, v90, v91
v_mfma_f32_16x16x32_f16 v[4:7], v[124:127], v[156:159], v[4:7]
v_pk_add_f16 v209, v209, 1.0 op_sel_hi:[1,0]
v_cvt_pk_f16_f32 v116, v116, v117
v_mfma_f32_16x16x32_bf16 v[72:75], v[120:123], v[40:43], v[72:75]
ds_read_b128 v[120:123], v248 offset:256
v_rcp_f16_sdwa v209, v209 dst_sel:WORD_0 dst_unused:UNUSED_PRESERVE src0_sel:WORD_0
v_mfma_f32_16x16x32_f16 v[224:227], v[124:127], v[172:175], v[224:227]
v_cvt_pkrtz_f16_f32 v241, v240, v241
v_and_b32_e64 v241, s49, v241
v_mfma_f32_16x16x32_bf16 v[24:27], v[184:187], v[28:31], 0
v_bfe_u32 v240, v241, 2, 14
v_lshrrev_b32 v241, 18, v241
v_mfma_f32_16x16x32_f16 v[92:95], v[124:127], v[0:3], v[92:95]
s_waitcnt lgkmcnt(4)
ds_read_b128 v[124:127], v252 offset:8192
ds_read_u16 v240, v240
v_mfma_f32_16x16x32_bf16 v[164:167], v[18:21], v[228:231], v[164:167]
ds_read_u16_d16_hi v241, v241
v_rcp_f16_sdwa v209, v209 dst_sel:WORD_1 dst_unused:UNUSED_PRESERVE src0_sel:WORD_1
v_mfma_f32_16x16x32_bf16 v[216:219], v[16:19], v[228:231], v[216:219]
v_pk_fma_f16 v117, v116, v116, s48
v_cvt_pkrtz_f16_f32 v73, v72, v73
v_mfma_f32_16x16x32_bf16 v[100:103], v[18:21], v[112:115], v[100:103]
v_and_b32_e64 v73, s49, v73
v_bfe_u32 v72, v73, 2, 14
v_mfma_f32_16x16x32_bf16 v[232:235], v[16:19], v[112:115], v[232:235]
v_lshrrev_b32 v73, 18, v73
v_or_b32 v212, v212, v213
v_mfma_f32_16x16x32_bf16 v[56:59], v[184:187], v[128:131], 0
ds_read_u16 v72, v72
ds_read_u16_d16_hi v73, v73
v_mfma_f32_16x16x32_f16 v[164:167], v[176:179], v[96:99], v[164:167]
s_setprio 1
v_pk_mul_f16 v117, v116, v117
v_cvt_pkrtz_f16_f32 v119, v118, v119
v_mfma_f32_16x16x32_bf16 v[60:63], v[184:187], v[136:139], 0
ds_read_b128 v[184:187], v248 offset:2304
v_and_b32 v119, s49, v119
v_mfma_f32_16x16x32_f16 v[168:171], v[176:179], v[12:15], v[168:171]
v_bfe_u32 v118, v119, 2, 14
v_lshrrev_b32_e64 v119, 18, v119
v_mfma_f32_16x16x32_bf16 v[24:27], v[188:191], v[36:39], v[24:27]
ds_read_u16 v118, v118
ds_read_u16_d16_hi v119, v119
v_mfma_f32_16x16x32_f16 v[132:135], v[176:179], v[8:11], v[132:135]
ds_read_b128 v[176:179], v252 offset:6144
v_pk_mul_f16 v208, v208, v209
v_mfma_f32_16x16x32_bf16 v[56:59], v[188:191], v[108:111], v[56:59]
v_exp_f16_sdwa v117, v117 dst_sel:WORD_0 dst_unused:UNUSED_PRESERVE src0_sel:WORD_0
v_mfma_f32_16x16x32_f16 v[216:219], v[160:163], v[96:99], v[216:219]
v_or_b32_e64 v180, v180, v181
v_cvt_pkrtz_f16_f32 v243, v242, v243
v_and_b32_e64 v243, s49, v243
v_bfe_u32 v242, v243, 2, 14
v_lshrrev_b32_e64 v243, 18, v243
v_mfma_f32_16x16x32_bf16 v[60:63], v[188:191], v[192:195], v[60:63]
ds_read_u16 v242, v242
ds_read_u16_d16_hi v243, v243
v_mfma_f32_16x16x32_f16 v[220:223], v[160:163], v[12:15], v[220:223]
s_waitcnt lgkmcnt(6)
ds_read_b128 v[188:191], v248 offset:4352
v_or_b32 v209, v210, v211
v_cvt_pkrtz_f16_f32 v75, v74, v75
v_and_b32_e64 v75, s49, v75
v_bfe_u32 v74, v75, 2, 14
v_lshrrev_b32_e64 v75, 18, v75
v_mfma_f32_16x16x32_bf16 v[24:27], v[52:55], v[44:47], v[24:27]
ds_read_u16 v74, v74
ds_read_u16_d16_hi v75, v75
v_mfma_f32_16x16x32_f16 v[76:79], v[160:163], v[8:11], v[76:79]
v_exp_f16_sdwa v117, v117 dst_sel:WORD_1 dst_unused:UNUSED_PRESERVE src0_sel:WORD_1
v_or_b32_e64 v213, v214, v215
v_mfma_f32_16x16x32_bf16 v[56:59], v[52:55], v[144:147], v[56:59]
ds_read_b128 v[160:163], v252 offset:9216
v_or_b32 v181, v182, v183
v_mfma_f32_16x16x32_f16 v[100:103], v[48:51], v[96:99], v[100:103]
s_setprio 0
v_pk_add_f16 v117, v117, 1.0 op_sel_hi:[1,0]
v_cvt_pk_f16_f32 v24, v24, v25
v_mfma_f32_16x16x32_bf16 v[60:63], v[52:55], v[148:151], v[60:63]
ds_read_b128 v[52:55], v248 offset:6144
v_rcp_f16_sdwa v117, v117 dst_sel:WORD_0 dst_unused:UNUSED_PRESERVE src0_sel:WORD_0
v_mfma_f32_16x16x32_f16 v[104:107], v[48:51], v[12:15], v[104:107]
v_cvt_pkrtz_f16_f32 v57, v56, v57
v_and_b32_e64 v57, s49, v57
v_mfma_f32_16x16x32_bf16 v[32:35], v[120:123], v[28:31], 0
v_bfe_u32 v56, v57, 2, 14
v_lshrrev_b32_e64 v57, 18, v57
v_mfma_f32_16x16x32_f16 v[140:143], v[48:51], v[8:11], v[140:143]
ds_read_b128 v[48:51], v252 offset:10240
ds_read_u16 v56, v56
v_mfma_f32_16x16x32_bf16 v[152:155], v[120:123], v[128:131], 0
ds_read_u16_d16_hi v57, v57
v_rcp_f16_sdwa v117, v117 dst_sel:WORD_1 dst_unused:UNUSED_PRESERVE src0_sel:WORD_1
v_mfma_f32_16x16x32_f16 v[232:235], v[124:127], v[96:99], v[232:235]
v_pk_fma_f16 v25, v24, v24, s48
v_cvt_pkrtz_f16_f32 v61, v60, v61
v_mfma_f32_16x16x32_bf16 v[80:83], v[120:123], v[136:139], 0
ds_read_b128 v[120:123], v248 offset:8192
v_and_b32_e64 v61, s49, v61
v_mfma_f32_16x16x32_f16 v[236:239], v[124:127], v[12:15], v[236:239]
v_bfe_u32 v60, v61, 2, 14
v_lshrrev_b32 v61, 18, v61
s_waitcnt lgkmcnt(4)
v_mfma_f32_16x16x32_bf16 v[32:35], v[184:187], v[36:39], v[32:35]
ds_read_u16 v60, v60
ds_read_u16_d16_hi v61, v61
v_mfma_f32_16x16x32_f16 v[84:87], v[124:127], v[8:11], v[84:87]
v_or_b32_e64 v214, v240, v241
v_pk_mul_f16 v25, v24, v25
v_cvt_pkrtz_f16_f32 v27, v26, v27
v_and_b32_e64 v27, s49, v27
v_bfe_u32 v26, v27, 2, 14
v_lshrrev_b32_e64 v27, 18, v27
v_pk_mul_f16 v210, v116, v117
ds_read_b128 v[124:127], v252 offset:13312
ds_read_u16 v26, v26
ds_read_u16_d16_hi v27, v27
v_mfma_f32_16x16x32_bf16 v[152:155], v[184:187], v[108:111], v[152:155]
v_exp_f16_sdwa v25, v25 dst_sel:WORD_0 dst_unused:UNUSED_PRESERVE src0_sel:WORD_0
v_mfma_f32_16x16x32_f16 v[200:203], v[176:179], v[96:99], v[200:203]
s_setprio 3
v_or_b32 v182, v72, v73
v_cvt_pkrtz_f16_f32 v59, v58, v59
v_and_b32_e64 v59, s49, v59
v_bfe_u32 v58, v59, 2, 14
v_lshrrev_b32_e64 v59, 18, v59
v_mfma_f32_16x16x32_bf16 v[80:83], v[184:187], v[192:195], v[80:83]
ds_read_u16 v58, v58
ds_read_u16_d16_hi v59, v59
v_mfma_f32_16x16x32_f16 v[204:207], v[176:179], v[12:15], v[204:207]
ds_read_b128 v[184:187], v248 offset:10240
v_or_b32_e64 v211, v118, v119
v_cvt_pkrtz_f16_f32 v63, v62, v63
v_and_b32_e64 v63, s49, v63
v_bfe_u32 v62, v63, 2, 14
v_lshrrev_b32_e64 v63, 18, v63
v_mfma_f32_16x16x32_bf16 v[32:35], v[188:191], v[44:47], v[32:35]
ds_read_u16 v62, v62
ds_read_u16_d16_hi v63, v63
v_mfma_f32_16x16x32_f16 v[244:247], v[176:179], v[8:11], v[244:247]
v_exp_f16_sdwa v25, v25 dst_sel:WORD_1 dst_unused:UNUSED_PRESERVE src0_sel:WORD_1
v_or_b32_e64 v215, v242, v243
v_mfma_f32_16x16x32_bf16 v[152:155], v[188:191], v[144:147], v[152:155]
ds_read_b128 v[176:179], v252 offset:11264
v_or_b32 v183, v74, v75
v_mfma_f32_16x16x32_f16 v[4:7], v[160:163], v[96:99], v[4:7]
v_pk_add_f16 v25, v25, 1.0 op_sel_hi:[1,0]
v_cvt_pk_f16_f32 v32, v32, v33
v_mfma_f32_16x16x32_bf16 v[80:83], v[188:191], v[148:151], v[80:83]
s_waitcnt lgkmcnt(6)
ds_read_b128 v[188:191], v248 offset:6400
v_rcp_f16_sdwa v25, v25 dst_sel:WORD_0 dst_unused:UNUSED_PRESERVE src0_sel:WORD_0
v_mfma_f32_16x16x32_f16 v[224:227], v[160:163], v[12:15], v[224:227]
v_cvt_pkrtz_f16_f32 v153, v152, v153
v_and_b32_e64 v153, s49, v153
v_mfma_f32_16x16x32_bf16 v[88:91], v[52:55], v[28:31], 0
v_bfe_u32 v152, v153, 2, 14
v_lshrrev_b32_e64 v153, 18, v153
v_mfma_f32_16x16x32_f16 v[92:95], v[160:163], v[8:11], v[92:95]
ds_read_b128 v[160:163], v252 offset:14336
ds_read_u16 v152, v152
v_mfma_f32_16x16x32_bf16 v[64:67], v[52:55], v[128:131], 0
ds_read_u16_d16_hi v153, v153
v_rcp_f16_sdwa v25, v25 dst_sel:WORD_1 dst_unused:UNUSED_PRESERVE src0_sel:WORD_1
v_mfma_f32_16x16x32_f16 v[164:167], v[48:51], v[180:183], v[164:167]
s_setprio 2
v_pk_fma_f16 v33, v32, v32, s48
v_cvt_pkrtz_f16_f32 v81, v80, v81
v_mfma_f32_16x16x32_bf16 v[68:71], v[52:55], v[136:139], 0
ds_read_b128 v[52:55], v248 offset:8448
v_and_b32 v81, s49, v81
v_mfma_f32_16x16x32_f16 v[168:171], v[48:51], v[212:215], v[168:171]
v_bfe_u32 v80, v81, 2, 14
v_lshrrev_b32_e64 v81, 18, v81
v_mfma_f32_16x16x32_bf16 v[88:91], v[120:123], v[36:39], v[88:91]
ds_read_u16 v80, v80
ds_read_u16_d16_hi v81, v81
v_mfma_f32_16x16x32_f16 v[132:135], v[48:51], v[208:211], v[132:135]
v_or_b32_e64 v56, v56, v57
v_pk_mul_f16 v33, v32, v33
v_cvt_pkrtz_f16_f32 v35, v34, v35
v_and_b32_e64 v35, s49, v35
v_bfe_u32 v34, v35, 2, 14
v_lshrrev_b32 v35, 18, v35
v_pk_mul_f16 v24, v24, v25
ds_read_b128 v[48:51], v252 offset:12288
ds_read_u16 v34, v34
s_waitcnt lgkmcnt(7)
ds_read_u16_d16_hi v35, v35
v_mfma_f32_16x16x32_bf16 v[64:67], v[120:123], v[108:111], v[64:67]
v_exp_f16_sdwa v33, v33 dst_sel:WORD_0 dst_unused:UNUSED_PRESERVE src0_sel:WORD_0
v_mfma_f32_16x16x32_f16 v[216:219], v[124:127], v[180:183], v[216:219]
v_or_b32_e64 v60, v60, v61
v_cvt_pkrtz_f16_f32 v155, v154, v155
v_and_b32_e64 v155, s49, v155
v_bfe_u32 v154, v155, 2, 14
v_lshrrev_b32_e64 v155, 18, v155
v_mfma_f32_16x16x32_bf16 v[68:71], v[120:123], v[192:195], v[68:71]
ds_read_u16 v154, v154
ds_read_u16_d16_hi v155, v155
v_mfma_f32_16x16x32_f16 v[220:223], v[124:127], v[212:215], v[220:223]
ds_read_b128 v[120:123], v248 offset:10496
v_or_b32_e64 v25, v26, v27
v_cvt_pkrtz_f16_f32 v83, v82, v83
v_and_b32_e64 v83, s49, v83
v_bfe_u32 v82, v83, 2, 14
v_lshrrev_b32_e64 v83, 18, v83
v_mfma_f32_16x16x32_bf16 v[88:91], v[184:187], v[44:47], v[88:91]
ds_read_u16 v82, v82
ds_read_u16_d16_hi v83, v83
v_mfma_f32_16x16x32_f16 v[76:79], v[124:127], v[208:211], v[76:79]
v_exp_f16_sdwa v33, v33 dst_sel:WORD_1 dst_unused:UNUSED_PRESERVE src0_sel:WORD_1
v_or_b32_e64 v57, v58, v59
v_mfma_f32_16x16x32_bf16 v[64:67], v[184:187], v[144:147], v[64:67]
ds_read_b128 v[124:127], v252 offset:15360
s_setprio 1
v_or_b32 v61, v62, v63
v_mfma_f32_16x16x32_f16 v[100:103], v[176:179], v[180:183], v[100:103]
v_pk_add_f16 v33, v33, 1.0 op_sel_hi:[1,0]
v_cvt_pk_f16_f32 v88, v88, v89
v_mfma_f32_16x16x32_bf16 v[68:71], v[184:187], v[148:151], v[68:71]
ds_read_b128 v[184:187], v248 offset:12288
v_rcp_f16_sdwa v33, v33 dst_sel:WORD_0 dst_unused:UNUSED_PRESERVE src0_sel:WORD_0
v_mfma_f32_16x16x32_f16 v[104:107], v[176:179], v[212:215], v[104:107]
v_cvt_pkrtz_f16_f32 v65, v64, v65
v_and_b32_e64 v65, s49, v65
v_mfma_f32_16x16x32_bf16 v[40:43], v[188:191], v[28:31], 0
v_bfe_u32 v64, v65, 2, 14
v_lshrrev_b32 v65, 18, v65
v_mfma_f32_16x16x32_f16 v[140:143], v[176:179], v[208:211], v[140:143]
s_waitcnt lgkmcnt(4)
ds_read_b128 v[176:179], v251 offset:8192
ds_read_u16 v64, v64
v_mfma_f32_16x16x32_bf16 v[0:3], v[188:191], v[128:131], 0
ds_read_u16_d16_hi v65, v65
v_rcp_f16_sdwa v33, v33 dst_sel:WORD_1 dst_unused:UNUSED_PRESERVE src0_sel:WORD_1
v_mfma_f32_16x16x32_f16 v[232:235], v[160:163], v[180:183], v[232:235]
v_pk_fma_f16 v89, v88, v88, s48
v_cvt_pkrtz_f16_f32 v69, v68, v69
v_mfma_f32_16x16x32_bf16 v[172:175], v[188:191], v[136:139], 0
ds_read_b128 v[188:191], v248 offset:14336
v_and_b32_e64 v69, s49, v69
v_mfma_f32_16x16x32_f16 v[236:239], v[160:163], v[212:215], v[236:239]
v_bfe_u32 v68, v69, 2, 14
v_lshrrev_b32_e64 v69, 18, v69
v_mfma_f32_16x16x32_bf16 v[40:43], v[52:55], v[36:39], v[40:43]
ds_read_u16 v68, v68
ds_read_u16_d16_hi v69, v69
v_mfma_f32_16x16x32_f16 v[84:87], v[160:163], v[208:211], v[84:87]
v_or_b32_e64 v58, v152, v153
v_pk_mul_f16 v89, v88, v89
v_cvt_pkrtz_f16_f32 v91, v90, v91
v_and_b32_e64 v91, s49, v91
v_bfe_u32 v90, v91, 2, 14
v_lshrrev_b32_e64 v91, 18, v91
v_pk_mul_f16 v26, v32, v33
ds_read_b128 v[160:163], v251 offset:11264
ds_read_u16 v90, v90
ds_read_u16_d16_hi v91, v91
v_mfma_f32_16x16x32_bf16 v[0:3], v[52:55], v[108:111], v[0:3]
s_setprio 0
v_exp_f16_sdwa v89, v89 dst_sel:WORD_0 dst_unused:UNUSED_PRESERVE src0_sel:WORD_0
v_mfma_f32_16x16x32_f16 v[200:203], v[48:51], v[180:183], v[200:203]
v_or_b32 v62, v80, v81
v_cvt_pkrtz_f16_f32 v67, v66, v67
v_and_b32_e64 v67, s49, v67
v_bfe_u32 v66, v67, 2, 14
v_lshrrev_b32_e64 v67, 18, v67
v_mfma_f32_16x16x32_bf16 v[172:175], v[52:55], v[192:195], v[172:175]
ds_read_u16 v66, v66
ds_read_u16_d16_hi v67, v67
v_mfma_f32_16x16x32_f16 v[204:207], v[48:51], v[212:215], v[204:207]
s_waitcnt lgkmcnt(6)
ds_read_b128 v[52:55], v248 offset:16384
v_or_b32 v27, v34, v35
v_cvt_pkrtz_f16_f32 v71, v70, v71
v_and_b32_e64 v71, s49, v71
v_bfe_u32 v70, v71, 2, 14
v_lshrrev_b32_e64 v71, 18, v71
v_mfma_f32_16x16x32_bf16 v[40:43], v[120:123], v[44:47], v[40:43]
ds_read_u16 v70, v70
ds_read_u16_d16_hi v71, v71
v_mfma_f32_16x16x32_f16 v[244:247], v[48:51], v[208:211], v[244:247]
v_cvt_pk_bf16_f32 v132, v132, v133
v_cvt_pk_bf16_f32 v133, v134, v135
v_cvt_pk_bf16_f32 v134, v76, v77
v_cvt_pk_bf16_f32 v135, v78, v79
v_cvt_pk_bf16_f32 v168, v168, v169
v_cvt_pk_bf16_f32 v169, v170, v171
v_cvt_pk_bf16_f32 v170, v220, v221
v_cvt_pk_bf16_f32 v171, v222, v223
v_cvt_pk_bf16_f32 v164, v164, v165
v_cvt_pk_bf16_f32 v165, v166, v167
v_cvt_pk_bf16_f32 v166, v216, v217
v_cvt_pk_bf16_f32 v167, v218, v219
v_exp_f16_sdwa v89, v89 dst_sel:WORD_1 dst_unused:UNUSED_PRESERVE src0_sel:WORD_1
v_or_b32_e64 v59, v154, v155
v_cvt_pk_bf16_f32 v140, v140, v141
v_cvt_pk_bf16_f32 v141, v142, v143
v_cvt_pk_bf16_f32 v142, v84, v85
v_cvt_pk_bf16_f32 v143, v86, v87
ds_read_b128 v[76:79], v254 offset:8192
ds_read_b128 v[220:223], v254 offset:8208
ds_read_b128 v[48:51], v251 offset:9216
v_cvt_pk_bf16_f32 v104, v104, v105
v_cvt_pk_bf16_f32 v105, v106, v107
v_cvt_pk_bf16_f32 v106, v236, v237
v_cvt_pk_bf16_f32 v107, v238, v239
v_cvt_pk_bf16_f32 v100, v100, v101
v_cvt_pk_bf16_f32 v101, v102, v103
v_cvt_pk_bf16_f32 v102, v232, v233
v_cvt_pk_bf16_f32 v103, v234, v235
v_mfma_f32_16x16x32_bf16 v[0:3], v[120:123], v[144:147], v[0:3]
ds_read_b128 v[84:87], v254 offset:8320
ds_read_b128 v[236:239], v254 offset:8336
v_mfma_f32_16x16x32_f16 v[4:7], v[124:127], v[180:183], v[4:7]
v_cvt_pk_bf16_f32 v244, v244, v245
v_cvt_pk_bf16_f32 v245, v246, v247
v_cvt_pk_bf16_f32 v204, v204, v205
v_cvt_pk_bf16_f32 v205, v206, v207
v_or_b32_e64 v63, v82, v83
v_mfma_f32_16x16x32_bf16 v[172:175], v[120:123], v[148:151], v[172:175]
v_pk_add_f16 v89, v89, 1.0 op_sel_hi:[1,0]
v_cvt_pkrtz_f16_f32 v1, v0, v1
v_mfma_f32_16x16x32_f16 v[224:227], v[124:127], v[212:215], v[224:227]
ds_read_b128 v[120:123], v248 offset:12544
v_rcp_f16_sdwa v89, v89 dst_sel:WORD_0 dst_unused:UNUSED_PRESERVE src0_sel:WORD_0
v_mfma_f32_16x16x32_bf16 v[156:159], v[184:187], v[28:31], 0
v_and_b32_e64 v1, s49, v1
v_bfe_u32 v0, v1, 2, 14
v_mfma_f32_16x16x32_f16 v[92:95], v[124:127], v[208:211], v[92:95]
s_nop 1
v_cvt_pk_bf16_f32 v206, v224, v225
v_cvt_pk_bf16_f32 v207, v226, v227
v_mfma_f32_16x16x32_bf16 v[200:203], v[18:21], v[196:199], v[200:203]
s_waitcnt lgkmcnt(2)
ds_read_b128 v[224:227], v254 offset:16
ds_read_b128 v[124:127], v251 offset:12288
v_mfma_f32_16x16x32_bf16 v[4:7], v[16:19], v[196:199], v[4:7]
v_lshrrev_b32 v1, 18, v1
v_cvt_pk_bf16_f32 v246, v92, v93
v_cvt_pk_bf16_f32 v247, v94, v95
v_mfma_f32_16x16x32_bf16 v[228:231], v[184:187], v[128:131], 0
ds_read_b128 v[92:95], v254
v_cvt_pk_bf16_f32 v200, v200, v201
v_cvt_pk_bf16_f32 v201, v202, v203
s_setprio 3
v_cvt_pk_bf16_f32 v202, v4, v5
v_cvt_pk_bf16_f32 v203, v6, v7
v_mfma_f32_16x16x32_f16 v[116:119], v[176:179], v[60:63], v[76:79]
ds_read_u16 v0, v0
ds_read_u16_d16_hi v1, v1
v_cvt_pk_f16_f32 v40, v40, v41
v_mfma_f32_16x16x32_bf16 v[112:115], v[184:187], v[136:139], 0
v_rcp_f16_sdwa v89, v89 dst_sel:WORD_1 dst_unused:UNUSED_PRESERVE src0_sel:WORD_1
buffer_store_dwordx4 v[132:135], v253, s[8:11], s70 offen sc1
buffer_store_dwordx4 v[140:143], v253, s[8:11], s70 offen offset:64 sc1
v_mfma_f32_16x16x32_f16 v[240:243], v[176:179], v[56:59], v[76:79]
ds_read_b128 v[184:187], v248 offset:14592
v_pk_fma_f16 v41, v40, v40, s48
v_cvt_pkrtz_f16_f32 v173, v172, v173
v_and_b32_e64 v173, s49, v173
v_bfe_u32 v172, v173, 2, 14
v_lshrrev_b32_e64 v173, 18, v173
v_mfma_f32_16x16x32_bf16 v[156:159], v[188:191], v[36:39], v[156:159]
ds_read_u16 v172, v172
ds_read_u16_d16_hi v173, v173
v_mfma_f32_16x16x32_f16 v[76:79], v[176:179], v[24:27], v[76:79]
v_or_b32_e64 v64, v64, v65
v_pk_mul_f16 v41, v40, v41
v_cvt_pkrtz_f16_f32 v43, v42, v43
v_and_b32_e64 v43, s49, v43
v_bfe_u32 v42, v43, 2, 14
v_lshrrev_b32_e64 v43, 18, v43
v_pk_mul_f16 v88, v88, v89
ds_read_b128 v[176:179], v251 offset:10240
ds_read_u16 v42, v42
ds_read_u16_d16_hi v43, v43
v_mfma_f32_16x16x32_bf16 v[228:231], v[188:191], v[108:111], v[228:231]
v_exp_f16_sdwa v41, v41 dst_sel:WORD_0 dst_unused:UNUSED_PRESERVE src0_sel:WORD_0
v_mfma_f32_16x16x32_f16 v[72:75], v[160:163], v[60:63], v[220:223]
v_or_b32_e64 v68, v68, v69
v_cvt_pkrtz_f16_f32 v3, v2, v3
v_and_b32_e64 v3, s49, v3
v_bfe_u32 v2, v3, 2, 14
v_lshrrev_b32_e64 v3, 18, v3
v_mfma_f32_16x16x32_bf16 v[112:115], v[188:191], v[192:195], v[112:115]
ds_read_u16 v2, v2
ds_read_u16_d16_hi v3, v3
v_mfma_f32_16x16x32_f16 v[8:11], v[160:163], v[56:59], v[220:223]
s_waitcnt lgkmcnt(6)
ds_read_b128 v[188:191], v248 offset:16640
v_or_b32 v89, v90, v91
v_cvt_pkrtz_f16_f32 v175, v174, v175
v_and_b32_e64 v175, s49, v175
v_bfe_u32 v174, v175, 2, 14
v_lshrrev_b32_e64 v175, 18, v175
v_mfma_f32_16x16x32_bf16 v[156:159], v[52:55], v[44:47], v[156:159]
ds_read_u16 v174, v174
ds_read_u16_d16_hi v175, v175
v_mfma_f32_16x16x32_f16 v[220:223], v[160:163], v[24:27], v[220:223]
v_exp_f16_sdwa v41, v41 dst_sel:WORD_1 dst_unused:UNUSED_PRESERVE src0_sel:WORD_1
v_or_b32_e64 v65, v66, v67
v_mfma_f32_16x16x32_bf16 v[228:231], v[52:55], v[144:147], v[228:231]
ds_read_b128 v[160:163], v251 offset:13312
s_setprio 2
v_or_b32 v69, v70, v71
v_mfma_f32_16x16x32_f16 v[12:15], v[48:51], v[60:63], v[84:87]
v_pk_add_f16 v41, v41, 1.0 op_sel_hi:[1,0]
v_cvt_pk_f16_f32 v156, v156, v157
v_mfma_f32_16x16x32_bf16 v[112:115], v[52:55], v[148:151], v[112:115]
ds_read_b128 v[52:55], v248 offset:18432
v_rcp_f16_sdwa v41, v41 dst_sel:WORD_0 dst_unused:UNUSED_PRESERVE src0_sel:WORD_0
v_mfma_f32_16x16x32_f16 v[96:99], v[48:51], v[56:59], v[84:87]
v_cvt_pkrtz_f16_f32 v229, v228, v229
v_and_b32_e64 v229, s49, v229
v_mfma_f32_16x16x32_bf16 v[32:35], v[120:123], v[28:31], 0
v_bfe_u32 v228, v229, 2, 14
v_lshrrev_b32_e64 v229, 18, v229
v_mfma_f32_16x16x32_f16 v[84:87], v[48:51], v[24:27], v[84:87]
ds_read_b128 v[48:51], v251 offset:14336
ds_read_u16 v228, v228
v_mfma_f32_16x16x32_bf16 v[152:155], v[120:123], v[128:131], 0
ds_read_u16_d16_hi v229, v229
v_rcp_f16_sdwa v41, v41 dst_sel:WORD_1 dst_unused:UNUSED_PRESERVE src0_sel:WORD_1
v_mfma_f32_16x16x32_f16 v[208:211], v[124:127], v[60:63], v[236:239]
v_pk_fma_f16 v157, v156, v156, s48
v_cvt_pkrtz_f16_f32 v113, v112, v113
v_mfma_f32_16x16x32_bf16 v[80:83], v[120:123], v[136:139], 0
ds_read_b128 v[120:123], v248 offset:20480
v_and_b32_e64 v113, s49, v113
v_mfma_f32_16x16x32_f16 v[212:215], v[124:127], v[56:59], v[236:239]
v_bfe_u32 v112, v113, 2, 14
v_lshrrev_b32 v113, 18, v113
v_mfma_f32_16x16x32_bf16 v[32:35], v[184:187], v[36:39], v[32:35]
s_waitcnt lgkmcnt(4)
ds_read_u16 v112, v112
ds_read_u16_d16_hi v113, v113
v_mfma_f32_16x16x32_f16 v[236:239], v[124:127], v[24:27], v[236:239]
v_or_b32_e64 v66, v0, v1
v_pk_mul_f16 v157, v156, v157
v_cvt_pkrtz_f16_f32 v159, v158, v159
v_and_b32_e64 v159, s49, v159
v_bfe_u32 v158, v159, 2, 14
v_lshrrev_b32 v159, 18, v159
v_pk_mul_f16 v90, v40, v41
ds_read_b128 v[124:127], v251 offset:17408
s_setprio 1
ds_read_u16 v158, v158
ds_read_u16_d16_hi v159, v159
v_mfma_f32_16x16x32_bf16 v[152:155], v[184:187], v[108:111], v[152:155]
v_exp_f16_sdwa v157, v157 dst_sel:WORD_0 dst_unused:UNUSED_PRESERVE src0_sel:WORD_0
v_mfma_f32_16x16x32_f16 v[180:183], v[176:179], v[60:63], v[92:95]
v_or_b32_e64 v70, v172, v173
v_cvt_pkrtz_f16_f32 v231, v230, v231
v_and_b32_e64 v231, s49, v231
v_bfe_u32 v230, v231, 2, 14
v_lshrrev_b32_e64 v231, 18, v231
v_mfma_f32_16x16x32_bf16 v[80:83], v[184:187], v[192:195], v[80:83]
ds_read_u16 v230, v230
ds_read_u16_d16_hi v231, v231
v_mfma_f32_16x16x32_f16 v[196:199], v[176:179], v[56:59], v[92:95]
ds_read_b128 v[184:187], v248 offset:22528
v_or_b32_e64 v91, v42, v43
v_cvt_pkrtz_f16_f32 v115, v114, v115
v_and_b32_e64 v115, s49, v115
v_bfe_u32 v114, v115, 2, 14
v_lshrrev_b32_e64 v115, 18, v115
v_mfma_f32_16x16x32_bf16 v[32:35], v[188:191], v[44:47], v[32:35]
ds_read_u16 v114, v114
ds_read_u16_d16_hi v115, v115
v_mfma_f32_16x16x32_f16 v[92:95], v[176:179], v[24:27], v[92:95]
v_exp_f16_sdwa v157, v157 dst_sel:WORD_1 dst_unused:UNUSED_PRESERVE src0_sel:WORD_1
v_or_b32_e64 v67, v2, v3
v_mfma_f32_16x16x32_bf16 v[152:155], v[188:191], v[144:147], v[152:155]
ds_read_b128 v[176:179], v251 offset:15360
v_or_b32 v71, v174, v175
v_mfma_f32_16x16x32_f16 v[216:219], v[160:163], v[60:63], v[224:227]
v_pk_add_f16 v157, v157, 1.0 op_sel_hi:[1,0]
v_cvt_pk_f16_f32 v32, v32, v33
v_mfma_f32_16x16x32_bf16 v[80:83], v[188:191], v[148:151], v[80:83]
s_waitcnt lgkmcnt(6)
ds_read_b128 v[188:191], v248 offset:18688
v_rcp_f16_sdwa v157, v157 dst_sel:WORD_0 dst_unused:UNUSED_PRESERVE src0_sel:WORD_0
v_mfma_f32_16x16x32_f16 v[232:235], v[160:163], v[56:59], v[224:227]
v_cvt_pkrtz_f16_f32 v153, v152, v153
v_and_b32_e64 v153, s49, v153
v_mfma_f32_16x16x32_bf16 v[4:7], v[52:55], v[28:31], 0
v_bfe_u32 v152, v153, 2, 14
v_lshrrev_b32 v153, 18, v153
v_mfma_f32_16x16x32_f16 v[224:227], v[160:163], v[24:27], v[224:227]
s_setprio 0
ds_read_b128 v[160:163], v251 offset:18432
ds_read_u16 v152, v152
v_mfma_f32_16x16x32_bf16 v[132:135], v[52:55], v[128:131], 0
ds_read_u16_d16_hi v153, v153
v_rcp_f16_sdwa v157, v157 dst_sel:WORD_1 dst_unused:UNUSED_PRESERVE src0_sel:WORD_1
v_mfma_f32_16x16x32_f16 v[116:119], v[48:51], v[68:71], v[116:119]
v_pk_fma_f16 v33, v32, v32, s48
v_cvt_pkrtz_f16_f32 v81, v80, v81
v_mfma_f32_16x16x32_bf16 v[140:143], v[52:55], v[136:139], 0
ds_read_b128 v[52:55], v248 offset:20736
v_and_b32_e64 v81, s49, v81
v_mfma_f32_16x16x32_f16 v[240:243], v[48:51], v[64:67], v[240:243]
v_bfe_u32 v80, v81, 2, 14
v_lshrrev_b32_e64 v81, 18, v81
v_mfma_f32_16x16x32_bf16 v[4:7], v[120:123], v[36:39], v[4:7]
ds_read_u16 v80, v80
ds_read_u16_d16_hi v81, v81
v_mfma_f32_16x16x32_f16 v[76:79], v[48:51], v[88:91], v[76:79]
buffer_store_dwordx4 v[244:247], v253, s[8:11], s70 offen offset:128 sc1
buffer_store_dwordx4 v[168:171], v253, s[8:11], s70 offen offset:192 sc1
v_or_b32_e64 v228, v228, v229
v_pk_mul_f16 v33, v32, v33
v_cvt_pkrtz_f16_f32 v35, v34, v35
v_and_b32_e64 v35, s49, v35
v_bfe_u32 v34, v35, 2, 14
v_lshrrev_b32 v35, 18, v35
v_pk_mul_f16 v156, v156, v157
ds_read_b128 v[48:51], v251 offset:16384
ds_read_u16 v34, v34
s_waitcnt lgkmcnt(6)
ds_read_u16_d16_hi v35, v35
v_mfma_f32_16x16x32_bf16 v[132:135], v[120:123], v[108:111], v[132:135]
v_exp_f16_sdwa v33, v33 dst_sel:WORD_0 dst_unused:UNUSED_PRESERVE src0_sel:WORD_0
v_mfma_f32_16x16x32_f16 v[72:75], v[124:127], v[68:71], v[72:75]
v_or_b32_e64 v112, v112, v113
v_cvt_pkrtz_f16_f32 v155, v154, v155
v_and_b32_e64 v155, s49, v155
v_bfe_u32 v154, v155, 2, 14
v_lshrrev_b32_e64 v155, 18, v155
v_mfma_f32_16x16x32_bf16 v[140:143], v[120:123], v[192:195], v[140:143]
ds_read_u16 v154, v154
ds_read_u16_d16_hi v155, v155
v_mfma_f32_16x16x32_f16 v[8:11], v[124:127], v[64:67], v[8:11]
ds_read_b128 v[120:123], v248 offset:22784
v_or_b32_e64 v157, v158, v159
v_cvt_pkrtz_f16_f32 v83, v82, v83
v_and_b32_e64 v83, s49, v83
v_bfe_u32 v82, v83, 2, 14
v_lshrrev_b32_e64 v83, 18, v83
v_mfma_f32_16x16x32_bf16 v[4:7], v[184:187], v[44:47], v[4:7]
ds_read_u16 v82, v82
ds_read_u16_d16_hi v83, v83
v_mfma_f32_16x16x32_f16 v[220:223], v[124:127], v[88:91], v[220:223]
v_exp_f16_sdwa v33, v33 dst_sel:WORD_1 dst_unused:UNUSED_PRESERVE src0_sel:WORD_1
s_setprio 3
v_or_b32 v229, v230, v231
v_mfma_f32_16x16x32_bf16 v[132:135], v[184:187], v[144:147], v[132:135]
ds_read_b128 v[124:127], v251 offset:19456
v_or_b32_e64 v113, v114, v115
v_mfma_f32_16x16x32_f16 v[12:15], v[176:179], v[68:71], v[12:15]
v_pk_add_f16 v33, v33, 1.0 op_sel_hi:[1,0]
v_cvt_pk_f16_f32 v4, v4, v5
v_mfma_f32_16x16x32_bf16 v[140:143], v[184:187], v[148:151], v[140:143]
ds_read_b128 v[184:187], v248 offset:24576
v_rcp_f16_sdwa v33, v33 dst_sel:WORD_0 dst_unused:UNUSED_PRESERVE src0_sel:WORD_0
v_mfma_f32_16x16x32_f16 v[96:99], v[176:179], v[64:67], v[96:99]
v_cvt_pkrtz_f16_f32 v133, v132, v133
v_and_b32_e64 v133, s49, v133
v_mfma_f32_16x16x32_bf16 v[40:43], v[188:191], v[28:31], 0
v_bfe_u32 v132, v133, 2, 14
v_lshrrev_b32 v133, 18, v133
v_mfma_f32_16x16x32_f16 v[84:87], v[176:179], v[88:91], v[84:87]
ds_read_b128 v[176:179], v251 offset:20480
s_waitcnt lgkmcnt(5)
ds_read_u16 v132, v132
v_mfma_f32_16x16x32_bf16 v[0:3], v[188:191], v[128:131], 0
ds_read_u16_d16_hi v133, v133
v_rcp_f16_sdwa v33, v33 dst_sel:WORD_1 dst_unused:UNUSED_PRESERVE src0_sel:WORD_1
v_mfma_f32_16x16x32_f16 v[208:211], v[160:163], v[68:71], v[208:211]
v_pk_fma_f16 v5, v4, v4, s48
v_cvt_pkrtz_f16_f32 v141, v140, v141
v_mfma_f32_16x16x32_bf16 v[172:175], v[188:191], v[136:139], 0
ds_read_b128 v[188:191], v248 offset:26624
v_and_b32_e64 v141, s49, v141
v_mfma_f32_16x16x32_f16 v[212:215], v[160:163], v[64:67], v[212:215]
v_bfe_u32 v140, v141, 2, 14
v_lshrrev_b32_e64 v141, 18, v141
v_mfma_f32_16x16x32_bf16 v[40:43], v[52:55], v[36:39], v[40:43]
ds_read_u16 v140, v140
ds_read_u16_d16_hi v141, v141
v_mfma_f32_16x16x32_f16 v[236:239], v[160:163], v[88:91], v[236:239]
s_setprio 2
v_or_b32 v230, v152, v153
v_pk_mul_f16 v5, v4, v5
v_cvt_pkrtz_f16_f32 v7, v6, v7
v_and_b32_e64 v7, s49, v7
v_bfe_u32 v6, v7, 2, 14
v_lshrrev_b32_e64 v7, 18, v7
v_pk_mul_f16 v158, v32, v33
ds_read_b128 v[160:163], v251 offset:23552
ds_read_u16 v6, v6
ds_read_u16_d16_hi v7, v7
v_mfma_f32_16x16x32_bf16 v[0:3], v[52:55], v[108:111], v[0:3]
v_exp_f16_sdwa v5, v5 dst_sel:WORD_0 dst_unused:UNUSED_PRESERVE src0_sel:WORD_0
v_mfma_f32_16x16x32_f16 v[180:183], v[48:51], v[68:71], v[180:183]
v_or_b32_e64 v114, v80, v81
v_cvt_pkrtz_f16_f32 v135, v134, v135
v_and_b32_e64 v135, s49, v135
v_bfe_u32 v134, v135, 2, 14
v_lshrrev_b32_e64 v135, 18, v135
v_mfma_f32_16x16x32_bf16 v[172:175], v[52:55], v[192:195], v[172:175]
ds_read_u16 v134, v134
ds_read_u16_d16_hi v135, v135
v_mfma_f32_16x16x32_f16 v[196:199], v[48:51], v[64:67], v[196:199]
s_waitcnt lgkmcnt(6)
ds_read_b128 v[52:55], v248 offset:28672
v_or_b32 v159, v34, v35
v_cvt_pkrtz_f16_f32 v143, v142, v143
v_and_b32_e64 v143, s49, v143
v_bfe_u32 v142, v143, 2, 14
v_lshrrev_b32_e64 v143, 18, v143
v_mfma_f32_16x16x32_bf16 v[40:43], v[120:123], v[44:47], v[40:43]
ds_read_u16 v142, v142
ds_read_u16_d16_hi v143, v143
v_mfma_f32_16x16x32_f16 v[92:95], v[48:51], v[88:91], v[92:95]
v_exp_f16_sdwa v5, v5 dst_sel:WORD_1 dst_unused:UNUSED_PRESERVE src0_sel:WORD_1
v_or_b32_e64 v231, v154, v155
v_mfma_f32_16x16x32_bf16 v[0:3], v[120:123], v[144:147], v[0:3]
ds_read_b128 v[48:51], v251 offset:21504
v_or_b32_e64 v115, v82, v83
v_mfma_f32_16x16x32_f16 v[216:219], v[124:127], v[68:71], v[216:219]
v_pk_add_f16 v5, v5, 1.0 op_sel_hi:[1,0]
v_cvt_pk_f16_f32 v40, v40, v41
v_mfma_f32_16x16x32_bf16 v[172:175], v[120:123], v[148:151], v[172:175]
ds_read_b128 v[120:123], v248 offset:24832
v_rcp_f16_sdwa v5, v5 dst_sel:WORD_0 dst_unused:UNUSED_PRESERVE src0_sel:WORD_0
v_mfma_f32_16x16x32_f16 v[232:235], v[124:127], v[64:67], v[232:235]
v_cvt_pkrtz_f16_f32 v1, v0, v1
v_and_b32 v1, s49, v1
v_mfma_f32_16x16x32_bf16 v[24:27], v[184:187], v[28:31], 0
s_setprio 1
v_bfe_u32 v0, v1, 2, 14
v_lshrrev_b32_e64 v1, 18, v1
v_mfma_f32_16x16x32_f16 v[224:227], v[124:127], v[88:91], v[224:227]
ds_read_b128 v[124:127], v251 offset:24576
ds_read_u16 v0, v0
v_mfma_f32_16x16x32_bf16 v[56:59], v[184:187], v[128:131], 0
ds_read_u16_d16_hi v1, v1
v_rcp_f16_sdwa v5, v5 dst_sel:WORD_1 dst_unused:UNUSED_PRESERVE src0_sel:WORD_1
v_mfma_f32_16x16x32_f16 v[116:119], v[176:179], v[112:115], v[116:119]
v_pk_fma_f16 v41, v40, v40, s48
v_cvt_pkrtz_f16_f32 v173, v172, v173
v_mfma_f32_16x16x32_bf16 v[60:63], v[184:187], v[136:139], 0
ds_read_b128 v[184:187], v248 offset:26880
v_and_b32_e64 v173, s49, v173
v_mfma_f32_16x16x32_f16 v[240:243], v[176:179], v[228:231], v[240:243]
v_bfe_u32 v172, v173, 2, 14
v_lshrrev_b32 v173, 18, v173
v_mfma_f32_16x16x32_bf16 v[24:27], v[188:191], v[36:39], v[24:27]
s_waitcnt lgkmcnt(4)
ds_read_u16 v172, v172
ds_read_u16_d16_hi v173, v173
v_mfma_f32_16x16x32_f16 v[76:79], v[176:179], v[156:159], v[76:79]
v_or_b32_e64 v132, v132, v133
v_pk_mul_f16 v41, v40, v41
v_cvt_pkrtz_f16_f32 v43, v42, v43
v_and_b32_e64 v43, s49, v43
v_bfe_u32 v42, v43, 2, 14
v_lshrrev_b32_e64 v43, 18, v43
v_pk_mul_f16 v4, v4, v5
ds_read_b128 v[176:179], v251 offset:22528
ds_read_u16 v42, v42
ds_read_u16_d16_hi v43, v43
v_mfma_f32_16x16x32_bf16 v[56:59], v[188:191], v[108:111], v[56:59]
v_exp_f16_sdwa v41, v41 dst_sel:WORD_0 dst_unused:UNUSED_PRESERVE src0_sel:WORD_0
v_mfma_f32_16x16x32_f16 v[72:75], v[160:163], v[112:115], v[72:75]
buffer_store_dwordx4 v[104:107], v253, s[8:11], s70 offen offset:256 sc1
buffer_store_dwordx4 v[204:207], v253, s[8:11], s70 offen offset:320 sc1
v_or_b32_e64 v140, v140, v141
v_cvt_pkrtz_f16_f32 v3, v2, v3
v_and_b32_e64 v3, s49, v3
v_bfe_u32 v2, v3, 2, 14
v_lshrrev_b32_e64 v3, 18, v3
v_mfma_f32_16x16x32_bf16 v[60:63], v[188:191], v[192:195], v[60:63]
ds_read_u16 v2, v2
ds_read_u16_d16_hi v3, v3
v_mfma_f32_16x16x32_f16 v[8:11], v[160:163], v[228:231], v[8:11]
ds_read_b128 v[188:191], v248 offset:28928
v_or_b32_e64 v5, v6, v7
v_cvt_pkrtz_f16_f32 v175, v174, v175
v_and_b32_e64 v175, s49, v175
v_bfe_u32 v174, v175, 2, 14
v_lshrrev_b32_e64 v175, 18, v175
v_mfma_f32_16x16x32_bf16 v[24:27], v[52:55], v[44:47], v[24:27]
ds_read_u16 v174, v174
ds_read_u16_d16_hi v175, v175
s_setprio 0
v_mfma_f32_16x16x32_f16 v[220:223], v[160:163], v[156:159], v[220:223]
v_exp_f16_sdwa v41, v41 dst_sel:WORD_1 dst_unused:UNUSED_PRESERVE src0_sel:WORD_1
v_or_b32 v133, v134, v135
v_mfma_f32_16x16x32_bf16 v[56:59], v[52:55], v[144:147], v[56:59]
ds_read_b128 v[160:163], v251 offset:25600
v_or_b32 v141, v142, v143
v_mfma_f32_16x16x32_f16 v[12:15], v[48:51], v[112:115], v[12:15]
v_pk_add_f16 v41, v41, 1.0 op_sel_hi:[1,0]
v_cvt_pk_f16_f32 v24, v24, v25
v_mfma_f32_16x16x32_bf16 v[60:63], v[52:55], v[148:151], v[60:63]
s_waitcnt lgkmcnt(6)
ds_read_b128 v[52:55], v248 offset:30720
v_rcp_f16_sdwa v41, v41 dst_sel:WORD_0 dst_unused:UNUSED_PRESERVE src0_sel:WORD_0
v_mfma_f32_16x16x32_f16 v[96:99], v[48:51], v[228:231], v[96:99]
v_cvt_pkrtz_f16_f32 v57, v56, v57
v_and_b32_e64 v57, s49, v57
v_mfma_f32_16x16x32_bf16 v[244:247], v[120:123], v[28:31], 0
v_bfe_u32 v56, v57, 2, 14
v_lshrrev_b32_e64 v57, 18, v57
v_mfma_f32_16x16x32_f16 v[84:87], v[48:51], v[156:159], v[84:87]
ds_read_b128 v[48:51], v251 offset:26624
ds_read_u16 v56, v56
v_mfma_f32_16x16x32_bf16 v[168:171], v[120:123], v[128:131], 0
ds_read_u16_d16_hi v57, v57
v_rcp_f16_sdwa v41, v41 dst_sel:WORD_1 dst_unused:UNUSED_PRESERVE src0_sel:WORD_1
v_mfma_f32_16x16x32_f16 v[208:211], v[124:127], v[112:115], v[208:211]
v_pk_fma_f16 v25, v24, v24, s48
v_cvt_pkrtz_f16_f32 v61, v60, v61
v_mfma_f32_16x16x32_bf16 v[32:35], v[120:123], v[136:139], 0
ds_read_b128 v[120:123], v248 offset:32768
v_and_b32_e64 v61, s49, v61
v_mfma_f32_16x16x32_f16 v[212:215], v[124:127], v[228:231], v[212:215]
v_bfe_u32 v60, v61, 2, 14
v_lshrrev_b32_e64 v61, 18, v61
v_mfma_f32_16x16x32_bf16 v[244:247], v[184:187], v[36:39], v[244:247]
ds_read_u16 v60, v60
ds_read_u16_d16_hi v61, v61
s_setprio 3
v_mfma_f32_16x16x32_f16 v[236:239], v[124:127], v[156:159], v[236:239]
v_or_b32 v134, v0, v1
v_pk_mul_f16 v25, v24, v25
v_cvt_pkrtz_f16_f32 v27, v26, v27
v_and_b32_e64 v27, s49, v27
v_bfe_u32 v26, v27, 2, 14
v_lshrrev_b32 v27, 18, v27
v_pk_mul_f16 v6, v40, v41
ds_read_b128 v[124:127], v251 offset:29696
ds_read_u16 v26, v26
s_waitcnt lgkmcnt(7)
ds_read_u16_d16_hi v27, v27
v_mfma_f32_16x16x32_bf16 v[168:171], v[184:187], v[108:111], v[168:171]
buffer_load_dwordx4 v[152:155], v253, s[4:7], s69 offen offset:192
v_exp_f16_sdwa v25, v25 dst_sel:WORD_0 dst_unused:UNUSED_PRESERVE src0_sel:WORD_0
v_mfma_f32_16x16x32_f16 v[180:183], v[176:179], v[112:115], v[180:183]
v_or_b32_e64 v142, v172, v173
v_cvt_pkrtz_f16_f32 v59, v58, v59
v_and_b32_e64 v59, s49, v59
v_bfe_u32 v58, v59, 2, 14
v_lshrrev_b32_e64 v59, 18, v59
v_mfma_f32_16x16x32_bf16 v[32:35], v[184:187], v[192:195], v[32:35]
ds_read_u16 v58, v58
ds_read_u16_d16_hi v59, v59
v_mfma_f32_16x16x32_f16 v[196:199], v[176:179], v[228:231], v[196:199]
ds_read_b128 v[184:187], v248 offset:34816
v_or_b32_e64 v7, v42, v43
v_cvt_pkrtz_f16_f32 v63, v62, v63
v_and_b32_e64 v63, s49, v63
v_bfe_u32 v62, v63, 2, 14
v_lshrrev_b32_e64 v63, 18, v63
v_mfma_f32_16x16x32_bf16 v[244:247], v[188:191], v[44:47], v[244:247]
ds_read_u16 v62, v62
ds_read_u16_d16_hi v63, v63
v_mfma_f32_16x16x32_f16 v[92:95], v[176:179], v[156:159], v[92:95]
v_exp_f16_sdwa v25, v25 dst_sel:WORD_1 dst_unused:UNUSED_PRESERVE src0_sel:WORD_1
v_or_b32_e64 v135, v2, v3
v_mfma_f32_16x16x32_bf16 v[168:171], v[188:191], v[144:147], v[168:171]
ds_read_b128 v[176:179], v251 offset:27648
v_or_b32_e64 v143, v174, v175
v_mfma_f32_16x16x32_f16 v[216:219], v[160:163], v[112:115], v[216:219]
v_pk_add_f16 v25, v25, 1.0 op_sel_hi:[1,0]
v_cvt_pk_f16_f32 v244, v244, v245
v_mfma_f32_16x16x32_bf16 v[32:35], v[188:191], v[148:151], v[32:35]
ds_read_b128 v[188:191], v248 offset:30976
v_rcp_f16_sdwa v25, v25 dst_sel:WORD_0 dst_unused:UNUSED_PRESERVE src0_sel:WORD_0
v_mfma_f32_16x16x32_f16 v[232:235], v[160:163], v[228:231], v[232:235]
s_setprio 2
v_cvt_pkrtz_f16_f32 v169, v168, v169
v_and_b32 v169, s49, v169
v_mfma_f32_16x16x32_bf16 v[80:83], v[52:55], v[28:31], 0
v_bfe_u32 v168, v169, 2, 14
v_lshrrev_b32 v169, 18, v169
v_mfma_f32_16x16x32_f16 v[224:227], v[160:163], v[156:159], v[224:227]
s_waitcnt lgkmcnt(4)
ds_read_b128 v[160:163], v251 offset:30720
ds_read_u16 v168, v168
v_mfma_f32_16x16x32_bf16 v[88:91], v[52:55], v[128:131], 0
ds_read_u16_d16_hi v169, v169
v_rcp_f16_sdwa v25, v25 dst_sel:WORD_1 dst_unused:UNUSED_PRESERVE src0_sel:WORD_1
v_mfma_f32_16x16x32_f16 v[116:119], v[48:51], v[140:143], v[116:119]
v_pk_fma_f16 v245, v244, v244, s48
v_cvt_pkrtz_f16_f32 v33, v32, v33
v_mfma_f32_16x16x32_bf16 v[64:67], v[52:55], v[136:139], 0
ds_read_b128 v[52:55], v248 offset:33024
v_and_b32_e64 v33, s49, v33
v_mfma_f32_16x16x32_f16 v[240:243], v[48:51], v[132:135], v[240:243]
v_bfe_u32 v32, v33, 2, 14
v_lshrrev_b32_e64 v33, 18, v33
v_mfma_f32_16x16x32_bf16 v[80:83], v[120:123], v[36:39], v[80:83]
ds_read_u16 v32, v32
ds_read_u16_d16_hi v33, v33
v_mfma_f32_16x16x32_f16 v[76:79], v[48:51], v[4:7], v[76:79]
v_or_b32_e64 v56, v56, v57
v_pk_mul_f16 v245, v244, v245
v_cvt_pkrtz_f16_f32 v247, v246, v247
v_and_b32_e64 v247, s49, v247
v_bfe_u32 v246, v247, 2, 14
v_lshrrev_b32_e64 v247, 18, v247
v_pk_mul_f16 v24, v24, v25
ds_read_b128 v[48:51], v251 offset:28672
ds_read_u16 v246, v246
ds_read_u16_d16_hi v247, v247
v_mfma_f32_16x16x32_bf16 v[88:91], v[120:123], v[108:111], v[88:91]
v_exp_f16_sdwa v245, v245 dst_sel:WORD_0 dst_unused:UNUSED_PRESERVE src0_sel:WORD_0
v_mfma_f32_16x16x32_f16 v[72:75], v[124:127], v[140:143], v[72:75]
v_or_b32_e64 v60, v60, v61
v_cvt_pkrtz_f16_f32 v171, v170, v171
v_and_b32_e64 v171, s49, v171
v_bfe_u32 v170, v171, 2, 14
v_lshrrev_b32_e64 v171, 18, v171
v_mfma_f32_16x16x32_bf16 v[64:67], v[120:123], v[192:195], v[64:67]
ds_read_u16 v170, v170
ds_read_u16_d16_hi v171, v171
v_mfma_f32_16x16x32_f16 v[8:11], v[124:127], v[132:135], v[8:11]
s_waitcnt lgkmcnt(6)
ds_read_b128 v[120:123], v248 offset:35072
v_or_b32_e64 v25, v26, v27
s_setprio 1
buffer_store_dwordx4 v[164:167], v253, s[8:11], s69 offen sc1
buffer_store_dwordx4 v[100:103], v253, s[8:11], s69 offen offset:64 sc1
v_cvt_pkrtz_f16_f32 v35, v34, v35
v_and_b32_e64 v35, s49, v35
v_bfe_u32 v34, v35, 2, 14
v_lshrrev_b32_e64 v35, 18, v35
v_mfma_f32_16x16x32_bf16 v[80:83], v[184:187], v[44:47], v[80:83]
ds_read_u16 v34, v34
ds_read_u16_d16_hi v35, v35
v_mfma_f32_16x16x32_f16 v[220:223], v[124:127], v[4:7], v[220:223]
v_exp_f16_sdwa v245, v245 dst_sel:WORD_1 dst_unused:UNUSED_PRESERVE src0_sel:WORD_1
v_or_b32_e64 v57, v58, v59
v_mfma_f32_16x16x32_bf16 v[88:91], v[184:187], v[144:147], v[88:91]
ds_read_b128 v[124:127], v251 offset:31744
v_or_b32_e64 v61, v62, v63
v_mfma_f32_16x16x32_f16 v[12:15], v[176:179], v[140:143], v[12:15]
v_pk_add_f16 v245, v245, 1.0 op_sel_hi:[1,0]
v_cvt_pk_f16_f32 v80, v80, v81
v_mfma_f32_16x16x32_bf16 v[64:67], v[184:187], v[148:151], v[64:67]
ds_read_b128 v[184:187], v249
v_rcp_f16_sdwa v245, v245 dst_sel:WORD_0 dst_unused:UNUSED_PRESERVE src0_sel:WORD_0
v_mfma_f32_16x16x32_f16 v[96:99], v[176:179], v[132:135], v[96:99]
v_cvt_pkrtz_f16_f32 v89, v88, v89
v_and_b32_e64 v89, s49, v89
v_mfma_f32_16x16x32_bf16 v[68:71], v[188:191], v[28:31], 0
v_bfe_u32 v88, v89, 2, 14
v_lshrrev_b32_e64 v89, 18, v89
v_mfma_f32_16x16x32_f16 v[84:87], v[176:179], v[4:7], v[84:87]
ds_read_b128 v[176:179], v251 offset:32768
ds_read_u16 v88, v88
v_mfma_f32_16x16x32_bf16 v[104:107], v[188:191], v[128:131], 0
ds_read_u16_d16_hi v89, v89
v_rcp_f16_sdwa v245, v245 dst_sel:WORD_1 dst_unused:UNUSED_PRESERVE src0_sel:WORD_1
v_mfma_f32_16x16x32_f16 v[208:211], v[160:163], v[140:143], v[208:211]
v_pk_fma_f16 v81, v80, v80, s48
v_cvt_pkrtz_f16_f32 v65, v64, v65
v_mfma_f32_16x16x32_bf16 v[204:207], v[188:191], v[136:139], 0
ds_read_b128 v[188:191], v249 offset:2048
v_and_b32 v65, s49, v65
v_mfma_f32_16x16x32_f16 v[212:215], v[160:163], v[132:135], v[212:215]
s_setprio 0
v_bfe_u32 v64, v65, 2, 14
v_lshrrev_b32 v65, 18, v65
v_mfma_f32_16x16x32_bf16 v[68:71], v[52:55], v[36:39], v[68:71]
s_waitcnt lgkmcnt(4)
ds_read_u16 v64, v64
ds_read_u16_d16_hi v65, v65
v_mfma_f32_16x16x32_f16 v[236:239], v[160:163], v[4:7], v[236:239]
v_or_b32_e64 v58, v168, v169
v_pk_mul_f16 v81, v80, v81
v_cvt_pkrtz_f16_f32 v83, v82, v83
v_and_b32_e64 v83, s49, v83
v_bfe_u32 v82, v83, 2, 14
v_lshrrev_b32_e64 v83, 18, v83
v_pk_mul_f16 v26, v244, v245
ds_read_b128 v[160:163], v251 offset:35840
ds_read_u16 v82, v82
ds_read_u16_d16_hi v83, v83
v_mfma_f32_16x16x32_bf16 v[104:107], v[52:55], v[108:111], v[104:107]
buffer_load_dwordx4 v[40:43], v253, s[4:7], s69 offen offset:256
buffer_load_dwordx4 v[0:3], v253, s[4:7], s69 offen offset:320
v_exp_f16_sdwa v81, v81 dst_sel:WORD_0 dst_unused:UNUSED_PRESERVE src0_sel:WORD_0
v_mfma_f32_16x16x32_f16 v[180:183], v[48:51], v[140:143], v[180:183]
v_or_b32_e64 v62, v32, v33
v_cvt_pkrtz_f16_f32 v91, v90, v91
v_and_b32_e64 v91, s49, v91
v_bfe_u32 v90, v91, 2, 14
v_lshrrev_b32_e64 v91, 18, v91
v_mfma_f32_16x16x32_bf16 v[204:207], v[52:55], v[192:195], v[204:207]
ds_read_u16 v90, v90
ds_read_u16_d16_hi v91, v91
v_mfma_f32_16x16x32_f16 v[196:199], v[48:51], v[132:135], v[196:199]
ds_read_b128 v[52:55], v249 offset:4096
v_or_b32_e64 v27, v246, v247
v_cvt_pkrtz_f16_f32 v67, v66, v67
v_and_b32_e64 v67, s49, v67
v_bfe_u32 v66, v67, 2, 14
v_lshrrev_b32_e64 v67, 18, v67
v_mfma_f32_16x16x32_bf16 v[68:71], v[120:123], v[44:47], v[68:71]
ds_read_u16 v66, v66
ds_read_u16_d16_hi v67, v67
v_mfma_f32_16x16x32_f16 v[92:95], v[48:51], v[4:7], v[92:95]
v_exp_f16_sdwa v81, v81 dst_sel:WORD_1 dst_unused:UNUSED_PRESERVE src0_sel:WORD_1
v_or_b32_e64 v59, v170, v171
v_mfma_f32_16x16x32_bf16 v[104:107], v[120:123], v[144:147], v[104:107]
ds_read_b128 v[48:51], v251 offset:33792
v_or_b32_e64 v63, v34, v35
v_mfma_f32_16x16x32_f16 v[216:219], v[124:127], v[140:143], v[216:219]
v_pk_add_f16 v81, v81, 1.0 op_sel_hi:[1,0]
v_cvt_pk_f16_f32 v68, v68, v69
v_mfma_f32_16x16x32_bf16 v[204:207], v[120:123], v[148:151], v[204:207]
s_waitcnt lgkmcnt(6)
ds_read_b128 v[120:123], v249 offset:256
v_rcp_f16_sdwa v81, v81 dst_sel:WORD_0 dst_unused:UNUSED_PRESERVE src0_sel:WORD_0
v_mfma_f32_16x16x32_f16 v[232:235], v[124:127], v[132:135], v[232:235]
s_setprio 3
v_cvt_pkrtz_f16_f32 v105, v104, v105
v_and_b32_e64 v105, s49, v105
v_mfma_f32_16x16x32_bf16 v[172:175], v[184:187], v[28:31], 0
v_bfe_u32 v104, v105, 2, 14
v_lshrrev_b32_e64 v105, 18, v105
v_mfma_f32_16x16x32_f16 v[224:227], v[124:127], v[4:7], v[224:227]
ds_read_b128 v[124:127], v251 offset:36864
ds_read_u16 v104, v104
v_mfma_f32_16x16x32_bf16 v[156:159], v[184:187], v[128:131], 0
ds_read_u16_d16_hi v105, v105
v_rcp_f16_sdwa v81, v81 dst_sel:WORD_1 dst_unused:UNUSED_PRESERVE src0_sel:WORD_1
v_mfma_f32_16x16x32_f16 v[116:119], v[176:179], v[60:63], v[116:119]
v_pk_fma_f16 v69, v68, v68, s48
v_cvt_pkrtz_f16_f32 v205, v204, v205
v_mfma_f32_16x16x32_bf16 v[228:231], v[184:187], v[136:139], 0
ds_read_b128 v[184:187], v249 offset:2304
v_and_b32_e64 v205, s49, v205
v_mfma_f32_16x16x32_f16 v[240:243], v[176:179], v[56:59], v[240:243]
v_bfe_u32 v204, v205, 2, 14
v_lshrrev_b32_e64 v205, 18, v205
v_mfma_f32_16x16x32_bf16 v[172:175], v[188:191], v[36:39], v[172:175]
ds_read_u16 v204, v204
ds_read_u16_d16_hi v205, v205
v_mfma_f32_16x16x32_f16 v[76:79], v[176:179], v[24:27], v[76:79]
v_or_b32_e64 v88, v88, v89
v_pk_mul_f16 v69, v68, v69
v_cvt_pkrtz_f16_f32 v71, v70, v71
v_and_b32_e64 v71, s49, v71
v_bfe_u32 v70, v71, 2, 14
v_lshrrev_b32 v71, 18, v71
v_pk_mul_f16 v80, v80, v81
ds_read_b128 v[176:179], v251 offset:34816
ds_read_u16 v70, v70
s_waitcnt lgkmcnt(7)
ds_read_u16_d16_hi v71, v71
v_mfma_f32_16x16x32_bf16 v[156:159], v[188:191], v[108:111], v[156:159]
v_exp_f16_sdwa v69, v69 dst_sel:WORD_0 dst_unused:UNUSED_PRESERVE src0_sel:WORD_0
v_mfma_f32_16x16x32_f16 v[72:75], v[160:163], v[60:63], v[72:75]
v_or_b32_e64 v64, v64, v65
v_cvt_pkrtz_f16_f32 v107, v106, v107
v_and_b32_e64 v107, s49, v107
v_bfe_u32 v106, v107, 2, 14
v_lshrrev_b32_e64 v107, 18, v107
v_mfma_f32_16x16x32_bf16 v[228:231], v[188:191], v[192:195], v[228:231]
ds_read_u16 v106, v106
ds_read_u16_d16_hi v107, v107
v_mfma_f32_16x16x32_f16 v[8:11], v[160:163], v[56:59], v[8:11]
s_setprio 2
ds_read_b128 v[188:191], v249 offset:4352
v_or_b32 v81, v82, v83
v_cvt_pkrtz_f16_f32 v207, v206, v207
v_and_b32_e64 v207, s49, v207
v_bfe_u32 v206, v207, 2, 14
v_lshrrev_b32_e64 v207, 18, v207
v_mfma_f32_16x16x32_bf16 v[172:175], v[52:55], v[44:47], v[172:175]
ds_read_u16 v206, v206
ds_read_u16_d16_hi v207, v207
v_mfma_f32_16x16x32_f16 v[220:223], v[160:163], v[24:27], v[220:223]
v_exp_f16_sdwa v69, v69 dst_sel:WORD_1 dst_unused:UNUSED_PRESERVE src0_sel:WORD_1
v_or_b32_e64 v89, v90, v91
v_mfma_f32_16x16x32_bf16 v[156:159], v[52:55], v[144:147], v[156:159]
ds_read_b128 v[160:163], v251 offset:37888
buffer_store_dwordx4 v[200:203], v253, s[8:11], s69 offen offset:128 sc1
v_or_b32_e64 v65, v66, v67
v_mfma_f32_16x16x32_f16 v[12:15], v[48:51], v[60:63], v[12:15]
v_pk_add_f16 v69, v69, 1.0 op_sel_hi:[1,0]
v_cvt_pk_f16_f32 v172, v172, v173
v_mfma_f32_16x16x32_bf16 v[228:231], v[52:55], v[148:151], v[228:231]
ds_read_b128 v[52:55], v249 offset:6144
v_rcp_f16_sdwa v69, v69 dst_sel:WORD_0 dst_unused:UNUSED_PRESERVE src0_sel:WORD_0
v_mfma_f32_16x16x32_f16 v[96:99], v[48:51], v[56:59], v[96:99]
v_cvt_pkrtz_f16_f32 v157, v156, v157
v_and_b32_e64 v157, s49, v157
v_mfma_f32_16x16x32_bf16 v[112:115], v[120:123], v[28:31], 0
v_bfe_u32 v156, v157, 2, 14
v_lshrrev_b32 v157, 18, v157
v_mfma_f32_16x16x32_f16 v[84:87], v[48:51], v[24:27], v[84:87]
s_waitcnt lgkmcnt(4)
ds_read_b128 v[48:51], v251 offset:38912
ds_read_u16 v156, v156
v_mfma_f32_16x16x32_bf16 v[164:167], v[120:123], v[128:131], 0
ds_read_u16_d16_hi v157, v157
v_rcp_f16_sdwa v69, v69 dst_sel:WORD_1 dst_unused:UNUSED_PRESERVE src0_sel:WORD_1
v_mfma_f32_16x16x32_f16 v[208:211], v[124:127], v[60:63], v[208:211]
v_pk_fma_f16 v173, v172, v172, s48
v_cvt_pkrtz_f16_f32 v229, v228, v229
v_mfma_f32_16x16x32_bf16 v[100:103], v[120:123], v[136:139], 0
s_setprio 1
ds_read_b128 v[120:123], v249 offset:8192
v_and_b32 v229, s49, v229
v_mfma_f32_16x16x32_f16 v[212:215], v[124:127], v[56:59], v[212:215]
v_bfe_u32 v228, v229, 2, 14
v_lshrrev_b32_e64 v229, 18, v229
v_mfma_f32_16x16x32_bf16 v[112:115], v[184:187], v[36:39], v[112:115]
ds_read_u16 v228, v228
ds_read_u16_d16_hi v229, v229
v_mfma_f32_16x16x32_f16 v[236:239], v[124:127], v[24:27], v[236:239]
v_or_b32_e64 v90, v104, v105
v_pk_mul_f16 v173, v172, v173
v_cvt_pkrtz_f16_f32 v175, v174, v175
v_and_b32_e64 v175, s49, v175
v_bfe_u32 v174, v175, 2, 14
v_lshrrev_b32_e64 v175, 18, v175
v_pk_mul_f16 v82, v68, v69
ds_read_b128 v[124:127], v251 offset:41984
ds_read_u16 v174, v174
ds_read_u16_d16_hi v175, v175
v_mfma_f32_16x16x32_bf16 v[164:167], v[184:187], v[108:111], v[164:167]
buffer_load_dwordx4 v[244:247], v253, s[4:7], s68 offen
buffer_load_dwordx4 v[168:171], v253, s[4:7], s68 offen offset:64
v_exp_f16_sdwa v173, v173 dst_sel:WORD_0 dst_unused:UNUSED_PRESERVE src0_sel:WORD_0
v_mfma_f32_16x16x32_f16 v[180:183], v[176:179], v[60:63], v[180:183]
v_or_b32_e64 v66, v204, v205
v_cvt_pkrtz_f16_f32 v159, v158, v159
v_and_b32_e64 v159, s49, v159
v_bfe_u32 v158, v159, 2, 14
v_lshrrev_b32_e64 v159, 18, v159
v_mfma_f32_16x16x32_bf16 v[100:103], v[184:187], v[192:195], v[100:103]
ds_read_u16 v158, v158
ds_read_u16_d16_hi v159, v159
v_mfma_f32_16x16x32_f16 v[196:199], v[176:179], v[56:59], v[196:199]
s_waitcnt lgkmcnt(6)
ds_read_b128 v[184:187], v249 offset:10240
v_or_b32 v83, v70, v71
v_cvt_pkrtz_f16_f32 v231, v230, v231
v_and_b32_e64 v231, s49, v231
v_bfe_u32 v230, v231, 2, 14
v_lshrrev_b32_e64 v231, 18, v231
v_mfma_f32_16x16x32_bf16 v[112:115], v[188:191], v[44:47], v[112:115]
ds_read_u16 v230, v230
ds_read_u16_d16_hi v231, v231
v_mfma_f32_16x16x32_f16 v[92:95], v[176:179], v[24:27], v[92:95]
v_exp_f16_sdwa v173, v173 dst_sel:WORD_1 dst_unused:UNUSED_PRESERVE src0_sel:WORD_1
v_or_b32_e64 v91, v106, v107
v_mfma_f32_16x16x32_bf16 v[164:167], v[188:191], v[144:147], v[164:167]
ds_read_b128 v[176:179], v251 offset:39936
v_or_b32_e64 v67, v206, v207
v_mfma_f32_16x16x32_f16 v[216:219], v[160:163], v[60:63], v[216:219]
v_pk_add_f16 v173, v173, 1.0 op_sel_hi:[1,0]
v_cvt_pkrtz_f16_f32 v113, v112, v113
v_mfma_f32_16x16x32_bf16 v[100:103], v[188:191], v[148:151], v[100:103]
s_setprio 0
ds_read_b128 v[188:191], v249 offset:6400
v_rcp_f16_sdwa v173, v173 dst_sel:WORD_0 dst_unused:UNUSED_PRESERVE src0_sel:WORD_0
v_mfma_f32_16x16x32_f16 v[232:235], v[160:163], v[56:59], v[232:235]
v_and_b32 v113, s49, v113
v_bfe_u32 v112, v113, 2, 14
v_mfma_f32_16x16x32_bf16 v[32:35], v[52:55], v[28:31], 0
v_lshrrev_b32_e64 v113, 18, v113
v_rcp_f16_sdwa v173, v173 dst_sel:WORD_1 dst_unused:UNUSED_PRESERVE src0_sel:WORD_1
v_mfma_f32_16x16x32_f16 v[224:227], v[160:163], v[24:27], v[224:227]
ds_read_b128 v[160:163], v251 offset:43008
ds_read_u16 v112, v112
v_mfma_f32_16x16x32_bf16 v[4:7], v[52:55], v[128:131], 0
ds_read_u16_d16_hi v113, v113
v_cvt_pkrtz_f16_f32 v165, v164, v165
v_mfma_f32_16x16x32_f16 v[116:119], v[48:51], v[64:67], v[116:119]
v_and_b32_e64 v165, s49, v165
v_bfe_u32 v164, v165, 2, 14
v_mfma_f32_16x16x32_bf16 v[132:135], v[52:55], v[136:139], 0
ds_read_b128 v[52:55], v249 offset:8448
v_lshrrev_b32 v165, 18, v165
v_mfma_f32_16x16x32_f16 v[240:243], v[48:51], v[88:91], v[240:243]
s_waitcnt lgkmcnt(5)
ds_read_u16 v164, v164
ds_read_u16_d16_hi v165, v165
v_mfma_f32_16x16x32_bf16 v[32:35], v[120:123], v[36:39], v[32:35]
v_cvt_pkrtz_f16_f32 v101, v100, v101
v_and_b32_e64 v101, s49, v101
v_mfma_f32_16x16x32_f16 v[76:79], v[48:51], v[80:83], v[76:79]
v_bfe_u32 v100, v101, 2, 14
v_lshrrev_b32 v101, 18, v101
v_or_b32 v156, v156, v157
v_pk_mul_f16 v172, v172, v173
v_mfma_f32_16x16x32_bf16 v[4:7], v[120:123], v[108:111], v[4:7]
ds_read_u16 v100, v100
ds_read_u16_d16_hi v101, v101
ds_read_b128 v[48:51], v251 offset:40960
v_mfma_f32_16x16x32_f16 v[72:75], v[124:127], v[64:67], v[72:75]
v_cvt_pkrtz_f16_f32 v115, v114, v115
v_and_b32_e64 v115, s49, v115
v_bfe_u32 v114, v115, 2, 14
v_lshrrev_b32 v115, 18, v115
v_or_b32 v228, v228, v229
v_mfma_f32_16x16x32_bf16 v[132:135], v[120:123], v[192:195], v[132:135]
ds_read_u16 v114, v114
ds_read_u16_d16_hi v115, v115
s_setprio 3
v_cvt_pkrtz_f16_f32 v167, v166, v167
v_and_b32 v167, s49, v167
v_bfe_u32 v166, v167, 2, 14
v_lshrrev_b32_e64 v167, 18, v167
v_mfma_f32_16x16x32_f16 v[8:11], v[124:127], v[88:91], v[8:11]
ds_read_u16 v166, v166
ds_read_u16_d16_hi v167, v167
ds_read_b128 v[120:123], v249 offset:10496
v_or_b32_e64 v173, v174, v175
v_cvt_pkrtz_f16_f32 v103, v102, v103
v_and_b32_e64 v103, s49, v103
v_bfe_u32 v102, v103, 2, 14
v_lshrrev_b32 v103, 18, v103
v_mfma_f32_16x16x32_bf16 v[32:35], v[184:187], v[44:47], v[32:35]
s_waitcnt lgkmcnt(8)
ds_read_u16 v102, v102
ds_read_u16_d16_hi v103, v103
v_mfma_f32_16x16x32_f16 v[220:223], v[124:127], v[80:83], v[220:223]
v_or_b32 v157, v158, v159
v_or_b32 v229, v230, v231
v_mfma_f32_16x16x32_bf16 v[4:7], v[184:187], v[144:147], v[4:7]
ds_read_b128 v[124:127], v251 offset:44032
v_cvt_pk_f16_f32 v32, v32, v33
v_mfma_f32_16x16x32_f16 v[12:15], v[176:179], v[64:67], v[12:15]
v_pk_fma_f16 v33, v32, v32, s48
v_or_b32 v174, v112, v113
v_mfma_f32_16x16x32_bf16 v[132:135], v[184:187], v[148:151], v[132:135]
ds_read_b128 v[184:187], v249 offset:12288
s_nop 0
v_cvt_pkrtz_f16_f32 v5, v4, v5
v_mfma_f32_16x16x32_f16 v[96:99], v[176:179], v[88:91], v[96:99]
v_and_b32_e64 v5, s49, v5
v_bfe_u32 v4, v5, 2, 14
v_mfma_f32_16x16x32_bf16 v[140:143], v[188:191], v[28:31], 0
v_lshrrev_b32_e64 v5, 18, v5
v_cvt_pkrtz_f16_f32 v133, v132, v133
v_mfma_f32_16x16x32_f16 v[84:87], v[176:179], v[80:83], v[84:87]
ds_read_b128 v[176:179], v251 offset:45056
ds_read_u16 v4, v4
v_mfma_f32_16x16x32_bf16 v[200:203], v[188:191], v[128:131], 0
ds_read_u16_d16_hi v5, v5
v_and_b32 v133, s49, v133
v_mfma_f32_16x16x32_f16 v[208:211], v[160:163], v[64:67], v[208:211]
s_setprio 2
v_bfe_u32 v132, v133, 2, 14
v_lshrrev_b32 v133, 18, v133
v_mfma_f32_16x16x32_bf16 v[68:71], v[188:191], v[136:139], 0
s_waitcnt lgkmcnt(7)
ds_read_b128 v[188:191], v249 offset:14336
ds_read_u16 v132, v132
v_mfma_f32_16x16x32_f16 v[212:215], v[160:163], v[88:91], v[212:215]
ds_read_u16_d16_hi v133, v133
v_pk_mul_f16 v33, v32, v33
v_mfma_f32_16x16x32_bf16 v[140:143], v[52:55], v[36:39], v[140:143]
v_cvt_pkrtz_f16_f32 v35, v34, v35
v_and_b32_e64 v35, s49, v35
v_mfma_f32_16x16x32_f16 v[236:239], v[160:163], v[80:83], v[236:239]
ds_read_b128 v[160:163], v251 offset:48128
v_bfe_u32 v34, v35, 2, 14
v_lshrrev_b32_e64 v35, 18, v35
v_mfma_f32_16x16x32_bf16 v[200:203], v[52:55], v[108:111], v[200:203]
ds_read_u16 v34, v34
ds_read_u16_d16_hi v35, v35
buffer_load_dwordx4 v[104:107], v253, s[4:7], s68 offen offset:128
buffer_load_dwordx4 v[204:207], v253, s[4:7], s68 offen offset:192
v_mfma_f32_16x16x32_f16 v[180:183], v[48:51], v[64:67], v[180:183]
v_or_b32_e64 v158, v164, v165
v_exp_f16_sdwa v33, v33 dst_sel:WORD_0 dst_unused:UNUSED_PRESERVE src0_sel:WORD_0
v_cvt_pkrtz_f16_f32 v7, v6, v7
v_and_b32_e64 v7, s49, v7
v_bfe_u32 v6, v7, 2, 14
v_lshrrev_b32_e64 v7, 18, v7
v_mfma_f32_16x16x32_bf16 v[68:71], v[52:55], v[192:195], v[68:71]
ds_read_u16 v6, v6
ds_read_u16_d16_hi v7, v7
v_mfma_f32_16x16x32_f16 v[196:199], v[48:51], v[88:91], v[196:199]
v_or_b32_e64 v230, v100, v101
v_cvt_pkrtz_f16_f32 v135, v134, v135
v_and_b32_e64 v135, s49, v135
v_bfe_u32 v134, v135, 2, 14
v_lshrrev_b32 v135, 18, v135
v_mfma_f32_16x16x32_bf16 v[140:143], v[120:123], v[44:47], v[140:143]
s_waitcnt lgkmcnt(7)
ds_read_b128 v[52:55], v249 offset:16384
ds_read_u16 v134, v134
ds_read_u16_d16_hi v135, v135
v_or_b32_e64 v175, v114, v115
v_mfma_f32_16x16x32_f16 v[92:95], v[48:51], v[80:83], v[92:95]
v_exp_f16_sdwa v33, v33 dst_sel:WORD_1 dst_unused:UNUSED_PRESERVE src0_sel:WORD_1
v_or_b32_e64 v159, v166, v167
v_mfma_f32_16x16x32_bf16 v[200:203], v[120:123], v[144:147], v[200:203]
ds_read_b128 v[48:51], v251 offset:46080
v_or_b32 v231, v102, v103
v_mfma_f32_16x16x32_f16 v[216:219], v[124:127], v[64:67], v[216:219]
s_setprio 1
v_pk_add_f16 v33, v33, 1.0 op_sel_hi:[1,0]
v_cvt_pk_f16_f32 v140, v140, v141
v_mfma_f32_16x16x32_bf16 v[68:71], v[120:123], v[148:151], v[68:71]
ds_read_b128 v[120:123], v249 offset:12544
v_rcp_f16_sdwa v33, v33 dst_sel:WORD_0 dst_unused:UNUSED_PRESERVE src0_sel:WORD_0
v_mfma_f32_16x16x32_f16 v[232:235], v[124:127], v[88:91], v[232:235]
v_cvt_pkrtz_f16_f32 v201, v200, v201
v_and_b32_e64 v201, s49, v201
v_mfma_f32_16x16x32_bf16 v[24:27], v[184:187], v[28:31], 0
v_bfe_u32 v200, v201, 2, 14
v_lshrrev_b32_e64 v201, 18, v201
v_mfma_f32_16x16x32_f16 v[224:227], v[124:127], v[80:83], v[224:227]
ds_read_b128 v[124:127], v251 offset:49152
ds_read_u16 v200, v200
v_mfma_f32_16x16x32_bf16 v[56:59], v[184:187], v[128:131], 0
ds_read_u16_d16_hi v201, v201
v_rcp_f16_sdwa v33, v33 dst_sel:WORD_1 dst_unused:UNUSED_PRESERVE src0_sel:WORD_1
v_mfma_f32_16x16x32_f16 v[116:119], v[176:179], v[228:231], v[116:119]
v_pk_fma_f16 v141, v140, v140, s48
v_cvt_pkrtz_f16_f32 v69, v68, v69
v_mfma_f32_16x16x32_bf16 v[60:63], v[184:187], v[136:139], 0
s_waitcnt lgkmcnt(6)
ds_read_b128 v[184:187], v249 offset:14592
v_and_b32 v69, s49, v69
v_mfma_f32_16x16x32_f16 v[240:243], v[176:179], v[156:159], v[240:243]
v_bfe_u32 v68, v69, 2, 14
v_lshrrev_b32_e64 v69, 18, v69
v_mfma_f32_16x16x32_bf16 v[24:27], v[188:191], v[36:39], v[24:27]
ds_read_u16 v68, v68
ds_read_u16_d16_hi v69, v69
v_mfma_f32_16x16x32_f16 v[76:79], v[176:179], v[172:175], v[76:79]
v_or_b32_e64 v4, v4, v5
v_pk_mul_f16 v141, v140, v141
v_cvt_pkrtz_f16_f32 v143, v142, v143
v_and_b32_e64 v143, s49, v143
v_bfe_u32 v142, v143, 2, 14
v_lshrrev_b32_e64 v143, 18, v143
v_pk_mul_f16 v32, v32, v33
ds_read_b128 v[176:179], v251 offset:47104
ds_read_u16 v142, v142
ds_read_u16_d16_hi v143, v143
v_mfma_f32_16x16x32_bf16 v[56:59], v[188:191], v[108:111], v[56:59]
v_exp_f16_sdwa v141, v141 dst_sel:WORD_0 dst_unused:UNUSED_PRESERVE src0_sel:WORD_0
v_mfma_f32_16x16x32_f16 v[72:75], v[160:163], v[228:231], v[72:75]
s_setprio 0
v_or_b32 v132, v132, v133
v_cvt_pkrtz_f16_f32 v203, v202, v203
v_and_b32_e64 v203, s49, v203
v_bfe_u32 v202, v203, 2, 14
v_lshrrev_b32_e64 v203, 18, v203
v_mfma_f32_16x16x32_bf16 v[60:63], v[188:191], v[192:195], v[60:63]
ds_read_u16 v202, v202
ds_read_u16_d16_hi v203, v203
v_mfma_f32_16x16x32_f16 v[8:11], v[160:163], v[156:159], v[8:11]
ds_read_b128 v[188:191], v249 offset:16640
v_or_b32_e64 v33, v34, v35
v_cvt_pkrtz_f16_f32 v71, v70, v71
v_and_b32_e64 v71, s49, v71
v_bfe_u32 v70, v71, 2, 14
v_lshrrev_b32 v71, 18, v71
v_mfma_f32_16x16x32_bf16 v[24:27], v[52:55], v[44:47], v[24:27]
s_waitcnt lgkmcnt(6)
ds_read_u16 v70, v70
ds_read_u16_d16_hi v71, v71
v_mfma_f32_16x16x32_f16 v[220:223], v[160:163], v[172:175], v[220:223]
v_exp_f16_sdwa v141, v141 dst_sel:WORD_1 dst_unused:UNUSED_PRESERVE src0_sel:WORD_1
v_or_b32_e64 v5, v6, v7
v_mfma_f32_16x16x32_bf16 v[56:59], v[52:55], v[144:147], v[56:59]
ds_read_b128 v[160:163], v251 offset:50176
v_or_b32_e64 v133, v134, v135
v_mfma_f32_16x16x32_f16 v[12:15], v[48:51], v[228:231], v[12:15]
v_pk_add_f16 v141, v141, 1.0 op_sel_hi:[1,0]
v_cvt_pk_f16_f32 v24, v24, v25
v_mfma_f32_16x16x32_bf16 v[60:63], v[52:55], v[148:151], v[60:63]
ds_read_b128 v[52:55], v249 offset:18432
v_rcp_f16_sdwa v141, v141 dst_sel:WORD_0 dst_unused:UNUSED_PRESERVE src0_sel:WORD_0
v_mfma_f32_16x16x32_f16 v[96:99], v[48:51], v[156:159], v[96:99]
v_cvt_pkrtz_f16_f32 v57, v56, v57
v_and_b32_e64 v57, s49, v57
v_mfma_f32_16x16x32_bf16 v[112:115], v[120:123], v[28:31], 0
v_bfe_u32 v56, v57, 2, 14
v_lshrrev_b32_e64 v57, 18, v57
v_mfma_f32_16x16x32_f16 v[84:87], v[48:51], v[172:175], v[84:87]
ds_read_b128 v[48:51], v251 offset:51200
ds_read_u16 v56, v56
v_mfma_f32_16x16x32_bf16 v[164:167], v[120:123], v[128:131], 0
ds_read_u16_d16_hi v57, v57
v_rcp_f16_sdwa v141, v141 dst_sel:WORD_1 dst_unused:UNUSED_PRESERVE src0_sel:WORD_1
v_mfma_f32_16x16x32_f16 v[208:211], v[124:127], v[228:231], v[208:211]
s_setprio 3
v_pk_fma_f16 v25, v24, v24, s48
v_cvt_pkrtz_f16_f32 v61, v60, v61
v_mfma_f32_16x16x32_bf16 v[100:103], v[120:123], v[136:139], 0
ds_read_b128 v[120:123], v249 offset:20480
v_and_b32 v61, s49, v61
v_mfma_f32_16x16x32_f16 v[212:215], v[124:127], v[156:159], v[212:215]
v_bfe_u32 v60, v61, 2, 14
v_lshrrev_b32 v61, 18, v61
v_mfma_f32_16x16x32_bf16 v[112:115], v[184:187], v[36:39], v[112:115]
ds_read_u16 v60, v60
s_waitcnt lgkmcnt(5)
ds_read_u16_d16_hi v61, v61
v_mfma_f32_16x16x32_f16 v[236:239], v[124:127], v[172:175], v[236:239]
v_or_b32_e64 v6, v200, v201
v_pk_mul_f16 v25, v24, v25
v_cvt_pkrtz_f16_f32 v27, v26, v27
v_and_b32_e64 v27, s49, v27
v_bfe_u32 v26, v27, 2, 14
v_lshrrev_b32_e64 v27, 18, v27
v_pk_mul_f16 v34, v140, v141
ds_read_b128 v[124:127], v251 offset:54272
ds_read_u16 v26, v26
ds_read_u16_d16_hi v27, v27
v_mfma_f32_16x16x32_bf16 v[164:167], v[184:187], v[108:111], v[164:167]
buffer_load_dwordx4 v[80:83], v253, s[4:7], s68 offen offset:256
buffer_load_dwordx4 v[88:91], v253, s[4:7], s68 offen offset:320
v_exp_f16_sdwa v25, v25 dst_sel:WORD_0 dst_unused:UNUSED_PRESERVE src0_sel:WORD_0
v_mfma_f32_16x16x32_f16 v[180:183], v[176:179], v[228:231], v[180:183]
v_or_b32_e64 v134, v68, v69
v_cvt_pkrtz_f16_f32 v59, v58, v59
v_and_b32_e64 v59, s49, v59
v_bfe_u32 v58, v59, 2, 14
v_lshrrev_b32_e64 v59, 18, v59
v_mfma_f32_16x16x32_bf16 v[100:103], v[184:187], v[192:195], v[100:103]
ds_read_u16 v58, v58
ds_read_u16_d16_hi v59, v59
v_mfma_f32_16x16x32_f16 v[196:199], v[176:179], v[156:159], v[196:199]
ds_read_b128 v[184:187], v249 offset:22528
v_or_b32_e64 v35, v142, v143
v_cvt_pkrtz_f16_f32 v63, v62, v63
v_and_b32_e64 v63, s49, v63
v_bfe_u32 v62, v63, 2, 14
v_lshrrev_b32_e64 v63, 18, v63
v_mfma_f32_16x16x32_bf16 v[112:115], v[188:191], v[44:47], v[112:115]
ds_read_u16 v62, v62
ds_read_u16_d16_hi v63, v63
v_mfma_f32_16x16x32_f16 v[92:95], v[176:179], v[172:175], v[92:95]
v_exp_f16_sdwa v25, v25 dst_sel:WORD_1 dst_unused:UNUSED_PRESERVE src0_sel:WORD_1
v_or_b32_e64 v7, v202, v203
v_mfma_f32_16x16x32_bf16 v[164:167], v[188:191], v[144:147], v[164:167]
ds_read_b128 v[176:179], v251 offset:52224
v_or_b32_e64 v135, v70, v71
v_mfma_f32_16x16x32_f16 v[216:219], v[160:163], v[228:231], v[216:219]
s_setprio 2
v_pk_add_f16 v25, v25, 1.0 op_sel_hi:[1,0]
v_cvt_pk_f16_f32 v112, v112, v113
v_mfma_f32_16x16x32_bf16 v[100:103], v[188:191], v[148:151], v[100:103]
s_waitcnt lgkmcnt(6)
ds_read_b128 v[188:191], v249 offset:18688
v_rcp_f16_sdwa v25, v25 dst_sel:WORD_0 dst_unused:UNUSED_PRESERVE src0_sel:WORD_0
v_mfma_f32_16x16x32_f16 v[232:235], v[160:163], v[156:159], v[232:235]
v_cvt_pkrtz_f16_f32 v165, v164, v165
v_and_b32_e64 v165, s49, v165
v_mfma_f32_16x16x32_bf16 v[64:67], v[52:55], v[28:31], 0
v_bfe_u32 v164, v165, 2, 14
v_lshrrev_b32 v165, 18, v165
v_mfma_f32_16x16x32_f16 v[224:227], v[160:163], v[172:175], v[224:227]
ds_read_b128 v[160:163], v251 offset:55296
ds_read_u16 v164, v164
s_waitcnt vmcnt(11)
v_mfma_f32_16x16x32_bf16 v[76:79], v[18:21], v[152:155], v[76:79]
ds_read_u16_d16_hi v165, v165
v_rcp_f16_sdwa v25, v25 dst_sel:WORD_1 dst_unused:UNUSED_PRESERVE src0_sel:WORD_1
v_mfma_f32_16x16x32_bf16 v[220:223], v[16:19], v[152:155], v[220:223]
v_pk_fma_f16 v113, v112, v112, s48
v_cvt_pkrtz_f16_f32 v101, v100, v101
v_mfma_f32_16x16x32_bf16 v[140:143], v[52:55], v[128:131], 0
v_and_b32_e64 v101, s49, v101
v_bfe_u32 v100, v101, 2, 14
v_mfma_f32_16x16x32_f16 v[116:119], v[48:51], v[132:135], v[116:119]
v_lshrrev_b32 v101, 18, v101
v_or_b32 v56, v56, v57
v_mfma_f32_16x16x32_bf16 v[200:203], v[52:55], v[136:139], 0
ds_read_b128 v[52:55], v249 offset:20736
ds_read_u16 v100, v100
v_mfma_f32_16x16x32_f16 v[240:243], v[48:51], v[4:7], v[240:243]
ds_read_u16_d16_hi v101, v101
v_pk_mul_f16 v113, v112, v113
v_mfma_f32_16x16x32_bf16 v[64:67], v[120:123], v[36:39], v[64:67]
v_cvt_pkrtz_f16_f32 v115, v114, v115
v_and_b32_e64 v115, s49, v115
v_mfma_f32_16x16x32_f16 v[76:79], v[48:51], v[32:35], v[76:79]
ds_read_b128 v[48:51], v251 offset:53248
v_bfe_u32 v114, v115, 2, 14
v_lshrrev_b32_e64 v115, 18, v115
v_pk_mul_f16 v24, v24, v25
v_mfma_f32_16x16x32_bf16 v[140:143], v[120:123], v[108:111], v[140:143]
ds_read_u16 v114, v114
s_waitcnt lgkmcnt(6)
ds_read_u16_d16_hi v115, v115
s_setprio 1
v_mfma_f32_16x16x32_f16 v[72:75], v[124:127], v[132:135], v[72:75]
v_exp_f16_sdwa v113, v113 dst_sel:WORD_0 dst_unused:UNUSED_PRESERVE src0_sel:WORD_0
v_or_b32_e64 v60, v60, v61
v_cvt_pkrtz_f16_f32 v167, v166, v167
v_and_b32_e64 v167, s49, v167
v_bfe_u32 v166, v167, 2, 14
v_lshrrev_b32_e64 v167, 18, v167
v_mfma_f32_16x16x32_bf16 v[200:203], v[120:123], v[192:195], v[200:203]
ds_read_u16 v166, v166
ds_read_u16_d16_hi v167, v167
v_mfma_f32_16x16x32_f16 v[8:11], v[124:127], v[4:7], v[8:11]
ds_read_b128 v[120:123], v249 offset:22784
v_or_b32_e64 v25, v26, v27
v_cvt_pkrtz_f16_f32 v103, v102, v103
v_and_b32_e64 v103, s49, v103
v_bfe_u32 v102, v103, 2, 14
v_lshrrev_b32_e64 v103, 18, v103
v_mfma_f32_16x16x32_bf16 v[64:67], v[184:187], v[44:47], v[64:67]
ds_read_u16 v102, v102
ds_read_u16_d16_hi v103, v103
v_mfma_f32_16x16x32_f16 v[220:223], v[124:127], v[32:35], v[220:223]
v_exp_f16_sdwa v113, v113 dst_sel:WORD_1 dst_unused:UNUSED_PRESERVE src0_sel:WORD_1
v_or_b32_e64 v57, v58, v59
v_mfma_f32_16x16x32_bf16 v[140:143], v[184:187], v[144:147], v[140:143]
ds_read_b128 v[124:127], v251 offset:56320
v_or_b32_e64 v61, v62, v63
v_mfma_f32_16x16x32_f16 v[12:15], v[176:179], v[132:135], v[12:15]
v_pk_add_f16 v113, v113, 1.0 op_sel_hi:[1,0]
v_cvt_pk_f16_f32 v64, v64, v65
v_mfma_f32_16x16x32_bf16 v[200:203], v[184:187], v[148:151], v[200:203]
ds_read_b128 v[184:187], v249 offset:24576
v_rcp_f16_sdwa v113, v113 dst_sel:WORD_0 dst_unused:UNUSED_PRESERVE src0_sel:WORD_0
v_mfma_f32_16x16x32_f16 v[96:99], v[176:179], v[4:7], v[96:99]
v_cvt_pkrtz_f16_f32 v141, v140, v141
v_and_b32_e64 v141, s49, v141
v_mfma_f32_16x16x32_bf16 v[68:71], v[188:191], v[28:31], 0
v_bfe_u32 v140, v141, 2, 14
v_lshrrev_b32_e64 v141, 18, v141
v_mfma_f32_16x16x32_f16 v[84:87], v[176:179], v[32:35], v[84:87]
ds_read_b128 v[176:179], v251 offset:57344
s_waitcnt lgkmcnt(5)
ds_read_u16 v140, v140
v_mfma_f32_16x16x32_bf16 v[172:175], v[188:191], v[128:131], 0
s_setprio 0
ds_read_u16_d16_hi v141, v141
v_rcp_f16_sdwa v113, v113 dst_sel:WORD_1 dst_unused:UNUSED_PRESERVE src0_sel:WORD_1
v_mfma_f32_16x16x32_f16 v[208:211], v[160:163], v[132:135], v[208:211]
v_pk_fma_f16 v65, v64, v64, s48
v_cvt_pkrtz_f16_f32 v201, v200, v201
v_mfma_f32_16x16x32_bf16 v[156:159], v[188:191], v[136:139], 0
ds_read_b128 v[188:191], v249 offset:26624
v_and_b32_e64 v201, s49, v201
v_mfma_f32_16x16x32_f16 v[212:215], v[160:163], v[4:7], v[212:215]
v_bfe_u32 v200, v201, 2, 14
v_lshrrev_b32_e64 v201, 18, v201
v_mfma_f32_16x16x32_bf16 v[68:71], v[52:55], v[36:39], v[68:71]
ds_read_u16 v200, v200
ds_read_u16_d16_hi v201, v201
v_mfma_f32_16x16x32_f16 v[236:239], v[160:163], v[32:35], v[236:239]
v_or_b32_e64 v58, v164, v165
v_pk_mul_f16 v65, v64, v65
v_cvt_pkrtz_f16_f32 v67, v66, v67
v_and_b32_e64 v67, s49, v67
v_bfe_u32 v66, v67, 2, 14
v_lshrrev_b32_e64 v67, 18, v67
v_pk_mul_f16 v26, v112, v113
ds_read_b128 v[160:163], v251 offset:60416
ds_read_u16 v66, v66
ds_read_u16_d16_hi v67, v67
v_mfma_f32_16x16x32_bf16 v[172:175], v[52:55], v[108:111], v[172:175]
v_exp_f16_sdwa v65, v65 dst_sel:WORD_0 dst_unused:UNUSED_PRESERVE src0_sel:WORD_0
v_mfma_f32_16x16x32_f16 v[180:183], v[48:51], v[132:135], v[180:183]
v_or_b32_e64 v62, v100, v101
v_cvt_pkrtz_f16_f32 v143, v142, v143
v_and_b32_e64 v143, s49, v143
v_bfe_u32 v142, v143, 2, 14
v_lshrrev_b32_e64 v143, 18, v143
v_mfma_f32_16x16x32_bf16 v[156:159], v[52:55], v[192:195], v[156:159]
ds_read_u16 v142, v142
ds_read_u16_d16_hi v143, v143
v_mfma_f32_16x16x32_f16 v[196:199], v[48:51], v[4:7], v[196:199]
s_waitcnt lgkmcnt(6)
ds_read_b128 v[52:55], v249 offset:28672
v_or_b32 v27, v114, v115
v_cvt_pkrtz_f16_f32 v203, v202, v203
v_and_b32_e64 v203, s49, v203
v_bfe_u32 v202, v203, 2, 14
v_lshrrev_b32_e64 v203, 18, v203
v_mfma_f32_16x16x32_bf16 v[68:71], v[120:123], v[44:47], v[68:71]
ds_read_u16 v202, v202
ds_read_u16_d16_hi v203, v203
v_mfma_f32_16x16x32_f16 v[92:95], v[48:51], v[32:35], v[92:95]
v_exp_f16_sdwa v65, v65 dst_sel:WORD_1 dst_unused:UNUSED_PRESERVE src0_sel:WORD_1
v_or_b32_e64 v59, v166, v167
v_mfma_f32_16x16x32_bf16 v[172:175], v[120:123], v[144:147], v[172:175]
ds_read_b128 v[48:51], v251 offset:58368
s_setprio 3
v_or_b32 v63, v102, v103
v_mfma_f32_16x16x32_f16 v[216:219], v[124:127], v[132:135], v[216:219]
v_pk_add_f16 v65, v65, 1.0 op_sel_hi:[1,0]
v_cvt_pk_f16_f32 v68, v68, v69
v_mfma_f32_16x16x32_bf16 v[156:159], v[120:123], v[148:151], v[156:159]
ds_read_b128 v[120:123], v249 offset:24832
v_rcp_f16_sdwa v65, v65 dst_sel:WORD_0 dst_unused:UNUSED_PRESERVE src0_sel:WORD_0
v_mfma_f32_16x16x32_f16 v[232:235], v[124:127], v[4:7], v[232:235]
v_cvt_pkrtz_f16_f32 v173, v172, v173
v_and_b32_e64 v173, s49, v173
v_mfma_f32_16x16x32_bf16 v[228:231], v[184:187], v[28:31], 0
v_bfe_u32 v172, v173, 2, 14
v_lshrrev_b32 v173, 18, v173
v_mfma_f32_16x16x32_f16 v[224:227], v[124:127], v[32:35], v[224:227]
ds_read_b128 v[124:127], v251 offset:61440
ds_read_u16 v172, v172
s_waitcnt vmcnt(8)
v_mfma_f32_16x16x32_bf16 v[84:87], v[18:21], v[40:43], v[84:87]
ds_read_u16_d16_hi v173, v173
v_rcp_f16_sdwa v65, v65 dst_sel:WORD_1 dst_unused:UNUSED_PRESERVE src0_sel:WORD_1
v_mfma_f32_16x16x32_bf16 v[236:239], v[16:19], v[40:43], v[236:239]
v_pk_fma_f16 v69, v68, v68, s48
v_cvt_pkrtz_f16_f32 v157, v156, v157
s_waitcnt vmcnt(7)
v_mfma_f32_16x16x32_bf16 v[92:95], v[18:21], v[0:3], v[92:95]
v_and_b32 v157, s49, v157
v_bfe_u32 v156, v157, 2, 14
v_mfma_f32_16x16x32_bf16 v[224:227], v[16:19], v[0:3], v[224:227]
v_lshrrev_b32_e64 v157, 18, v157
v_or_b32 v140, v140, v141
v_mfma_f32_16x16x32_bf16 v[152:155], v[184:187], v[128:131], 0
ds_read_u16 v156, v156
s_waitcnt lgkmcnt(4)
ds_read_u16_d16_hi v157, v157
v_mfma_f32_16x16x32_f16 v[116:119], v[176:179], v[60:63], v[116:119]
v_pk_mul_f16 v69, v68, v69
v_cvt_pkrtz_f16_f32 v71, v70, v71
v_mfma_f32_16x16x32_bf16 v[112:115], v[184:187], v[136:139], 0
ds_read_b128 v[184:187], v249 offset:26880
v_and_b32_e64 v71, s49, v71
v_mfma_f32_16x16x32_f16 v[240:243], v[176:179], v[56:59], v[240:243]
v_bfe_u32 v70, v71, 2, 14
v_lshrrev_b32_e64 v71, 18, v71
v_mfma_f32_16x16x32_bf16 v[228:231], v[188:191], v[36:39], v[228:231]
ds_read_u16 v70, v70
ds_read_u16_d16_hi v71, v71
v_mfma_f32_16x16x32_f16 v[76:79], v[176:179], v[24:27], v[76:79]
ds_read_b128 v[176:179], v251 offset:59392
s_setprio 2
v_pk_mul_f16 v64, v64, v65
v_mfma_f32_16x16x32_bf16 v[152:155], v[188:191], v[108:111], v[152:155]
v_exp_f16_sdwa v69, v69 dst_sel:WORD_0 dst_unused:UNUSED_PRESERVE src0_sel:WORD_0
v_mfma_f32_16x16x32_f16 v[72:75], v[160:163], v[60:63], v[72:75]
v_or_b32 v200, v200, v201
v_cvt_pkrtz_f16_f32 v175, v174, v175
v_and_b32_e64 v175, s49, v175
v_bfe_u32 v174, v175, 2, 14
v_lshrrev_b32_e64 v175, 18, v175
v_mfma_f32_16x16x32_bf16 v[112:115], v[188:191], v[192:195], v[112:115]
ds_read_u16 v174, v174
ds_read_u16_d16_hi v175, v175
v_mfma_f32_16x16x32_f16 v[8:11], v[160:163], v[56:59], v[8:11]
ds_read_b128 v[188:191], v249 offset:28928
v_or_b32_e64 v65, v66, v67
v_cvt_pkrtz_f16_f32 v159, v158, v159
v_and_b32_e64 v159, s49, v159
v_bfe_u32 v158, v159, 2, 14
v_lshrrev_b32_e64 v159, 18, v159
v_mfma_f32_16x16x32_bf16 v[228:231], v[52:55], v[44:47], v[228:231]
ds_read_u16 v158, v158
ds_read_u16_d16_hi v159, v159
v_mfma_f32_16x16x32_f16 v[220:223], v[160:163], v[24:27], v[220:223]
v_exp_f16_sdwa v69, v69 dst_sel:WORD_1 dst_unused:UNUSED_PRESERVE src0_sel:WORD_1
v_or_b32_e64 v141, v142, v143
v_mfma_f32_16x16x32_bf16 v[152:155], v[52:55], v[144:147], v[152:155]
ds_read_b128 v[160:163], v251 offset:62464
v_or_b32 v201, v202, v203
v_mfma_f32_16x16x32_f16 v[12:15], v[48:51], v[60:63], v[12:15]
v_pk_add_f16 v69, v69, 1.0 op_sel_hi:[1,0]
v_cvt_pk_f16_f32 v228, v228, v229
v_mfma_f32_16x16x32_bf16 v[112:115], v[52:55], v[148:151], v[112:115]
s_waitcnt lgkmcnt(6)
ds_read_b128 v[52:55], v249 offset:30720
v_rcp_f16_sdwa v69, v69 dst_sel:WORD_0 dst_unused:UNUSED_PRESERVE src0_sel:WORD_0
v_mfma_f32_16x16x32_f16 v[96:99], v[48:51], v[56:59], v[96:99]
v_cvt_pkrtz_f16_f32 v153, v152, v153
v_and_b32_e64 v153, s49, v153
v_mfma_f32_16x16x32_bf16 v[164:167], v[120:123], v[28:31], 0
v_bfe_u32 v152, v153, 2, 14
v_lshrrev_b32 v153, 18, v153
v_mfma_f32_16x16x32_f16 v[84:87], v[48:51], v[24:27], v[84:87]
ds_read_b128 v[48:51], v251 offset:63488
s_setprio 1
ds_read_u16 v152, v152
v_mfma_f32_16x16x32_bf16 v[100:103], v[120:123], v[128:131], 0
ds_read_u16_d16_hi v153, v153
v_rcp_f16_sdwa v69, v69 dst_sel:WORD_1 dst_unused:UNUSED_PRESERVE src0_sel:WORD_1
v_mfma_f32_16x16x32_f16 v[208:211], v[124:127], v[60:63], v[208:211]
v_pk_fma_f16 v229, v228, v228, s48
v_cvt_pkrtz_f16_f32 v113, v112, v113
v_mfma_f32_16x16x32_bf16 v[32:35], v[120:123], v[136:139], 0
ds_read_b128 v[120:123], v249 offset:32768
v_and_b32_e64 v113, s49, v113
v_mfma_f32_16x16x32_f16 v[212:215], v[124:127], v[56:59], v[212:215]
v_bfe_u32 v112, v113, 2, 14
v_lshrrev_b32_e64 v113, 18, v113
v_mfma_f32_16x16x32_bf16 v[164:167], v[184:187], v[36:39], v[164:167]
ds_read_u16 v112, v112
ds_read_u16_d16_hi v113, v113
v_mfma_f32_16x16x32_f16 v[236:239], v[124:127], v[24:27], v[236:239]
v_or_b32_e64 v142, v172, v173
v_pk_mul_f16 v229, v228, v229
v_cvt_pkrtz_f16_f32 v231, v230, v231
v_and_b32_e64 v231, s49, v231
v_bfe_u32 v230, v231, 2, 14
v_lshrrev_b32 v231, 18, v231
v_pk_mul_f16 v66, v68, v69
ds_read_b128 v[124:127], v252 offset:1024
ds_read_u16 v230, v230
s_waitcnt lgkmcnt(7)
ds_read_u16_d16_hi v231, v231
v_mfma_f32_16x16x32_bf16 v[100:103], v[184:187], v[108:111], v[100:103]
v_exp_f16_sdwa v229, v229 dst_sel:WORD_0 dst_unused:UNUSED_PRESERVE src0_sel:WORD_0
v_mfma_f32_16x16x32_f16 v[180:183], v[176:179], v[60:63], v[180:183]
v_or_b32_e64 v202, v156, v157
v_cvt_pkrtz_f16_f32 v155, v154, v155
v_and_b32_e64 v155, s49, v155
v_bfe_u32 v154, v155, 2, 14
v_lshrrev_b32_e64 v155, 18, v155
v_mfma_f32_16x16x32_bf16 v[32:35], v[184:187], v[192:195], v[32:35]
ds_read_u16 v154, v154
ds_read_u16_d16_hi v155, v155
v_mfma_f32_16x16x32_f16 v[196:199], v[176:179], v[56:59], v[196:199]
ds_read_b128 v[184:187], v249 offset:34816
v_or_b32_e64 v67, v70, v71
v_cvt_pkrtz_f16_f32 v115, v114, v115
v_and_b32_e64 v115, s49, v115
v_bfe_u32 v114, v115, 2, 14
v_lshrrev_b32_e64 v115, 18, v115
v_mfma_f32_16x16x32_bf16 v[164:167], v[188:191], v[44:47], v[164:167]
ds_read_u16 v114, v114
ds_read_u16_d16_hi v115, v115
v_mfma_f32_16x16x32_f16 v[92:95], v[176:179], v[24:27], v[92:95]
v_exp_f16_sdwa v229, v229 dst_sel:WORD_1 dst_unused:UNUSED_PRESERVE src0_sel:WORD_1
s_setprio 0
v_or_b32 v143, v174, v175
v_mfma_f32_16x16x32_bf16 v[100:103], v[188:191], v[144:147], v[100:103]
ds_read_b128 v[176:179], v251 offset:64512
v_or_b32_e64 v203, v158, v159
v_mfma_f32_16x16x32_f16 v[216:219], v[160:163], v[60:63], v[216:219]
v_pk_add_f16 v229, v229, 1.0 op_sel_hi:[1,0]
v_cvt_pk_f16_f32 v164, v164, v165
v_mfma_f32_16x16x32_bf16 v[32:35], v[188:191], v[148:151], v[32:35]
ds_read_b128 v[188:191], v249 offset:30976
v_rcp_f16_sdwa v229, v229 dst_sel:WORD_0 dst_unused:UNUSED_PRESERVE src0_sel:WORD_0
v_mfma_f32_16x16x32_f16 v[232:235], v[160:163], v[56:59], v[232:235]
v_cvt_pkrtz_f16_f32 v101, v100, v101
v_and_b32_e64 v101, s49, v101
v_mfma_f32_16x16x32_bf16 v[4:7], v[52:55], v[28:31], 0
v_bfe_u32 v100, v101, 2, 14
v_lshrrev_b32_e64 v101, 18, v101
v_mfma_f32_16x16x32_f16 v[224:227], v[160:163], v[24:27], v[224:227]
s_waitcnt lgkmcnt(4)
ds_read_b128 v[160:163], v252 offset:2048
ds_read_u16 v100, v100
s_waitcnt vmcnt(5)
v_mfma_f32_16x16x32_bf16 v[240:243], v[18:21], v[244:247], v[240:243]
ds_read_u16_d16_hi v101, v101
v_rcp_f16_sdwa v229, v229 dst_sel:WORD_1 dst_unused:UNUSED_PRESERVE src0_sel:WORD_1
v_mfma_f32_16x16x32_bf16 v[8:11], v[16:19], v[244:247], v[8:11]
v_pk_fma_f16 v165, v164, v164, s48
v_cvt_pkrtz_f16_f32 v33, v32, v33
s_waitcnt vmcnt(4)
v_mfma_f32_16x16x32_bf16 v[96:99], v[18:21], v[168:171], v[96:99]
v_and_b32 v33, s49, v33
v_bfe_u32 v32, v33, 2, 14
v_mfma_f32_16x16x32_bf16 v[212:215], v[16:19], v[168:171], v[212:215]
v_lshrrev_b32 v33, 18, v33
v_or_b32 v152, v152, v153
v_mfma_f32_16x16x32_bf16 v[132:135], v[52:55], v[128:131], 0
ds_read_u16 v32, v32
ds_read_u16_d16_hi v33, v33
v_mfma_f32_16x16x32_f16 v[116:119], v[48:51], v[200:203], v[116:119]
v_pk_mul_f16 v165, v164, v165
v_cvt_pkrtz_f16_f32 v167, v166, v167
v_mfma_f32_16x16x32_bf16 v[40:43], v[52:55], v[136:139], 0
ds_read_b128 v[52:55], v249 offset:33024
v_and_b32_e64 v167, s49, v167
v_mfma_f32_16x16x32_f16 v[240:243], v[48:51], v[140:143], v[240:243]
v_bfe_u32 v166, v167, 2, 14
v_lshrrev_b32 v167, 18, v167
v_mfma_f32_16x16x32_bf16 v[4:7], v[120:123], v[36:39], v[4:7]
ds_read_u16 v166, v166
ds_read_u16_d16_hi v167, v167
v_mfma_f32_16x16x32_f16 v[76:79], v[48:51], v[64:67], v[76:79]
s_setprio 3
ds_read_b128 v[48:51], v252
v_pk_mul_f16 v228, v228, v229
v_mfma_f32_16x16x32_bf16 v[132:135], v[120:123], v[108:111], v[132:135]
v_exp_f16_sdwa v165, v165 dst_sel:WORD_0 dst_unused:UNUSED_PRESERVE src0_sel:WORD_0
v_mfma_f32_16x16x32_f16 v[72:75], v[124:127], v[200:203], v[72:75]
v_or_b32_e64 v112, v112, v113
v_cvt_pkrtz_f16_f32 v103, v102, v103
v_and_b32_e64 v103, s49, v103
v_bfe_u32 v102, v103, 2, 14
v_lshrrev_b32_e64 v103, 18, v103
v_mfma_f32_16x16x32_bf16 v[40:43], v[120:123], v[192:195], v[40:43]
ds_read_u16 v102, v102
ds_read_u16_d16_hi v103, v103
v_mfma_f32_16x16x32_f16 v[8:11], v[124:127], v[140:143], v[8:11]
s_waitcnt lgkmcnt(6)
ds_read_b128 v[120:123], v249 offset:35072
v_or_b32 v229, v230, v231
v_cvt_pkrtz_f16_f32 v35, v34, v35
v_and_b32_e64 v35, s49, v35
v_bfe_u32 v34, v35, 2, 14
v_lshrrev_b32_e64 v35, 18, v35
v_mfma_f32_16x16x32_bf16 v[4:7], v[184:187], v[44:47], v[4:7]
ds_read_u16 v34, v34
ds_read_u16_d16_hi v35, v35
v_mfma_f32_16x16x32_f16 v[220:223], v[124:127], v[64:67], v[220:223]
v_exp_f16_sdwa v165, v165 dst_sel:WORD_1 dst_unused:UNUSED_PRESERVE src0_sel:WORD_1
v_or_b32_e64 v153, v154, v155
v_mfma_f32_16x16x32_bf16 v[132:135], v[184:187], v[144:147], v[132:135]
ds_read_b128 v[124:127], v252 offset:3072
v_or_b32_e64 v113, v114, v115
v_mfma_f32_16x16x32_f16 v[12:15], v[176:179], v[200:203], v[12:15]
v_pk_add_f16 v165, v165, 1.0 op_sel_hi:[1,0]
v_cvt_pk_f16_f32 v4, v4, v5
v_mfma_f32_16x16x32_bf16 v[40:43], v[184:187], v[148:151], v[40:43]
v_rcp_f16_sdwa v165, v165 dst_sel:WORD_0 dst_unused:UNUSED_PRESERVE src0_sel:WORD_0
v_mfma_f32_16x16x32_f16 v[96:99], v[176:179], v[140:143], v[96:99]
ds_read_b128 v[184:187], v252 offset:4096
v_cvt_pkrtz_f16_f32 v133, v132, v133
v_mfma_f32_16x16x32_bf16 v[0:3], v[188:191], v[28:31], 0
v_and_b32_e64 v133, s49, v133
v_bfe_u32 v132, v133, 2, 14
v_mfma_f32_16x16x32_f16 v[84:87], v[176:179], v[64:67], v[84:87]
s_setprio 2
v_lshrrev_b32 v133, 18, v133
v_rcp_f16_sdwa v165, v165 dst_sel:WORD_1 dst_unused:UNUSED_PRESERVE src0_sel:WORD_1
v_mfma_f32_16x16x32_bf16 v[68:71], v[188:191], v[128:131], 0
ds_read_u16 v132, v132
ds_read_u16_d16_hi v133, v133
v_mfma_f32_16x16x32_f16 v[208:211], v[160:163], v[200:203], v[208:211]
v_pk_fma_f16 v5, v4, v4, s48
v_cvt_pkrtz_f16_f32 v41, v40, v41
v_mfma_f32_16x16x32_bf16 v[172:175], v[188:191], v[136:139], 0
v_and_b32_e64 v41, s49, v41
v_bfe_u32 v40, v41, 2, 14
v_mfma_f32_16x16x32_f16 v[212:215], v[160:163], v[140:143], v[212:215]
v_lshrrev_b32_e64 v41, 18, v41
v_or_b32 v154, v100, v101
s_waitcnt lgkmcnt(3)
v_mfma_f32_16x16x32_bf16 v[0:3], v[52:55], v[36:39], v[0:3]
ds_read_u16 v40, v40
ds_read_u16_d16_hi v41, v41
v_mfma_f32_16x16x32_f16 v[236:239], v[160:163], v[64:67], v[236:239]
ds_read_b128 v[176:179], v252 offset:7168
v_pk_mul_f16 v5, v4, v5
v_cvt_pkrtz_f16_f32 v7, v6, v7
v_and_b32_e64 v7, s49, v7
v_bfe_u32 v6, v7, 2, 14
v_lshrrev_b32_e64 v7, 18, v7
v_pk_mul_f16 v230, v164, v165
v_mfma_f32_16x16x32_bf16 v[68:71], v[52:55], v[108:111], v[68:71]
ds_read_u16 v6, v6
ds_read_u16_d16_hi v7, v7
v_mfma_f32_16x16x32_f16 v[180:183], v[48:51], v[200:203], v[180:183]
v_exp_f16_sdwa v5, v5 dst_sel:WORD_0 dst_unused:UNUSED_PRESERVE src0_sel:WORD_0
v_or_b32_e64 v114, v32, v33
v_cvt_pkrtz_f16_f32 v135, v134, v135
v_and_b32_e64 v135, s49, v135
v_bfe_u32 v134, v135, 2, 14
v_lshrrev_b32_e64 v135, 18, v135
v_mfma_f32_16x16x32_bf16 v[172:175], v[52:55], v[192:195], v[172:175]
ds_read_u16 v134, v134
ds_read_u16_d16_hi v135, v135
v_mfma_f32_16x16x32_f16 v[196:199], v[48:51], v[140:143], v[196:199]
v_or_b32_e64 v231, v166, v167
v_cvt_pkrtz_f16_f32 v43, v42, v43
v_and_b32_e64 v43, s49, v43
v_bfe_u32 v42, v43, 2, 14
v_lshrrev_b32_e64 v43, 18, v43
v_mfma_f32_16x16x32_bf16 v[0:3], v[120:123], v[44:47], v[0:3]
ds_read_u16 v42, v42
ds_read_u16_d16_hi v43, v43
s_setprio 1
v_mfma_f32_16x16x32_f16 v[92:95], v[48:51], v[64:67], v[92:95]
v_exp_f16_sdwa v5, v5 dst_sel:WORD_1 dst_unused:UNUSED_PRESERVE src0_sel:WORD_1
v_or_b32 v155, v102, v103
v_mfma_f32_16x16x32_bf16 v[68:71], v[120:123], v[144:147], v[68:71]
ds_read_b128 v[188:191], v252 offset:5120
v_or_b32_e64 v115, v34, v35
v_mfma_f32_16x16x32_f16 v[216:219], v[124:127], v[200:203], v[216:219]
v_pk_add_f16 v5, v5, 1.0 op_sel_hi:[1,0]
v_cvt_pk_f16_f32 v0, v0, v1
v_mfma_f32_16x16x32_bf16 v[172:175], v[120:123], v[148:151], v[172:175]
v_rcp_f16_sdwa v5, v5 dst_sel:WORD_0 dst_unused:UNUSED_PRESERVE src0_sel:WORD_0
v_mfma_f32_16x16x32_f16 v[232:235], v[124:127], v[140:143], v[232:235]
ds_read_b128 v[160:163], v252 offset:8192
v_cvt_pkrtz_f16_f32 v69, v68, v69
v_mfma_f32_16x16x32_f16 v[224:227], v[124:127], v[64:67], v[224:227]
v_and_b32 v69, s49, v69
v_bfe_u32 v68, v69, 2, 14
s_waitcnt vmcnt(3)
v_mfma_f32_16x16x32_bf16 v[196:199], v[18:21], v[104:107], v[196:199]
v_lshrrev_b32_e64 v69, 18, v69
v_rcp_f16_sdwa v5, v5 dst_sel:WORD_1 dst_unused:UNUSED_PRESERVE src0_sel:WORD_1
v_mfma_f32_16x16x32_bf16 v[232:235], v[16:19], v[104:107], v[232:235]
ds_read_u16 v68, v68
s_waitcnt lgkmcnt(4)
ds_read_u16_d16_hi v69, v69
s_waitcnt vmcnt(2)
v_mfma_f32_16x16x32_bf16 v[116:119], v[18:21], v[204:207], v[116:119]
v_pk_fma_f16 v1, v0, v0, s48
v_cvt_pkrtz_f16_f32 v173, v172, v173
v_mfma_f32_16x16x32_bf16 v[72:75], v[16:19], v[204:207], v[72:75]
v_and_b32_e64 v173, s49, v173
v_bfe_u32 v172, v173, 2, 14
v_mfma_f32_16x16x32_f16 v[116:119], v[184:187], v[112:115], v[116:119]
v_lshrrev_b32_e64 v173, 18, v173
v_or_b32 v132, v132, v133
v_mfma_f32_16x16x32_f16 v[240:243], v[184:187], v[152:155], v[240:243]
ds_read_u16 v172, v172
ds_read_u16_d16_hi v173, v173
s_setprio 0
v_mfma_f32_16x16x32_f16 v[76:79], v[184:187], v[228:231], v[76:79]
ds_read_b128 v[52:55], v252 offset:6144
v_pk_mul_f16 v1, v0, v1
v_cvt_pkrtz_f16_f32 v3, v2, v3
v_and_b32_e64 v3, s49, v3
v_bfe_u32 v2, v3, 2, 14
v_lshrrev_b32_e64 v3, 18, v3
v_pk_mul_f16 v4, v4, v5
v_mfma_f32_16x16x32_f16 v[72:75], v[176:179], v[112:115], v[72:75]
ds_read_u16 v2, v2
ds_read_u16_d16_hi v3, v3
v_exp_f16_sdwa v1, v1 dst_sel:WORD_0 dst_unused:UNUSED_PRESERVE src0_sel:WORD_0
v_or_b32_e64 v40, v40, v41
v_cvt_pkrtz_f16_f32 v71, v70, v71
v_and_b32_e64 v71, s49, v71
v_bfe_u32 v70, v71, 2, 14
v_lshrrev_b32_e64 v71, 18, v71
v_mfma_f32_16x16x32_f16 v[8:11], v[176:179], v[152:155], v[8:11]
ds_read_u16 v70, v70
ds_read_u16_d16_hi v71, v71
v_or_b32_e64 v5, v6, v7
v_cvt_pkrtz_f16_f32 v175, v174, v175
v_and_b32_e64 v175, s49, v175
v_bfe_u32 v174, v175, 2, 14
v_lshrrev_b32_e64 v175, 18, v175
v_mfma_f32_16x16x32_f16 v[220:223], v[176:179], v[228:231], v[220:223]
ds_read_u16 v174, v174
ds_read_u16_d16_hi v175, v175
v_exp_f16_sdwa v1, v1 dst_sel:WORD_1 dst_unused:UNUSED_PRESERVE src0_sel:WORD_1
v_or_b32 v133, v134, v135
s_waitcnt lgkmcnt(7)
v_mfma_f32_16x16x32_f16 v[12:15], v[188:191], v[112:115], v[12:15]
ds_read_b128 v[48:51], v252 offset:9216
v_or_b32 v41, v42, v43
v_mfma_f32_16x16x32_f16 v[96:99], v[188:191], v[152:155], v[96:99]
v_pk_add_f16 v1, v1, 1.0 op_sel_hi:[1,0]
s_setprio 3
ds_read_b128 v[120:123], v252 offset:10240
v_rcp_f16_sdwa v1, v1 dst_sel:WORD_0 dst_unused:UNUSED_PRESERVE src0_sel:WORD_0
v_mfma_f32_16x16x32_f16 v[84:87], v[188:191], v[228:231], v[84:87]
ds_read_b128 v[124:127], v252 offset:13312
v_rcp_f16_sdwa v1, v1 dst_sel:WORD_1 dst_unused:UNUSED_PRESERVE src0_sel:WORD_1
v_mfma_f32_16x16x32_f16 v[208:211], v[160:163], v[112:115], v[208:211]
ds_read_b128 v[184:187], v252 offset:11264
v_or_b32_e64 v134, v68, v69
v_mfma_f32_16x16x32_f16 v[212:215], v[160:163], v[152:155], v[212:215]
v_pk_mul_f16 v6, v0, v1
v_or_b32_e64 v42, v172, v173
v_mfma_f32_16x16x32_f16 v[236:239], v[160:163], v[228:231], v[236:239]
ds_read_b128 v[176:179], v252 offset:14336
s_waitcnt lgkmcnt(8)
v_or_b32 v7, v2, v3
v_mfma_f32_16x16x32_f16 v[180:183], v[52:55], v[112:115], v[180:183]
ds_read_b128 v[188:191], v252 offset:12288
s_waitcnt lgkmcnt(8)
v_or_b32 v135, v70, v71
v_mfma_f32_16x16x32_f16 v[196:199], v[52:55], v[152:155], v[196:199]
s_setprio 2
s_waitcnt lgkmcnt(6)
v_or_b32_e64 v43, v174, v175
ds_read_b128 v[160:163], v252 offset:15360
v_mfma_f32_16x16x32_f16 v[92:95], v[52:55], v[228:231], v[92:95]
s_waitcnt lgkmcnt(6)
v_mfma_f32_16x16x32_f16 v[216:219], v[48:51], v[112:115], v[216:219]
v_mfma_f32_16x16x32_f16 v[232:235], v[48:51], v[152:155], v[232:235]
v_mfma_f32_16x16x32_f16 v[224:227], v[48:51], v[228:231], v[224:227]
s_waitcnt vmcnt(1)
v_mfma_f32_16x16x32_bf16 v[12:15], v[18:21], v[80:83], v[12:15]
v_mfma_f32_16x16x32_bf16 v[208:211], v[16:19], v[80:83], v[208:211]
s_waitcnt vmcnt(0)
v_mfma_f32_16x16x32_bf16 v[180:183], v[18:21], v[88:91], v[180:183]
v_mfma_f32_16x16x32_bf16 v[216:219], v[16:19], v[88:91], v[216:219]
s_waitcnt lgkmcnt(0)
v_mfma_f32_16x16x32_f16 v[116:119], v[120:123], v[40:43], v[116:119]
v_mfma_f32_16x16x32_f16 v[240:243], v[120:123], v[132:135], v[240:243]
v_mfma_f32_16x16x32_f16 v[76:79], v[120:123], v[4:7], v[76:79]
s_nop 5
v_cvt_pk_bf16_f32 v116, v116, v117
v_mfma_f32_16x16x32_f16 v[72:75], v[124:127], v[40:43], v[72:75]
s_setprio 1
v_cvt_pk_bf16_f32 v117, v118, v119
v_cvt_pk_bf16_f32 v240, v240, v241
v_mfma_f32_16x16x32_f16 v[8:11], v[124:127], v[132:135], v[8:11]
v_cvt_pk_bf16_f32 v76, v76, v77
v_cvt_pk_bf16_f32 v77, v78, v79
v_mfma_f32_16x16x32_f16 v[220:223], v[124:127], v[4:7], v[220:223]
v_cvt_pk_bf16_f32 v241, v242, v243
v_cvt_pk_bf16_f32 v118, v72, v73
v_mfma_f32_16x16x32_f16 v[12:15], v[184:187], v[40:43], v[12:15]
s_nop 1
v_cvt_pk_bf16_f32 v242, v8, v9
v_cvt_pk_bf16_f32 v243, v10, v11
v_mfma_f32_16x16x32_f16 v[96:99], v[184:187], v[132:135], v[96:99]
v_cvt_pk_bf16_f32 v78, v220, v221
v_cvt_pk_bf16_f32 v79, v222, v223
v_mfma_f32_16x16x32_f16 v[84:87], v[184:187], v[4:7], v[84:87]
v_cvt_pk_bf16_f32 v119, v74, v75
v_cvt_pk_bf16_f32 v12, v12, v13
v_mfma_f32_16x16x32_f16 v[208:211], v[176:179], v[40:43], v[208:211]
s_nop 1
v_cvt_pk_bf16_f32 v96, v96, v97
v_cvt_pk_bf16_f32 v97, v98, v99
v_mfma_f32_16x16x32_f16 v[212:215], v[176:179], v[132:135], v[212:215]
v_cvt_pk_bf16_f32 v84, v84, v85
v_cvt_pk_bf16_f32 v85, v86, v87
v_mfma_f32_16x16x32_f16 v[236:239], v[176:179], v[4:7], v[236:239]
v_cvt_pk_bf16_f32 v13, v14, v15
v_cvt_pk_bf16_f32 v14, v208, v209
v_cvt_pk_bf16_f32 v15, v210, v211
v_mfma_f32_16x16x32_f16 v[180:183], v[188:191], v[40:43], v[180:183]
s_nop 0
v_cvt_pk_bf16_f32 v98, v212, v213
v_cvt_pk_bf16_f32 v99, v214, v215
v_mfma_f32_16x16x32_f16 v[196:199], v[188:191], v[132:135], v[196:199]
v_cvt_pk_bf16_f32 v86, v236, v237
v_cvt_pk_bf16_f32 v87, v238, v239
v_mfma_f32_16x16x32_f16 v[92:95], v[188:191], v[4:7], v[92:95]
s_nop 0
v_cvt_pk_bf16_f32 v180, v180, v181
v_cvt_pk_bf16_f32 v181, v182, v183
v_mfma_f32_16x16x32_f16 v[216:219], v[160:163], v[40:43], v[216:219]
s_nop 0
v_cvt_pk_bf16_f32 v196, v196, v197
v_cvt_pk_bf16_f32 v197, v198, v199
v_mfma_f32_16x16x32_f16 v[232:235], v[160:163], v[132:135], v[232:235]
v_cvt_pk_bf16_f32 v92, v92, v93
v_cvt_pk_bf16_f32 v93, v94, v95
s_setprio 0
v_mfma_f32_16x16x32_f16 v[224:227], v[160:163], v[4:7], v[224:227]
v_cvt_pk_bf16_f32 v182, v216, v217
v_cvt_pk_bf16_f32 v183, v218, v219
s_nop 1
v_cvt_pk_bf16_f32 v198, v232, v233
v_cvt_pk_bf16_f32 v199, v234, v235
s_nop 1
v_cvt_pk_bf16_f32 v94, v224, v225
v_cvt_pk_bf16_f32 v95, v226, v227
buffer_store_dwordx4 v[76:79], v253, s[8:11], s69 offen offset:192 sc1
buffer_store_dwordx4 v[84:87], v253, s[8:11], s69 offen offset:256 sc1
buffer_store_dwordx4 v[92:95], v253, s[8:11], s69 offen offset:320 sc1
buffer_store_dwordx4 v[240:243], v253, s[8:11], s68 offen sc1
buffer_store_dwordx4 v[96:99], v253, s[8:11], s68 offen offset:64 sc1
buffer_store_dwordx4 v[196:199], v253, s[8:11], s68 offen offset:128 sc1
buffer_store_dwordx4 v[116:119], v253, s[8:11], s68 offen offset:192 sc1
buffer_store_dwordx4 v[12:15], v253, s[8:11], s68 offen offset:256 sc1
buffer_store_dwordx4 v[180:183], v253, s[8:11], s68 offen offset:320 sc1
s_endpgm
Lpolln:
s_getreg_b32 s43, hwreg(HW_REG_IB_STS, 0, 4)
s_cmp_eq_u32 s43, 0
s_cbranch_scc1 Lpoll
s_setpc_b64 s[78:79]
Lpoll:
s_waitcnt vmcnt(0)
s_cmp_eq_u32 s77, 2
s_cbranch_scc1 LpollC
v_max_u32 v241, v128, v129
v_max3_u32 v241, v241, v130, v131
v_max3_u32 v241, v241, v132, v133
v_max3_u32 v241, v241, v134, v135
v_max3_u32 v241, v241, v136, v137
v_max3_u32 v241, v241, v138, v139
v_max3_u32 v241, v241, v140, v141
v_max3_u32 v241, v241, v142, v143
v_cmp_eq_u32 vcc, -1, v241
s_nop 4
s_cbranch_vccz LpollR
s_lshl_b32 s44, s2, 12
buffer_load_dwordx4 v[128:131], v245, s[32:35], s44 offen sc1
buffer_load_dwordx4 v[132:135], v245, s[32:35], s44 offen offset:1024 sc1
buffer_load_dwordx4 v[136:139], v245, s[32:35], s44 offen offset:2048 sc1
buffer_load_dwordx4 v[140:143], v245, s[32:35], s44 offen offset:3072 sc1
s_setpc_b64 s[78:79]
LpollR:
v_add_f32 v128, v128, v132
v_add_f32 v140, v136, v140
v_add_f32 v140, v128, v140
v_add_f32 v129, v129, v133
v_add_f32 v141, v137, v141
v_add_f32 v141, v129, v141
v_add_f32 v130, v130, v134
v_add_f32 v142, v138, v142
v_add_f32 v142, v130, v142
v_add_f32 v131, v131, v135
v_add_f32 v143, v139, v143
v_add_f32 v143, v131, v143
v_permlane32_swap_b32 v140, v141
s_nop 0
v_permlane32_swap_b32 v142, v143
v_add_f32 v140, v140, v141
v_add_f32_e64 v142, v142, v143
v_bfe_u32 v241, v245, 4, 4
v_lshlrev_b32 v241, 11, v241
v_permlane16_swap_b32 v140, v142
v_add_f32 v140, v140, v142
v_bfe_u32 v242, v245, 8, 1
v_lshl_add_u32 v241, v242, 3, v241
v_add_f32_dpp v140, v140, v140 row_ror:8 row_mask:0xf bank_mask:0xf
v_bfe_u32 v242, v245, 9, 1
v_lshl_add_u32 v241, v242, 2, v241
v_add_f32_dpp v140, v140, v140 row_ror:4 row_mask:0xf bank_mask:0xf
s_lshl_b32 s44, s2, 4
s_add_u32 s44, s44, 393216
v_add_f32_dpp v140, v140, v140 row_ror:2 row_mask:0xf bank_mask:0xf
s_mov_b32 s43, 1083289508
v_mov_b32 v242, 897988541
v_add_f32_dpp v140, v140, v140 row_ror:1 row_mask:0xf bank_mask:0xf
v_fma_f32 v140, v140, s43, v242
v_sqrt_f32_e64 v140, v140
s_mov_b32 exec_lo, 16711935
s_mov_b32 exec_hi, 16711935
v_min_u32_e64 v140, -2, v140
buffer_store_dword v140, v241, s[32:35], s44 offen sc1
s_mov_b64 exec, -1
s_mov_b32 s77, 2
s_and_b32 s44, s2, 7
s_lshl_b32 s44, s44, 11
s_add_u32 s44, s44, 393216
buffer_load_dwordx2 v[128:129], v240, s[32:35], s44 offen sc1
buffer_load_dwordx2 v[130:131], v240, s[32:35], s44 offen offset:8 sc1
buffer_load_dwordx2 v[132:133], v240, s[32:35], s44 offen offset:16 sc1
v_lshrrev_b32 v241, 1, v240
buffer_load_dword v135, v241, s[24:27], 0 offen
buffer_load_dword v137, v241, s[24:27], 0 offen offset:4
buffer_load_dword v139, v241, s[24:27], 0 offen offset:8
s_setpc_b64 s[78:79]
LpollC:
v_max3_u32 v241, v128, v129, v130
v_max3_u32 v241, v241, v131, v132
v_max_u32 v241, v241, v133
v_cmp_eq_u32 vcc, -1, v241
s_nop 4
s_cbranch_vccz LpollS
s_and_b32 s44, s2, 7
s_lshl_b32 s44, s44, 11
s_add_u32 s44, s44, 393216
buffer_load_dwordx2 v[128:129], v240, s[32:35], s44 offen sc1
buffer_load_dwordx2 v[130:131], v240, s[32:35], s44 offen offset:8 sc1
buffer_load_dwordx2 v[132:133], v240, s[32:35], s44 offen offset:16 sc1
s_setpc_b64 s[78:79]
LpollS:
v_add_f32 v243, v128, v129
v_add_f32 v243, v243, v130
v_add_f32 v243, v243, v131
v_add_f32 v243, v243, v132
v_add_f32 v243, v243, v133
v_lshlrev_b32_e64 v134, 16, v135
v_and_b32 v135, 4294901760, v135
v_add_f32_dpp v243, v243, v243 row_ror:8 row_mask:0xf bank_mask:0xf
v_lshlrev_b32_e64 v136, 16, v137
v_and_b32 v137, 4294901760, v137
v_add_f32_dpp v243, v243, v243 row_ror:4 row_mask:0xf bank_mask:0xf
v_lshlrev_b32_e64 v138, 16, v139
v_and_b32 v139, 4294901760, v139
v_add_f32_dpp v243, v243, v243 row_ror:2 row_mask:0xf bank_mask:0xf
v_mul_f32 v128, v128, v134
v_mul_f32 v129, v129, v135
v_add_f32_dpp v243, v243, v243 row_ror:1 row_mask:0xf bank_mask:0xf
v_mov_b32 v241, v243
v_mul_f32 v130, v130, v136
v_mul_f32 v131, v131, v137
v_permlane16_swap_b32 v243, v241
v_add_f32 v243, v243, v241
v_mov_b32 v241, v243
v_mul_f32 v132, v132, v138
v_mul_f32 v133, v133, v139
v_permlane32_swap_b32 v243, v241
v_add_f32 v243, v243, v241
v_mov_b32 v242, 3036348137
s_mov_b32 s43, 3131020332
v_fma_f32 v243, v243, s43, v242
v_rcp_f32_e64 v243, v243
s_mov_b32 s43, 3221808330
v_fma_f32 v128, v128, v243, s43
v_fma_f32 v129, v129, v243, s43
v_fma_f32 v130, v130, v243, s43
v_fma_f32 v131, v131, v243, s43
v_fma_f32 v132, v132, v243, s43
v_fma_f32 v133, v133, v243, s43
v_cvt_pk_f16_f32 v128, v128, v129
v_cvt_pk_f16_f32 v129, v130, v131
v_cvt_pk_f16_f32 v130, v132, v133
s_mov_b32 s77, 0
s_nop 1
s_setpc_b64 s[78:79]
Lend:
s_endpgm

.section .rodata,"a"
.p2align 6
.amdhsa_kernel standalone__modern_conv_block_convnext_v2__vision_kernel
  .amdhsa_next_free_vgpr 256
  .amdhsa_next_free_sgpr 102
  .amdhsa_accum_offset 256
  .amdhsa_group_segment_fixed_size 0
  .amdhsa_kernarg_size 72
  .amdhsa_user_sgpr_count 2
  .amdhsa_user_sgpr_kernarg_segment_ptr 1
  .amdhsa_system_sgpr_workgroup_id_x 1
.end_amdhsa_kernel
```

```asm
; @launch grid=(256,1,1) block=(512,1,1) lds=163840
.amdgcn_target "amdgcn-amd-amdhsa--gfx950"
.text
.globl standalone__modern_conv_block_convnext_v2__vision_kernel
.p2align 8
.type standalone__modern_conv_block_convnext_v2__vision_kernel,@function
standalone__modern_conv_block_convnext_v2__vision_kernel:
s_cmp_ge_u32 s2, 256
s_cbranch_scc1 Lend
s_load_dwordx16 s[80:95], s[0:1], 0
s_load_dwordx2 s[96:97], s[0:1], 64
v_mov_b32 v119, v0
v_and_b32 v118, 63, v0
v_lshrrev_b32 v120, 6, v0
s_nop 0
v_readfirstlane_b32 s40, v120
s_getpc_b64 s[74:75]
Lpc:
s_lshr_b32 s43, s2, 3
s_and_b32 s43, s43, 15
s_lshl_b32 s43, s43, 13
v_lshrrev_b32_e64 v122, 3, v0
v_lshl_add_u32 v122, v122, 7, s43
v_min_u32 v122, Lend-Lpc, v122
global_load_dword v112, v122, s[74:75]
s_and_b32 s43, s2, 7
s_lshr_b32 s44, s2, 3
s_and_b32 s41, s43, 3
s_lshl_b32 s41, s41, 2
s_and_b32 s45, s44, 3
s_add_u32 s41, s41, s45
s_lshr_b32 s42, s43, 2
s_lshl_b32 s42, s42, 3
s_lshr_b32 s45, s44, 2
s_add_u32 s42, s42, s45
s_lshl_b32 s41, s41, 5
s_lshl_b32 s42, s42, 5
s_and_b32 s43, s40, 3
s_mul_i32 s43, s43, 1536
s_add_u32 s67, s43, 90112
s_mul_i32 s44, s41, 192
s_add_u32 s43, s43, s44
s_sub_u32 s43, s43, 192
v_lshl_add_u32 v121, v118, 4, s43
v_add_u32 v123, 896, v121
v_mov_b32 v122, 2147483648
s_mov_b32 s44, 98304
v_cmp_gt_u32 vcc, s44, v121
s_nop 1
v_cndmask_b32 v236, v122, v121, vcc
v_cmp_gt_u32 vcc, s44, v123
s_nop 1
v_cndmask_b32 v237, v122, v123, vcc
s_mul_i32 s66, s42, 98304
v_min_u32 v128, 215, v119
v_lshlrev_b32_e64 v130, 3, v128
v_lshlrev_b32 v250, 4, v118
s_waitcnt lgkmcnt(0)
s_mov_b32 s4, s80
s_and_b32 s5, s81, 65535
s_mov_b32 s6, 50331648
s_mov_b32 s7, 131072
s_cmp_ge_u32 s40, 4
s_cbranch_scc1 Lrowb
s_mov_b32 s20, s82
s_and_b32 s21, s83, 65535
s_mov_b32 s22, 1728
s_mov_b32 s23, 131072
buffer_load_dwordx2 v[126:127], v130, s[20:23], 0 offen
s_add_u32 m0, s67, 0
s_sub_u32 s45, s66, 98304
s_cmp_eq_u32 s42, 0
s_cselect_b32 s45, 1073741824, s45
buffer_load_dwordx4 v236, s[4:7], s45 offen lds
s_add_u32 m0, s67, 6592
s_nop 0
buffer_load_dwordx4 v236, s[4:7], s66 offen lds
s_add_u32 m0, s67, 13200
s_add_u32 s66, s66, 98304
buffer_load_dwordx4 v236, s[4:7], s66 offen lds
s_add_u32 m0, s67, 19792
s_add_u32 s66, s66, 98304
buffer_load_dwordx4 v236, s[4:7], s66 offen lds
s_add_u32 m0, s67, 26400
s_add_u32 s66, s66, 98304
buffer_load_dwordx4 v236, s[4:7], s66 offen lds
s_add_u32 m0, s67, 32992
s_add_u32 s66, s66, 98304
buffer_load_dwordx4 v236, s[4:7], s66 offen lds
s_add_u32 m0, s67, 39600
s_add_u32 s66, s66, 98304
buffer_load_dwordx4 v236, s[4:7], s66 offen lds
s_add_u32 m0, s67, 46192
s_add_u32 s66, s66, 98304
buffer_load_dwordx4 v236, s[4:7], s66 offen lds
s_add_u32 m0, s67, 52736
s_add_u32 s66, s66, 98304
buffer_load_dwordx4 v236, s[4:7], s66 offen lds
s_add_u32 m0, s67, 59328
s_add_u32 s66, s66, 98304
buffer_load_dwordx4 v236, s[4:7], s66 offen lds
s_branch Lsetup
Lrowb:
s_add_u32 m0, s67, 896
s_sub_u32 s45, s66, 98304
s_cmp_eq_u32 s42, 0
s_cselect_b32 s45, 1073741824, s45
buffer_load_dwordx4 v237, s[4:7], s45 offen lds
s_add_u32 m0, s67, 7488
s_nop 0
buffer_load_dwordx4 v237, s[4:7], s66 offen lds
s_add_u32 m0, s67, 14096
s_add_u32 s66, s66, 98304
buffer_load_dwordx4 v237, s[4:7], s66 offen lds
s_add_u32 m0, s67, 20688
s_add_u32 s66, s66, 98304
buffer_load_dwordx4 v237, s[4:7], s66 offen lds
s_add_u32 m0, s67, 27296
s_add_u32 s66, s66, 98304
buffer_load_dwordx4 v237, s[4:7], s66 offen lds
s_add_u32 m0, s67, 33888
s_add_u32 s66, s66, 98304
buffer_load_dwordx4 v237, s[4:7], s66 offen lds
s_add_u32 m0, s67, 40496
s_add_u32 s66, s66, 98304
buffer_load_dwordx4 v237, s[4:7], s66 offen lds
s_add_u32 m0, s67, 47088
s_add_u32 s66, s66, 98304
buffer_load_dwordx4 v237, s[4:7], s66 offen lds
s_add_u32 m0, s67, 53632
s_add_u32 s66, s66, 98304
buffer_load_dwordx4 v237, s[4:7], s66 offen lds
s_add_u32 m0, s67, 60224
s_add_u32 s66, s66, 98304
buffer_load_dwordx4 v237, s[4:7], s66 offen lds
s_mov_b32 s12, s84
s_and_b32 s13, s85, 65535
s_mov_b32 s14, 73728
s_mov_b32 s15, 131072
v_lshrrev_b32 v115, 2, v118
v_mul_u32_u24 v115, 768, v115
v_and_b32_e64 v125, 3, v118
v_lshl_add_u32 v115, v125, 4, v115
s_and_b32 s43, s40, 3
s_add_u32 s43, s43, 0
s_mul_i32 s44, s43, 43
s_lshr_b32 s44, s44, 8
s_lshl_b32 s46, s43, 10
s_add_u32 m0, s46, 16384
s_mul_i32 s46, s44, 6
s_sub_u32 s43, s43, s46
s_mul_i32 s43, s43, 12288
s_lshl_b32 s44, s44, 6
s_add_u32 s43, s43, s44
buffer_load_dwordx4 v115, s[12:15], s43 offen lds
s_and_b32 s43, s40, 3
s_add_u32 s43, s43, 4
s_mul_i32 s44, s43, 43
s_lshr_b32 s44, s44, 8
s_lshl_b32 s46, s43, 10
s_add_u32 m0, s46, 16384
s_mul_i32 s46, s44, 6
s_sub_u32 s43, s43, s46
s_mul_i32 s43, s43, 12288
s_lshl_b32 s44, s44, 6
s_add_u32 s43, s43, s44
buffer_load_dwordx4 v115, s[12:15], s43 offen lds
s_and_b32 s43, s40, 3
s_add_u32 s43, s43, 8
s_mul_i32 s44, s43, 43
s_lshr_b32 s44, s44, 8
s_lshl_b32 s46, s43, 10
s_add_u32 m0, s46, 16384
s_mul_i32 s46, s44, 6
s_sub_u32 s43, s43, s46
s_mul_i32 s43, s43, 12288
s_lshl_b32 s44, s44, 6
s_add_u32 s43, s43, s44
buffer_load_dwordx4 v115, s[12:15], s43 offen lds
s_and_b32 s43, s40, 3
s_add_u32 s43, s43, 12
s_mul_i32 s44, s43, 43
s_lshr_b32 s44, s44, 8
s_lshl_b32 s46, s43, 10
s_add_u32 m0, s46, 16384
s_mul_i32 s46, s44, 6
s_sub_u32 s43, s43, s46
s_mul_i32 s43, s43, 12288
s_lshl_b32 s44, s44, 6
s_add_u32 s43, s43, s44
buffer_load_dwordx4 v115, s[12:15], s43 offen lds
s_and_b32 s43, s40, 3
s_add_u32 s43, s43, 16
s_mul_i32 s44, s43, 43
s_lshr_b32 s44, s44, 8
s_lshl_b32 s46, s43, 10
s_add_u32 m0, s46, 16384
s_mul_i32 s46, s44, 6
s_sub_u32 s43, s43, s46
s_mul_i32 s43, s43, 12288
s_lshl_b32 s44, s44, 6
s_add_u32 s43, s43, s44
buffer_load_dwordx4 v115, s[12:15], s43 offen lds
s_and_b32 s43, s40, 3
s_add_u32 s43, s43, 20
s_mul_i32 s44, s43, 43
s_lshr_b32 s44, s44, 8
s_lshl_b32 s46, s43, 10
s_add_u32 m0, s46, 16384
s_mul_i32 s46, s44, 6
s_sub_u32 s43, s43, s46
s_mul_i32 s43, s43, 12288
s_lshl_b32 s44, s44, 6
s_add_u32 s43, s43, s44
buffer_load_dwordx4 v115, s[12:15], s43 offen lds
v_bfe_u32 v141, v250, 4, 6
v_and_b32 v140, 15, v141
v_lshlrev_b32 v140, 7, v140
v_lshrrev_b32 v141, 4, v141
v_mul_u32_u24 v141, 98304, v141
s_sub_u32 s43, s67, -8000
s_mul_i32 s44, s41, 192
s_add_u32 s43, s43, s44
v_add3_u32 v140, v140, v141, s43
s_mov_b32 m0, 163840
s_add_u32 s44, s66, 393216
buffer_load_dword v140, s[4:7], s66 offen lds
buffer_load_dword v140, s[4:7], s44 offen lds
s_waitcnt vmcnt(8)
s_barrier
s_setprio 0
s_and_b32 s43, s40, 3
s_add_u32 s43, s43, 24
s_mul_i32 s44, s43, 43
s_lshr_b32 s44, s44, 8
s_lshl_b32 s46, s43, 10
s_add_u32 m0, s46, 16384
s_mul_i32 s46, s44, 6
s_sub_u32 s43, s43, s46
s_mul_i32 s43, s43, 12288
s_lshl_b32 s44, s44, 6
s_add_u32 s43, s43, s44
buffer_load_dwordx4 v115, s[12:15], s43 offen lds
s_and_b32 s43, s40, 3
s_add_u32 s43, s43, 28
s_mul_i32 s44, s43, 43
s_lshr_b32 s44, s44, 8
s_lshl_b32 s46, s43, 10
s_add_u32 m0, s46, 16384
s_mul_i32 s46, s44, 6
s_sub_u32 s43, s43, s46
s_mul_i32 s43, s43, 12288
s_lshl_b32 s44, s44, 6
s_add_u32 s43, s43, s44
buffer_load_dwordx4 v115, s[12:15], s43 offen lds
s_and_b32 s43, s40, 3
s_add_u32 s43, s43, 32
s_mul_i32 s44, s43, 43
s_lshr_b32 s44, s44, 8
s_lshl_b32 s46, s43, 10
s_add_u32 m0, s46, 16384
s_mul_i32 s46, s44, 6
s_sub_u32 s43, s43, s46
s_mul_i32 s43, s43, 12288
s_lshl_b32 s44, s44, 6
s_add_u32 s43, s43, s44
buffer_load_dwordx4 v115, s[12:15], s43 offen lds
s_and_b32 s43, s40, 3
s_add_u32 s43, s43, 36
s_mul_i32 s44, s43, 43
s_lshr_b32 s44, s44, 8
s_lshl_b32 s46, s43, 10
s_add_u32 m0, s46, 16384
s_mul_i32 s46, s44, 6
s_sub_u32 s43, s43, s46
s_mul_i32 s43, s43, 12288
s_lshl_b32 s44, s44, 6
s_add_u32 s43, s43, s44
buffer_load_dwordx4 v115, s[12:15], s43 offen lds
s_and_b32 s43, s40, 3
s_add_u32 s43, s43, 40
s_mul_i32 s44, s43, 43
s_lshr_b32 s44, s44, 8
s_lshl_b32 s46, s43, 10
s_add_u32 m0, s46, 16384
s_mul_i32 s46, s44, 6
s_sub_u32 s43, s43, s46
s_mul_i32 s43, s43, 12288
s_lshl_b32 s44, s44, 6
s_add_u32 s43, s43, s44
buffer_load_dwordx4 v115, s[12:15], s43 offen lds
s_and_b32 s43, s40, 3
s_add_u32 s43, s43, 44
s_mul_i32 s44, s43, 43
s_lshr_b32 s44, s44, 8
s_lshl_b32 s46, s43, 10
s_add_u32 m0, s46, 16384
s_mul_i32 s46, s44, 6
s_sub_u32 s43, s43, s46
s_mul_i32 s43, s43, 12288
s_lshl_b32 s44, s44, 6
s_add_u32 s43, s43, s44
buffer_load_dwordx4 v115, s[12:15], s43 offen lds
s_and_b32 s43, s40, 3
s_add_u32 s43, s43, 48
s_mul_i32 s44, s43, 43
s_lshr_b32 s44, s44, 8
s_lshl_b32 s46, s43, 10
s_add_u32 m0, s46, 16384
s_mul_i32 s46, s44, 6
s_sub_u32 s43, s43, s46
s_mul_i32 s43, s43, 12288
s_lshl_b32 s44, s44, 6
s_add_u32 s43, s43, s44
buffer_load_dwordx4 v115, s[12:15], s43 offen lds
s_and_b32 s43, s40, 3
s_add_u32 s43, s43, 52
s_mul_i32 s44, s43, 43
s_lshr_b32 s44, s44, 8
s_lshl_b32 s46, s43, 10
s_add_u32 m0, s46, 16384
s_mul_i32 s46, s44, 6
s_sub_u32 s43, s43, s46
s_mul_i32 s43, s43, 12288
s_lshl_b32 s44, s44, 6
s_add_u32 s43, s43, s44
buffer_load_dwordx4 v115, s[12:15], s43 offen lds
s_and_b32 s43, s40, 3
s_add_u32 s43, s43, 56
s_mul_i32 s44, s43, 43
s_lshr_b32 s44, s44, 8
s_lshl_b32 s46, s43, 10
s_add_u32 m0, s46, 16384
s_mul_i32 s46, s44, 6
s_sub_u32 s43, s43, s46
s_mul_i32 s43, s43, 12288
s_lshl_b32 s44, s44, 6
s_add_u32 s43, s43, s44
buffer_load_dwordx4 v115, s[12:15], s43 offen lds
s_and_b32 s43, s40, 3
s_add_u32 s43, s43, 60
s_mul_i32 s44, s43, 43
s_lshr_b32 s44, s44, 8
s_lshl_b32 s46, s43, 10
s_add_u32 m0, s46, 16384
s_mul_i32 s46, s44, 6
s_sub_u32 s43, s43, s46
s_mul_i32 s43, s43, 12288
s_lshl_b32 s44, s44, 6
s_add_u32 s43, s43, s44
buffer_load_dwordx4 v115, s[12:15], s43 offen lds
s_and_b32 s43, s40, 3
s_add_u32 s43, s43, 64
s_mul_i32 s44, s43, 43
s_lshr_b32 s44, s44, 8
s_lshl_b32 s46, s43, 10
s_add_u32 m0, s46, 16384
s_mul_i32 s46, s44, 6
s_sub_u32 s43, s43, s46
s_mul_i32 s43, s43, 12288
s_lshl_b32 s44, s44, 6
s_add_u32 s43, s43, s44
buffer_load_dwordx4 v115, s[12:15], s43 offen lds
s_and_b32 s43, s40, 3
s_add_u32 s43, s43, 68
s_mul_i32 s44, s43, 43
s_lshr_b32 s44, s44, 8
s_lshl_b32 s46, s43, 10
s_add_u32 m0, s46, 16384
s_mul_i32 s46, s44, 6
s_sub_u32 s43, s43, s46
s_mul_i32 s43, s43, 12288
s_lshl_b32 s44, s44, 6
s_add_u32 s43, s43, s44
buffer_load_dwordx4 v115, s[12:15], s43 offen lds
Lsetup:
s_mov_b32 s16, s86
s_and_b32 s17, s87, 65535
s_mov_b32 s18, 73728
s_mov_b32 s19, 131072
s_mov_b32 s24, s88
s_and_b32 s25, s89, 65535
s_mov_b32 s26, 768
s_mov_b32 s27, 131072
s_mov_b32 s28, s90
s_and_b32 s29, s91, 65535
s_mov_b32 s30, 768
s_mov_b32 s31, 131072
s_mov_b32 s8, s92
s_and_b32 s9, s93, 65535
s_mov_b32 s10, 50331648
s_mov_b32 s11, 131072
s_mov_b32 s36, s94
s_and_b32 s37, s95, 65535
s_mov_b32 s38, 256
s_mov_b32 s39, 131072
s_mov_b32 s32, s96
s_and_b32 s33, s97, 65535
s_mov_b32 s34, 83886080
s_mov_b32 s35, 131072
v_lshlrev_b32_e64 v250, 4, v118
v_add_u32 v250, 16384, v250
v_lshlrev_b32_e64 v251, 4, v118
v_add_u32 v251, 81920, v251
v_lshlrev_b32_e64 v252, 4, v118
v_add_u32 v252, 147456, v252
s_lshl_b32 s73, s2, 3
s_add_u32 s73, s73, s40
s_lshl_b32 s80, s73, 10
s_add_u32 s80, s80, 4177920
s_mul_i32 s73, s73, 16
s_add_u32 s73, s73, 1048576
s_mov_b32 s48, 1156203754
s_mov_b32 s49, 4294508536
s_mov_b32 s47, 16382
v_and_b32 v131, 15, v118
v_lshrrev_b32 v132, 4, v118
v_and_b32_e64 v133, 3, v131
v_mul_u32_u24 v134, 13200, v133
v_lshrrev_b32_e64 v133, 2, v131
v_lshl_add_u32 v133, v133, 1, v132
v_mul_u32_u24 v133, 192, v133
s_sub_u32 s43, s67, 90112
v_add3_u32 v246, v133, v134, s43
v_bfe_u32 v133, v131, 2, 1
v_sub_u32 v133, v132, v133
v_lshrrev_b32 v134, 3, v131
v_and_b32_e64 v135, 3, v131
v_lshl_add_u32 v135, v134, 2, v135
v_lshlrev_b32_e64 v136, 6, v133
v_lshl_add_u32 v136, v135, 3, v136
v_add_u32 v136, 156040, v136
v_mov_b32 v137, 156032
v_cmp_gt_u32 vcc, 3, v133
s_nop 1
v_cndmask_b32 v136, v137, v136, vcc
v_cmp_eq_u32 vcc, 0, v134
s_nop 1
v_cndmask_b32 v238, v137, v136, vcc
v_cndmask_b32 v239, v136, v137, vcc
v_lshrrev_b32 v133, 2, v131
v_bfe_u32 v135, v131, 1, 1
v_cmp_eq_u32 vcc, v133, v132
s_nop 1
v_cndmask_b32 v135, 8, v135, vcc
v_cmp_eq_u32 s[88:89], 0, v135
v_cmp_eq_u32 s[90:91], 1, v135
v_lshlrev_b32 v254, 5, v132
v_add_u32 v254, 7936, v254
v_lshlrev_b32 v253, 4, v132
v_and_b32 v131, 31, v118
v_lshrrev_b32_e64 v132, 5, v118
v_bfe_u32 v133, v131, 2, 1
v_bfe_u32 v134, v131, 3, 1
v_bfe_u32 v135, v131, 1, 1
v_lshrrev_b32 v136, 4, v131
v_lshl_add_u32 v135, v136, 1, v135
v_lshl_add_u32 v135, v134, 2, v135
v_cmp_eq_u32 vcc, v133, v132
s_nop 1
v_cndmask_b32 v135, 8, v135, vcc
v_cmp_eq_u32 s[50:51], 0, v135
v_cmp_eq_u32 s[52:53], 1, v135
v_cmp_eq_u32 s[54:55], 2, v135
v_cmp_eq_u32 s[56:57], 3, v135
v_cmp_eq_u32 s[58:59], 4, v135
v_cmp_eq_u32 s[60:61], 5, v135
v_cmp_eq_u32 s[62:63], 6, v135
v_cmp_eq_u32 s[64:65], 7, v135
v_and_b32 v136, 1, v131
v_lshlrev_b32 v136, 4, v136
v_mov_b32 v255, 16256
v_lshlrev_b32 v255, v136, v255
v_and_b32 v137, 19, v131
v_lshl_add_u32 v137, v133, 3, v137
v_lshl_add_u32 v137, v134, 2, v137
v_lshlrev_b32_e64 v137, 2, v137
v_lshl_add_u32 v137, v132, 7, v137
s_mul_i32 s82, s40, 9216
s_add_u32 s72, s82, 90112
v_add_u32 v248, s72, v137
v_and_b32 v133, 3, v118
v_mul_u32_u24 v134, 196608, v133
v_bfe_u32 v133, v118, 2, 2
v_mul_u32_u24 v133, 384, v133
v_add3_u32 v253, v253, v133, v134
s_mul_i32 s46, s41, 192
s_add_u32 s46, s46, s67
s_sub_u32 s46, s46, 90112
s_and_b32 s83, s40, 4
s_lshl_b32 s44, s83, 1
s_add_u32 s44, s44, s42
s_add_u32 s43, s44, 0
s_mul_i32 s43, s43, 98304
s_add_u32 s68, s43, s46
s_add_u32 s43, s44, 1
s_mul_i32 s43, s43, 98304
s_add_u32 s69, s43, s46
s_add_u32 s43, s44, 16
s_mul_i32 s43, s43, 98304
s_add_u32 s70, s43, s46
s_add_u32 s43, s44, 17
s_mul_i32 s43, s43, 98304
s_add_u32 s71, s43, s46
s_mov_b32 s92, 2863311530
s_mov_b32 s94, 3435973836
s_mov_b32 s93, 2863311530
s_mov_b32 s95, 3435973836
s_mov_b32 s81, 59328
s_mov_b32 s76, 200000
v_mov_b32 v247, 8128
v_lshrrev_b32 v148, 5, v118
v_lshlrev_b32 v116, 8, v148
v_bfe_u32 v148, v118, 2, 2
v_lshl_add_u32 v116, v148, 6, v116
v_bfe_u32 v148, v118, 4, 1
v_lshl_add_u32 v116, v148, 5, v116
v_and_b32_e64 v148, 1, v118
v_lshl_add_u32 v116, v148, 4, v116
v_bfe_u32 v148, v118, 1, 1
v_lshl_add_u32 v116, v148, 3, v116
s_and_b32 s43, s40, 3
s_lshl_b32 s43, s43, 10
v_add_u32_e64 v117, s43, v250
s_add_u32 s43, s43, 16384
v_add_u32 v116, s43, v116
v_mov_b32 v224, 0
v_mov_b32 v225, 0
v_mov_b32 v226, 0
v_mov_b32 v227, 0
v_mov_b32 v228, 0
v_mov_b32 v229, 0
v_mov_b32 v230, 0
v_mov_b32 v231, 0
v_mov_b32 v232, 0
v_mov_b32 v233, 0
v_mov_b32 v234, 0
v_mov_b32 v235, 0
s_cmp_ge_u32 s40, 4
s_cbranch_scc1 Lwa
v_mov_b32 v65, 0
v_mov_b32 v67, 0
v_mov_b32 v68, 0
v_mov_b32 v70, 0
v_mov_b32 v72, 0
v_mov_b32 v73, 0
v_min_u32 v140, 35, v119
v_mul_u32_u24 v140, 200, v140
v_add_u32 v140, 156032, v140
v_and_b32 v141, 31, v119
v_lshlrev_b32 v141, 3, v141
v_bfe_u32 v142, v119, 5, 1
v_lshl_add_u32 v141, v142, 13, v141
v_add_u32 v141, 7936, v141
v_cmp_gt_u32 vcc, 64, v119
s_nop 1
v_cndmask_b32 v140, v141, v140, vcc
ds_write_b64 v140, v[72:73]
v_lshrrev_b32 v140, 1, v128
v_mul_u32_u24 v141, 57, v140
v_lshrrev_b32 v141, 11, v141
v_mul_u32_u24 v142, 171, v140
v_lshrrev_b32_e64 v142, 11, v142
v_mul_u32_u24 v140, 200, v140
v_mul_u32_u24 v142, 2336, v142
v_mul_u32_u24 v141, 2208, v141
v_sub_u32 v140, v140, v142
v_add_u32 v140, v140, v141
v_and_b32_e64 v141, 1, v128
v_lshl_add_u32 v140, v141, 5, v140
v_add_u32 v140, 156040, v140
v_and_b32 v120, 255, v119
v_lshlrev_b32 v121, 8, v120
v_add_u32 v0, 4, v121
v_cvt_f32_f16 v0, v0
v_add_u32 v1, 12, v121
v_cvt_f32_f16 v1, v1
v_add_u32 v2, 20, v121
v_cvt_f32_f16 v2, v2
v_add_u32 v3, 28, v121
v_cvt_f32_f16 v3, v3
v_add_u32 v4, 36, v121
v_cvt_f32_f16 v4, v4
v_add_u32 v5, 44, v121
v_cvt_f32_f16 v5, v5
v_add_u32 v6, 52, v121
v_cvt_f32_f16 v6, v6
v_add_u32 v7, 60, v121
v_cvt_f32_f16_e64 v7, v7
v_add_u32 v8, 68, v121
v_cvt_f32_f16_e64 v8, v8
v_add_u32 v9, 76, v121
v_cvt_f32_f16_e64 v9, v9
v_add_u32 v10, 84, v121
v_cvt_f32_f16_e64 v10, v10
v_add_u32 v11, 92, v121
v_cvt_f32_f16_e64 v11, v11
v_add_u32 v12, 100, v121
v_cvt_f32_f16_e64 v12, v12
v_add_u32 v13, 108, v121
v_cvt_f32_f16_e64 v13, v13
v_add_u32 v14, 116, v121
v_cvt_f32_f16_e64 v14, v14
v_add_u32 v15, 124, v121
v_cvt_f32_f16_e64 v15, v15
v_add_u32 v16, 132, v121
v_cvt_f32_f16_e64 v16, v16
v_add_u32 v17, 140, v121
v_cvt_f32_f16_e64 v17, v17
v_add_u32 v18, 148, v121
v_cvt_f32_f16_e64 v18, v18
v_add_u32 v19, 156, v121
v_cvt_f32_f16_e64 v19, v19
v_add_u32 v20, 164, v121
v_cvt_f32_f16_e64 v20, v20
v_add_u32 v21, 172, v121
v_cvt_f32_f16_e64 v21, v21
v_add_u32 v22, 180, v121
v_cvt_f32_f16_e64 v22, v22
v_add_u32 v23, 188, v121
v_cvt_f32_f16_e64 v23, v23
v_add_u32 v24, 196, v121
v_cvt_f32_f16_e64 v24, v24
v_add_u32 v25, 204, v121
v_cvt_f32_f16_e64 v25, v25
v_add_u32 v26, 212, v121
v_cvt_f32_f16_e64 v26, v26
v_add_u32 v27, 220, v121
v_cvt_f32_f16_e64 v27, v27
v_add_u32 v28, 228, v121
v_cvt_f32_f16_e64 v28, v28
v_add_u32 v29, 236, v121
v_cvt_f32_f16_e64 v29, v29
v_add_u32 v30, 244, v121
v_cvt_f32_f16_e64 v30, v30
v_add_u32 v31, 252, v121
v_cvt_f32_f16_e64 v31, v31
v_fmaak_f32 v32, v0, v0, 0x409d30fc
v_mul_f32_e64 v32, v0, v32
v_fmaak_f32 v33, v1, v1, 0x409d30fc
v_mul_f32_e64 v33, v1, v33
v_fmaak_f32 v34, v2, v2, 0x409d30fc
v_mul_f32_e64 v34, v2, v34
v_fmaak_f32 v35, v3, v3, 0x409d30fc
v_mul_f32_e64 v35, v3, v35
v_fmaak_f32 v36, v4, v4, 0x409d30fc
v_mul_f32_e64 v36, v4, v36
v_fmaak_f32 v37, v5, v5, 0x409d30fc
v_mul_f32_e64 v37, v5, v37
v_fmaak_f32 v38, v6, v6, 0x409d30fc
v_mul_f32_e64 v38, v6, v38
v_fmaak_f32 v39, v7, v7, 0x409d30fc
v_mul_f32_e64 v39, v7, v39
v_fmaak_f32 v40, v8, v8, 0x409d30fc
v_mul_f32_e64 v40, v8, v40
v_fmaak_f32 v41, v9, v9, 0x409d30fc
v_mul_f32_e64 v41, v9, v41
v_fmaak_f32 v42, v10, v10, 0x409d30fc
v_mul_f32_e64 v42, v10, v42
v_fmaak_f32 v43, v11, v11, 0x409d30fc
v_mul_f32_e64 v43, v11, v43
v_fmaak_f32 v44, v12, v12, 0x409d30fc
v_mul_f32_e64 v44, v12, v44
v_fmaak_f32 v45, v13, v13, 0x409d30fc
v_mul_f32_e64 v45, v13, v45
v_fmaak_f32 v46, v14, v14, 0x409d30fc
v_mul_f32_e64 v46, v14, v46
v_fmaak_f32 v47, v15, v15, 0x409d30fc
v_mul_f32_e64 v47, v15, v47
v_fmaak_f32 v48, v16, v16, 0x409d30fc
v_mul_f32_e64 v48, v16, v48
v_fmaak_f32 v49, v17, v17, 0x409d30fc
v_mul_f32_e64 v49, v17, v49
v_fmaak_f32 v50, v18, v18, 0x409d30fc
v_mul_f32_e64 v50, v18, v50
v_fmaak_f32 v51, v19, v19, 0x409d30fc
v_mul_f32_e64 v51, v19, v51
v_fmaak_f32 v52, v20, v20, 0x409d30fc
v_mul_f32_e64 v52, v20, v52
v_fmaak_f32 v53, v21, v21, 0x409d30fc
v_mul_f32_e64 v53, v21, v53
v_fmaak_f32 v54, v22, v22, 0x409d30fc
v_mul_f32_e64 v54, v22, v54
v_fmaak_f32 v55, v23, v23, 0x409d30fc
v_mul_f32_e64 v55, v23, v55
v_fmaak_f32 v56, v24, v24, 0x409d30fc
v_mul_f32_e64 v56, v24, v56
v_fmaak_f32 v57, v25, v25, 0x409d30fc
v_mul_f32_e64 v57, v25, v57
v_fmaak_f32 v58, v26, v26, 0x409d30fc
v_mul_f32_e64 v58, v26, v58
v_fmaak_f32 v59, v27, v27, 0x409d30fc
v_mul_f32_e64 v59, v27, v59
v_fmaak_f32 v60, v28, v28, 0x409d30fc
v_mul_f32_e64 v60, v28, v60
v_fmaak_f32 v61, v29, v29, 0x409d30fc
v_mul_f32_e64 v61, v29, v61
v_fmaak_f32 v62, v30, v30, 0x409d30fc
v_mul_f32_e64 v62, v30, v62
v_fmaak_f32 v63, v31, v31, 0x409d30fc
v_mul_f32 v63, v31, v63
v_exp_f32 v32, v32
v_exp_f32 v33, v33
v_exp_f32 v34, v34
v_exp_f32 v35, v35
v_exp_f32 v36, v36
v_exp_f32 v37, v37
v_exp_f32 v38, v38
v_exp_f32 v39, v39
v_exp_f32 v40, v40
v_exp_f32 v41, v41
v_exp_f32 v42, v42
v_exp_f32 v43, v43
v_exp_f32 v44, v44
v_exp_f32 v45, v45
v_exp_f32 v46, v46
v_exp_f32 v47, v47
v_exp_f32 v48, v48
v_exp_f32 v49, v49
v_exp_f32 v50, v50
v_exp_f32 v51, v51
v_exp_f32 v52, v52
v_exp_f32 v53, v53
v_exp_f32 v54, v54
v_exp_f32 v55, v55
v_exp_f32 v56, v56
v_exp_f32 v57, v57
v_exp_f32 v58, v58
v_exp_f32 v59, v59
v_exp_f32 v60, v60
v_exp_f32 v61, v61
v_exp_f32 v62, v62
v_exp_f32 v63, v63
v_add_f32 v32, 1.0, v32
v_add_f32 v33, 1.0, v33
v_add_f32 v34, 1.0, v34
v_add_f32 v35, 1.0, v35
v_add_f32 v36, 1.0, v36
v_add_f32 v37, 1.0, v37
v_add_f32 v38, 1.0, v38
v_add_f32 v39, 1.0, v39
v_add_f32 v40, 1.0, v40
v_add_f32 v41, 1.0, v41
v_add_f32 v42, 1.0, v42
v_add_f32 v43, 1.0, v43
v_add_f32 v44, 1.0, v44
v_add_f32 v45, 1.0, v45
v_add_f32 v46, 1.0, v46
v_add_f32 v47, 1.0, v47
v_add_f32 v48, 1.0, v48
v_add_f32 v49, 1.0, v49
v_add_f32 v50, 1.0, v50
v_add_f32 v51, 1.0, v51
v_add_f32 v52, 1.0, v52
v_add_f32 v53, 1.0, v53
v_add_f32 v54, 1.0, v54
v_add_f32 v55, 1.0, v55
v_add_f32 v56, 1.0, v56
v_add_f32 v57, 1.0, v57
v_add_f32 v58, 1.0, v58
v_add_f32 v59, 1.0, v59
v_add_f32 v60, 1.0, v60
v_add_f32 v61, 1.0, v61
v_add_f32 v62, 1.0, v62
v_add_f32 v63, 1.0, v63
v_rcp_f32 v32, v32
v_rcp_f32 v33, v33
v_rcp_f32 v34, v34
v_rcp_f32 v35, v35
v_rcp_f32 v36, v36
v_rcp_f32 v37, v37
v_rcp_f32 v38, v38
v_rcp_f32 v39, v39
v_rcp_f32 v40, v40
v_rcp_f32 v41, v41
v_rcp_f32 v42, v42
v_rcp_f32 v43, v43
v_rcp_f32 v44, v44
v_rcp_f32 v45, v45
v_rcp_f32 v46, v46
v_rcp_f32 v47, v47
v_rcp_f32 v48, v48
v_rcp_f32 v49, v49
v_rcp_f32 v50, v50
v_rcp_f32 v51, v51
v_rcp_f32 v52, v52
v_rcp_f32 v53, v53
v_rcp_f32 v54, v54
v_rcp_f32 v55, v55
v_rcp_f32 v56, v56
v_rcp_f32 v57, v57
v_rcp_f32 v58, v58
v_rcp_f32 v59, v59
v_rcp_f32 v60, v60
v_rcp_f32 v61, v61
v_rcp_f32 v62, v62
v_rcp_f32 v63, v63
v_mul_f32 v0, v0, v32
v_mul_f32 v1, v1, v33
v_mul_f32 v2, v2, v34
v_mul_f32 v3, v3, v35
v_mul_f32 v4, v4, v36
v_mul_f32 v5, v5, v37
v_mul_f32 v6, v6, v38
v_mul_f32 v7, v7, v39
v_mul_f32 v8, v8, v40
v_mul_f32 v9, v9, v41
v_mul_f32 v10, v10, v42
v_mul_f32 v11, v11, v43
v_mul_f32 v12, v12, v44
v_mul_f32 v13, v13, v45
v_mul_f32 v14, v14, v46
v_mul_f32 v15, v15, v47
v_mul_f32 v16, v16, v48
v_mul_f32 v17, v17, v49
v_mul_f32 v18, v18, v50
v_mul_f32 v19, v19, v51
v_mul_f32 v20, v20, v52
v_mul_f32 v21, v21, v53
v_mul_f32 v22, v22, v54
v_mul_f32 v23, v23, v55
v_mul_f32 v24, v24, v56
v_mul_f32 v25, v25, v57
v_mul_f32 v26, v26, v58
v_mul_f32 v27, v27, v59
v_mul_f32 v28, v28, v60
v_mul_f32 v29, v29, v61
v_mul_f32 v30, v30, v62
v_mul_f32_e64 v31, v31, v63
v_cvt_pk_f16_f32 v32, v0, v1
v_cvt_pk_f16_f32 v33, v2, v3
v_cvt_pk_f16_f32 v34, v4, v5
v_cvt_pk_f16_f32 v35, v6, v7
v_cvt_pk_f16_f32 v36, v8, v9
v_cvt_pk_f16_f32 v37, v10, v11
v_cvt_pk_f16_f32 v38, v12, v13
v_cvt_pk_f16_f32 v39, v14, v15
v_cvt_pk_f16_f32 v40, v16, v17
v_cvt_pk_f16_f32 v41, v18, v19
v_cvt_pk_f16_f32 v42, v20, v21
v_cvt_pk_f16_f32 v43, v22, v23
v_cvt_pk_f16_f32 v44, v24, v25
v_cvt_pk_f16_f32 v45, v26, v27
v_cvt_pk_f16_f32 v46, v28, v29
v_cvt_pk_f16_f32 v47, v30, v31
v_add_u32 v32, 131074, v32
v_and_b32 v32, 4294770684, v32
v_add_u32 v33, 131074, v33
v_and_b32 v33, 4294770684, v33
v_add_u32 v34, 131074, v34
v_and_b32 v34, 4294770684, v34
v_add_u32 v35, 131074, v35
v_and_b32 v35, 4294770684, v35
v_add_u32 v36, 131074, v36
v_and_b32 v36, 4294770684, v36
v_add_u32 v37, 131074, v37
v_and_b32 v37, 4294770684, v37
v_add_u32 v38, 131074, v38
v_and_b32 v38, 4294770684, v38
v_add_u32 v39, 131074, v39
v_and_b32 v39, 4294770684, v39
v_add_u32 v40, 131074, v40
v_and_b32 v40, 4294770684, v40
v_add_u32 v41, 131074, v41
v_and_b32 v41, 4294770684, v41
v_add_u32 v42, 131074, v42
v_and_b32 v42, 4294770684, v42
v_add_u32 v43, 131074, v43
v_and_b32 v43, 4294770684, v43
v_add_u32 v44, 131074, v44
v_and_b32 v44, 4294770684, v44
v_add_u32 v45, 131074, v45
v_and_b32 v45, 4294770684, v45
v_add_u32 v46, 131074, v46
v_and_b32 v46, 4294770684, v46
v_add_u32 v47, 131074, v47
v_and_b32 v47, 4294770684, v47
v_lshlrev_b32 v121, 6, v120
v_bfe_u32 v120, v120, 2, 5
v_cmp_ne_u32 vcc, 31, v120
s_and_saveexec_b64 s[74:75], vcc
ds_write_b128 v121, v[32:35]
ds_write_b128 v121, v[36:39] offset:16
ds_write_b128 v121, v[40:43] offset:32
ds_write_b128 v121, v[44:47] offset:48
s_mov_b64 exec, s[74:75]
s_waitcnt vmcnt(10)
v_and_b32 v64, 65535, v126
ds_write_b64 v140, v[64:65]
v_and_b32 v66, 4294901760, v126
ds_write_b64 v140, v[66:67] offset:8
v_and_b32 v69, 65535, v127
ds_write_b64 v140, v[68:69] offset:16
v_and_b32 v71, 4294901760, v127
ds_write_b64 v140, v[70:71] offset:24
s_waitcnt vmcnt(0) lgkmcnt(0)
s_barrier
Lwa:
s_cmp_lt_u32 s40, 4
s_cbranch_scc1 Lsu1
s_waitcnt vmcnt(14)
v_add_u32 v113, 65536, v116
v_add_u32 v114, 65536, v117
ds_read_b64_tr_b16 v[0:1], v116
ds_read_b64_tr_b16 v[2:3], v116 offset:512
ds_read_b64_tr_b16 v[4:5], v116 offset:4096
ds_read_b64_tr_b16 v[6:7], v116 offset:4608
ds_read_b64_tr_b16 v[8:9], v116 offset:8192
ds_read_b64_tr_b16 v[10:11], v116 offset:8704
ds_read_b64_tr_b16 v[12:13], v116 offset:12288
ds_read_b64_tr_b16 v[14:15], v116 offset:12800
ds_read_b64_tr_b16 v[16:17], v116 offset:16384
ds_read_b64_tr_b16 v[18:19], v116 offset:16896
ds_read_b64_tr_b16 v[20:21], v116 offset:20480
ds_read_b64_tr_b16 v[22:23], v116 offset:20992
s_waitcnt lgkmcnt(10)
ds_write_b128 v117, v[0:3]
s_waitcnt lgkmcnt(9)
ds_write_b128 v117, v[4:7] offset:4096
s_waitcnt lgkmcnt(8)
ds_write_b128 v117, v[8:11] offset:8192
s_waitcnt lgkmcnt(7)
ds_write_b128 v117, v[12:15] offset:12288
s_waitcnt lgkmcnt(6)
ds_write_b128 v117, v[16:19] offset:16384
s_waitcnt lgkmcnt(5)
ds_write_b128 v117, v[20:23] offset:20480
v_mov_b32_e64 v223, 1
s_waitcnt lgkmcnt(0)
s_mov_b64 exec, 1
ds_add_u32 v247, v223 offset:8
s_mov_b64 exec, -1
s_nop 0
v_mov_b32_e64 v223, 0
s_branch Law1
Lax1:
s_sleep 2
Law1:
ds_read_b32 v223, v247 offset:16
s_sub_u32 s76, s76, 1
s_cselect_b32 s44, 4, 0
s_cselect_b32 s76, 0, s76
s_waitcnt lgkmcnt(0)
v_readfirstlane_b32 s43, v223
s_nop 1
s_max_u32 s43, s43, s44
s_cmp_lt_u32 s43, 4
s_cbranch_scc1 Lax1
s_add_u32 s81, s81, 6592
s_cmp_eq_u32 s81, 65920
s_cselect_b32 s81, 0, s81
s_add_u32 s43, s81, s67
s_add_u32 m0, s43, 16
s_add_u32 s66, s66, 98304
buffer_load_dwordx4 v236, s[4:7], s66 offen lds
s_add_u32 m0, s43, 912
s_nop 0
buffer_load_dwordx4 v237, s[4:7], s66 offen lds
s_add_u32 s81, s81, 6592
s_cmp_eq_u32 s81, 65920
s_cselect_b32 s81, 0, s81
s_add_u32 s43, s81, s67
s_add_u32 m0, s43, 16
s_add_u32 s66, s66, 98304
buffer_load_dwordx4 v236, s[4:7], s66 offen lds
s_add_u32 m0, s43, 912
s_nop 0
buffer_load_dwordx4 v237, s[4:7], s66 offen lds
s_add_u32 s81, s81, 6592
s_cmp_eq_u32 s81, 65920
s_cselect_b32 s81, 0, s81
s_add_u32 s43, s81, s67
s_add_u32 m0, s43, 32
s_add_u32 s66, s66, 98304
buffer_load_dwordx4 v236, s[4:7], s66 offen lds
s_add_u32 m0, s43, 928
s_nop 0
buffer_load_dwordx4 v237, s[4:7], s66 offen lds
s_add_u32 s81, s81, 6592
s_cmp_eq_u32 s81, 65920
s_cselect_b32 s81, 0, s81
s_add_u32 s43, s81, s67
s_add_u32 m0, s43, 32
s_add_u32 s66, s66, 98304
buffer_load_dwordx4 v236, s[4:7], s66 offen lds
s_add_u32 m0, s43, 928
s_nop 0
buffer_load_dwordx4 v237, s[4:7], s66 offen lds
s_add_u32 s81, s81, 6592
s_cmp_eq_u32 s81, 65920
s_cselect_b32 s81, 0, s81
s_add_u32 s43, s81, s67
s_add_u32 m0, s43, 48
s_add_u32 s66, s66, 98304
buffer_load_dwordx4 v236, s[4:7], s66 offen lds
s_add_u32 m0, s43, 944
s_nop 0
buffer_load_dwordx4 v237, s[4:7], s66 offen lds
s_add_u32 s81, s81, 6592
s_cmp_eq_u32 s81, 65920
s_cselect_b32 s81, 0, s81
s_add_u32 s43, s81, s67
s_add_u32 m0, s43, 48
s_add_u32 s66, s66, 98304
buffer_load_dwordx4 v236, s[4:7], s66 offen lds
s_add_u32 m0, s43, 944
s_nop 0
buffer_load_dwordx4 v237, s[4:7], s66 offen lds
s_add_u32 s81, s81, 6592
s_cmp_eq_u32 s81, 65920
s_cselect_b32 s81, 0, s81
s_add_u32 s43, s81, s67
s_add_u32 m0, s43, 0
s_add_u32 s66, s66, 98304
buffer_load_dwordx4 v236, s[4:7], s66 offen lds
s_add_u32 m0, s43, 896
s_nop 0
buffer_load_dwordx4 v237, s[4:7], s66 offen lds
s_add_u32 s81, s81, 6592
s_cmp_eq_u32 s81, 65920
s_cselect_b32 s81, 0, s81
s_add_u32 s43, s81, s67
s_add_u32 m0, s43, 0
s_add_u32 s66, s66, 98304
buffer_load_dwordx4 v236, s[4:7], s66 offen lds
s_add_u32 m0, s43, 896
s_nop 0
buffer_load_dwordx4 v237, s[4:7], s66 offen lds
s_waitcnt vmcnt(16)
v_add_u32 v113, 65536, v116
v_add_u32 v114, 65536, v117
ds_read_b64_tr_b16 v[0:1], v116 offset:24576
ds_read_b64_tr_b16 v[2:3], v116 offset:25088
ds_read_b64_tr_b16 v[4:5], v116 offset:28672
ds_read_b64_tr_b16 v[6:7], v116 offset:29184
ds_read_b64_tr_b16 v[8:9], v116 offset:32768
ds_read_b64_tr_b16 v[10:11], v116 offset:33280
ds_read_b64_tr_b16 v[12:13], v116 offset:36864
ds_read_b64_tr_b16 v[14:15], v116 offset:37376
ds_read_b64_tr_b16 v[16:17], v116 offset:40960
ds_read_b64_tr_b16 v[18:19], v116 offset:41472
ds_read_b64_tr_b16 v[20:21], v116 offset:45056
ds_read_b64_tr_b16 v[22:23], v116 offset:45568
ds_read_b64_tr_b16 v[24:25], v116 offset:49152
ds_read_b64_tr_b16 v[26:27], v116 offset:49664
ds_read_b64_tr_b16 v[28:29], v116 offset:53248
s_waitcnt lgkmcnt(14)
ds_read_b64_tr_b16 v[30:31], v116 offset:53760
s_waitcnt lgkmcnt(14)
ds_read_b64_tr_b16 v[32:33], v116 offset:57344
s_waitcnt lgkmcnt(14)
ds_read_b64_tr_b16 v[34:35], v116 offset:57856
s_waitcnt lgkmcnt(14)
ds_read_b64_tr_b16 v[36:37], v116 offset:61440
s_waitcnt lgkmcnt(14)
ds_read_b64_tr_b16 v[38:39], v116 offset:61952
s_waitcnt lgkmcnt(14)
ds_read_b64_tr_b16 v[40:41], v113
s_waitcnt lgkmcnt(14)
ds_read_b64_tr_b16 v[42:43], v113 offset:512
s_waitcnt lgkmcnt(14)
ds_read_b64_tr_b16 v[44:45], v113 offset:4096
s_waitcnt lgkmcnt(14)
ds_read_b64_tr_b16 v[46:47], v113 offset:4608
s_waitcnt lgkmcnt(14)
ds_write_b128 v117, v[0:3] offset:24576
s_waitcnt lgkmcnt(14)
ds_write_b128 v117, v[4:7] offset:28672
s_waitcnt lgkmcnt(14)
ds_write_b128 v117, v[8:11] offset:32768
s_waitcnt lgkmcnt(14)
ds_write_b128 v117, v[12:15] offset:36864
s_waitcnt lgkmcnt(14)
ds_write_b128 v117, v[16:19] offset:40960
s_waitcnt lgkmcnt(14)
ds_write_b128 v117, v[20:23] offset:45056
s_waitcnt lgkmcnt(14)
ds_write_b128 v117, v[24:27] offset:49152
s_waitcnt lgkmcnt(14)
ds_write_b128 v117, v[28:31] offset:53248
s_waitcnt lgkmcnt(14)
ds_write_b128 v117, v[32:35] offset:57344
s_waitcnt lgkmcnt(14)
s_waitcnt lgkmcnt(13)
ds_write_b128 v117, v[36:39] offset:61440
s_waitcnt lgkmcnt(12)
ds_write_b128 v114, v[40:43]
s_waitcnt lgkmcnt(11)
ds_write_b128 v114, v[44:47] offset:4096
v_mov_b32 v223, 1
s_waitcnt lgkmcnt(0)
s_mov_b64 exec, 1
ds_add_u32 v247, v223 offset:12
s_mov_b64 exec, -1
s_cmp_lg_u32 s40, 7
s_cbranch_scc1 Lnosent
v_bfe_u32 v104, v250, 4, 6
v_mov_b32 v108, -1
v_mov_b32 v109, -1
v_mov_b32 v110, -1
v_mov_b32 v111, -1
v_lshlrev_b32_e64 v100, 12, v104
v_add_u32 v101, 262144, v100
v_cmp_gt_u32 vcc, 32, v104
v_mov_b32 v105, 2147483648
s_nop 0
v_cndmask_b32 v101, v105, v101, vcc
s_lshl_b32 s43, s2, 4
buffer_store_dwordx4 v[108:111], v100, s[32:35], s43 offen sc1
buffer_store_dwordx4 v[108:111], v101, s[32:35], s43 offen sc1
s_add_u32 s43, s43, 393216
s_cmp_lt_u32 s2, 96
s_cselect_b32 s43, s43, 1073741824
v_lshlrev_b32 v103, 11, v104
s_mov_b64 exec, 0xff
buffer_store_dwordx4 v[108:111], v103, s[32:35], s43 offen sc1
s_mov_b64 exec, -1
s_nop 1
Lnosent:
s_setprio 3
s_waitcnt vmcnt(0)
Lsu1:
s_add_u32 s43, s81, 6592
v_add_u32_e64 v212, s43, v246
v_subrev_u32 v222, 65920, v212
v_min_u32_e64 v212, v212, v222
v_add_u32 v212, 90112, v212
v_add_u32_e64 v213, s43, v246
v_add_u32 v213, 6592, v213
v_subrev_u32 v222, 65920, v213
v_min_u32_e64 v213, v213, v222
v_add_u32 v213, 90112, v213
v_add_u32_e64 v214, s43, v246
v_add_u32 v214, 13184, v214
v_add_u32_e64 v222, 16, v214
v_bfi_b32 v214, 48, v222, v214
v_subrev_u32 v222, 65920, v214
v_min_u32_e64 v214, v214, v222
v_add_u32 v214, 90112, v214
v_add_u32_e64 v215, s43, v246
v_add_u32 v215, 19776, v215
v_add_u32_e64 v222, 16, v215
v_bfi_b32 v215, 48, v222, v215
v_subrev_u32 v222, 65920, v215
v_min_u32 v215, v215, v222
v_add_u32 v215, 90112, v215
ds_read_b128 v[144:147], v212
ds_read_b64 v[192:193], v238
ds_read_b64 v[194:195], v239
ds_read_b128 v[148:151], v213
ds_read_b128 v[152:155], v214
ds_read_b64 v[196:197], v238 offset:2400
ds_read_b64 v[198:199], v239 offset:2400
ds_read_b128 v[156:159], v215
ds_read_b64 v[200:201], v238 offset:4800
ds_read_b64 v[202:203], v239 offset:4800
ds_read_b128 v[160:163], v212 offset:16
ds_read_b64 v[204:205], v238 offset:200
ds_read_b64 v[206:207], v239 offset:200
ds_read_b128 v[164:167], v213 offset:16
ds_read_b128 v[168:171], v214 offset:16
s_waitcnt lgkmcnt(14)
ds_read_b64 v[208:209], v238 offset:2600
s_waitcnt lgkmcnt(13)
v_mfma_f32_16x16x32_bf16 v[0:3], v[192:195], v[144:147], 0
ds_read_b64 v[210:211], v239 offset:2600
ds_read_b128 v[172:175], v215 offset:16
s_waitcnt lgkmcnt(14)
v_mfma_f32_16x16x32_bf16 v[48:51], v[192:195], v[148:151], 0
ds_read_b64 v[192:193], v238 offset:5000
s_waitcnt lgkmcnt(14)
ds_read_b64 v[194:195], v239 offset:5000
s_waitcnt lgkmcnt(13)
v_mfma_f32_16x16x32_bf16 v[0:3], v[196:199], v[148:151], v[0:3]
ds_read_b128 v[144:147], v212 offset:32
ds_read_b128 v[148:151], v213 offset:32
v_mfma_f32_16x16x32_bf16 v[48:51], v[196:199], v[152:155], v[48:51]
s_waitcnt lgkmcnt(14)
ds_read_b64 v[196:197], v238 offset:400
s_waitcnt lgkmcnt(14)
ds_read_b64 v[198:199], v239 offset:400
s_waitcnt lgkmcnt(14)
v_mfma_f32_16x16x32_bf16 v[0:3], v[200:203], v[152:155], v[0:3]
ds_read_b128 v[152:155], v214 offset:32
v_mfma_f32_16x16x32_bf16 v[48:51], v[200:203], v[156:159], v[48:51]
s_waitcnt lgkmcnt(14)
ds_read_b64 v[200:201], v238 offset:2800
s_waitcnt lgkmcnt(14)
ds_read_b64 v[202:203], v239 offset:2800
s_waitcnt lgkmcnt(14)
v_mfma_f32_16x16x32_bf16 v[4:7], v[204:207], v[160:163], 0
ds_read_b128 v[156:159], v215 offset:32
s_waitcnt lgkmcnt(14)
v_mfma_f32_16x16x32_bf16 v[52:55], v[204:207], v[164:167], 0
ds_read_b64 v[204:205], v238 offset:5200
s_waitcnt lgkmcnt(14)
ds_read_b64 v[206:207], v239 offset:5200
s_waitcnt lgkmcnt(13)
v_mfma_f32_16x16x32_bf16 v[4:7], v[208:211], v[164:167], v[4:7]
ds_read_b128 v[160:163], v212 offset:48
ds_read_b128 v[164:167], v213 offset:48
v_mfma_f32_16x16x32_bf16 v[52:55], v[208:211], v[168:171], v[52:55]
s_waitcnt lgkmcnt(14)
ds_read_b64 v[208:209], v238 offset:600
s_waitcnt lgkmcnt(14)
ds_read_b64 v[210:211], v239 offset:600
s_waitcnt lgkmcnt(14)
v_mfma_f32_16x16x32_bf16 v[4:7], v[192:195], v[168:171], v[4:7]
ds_read_b128 v[168:171], v214 offset:48
v_mfma_f32_16x16x32_bf16 v[52:55], v[192:195], v[172:175], v[52:55]
s_waitcnt lgkmcnt(14)
ds_read_b64 v[192:193], v238 offset:3000
s_waitcnt lgkmcnt(14)
ds_read_b64 v[194:195], v239 offset:3000
s_waitcnt lgkmcnt(13)
v_mfma_f32_16x16x32_bf16 v[8:11], v[196:199], v[144:147], 0
ds_read_b128 v[172:175], v215 offset:48
ds_read_b128 v[144:147], v212 offset:64
v_mfma_f32_16x16x32_bf16 v[56:59], v[196:199], v[148:151], 0
s_waitcnt lgkmcnt(14)
ds_read_b64 v[196:197], v238 offset:5400
s_waitcnt lgkmcnt(14)
ds_read_b64 v[198:199], v239 offset:5400
s_waitcnt lgkmcnt(14)
v_mfma_f32_16x16x32_bf16 v[8:11], v[200:203], v[148:151], v[8:11]
ds_read_b128 v[148:151], v213 offset:64
v_mfma_f32_16x16x32_bf16 v[56:59], v[200:203], v[152:155], v[56:59]
s_waitcnt lgkmcnt(14)
ds_read_b64 v[200:201], v238 offset:800
s_waitcnt lgkmcnt(14)
ds_read_b64 v[202:203], v239 offset:800
s_waitcnt lgkmcnt(14)
v_mfma_f32_16x16x32_bf16 v[8:11], v[204:207], v[152:155], v[8:11]
ds_read_b128 v[152:155], v214 offset:64
v_mfma_f32_16x16x32_bf16 v[56:59], v[204:207], v[156:159], v[56:59]
s_waitcnt lgkmcnt(14)
ds_read_b64 v[204:205], v238 offset:3200
s_waitcnt lgkmcnt(14)
ds_read_b64 v[206:207], v239 offset:3200
s_waitcnt lgkmcnt(13)
v_mfma_f32_16x16x32_bf16 v[12:15], v[208:211], v[160:163], 0
ds_read_b128 v[156:159], v215 offset:64
ds_read_b128 v[160:163], v212 offset:80
v_mfma_f32_16x16x32_bf16 v[60:63], v[208:211], v[164:167], 0
s_waitcnt lgkmcnt(14)
ds_read_b64 v[208:209], v238 offset:5600
s_waitcnt lgkmcnt(14)
ds_read_b64 v[210:211], v239 offset:5600
s_waitcnt lgkmcnt(14)
v_mfma_f32_16x16x32_bf16 v[12:15], v[192:195], v[164:167], v[12:15]
ds_read_b128 v[164:167], v213 offset:80
v_mfma_f32_16x16x32_bf16 v[60:63], v[192:195], v[168:171], v[60:63]
s_waitcnt lgkmcnt(14)
ds_read_b64 v[192:193], v238 offset:1000
s_waitcnt lgkmcnt(14)
ds_read_b64 v[194:195], v239 offset:1000
s_waitcnt lgkmcnt(13)
v_mfma_f32_16x16x32_bf16 v[12:15], v[196:199], v[168:171], v[12:15]
ds_read_b128 v[168:171], v214 offset:80
v_mfma_f32_16x16x32_bf16 v[60:63], v[196:199], v[172:175], v[60:63]
ds_read_b64 v[196:197], v238 offset:3400
s_waitcnt lgkmcnt(14)
ds_read_b64 v[198:199], v239 offset:3400
s_waitcnt lgkmcnt(13)
v_mfma_f32_16x16x32_bf16 v[16:19], v[200:203], v[144:147], 0
ds_read_b128 v[172:175], v215 offset:80
ds_read_b128 v[144:147], v212 offset:96
v_mfma_f32_16x16x32_bf16 v[64:67], v[200:203], v[148:151], 0
s_waitcnt lgkmcnt(14)
ds_read_b64 v[200:201], v238 offset:5800
s_waitcnt lgkmcnt(14)
ds_read_b64 v[202:203], v239 offset:5800
s_waitcnt lgkmcnt(14)
v_mfma_f32_16x16x32_bf16 v[16:19], v[204:207], v[148:151], v[16:19]
ds_read_b128 v[148:151], v213 offset:96
v_mfma_f32_16x16x32_bf16 v[64:67], v[204:207], v[152:155], v[64:67]
s_waitcnt lgkmcnt(14)
ds_read_b64 v[204:205], v238 offset:1200
s_waitcnt lgkmcnt(14)
ds_read_b64 v[206:207], v239 offset:1200
s_waitcnt lgkmcnt(13)
v_mfma_f32_16x16x32_bf16 v[16:19], v[208:211], v[152:155], v[16:19]
ds_read_b128 v[152:155], v214 offset:96
v_mfma_f32_16x16x32_bf16 v[64:67], v[208:211], v[156:159], v[64:67]
ds_read_b64 v[208:209], v238 offset:3600
s_waitcnt lgkmcnt(14)
ds_read_b64 v[210:211], v239 offset:3600
s_waitcnt lgkmcnt(13)
v_mfma_f32_16x16x32_bf16 v[20:23], v[192:195], v[160:163], 0
ds_read_b128 v[156:159], v215 offset:96
ds_read_b128 v[160:163], v212 offset:112
v_mfma_f32_16x16x32_bf16 v[68:71], v[192:195], v[164:167], 0
s_waitcnt lgkmcnt(14)
ds_read_b64 v[192:193], v238 offset:6000
s_waitcnt lgkmcnt(14)
ds_read_b64 v[194:195], v239 offset:6000
s_waitcnt lgkmcnt(14)
v_mfma_f32_16x16x32_bf16 v[20:23], v[196:199], v[164:167], v[20:23]
ds_read_b128 v[164:167], v213 offset:112
v_mfma_f32_16x16x32_bf16 v[68:71], v[196:199], v[168:171], v[68:71]
s_waitcnt lgkmcnt(14)
ds_read_b64 v[196:197], v238 offset:1400
s_waitcnt lgkmcnt(14)
ds_read_b64 v[198:199], v239 offset:1400
s_waitcnt lgkmcnt(13)
v_mfma_f32_16x16x32_bf16 v[20:23], v[200:203], v[168:171], v[20:23]
ds_read_b128 v[168:171], v214 offset:112
v_mfma_f32_16x16x32_bf16 v[68:71], v[200:203], v[172:175], v[68:71]
ds_read_b64 v[200:201], v238 offset:3800
s_waitcnt lgkmcnt(14)
ds_read_b64 v[202:203], v239 offset:3800
s_waitcnt lgkmcnt(13)
v_mfma_f32_16x16x32_bf16 v[24:27], v[204:207], v[144:147], 0
ds_read_b128 v[172:175], v215 offset:112
ds_read_b128 v[144:147], v212 offset:128
v_mfma_f32_16x16x32_bf16 v[72:75], v[204:207], v[148:151], 0
s_waitcnt lgkmcnt(14)
ds_read_b64 v[204:205], v238 offset:6200
s_waitcnt lgkmcnt(14)
ds_read_b64 v[206:207], v239 offset:6200
s_waitcnt lgkmcnt(14)
v_mfma_f32_16x16x32_bf16 v[24:27], v[208:211], v[148:151], v[24:27]
ds_read_b128 v[148:151], v213 offset:128
v_mfma_f32_16x16x32_bf16 v[72:75], v[208:211], v[152:155], v[72:75]
s_waitcnt lgkmcnt(14)
ds_read_b64 v[208:209], v238 offset:1600
s_waitcnt lgkmcnt(14)
ds_read_b64 v[210:211], v239 offset:1600
s_waitcnt lgkmcnt(13)
v_mfma_f32_16x16x32_bf16 v[24:27], v[192:195], v[152:155], v[24:27]
ds_read_b128 v[152:155], v214 offset:128
v_mfma_f32_16x16x32_bf16 v[72:75], v[192:195], v[156:159], v[72:75]
ds_read_b64 v[192:193], v238 offset:4000
s_waitcnt lgkmcnt(14)
ds_read_b64 v[194:195], v239 offset:4000
s_waitcnt lgkmcnt(13)
v_mfma_f32_16x16x32_bf16 v[28:31], v[196:199], v[160:163], 0
ds_read_b128 v[156:159], v215 offset:128
ds_read_b128 v[160:163], v212 offset:144
v_mfma_f32_16x16x32_bf16 v[76:79], v[196:199], v[164:167], 0
s_waitcnt lgkmcnt(14)
ds_read_b64 v[196:197], v238 offset:6400
s_waitcnt lgkmcnt(14)
ds_read_b64 v[198:199], v239 offset:6400
s_waitcnt lgkmcnt(14)
v_mfma_f32_16x16x32_bf16 v[28:31], v[200:203], v[164:167], v[28:31]
ds_read_b128 v[164:167], v213 offset:144
v_mfma_f32_16x16x32_bf16 v[76:79], v[200:203], v[168:171], v[76:79]
s_waitcnt lgkmcnt(14)
ds_read_b64 v[200:201], v238 offset:1800
s_waitcnt lgkmcnt(14)
ds_read_b64 v[202:203], v239 offset:1800
s_waitcnt lgkmcnt(13)
v_mfma_f32_16x16x32_bf16 v[28:31], v[204:207], v[168:171], v[28:31]
ds_read_b128 v[168:171], v214 offset:144
v_mfma_f32_16x16x32_bf16 v[76:79], v[204:207], v[172:175], v[76:79]
ds_read_b64 v[204:205], v238 offset:4200
s_waitcnt lgkmcnt(14)
ds_read_b64 v[206:207], v239 offset:4200
s_waitcnt lgkmcnt(13)
v_mfma_f32_16x16x32_bf16 v[32:35], v[208:211], v[144:147], 0
ds_read_b128 v[172:175], v215 offset:144
ds_read_b128 v[144:147], v212 offset:160
v_mfma_f32_16x16x32_bf16 v[80:83], v[208:211], v[148:151], 0
s_waitcnt lgkmcnt(14)
ds_read_b64 v[208:209], v238 offset:6600
s_waitcnt lgkmcnt(14)
ds_read_b64 v[210:211], v239 offset:6600
s_waitcnt lgkmcnt(14)
v_mfma_f32_16x16x32_bf16 v[32:35], v[192:195], v[148:151], v[32:35]
ds_read_b128 v[148:151], v213 offset:160
v_mfma_f32_16x16x32_bf16 v[80:83], v[192:195], v[152:155], v[80:83]
s_waitcnt lgkmcnt(14)
ds_read_b64 v[192:193], v238 offset:2000
s_waitcnt lgkmcnt(14)
ds_read_b64 v[194:195], v239 offset:2000
s_waitcnt lgkmcnt(13)
v_mfma_f32_16x16x32_bf16 v[32:35], v[196:199], v[152:155], v[32:35]
ds_read_b128 v[152:155], v214 offset:160
v_mfma_f32_16x16x32_bf16 v[80:83], v[196:199], v[156:159], v[80:83]
ds_read_b64 v[196:197], v238 offset:4400
s_waitcnt lgkmcnt(14)
ds_read_b64 v[198:199], v239 offset:4400
s_waitcnt lgkmcnt(13)
v_mfma_f32_16x16x32_bf16 v[36:39], v[200:203], v[160:163], 0
ds_read_b128 v[156:159], v215 offset:160
ds_read_b128 v[160:163], v212 offset:176
v_mfma_f32_16x16x32_bf16 v[84:87], v[200:203], v[164:167], 0
s_waitcnt lgkmcnt(14)
ds_read_b64 v[200:201], v238 offset:6800
s_waitcnt lgkmcnt(14)
ds_read_b64 v[202:203], v239 offset:6800
s_waitcnt lgkmcnt(14)
v_mfma_f32_16x16x32_bf16 v[36:39], v[204:207], v[164:167], v[36:39]
ds_read_b128 v[164:167], v213 offset:176
v_mfma_f32_16x16x32_bf16 v[84:87], v[204:207], v[168:171], v[84:87]
s_waitcnt lgkmcnt(14)
ds_read_b64 v[204:205], v238 offset:2200
s_waitcnt lgkmcnt(14)
ds_read_b64 v[206:207], v239 offset:2200
s_waitcnt lgkmcnt(13)
v_mfma_f32_16x16x32_bf16 v[36:39], v[208:211], v[168:171], v[36:39]
ds_read_b128 v[168:171], v214 offset:176
v_mfma_f32_16x16x32_bf16 v[84:87], v[208:211], v[172:175], v[84:87]
ds_read_b64 v[208:209], v238 offset:4600
s_waitcnt lgkmcnt(14)
ds_read_b64 v[210:211], v239 offset:4600
s_waitcnt lgkmcnt(13)
v_mfma_f32_16x16x32_bf16 v[40:43], v[192:195], v[144:147], 0
ds_read_b128 v[172:175], v215 offset:176
v_mfma_f32_16x16x32_bf16 v[88:91], v[192:195], v[148:151], 0
ds_read_b64 v[192:193], v238 offset:7000
s_waitcnt lgkmcnt(14)
ds_read_b64 v[194:195], v239 offset:7000
s_waitcnt lgkmcnt(13)
v_mfma_f32_16x16x32_bf16 v[40:43], v[196:199], v[148:151], v[40:43]
v_mfma_f32_16x16x32_bf16 v[88:91], v[196:199], v[152:155], v[88:91]
s_waitcnt lgkmcnt(9)
v_mfma_f32_16x16x32_bf16 v[40:43], v[200:203], v[152:155], v[40:43]
v_mfma_f32_16x16x32_bf16 v[88:91], v[200:203], v[156:159], v[88:91]
s_waitcnt lgkmcnt(6)
v_mfma_f32_16x16x32_bf16 v[44:47], v[204:207], v[160:163], 0
v_mfma_f32_16x16x32_bf16 v[92:95], v[204:207], v[164:167], 0
s_waitcnt lgkmcnt(3)
v_mfma_f32_16x16x32_bf16 v[44:47], v[208:211], v[164:167], v[44:47]
v_mfma_f32_16x16x32_bf16 v[92:95], v[208:211], v[168:171], v[92:95]
s_waitcnt lgkmcnt(0)
v_mfma_f32_16x16x32_bf16 v[44:47], v[192:195], v[168:171], v[44:47]
v_mfma_f32_16x16x32_bf16 v[92:95], v[192:195], v[172:175], v[92:95]
v_mov_b32_e64 v223, 1
v_add_u32 v222, s83, v247
s_nop 7
s_mov_b64 exec, 1
ds_add_u32 v222, v223 offset:16
s_mov_b64 exec, -1
v_pk_mul_f32 v[242:243], v[0:1], v[0:1]
v_pk_add_f32 v[240:241], v[0:1], v[2:3]
v_pk_fma_f32 v[242:243], v[2:3], v[2:3], v[242:243]
v_pk_mul_f32 v[218:219], v[48:49], v[48:49]
v_pk_add_f32 v[216:217], v[48:49], v[50:51]
v_pk_fma_f32 v[218:219], v[50:51], v[50:51], v[218:219]
v_pk_fma_f32 v[242:243], v[4:5], v[4:5], v[242:243]
v_pk_add_f32 v[240:241], v[240:241], v[4:5]
v_pk_fma_f32 v[242:243], v[6:7], v[6:7], v[242:243]
v_pk_add_f32 v[240:241], v[240:241], v[6:7]
v_pk_fma_f32 v[218:219], v[52:53], v[52:53], v[218:219]
v_pk_add_f32 v[216:217], v[216:217], v[52:53]
v_pk_fma_f32 v[218:219], v[54:55], v[54:55], v[218:219]
v_pk_add_f32 v[216:217], v[216:217], v[54:55]
v_pk_fma_f32 v[242:243], v[8:9], v[8:9], v[242:243]
v_pk_add_f32 v[240:241], v[240:241], v[8:9]
v_pk_fma_f32 v[242:243], v[10:11], v[10:11], v[242:243]
v_pk_add_f32 v[240:241], v[240:241], v[10:11]
v_pk_fma_f32 v[218:219], v[56:57], v[56:57], v[218:219]
v_pk_add_f32 v[216:217], v[216:217], v[56:57]
v_pk_fma_f32 v[218:219], v[58:59], v[58:59], v[218:219]
v_pk_add_f32 v[216:217], v[216:217], v[58:59]
v_pk_fma_f32 v[242:243], v[12:13], v[12:13], v[242:243]
v_pk_add_f32 v[240:241], v[240:241], v[12:13]
v_pk_fma_f32 v[242:243], v[14:15], v[14:15], v[242:243]
v_pk_add_f32 v[240:241], v[240:241], v[14:15]
v_pk_fma_f32 v[218:219], v[60:61], v[60:61], v[218:219]
v_pk_add_f32 v[216:217], v[216:217], v[60:61]
v_pk_fma_f32 v[218:219], v[62:63], v[62:63], v[218:219]
v_pk_add_f32 v[216:217], v[216:217], v[62:63]
v_pk_fma_f32 v[242:243], v[16:17], v[16:17], v[242:243]
v_pk_add_f32 v[240:241], v[240:241], v[16:17]
v_pk_fma_f32 v[242:243], v[18:19], v[18:19], v[242:243]
v_pk_add_f32 v[240:241], v[240:241], v[18:19]
v_pk_fma_f32 v[218:219], v[64:65], v[64:65], v[218:219]
v_pk_add_f32 v[216:217], v[216:217], v[64:65]
v_pk_fma_f32 v[218:219], v[66:67], v[66:67], v[218:219]
v_pk_add_f32 v[216:217], v[216:217], v[66:67]
v_pk_fma_f32 v[242:243], v[20:21], v[20:21], v[242:243]
v_pk_add_f32 v[240:241], v[240:241], v[20:21]
v_pk_fma_f32 v[242:243], v[22:23], v[22:23], v[242:243]
v_pk_add_f32 v[240:241], v[240:241], v[22:23]
v_pk_fma_f32 v[218:219], v[68:69], v[68:69], v[218:219]
v_pk_add_f32 v[216:217], v[216:217], v[68:69]
v_pk_fma_f32 v[218:219], v[70:71], v[70:71], v[218:219]
v_pk_add_f32 v[216:217], v[216:217], v[70:71]
v_pk_fma_f32 v[242:243], v[24:25], v[24:25], v[242:243]
v_pk_add_f32 v[240:241], v[240:241], v[24:25]
v_pk_fma_f32 v[242:243], v[26:27], v[26:27], v[242:243]
v_pk_add_f32 v[240:241], v[240:241], v[26:27]
v_pk_fma_f32 v[218:219], v[72:73], v[72:73], v[218:219]
v_pk_add_f32 v[216:217], v[216:217], v[72:73]
v_pk_fma_f32 v[218:219], v[74:75], v[74:75], v[218:219]
v_pk_add_f32 v[216:217], v[216:217], v[74:75]
v_pk_fma_f32 v[242:243], v[28:29], v[28:29], v[242:243]
v_pk_add_f32 v[240:241], v[240:241], v[28:29]
v_pk_fma_f32 v[242:243], v[30:31], v[30:31], v[242:243]
v_pk_add_f32 v[240:241], v[240:241], v[30:31]
v_pk_fma_f32 v[218:219], v[76:77], v[76:77], v[218:219]
v_pk_add_f32 v[216:217], v[216:217], v[76:77]
v_pk_fma_f32 v[218:219], v[78:79], v[78:79], v[218:219]
v_pk_add_f32 v[216:217], v[216:217], v[78:79]
v_pk_fma_f32 v[242:243], v[32:33], v[32:33], v[242:243]
v_pk_add_f32 v[240:241], v[240:241], v[32:33]
v_pk_fma_f32 v[242:243], v[34:35], v[34:35], v[242:243]
v_pk_add_f32 v[240:241], v[240:241], v[34:35]
v_pk_fma_f32 v[218:219], v[80:81], v[80:81], v[218:219]
v_pk_add_f32 v[216:217], v[216:217], v[80:81]
v_pk_fma_f32 v[218:219], v[82:83], v[82:83], v[218:219]
v_pk_add_f32 v[216:217], v[216:217], v[82:83]
v_pk_fma_f32 v[242:243], v[36:37], v[36:37], v[242:243]
v_pk_add_f32 v[240:241], v[240:241], v[36:37]
v_pk_fma_f32 v[242:243], v[38:39], v[38:39], v[242:243]
v_pk_add_f32 v[240:241], v[240:241], v[38:39]
v_pk_fma_f32 v[218:219], v[84:85], v[84:85], v[218:219]
v_pk_add_f32 v[216:217], v[216:217], v[84:85]
v_pk_fma_f32 v[218:219], v[86:87], v[86:87], v[218:219]
v_pk_add_f32 v[216:217], v[216:217], v[86:87]
v_pk_fma_f32 v[242:243], v[40:41], v[40:41], v[242:243]
v_pk_add_f32 v[240:241], v[240:241], v[40:41]
v_pk_fma_f32 v[242:243], v[42:43], v[42:43], v[242:243]
v_pk_add_f32 v[240:241], v[240:241], v[42:43]
v_pk_fma_f32 v[218:219], v[88:89], v[88:89], v[218:219]
v_pk_add_f32 v[216:217], v[216:217], v[88:89]
v_pk_fma_f32 v[218:219], v[90:91], v[90:91], v[218:219]
v_pk_add_f32 v[216:217], v[216:217], v[90:91]
v_pk_fma_f32 v[242:243], v[44:45], v[44:45], v[242:243]
v_pk_add_f32 v[240:241], v[240:241], v[44:45]
v_pk_fma_f32 v[242:243], v[46:47], v[46:47], v[242:243]
v_pk_add_f32 v[240:241], v[240:241], v[46:47]
v_pk_fma_f32 v[218:219], v[92:93], v[92:93], v[218:219]
v_pk_add_f32 v[216:217], v[216:217], v[92:93]
v_pk_fma_f32 v[218:219], v[94:95], v[94:95], v[218:219]
v_pk_add_f32 v[216:217], v[216:217], v[94:95]
v_add_f32 v218, v218, v219
v_add_f32 v216, v216, v217
s_nop 1
v_permlane32_swap_b32 v216, v218
v_add_f32_e64 v216, v216, v218
v_mul_f32 v216, 1009429163, v216
v_mov_b32_e64 v218, v216
s_nop 1
v_permlane32_swap_b32 v216, v218
v_fma_f32 v218, -v216, v216, v218
v_max_f32_e64 v218, 0, v218
v_add_f32 v218, 925353388, v218
v_rsq_f32 v218, v218
v_add_f32 v240, v240, v241
v_mul_f32 v220, 3203396952, v218
v_mul_f32 v221, 3203396952, v218
v_mul_f32 v218, v216, v220
v_mul_f32 v219, v216, v220
v_add_f32 v242, v242, v243
s_nop 1
v_permlane32_swap_b32 v240, v242
v_add_f32 v240, v240, v242
v_mul_f32 v240, 1009429163, v240
v_mov_b32_e64 v242, v240
s_nop 1
v_permlane32_swap_b32 v240, v242
v_fma_f32 v242, -v240, v240, v242
v_max_f32_e64 v242, 0, v242
v_add_f32 v242, 925353388, v242
v_rsq_f32 v242, v242
s_nop 0
v_mul_f32 v244, 3203396952, v242
v_mul_f32 v245, 3203396952, v242
v_mul_f32 v242, v240, v244
v_mul_f32 v243, v240, v244
v_pk_fma_f32 v[0:1], v[0:1], v[244:245], v[242:243] neg_lo:[0,0,1] neg_hi:[0,0,1]
v_pk_fma_f32 v[2:3], v[2:3], v[244:245], v[242:243] neg_lo:[0,0,1] neg_hi:[0,0,1]
v_cvt_pk_bf16_f32 v0, v0, v1
v_cvt_pk_bf16_f32 v1, v2, v3
v_pk_fma_f32 v[4:5], v[4:5], v[244:245], v[242:243] neg_lo:[0,0,1] neg_hi:[0,0,1]
v_pk_fma_f32 v[6:7], v[6:7], v[244:245], v[242:243] neg_lo:[0,0,1] neg_hi:[0,0,1]
v_cvt_pk_bf16_f32 v2, v4, v5
v_cvt_pk_bf16_f32 v3, v6, v7
v_pk_fma_f32 v[8:9], v[8:9], v[244:245], v[242:243] neg_lo:[0,0,1] neg_hi:[0,0,1]
v_pk_fma_f32 v[10:11], v[10:11], v[244:245], v[242:243] neg_lo:[0,0,1] neg_hi:[0,0,1]
v_cvt_pk_bf16_f32 v4, v8, v9
v_cvt_pk_bf16_f32 v5, v10, v11
v_pk_fma_f32 v[12:13], v[12:13], v[244:245], v[242:243] neg_lo:[0,0,1] neg_hi:[0,0,1]
v_pk_fma_f32 v[14:15], v[14:15], v[244:245], v[242:243] neg_lo:[0,0,1] neg_hi:[0,0,1]
v_cvt_pk_bf16_f32 v6, v12, v13
v_cvt_pk_bf16_f32 v7, v14, v15
v_pk_fma_f32 v[16:17], v[16:17], v[244:245], v[242:243] neg_lo:[0,0,1] neg_hi:[0,0,1]
v_pk_fma_f32 v[18:19], v[18:19], v[244:245], v[242:243] neg_lo:[0,0,1] neg_hi:[0,0,1]
v_cvt_pk_bf16_f32 v8, v16, v17
v_cvt_pk_bf16_f32 v9, v18, v19
v_pk_fma_f32 v[20:21], v[20:21], v[244:245], v[242:243] neg_lo:[0,0,1] neg_hi:[0,0,1]
v_pk_fma_f32 v[22:23], v[22:23], v[244:245], v[242:243] neg_lo:[0,0,1] neg_hi:[0,0,1]
v_cvt_pk_bf16_f32 v10, v20, v21
v_cvt_pk_bf16_f32 v11, v22, v23
v_pk_fma_f32 v[24:25], v[24:25], v[244:245], v[242:243] neg_lo:[0,0,1] neg_hi:[0,0,1]
v_pk_fma_f32 v[26:27], v[26:27], v[244:245], v[242:243] neg_lo:[0,0,1] neg_hi:[0,0,1]
v_cvt_pk_bf16_f32 v12, v24, v25
v_cvt_pk_bf16_f32 v13, v26, v27
v_mov_b32 v223, 0
s_branch Law2
Lax2:
s_sleep 2
Law2:
ds_read_b32 v223, v247 offset:8
s_sub_u32 s76, s76, 1
s_cselect_b32 s44, 4, 0
s_cselect_b32 s76, 0, s76
s_waitcnt lgkmcnt(0)
v_readfirstlane_b32 s43, v223
s_nop 1
s_max_u32 s43, s43, s44
s_cmp_lt_u32 s43, 4
s_cbranch_scc1 Lax2
v_pk_fma_f32 v[28:29], v[28:29], v[244:245], v[242:243] neg_lo:[0,0,1] neg_hi:[0,0,1]
v_pk_fma_f32 v[30:31], v[30:31], v[244:245], v[242:243] neg_lo:[0,0,1] neg_hi:[0,0,1]
v_cvt_pk_bf16_f32 v14, v28, v29
v_cvt_pk_bf16_f32 v15, v30, v31
v_pk_fma_f32 v[32:33], v[32:33], v[244:245], v[242:243] neg_lo:[0,0,1] neg_hi:[0,0,1]
v_pk_fma_f32 v[34:35], v[34:35], v[244:245], v[242:243] neg_lo:[0,0,1] neg_hi:[0,0,1]
v_cvt_pk_bf16_f32 v16, v32, v33
v_cvt_pk_bf16_f32 v17, v34, v35
v_pk_fma_f32 v[36:37], v[36:37], v[244:245], v[242:243] neg_lo:[0,0,1] neg_hi:[0,0,1]
v_pk_fma_f32 v[38:39], v[38:39], v[244:245], v[242:243] neg_lo:[0,0,1] neg_hi:[0,0,1]
v_cvt_pk_bf16_f32 v18, v36, v37
v_cvt_pk_bf16_f32 v19, v38, v39
v_pk_fma_f32 v[40:41], v[40:41], v[244:245], v[242:243] neg_lo:[0,0,1] neg_hi:[0,0,1]
v_pk_fma_f32 v[42:43], v[42:43], v[244:245], v[242:243] neg_lo:[0,0,1] neg_hi:[0,0,1]
v_cvt_pk_bf16_f32 v20, v40, v41
v_cvt_pk_bf16_f32 v21, v42, v43
v_pk_fma_f32 v[44:45], v[44:45], v[244:245], v[242:243] neg_lo:[0,0,1] neg_hi:[0,0,1]
v_pk_fma_f32 v[46:47], v[46:47], v[244:245], v[242:243] neg_lo:[0,0,1] neg_hi:[0,0,1]
v_cvt_pk_bf16_f32 v22, v44, v45
v_cvt_pk_bf16_f32 v23, v46, v47
v_pk_fma_f32 v[48:49], v[48:49], v[220:221], v[218:219] neg_lo:[0,0,1] neg_hi:[0,0,1]
ds_read_b128 v[176:179], v250
v_cvt_pk_bf16_f32 v24, v48, v49
v_pk_fma_f32 v[50:51], v[50:51], v[220:221], v[218:219] neg_lo:[0,0,1] neg_hi:[0,0,1]
v_pk_fma_f32 v[52:53], v[52:53], v[220:221], v[218:219] neg_lo:[0,0,1] neg_hi:[0,0,1]
v_cvt_pk_bf16_f32 v25, v50, v51
v_cvt_pk_bf16_f32 v26, v52, v53
v_pk_fma_f32 v[54:55], v[54:55], v[220:221], v[218:219] neg_lo:[0,0,1] neg_hi:[0,0,1]
v_pk_fma_f32 v[56:57], v[56:57], v[220:221], v[218:219] neg_lo:[0,0,1] neg_hi:[0,0,1]
v_cvt_pk_bf16_f32 v27, v54, v55
v_cvt_pk_bf16_f32 v28, v56, v57
v_pk_fma_f32 v[58:59], v[58:59], v[220:221], v[218:219] neg_lo:[0,0,1] neg_hi:[0,0,1]
v_pk_fma_f32 v[60:61], v[60:61], v[220:221], v[218:219] neg_lo:[0,0,1] neg_hi:[0,0,1]
v_cvt_pk_bf16_f32 v29, v58, v59
v_cvt_pk_bf16_f32 v30, v60, v61
v_pk_fma_f32 v[62:63], v[62:63], v[220:221], v[218:219] neg_lo:[0,0,1] neg_hi:[0,0,1]
v_pk_fma_f32 v[64:65], v[64:65], v[220:221], v[218:219] neg_lo:[0,0,1] neg_hi:[0,0,1]
v_cvt_pk_bf16_f32 v31, v62, v63
v_cvt_pk_bf16_f32 v32, v64, v65
v_pk_fma_f32 v[66:67], v[66:67], v[220:221], v[218:219] neg_lo:[0,0,1] neg_hi:[0,0,1]
v_pk_fma_f32 v[68:69], v[68:69], v[220:221], v[218:219] neg_lo:[0,0,1] neg_hi:[0,0,1]
v_cvt_pk_bf16_f32 v33, v66, v67
v_cvt_pk_bf16_f32 v34, v68, v69
v_pk_fma_f32 v[70:71], v[70:71], v[220:221], v[218:219] neg_lo:[0,0,1] neg_hi:[0,0,1]
v_pk_fma_f32 v[72:73], v[72:73], v[220:221], v[218:219] neg_lo:[0,0,1] neg_hi:[0,0,1]
ds_read_b128 v[180:183], v250 offset:1024
v_cvt_pk_bf16_f32 v35, v70, v71
v_cvt_pk_bf16_f32 v36, v72, v73
v_pk_fma_f32 v[74:75], v[74:75], v[220:221], v[218:219] neg_lo:[0,0,1] neg_hi:[0,0,1]
v_pk_fma_f32 v[76:77], v[76:77], v[220:221], v[218:219] neg_lo:[0,0,1] neg_hi:[0,0,1]
v_cvt_pk_bf16_f32 v37, v74, v75
v_cvt_pk_bf16_f32 v38, v76, v77
v_pk_fma_f32 v[78:79], v[78:79], v[220:221], v[218:219] neg_lo:[0,0,1] neg_hi:[0,0,1]
v_pk_fma_f32 v[80:81], v[80:81], v[220:221], v[218:219] neg_lo:[0,0,1] neg_hi:[0,0,1]
v_cvt_pk_bf16_f32 v39, v78, v79
v_cvt_pk_bf16_f32 v40, v80, v81
v_pk_fma_f32 v[82:83], v[82:83], v[220:221], v[218:219] neg_lo:[0,0,1] neg_hi:[0,0,1]
v_pk_fma_f32 v[84:85], v[84:85], v[220:221], v[218:219] neg_lo:[0,0,1] neg_hi:[0,0,1]
v_cvt_pk_bf16_f32 v41, v82, v83
v_cvt_pk_bf16_f32 v42, v84, v85
v_pk_fma_f32 v[86:87], v[86:87], v[220:221], v[218:219] neg_lo:[0,0,1] neg_hi:[0,0,1]
v_pk_fma_f32 v[88:89], v[88:89], v[220:221], v[218:219] neg_lo:[0,0,1] neg_hi:[0,0,1]
v_cvt_pk_bf16_f32 v43, v86, v87
v_cvt_pk_bf16_f32 v44, v88, v89
v_pk_fma_f32 v[90:91], v[90:91], v[220:221], v[218:219] neg_lo:[0,0,1] neg_hi:[0,0,1]
v_pk_fma_f32 v[92:93], v[92:93], v[220:221], v[218:219] neg_lo:[0,0,1] neg_hi:[0,0,1]
v_cvt_pk_bf16_f32 v45, v90, v91
v_cvt_pk_bf16_f32 v46, v92, v93
v_pk_fma_f32 v[94:95], v[94:95], v[220:221], v[218:219] neg_lo:[0,0,1] neg_hi:[0,0,1]
ds_read_b128 v[184:187], v250 offset:2048
v_cvt_pk_bf16_f32 v47, v94, v95
s_waitcnt lgkmcnt(2)
v_mfma_f32_32x32x16_bf16 v[160:175], v[0:3], v[176:179], 0
ds_read_b128 v[188:191], v250 offset:3072
v_mfma_f32_32x32x16_bf16 v[96:111], v[24:27], v[176:179], 0
ds_read_b128 v[176:179], v250 offset:4096
s_waitcnt lgkmcnt(3)
v_mfma_f32_32x32x16_bf16 v[160:175], v[4:7], v[180:183], v[160:175]
v_mfma_f32_32x32x16_bf16 v[96:111], v[28:31], v[180:183], v[96:111]
ds_read_b128 v[180:183], v250 offset:5120
s_waitcnt lgkmcnt(3)
v_mfma_f32_32x32x16_bf16 v[160:175], v[8:11], v[184:187], v[160:175]
v_mfma_f32_32x32x16_bf16 v[96:111], v[32:35], v[184:187], v[96:111]
ds_read_b128 v[184:187], v250 offset:6144
s_waitcnt lgkmcnt(2)
v_mfma_f32_32x32x16_bf16 v[160:175], v[12:15], v[188:191], v[160:175]
v_mfma_f32_32x32x16_bf16 v[96:111], v[36:39], v[188:191], v[96:111]
ds_read_b128 v[188:191], v250 offset:7168
v_mfma_f32_32x32x16_bf16 v[160:175], v[16:19], v[176:179], v[160:175]
v_mfma_f32_32x32x16_bf16 v[96:111], v[40:43], v[176:179], v[96:111]
ds_read_b128 v[176:179], v250 offset:8192
s_waitcnt lgkmcnt(2)
v_mfma_f32_32x32x16_bf16 v[160:175], v[20:23], v[180:183], v[160:175]
v_mfma_f32_32x32x16_bf16 v[96:111], v[44:47], v[180:183], v[96:111]
ds_read_b128 v[180:183], v250 offset:9216
s_nop 9
v_cvt_pkrtz_f16_f32 v160, v160, v161
v_mfma_f32_32x32x16_bf16 v[112:127], v[0:3], v[184:187], 0
v_cvt_pkrtz_f16_f32 v161, v162, v163
v_lshrrev_b64 v[160:161], 2, v[160:161]
v_and_b32_sdwa v162, s47, v160 dst_sel:DWORD dst_unused:UNUSED_PAD src0_sel:DWORD src1_sel:WORD_1
v_and_b32_e64 v160, s47, v160
v_cvt_pk_f16_f32 v172, v172, v173
v_cvt_pk_f16_f32 v174, v174, v175
v_pk_fma_f16 v173, v172, v172, s48
v_mfma_f32_32x32x16_bf16 v[128:143], v[24:27], v[184:187], 0
ds_read_u16 v162, v162
ds_read_u16 v160, v160
v_and_b32_sdwa v163, s47, v161 dst_sel:DWORD dst_unused:UNUSED_PAD src0_sel:DWORD src1_sel:WORD_1
v_and_b32_e64 v161, s47, v161
v_pk_fma_f16 v175, v174, v174, s48
v_pk_mul_f16 v173, v172, v173
v_pk_mul_f16 v175, v174, v175
v_cvt_pkrtz_f16_f32 v164, v164, v165
v_cvt_pkrtz_f16_f32 v165, v166, v167
v_lshrrev_b64 v[164:165], 2, v[164:165]
ds_read_u16 v163, v163
ds_read_u16 v161, v161
v_and_b32_sdwa v166, s47, v164 dst_sel:DWORD dst_unused:UNUSED_PAD src0_sel:DWORD src1_sel:WORD_1
v_and_b32 v164, s47, v164
v_exp_f16_sdwa v173, v173 dst_sel:WORD_0 dst_unused:UNUSED_PRESERVE src0_sel:WORD_0
s_waitcnt lgkmcnt(4)
v_mfma_f32_32x32x16_bf16 v[112:127], v[4:7], v[188:191], v[112:127]
ds_read_u16 v166, v166
ds_read_u16 v164, v164
v_exp_f16_sdwa v175, v175 dst_sel:WORD_0 dst_unused:UNUSED_PRESERVE src0_sel:WORD_0
v_and_b32_sdwa v167, s47, v165 dst_sel:DWORD dst_unused:UNUSED_PAD src0_sel:DWORD src1_sel:WORD_1
v_and_b32_e64 v165, s47, v165
v_exp_f16_sdwa v173, v173 dst_sel:WORD_1 dst_unused:UNUSED_PRESERVE src0_sel:WORD_1
v_cvt_pkrtz_f16_f32 v168, v168, v169
v_cvt_pkrtz_f16_f32 v169, v170, v171
v_lshrrev_b64 v[168:169], 2, v[168:169]
v_and_b32_sdwa v170, s47, v168 dst_sel:DWORD dst_unused:UNUSED_PAD src0_sel:DWORD src1_sel:WORD_1
v_and_b32_e64 v168, s47, v168
ds_read_u16 v167, v167
ds_read_u16 v165, v165
ds_read_u16 v170, v170
ds_read_u16 v168, v168
v_exp_f16_sdwa v175, v175 dst_sel:WORD_1 dst_unused:UNUSED_PRESERVE src0_sel:WORD_1
v_mfma_f32_32x32x16_bf16 v[128:143], v[28:31], v[188:191], v[128:143]
ds_read_b128 v[184:187], v250 offset:10240
v_and_b32_sdwa v171, s47, v169 dst_sel:DWORD dst_unused:UNUSED_PAD src0_sel:DWORD src1_sel:WORD_1
v_and_b32_e64 v169, s47, v169
v_pk_add_f16 v173, v173, 1.0 op_sel_hi:[1,0]
v_pk_add_f16 v175, v175, 1.0 op_sel_hi:[1,0]
v_rcp_f16_sdwa v173, v173 dst_sel:WORD_0 dst_unused:UNUSED_PRESERVE src0_sel:WORD_0
v_mfma_f32_32x32x16_bf16 v[112:127], v[8:11], v[176:179], v[112:127]
ds_read_u16 v171, v171
ds_read_u16 v169, v169
v_rcp_f16_sdwa v175, v175 dst_sel:WORD_0 dst_unused:UNUSED_PRESERVE src0_sel:WORD_0
v_rcp_f16_sdwa v173, v173 dst_sel:WORD_1 dst_unused:UNUSED_PRESERVE src0_sel:WORD_1
v_rcp_f16_sdwa v175, v175 dst_sel:WORD_1 dst_unused:UNUSED_PRESERVE src0_sel:WORD_1
v_mfma_f32_32x32x16_bf16 v[128:143], v[32:35], v[176:179], v[128:143]
ds_read_b128 v[188:191], v250 offset:11264
v_pk_mul_f16 v172, v172, v173
v_pk_mul_f16 v174, v174, v175
v_fma_mix_f32 v224, v172, v172, v224 op_sel_hi:[1,1,0]
v_cvt_pkrtz_f16_f32 v96, v96, v97
v_fma_mix_f32 v224, v174, v174, v224 op_sel_hi:[1,1,0]
v_mfma_f32_32x32x16_bf16 v[112:127], v[12:15], v[180:183], v[112:127]
v_fma_mix_f32 v224, v172, v172, v224 op_sel:[1,1,0] op_sel_hi:[1,1,0]
v_cvt_pkrtz_f16_f32 v97, v98, v99
v_fma_mix_f32 v224, v174, v174, v224 op_sel:[1,1,0] op_sel_hi:[1,1,0]
v_lshrrev_b64 v[96:97], 2, v[96:97]
s_waitcnt lgkmcnt(7)
v_fma_mix_f32 v224, v160, v160, v224 op_sel_hi:[1,1,0]
v_and_b32_sdwa v98, s47, v96 dst_sel:DWORD dst_unused:UNUSED_PAD src0_sel:DWORD src1_sel:WORD_1
v_fma_mix_f32 v224, v161, v161, v224 op_sel_hi:[1,1,0]
v_and_b32 v96, s47, v96
v_fma_mix_f32 v224, v162, v162, v224 op_sel_hi:[1,1,0]
v_cvt_pk_f16_f32 v108, v108, v109
v_fma_mix_f32 v224, v163, v163, v224 op_sel_hi:[1,1,0]
v_cvt_pk_f16_f32 v110, v110, v111
v_pk_fma_f16 v109, v108, v108, s48
v_mfma_f32_32x32x16_bf16 v[128:143], v[36:39], v[180:183], v[128:143]
ds_read_u16 v98, v98
ds_read_u16 v96, v96
v_fma_mix_f32 v224, v164, v164, v224 op_sel_hi:[1,1,0]
v_and_b32_sdwa v99, s47, v97 dst_sel:DWORD dst_unused:UNUSED_PAD src0_sel:DWORD src1_sel:WORD_1
s_waitcnt lgkmcnt(6)
v_fma_mix_f32 v224, v165, v165, v224 op_sel_hi:[1,1,0]
v_and_b32 v97, s47, v97
v_pk_fma_f16 v111, v110, v110, s48
v_pk_mul_f16 v109, v108, v109
v_pk_mul_f16 v111, v110, v111
v_fma_mix_f32 v224, v166, v166, v224 op_sel_hi:[1,1,0]
v_cvt_pkrtz_f16_f32 v100, v100, v101
v_fma_mix_f32 v224, v167, v167, v224 op_sel_hi:[1,1,0]
ds_read_u16 v99, v99
ds_read_u16 v97, v97
ds_read_b128 v[176:179], v250 offset:12288
v_cvt_pkrtz_f16_f32 v101, v102, v103
v_lshrrev_b64 v[100:101], 2, v[100:101]
v_and_b32_sdwa v102, s47, v100 dst_sel:DWORD dst_unused:UNUSED_PAD src0_sel:DWORD src1_sel:WORD_1
v_and_b32 v100, s47, v100
v_exp_f16_sdwa v109, v109 dst_sel:WORD_0 dst_unused:UNUSED_PRESERVE src0_sel:WORD_0
s_waitcnt lgkmcnt(6)
v_mfma_f32_32x32x16_bf16 v[112:127], v[16:19], v[184:187], v[112:127]
ds_read_u16 v102, v102
ds_read_u16 v100, v100
v_exp_f16_sdwa v111, v111 dst_sel:WORD_0 dst_unused:UNUSED_PRESERVE src0_sel:WORD_0
v_fma_mix_f32 v224, v168, v168, v224 op_sel_hi:[1,1,0]
v_and_b32_sdwa v103, s47, v101 dst_sel:DWORD dst_unused:UNUSED_PAD src0_sel:DWORD src1_sel:WORD_1
v_fma_mix_f32 v224, v169, v169, v224 op_sel_hi:[1,1,0]
v_and_b32_e64 v101, s47, v101
v_exp_f16_sdwa v109, v109 dst_sel:WORD_1 dst_unused:UNUSED_PRESERVE src0_sel:WORD_1
v_fma_mix_f32 v224, v170, v170, v224 op_sel_hi:[1,1,0]
v_cvt_pkrtz_f16_f32 v104, v104, v105
v_fma_mix_f32 v224, v171, v171, v224 op_sel_hi:[1,1,0]
v_cvt_pkrtz_f16_f32 v105, v106, v107
v_lshrrev_b64 v[104:105], 2, v[104:105]
ds_read_u16 v103, v103
ds_read_u16 v101, v101
v_and_b32_sdwa v106, s47, v104 dst_sel:DWORD dst_unused:UNUSED_PAD src0_sel:DWORD src1_sel:WORD_1
v_and_b32_e64 v104, s47, v104
v_exp_f16_sdwa v111, v111 dst_sel:WORD_1 dst_unused:UNUSED_PRESERVE src0_sel:WORD_1
v_mfma_f32_32x32x16_bf16 v[128:143], v[40:43], v[184:187], v[128:143]
ds_read_u16 v106, v106
ds_read_u16 v104, v104
ds_read_b128 v[180:183], v250 offset:13312
v_and_b32_sdwa v107, s47, v105 dst_sel:DWORD dst_unused:UNUSED_PAD src0_sel:DWORD src1_sel:WORD_1
v_and_b32 v105, s47, v105
v_pk_add_f16 v109, v109, 1.0 op_sel_hi:[1,0]
v_pk_add_f16 v111, v111, 1.0 op_sel_hi:[1,0]
v_rcp_f16_sdwa v109, v109 dst_sel:WORD_0 dst_unused:UNUSED_PRESERVE src0_sel:WORD_0
s_waitcnt lgkmcnt(7)
v_mfma_f32_32x32x16_bf16 v[112:127], v[20:23], v[188:191], v[112:127]
ds_read_u16 v107, v107
ds_read_u16 v105, v105
v_rcp_f16_sdwa v111, v111 dst_sel:WORD_0 dst_unused:UNUSED_PRESERVE src0_sel:WORD_0
v_rcp_f16_sdwa v109, v109 dst_sel:WORD_1 dst_unused:UNUSED_PRESERVE src0_sel:WORD_1
v_rcp_f16_sdwa v111, v111 dst_sel:WORD_1 dst_unused:UNUSED_PRESERVE src0_sel:WORD_1
v_mfma_f32_32x32x16_bf16 v[128:143], v[44:47], v[188:191], v[128:143]
ds_read_b128 v[184:187], v250 offset:14336
v_pk_mul_f16 v108, v108, v109
v_pk_mul_f16 v110, v110, v111
v_fma_mix_f32 v224, v108, v108, v224 op_sel_hi:[1,1,0]
buffer_store_dwordx4 v[0:3], v250, s[32:35], s80 offen
v_fma_mix_f32 v224, v110, v110, v224 op_sel_hi:[1,1,0]
v_mfma_f32_32x32x16_bf16 v[144:159], v[0:3], v[176:179], 0
v_fma_mix_f32 v224, v108, v108, v224 op_sel:[1,1,0] op_sel_hi:[1,1,0]
v_cvt_pkrtz_f16_f32 v112, v112, v113
v_fma_mix_f32 v224, v110, v110, v224 op_sel:[1,1,0] op_sel_hi:[1,1,0]
v_cvt_pkrtz_f16_f32 v113, v114, v115
v_fma_mix_f32 v224, v96, v96, v224 op_sel_hi:[1,1,0]
v_lshrrev_b64 v[112:113], 2, v[112:113]
v_fma_mix_f32 v224, v97, v97, v224 op_sel_hi:[1,1,0]
v_and_b32_sdwa v114, s47, v112 dst_sel:DWORD dst_unused:UNUSED_PAD src0_sel:DWORD src1_sel:WORD_1
v_fma_mix_f32 v224, v98, v98, v224 op_sel_hi:[1,1,0]
v_and_b32_e64 v112, s47, v112
v_fma_mix_f32 v224, v99, v99, v224 op_sel_hi:[1,1,0]
v_cvt_pk_f16_f32 v124, v124, v125
v_cvt_pk_f16_f32 v126, v126, v127
v_pk_fma_f16 v125, v124, v124, s48
v_mfma_f32_32x32x16_bf16 v[160:175], v[24:27], v[176:179], 0
ds_read_u16 v114, v114
ds_read_u16 v112, v112
s_waitcnt lgkmcnt(5)
v_fma_mix_f32 v224, v100, v100, v224 op_sel_hi:[1,1,0]
v_and_b32_sdwa v115, s47, v113 dst_sel:DWORD dst_unused:UNUSED_PAD src0_sel:DWORD src1_sel:WORD_1
v_fma_mix_f32 v224, v101, v101, v224 op_sel_hi:[1,1,0]
v_and_b32 v113, s47, v113
v_pk_fma_f16 v127, v126, v126, s48
v_pk_mul_f16 v125, v124, v125
v_pk_mul_f16 v127, v126, v127
v_fma_mix_f32 v224, v102, v102, v224 op_sel_hi:[1,1,0]
v_cvt_pkrtz_f16_f32 v116, v116, v117
v_fma_mix_f32 v224, v103, v103, v224 op_sel_hi:[1,1,0]
ds_read_u16 v115, v115
ds_read_u16 v113, v113
ds_read_b128 v[188:191], v250 offset:15360
v_cvt_pkrtz_f16_f32 v117, v118, v119
v_lshrrev_b64 v[116:117], 2, v[116:117]
v_and_b32_sdwa v118, s47, v116 dst_sel:DWORD dst_unused:UNUSED_PAD src0_sel:DWORD src1_sel:WORD_1
v_and_b32_e64 v116, s47, v116
v_exp_f16_sdwa v125, v125 dst_sel:WORD_0 dst_unused:UNUSED_PRESERVE src0_sel:WORD_0
v_mfma_f32_32x32x16_bf16 v[144:159], v[4:7], v[180:183], v[144:159]
ds_read_u16 v118, v118
ds_read_u16 v116, v116
v_exp_f16_sdwa v127, v127 dst_sel:WORD_0 dst_unused:UNUSED_PRESERVE src0_sel:WORD_0
v_fma_mix_f32 v224, v104, v104, v224 op_sel_hi:[1,1,0]
v_and_b32_sdwa v119, s47, v117 dst_sel:DWORD dst_unused:UNUSED_PAD src0_sel:DWORD src1_sel:WORD_1
s_waitcnt lgkmcnt(7)
v_fma_mix_f32 v224, v105, v105, v224 op_sel_hi:[1,1,0]
v_and_b32 v117, s47, v117
v_exp_f16_sdwa v125, v125 dst_sel:WORD_1 dst_unused:UNUSED_PRESERVE src0_sel:WORD_1
v_fma_mix_f32 v224, v106, v106, v224 op_sel_hi:[1,1,0]
v_cvt_pkrtz_f16_f32 v120, v120, v121
v_fma_mix_f32 v224, v107, v107, v224 op_sel_hi:[1,1,0]
v_cvt_pkrtz_f16_f32 v121, v122, v123
v_lshrrev_b64 v[120:121], 2, v[120:121]
ds_read_u16 v119, v119
ds_read_u16 v117, v117
v_and_b32_sdwa v122, s47, v120 dst_sel:DWORD dst_unused:UNUSED_PAD src0_sel:DWORD src1_sel:WORD_1
v_and_b32_e64 v120, s47, v120
v_exp_f16_sdwa v127, v127 dst_sel:WORD_1 dst_unused:UNUSED_PRESERVE src0_sel:WORD_1
v_mfma_f32_32x32x16_bf16 v[160:175], v[28:31], v[180:183], v[160:175]
ds_read_u16 v122, v122
ds_read_u16 v120, v120
ds_read_b128 v[176:179], v250 offset:16384
v_and_b32_sdwa v123, s47, v121 dst_sel:DWORD dst_unused:UNUSED_PAD src0_sel:DWORD src1_sel:WORD_1
v_and_b32_e64 v121, s47, v121
v_pk_add_f16 v125, v125, 1.0 op_sel_hi:[1,0]
v_pk_add_f16 v127, v127, 1.0 op_sel_hi:[1,0]
v_rcp_f16_sdwa v125, v125 dst_sel:WORD_0 dst_unused:UNUSED_PRESERVE src0_sel:WORD_0
v_mfma_f32_32x32x16_bf16 v[144:159], v[8:11], v[184:187], v[144:159]
ds_read_u16 v123, v123
ds_read_u16 v121, v121
v_rcp_f16_sdwa v127, v127 dst_sel:WORD_0 dst_unused:UNUSED_PRESERVE src0_sel:WORD_0
s_add_u32 s46, s80, 2097152
buffer_store_dwordx4 v[4:7], v250, s[32:35], s46 offen
v_rcp_f16_sdwa v125, v125 dst_sel:WORD_1 dst_unused:UNUSED_PRESERVE src0_sel:WORD_1
v_rcp_f16_sdwa v127, v127 dst_sel:WORD_1 dst_unused:UNUSED_PRESERVE src0_sel:WORD_1
v_mfma_f32_32x32x16_bf16 v[160:175], v[32:35], v[184:187], v[160:175]
ds_read_b128 v[180:183], v250 offset:17408
v_pk_mul_f16 v124, v124, v125
v_pk_mul_f16 v126, v126, v127
v_fma_mix_f32 v225, v124, v124, v225 op_sel_hi:[1,1,0]
v_cvt_pkrtz_f16_f32 v128, v128, v129
v_fma_mix_f32 v225, v126, v126, v225 op_sel_hi:[1,1,0]
s_waitcnt lgkmcnt(7)
v_mfma_f32_32x32x16_bf16 v[144:159], v[12:15], v[188:191], v[144:159]
v_fma_mix_f32 v225, v124, v124, v225 op_sel:[1,1,0] op_sel_hi:[1,1,0]
v_cvt_pkrtz_f16_f32 v129, v130, v131
v_fma_mix_f32 v225, v126, v126, v225 op_sel:[1,1,0] op_sel_hi:[1,1,0]
v_lshrrev_b64 v[128:129], 2, v[128:129]
v_fma_mix_f32 v225, v112, v112, v225 op_sel_hi:[1,1,0]
v_and_b32_sdwa v130, s47, v128 dst_sel:DWORD dst_unused:UNUSED_PAD src0_sel:DWORD src1_sel:WORD_1
v_fma_mix_f32 v225, v113, v113, v225 op_sel_hi:[1,1,0]
v_and_b32 v128, s47, v128
v_fma_mix_f32 v225, v114, v114, v225 op_sel_hi:[1,1,0]
v_cvt_pk_f16_f32 v140, v140, v141
v_fma_mix_f32 v225, v115, v115, v225 op_sel_hi:[1,1,0]
v_cvt_pk_f16_f32 v142, v142, v143
v_pk_fma_f16 v141, v140, v140, s48
v_mfma_f32_32x32x16_bf16 v[160:175], v[36:39], v[188:191], v[160:175]
ds_read_u16 v130, v130
ds_read_u16 v128, v128
v_fma_mix_f32 v225, v116, v116, v225 op_sel_hi:[1,1,0]
v_and_b32_sdwa v131, s47, v129 dst_sel:DWORD dst_unused:UNUSED_PAD src0_sel:DWORD src1_sel:WORD_1
s_waitcnt lgkmcnt(5)
v_fma_mix_f32 v225, v117, v117, v225 op_sel_hi:[1,1,0]
v_and_b32 v129, s47, v129
v_pk_fma_f16 v143, v142, v142, s48
v_pk_mul_f16 v141, v140, v141
v_pk_mul_f16 v143, v142, v143
v_fma_mix_f32 v225, v118, v118, v225 op_sel_hi:[1,1,0]
v_cvt_pkrtz_f16_f32 v132, v132, v133
v_fma_mix_f32 v225, v119, v119, v225 op_sel_hi:[1,1,0]
ds_read_u16 v131, v131
ds_read_u16 v129, v129
ds_read_b128 v[184:187], v250 offset:18432
v_cvt_pkrtz_f16_f32 v133, v134, v135
v_lshrrev_b64 v[132:133], 2, v[132:133]
v_and_b32_sdwa v134, s47, v132 dst_sel:DWORD dst_unused:UNUSED_PAD src0_sel:DWORD src1_sel:WORD_1
v_and_b32_e64 v132, s47, v132
v_exp_f16_sdwa v141, v141 dst_sel:WORD_0 dst_unused:UNUSED_PRESERVE src0_sel:WORD_0
v_mfma_f32_32x32x16_bf16 v[144:159], v[16:19], v[176:179], v[144:159]
ds_read_u16 v134, v134
ds_read_u16 v132, v132
v_exp_f16_sdwa v143, v143 dst_sel:WORD_0 dst_unused:UNUSED_PRESERVE src0_sel:WORD_0
v_fma_mix_f32 v225, v120, v120, v225 op_sel_hi:[1,1,0]
v_and_b32_sdwa v135, s47, v133 dst_sel:DWORD dst_unused:UNUSED_PAD src0_sel:DWORD src1_sel:WORD_1
s_waitcnt lgkmcnt(7)
v_fma_mix_f32 v225, v121, v121, v225 op_sel_hi:[1,1,0]
v_and_b32 v133, s47, v133
v_exp_f16_sdwa v141, v141 dst_sel:WORD_1 dst_unused:UNUSED_PRESERVE src0_sel:WORD_1
v_fma_mix_f32 v225, v122, v122, v225 op_sel_hi:[1,1,0]
v_cvt_pkrtz_f16_f32 v136, v136, v137
v_fma_mix_f32 v225, v123, v123, v225 op_sel_hi:[1,1,0]
v_cvt_pkrtz_f16_f32 v137, v138, v139
v_lshrrev_b64 v[136:137], 2, v[136:137]
ds_read_u16 v135, v135
ds_read_u16 v133, v133
s_add_u32 s46, s80, 4194304
buffer_store_dwordx4 v[8:11], v250, s[32:35], s46 offen
v_and_b32_sdwa v138, s47, v136 dst_sel:DWORD dst_unused:UNUSED_PAD src0_sel:DWORD src1_sel:WORD_1
v_and_b32_e64 v136, s47, v136
v_exp_f16_sdwa v143, v143 dst_sel:WORD_1 dst_unused:UNUSED_PRESERVE src0_sel:WORD_1
v_mfma_f32_32x32x16_bf16 v[160:175], v[40:43], v[176:179], v[160:175]
ds_read_u16 v138, v138
ds_read_u16 v136, v136
ds_read_b128 v[188:191], v250 offset:19456
v_and_b32_sdwa v139, s47, v137 dst_sel:DWORD dst_unused:UNUSED_PAD src0_sel:DWORD src1_sel:WORD_1
v_and_b32_e64 v137, s47, v137
v_pk_add_f16 v141, v141, 1.0 op_sel_hi:[1,0]
v_pk_add_f16 v143, v143, 1.0 op_sel_hi:[1,0]
v_rcp_f16_sdwa v141, v141 dst_sel:WORD_0 dst_unused:UNUSED_PRESERVE src0_sel:WORD_0
v_mfma_f32_32x32x16_bf16 v[144:159], v[20:23], v[180:183], v[144:159]
ds_read_u16 v139, v139
ds_read_u16 v137, v137
v_rcp_f16_sdwa v143, v143 dst_sel:WORD_0 dst_unused:UNUSED_PRESERVE src0_sel:WORD_0
v_rcp_f16_sdwa v141, v141 dst_sel:WORD_1 dst_unused:UNUSED_PRESERVE src0_sel:WORD_1
v_rcp_f16_sdwa v143, v143 dst_sel:WORD_1 dst_unused:UNUSED_PRESERVE src0_sel:WORD_1
v_mfma_f32_32x32x16_bf16 v[160:175], v[44:47], v[180:183], v[160:175]
ds_read_b128 v[176:179], v250 offset:20480
v_pk_mul_f16 v140, v140, v141
v_pk_mul_f16 v142, v142, v143
v_fma_mix_f32 v225, v140, v140, v225 op_sel_hi:[1,1,0]
s_nop 1
v_cvt_pkrtz_f16_f32 v144, v144, v145
v_fma_mix_f32 v225, v142, v142, v225 op_sel_hi:[1,1,0]
s_waitcnt lgkmcnt(7)
v_mfma_f32_32x32x16_bf16 v[96:111], v[0:3], v[184:187], 0
v_fma_mix_f32 v225, v140, v140, v225 op_sel:[1,1,0] op_sel_hi:[1,1,0]
v_cvt_pkrtz_f16_f32 v145, v146, v147
v_fma_mix_f32 v225, v142, v142, v225 op_sel:[1,1,0] op_sel_hi:[1,1,0]
v_lshrrev_b64 v[144:145], 2, v[144:145]
v_fma_mix_f32 v225, v128, v128, v225 op_sel_hi:[1,1,0]
v_and_b32_sdwa v146, s47, v144 dst_sel:DWORD dst_unused:UNUSED_PAD src0_sel:DWORD src1_sel:WORD_1
v_fma_mix_f32 v225, v129, v129, v225 op_sel_hi:[1,1,0]
v_and_b32_e64 v144, s47, v144
v_fma_mix_f32 v225, v130, v130, v225 op_sel_hi:[1,1,0]
v_cvt_pk_f16_f32 v156, v156, v157
v_fma_mix_f32 v225, v131, v131, v225 op_sel_hi:[1,1,0]
s_add_u32 s46, s80, 6291456
buffer_store_dwordx4 v[12:15], v250, s[32:35], s46 offen
ds_read_u16 v146, v146
ds_read_u16 v144, v144
v_cvt_pk_f16_f32 v158, v158, v159
v_pk_fma_f16 v157, v156, v156, s48
v_mfma_f32_32x32x16_bf16 v[112:127], v[24:27], v[184:187], 0
v_fma_mix_f32 v225, v132, v132, v225 op_sel_hi:[1,1,0]
v_and_b32_sdwa v147, s47, v145 dst_sel:DWORD dst_unused:UNUSED_PAD src0_sel:DWORD src1_sel:WORD_1
s_waitcnt lgkmcnt(5)
v_fma_mix_f32 v225, v133, v133, v225 op_sel_hi:[1,1,0]
v_and_b32 v145, s47, v145
v_pk_fma_f16 v159, v158, v158, s48
v_pk_mul_f16 v157, v156, v157
v_pk_mul_f16 v159, v158, v159
v_fma_mix_f32 v225, v134, v134, v225 op_sel_hi:[1,1,0]
v_cvt_pkrtz_f16_f32 v148, v148, v149
v_fma_mix_f32 v225, v135, v135, v225 op_sel_hi:[1,1,0]
ds_read_u16 v147, v147
ds_read_u16 v145, v145
ds_read_b128 v[180:183], v250 offset:21504
v_cvt_pkrtz_f16_f32 v149, v150, v151
v_lshrrev_b64 v[148:149], 2, v[148:149]
v_and_b32_sdwa v150, s47, v148 dst_sel:DWORD dst_unused:UNUSED_PAD src0_sel:DWORD src1_sel:WORD_1
v_and_b32_e64 v148, s47, v148
v_exp_f16_sdwa v157, v157 dst_sel:WORD_0 dst_unused:UNUSED_PRESERVE src0_sel:WORD_0
v_mfma_f32_32x32x16_bf16 v[96:111], v[4:7], v[188:191], v[96:111]
ds_read_u16 v150, v150
ds_read_u16 v148, v148
v_exp_f16_sdwa v159, v159 dst_sel:WORD_0 dst_unused:UNUSED_PRESERVE src0_sel:WORD_0
v_fma_mix_f32 v225, v136, v136, v225 op_sel_hi:[1,1,0]
v_and_b32_sdwa v151, s47, v149 dst_sel:DWORD dst_unused:UNUSED_PAD src0_sel:DWORD src1_sel:WORD_1
s_waitcnt lgkmcnt(6)
v_fma_mix_f32 v225, v137, v137, v225 op_sel_hi:[1,1,0]
v_and_b32 v149, s47, v149
v_exp_f16_sdwa v157, v157 dst_sel:WORD_1 dst_unused:UNUSED_PRESERVE src0_sel:WORD_1
v_fma_mix_f32 v225, v138, v138, v225 op_sel_hi:[1,1,0]
v_cvt_pkrtz_f16_f32 v152, v152, v153
v_fma_mix_f32 v225, v139, v139, v225 op_sel_hi:[1,1,0]
v_cvt_pkrtz_f16_f32 v153, v154, v155
v_lshrrev_b64 v[152:153], 2, v[152:153]
ds_read_u16 v151, v151
ds_read_u16 v149, v149
v_and_b32_sdwa v154, s47, v152 dst_sel:DWORD dst_unused:UNUSED_PAD src0_sel:DWORD src1_sel:WORD_1
v_and_b32_e64 v152, s47, v152
v_exp_f16_sdwa v159, v159 dst_sel:WORD_1 dst_unused:UNUSED_PRESERVE src0_sel:WORD_1
v_mfma_f32_32x32x16_bf16 v[112:127], v[28:31], v[188:191], v[112:127]
ds_read_u16 v154, v154
ds_read_u16 v152, v152
ds_read_b128 v[184:187], v250 offset:22528
v_and_b32_sdwa v155, s47, v153 dst_sel:DWORD dst_unused:UNUSED_PAD src0_sel:DWORD src1_sel:WORD_1
v_and_b32_e64 v153, s47, v153
v_pk_add_f16 v157, v157, 1.0 op_sel_hi:[1,0]
v_pk_add_f16 v159, v159, 1.0 op_sel_hi:[1,0]
v_rcp_f16_sdwa v157, v157 dst_sel:WORD_0 dst_unused:UNUSED_PRESERVE src0_sel:WORD_0
v_mfma_f32_32x32x16_bf16 v[96:111], v[8:11], v[176:179], v[96:111]
ds_read_u16 v155, v155
ds_read_u16 v153, v153
v_rcp_f16_sdwa v159, v159 dst_sel:WORD_0 dst_unused:UNUSED_PRESERVE src0_sel:WORD_0
v_rcp_f16_sdwa v157, v157 dst_sel:WORD_1 dst_unused:UNUSED_PRESERVE src0_sel:WORD_1
s_add_u32 s46, s80, 8388608
buffer_store_dwordx4 v[16:19], v250, s[32:35], s46 offen
v_rcp_f16_sdwa v159, v159 dst_sel:WORD_1 dst_unused:UNUSED_PRESERVE src0_sel:WORD_1
v_mfma_f32_32x32x16_bf16 v[112:127], v[32:35], v[176:179], v[112:127]
ds_read_b128 v[188:191], v250 offset:23552
v_mov_b32_e64 v223, 0
s_branch Law3
Lax3:
s_sleep 2
Law3:
ds_read_b32 v223, v247 offset:12
s_sub_u32 s76, s76, 1
s_cselect_b32 s44, 4, 0
s_cselect_b32 s76, 0, s76
s_waitcnt lgkmcnt(0)
v_readfirstlane_b32 s43, v223
s_nop 1
s_max_u32 s43, s43, s44
s_cmp_lt_u32 s43, 4
s_cbranch_scc1 Lax3
v_pk_mul_f16 v156, v156, v157
v_pk_mul_f16 v158, v158, v159
v_fma_mix_f32 v226, v156, v156, v226 op_sel_hi:[1,1,0]
v_mfma_f32_32x32x16_bf16 v[96:111], v[12:15], v[180:183], v[96:111]
v_fma_mix_f32 v226, v158, v158, v226 op_sel_hi:[1,1,0]
s_setprio 3
v_cvt_pkrtz_f16_f32 v160, v160, v161
v_fma_mix_f32 v226, v156, v156, v226 op_sel:[1,1,0] op_sel_hi:[1,1,0]
v_cvt_pkrtz_f16_f32 v161, v162, v163
v_fma_mix_f32 v226, v158, v158, v226 op_sel:[1,1,0] op_sel_hi:[1,1,0]
v_lshrrev_b64 v[160:161], 2, v[160:161]
v_fma_mix_f32 v226, v144, v144, v226 op_sel_hi:[1,1,0]
v_and_b32_sdwa v162, s47, v160 dst_sel:DWORD dst_unused:UNUSED_PAD src0_sel:DWORD src1_sel:WORD_1
v_fma_mix_f32 v226, v145, v145, v226 op_sel_hi:[1,1,0]
v_and_b32_e64 v160, s47, v160
v_fma_mix_f32 v226, v146, v146, v226 op_sel_hi:[1,1,0]
v_cvt_pk_f16_f32 v172, v172, v173
v_fma_mix_f32 v226, v147, v147, v226 op_sel_hi:[1,1,0]
v_cvt_pk_f16_f32 v174, v174, v175
v_pk_fma_f16 v173, v172, v172, s48
v_mfma_f32_32x32x16_bf16 v[112:127], v[36:39], v[180:183], v[112:127]
ds_read_u16 v162, v162
ds_read_u16 v160, v160
v_fma_mix_f32 v226, v148, v148, v226 op_sel_hi:[1,1,0]
v_and_b32_sdwa v163, s47, v161 dst_sel:DWORD dst_unused:UNUSED_PAD src0_sel:DWORD src1_sel:WORD_1
v_fma_mix_f32 v226, v149, v149, v226 op_sel_hi:[1,1,0]
v_and_b32_e64 v161, s47, v161
v_pk_fma_f16 v175, v174, v174, s48
v_pk_mul_f16 v173, v172, v173
v_pk_mul_f16 v175, v174, v175
v_fma_mix_f32 v226, v150, v150, v226 op_sel_hi:[1,1,0]
v_cvt_pkrtz_f16_f32 v164, v164, v165
v_fma_mix_f32 v226, v151, v151, v226 op_sel_hi:[1,1,0]
ds_read_u16 v163, v163
ds_read_u16 v161, v161
ds_read_b128 v[176:179], v250 offset:24576
v_cvt_pkrtz_f16_f32 v165, v166, v167
v_lshrrev_b64 v[164:165], 2, v[164:165]
v_and_b32_sdwa v166, s47, v164 dst_sel:DWORD dst_unused:UNUSED_PAD src0_sel:DWORD src1_sel:WORD_1
v_and_b32_e64 v164, s47, v164
v_exp_f16_sdwa v173, v173 dst_sel:WORD_0 dst_unused:UNUSED_PRESERVE src0_sel:WORD_0
v_mfma_f32_32x32x16_bf16 v[96:111], v[16:19], v[184:187], v[96:111]
ds_read_u16 v166, v166
ds_read_u16 v164, v164
v_exp_f16_sdwa v175, v175 dst_sel:WORD_0 dst_unused:UNUSED_PRESERVE src0_sel:WORD_0
v_fma_mix_f32 v226, v152, v152, v226 op_sel_hi:[1,1,0]
v_and_b32_sdwa v167, s47, v165 dst_sel:DWORD dst_unused:UNUSED_PAD src0_sel:DWORD src1_sel:WORD_1
v_fma_mix_f32 v226, v153, v153, v226 op_sel_hi:[1,1,0]
v_and_b32_e64 v165, s47, v165
v_exp_f16_sdwa v173, v173 dst_sel:WORD_1 dst_unused:UNUSED_PRESERVE src0_sel:WORD_1
v_fma_mix_f32 v226, v154, v154, v226 op_sel_hi:[1,1,0]
v_cvt_pkrtz_f16_f32 v168, v168, v169
v_fma_mix_f32 v226, v155, v155, v226 op_sel_hi:[1,1,0]
v_cvt_pkrtz_f16_f32 v169, v170, v171
v_lshrrev_b64 v[168:169], 2, v[168:169]
ds_read_u16 v167, v167
ds_read_u16 v165, v165
v_and_b32_sdwa v170, s47, v168 dst_sel:DWORD dst_unused:UNUSED_PAD src0_sel:DWORD src1_sel:WORD_1
v_and_b32_e64 v168, s47, v168
v_exp_f16_sdwa v175, v175 dst_sel:WORD_1 dst_unused:UNUSED_PRESERVE src0_sel:WORD_1
v_mfma_f32_32x32x16_bf16 v[112:127], v[40:43], v[184:187], v[112:127]
ds_read_u16 v170, v170
ds_read_u16 v168, v168
s_add_u32 s46, s80, 10485760
buffer_store_dwordx4 v[20:23], v250, s[32:35], s46 offen
ds_read_b128 v[180:183], v250 offset:25600
v_and_b32_sdwa v171, s47, v169 dst_sel:DWORD dst_unused:UNUSED_PAD src0_sel:DWORD src1_sel:WORD_1
v_and_b32_e64 v169, s47, v169
v_pk_add_f16 v173, v173, 1.0 op_sel_hi:[1,0]
v_pk_add_f16 v175, v175, 1.0 op_sel_hi:[1,0]
v_rcp_f16_sdwa v173, v173 dst_sel:WORD_0 dst_unused:UNUSED_PRESERVE src0_sel:WORD_0
v_mfma_f32_32x32x16_bf16 v[96:111], v[20:23], v[188:191], v[96:111]
ds_read_u16 v171, v171
ds_read_u16 v169, v169
v_rcp_f16_sdwa v175, v175 dst_sel:WORD_0 dst_unused:UNUSED_PRESERVE src0_sel:WORD_0
v_rcp_f16_sdwa v173, v173 dst_sel:WORD_1 dst_unused:UNUSED_PRESERVE src0_sel:WORD_1
v_rcp_f16_sdwa v175, v175 dst_sel:WORD_1 dst_unused:UNUSED_PRESERVE src0_sel:WORD_1
v_mfma_f32_32x32x16_bf16 v[112:127], v[44:47], v[188:191], v[112:127]
ds_read_b128 v[184:187], v250 offset:26624
v_pk_mul_f16 v172, v172, v173
v_pk_mul_f16 v174, v174, v175
v_fma_mix_f32 v226, v172, v172, v226 op_sel_hi:[1,1,0]
s_nop 1
v_cvt_pkrtz_f16_f32 v96, v96, v97
v_fma_mix_f32 v226, v174, v174, v226 op_sel_hi:[1,1,0]
s_waitcnt lgkmcnt(7)
v_mfma_f32_32x32x16_bf16 v[128:143], v[0:3], v[176:179], 0
v_fma_mix_f32 v226, v172, v172, v226 op_sel:[1,1,0] op_sel_hi:[1,1,0]
v_cvt_pkrtz_f16_f32 v97, v98, v99
v_fma_mix_f32 v226, v174, v174, v226 op_sel:[1,1,0] op_sel_hi:[1,1,0]
v_lshrrev_b64 v[96:97], 2, v[96:97]
v_fma_mix_f32 v226, v160, v160, v226 op_sel_hi:[1,1,0]
v_and_b32_sdwa v98, s47, v96 dst_sel:DWORD dst_unused:UNUSED_PAD src0_sel:DWORD src1_sel:WORD_1
v_fma_mix_f32 v226, v161, v161, v226 op_sel_hi:[1,1,0]
v_and_b32_e64 v96, s47, v96
v_fma_mix_f32 v226, v162, v162, v226 op_sel_hi:[1,1,0]
v_cvt_pk_f16_f32 v108, v108, v109
v_fma_mix_f32 v226, v163, v163, v226 op_sel_hi:[1,1,0]
v_cvt_pk_f16_f32 v110, v110, v111
v_pk_fma_f16 v109, v108, v108, s48
v_mfma_f32_32x32x16_bf16 v[144:159], v[24:27], v[176:179], 0
ds_read_u16 v98, v98
ds_read_u16 v96, v96
v_fma_mix_f32 v226, v164, v164, v226 op_sel_hi:[1,1,0]
v_and_b32_sdwa v99, s47, v97 dst_sel:DWORD dst_unused:UNUSED_PAD src0_sel:DWORD src1_sel:WORD_1
s_waitcnt lgkmcnt(5)
v_fma_mix_f32 v226, v165, v165, v226 op_sel_hi:[1,1,0]
v_and_b32 v97, s47, v97
v_pk_fma_f16 v111, v110, v110, s48
v_pk_mul_f16 v109, v108, v109
v_pk_mul_f16 v111, v110, v111
v_fma_mix_f32 v226, v166, v166, v226 op_sel_hi:[1,1,0]
v_cvt_pkrtz_f16_f32 v100, v100, v101
v_fma_mix_f32 v226, v167, v167, v226 op_sel_hi:[1,1,0]
ds_read_u16 v99, v99
ds_read_u16 v97, v97
ds_read_b128 v[188:191], v250 offset:27648
v_cvt_pkrtz_f16_f32 v101, v102, v103
v_lshrrev_b64 v[100:101], 2, v[100:101]
v_and_b32_sdwa v102, s47, v100 dst_sel:DWORD dst_unused:UNUSED_PAD src0_sel:DWORD src1_sel:WORD_1
v_and_b32_e64 v100, s47, v100
v_exp_f16_sdwa v109, v109 dst_sel:WORD_0 dst_unused:UNUSED_PRESERVE src0_sel:WORD_0
v_mfma_f32_32x32x16_bf16 v[128:143], v[4:7], v[180:183], v[128:143]
ds_read_u16 v102, v102
ds_read_u16 v100, v100
v_exp_f16_sdwa v111, v111 dst_sel:WORD_0 dst_unused:UNUSED_PRESERVE src0_sel:WORD_0
v_fma_mix_f32 v226, v168, v168, v226 op_sel_hi:[1,1,0]
v_and_b32_sdwa v103, s47, v101 dst_sel:DWORD dst_unused:UNUSED_PAD src0_sel:DWORD src1_sel:WORD_1
s_waitcnt lgkmcnt(7)
v_fma_mix_f32 v226, v169, v169, v226 op_sel_hi:[1,1,0]
v_and_b32 v101, s47, v101
v_exp_f16_sdwa v109, v109 dst_sel:WORD_1 dst_unused:UNUSED_PRESERVE src0_sel:WORD_1
v_fma_mix_f32 v226, v170, v170, v226 op_sel_hi:[1,1,0]
v_cvt_pkrtz_f16_f32 v104, v104, v105
v_fma_mix_f32 v226, v171, v171, v226 op_sel_hi:[1,1,0]
v_cvt_pkrtz_f16_f32 v105, v106, v107
v_lshrrev_b64 v[104:105], 2, v[104:105]
ds_read_u16 v103, v103
ds_read_u16 v101, v101
v_and_b32_sdwa v106, s47, v104 dst_sel:DWORD dst_unused:UNUSED_PAD src0_sel:DWORD src1_sel:WORD_1
v_and_b32_e64 v104, s47, v104
v_exp_f16_sdwa v111, v111 dst_sel:WORD_1 dst_unused:UNUSED_PRESERVE src0_sel:WORD_1
v_mfma_f32_32x32x16_bf16 v[144:159], v[28:31], v[180:183], v[144:159]
ds_read_u16 v106, v106
ds_read_u16 v104, v104
ds_read_b128 v[176:179], v250 offset:28672
v_and_b32_sdwa v107, s47, v105 dst_sel:DWORD dst_unused:UNUSED_PAD src0_sel:DWORD src1_sel:WORD_1
v_and_b32_e64 v105, s47, v105
v_pk_add_f16 v109, v109, 1.0 op_sel_hi:[1,0]
v_pk_add_f16 v111, v111, 1.0 op_sel_hi:[1,0]
v_rcp_f16_sdwa v109, v109 dst_sel:WORD_0 dst_unused:UNUSED_PRESERVE src0_sel:WORD_0
v_mfma_f32_32x32x16_bf16 v[128:143], v[8:11], v[184:187], v[128:143]
ds_read_u16 v107, v107
ds_read_u16 v105, v105
v_rcp_f16_sdwa v111, v111 dst_sel:WORD_0 dst_unused:UNUSED_PRESERVE src0_sel:WORD_0
v_rcp_f16_sdwa v109, v109 dst_sel:WORD_1 dst_unused:UNUSED_PRESERVE src0_sel:WORD_1
v_rcp_f16_sdwa v111, v111 dst_sel:WORD_1 dst_unused:UNUSED_PRESERVE src0_sel:WORD_1
v_mfma_f32_32x32x16_bf16 v[144:159], v[32:35], v[184:187], v[144:159]
ds_read_b128 v[180:183], v250 offset:29696
v_pk_mul_f16 v108, v108, v109
v_pk_mul_f16 v110, v110, v111
v_fma_mix_f32 v227, v108, v108, v227 op_sel_hi:[1,1,0]
v_cvt_pkrtz_f16_f32 v112, v112, v113
v_fma_mix_f32 v227, v110, v110, v227 op_sel_hi:[1,1,0]
s_waitcnt lgkmcnt(7)
v_mfma_f32_32x32x16_bf16 v[128:143], v[12:15], v[188:191], v[128:143]
v_fma_mix_f32 v227, v108, v108, v227 op_sel:[1,1,0] op_sel_hi:[1,1,0]
v_cvt_pkrtz_f16_f32 v113, v114, v115
v_fma_mix_f32 v227, v110, v110, v227 op_sel:[1,1,0] op_sel_hi:[1,1,0]
v_lshrrev_b64 v[112:113], 2, v[112:113]
v_fma_mix_f32 v227, v96, v96, v227 op_sel_hi:[1,1,0]
v_and_b32_sdwa v114, s47, v112 dst_sel:DWORD dst_unused:UNUSED_PAD src0_sel:DWORD src1_sel:WORD_1
v_fma_mix_f32 v227, v97, v97, v227 op_sel_hi:[1,1,0]
v_and_b32 v112, s47, v112
v_fma_mix_f32 v227, v98, v98, v227 op_sel_hi:[1,1,0]
v_cvt_pk_f16_f32 v124, v124, v125
v_fma_mix_f32 v227, v99, v99, v227 op_sel_hi:[1,1,0]
v_cvt_pk_f16_f32 v126, v126, v127
v_pk_fma_f16 v125, v124, v124, s48
v_mfma_f32_32x32x16_bf16 v[144:159], v[36:39], v[188:191], v[144:159]
ds_read_u16 v114, v114
ds_read_u16 v112, v112
v_fma_mix_f32 v227, v100, v100, v227 op_sel_hi:[1,1,0]
v_and_b32_sdwa v115, s47, v113 dst_sel:DWORD dst_unused:UNUSED_PAD src0_sel:DWORD src1_sel:WORD_1
s_waitcnt lgkmcnt(5)
v_fma_mix_f32 v227, v101, v101, v227 op_sel_hi:[1,1,0]
v_and_b32 v113, s47, v113
v_pk_fma_f16 v127, v126, v126, s48
v_pk_mul_f16 v125, v124, v125
v_pk_mul_f16 v127, v126, v127
v_fma_mix_f32 v227, v102, v102, v227 op_sel_hi:[1,1,0]
v_cvt_pkrtz_f16_f32 v116, v116, v117
v_fma_mix_f32 v227, v103, v103, v227 op_sel_hi:[1,1,0]
ds_read_u16 v115, v115
ds_read_u16 v113, v113
ds_read_b128 v[184:187], v250 offset:30720
v_cvt_pkrtz_f16_f32 v117, v118, v119
v_lshrrev_b64 v[116:117], 2, v[116:117]
v_and_b32_sdwa v118, s47, v116 dst_sel:DWORD dst_unused:UNUSED_PAD src0_sel:DWORD src1_sel:WORD_1
v_and_b32_e64 v116, s47, v116
v_exp_f16_sdwa v125, v125 dst_sel:WORD_0 dst_unused:UNUSED_PRESERVE src0_sel:WORD_0
v_mfma_f32_32x32x16_bf16 v[128:143], v[16:19], v[176:179], v[128:143]
ds_read_u16 v118, v118
ds_read_u16 v116, v116
v_exp_f16_sdwa v127, v127 dst_sel:WORD_0 dst_unused:UNUSED_PRESERVE src0_sel:WORD_0
v_fma_mix_f32 v227, v104, v104, v227 op_sel_hi:[1,1,0]
v_and_b32_sdwa v119, s47, v117 dst_sel:DWORD dst_unused:UNUSED_PAD src0_sel:DWORD src1_sel:WORD_1
s_waitcnt lgkmcnt(7)
v_fma_mix_f32 v227, v105, v105, v227 op_sel_hi:[1,1,0]
v_and_b32 v117, s47, v117
v_exp_f16_sdwa v125, v125 dst_sel:WORD_1 dst_unused:UNUSED_PRESERVE src0_sel:WORD_1
v_fma_mix_f32 v227, v106, v106, v227 op_sel_hi:[1,1,0]
v_cvt_pkrtz_f16_f32 v120, v120, v121
v_fma_mix_f32 v227, v107, v107, v227 op_sel_hi:[1,1,0]
v_cvt_pkrtz_f16_f32 v121, v122, v123
v_lshrrev_b64 v[120:121], 2, v[120:121]
ds_read_u16 v119, v119
ds_read_u16 v117, v117
v_and_b32_sdwa v122, s47, v120 dst_sel:DWORD dst_unused:UNUSED_PAD src0_sel:DWORD src1_sel:WORD_1
v_and_b32_e64 v120, s47, v120
v_exp_f16_sdwa v127, v127 dst_sel:WORD_1 dst_unused:UNUSED_PRESERVE src0_sel:WORD_1
v_mfma_f32_32x32x16_bf16 v[144:159], v[40:43], v[176:179], v[144:159]
ds_read_u16 v122, v122
ds_read_u16 v120, v120
ds_read_b128 v[188:191], v250 offset:31744
v_and_b32_sdwa v123, s47, v121 dst_sel:DWORD dst_unused:UNUSED_PAD src0_sel:DWORD src1_sel:WORD_1
v_and_b32_e64 v121, s47, v121
v_pk_add_f16 v125, v125, 1.0 op_sel_hi:[1,0]
v_pk_add_f16 v127, v127, 1.0 op_sel_hi:[1,0]
v_rcp_f16_sdwa v125, v125 dst_sel:WORD_0 dst_unused:UNUSED_PRESERVE src0_sel:WORD_0
v_mfma_f32_32x32x16_bf16 v[128:143], v[20:23], v[180:183], v[128:143]
ds_read_u16 v123, v123
ds_read_u16 v121, v121
v_rcp_f16_sdwa v127, v127 dst_sel:WORD_0 dst_unused:UNUSED_PRESERVE src0_sel:WORD_0
v_rcp_f16_sdwa v125, v125 dst_sel:WORD_1 dst_unused:UNUSED_PRESERVE src0_sel:WORD_1
v_rcp_f16_sdwa v127, v127 dst_sel:WORD_1 dst_unused:UNUSED_PRESERVE src0_sel:WORD_1
v_mfma_f32_32x32x16_bf16 v[144:159], v[44:47], v[180:183], v[144:159]
ds_read_b128 v[176:179], v250 offset:32768
v_pk_mul_f16 v124, v124, v125
v_pk_mul_f16 v126, v126, v127
v_fma_mix_f32 v227, v124, v124, v227 op_sel_hi:[1,1,0]
s_cmp_lg_u32 s40, 7
s_cbranch_scc1 Lnoinit
s_waitcnt vmcnt(0)
v_mov_b32 v222, 1
v_mov_b32 v223, 0
s_nop 4
s_mov_b64 exec, 1
buffer_atomic_add v222, v223, s[36:39], 0 offen
s_mov_b64 exec, -1
s_nop 1
Lnoinit:
v_cvt_pkrtz_f16_f32 v128, v128, v129
v_fma_mix_f32 v227, v126, v126, v227 op_sel_hi:[1,1,0]
s_waitcnt lgkmcnt(7)
v_mfma_f32_32x32x16_bf16 v[160:175], v[0:3], v[184:187], 0
v_fma_mix_f32 v227, v124, v124, v227 op_sel:[1,1,0] op_sel_hi:[1,1,0]
v_cvt_pkrtz_f16_f32 v129, v130, v131
v_fma_mix_f32 v227, v126, v126, v227 op_sel:[1,1,0] op_sel_hi:[1,1,0]
v_lshrrev_b64 v[128:129], 2, v[128:129]
v_fma_mix_f32 v227, v112, v112, v227 op_sel_hi:[1,1,0]
v_and_b32_sdwa v130, s47, v128 dst_sel:DWORD dst_unused:UNUSED_PAD src0_sel:DWORD src1_sel:WORD_1
v_fma_mix_f32 v227, v113, v113, v227 op_sel_hi:[1,1,0]
v_and_b32_e64 v128, s47, v128
v_fma_mix_f32 v227, v114, v114, v227 op_sel_hi:[1,1,0]
v_cvt_pk_f16_f32 v140, v140, v141
v_fma_mix_f32 v227, v115, v115, v227 op_sel_hi:[1,1,0]
v_cvt_pk_f16_f32 v142, v142, v143
v_pk_fma_f16 v141, v140, v140, s48
v_mfma_f32_32x32x16_bf16 v[96:111], v[24:27], v[184:187], 0
ds_read_u16 v130, v130
ds_read_u16 v128, v128
v_fma_mix_f32 v227, v116, v116, v227 op_sel_hi:[1,1,0]
v_and_b32_sdwa v131, s47, v129 dst_sel:DWORD dst_unused:UNUSED_PAD src0_sel:DWORD src1_sel:WORD_1
s_waitcnt lgkmcnt(5)
v_fma_mix_f32 v227, v117, v117, v227 op_sel_hi:[1,1,0]
v_and_b32 v129, s47, v129
v_pk_fma_f16 v143, v142, v142, s48
v_pk_mul_f16 v141, v140, v141
v_pk_mul_f16 v143, v142, v143
v_fma_mix_f32 v227, v118, v118, v227 op_sel_hi:[1,1,0]
v_cvt_pkrtz_f16_f32 v132, v132, v133
v_fma_mix_f32 v227, v119, v119, v227 op_sel_hi:[1,1,0]
ds_read_u16 v131, v131
ds_read_u16 v129, v129
ds_read_b128 v[180:183], v250 offset:33792
v_cvt_pkrtz_f16_f32 v133, v134, v135
v_lshrrev_b64 v[132:133], 2, v[132:133]
v_and_b32_sdwa v134, s47, v132 dst_sel:DWORD dst_unused:UNUSED_PAD src0_sel:DWORD src1_sel:WORD_1
v_and_b32_e64 v132, s47, v132
v_exp_f16_sdwa v141, v141 dst_sel:WORD_0 dst_unused:UNUSED_PRESERVE src0_sel:WORD_0
v_mfma_f32_32x32x16_bf16 v[160:175], v[4:7], v[188:191], v[160:175]
ds_read_u16 v134, v134
ds_read_u16 v132, v132
v_exp_f16_sdwa v143, v143 dst_sel:WORD_0 dst_unused:UNUSED_PRESERVE src0_sel:WORD_0
v_fma_mix_f32 v227, v120, v120, v227 op_sel_hi:[1,1,0]
v_and_b32_sdwa v135, s47, v133 dst_sel:DWORD dst_unused:UNUSED_PAD src0_sel:DWORD src1_sel:WORD_1
s_waitcnt lgkmcnt(7)
v_fma_mix_f32 v227, v121, v121, v227 op_sel_hi:[1,1,0]
v_and_b32 v133, s47, v133
v_exp_f16_sdwa v141, v141 dst_sel:WORD_1 dst_unused:UNUSED_PRESERVE src0_sel:WORD_1
v_fma_mix_f32 v227, v122, v122, v227 op_sel_hi:[1,1,0]
v_cvt_pkrtz_f16_f32 v136, v136, v137
v_fma_mix_f32 v227, v123, v123, v227 op_sel_hi:[1,1,0]
v_cvt_pkrtz_f16_f32 v137, v138, v139
v_lshrrev_b64 v[136:137], 2, v[136:137]
ds_read_u16 v135, v135
ds_read_u16 v133, v133
v_and_b32_sdwa v138, s47, v136 dst_sel:DWORD dst_unused:UNUSED_PAD src0_sel:DWORD src1_sel:WORD_1
v_and_b32_e64 v136, s47, v136
v_exp_f16_sdwa v143, v143 dst_sel:WORD_1 dst_unused:UNUSED_PRESERVE src0_sel:WORD_1
v_mfma_f32_32x32x16_bf16 v[96:111], v[28:31], v[188:191], v[96:111]
ds_read_u16 v138, v138
ds_read_u16 v136, v136
ds_read_b128 v[184:187], v250 offset:34816
v_and_b32_sdwa v139, s47, v137 dst_sel:DWORD dst_unused:UNUSED_PAD src0_sel:DWORD src1_sel:WORD_1
v_and_b32_e64 v137, s47, v137
v_pk_add_f16 v141, v141, 1.0 op_sel_hi:[1,0]
v_pk_add_f16 v143, v143, 1.0 op_sel_hi:[1,0]
v_rcp_f16_sdwa v141, v141 dst_sel:WORD_0 dst_unused:UNUSED_PRESERVE src0_sel:WORD_0
v_mfma_f32_32x32x16_bf16 v[160:175], v[8:11], v[176:179], v[160:175]
ds_read_u16 v139, v139
ds_read_u16 v137, v137
v_rcp_f16_sdwa v143, v143 dst_sel:WORD_0 dst_unused:UNUSED_PRESERVE src0_sel:WORD_0
v_rcp_f16_sdwa v141, v141 dst_sel:WORD_1 dst_unused:UNUSED_PRESERVE src0_sel:WORD_1
v_rcp_f16_sdwa v143, v143 dst_sel:WORD_1 dst_unused:UNUSED_PRESERVE src0_sel:WORD_1
v_mfma_f32_32x32x16_bf16 v[96:111], v[32:35], v[176:179], v[96:111]
ds_read_b128 v[188:191], v250 offset:35840
v_pk_mul_f16 v140, v140, v141
v_pk_mul_f16 v142, v142, v143
v_fma_mix_f32 v228, v140, v140, v228 op_sel_hi:[1,1,0]
s_add_u32 s66, s66, 786432
s_sub_u32 s81, s81, 13184
v_bfe_u32 v223, v250, 4, 6
v_and_b32 v222, 15, v223
v_lshlrev_b32 v222, 7, v222
v_lshrrev_b32_e64 v223, 4, v223
v_mul_u32_u24 v223, 98304, v223
s_sub_u32 s43, s67, -8000
s_mul_i32 s44, s41, 192
s_add_u32 s43, s43, s44
v_add3_u32 v222, v222, v223, s43
s_mov_b32 m0, 163840
s_add_u32 s44, s66, 393216
buffer_load_dword v222, s[4:7], s66 offen lds
buffer_load_dword v222, s[4:7], s44 offen lds
v_fma_mix_f32 v228, v142, v142, v228 op_sel_hi:[1,1,0]
s_waitcnt lgkmcnt(6)
v_mfma_f32_32x32x16_bf16 v[160:175], v[12:15], v[180:183], v[160:175]
v_fma_mix_f32 v228, v140, v140, v228 op_sel:[1,1,0] op_sel_hi:[1,1,0]
v_cvt_pkrtz_f16_f32 v144, v144, v145
v_fma_mix_f32 v228, v142, v142, v228 op_sel:[1,1,0] op_sel_hi:[1,1,0]
v_cvt_pkrtz_f16_f32 v145, v146, v147
v_fma_mix_f32 v228, v128, v128, v228 op_sel_hi:[1,1,0]
v_lshrrev_b64 v[144:145], 2, v[144:145]
v_fma_mix_f32 v228, v129, v129, v228 op_sel_hi:[1,1,0]
v_and_b32_sdwa v146, s47, v144 dst_sel:DWORD dst_unused:UNUSED_PAD src0_sel:DWORD src1_sel:WORD_1
v_fma_mix_f32 v228, v130, v130, v228 op_sel_hi:[1,1,0]
v_and_b32_e64 v144, s47, v144
v_fma_mix_f32 v228, v131, v131, v228 op_sel_hi:[1,1,0]
v_cvt_pk_f16_f32 v156, v156, v157
v_cvt_pk_f16_f32 v158, v158, v159
v_pk_fma_f16 v157, v156, v156, s48
v_mfma_f32_32x32x16_bf16 v[96:111], v[36:39], v[180:183], v[96:111]
ds_read_u16 v146, v146
ds_read_u16 v144, v144
v_fma_mix_f32 v228, v132, v132, v228 op_sel_hi:[1,1,0]
v_and_b32_sdwa v147, s47, v145 dst_sel:DWORD dst_unused:UNUSED_PAD src0_sel:DWORD src1_sel:WORD_1
v_fma_mix_f32 v228, v133, v133, v228 op_sel_hi:[1,1,0]
v_and_b32_e64 v145, s47, v145
v_pk_fma_f16 v159, v158, v158, s48
v_pk_mul_f16 v157, v156, v157
v_pk_mul_f16 v159, v158, v159
v_fma_mix_f32 v228, v134, v134, v228 op_sel_hi:[1,1,0]
v_cvt_pkrtz_f16_f32 v148, v148, v149
v_fma_mix_f32 v228, v135, v135, v228 op_sel_hi:[1,1,0]
ds_read_u16 v147, v147
ds_read_u16 v145, v145
ds_read_b128 v[176:179], v250 offset:36864
v_cvt_pkrtz_f16_f32 v149, v150, v151
v_lshrrev_b64 v[148:149], 2, v[148:149]
v_and_b32_sdwa v150, s47, v148 dst_sel:DWORD dst_unused:UNUSED_PAD src0_sel:DWORD src1_sel:WORD_1
v_and_b32 v148, s47, v148
v_exp_f16_sdwa v157, v157 dst_sel:WORD_0 dst_unused:UNUSED_PRESERVE src0_sel:WORD_0
s_waitcnt lgkmcnt(5)
v_mfma_f32_32x32x16_bf16 v[160:175], v[16:19], v[184:187], v[160:175]
ds_read_u16 v150, v150
ds_read_u16 v148, v148
v_exp_f16_sdwa v159, v159 dst_sel:WORD_0 dst_unused:UNUSED_PRESERVE src0_sel:WORD_0
v_fma_mix_f32 v228, v136, v136, v228 op_sel_hi:[1,1,0]
v_and_b32_sdwa v151, s47, v149 dst_sel:DWORD dst_unused:UNUSED_PAD src0_sel:DWORD src1_sel:WORD_1
v_fma_mix_f32 v228, v137, v137, v228 op_sel_hi:[1,1,0]
v_and_b32_e64 v149, s47, v149
v_exp_f16_sdwa v157, v157 dst_sel:WORD_1 dst_unused:UNUSED_PRESERVE src0_sel:WORD_1
v_fma_mix_f32 v228, v138, v138, v228 op_sel_hi:[1,1,0]
v_cvt_pkrtz_f16_f32 v152, v152, v153
v_fma_mix_f32 v228, v139, v139, v228 op_sel_hi:[1,1,0]
v_cvt_pkrtz_f16_f32 v153, v154, v155
v_lshrrev_b64 v[152:153], 2, v[152:153]
ds_read_u16 v151, v151
ds_read_u16 v149, v149
v_and_b32_sdwa v154, s47, v152 dst_sel:DWORD dst_unused:UNUSED_PAD src0_sel:DWORD src1_sel:WORD_1
v_and_b32_e64 v152, s47, v152
v_exp_f16_sdwa v159, v159 dst_sel:WORD_1 dst_unused:UNUSED_PRESERVE src0_sel:WORD_1
v_mfma_f32_32x32x16_bf16 v[96:111], v[40:43], v[184:187], v[96:111]
ds_read_u16 v154, v154
ds_read_u16 v152, v152
ds_read_b128 v[180:183], v250 offset:37888
v_and_b32_sdwa v155, s47, v153 dst_sel:DWORD dst_unused:UNUSED_PAD src0_sel:DWORD src1_sel:WORD_1
v_and_b32_e64 v153, s47, v153
v_pk_add_f16 v157, v157, 1.0 op_sel_hi:[1,0]
v_pk_add_f16 v159, v159, 1.0 op_sel_hi:[1,0]
v_rcp_f16_sdwa v157, v157 dst_sel:WORD_0 dst_unused:UNUSED_PRESERVE src0_sel:WORD_0
v_mfma_f32_32x32x16_bf16 v[160:175], v[20:23], v[188:191], v[160:175]
ds_read_u16 v155, v155
ds_read_u16 v153, v153
v_rcp_f16_sdwa v159, v159 dst_sel:WORD_0 dst_unused:UNUSED_PRESERVE src0_sel:WORD_0
v_rcp_f16_sdwa v157, v157 dst_sel:WORD_1 dst_unused:UNUSED_PRESERVE src0_sel:WORD_1
v_rcp_f16_sdwa v159, v159 dst_sel:WORD_1 dst_unused:UNUSED_PRESERVE src0_sel:WORD_1
v_mfma_f32_32x32x16_bf16 v[96:111], v[44:47], v[188:191], v[96:111]
ds_read_b128 v[184:187], v250 offset:38912
v_pk_mul_f16 v156, v156, v157
v_pk_mul_f16 v158, v158, v159
v_fma_mix_f32 v228, v156, v156, v228 op_sel_hi:[1,1,0]
s_nop 1
v_cvt_pkrtz_f16_f32 v160, v160, v161
v_fma_mix_f32 v228, v158, v158, v228 op_sel_hi:[1,1,0]
s_waitcnt lgkmcnt(7)
v_mfma_f32_32x32x16_bf16 v[112:127], v[0:3], v[176:179], 0
v_fma_mix_f32 v228, v156, v156, v228 op_sel:[1,1,0] op_sel_hi:[1,1,0]
v_cvt_pkrtz_f16_f32 v161, v162, v163
v_fma_mix_f32 v228, v158, v158, v228 op_sel:[1,1,0] op_sel_hi:[1,1,0]
v_lshrrev_b64 v[160:161], 2, v[160:161]
v_fma_mix_f32 v228, v144, v144, v228 op_sel_hi:[1,1,0]
v_and_b32_sdwa v162, s47, v160 dst_sel:DWORD dst_unused:UNUSED_PAD src0_sel:DWORD src1_sel:WORD_1
v_fma_mix_f32 v228, v145, v145, v228 op_sel_hi:[1,1,0]
v_and_b32_e64 v160, s47, v160
v_fma_mix_f32 v228, v146, v146, v228 op_sel_hi:[1,1,0]
v_cvt_pk_f16_f32 v172, v172, v173
v_fma_mix_f32 v228, v147, v147, v228 op_sel_hi:[1,1,0]
v_cvt_pk_f16_f32 v174, v174, v175
v_pk_fma_f16 v173, v172, v172, s48
v_mfma_f32_32x32x16_bf16 v[128:143], v[24:27], v[176:179], 0
ds_read_u16 v162, v162
ds_read_u16 v160, v160
v_fma_mix_f32 v228, v148, v148, v228 op_sel_hi:[1,1,0]
v_and_b32_sdwa v163, s47, v161 dst_sel:DWORD dst_unused:UNUSED_PAD src0_sel:DWORD src1_sel:WORD_1
s_waitcnt lgkmcnt(5)
v_fma_mix_f32 v228, v149, v149, v228 op_sel_hi:[1,1,0]
v_and_b32 v161, s47, v161
v_pk_fma_f16 v175, v174, v174, s48
v_pk_mul_f16 v173, v172, v173
v_pk_mul_f16 v175, v174, v175
v_fma_mix_f32 v228, v150, v150, v228 op_sel_hi:[1,1,0]
v_cvt_pkrtz_f16_f32 v164, v164, v165
v_fma_mix_f32 v228, v151, v151, v228 op_sel_hi:[1,1,0]
ds_read_u16 v163, v163
ds_read_u16 v161, v161
ds_read_b128 v[188:191], v250 offset:39936
v_cvt_pkrtz_f16_f32 v165, v166, v167
v_lshrrev_b64 v[164:165], 2, v[164:165]
v_and_b32_sdwa v166, s47, v164 dst_sel:DWORD dst_unused:UNUSED_PAD src0_sel:DWORD src1_sel:WORD_1
v_and_b32_e64 v164, s47, v164
v_exp_f16_sdwa v173, v173 dst_sel:WORD_0 dst_unused:UNUSED_PRESERVE src0_sel:WORD_0
v_mfma_f32_32x32x16_bf16 v[112:127], v[4:7], v[180:183], v[112:127]
ds_read_u16 v166, v166
ds_read_u16 v164, v164
v_fma_mix_f32 v228, v152, v152, v228 op_sel_hi:[1,1,0]
v_exp_f16_sdwa v175, v175 dst_sel:WORD_0 dst_unused:UNUSED_PRESERVE src0_sel:WORD_0
s_waitcnt lgkmcnt(7)
v_fma_mix_f32 v228, v153, v153, v228 op_sel_hi:[1,1,0]
v_and_b32_sdwa v167, s47, v165 dst_sel:DWORD dst_unused:UNUSED_PAD src0_sel:DWORD src1_sel:WORD_1
v_and_b32 v165, s47, v165
v_exp_f16_sdwa v173, v173 dst_sel:WORD_1 dst_unused:UNUSED_PRESERVE src0_sel:WORD_1
v_fma_mix_f32 v228, v154, v154, v228 op_sel_hi:[1,1,0]
v_cvt_pkrtz_f16_f32 v168, v168, v169
v_fma_mix_f32 v228, v155, v155, v228 op_sel_hi:[1,1,0]
v_cvt_pkrtz_f16_f32 v169, v170, v171
v_lshrrev_b64 v[168:169], 2, v[168:169]
ds_read_u16 v167, v167
ds_read_u16 v165, v165
v_and_b32_sdwa v170, s47, v168 dst_sel:DWORD dst_unused:UNUSED_PAD src0_sel:DWORD src1_sel:WORD_1
v_and_b32_e64 v168, s47, v168
v_exp_f16_sdwa v175, v175 dst_sel:WORD_1 dst_unused:UNUSED_PRESERVE src0_sel:WORD_1
v_mfma_f32_32x32x16_bf16 v[128:143], v[28:31], v[180:183], v[128:143]
ds_read_u16 v170, v170
ds_read_u16 v168, v168
ds_read_b128 v[176:179], v250 offset:40960
v_and_b32_sdwa v171, s47, v169 dst_sel:DWORD dst_unused:UNUSED_PAD src0_sel:DWORD src1_sel:WORD_1
v_and_b32_e64 v169, s47, v169
v_pk_add_f16 v173, v173, 1.0 op_sel_hi:[1,0]
v_pk_add_f16 v175, v175, 1.0 op_sel_hi:[1,0]
v_rcp_f16_sdwa v173, v173 dst_sel:WORD_0 dst_unused:UNUSED_PRESERVE src0_sel:WORD_0
v_mfma_f32_32x32x16_bf16 v[112:127], v[8:11], v[184:187], v[112:127]
ds_read_u16 v171, v171
ds_read_u16 v169, v169
v_rcp_f16_sdwa v175, v175 dst_sel:WORD_0 dst_unused:UNUSED_PRESERVE src0_sel:WORD_0
v_rcp_f16_sdwa v173, v173 dst_sel:WORD_1 dst_unused:UNUSED_PRESERVE src0_sel:WORD_1
v_rcp_f16_sdwa v175, v175 dst_sel:WORD_1 dst_unused:UNUSED_PRESERVE src0_sel:WORD_1
v_mfma_f32_32x32x16_bf16 v[128:143], v[32:35], v[184:187], v[128:143]
ds_read_b128 v[180:183], v250 offset:41984
v_pk_mul_f16 v172, v172, v173
v_pk_mul_f16 v174, v174, v175
v_fma_mix_f32 v229, v172, v172, v229 op_sel_hi:[1,1,0]
v_cvt_pkrtz_f16_f32 v96, v96, v97
v_fma_mix_f32 v229, v174, v174, v229 op_sel_hi:[1,1,0]
s_waitcnt lgkmcnt(7)
v_mfma_f32_32x32x16_bf16 v[112:127], v[12:15], v[188:191], v[112:127]
v_fma_mix_f32 v229, v172, v172, v229 op_sel:[1,1,0] op_sel_hi:[1,1,0]
v_cvt_pkrtz_f16_f32 v97, v98, v99
v_fma_mix_f32 v229, v174, v174, v229 op_sel:[1,1,0] op_sel_hi:[1,1,0]
v_lshrrev_b64 v[96:97], 2, v[96:97]
v_fma_mix_f32 v229, v160, v160, v229 op_sel_hi:[1,1,0]
v_and_b32_sdwa v98, s47, v96 dst_sel:DWORD dst_unused:UNUSED_PAD src0_sel:DWORD src1_sel:WORD_1
v_fma_mix_f32 v229, v161, v161, v229 op_sel_hi:[1,1,0]
v_and_b32 v96, s47, v96
v_fma_mix_f32 v229, v162, v162, v229 op_sel_hi:[1,1,0]
v_cvt_pk_f16_f32 v108, v108, v109
v_fma_mix_f32 v229, v163, v163, v229 op_sel_hi:[1,1,0]
v_cvt_pk_f16_f32 v110, v110, v111
v_pk_fma_f16 v109, v108, v108, s48
v_mfma_f32_32x32x16_bf16 v[128:143], v[36:39], v[188:191], v[128:143]
ds_read_u16 v98, v98
ds_read_u16 v96, v96
v_fma_mix_f32 v229, v164, v164, v229 op_sel_hi:[1,1,0]
v_and_b32_sdwa v99, s47, v97 dst_sel:DWORD dst_unused:UNUSED_PAD src0_sel:DWORD src1_sel:WORD_1
s_waitcnt lgkmcnt(5)
v_fma_mix_f32 v229, v165, v165, v229 op_sel_hi:[1,1,0]
v_and_b32 v97, s47, v97
v_pk_fma_f16 v111, v110, v110, s48
v_pk_mul_f16 v109, v108, v109
v_pk_mul_f16 v111, v110, v111
v_fma_mix_f32 v229, v166, v166, v229 op_sel_hi:[1,1,0]
v_cvt_pkrtz_f16_f32 v100, v100, v101
v_fma_mix_f32 v229, v167, v167, v229 op_sel_hi:[1,1,0]
ds_read_u16 v99, v99
ds_read_u16 v97, v97
ds_read_b128 v[184:187], v250 offset:43008
v_cvt_pkrtz_f16_f32 v101, v102, v103
v_lshrrev_b64 v[100:101], 2, v[100:101]
v_and_b32_sdwa v102, s47, v100 dst_sel:DWORD dst_unused:UNUSED_PAD src0_sel:DWORD src1_sel:WORD_1
v_and_b32_e64 v100, s47, v100
v_exp_f16_sdwa v109, v109 dst_sel:WORD_0 dst_unused:UNUSED_PRESERVE src0_sel:WORD_0
v_mfma_f32_32x32x16_bf16 v[112:127], v[16:19], v[176:179], v[112:127]
ds_read_u16 v102, v102
ds_read_u16 v100, v100
v_fma_mix_f32 v229, v168, v168, v229 op_sel_hi:[1,1,0]
v_exp_f16_sdwa v111, v111 dst_sel:WORD_0 dst_unused:UNUSED_PRESERVE src0_sel:WORD_0
s_waitcnt lgkmcnt(7)
v_fma_mix_f32 v229, v169, v169, v229 op_sel_hi:[1,1,0]
v_and_b32_sdwa v103, s47, v101 dst_sel:DWORD dst_unused:UNUSED_PAD src0_sel:DWORD src1_sel:WORD_1
v_and_b32 v101, s47, v101
v_exp_f16_sdwa v109, v109 dst_sel:WORD_1 dst_unused:UNUSED_PRESERVE src0_sel:WORD_1
v_fma_mix_f32 v229, v170, v170, v229 op_sel_hi:[1,1,0]
v_cvt_pkrtz_f16_f32 v104, v104, v105
v_fma_mix_f32 v229, v171, v171, v229 op_sel_hi:[1,1,0]
v_cvt_pkrtz_f16_f32 v105, v106, v107
v_lshrrev_b64 v[104:105], 2, v[104:105]
ds_read_u16 v103, v103
ds_read_u16 v101, v101
v_and_b32_sdwa v106, s47, v104 dst_sel:DWORD dst_unused:UNUSED_PAD src0_sel:DWORD src1_sel:WORD_1
v_and_b32_e64 v104, s47, v104
v_exp_f16_sdwa v111, v111 dst_sel:WORD_1 dst_unused:UNUSED_PRESERVE src0_sel:WORD_1
v_mfma_f32_32x32x16_bf16 v[128:143], v[40:43], v[176:179], v[128:143]
ds_read_u16 v106, v106
ds_read_u16 v104, v104
ds_read_b128 v[188:191], v250 offset:44032
v_and_b32_sdwa v107, s47, v105 dst_sel:DWORD dst_unused:UNUSED_PAD src0_sel:DWORD src1_sel:WORD_1
v_and_b32_e64 v105, s47, v105
v_pk_add_f16 v109, v109, 1.0 op_sel_hi:[1,0]
v_pk_add_f16 v111, v111, 1.0 op_sel_hi:[1,0]
v_rcp_f16_sdwa v109, v109 dst_sel:WORD_0 dst_unused:UNUSED_PRESERVE src0_sel:WORD_0
v_mfma_f32_32x32x16_bf16 v[112:127], v[20:23], v[180:183], v[112:127]
ds_read_u16 v107, v107
ds_read_u16 v105, v105
v_rcp_f16_sdwa v111, v111 dst_sel:WORD_0 dst_unused:UNUSED_PRESERVE src0_sel:WORD_0
v_rcp_f16_sdwa v109, v109 dst_sel:WORD_1 dst_unused:UNUSED_PRESERVE src0_sel:WORD_1
v_rcp_f16_sdwa v111, v111 dst_sel:WORD_1 dst_unused:UNUSED_PRESERVE src0_sel:WORD_1
v_mfma_f32_32x32x16_bf16 v[128:143], v[44:47], v[180:183], v[128:143]
ds_read_b128 v[176:179], v250 offset:45056
v_pk_mul_f16 v108, v108, v109
v_pk_mul_f16 v110, v110, v111
v_fma_mix_f32 v229, v108, v108, v229 op_sel_hi:[1,1,0]
s_nop 1
v_cvt_pkrtz_f16_f32 v112, v112, v113
v_fma_mix_f32 v229, v110, v110, v229 op_sel_hi:[1,1,0]
s_waitcnt lgkmcnt(7)
v_mfma_f32_32x32x16_bf16 v[144:159], v[0:3], v[184:187], 0
v_fma_mix_f32 v229, v108, v108, v229 op_sel:[1,1,0] op_sel_hi:[1,1,0]
v_cvt_pkrtz_f16_f32 v113, v114, v115
v_fma_mix_f32 v229, v110, v110, v229 op_sel:[1,1,0] op_sel_hi:[1,1,0]
v_lshrrev_b64 v[112:113], 2, v[112:113]
v_fma_mix_f32 v229, v96, v96, v229 op_sel_hi:[1,1,0]
v_and_b32_sdwa v114, s47, v112 dst_sel:DWORD dst_unused:UNUSED_PAD src0_sel:DWORD src1_sel:WORD_1
v_fma_mix_f32 v229, v97, v97, v229 op_sel_hi:[1,1,0]
v_and_b32_e64 v112, s47, v112
v_fma_mix_f32 v229, v98, v98, v229 op_sel_hi:[1,1,0]
v_cvt_pk_f16_f32 v124, v124, v125
v_fma_mix_f32 v229, v99, v99, v229 op_sel_hi:[1,1,0]
v_cvt_pk_f16_f32 v126, v126, v127
v_pk_fma_f16 v125, v124, v124, s48
v_mfma_f32_32x32x16_bf16 v[160:175], v[24:27], v[184:187], 0
ds_read_u16 v114, v114
ds_read_u16 v112, v112
v_fma_mix_f32 v229, v100, v100, v229 op_sel_hi:[1,1,0]
v_and_b32_sdwa v115, s47, v113 dst_sel:DWORD dst_unused:UNUSED_PAD src0_sel:DWORD src1_sel:WORD_1
s_waitcnt lgkmcnt(5)
v_fma_mix_f32 v229, v101, v101, v229 op_sel_hi:[1,1,0]
v_and_b32 v113, s47, v113
v_pk_fma_f16 v127, v126, v126, s48
v_pk_mul_f16 v125, v124, v125
v_pk_mul_f16 v127, v126, v127
v_fma_mix_f32 v229, v102, v102, v229 op_sel_hi:[1,1,0]
v_cvt_pkrtz_f16_f32 v116, v116, v117
v_fma_mix_f32 v229, v103, v103, v229 op_sel_hi:[1,1,0]
ds_read_u16 v115, v115
ds_read_u16 v113, v113
ds_read_b128 v[180:183], v250 offset:46080
v_cvt_pkrtz_f16_f32 v117, v118, v119
v_lshrrev_b64 v[116:117], 2, v[116:117]
v_and_b32_sdwa v118, s47, v116 dst_sel:DWORD dst_unused:UNUSED_PAD src0_sel:DWORD src1_sel:WORD_1
v_and_b32_e64 v116, s47, v116
v_exp_f16_sdwa v125, v125 dst_sel:WORD_0 dst_unused:UNUSED_PRESERVE src0_sel:WORD_0
v_mfma_f32_32x32x16_bf16 v[144:159], v[4:7], v[188:191], v[144:159]
ds_read_u16 v118, v118
ds_read_u16 v116, v116
v_fma_mix_f32 v229, v104, v104, v229 op_sel_hi:[1,1,0]
v_exp_f16_sdwa v127, v127 dst_sel:WORD_0 dst_unused:UNUSED_PRESERVE src0_sel:WORD_0
s_waitcnt lgkmcnt(7)
v_fma_mix_f32 v229, v105, v105, v229 op_sel_hi:[1,1,0]
v_and_b32_sdwa v119, s47, v117 dst_sel:DWORD dst_unused:UNUSED_PAD src0_sel:DWORD src1_sel:WORD_1
v_and_b32 v117, s47, v117
v_exp_f16_sdwa v125, v125 dst_sel:WORD_1 dst_unused:UNUSED_PRESERVE src0_sel:WORD_1
v_fma_mix_f32 v229, v106, v106, v229 op_sel_hi:[1,1,0]
v_cvt_pkrtz_f16_f32 v120, v120, v121
v_fma_mix_f32 v229, v107, v107, v229 op_sel_hi:[1,1,0]
v_cvt_pkrtz_f16_f32 v121, v122, v123
v_lshrrev_b64 v[120:121], 2, v[120:121]
ds_read_u16 v119, v119
ds_read_u16 v117, v117
v_and_b32_sdwa v122, s47, v120 dst_sel:DWORD dst_unused:UNUSED_PAD src0_sel:DWORD src1_sel:WORD_1
v_and_b32_e64 v120, s47, v120
v_exp_f16_sdwa v127, v127 dst_sel:WORD_1 dst_unused:UNUSED_PRESERVE src0_sel:WORD_1
v_mfma_f32_32x32x16_bf16 v[160:175], v[28:31], v[188:191], v[160:175]
ds_read_u16 v122, v122
ds_read_u16 v120, v120
ds_read_b128 v[184:187], v250 offset:47104
v_and_b32_sdwa v123, s47, v121 dst_sel:DWORD dst_unused:UNUSED_PAD src0_sel:DWORD src1_sel:WORD_1
v_and_b32_e64 v121, s47, v121
v_pk_add_f16 v125, v125, 1.0 op_sel_hi:[1,0]
v_pk_add_f16 v127, v127, 1.0 op_sel_hi:[1,0]
v_rcp_f16_sdwa v125, v125 dst_sel:WORD_0 dst_unused:UNUSED_PRESERVE src0_sel:WORD_0
v_mfma_f32_32x32x16_bf16 v[144:159], v[8:11], v[176:179], v[144:159]
ds_read_u16 v123, v123
ds_read_u16 v121, v121
v_rcp_f16_sdwa v127, v127 dst_sel:WORD_0 dst_unused:UNUSED_PRESERVE src0_sel:WORD_0
v_rcp_f16_sdwa v125, v125 dst_sel:WORD_1 dst_unused:UNUSED_PRESERVE src0_sel:WORD_1
v_rcp_f16_sdwa v127, v127 dst_sel:WORD_1 dst_unused:UNUSED_PRESERVE src0_sel:WORD_1
v_mfma_f32_32x32x16_bf16 v[160:175], v[32:35], v[176:179], v[160:175]
ds_read_b128 v[188:191], v250 offset:48128
v_pk_mul_f16 v124, v124, v125
v_pk_mul_f16 v126, v126, v127
v_fma_mix_f32 v230, v124, v124, v230 op_sel_hi:[1,1,0]
v_cvt_pkrtz_f16_f32 v128, v128, v129
v_fma_mix_f32 v230, v126, v126, v230 op_sel_hi:[1,1,0]
s_waitcnt lgkmcnt(7)
v_mfma_f32_32x32x16_bf16 v[144:159], v[12:15], v[180:183], v[144:159]
v_fma_mix_f32 v230, v124, v124, v230 op_sel:[1,1,0] op_sel_hi:[1,1,0]
v_cvt_pkrtz_f16_f32 v129, v130, v131
v_fma_mix_f32 v230, v126, v126, v230 op_sel:[1,1,0] op_sel_hi:[1,1,0]
v_lshrrev_b64 v[128:129], 2, v[128:129]
v_fma_mix_f32 v230, v112, v112, v230 op_sel_hi:[1,1,0]
v_and_b32_sdwa v130, s47, v128 dst_sel:DWORD dst_unused:UNUSED_PAD src0_sel:DWORD src1_sel:WORD_1
v_fma_mix_f32 v230, v113, v113, v230 op_sel_hi:[1,1,0]
v_and_b32 v128, s47, v128
v_fma_mix_f32 v230, v114, v114, v230 op_sel_hi:[1,1,0]
v_cvt_pk_f16_f32 v140, v140, v141
v_fma_mix_f32 v230, v115, v115, v230 op_sel_hi:[1,1,0]
v_cvt_pk_f16_f32 v142, v142, v143
v_pk_fma_f16 v141, v140, v140, s48
v_mfma_f32_32x32x16_bf16 v[160:175], v[36:39], v[180:183], v[160:175]
ds_read_u16 v130, v130
ds_read_u16 v128, v128
v_fma_mix_f32 v230, v116, v116, v230 op_sel_hi:[1,1,0]
v_and_b32_sdwa v131, s47, v129 dst_sel:DWORD dst_unused:UNUSED_PAD src0_sel:DWORD src1_sel:WORD_1
s_waitcnt lgkmcnt(5)
v_fma_mix_f32 v230, v117, v117, v230 op_sel_hi:[1,1,0]
v_and_b32 v129, s47, v129
v_pk_fma_f16 v143, v142, v142, s48
v_pk_mul_f16 v141, v140, v141
v_pk_mul_f16 v143, v142, v143
v_fma_mix_f32 v230, v118, v118, v230 op_sel_hi:[1,1,0]
v_cvt_pkrtz_f16_f32 v132, v132, v133
v_fma_mix_f32 v230, v119, v119, v230 op_sel_hi:[1,1,0]
ds_read_u16 v131, v131
ds_read_u16 v129, v129
ds_read_b128 v[176:179], v250 offset:49152
v_cvt_pkrtz_f16_f32 v133, v134, v135
v_lshrrev_b64 v[132:133], 2, v[132:133]
v_and_b32_sdwa v134, s47, v132 dst_sel:DWORD dst_unused:UNUSED_PAD src0_sel:DWORD src1_sel:WORD_1
v_and_b32_e64 v132, s47, v132
v_exp_f16_sdwa v141, v141 dst_sel:WORD_0 dst_unused:UNUSED_PRESERVE src0_sel:WORD_0
v_mfma_f32_32x32x16_bf16 v[144:159], v[16:19], v[184:187], v[144:159]
ds_read_u16 v134, v134
ds_read_u16 v132, v132
v_fma_mix_f32 v230, v120, v120, v230 op_sel_hi:[1,1,0]
v_exp_f16_sdwa v143, v143 dst_sel:WORD_0 dst_unused:UNUSED_PRESERVE src0_sel:WORD_0
s_waitcnt lgkmcnt(7)
v_fma_mix_f32 v230, v121, v121, v230 op_sel_hi:[1,1,0]
v_and_b32_sdwa v135, s47, v133 dst_sel:DWORD dst_unused:UNUSED_PAD src0_sel:DWORD src1_sel:WORD_1
v_and_b32 v133, s47, v133
v_exp_f16_sdwa v141, v141 dst_sel:WORD_1 dst_unused:UNUSED_PRESERVE src0_sel:WORD_1
v_fma_mix_f32 v230, v122, v122, v230 op_sel_hi:[1,1,0]
v_cvt_pkrtz_f16_f32 v136, v136, v137
v_fma_mix_f32 v230, v123, v123, v230 op_sel_hi:[1,1,0]
v_cvt_pkrtz_f16_f32 v137, v138, v139
v_lshrrev_b64 v[136:137], 2, v[136:137]
ds_read_u16 v135, v135
ds_read_u16 v133, v133
v_and_b32_sdwa v138, s47, v136 dst_sel:DWORD dst_unused:UNUSED_PAD src0_sel:DWORD src1_sel:WORD_1
v_and_b32_e64 v136, s47, v136
v_exp_f16_sdwa v143, v143 dst_sel:WORD_1 dst_unused:UNUSED_PRESERVE src0_sel:WORD_1
v_mfma_f32_32x32x16_bf16 v[160:175], v[40:43], v[184:187], v[160:175]
ds_read_u16 v138, v138
ds_read_u16 v136, v136
ds_read_b128 v[180:183], v250 offset:50176
v_and_b32_sdwa v139, s47, v137 dst_sel:DWORD dst_unused:UNUSED_PAD src0_sel:DWORD src1_sel:WORD_1
v_and_b32_e64 v137, s47, v137
v_pk_add_f16 v141, v141, 1.0 op_sel_hi:[1,0]
v_pk_add_f16 v143, v143, 1.0 op_sel_hi:[1,0]
v_rcp_f16_sdwa v141, v141 dst_sel:WORD_0 dst_unused:UNUSED_PRESERVE src0_sel:WORD_0
v_mfma_f32_32x32x16_bf16 v[144:159], v[20:23], v[188:191], v[144:159]
ds_read_u16 v139, v139
ds_read_u16 v137, v137
v_rcp_f16_sdwa v143, v143 dst_sel:WORD_0 dst_unused:UNUSED_PRESERVE src0_sel:WORD_0
v_rcp_f16_sdwa v141, v141 dst_sel:WORD_1 dst_unused:UNUSED_PRESERVE src0_sel:WORD_1
v_rcp_f16_sdwa v143, v143 dst_sel:WORD_1 dst_unused:UNUSED_PRESERVE src0_sel:WORD_1
v_mfma_f32_32x32x16_bf16 v[160:175], v[44:47], v[188:191], v[160:175]
ds_read_b128 v[184:187], v250 offset:51200
v_pk_mul_f16 v140, v140, v141
v_pk_mul_f16 v142, v142, v143
v_fma_mix_f32 v230, v140, v140, v230 op_sel_hi:[1,1,0]
s_nop 1
v_cvt_pkrtz_f16_f32 v144, v144, v145
v_fma_mix_f32 v230, v142, v142, v230 op_sel_hi:[1,1,0]
s_waitcnt lgkmcnt(7)
v_mfma_f32_32x32x16_bf16 v[96:111], v[0:3], v[176:179], 0
v_fma_mix_f32 v230, v140, v140, v230 op_sel:[1,1,0] op_sel_hi:[1,1,0]
v_cvt_pkrtz_f16_f32 v145, v146, v147
v_fma_mix_f32 v230, v142, v142, v230 op_sel:[1,1,0] op_sel_hi:[1,1,0]
v_lshrrev_b64 v[144:145], 2, v[144:145]
v_fma_mix_f32 v230, v128, v128, v230 op_sel_hi:[1,1,0]
v_and_b32_sdwa v146, s47, v144 dst_sel:DWORD dst_unused:UNUSED_PAD src0_sel:DWORD src1_sel:WORD_1
v_fma_mix_f32 v230, v129, v129, v230 op_sel_hi:[1,1,0]
v_and_b32_e64 v144, s47, v144
v_fma_mix_f32 v230, v130, v130, v230 op_sel_hi:[1,1,0]
v_cvt_pk_f16_f32 v156, v156, v157
v_fma_mix_f32 v230, v131, v131, v230 op_sel_hi:[1,1,0]
v_cvt_pk_f16_f32 v158, v158, v159
v_pk_fma_f16 v157, v156, v156, s48
v_mfma_f32_32x32x16_bf16 v[112:127], v[24:27], v[176:179], 0
ds_read_u16 v146, v146
ds_read_u16 v144, v144
v_fma_mix_f32 v230, v132, v132, v230 op_sel_hi:[1,1,0]
v_and_b32_sdwa v147, s47, v145 dst_sel:DWORD dst_unused:UNUSED_PAD src0_sel:DWORD src1_sel:WORD_1
s_waitcnt lgkmcnt(5)
v_fma_mix_f32 v230, v133, v133, v230 op_sel_hi:[1,1,0]
v_and_b32 v145, s47, v145
v_pk_fma_f16 v159, v158, v158, s48
v_pk_mul_f16 v157, v156, v157
v_pk_mul_f16 v159, v158, v159
v_fma_mix_f32 v230, v134, v134, v230 op_sel_hi:[1,1,0]
v_cvt_pkrtz_f16_f32 v148, v148, v149
v_fma_mix_f32 v230, v135, v135, v230 op_sel_hi:[1,1,0]
ds_read_u16 v147, v147
ds_read_u16 v145, v145
ds_read_b128 v[188:191], v250 offset:52224
v_cvt_pkrtz_f16_f32 v149, v150, v151
v_lshrrev_b64 v[148:149], 2, v[148:149]
v_and_b32_sdwa v150, s47, v148 dst_sel:DWORD dst_unused:UNUSED_PAD src0_sel:DWORD src1_sel:WORD_1
v_and_b32_e64 v148, s47, v148
v_exp_f16_sdwa v157, v157 dst_sel:WORD_0 dst_unused:UNUSED_PRESERVE src0_sel:WORD_0
v_mfma_f32_32x32x16_bf16 v[96:111], v[4:7], v[180:183], v[96:111]
ds_read_u16 v150, v150
ds_read_u16 v148, v148
v_fma_mix_f32 v230, v136, v136, v230 op_sel_hi:[1,1,0]
v_exp_f16_sdwa v159, v159 dst_sel:WORD_0 dst_unused:UNUSED_PRESERVE src0_sel:WORD_0
s_waitcnt lgkmcnt(7)
v_fma_mix_f32 v230, v137, v137, v230 op_sel_hi:[1,1,0]
v_and_b32_sdwa v151, s47, v149 dst_sel:DWORD dst_unused:UNUSED_PAD src0_sel:DWORD src1_sel:WORD_1
v_and_b32 v149, s47, v149
v_exp_f16_sdwa v157, v157 dst_sel:WORD_1 dst_unused:UNUSED_PRESERVE src0_sel:WORD_1
v_fma_mix_f32 v230, v138, v138, v230 op_sel_hi:[1,1,0]
v_cvt_pkrtz_f16_f32 v152, v152, v153
v_fma_mix_f32 v230, v139, v139, v230 op_sel_hi:[1,1,0]
v_cvt_pkrtz_f16_f32 v153, v154, v155
v_lshrrev_b64 v[152:153], 2, v[152:153]
ds_read_u16 v151, v151
ds_read_u16 v149, v149
v_and_b32_sdwa v154, s47, v152 dst_sel:DWORD dst_unused:UNUSED_PAD src0_sel:DWORD src1_sel:WORD_1
v_and_b32_e64 v152, s47, v152
v_exp_f16_sdwa v159, v159 dst_sel:WORD_1 dst_unused:UNUSED_PRESERVE src0_sel:WORD_1
v_mfma_f32_32x32x16_bf16 v[112:127], v[28:31], v[180:183], v[112:127]
ds_read_u16 v154, v154
ds_read_u16 v152, v152
ds_read_b128 v[176:179], v250 offset:53248
v_and_b32_sdwa v155, s47, v153 dst_sel:DWORD dst_unused:UNUSED_PAD src0_sel:DWORD src1_sel:WORD_1
v_and_b32_e64 v153, s47, v153
v_pk_add_f16 v157, v157, 1.0 op_sel_hi:[1,0]
v_pk_add_f16 v159, v159, 1.0 op_sel_hi:[1,0]
v_rcp_f16_sdwa v157, v157 dst_sel:WORD_0 dst_unused:UNUSED_PRESERVE src0_sel:WORD_0
v_mfma_f32_32x32x16_bf16 v[96:111], v[8:11], v[184:187], v[96:111]
ds_read_u16 v155, v155
ds_read_u16 v153, v153
v_rcp_f16_sdwa v159, v159 dst_sel:WORD_0 dst_unused:UNUSED_PRESERVE src0_sel:WORD_0
v_rcp_f16_sdwa v157, v157 dst_sel:WORD_1 dst_unused:UNUSED_PRESERVE src0_sel:WORD_1
v_rcp_f16_sdwa v159, v159 dst_sel:WORD_1 dst_unused:UNUSED_PRESERVE src0_sel:WORD_1
v_mfma_f32_32x32x16_bf16 v[112:127], v[32:35], v[184:187], v[112:127]
ds_read_b128 v[180:183], v250 offset:54272
v_pk_mul_f16 v156, v156, v157
v_pk_mul_f16 v158, v158, v159
v_fma_mix_f32 v231, v156, v156, v231 op_sel_hi:[1,1,0]
v_cvt_pkrtz_f16_f32 v160, v160, v161
v_fma_mix_f32 v231, v158, v158, v231 op_sel_hi:[1,1,0]
s_waitcnt lgkmcnt(7)
v_mfma_f32_32x32x16_bf16 v[96:111], v[12:15], v[188:191], v[96:111]
v_fma_mix_f32 v231, v156, v156, v231 op_sel:[1,1,0] op_sel_hi:[1,1,0]
v_cvt_pkrtz_f16_f32 v161, v162, v163
v_fma_mix_f32 v231, v158, v158, v231 op_sel:[1,1,0] op_sel_hi:[1,1,0]
v_lshrrev_b64 v[160:161], 2, v[160:161]
v_fma_mix_f32 v231, v144, v144, v231 op_sel_hi:[1,1,0]
v_and_b32_sdwa v162, s47, v160 dst_sel:DWORD dst_unused:UNUSED_PAD src0_sel:DWORD src1_sel:WORD_1
v_fma_mix_f32 v231, v145, v145, v231 op_sel_hi:[1,1,0]
v_and_b32 v160, s47, v160
v_fma_mix_f32 v231, v146, v146, v231 op_sel_hi:[1,1,0]
v_cvt_pk_f16_f32 v172, v172, v173
v_fma_mix_f32 v231, v147, v147, v231 op_sel_hi:[1,1,0]
v_cvt_pk_f16_f32 v174, v174, v175
v_pk_fma_f16 v173, v172, v172, s48
v_mfma_f32_32x32x16_bf16 v[112:127], v[36:39], v[188:191], v[112:127]
ds_read_u16 v162, v162
ds_read_u16 v160, v160
v_fma_mix_f32 v231, v148, v148, v231 op_sel_hi:[1,1,0]
v_and_b32_sdwa v163, s47, v161 dst_sel:DWORD dst_unused:UNUSED_PAD src0_sel:DWORD src1_sel:WORD_1
s_waitcnt lgkmcnt(5)
v_fma_mix_f32 v231, v149, v149, v231 op_sel_hi:[1,1,0]
v_and_b32 v161, s47, v161
v_pk_fma_f16 v175, v174, v174, s48
v_pk_mul_f16 v173, v172, v173
v_pk_mul_f16 v175, v174, v175
v_fma_mix_f32 v231, v150, v150, v231 op_sel_hi:[1,1,0]
v_cvt_pkrtz_f16_f32 v164, v164, v165
v_fma_mix_f32 v231, v151, v151, v231 op_sel_hi:[1,1,0]
ds_read_u16 v163, v163
ds_read_u16 v161, v161
ds_read_b128 v[184:187], v250 offset:55296
v_cvt_pkrtz_f16_f32 v165, v166, v167
v_lshrrev_b64 v[164:165], 2, v[164:165]
v_and_b32_sdwa v166, s47, v164 dst_sel:DWORD dst_unused:UNUSED_PAD src0_sel:DWORD src1_sel:WORD_1
v_and_b32_e64 v164, s47, v164
v_exp_f16_sdwa v173, v173 dst_sel:WORD_0 dst_unused:UNUSED_PRESERVE src0_sel:WORD_0
v_mfma_f32_32x32x16_bf16 v[96:111], v[16:19], v[176:179], v[96:111]
ds_read_u16 v166, v166
ds_read_u16 v164, v164
v_fma_mix_f32 v231, v152, v152, v231 op_sel_hi:[1,1,0]
v_exp_f16_sdwa v175, v175 dst_sel:WORD_0 dst_unused:UNUSED_PRESERVE src0_sel:WORD_0
s_waitcnt lgkmcnt(7)
v_fma_mix_f32 v231, v153, v153, v231 op_sel_hi:[1,1,0]
v_and_b32_sdwa v167, s47, v165 dst_sel:DWORD dst_unused:UNUSED_PAD src0_sel:DWORD src1_sel:WORD_1
v_and_b32 v165, s47, v165
v_exp_f16_sdwa v173, v173 dst_sel:WORD_1 dst_unused:UNUSED_PRESERVE src0_sel:WORD_1
v_fma_mix_f32 v231, v154, v154, v231 op_sel_hi:[1,1,0]
v_cvt_pkrtz_f16_f32 v168, v168, v169
v_fma_mix_f32 v231, v155, v155, v231 op_sel_hi:[1,1,0]
v_cvt_pkrtz_f16_f32 v169, v170, v171
v_lshrrev_b64 v[168:169], 2, v[168:169]
ds_read_u16 v167, v167
ds_read_u16 v165, v165
v_and_b32_sdwa v170, s47, v168 dst_sel:DWORD dst_unused:UNUSED_PAD src0_sel:DWORD src1_sel:WORD_1
v_and_b32_e64 v168, s47, v168
v_exp_f16_sdwa v175, v175 dst_sel:WORD_1 dst_unused:UNUSED_PRESERVE src0_sel:WORD_1
v_mfma_f32_32x32x16_bf16 v[112:127], v[40:43], v[176:179], v[112:127]
ds_read_u16 v170, v170
ds_read_u16 v168, v168
ds_read_b128 v[188:191], v250 offset:56320
v_and_b32_sdwa v171, s47, v169 dst_sel:DWORD dst_unused:UNUSED_PAD src0_sel:DWORD src1_sel:WORD_1
v_and_b32_e64 v169, s47, v169
v_pk_add_f16 v173, v173, 1.0 op_sel_hi:[1,0]
v_pk_add_f16 v175, v175, 1.0 op_sel_hi:[1,0]
v_rcp_f16_sdwa v173, v173 dst_sel:WORD_0 dst_unused:UNUSED_PRESERVE src0_sel:WORD_0
v_mfma_f32_32x32x16_bf16 v[96:111], v[20:23], v[180:183], v[96:111]
ds_read_u16 v171, v171
ds_read_u16 v169, v169
v_rcp_f16_sdwa v175, v175 dst_sel:WORD_0 dst_unused:UNUSED_PRESERVE src0_sel:WORD_0
v_rcp_f16_sdwa v173, v173 dst_sel:WORD_1 dst_unused:UNUSED_PRESERVE src0_sel:WORD_1
v_rcp_f16_sdwa v175, v175 dst_sel:WORD_1 dst_unused:UNUSED_PRESERVE src0_sel:WORD_1
v_mfma_f32_32x32x16_bf16 v[112:127], v[44:47], v[180:183], v[112:127]
ds_read_b128 v[176:179], v250 offset:57344
v_pk_mul_f16 v172, v172, v173
v_pk_mul_f16 v174, v174, v175
v_fma_mix_f32 v231, v172, v172, v231 op_sel_hi:[1,1,0]
s_nop 1
v_cvt_pkrtz_f16_f32 v96, v96, v97
v_fma_mix_f32 v231, v174, v174, v231 op_sel_hi:[1,1,0]
s_waitcnt lgkmcnt(7)
v_mfma_f32_32x32x16_bf16 v[128:143], v[0:3], v[184:187], 0
v_fma_mix_f32 v231, v172, v172, v231 op_sel:[1,1,0] op_sel_hi:[1,1,0]
v_cvt_pkrtz_f16_f32 v97, v98, v99
v_fma_mix_f32 v231, v174, v174, v231 op_sel:[1,1,0] op_sel_hi:[1,1,0]
v_lshrrev_b64 v[96:97], 2, v[96:97]
v_fma_mix_f32 v231, v160, v160, v231 op_sel_hi:[1,1,0]
v_and_b32_sdwa v98, s47, v96 dst_sel:DWORD dst_unused:UNUSED_PAD src0_sel:DWORD src1_sel:WORD_1
v_fma_mix_f32 v231, v161, v161, v231 op_sel_hi:[1,1,0]
v_and_b32_e64 v96, s47, v96
v_fma_mix_f32 v231, v162, v162, v231 op_sel_hi:[1,1,0]
v_cvt_pk_f16_f32 v108, v108, v109
v_fma_mix_f32 v231, v163, v163, v231 op_sel_hi:[1,1,0]
v_cvt_pk_f16_f32 v110, v110, v111
v_pk_fma_f16 v109, v108, v108, s48
v_mfma_f32_32x32x16_bf16 v[144:159], v[24:27], v[184:187], 0
ds_read_u16 v98, v98
ds_read_u16 v96, v96
v_fma_mix_f32 v231, v164, v164, v231 op_sel_hi:[1,1,0]
v_and_b32_sdwa v99, s47, v97 dst_sel:DWORD dst_unused:UNUSED_PAD src0_sel:DWORD src1_sel:WORD_1
s_waitcnt lgkmcnt(5)
v_fma_mix_f32 v231, v165, v165, v231 op_sel_hi:[1,1,0]
v_and_b32 v97, s47, v97
v_pk_fma_f16 v111, v110, v110, s48
v_pk_mul_f16 v109, v108, v109
v_pk_mul_f16 v111, v110, v111
v_fma_mix_f32 v231, v166, v166, v231 op_sel_hi:[1,1,0]
v_cvt_pkrtz_f16_f32 v100, v100, v101
v_fma_mix_f32 v231, v167, v167, v231 op_sel_hi:[1,1,0]
ds_read_u16 v99, v99
ds_read_u16 v97, v97
ds_read_b128 v[180:183], v250 offset:58368
v_cvt_pkrtz_f16_f32 v101, v102, v103
v_lshrrev_b64 v[100:101], 2, v[100:101]
v_and_b32_sdwa v102, s47, v100 dst_sel:DWORD dst_unused:UNUSED_PAD src0_sel:DWORD src1_sel:WORD_1
v_and_b32_e64 v100, s47, v100
v_exp_f16_sdwa v109, v109 dst_sel:WORD_0 dst_unused:UNUSED_PRESERVE src0_sel:WORD_0
v_mfma_f32_32x32x16_bf16 v[128:143], v[4:7], v[188:191], v[128:143]
ds_read_u16 v102, v102
ds_read_u16 v100, v100
v_fma_mix_f32 v231, v168, v168, v231 op_sel_hi:[1,1,0]
v_exp_f16_sdwa v111, v111 dst_sel:WORD_0 dst_unused:UNUSED_PRESERVE src0_sel:WORD_0
s_waitcnt lgkmcnt(7)
v_fma_mix_f32 v231, v169, v169, v231 op_sel_hi:[1,1,0]
v_and_b32_sdwa v103, s47, v101 dst_sel:DWORD dst_unused:UNUSED_PAD src0_sel:DWORD src1_sel:WORD_1
v_and_b32 v101, s47, v101
v_exp_f16_sdwa v109, v109 dst_sel:WORD_1 dst_unused:UNUSED_PRESERVE src0_sel:WORD_1
v_fma_mix_f32 v231, v170, v170, v231 op_sel_hi:[1,1,0]
v_cvt_pkrtz_f16_f32 v104, v104, v105
v_fma_mix_f32 v231, v171, v171, v231 op_sel_hi:[1,1,0]
v_cvt_pkrtz_f16_f32 v105, v106, v107
v_lshrrev_b64 v[104:105], 2, v[104:105]
ds_read_u16 v103, v103
ds_read_u16 v101, v101
v_and_b32_sdwa v106, s47, v104 dst_sel:DWORD dst_unused:UNUSED_PAD src0_sel:DWORD src1_sel:WORD_1
v_and_b32_e64 v104, s47, v104
v_exp_f16_sdwa v111, v111 dst_sel:WORD_1 dst_unused:UNUSED_PRESERVE src0_sel:WORD_1
v_mfma_f32_32x32x16_bf16 v[144:159], v[28:31], v[188:191], v[144:159]
ds_read_u16 v106, v106
ds_read_u16 v104, v104
ds_read_b128 v[184:187], v250 offset:59392
v_and_b32_sdwa v107, s47, v105 dst_sel:DWORD dst_unused:UNUSED_PAD src0_sel:DWORD src1_sel:WORD_1
v_and_b32_e64 v105, s47, v105
v_pk_add_f16 v109, v109, 1.0 op_sel_hi:[1,0]
v_pk_add_f16 v111, v111, 1.0 op_sel_hi:[1,0]
v_rcp_f16_sdwa v109, v109 dst_sel:WORD_0 dst_unused:UNUSED_PRESERVE src0_sel:WORD_0
v_mfma_f32_32x32x16_bf16 v[128:143], v[8:11], v[176:179], v[128:143]
ds_read_u16 v107, v107
ds_read_u16 v105, v105
v_rcp_f16_sdwa v111, v111 dst_sel:WORD_0 dst_unused:UNUSED_PRESERVE src0_sel:WORD_0
v_rcp_f16_sdwa v109, v109 dst_sel:WORD_1 dst_unused:UNUSED_PRESERVE src0_sel:WORD_1
v_rcp_f16_sdwa v111, v111 dst_sel:WORD_1 dst_unused:UNUSED_PRESERVE src0_sel:WORD_1
v_mfma_f32_32x32x16_bf16 v[144:159], v[32:35], v[176:179], v[144:159]
ds_read_b128 v[188:191], v250 offset:60416
v_pk_mul_f16 v108, v108, v109
v_pk_mul_f16 v110, v110, v111
v_fma_mix_f32 v232, v108, v108, v232 op_sel_hi:[1,1,0]
v_add_u32_e64 v222, s83, v247
v_mov_b32 v223, 0
s_branch Law4
Lax4:
s_sleep 2
Law4:
ds_read_b32 v223, v222 offset:20
s_sub_u32 s76, s76, 1
s_cselect_b32 s44, 4, 0
s_cselect_b32 s76, 0, s76
s_waitcnt lgkmcnt(0)
v_readfirstlane_b32 s43, v223
s_nop 1
s_max_u32 s43, s43, s44
s_cmp_lt_u32 s43, 4
s_cbranch_scc1 Lax4
v_mfma_f32_32x32x16_bf16 v[128:143], v[12:15], v[180:183], v[128:143]
s_add_u32 s81, s81, 6592
s_cmp_eq_u32 s81, 65920
s_cselect_b32 s81, 0, s81
s_add_u32 s43, s81, s67
s_add_u32 m0, s43, 16
s_add_u32 s66, s66, 98304
buffer_load_dwordx4 v236, s[4:7], s66 offen lds
s_add_u32 m0, s43, 912
s_nop 0
buffer_load_dwordx4 v237, s[4:7], s66 offen lds
v_fma_mix_f32 v232, v110, v110, v232 op_sel_hi:[1,1,0]
v_cvt_pkrtz_f16_f32 v112, v112, v113
v_fma_mix_f32 v232, v108, v108, v232 op_sel:[1,1,0] op_sel_hi:[1,1,0]
v_cvt_pkrtz_f16_f32 v113, v114, v115
v_fma_mix_f32 v232, v110, v110, v232 op_sel:[1,1,0] op_sel_hi:[1,1,0]
v_lshrrev_b64 v[112:113], 2, v[112:113]
v_fma_mix_f32 v232, v96, v96, v232 op_sel_hi:[1,1,0]
v_and_b32_sdwa v114, s47, v112 dst_sel:DWORD dst_unused:UNUSED_PAD src0_sel:DWORD src1_sel:WORD_1
v_fma_mix_f32 v232, v97, v97, v232 op_sel_hi:[1,1,0]
v_and_b32_e64 v112, s47, v112
v_fma_mix_f32 v232, v98, v98, v232 op_sel_hi:[1,1,0]
v_cvt_pk_f16_f32 v124, v124, v125
v_fma_mix_f32 v232, v99, v99, v232 op_sel_hi:[1,1,0]
v_cvt_pk_f16_f32 v126, v126, v127
v_pk_fma_f16 v125, v124, v124, s48
v_mfma_f32_32x32x16_bf16 v[144:159], v[36:39], v[180:183], v[144:159]
ds_read_u16 v114, v114
ds_read_u16 v112, v112
v_fma_mix_f32 v232, v100, v100, v232 op_sel_hi:[1,1,0]
v_and_b32_sdwa v115, s47, v113 dst_sel:DWORD dst_unused:UNUSED_PAD src0_sel:DWORD src1_sel:WORD_1
v_fma_mix_f32 v232, v101, v101, v232 op_sel_hi:[1,1,0]
v_and_b32_e64 v113, s47, v113
v_pk_fma_f16 v127, v126, v126, s48
v_pk_mul_f16 v125, v124, v125
v_pk_mul_f16 v127, v126, v127
v_fma_mix_f32 v232, v102, v102, v232 op_sel_hi:[1,1,0]
v_cvt_pkrtz_f16_f32 v116, v116, v117
v_fma_mix_f32 v232, v103, v103, v232 op_sel_hi:[1,1,0]
ds_read_u16 v115, v115
ds_read_u16 v113, v113
ds_read_b128 v[176:179], v250 offset:61440
v_cvt_pkrtz_f16_f32 v117, v118, v119
v_lshrrev_b64 v[116:117], 2, v[116:117]
v_and_b32_sdwa v118, s47, v116 dst_sel:DWORD dst_unused:UNUSED_PAD src0_sel:DWORD src1_sel:WORD_1
v_and_b32_e64 v116, s47, v116
v_exp_f16_sdwa v125, v125 dst_sel:WORD_0 dst_unused:UNUSED_PRESERVE src0_sel:WORD_0
v_mfma_f32_32x32x16_bf16 v[128:143], v[16:19], v[184:187], v[128:143]
ds_read_u16 v118, v118
ds_read_u16 v116, v116
s_add_u32 s81, s81, 6592
s_cmp_eq_u32 s81, 65920
s_cselect_b32 s81, 0, s81
s_add_u32 s43, s81, s67
s_add_u32 m0, s43, 16
s_add_u32 s66, s66, 98304
buffer_load_dwordx4 v236, s[4:7], s66 offen lds
s_add_u32 m0, s43, 912
s_nop 0
buffer_load_dwordx4 v237, s[4:7], s66 offen lds
v_fma_mix_f32 v232, v104, v104, v232 op_sel_hi:[1,1,0]
v_exp_f16_sdwa v127, v127 dst_sel:WORD_0 dst_unused:UNUSED_PRESERVE src0_sel:WORD_0
v_fma_mix_f32 v232, v105, v105, v232 op_sel_hi:[1,1,0]
v_and_b32_sdwa v119, s47, v117 dst_sel:DWORD dst_unused:UNUSED_PAD src0_sel:DWORD src1_sel:WORD_1
v_and_b32_e64 v117, s47, v117
v_exp_f16_sdwa v125, v125 dst_sel:WORD_1 dst_unused:UNUSED_PRESERVE src0_sel:WORD_1
v_fma_mix_f32 v232, v106, v106, v232 op_sel_hi:[1,1,0]
v_cvt_pkrtz_f16_f32 v120, v120, v121
v_fma_mix_f32 v232, v107, v107, v232 op_sel_hi:[1,1,0]
v_cvt_pkrtz_f16_f32 v121, v122, v123
v_lshrrev_b64 v[120:121], 2, v[120:121]
ds_read_u16 v119, v119
ds_read_u16 v117, v117
v_and_b32_sdwa v122, s47, v120 dst_sel:DWORD dst_unused:UNUSED_PAD src0_sel:DWORD src1_sel:WORD_1
v_and_b32_e64 v120, s47, v120
v_exp_f16_sdwa v127, v127 dst_sel:WORD_1 dst_unused:UNUSED_PRESERVE src0_sel:WORD_1
v_mfma_f32_32x32x16_bf16 v[144:159], v[40:43], v[184:187], v[144:159]
ds_read_u16 v122, v122
ds_read_u16 v120, v120
ds_read_b128 v[180:183], v250 offset:62464
v_and_b32_sdwa v123, s47, v121 dst_sel:DWORD dst_unused:UNUSED_PAD src0_sel:DWORD src1_sel:WORD_1
v_and_b32_e64 v121, s47, v121
v_pk_add_f16 v125, v125, 1.0 op_sel_hi:[1,0]
v_pk_add_f16 v127, v127, 1.0 op_sel_hi:[1,0]
v_rcp_f16_sdwa v125, v125 dst_sel:WORD_0 dst_unused:UNUSED_PRESERVE src0_sel:WORD_0
v_mfma_f32_32x32x16_bf16 v[128:143], v[20:23], v[188:191], v[128:143]
ds_read_u16 v123, v123
ds_read_u16 v121, v121
s_add_u32 s81, s81, 6592
s_cmp_eq_u32 s81, 65920
s_cselect_b32 s81, 0, s81
s_add_u32 s43, s81, s67
s_add_u32 m0, s43, 32
s_add_u32 s66, s66, 98304
buffer_load_dwordx4 v236, s[4:7], s66 offen lds
s_add_u32 m0, s43, 928
s_nop 0
buffer_load_dwordx4 v237, s[4:7], s66 offen lds
v_rcp_f16_sdwa v127, v127 dst_sel:WORD_0 dst_unused:UNUSED_PRESERVE src0_sel:WORD_0
v_rcp_f16_sdwa v125, v125 dst_sel:WORD_1 dst_unused:UNUSED_PRESERVE src0_sel:WORD_1
v_rcp_f16_sdwa v127, v127 dst_sel:WORD_1 dst_unused:UNUSED_PRESERVE src0_sel:WORD_1
v_mfma_f32_32x32x16_bf16 v[144:159], v[44:47], v[188:191], v[144:159]
ds_read_b128 v[184:187], v250 offset:63488
v_pk_mul_f16 v124, v124, v125
v_pk_mul_f16 v126, v126, v127
s_add_u32 s81, s81, 6592
s_cmp_eq_u32 s81, 65920
s_cselect_b32 s81, 0, s81
s_add_u32 s43, s81, s67
s_add_u32 m0, s43, 32
s_add_u32 s66, s66, 98304
buffer_load_dwordx4 v236, s[4:7], s66 offen lds
s_add_u32 m0, s43, 928
s_nop 0
buffer_load_dwordx4 v237, s[4:7], s66 offen lds
v_fma_mix_f32 v232, v124, v124, v232 op_sel_hi:[1,1,0]
v_cvt_pkrtz_f16_f32 v128, v128, v129
s_waitcnt lgkmcnt(7)
v_mfma_f32_32x32x16_bf16 v[160:175], v[0:3], v[176:179], 0
v_fma_mix_f32 v232, v126, v126, v232 op_sel_hi:[1,1,0]
v_cvt_pkrtz_f16_f32 v129, v130, v131
v_fma_mix_f32 v232, v124, v124, v232 op_sel:[1,1,0] op_sel_hi:[1,1,0]
v_lshrrev_b64 v[128:129], 2, v[128:129]
v_fma_mix_f32 v232, v126, v126, v232 op_sel:[1,1,0] op_sel_hi:[1,1,0]
v_and_b32_sdwa v130, s47, v128 dst_sel:DWORD dst_unused:UNUSED_PAD src0_sel:DWORD src1_sel:WORD_1
v_fma_mix_f32 v232, v112, v112, v232 op_sel_hi:[1,1,0]
v_and_b32 v128, s47, v128
v_fma_mix_f32 v232, v113, v113, v232 op_sel_hi:[1,1,0]
v_cvt_pk_f16_f32 v140, v140, v141
v_fma_mix_f32 v232, v114, v114, v232 op_sel_hi:[1,1,0]
v_cvt_pk_f16_f32 v142, v142, v143
v_fma_mix_f32 v232, v115, v115, v232 op_sel_hi:[1,1,0]
v_pk_fma_f16 v141, v140, v140, s48
v_mfma_f32_32x32x16_bf16 v[96:111], v[24:27], v[176:179], 0
ds_read_u16 v130, v130
ds_read_u16 v128, v128
v_fma_mix_f32 v232, v116, v116, v232 op_sel_hi:[1,1,0]
v_and_b32_sdwa v131, s47, v129 dst_sel:DWORD dst_unused:UNUSED_PAD src0_sel:DWORD src1_sel:WORD_1
s_waitcnt lgkmcnt(5)
v_fma_mix_f32 v232, v117, v117, v232 op_sel_hi:[1,1,0]
v_and_b32 v129, s47, v129
v_pk_fma_f16 v143, v142, v142, s48
v_pk_mul_f16 v141, v140, v141
v_pk_mul_f16 v143, v142, v143
v_fma_mix_f32 v232, v118, v118, v232 op_sel_hi:[1,1,0]
v_cvt_pkrtz_f16_f32 v132, v132, v133
v_fma_mix_f32 v232, v119, v119, v232 op_sel_hi:[1,1,0]
ds_read_u16 v131, v131
ds_read_u16 v129, v129
ds_read_b128 v[188:191], v250 offset:64512
s_add_u32 s81, s81, 6592
s_cmp_eq_u32 s81, 65920
s_cselect_b32 s81, 0, s81
s_add_u32 s43, s81, s67
s_add_u32 m0, s43, 48
s_add_u32 s66, s66, 98304
buffer_load_dwordx4 v236, s[4:7], s66 offen lds
s_add_u32 m0, s43, 944
s_nop 0
buffer_load_dwordx4 v237, s[4:7], s66 offen lds
v_cvt_pkrtz_f16_f32 v133, v134, v135
v_lshrrev_b64 v[132:133], 2, v[132:133]
v_and_b32_sdwa v134, s47, v132 dst_sel:DWORD dst_unused:UNUSED_PAD src0_sel:DWORD src1_sel:WORD_1
v_and_b32_e64 v132, s47, v132
v_exp_f16_sdwa v141, v141 dst_sel:WORD_0 dst_unused:UNUSED_PRESERVE src0_sel:WORD_0
v_mfma_f32_32x32x16_bf16 v[160:175], v[4:7], v[180:183], v[160:175]
ds_read_u16 v134, v134
ds_read_u16 v132, v132
v_fma_mix_f32 v232, v120, v120, v232 op_sel_hi:[1,1,0]
v_exp_f16_sdwa v143, v143 dst_sel:WORD_0 dst_unused:UNUSED_PRESERVE src0_sel:WORD_0
s_waitcnt lgkmcnt(7)
v_fma_mix_f32 v232, v121, v121, v232 op_sel_hi:[1,1,0]
v_and_b32_sdwa v135, s47, v133 dst_sel:DWORD dst_unused:UNUSED_PAD src0_sel:DWORD src1_sel:WORD_1
v_and_b32 v133, s47, v133
v_exp_f16_sdwa v141, v141 dst_sel:WORD_1 dst_unused:UNUSED_PRESERVE src0_sel:WORD_1
v_fma_mix_f32 v232, v122, v122, v232 op_sel_hi:[1,1,0]
v_cvt_pkrtz_f16_f32 v136, v136, v137
v_fma_mix_f32 v232, v123, v123, v232 op_sel_hi:[1,1,0]
v_cvt_pkrtz_f16_f32 v137, v138, v139
v_lshrrev_b64 v[136:137], 2, v[136:137]
ds_read_u16 v135, v135
ds_read_u16 v133, v133
v_and_b32_sdwa v138, s47, v136 dst_sel:DWORD dst_unused:UNUSED_PAD src0_sel:DWORD src1_sel:WORD_1
v_and_b32_e64 v136, s47, v136
v_exp_f16_sdwa v143, v143 dst_sel:WORD_1 dst_unused:UNUSED_PRESERVE src0_sel:WORD_1
v_mfma_f32_32x32x16_bf16 v[96:111], v[28:31], v[180:183], v[96:111]
ds_read_u16 v138, v138
ds_read_u16 v136, v136
ds_read_b128 v[176:179], v251
v_and_b32_sdwa v139, s47, v137 dst_sel:DWORD dst_unused:UNUSED_PAD src0_sel:DWORD src1_sel:WORD_1
v_and_b32_e64 v137, s47, v137
v_pk_add_f16 v141, v141, 1.0 op_sel_hi:[1,0]
v_pk_add_f16 v143, v143, 1.0 op_sel_hi:[1,0]
v_rcp_f16_sdwa v141, v141 dst_sel:WORD_0 dst_unused:UNUSED_PRESERVE src0_sel:WORD_0
v_mfma_f32_32x32x16_bf16 v[160:175], v[8:11], v[184:187], v[160:175]
ds_read_u16 v139, v139
ds_read_u16 v137, v137
s_add_u32 s81, s81, 6592
s_cmp_eq_u32 s81, 65920
s_cselect_b32 s81, 0, s81
s_add_u32 s43, s81, s67
s_add_u32 m0, s43, 48
s_add_u32 s66, s66, 98304
buffer_load_dwordx4 v236, s[4:7], s66 offen lds
s_add_u32 m0, s43, 944
s_nop 0
buffer_load_dwordx4 v237, s[4:7], s66 offen lds
v_rcp_f16_sdwa v143, v143 dst_sel:WORD_0 dst_unused:UNUSED_PRESERVE src0_sel:WORD_0
v_rcp_f16_sdwa v141, v141 dst_sel:WORD_1 dst_unused:UNUSED_PRESERVE src0_sel:WORD_1
v_rcp_f16_sdwa v143, v143 dst_sel:WORD_1 dst_unused:UNUSED_PRESERVE src0_sel:WORD_1
v_mfma_f32_32x32x16_bf16 v[96:111], v[32:35], v[184:187], v[96:111]
ds_read_b128 v[180:183], v251 offset:1024
s_add_u32 s81, s81, 6592
s_cmp_eq_u32 s81, 65920
s_cselect_b32 s81, 0, s81
s_add_u32 s43, s81, s67
s_add_u32 m0, s43, 0
s_add_u32 s66, s66, 98304
buffer_load_dwordx4 v236, s[4:7], s66 offen lds
s_add_u32 m0, s43, 896
s_nop 0
buffer_load_dwordx4 v237, s[4:7], s66 offen lds
v_pk_mul_f16 v140, v140, v141
v_pk_mul_f16 v142, v142, v143
v_fma_mix_f32 v233, v140, v140, v233 op_sel_hi:[1,1,0]
v_cvt_pkrtz_f16_f32 v144, v144, v145
s_waitcnt lgkmcnt(7)
v_mfma_f32_32x32x16_bf16 v[160:175], v[12:15], v[188:191], v[160:175]
v_fma_mix_f32 v233, v142, v142, v233 op_sel_hi:[1,1,0]
v_cvt_pkrtz_f16_f32 v145, v146, v147
v_fma_mix_f32 v233, v140, v140, v233 op_sel:[1,1,0] op_sel_hi:[1,1,0]
v_lshrrev_b64 v[144:145], 2, v[144:145]
v_fma_mix_f32 v233, v142, v142, v233 op_sel:[1,1,0] op_sel_hi:[1,1,0]
v_and_b32_sdwa v146, s47, v144 dst_sel:DWORD dst_unused:UNUSED_PAD src0_sel:DWORD src1_sel:WORD_1
v_fma_mix_f32 v233, v128, v128, v233 op_sel_hi:[1,1,0]
v_and_b32 v144, s47, v144
v_fma_mix_f32 v233, v129, v129, v233 op_sel_hi:[1,1,0]
v_cvt_pk_f16_f32 v156, v156, v157
v_fma_mix_f32 v233, v130, v130, v233 op_sel_hi:[1,1,0]
v_cvt_pk_f16_f32 v158, v158, v159
v_fma_mix_f32 v233, v131, v131, v233 op_sel_hi:[1,1,0]
v_pk_fma_f16 v157, v156, v156, s48
v_mfma_f32_32x32x16_bf16 v[96:111], v[36:39], v[188:191], v[96:111]
ds_read_u16 v146, v146
ds_read_u16 v144, v144
v_fma_mix_f32 v233, v132, v132, v233 op_sel_hi:[1,1,0]
v_and_b32_sdwa v147, s47, v145 dst_sel:DWORD dst_unused:UNUSED_PAD src0_sel:DWORD src1_sel:WORD_1
s_waitcnt lgkmcnt(5)
v_fma_mix_f32 v233, v133, v133, v233 op_sel_hi:[1,1,0]
s_add_u32 s81, s81, 6592
s_cmp_eq_u32 s81, 65920
s_cselect_b32 s81, 0, s81
s_add_u32 s43, s81, s67
s_add_u32 m0, s43, 0
s_add_u32 s66, s66, 98304
buffer_load_dwordx4 v236, s[4:7], s66 offen lds
s_add_u32 m0, s43, 896
s_nop 0
buffer_load_dwordx4 v237, s[4:7], s66 offen lds
v_and_b32 v145, s47, v145
v_pk_fma_f16 v159, v158, v158, s48
v_pk_mul_f16 v157, v156, v157
v_pk_mul_f16 v159, v158, v159
v_fma_mix_f32 v233, v134, v134, v233 op_sel_hi:[1,1,0]
v_cvt_pkrtz_f16_f32 v148, v148, v149
v_fma_mix_f32 v233, v135, v135, v233 op_sel_hi:[1,1,0]
ds_read_u16 v147, v147
ds_read_u16 v145, v145
ds_read_b128 v[184:187], v251 offset:2048
v_cvt_pkrtz_f16_f32 v149, v150, v151
v_lshrrev_b64 v[148:149], 2, v[148:149]
v_and_b32_sdwa v150, s47, v148 dst_sel:DWORD dst_unused:UNUSED_PAD src0_sel:DWORD src1_sel:WORD_1
v_and_b32_e64 v148, s47, v148
v_exp_f16_sdwa v157, v157 dst_sel:WORD_0 dst_unused:UNUSED_PRESERVE src0_sel:WORD_0
v_mfma_f32_32x32x16_bf16 v[160:175], v[16:19], v[176:179], v[160:175]
ds_read_u16 v150, v150
ds_read_u16 v148, v148
v_fma_mix_f32 v233, v136, v136, v233 op_sel_hi:[1,1,0]
v_exp_f16_sdwa v159, v159 dst_sel:WORD_0 dst_unused:UNUSED_PRESERVE src0_sel:WORD_0
s_waitcnt lgkmcnt(7)
v_fma_mix_f32 v233, v137, v137, v233 op_sel_hi:[1,1,0]
v_and_b32_sdwa v151, s47, v149 dst_sel:DWORD dst_unused:UNUSED_PAD src0_sel:DWORD src1_sel:WORD_1
v_and_b32 v149, s47, v149
v_exp_f16_sdwa v157, v157 dst_sel:WORD_1 dst_unused:UNUSED_PRESERVE src0_sel:WORD_1
v_fma_mix_f32 v233, v138, v138, v233 op_sel_hi:[1,1,0]
v_cvt_pkrtz_f16_f32 v152, v152, v153
v_fma_mix_f32 v233, v139, v139, v233 op_sel_hi:[1,1,0]
v_cvt_pkrtz_f16_f32 v153, v154, v155
v_lshrrev_b64 v[152:153], 2, v[152:153]
ds_read_u16 v151, v151
ds_read_u16 v149, v149
v_and_b32_sdwa v154, s47, v152 dst_sel:DWORD dst_unused:UNUSED_PAD src0_sel:DWORD src1_sel:WORD_1
v_and_b32_e64 v152, s47, v152
v_exp_f16_sdwa v159, v159 dst_sel:WORD_1 dst_unused:UNUSED_PRESERVE src0_sel:WORD_1
v_mfma_f32_32x32x16_bf16 v[96:111], v[40:43], v[176:179], v[96:111]
ds_read_u16 v154, v154
ds_read_u16 v152, v152
ds_read_b128 v[188:191], v251 offset:3072
v_and_b32_sdwa v155, s47, v153 dst_sel:DWORD dst_unused:UNUSED_PAD src0_sel:DWORD src1_sel:WORD_1
v_and_b32_e64 v153, s47, v153
v_pk_add_f16 v157, v157, 1.0 op_sel_hi:[1,0]
v_pk_add_f16 v159, v159, 1.0 op_sel_hi:[1,0]
v_rcp_f16_sdwa v157, v157 dst_sel:WORD_0 dst_unused:UNUSED_PRESERVE src0_sel:WORD_0
v_mfma_f32_32x32x16_bf16 v[160:175], v[20:23], v[180:183], v[160:175]
ds_read_u16 v155, v155
ds_read_u16 v153, v153
v_rcp_f16_sdwa v159, v159 dst_sel:WORD_0 dst_unused:UNUSED_PRESERVE src0_sel:WORD_0
v_rcp_f16_sdwa v157, v157 dst_sel:WORD_1 dst_unused:UNUSED_PRESERVE src0_sel:WORD_1
v_rcp_f16_sdwa v159, v159 dst_sel:WORD_1 dst_unused:UNUSED_PRESERVE src0_sel:WORD_1
v_mfma_f32_32x32x16_bf16 v[96:111], v[44:47], v[180:183], v[96:111]
ds_read_b128 v[176:179], v251 offset:4096
v_pk_mul_f16 v156, v156, v157
v_pk_mul_f16 v158, v158, v159
v_fma_mix_f32 v233, v156, v156, v233 op_sel_hi:[1,1,0]
s_nop 1
v_cvt_pkrtz_f16_f32 v160, v160, v161
v_fma_mix_f32 v233, v158, v158, v233 op_sel_hi:[1,1,0]
s_waitcnt lgkmcnt(7)
v_mfma_f32_32x32x16_bf16 v[112:127], v[0:3], v[184:187], 0
v_fma_mix_f32 v233, v156, v156, v233 op_sel:[1,1,0] op_sel_hi:[1,1,0]
v_cvt_pkrtz_f16_f32 v161, v162, v163
v_fma_mix_f32 v233, v158, v158, v233 op_sel:[1,1,0] op_sel_hi:[1,1,0]
v_lshrrev_b64 v[160:161], 2, v[160:161]
v_fma_mix_f32 v233, v144, v144, v233 op_sel_hi:[1,1,0]
v_and_b32_sdwa v162, s47, v160 dst_sel:DWORD dst_unused:UNUSED_PAD src0_sel:DWORD src1_sel:WORD_1
v_fma_mix_f32 v233, v145, v145, v233 op_sel_hi:[1,1,0]
v_and_b32_e64 v160, s47, v160
v_fma_mix_f32 v233, v146, v146, v233 op_sel_hi:[1,1,0]
v_cvt_pk_f16_f32 v172, v172, v173
v_fma_mix_f32 v233, v147, v147, v233 op_sel_hi:[1,1,0]
v_cvt_pk_f16_f32 v174, v174, v175
v_pk_fma_f16 v173, v172, v172, s48
v_mfma_f32_32x32x16_bf16 v[128:143], v[24:27], v[184:187], 0
ds_read_u16 v162, v162
ds_read_u16 v160, v160
v_fma_mix_f32 v233, v148, v148, v233 op_sel_hi:[1,1,0]
v_and_b32_sdwa v163, s47, v161 dst_sel:DWORD dst_unused:UNUSED_PAD src0_sel:DWORD src1_sel:WORD_1
s_waitcnt lgkmcnt(5)
v_fma_mix_f32 v233, v149, v149, v233 op_sel_hi:[1,1,0]
v_and_b32 v161, s47, v161
v_pk_fma_f16 v175, v174, v174, s48
v_pk_mul_f16 v173, v172, v173
v_pk_mul_f16 v175, v174, v175
v_fma_mix_f32 v233, v150, v150, v233 op_sel_hi:[1,1,0]
v_cvt_pkrtz_f16_f32 v164, v164, v165
v_fma_mix_f32 v233, v151, v151, v233 op_sel_hi:[1,1,0]
ds_read_u16 v163, v163
ds_read_u16 v161, v161
ds_read_b128 v[180:183], v251 offset:5120
v_cvt_pkrtz_f16_f32 v165, v166, v167
v_lshrrev_b64 v[164:165], 2, v[164:165]
v_and_b32_sdwa v166, s47, v164 dst_sel:DWORD dst_unused:UNUSED_PAD src0_sel:DWORD src1_sel:WORD_1
v_and_b32_e64 v164, s47, v164
v_exp_f16_sdwa v173, v173 dst_sel:WORD_0 dst_unused:UNUSED_PRESERVE src0_sel:WORD_0
v_mfma_f32_32x32x16_bf16 v[112:127], v[4:7], v[188:191], v[112:127]
ds_read_u16 v166, v166
ds_read_u16 v164, v164
v_fma_mix_f32 v233, v152, v152, v233 op_sel_hi:[1,1,0]
v_exp_f16_sdwa v175, v175 dst_sel:WORD_0 dst_unused:UNUSED_PRESERVE src0_sel:WORD_0
s_waitcnt lgkmcnt(7)
v_fma_mix_f32 v233, v153, v153, v233 op_sel_hi:[1,1,0]
v_and_b32_sdwa v167, s47, v165 dst_sel:DWORD dst_unused:UNUSED_PAD src0_sel:DWORD src1_sel:WORD_1
v_and_b32 v165, s47, v165
v_exp_f16_sdwa v173, v173 dst_sel:WORD_1 dst_unused:UNUSED_PRESERVE src0_sel:WORD_1
v_fma_mix_f32 v233, v154, v154, v233 op_sel_hi:[1,1,0]
v_cvt_pkrtz_f16_f32 v168, v168, v169
v_fma_mix_f32 v233, v155, v155, v233 op_sel_hi:[1,1,0]
v_cvt_pkrtz_f16_f32 v169, v170, v171
v_lshrrev_b64 v[168:169], 2, v[168:169]
ds_read_u16 v167, v167
ds_read_u16 v165, v165
v_and_b32_sdwa v170, s47, v168 dst_sel:DWORD dst_unused:UNUSED_PAD src0_sel:DWORD src1_sel:WORD_1
v_and_b32_e64 v168, s47, v168
v_exp_f16_sdwa v175, v175 dst_sel:WORD_1 dst_unused:UNUSED_PRESERVE src0_sel:WORD_1
v_mfma_f32_32x32x16_bf16 v[128:143], v[28:31], v[188:191], v[128:143]
ds_read_u16 v170, v170
ds_read_u16 v168, v168
ds_read_b128 v[184:187], v251 offset:6144
v_and_b32_sdwa v171, s47, v169 dst_sel:DWORD dst_unused:UNUSED_PAD src0_sel:DWORD src1_sel:WORD_1
v_and_b32_e64 v169, s47, v169
v_pk_add_f16 v173, v173, 1.0 op_sel_hi:[1,0]
v_pk_add_f16 v175, v175, 1.0 op_sel_hi:[1,0]
v_rcp_f16_sdwa v173, v173 dst_sel:WORD_0 dst_unused:UNUSED_PRESERVE src0_sel:WORD_0
v_mfma_f32_32x32x16_bf16 v[112:127], v[8:11], v[176:179], v[112:127]
ds_read_u16 v171, v171
ds_read_u16 v169, v169
v_rcp_f16_sdwa v175, v175 dst_sel:WORD_0 dst_unused:UNUSED_PRESERVE src0_sel:WORD_0
v_rcp_f16_sdwa v173, v173 dst_sel:WORD_1 dst_unused:UNUSED_PRESERVE src0_sel:WORD_1
v_rcp_f16_sdwa v175, v175 dst_sel:WORD_1 dst_unused:UNUSED_PRESERVE src0_sel:WORD_1
v_mfma_f32_32x32x16_bf16 v[128:143], v[32:35], v[176:179], v[128:143]
ds_read_b128 v[188:191], v251 offset:7168
v_pk_mul_f16 v172, v172, v173
v_pk_mul_f16 v174, v174, v175
v_fma_mix_f32 v234, v172, v172, v234 op_sel_hi:[1,1,0]
v_cvt_pkrtz_f16_f32 v96, v96, v97
v_fma_mix_f32 v234, v174, v174, v234 op_sel_hi:[1,1,0]
s_waitcnt lgkmcnt(7)
v_mfma_f32_32x32x16_bf16 v[112:127], v[12:15], v[180:183], v[112:127]
v_fma_mix_f32 v234, v172, v172, v234 op_sel:[1,1,0] op_sel_hi:[1,1,0]
v_cvt_pkrtz_f16_f32 v97, v98, v99
v_fma_mix_f32 v234, v174, v174, v234 op_sel:[1,1,0] op_sel_hi:[1,1,0]
v_lshrrev_b64 v[96:97], 2, v[96:97]
v_fma_mix_f32 v234, v160, v160, v234 op_sel_hi:[1,1,0]
v_and_b32_sdwa v98, s47, v96 dst_sel:DWORD dst_unused:UNUSED_PAD src0_sel:DWORD src1_sel:WORD_1
v_fma_mix_f32 v234, v161, v161, v234 op_sel_hi:[1,1,0]
v_and_b32 v96, s47, v96
v_fma_mix_f32 v234, v162, v162, v234 op_sel_hi:[1,1,0]
v_cvt_pk_f16_f32 v108, v108, v109
v_fma_mix_f32 v234, v163, v163, v234 op_sel_hi:[1,1,0]
v_cvt_pk_f16_f32 v110, v110, v111
v_pk_fma_f16 v109, v108, v108, s48
v_mfma_f32_32x32x16_bf16 v[128:143], v[36:39], v[180:183], v[128:143]
ds_read_u16 v98, v98
ds_read_u16 v96, v96
v_fma_mix_f32 v234, v164, v164, v234 op_sel_hi:[1,1,0]
v_and_b32_sdwa v99, s47, v97 dst_sel:DWORD dst_unused:UNUSED_PAD src0_sel:DWORD src1_sel:WORD_1
s_waitcnt lgkmcnt(5)
v_fma_mix_f32 v234, v165, v165, v234 op_sel_hi:[1,1,0]
v_and_b32 v97, s47, v97
v_pk_fma_f16 v111, v110, v110, s48
v_pk_mul_f16 v109, v108, v109
v_pk_mul_f16 v111, v110, v111
v_fma_mix_f32 v234, v166, v166, v234 op_sel_hi:[1,1,0]
v_cvt_pkrtz_f16_f32 v100, v100, v101
v_fma_mix_f32 v234, v167, v167, v234 op_sel_hi:[1,1,0]
ds_read_u16 v99, v99
ds_read_u16 v97, v97
v_cvt_pkrtz_f16_f32 v101, v102, v103
v_lshrrev_b64 v[100:101], 2, v[100:101]
v_and_b32_sdwa v102, s47, v100 dst_sel:DWORD dst_unused:UNUSED_PAD src0_sel:DWORD src1_sel:WORD_1
v_and_b32_e64 v100, s47, v100
v_exp_f16_sdwa v109, v109 dst_sel:WORD_0 dst_unused:UNUSED_PRESERVE src0_sel:WORD_0
v_mfma_f32_32x32x16_bf16 v[112:127], v[16:19], v[184:187], v[112:127]
ds_read_u16 v102, v102
ds_read_u16 v100, v100
v_fma_mix_f32 v234, v168, v168, v234 op_sel_hi:[1,1,0]
v_exp_f16_sdwa v111, v111 dst_sel:WORD_0 dst_unused:UNUSED_PRESERVE src0_sel:WORD_0
s_waitcnt lgkmcnt(6)
v_fma_mix_f32 v234, v169, v169, v234 op_sel_hi:[1,1,0]
v_and_b32_sdwa v103, s47, v101 dst_sel:DWORD dst_unused:UNUSED_PAD src0_sel:DWORD src1_sel:WORD_1
v_and_b32 v101, s47, v101
v_exp_f16_sdwa v109, v109 dst_sel:WORD_1 dst_unused:UNUSED_PRESERVE src0_sel:WORD_1
v_fma_mix_f32 v234, v170, v170, v234 op_sel_hi:[1,1,0]
v_cvt_pkrtz_f16_f32 v104, v104, v105
v_fma_mix_f32 v234, v171, v171, v234 op_sel_hi:[1,1,0]
v_cvt_pkrtz_f16_f32 v105, v106, v107
v_lshrrev_b64 v[104:105], 2, v[104:105]
ds_read_u16 v103, v103
ds_read_u16 v101, v101
v_and_b32_sdwa v106, s47, v104 dst_sel:DWORD dst_unused:UNUSED_PAD src0_sel:DWORD src1_sel:WORD_1
v_and_b32_e64 v104, s47, v104
v_exp_f16_sdwa v111, v111 dst_sel:WORD_1 dst_unused:UNUSED_PRESERVE src0_sel:WORD_1
v_mfma_f32_32x32x16_bf16 v[128:143], v[40:43], v[184:187], v[128:143]
ds_read_u16 v106, v106
ds_read_u16 v104, v104
v_and_b32_sdwa v107, s47, v105 dst_sel:DWORD dst_unused:UNUSED_PAD src0_sel:DWORD src1_sel:WORD_1
v_and_b32_e64 v105, s47, v105
v_pk_add_f16 v109, v109, 1.0 op_sel_hi:[1,0]
v_pk_add_f16 v111, v111, 1.0 op_sel_hi:[1,0]
v_rcp_f16_sdwa v109, v109 dst_sel:WORD_0 dst_unused:UNUSED_PRESERVE src0_sel:WORD_0
v_mfma_f32_32x32x16_bf16 v[112:127], v[20:23], v[188:191], v[112:127]
ds_read_u16 v107, v107
ds_read_u16 v105, v105
v_rcp_f16_sdwa v111, v111 dst_sel:WORD_0 dst_unused:UNUSED_PRESERVE src0_sel:WORD_0
v_rcp_f16_sdwa v109, v109 dst_sel:WORD_1 dst_unused:UNUSED_PRESERVE src0_sel:WORD_1
v_rcp_f16_sdwa v111, v111 dst_sel:WORD_1 dst_unused:UNUSED_PRESERVE src0_sel:WORD_1
v_mfma_f32_32x32x16_bf16 v[128:143], v[44:47], v[188:191], v[128:143]
v_pk_mul_f16 v108, v108, v109
v_pk_mul_f16 v110, v110, v111
v_fma_mix_f32 v234, v108, v108, v234 op_sel_hi:[1,1,0]
s_nop 2
v_cvt_pkrtz_f16_f32 v112, v112, v113
v_fma_mix_f32 v234, v110, v110, v234 op_sel_hi:[1,1,0]
v_cvt_pkrtz_f16_f32 v113, v114, v115
v_fma_mix_f32 v234, v108, v108, v234 op_sel:[1,1,0] op_sel_hi:[1,1,0]
v_lshrrev_b64 v[112:113], 2, v[112:113]
v_fma_mix_f32 v234, v110, v110, v234 op_sel:[1,1,0] op_sel_hi:[1,1,0]
v_and_b32_sdwa v114, s47, v112 dst_sel:DWORD dst_unused:UNUSED_PAD src0_sel:DWORD src1_sel:WORD_1
s_waitcnt lgkmcnt(4)
v_fma_mix_f32 v234, v96, v96, v234 op_sel_hi:[1,1,0]
v_and_b32_e64 v112, s47, v112
v_fma_mix_f32 v234, v97, v97, v234 op_sel_hi:[1,1,0]
v_cvt_pk_f16_f32 v124, v124, v125
v_fma_mix_f32 v234, v98, v98, v234 op_sel_hi:[1,1,0]
v_cvt_pk_f16_f32 v126, v126, v127
v_fma_mix_f32 v234, v99, v99, v234 op_sel_hi:[1,1,0]
v_pk_fma_f16 v125, v124, v124, s48
v_fma_mix_f32 v234, v100, v100, v234 op_sel_hi:[1,1,0]
v_and_b32_sdwa v115, s47, v113 dst_sel:DWORD dst_unused:UNUSED_PAD src0_sel:DWORD src1_sel:WORD_1
v_fma_mix_f32 v234, v101, v101, v234 op_sel_hi:[1,1,0]
v_and_b32_e64 v113, s47, v113
v_pk_fma_f16 v127, v126, v126, s48
ds_read_u16 v114, v114
ds_read_u16 v112, v112
ds_read_u16 v115, v115
ds_read_u16 v113, v113
s_add_u32 s43, s81, 6592
v_add_u32_e64 v212, s43, v246
v_subrev_u32 v222, 65920, v212
v_min_u32_e64 v212, v212, v222
v_add_u32 v212, 90112, v212
v_add_u32_e64 v213, s43, v246
v_add_u32 v213, 6592, v213
v_subrev_u32 v222, 65920, v213
v_min_u32_e64 v213, v213, v222
v_add_u32 v213, 90112, v213
v_add_u32_e64 v214, s43, v246
v_add_u32 v214, 13184, v214
v_add_u32_e64 v222, 16, v214
v_bfi_b32 v214, 48, v222, v214
v_subrev_u32 v222, 65920, v214
v_min_u32_e64 v214, v214, v222
v_add_u32 v214, 90112, v214
v_add_u32_e64 v215, s43, v246
v_add_u32 v215, 19776, v215
v_add_u32_e64 v222, 16, v215
v_bfi_b32 v215, 48, v222, v215
v_subrev_u32 v222, 65920, v215
v_min_u32_e64 v215, v215, v222
v_add_u32 v215, 90112, v215
v_pk_mul_f16 v125, v124, v125
v_pk_mul_f16 v127, v126, v127
v_fma_mix_f32 v234, v102, v102, v234 op_sel_hi:[1,1,0]
v_cvt_pkrtz_f16_f32 v116, v116, v117
v_fma_mix_f32 v234, v103, v103, v234 op_sel_hi:[1,1,0]
v_cvt_pkrtz_f16_f32 v117, v118, v119
v_lshrrev_b64 v[116:117], 2, v[116:117]
v_and_b32_sdwa v118, s47, v116 dst_sel:DWORD dst_unused:UNUSED_PAD src0_sel:DWORD src1_sel:WORD_1
v_and_b32 v116, s47, v116
v_exp_f16_sdwa v125, v125 dst_sel:WORD_0 dst_unused:UNUSED_PRESERVE src0_sel:WORD_0
s_waitcnt lgkmcnt(2)
v_fma_mix_f32 v234, v104, v104, v234 op_sel_hi:[1,1,0]
v_exp_f16_sdwa v127, v127 dst_sel:WORD_0 dst_unused:UNUSED_PRESERVE src0_sel:WORD_0
v_fma_mix_f32 v234, v105, v105, v234 op_sel_hi:[1,1,0]
v_and_b32_sdwa v119, s47, v117 dst_sel:DWORD dst_unused:UNUSED_PAD src0_sel:DWORD src1_sel:WORD_1
v_and_b32 v117, s47, v117
ds_read_u16 v118, v118
ds_read_u16 v116, v116
ds_read_u16 v119, v119
ds_read_u16 v117, v117
s_waitcnt vmcnt(0)
v_exp_f16_sdwa v125, v125 dst_sel:WORD_1 dst_unused:UNUSED_PRESERVE src0_sel:WORD_1
v_fma_mix_f32 v234, v106, v106, v234 op_sel_hi:[1,1,0]
v_cvt_pkrtz_f16_f32 v120, v120, v121
v_fma_mix_f32 v234, v107, v107, v234 op_sel_hi:[1,1,0]
v_cvt_pkrtz_f16_f32 v121, v122, v123
v_lshrrev_b64 v[120:121], 2, v[120:121]
v_and_b32_sdwa v122, s47, v120 dst_sel:DWORD dst_unused:UNUSED_PAD src0_sel:DWORD src1_sel:WORD_1
ds_read_b128 v[144:147], v212
ds_read_b64 v[196:197], v238
ds_read_b64 v[198:199], v239
v_and_b32_e64 v120, s47, v120
v_exp_f16_sdwa v127, v127 dst_sel:WORD_1 dst_unused:UNUSED_PRESERVE src0_sel:WORD_1
v_and_b32_sdwa v123, s47, v121 dst_sel:DWORD dst_unused:UNUSED_PAD src0_sel:DWORD src1_sel:WORD_1
v_and_b32_e64 v121, s47, v121
v_pk_add_f16 v125, v125, 1.0 op_sel_hi:[1,0]
v_pk_add_f16 v127, v127, 1.0 op_sel_hi:[1,0]
v_rcp_f16_sdwa v125, v125 dst_sel:WORD_0 dst_unused:UNUSED_PRESERVE src0_sel:WORD_0
ds_read_u16 v122, v122
ds_read_u16 v120, v120
ds_read_b128 v[148:151], v213
ds_read_b128 v[152:155], v214
ds_read_b64 v[200:201], v238 offset:2400
ds_read_b64 v[202:203], v239 offset:2400
s_waitcnt lgkmcnt(13)
ds_read_b128 v[156:159], v215
ds_read_u16 v123, v123
s_waitcnt lgkmcnt(14)
ds_read_u16 v121, v121
v_rcp_f16_sdwa v127, v127 dst_sel:WORD_0 dst_unused:UNUSED_PRESERVE src0_sel:WORD_0
v_rcp_f16_sdwa v125, v125 dst_sel:WORD_1 dst_unused:UNUSED_PRESERVE src0_sel:WORD_1
v_rcp_f16_sdwa v127, v127 dst_sel:WORD_1 dst_unused:UNUSED_PRESERVE src0_sel:WORD_1
v_pk_mul_f16 v124, v124, v125
v_pk_mul_f16 v126, v126, v127
v_fma_mix_f32 v235, v124, v124, v235 op_sel_hi:[1,1,0]
s_waitcnt lgkmcnt(14)
ds_read_b64 v[204:205], v238 offset:4800
s_waitcnt lgkmcnt(14)
ds_read_b64 v[206:207], v239 offset:4800
v_fma_mix_f32 v235, v126, v126, v235 op_sel_hi:[1,1,0]
v_cvt_pkrtz_f16_f32 v128, v128, v129
v_fma_mix_f32 v235, v124, v124, v235 op_sel:[1,1,0] op_sel_hi:[1,1,0]
v_cvt_pkrtz_f16_f32 v129, v130, v131
v_fma_mix_f32 v235, v126, v126, v235 op_sel:[1,1,0] op_sel_hi:[1,1,0]
v_lshrrev_b64 v[128:129], 2, v[128:129]
v_fma_mix_f32 v235, v112, v112, v235 op_sel_hi:[1,1,0]
s_waitcnt lgkmcnt(11)
v_mfma_f32_16x16x32_bf16 v[48:51], v[196:199], v[144:147], 0
ds_read_b128 v[160:163], v212 offset:16
ds_read_b64 v[208:209], v238 offset:200
ds_read_b64 v[210:211], v239 offset:200
v_fma_mix_f32 v235, v113, v113, v235 op_sel_hi:[1,1,0]
v_and_b32_sdwa v130, s47, v128 dst_sel:DWORD dst_unused:UNUSED_PAD src0_sel:DWORD src1_sel:WORD_1
v_fma_mix_f32 v235, v114, v114, v235 op_sel_hi:[1,1,0]
v_and_b32 v128, s47, v128
v_fma_mix_f32 v235, v115, v115, v235 op_sel_hi:[1,1,0]
v_cvt_pk_f16_f32 v140, v140, v141
v_cvt_pk_f16_f32 v142, v142, v143
ds_read_b128 v[164:167], v213 offset:16
s_waitcnt lgkmcnt(14)
ds_read_b128 v[168:171], v214 offset:16
v_pk_fma_f16 v141, v140, v140, s48
v_fma_mix_f32 v235, v116, v116, v235 op_sel_hi:[1,1,0]
s_waitcnt lgkmcnt(13)
v_mfma_f32_16x16x32_bf16 v[96:99], v[196:199], v[148:151], 0
ds_read_b64 v[192:193], v238 offset:2600
ds_read_b64 v[194:195], v239 offset:2600
v_fma_mix_f32 v235, v117, v117, v235 op_sel_hi:[1,1,0]
v_and_b32_sdwa v131, s47, v129 dst_sel:DWORD dst_unused:UNUSED_PAD src0_sel:DWORD src1_sel:WORD_1
v_and_b32 v129, s47, v129
s_waitcnt lgkmcnt(12)
v_mfma_f32_16x16x32_bf16 v[48:51], v[200:203], v[148:151], v[48:51]
ds_read_b128 v[172:175], v215 offset:16
ds_read_b64 v[196:197], v238 offset:5000
ds_read_b64 v[198:199], v239 offset:5000
v_mfma_f32_16x16x32_bf16 v[96:99], v[200:203], v[152:155], v[96:99]
v_pk_fma_f16 v143, v142, v142, s48
v_pk_mul_f16 v141, v140, v141
v_pk_mul_f16 v143, v142, v143
v_fma_mix_f32 v235, v118, v118, v235 op_sel_hi:[1,1,0]
v_cvt_pkrtz_f16_f32 v132, v132, v133
v_fma_mix_f32 v235, v119, v119, v235 op_sel_hi:[1,1,0]
v_cvt_pkrtz_f16_f32 v133, v134, v135
v_lshrrev_b64 v[132:133], 2, v[132:133]
v_and_b32_sdwa v134, s47, v132 dst_sel:DWORD dst_unused:UNUSED_PAD src0_sel:DWORD src1_sel:WORD_1
s_waitcnt lgkmcnt(14)
ds_read_b128 v[144:147], v212 offset:32
s_waitcnt lgkmcnt(14)
ds_read_b64 v[200:201], v238 offset:400
s_waitcnt lgkmcnt(14)
ds_read_b64 v[202:203], v239 offset:400
v_and_b32 v132, s47, v132
s_waitcnt lgkmcnt(13)
v_mfma_f32_16x16x32_bf16 v[48:51], v[204:207], v[152:155], v[48:51]
ds_read_b128 v[148:151], v213 offset:32
ds_read_b128 v[152:155], v214 offset:32
v_mfma_f32_16x16x32_bf16 v[96:99], v[204:207], v[156:159], v[96:99]
s_waitcnt lgkmcnt(14)
ds_read_b64 v[204:205], v238 offset:2800
s_waitcnt lgkmcnt(14)
ds_read_b64 v[206:207], v239 offset:2800
s_waitcnt lgkmcnt(14)
v_mfma_f32_16x16x32_bf16 v[52:55], v[208:211], v[160:163], 0
v_exp_f16_sdwa v141, v141 dst_sel:WORD_0 dst_unused:UNUSED_PRESERVE src0_sel:WORD_0
s_waitcnt lgkmcnt(13)
v_mfma_f32_16x16x32_bf16 v[100:103], v[208:211], v[164:167], 0
ds_read_b128 v[156:159], v215 offset:32
ds_read_b64 v[208:209], v238 offset:5200
v_fma_mix_f32 v235, v120, v120, v235 op_sel_hi:[1,1,0]
v_exp_f16_sdwa v143, v143 dst_sel:WORD_0 dst_unused:UNUSED_PRESERVE src0_sel:WORD_0
s_waitcnt lgkmcnt(12)
v_mfma_f32_16x16x32_bf16 v[52:55], v[192:195], v[164:167], v[52:55]
ds_read_b64 v[210:211], v239 offset:5200
ds_read_b128 v[160:163], v212 offset:48
v_mfma_f32_16x16x32_bf16 v[100:103], v[192:195], v[168:171], v[100:103]
ds_read_b64 v[192:193], v238 offset:600
s_waitcnt lgkmcnt(14)
ds_read_b64 v[194:195], v239 offset:600
s_waitcnt lgkmcnt(13)
v_mfma_f32_16x16x32_bf16 v[52:55], v[196:199], v[168:171], v[52:55]
ds_read_u16 v130, v130
ds_read_u16 v128, v128
v_mfma_f32_16x16x32_bf16 v[100:103], v[196:199], v[172:175], v[100:103]
s_waitcnt lgkmcnt(14)
ds_read_b128 v[164:167], v213 offset:48
s_waitcnt lgkmcnt(14)
ds_read_b128 v[168:171], v214 offset:48
s_waitcnt lgkmcnt(14)
v_mfma_f32_16x16x32_bf16 v[56:59], v[200:203], v[144:147], 0
ds_read_b64 v[196:197], v238 offset:3000
v_fma_mix_f32 v235, v121, v121, v235 op_sel_hi:[1,1,0]
s_waitcnt lgkmcnt(14)
v_mfma_f32_16x16x32_bf16 v[104:107], v[200:203], v[148:151], 0
ds_read_b64 v[198:199], v239 offset:3000
v_and_b32_sdwa v135, s47, v133 dst_sel:DWORD dst_unused:UNUSED_PAD src0_sel:DWORD src1_sel:WORD_1
v_and_b32 v133, s47, v133
s_waitcnt lgkmcnt(12)
v_mfma_f32_16x16x32_bf16 v[56:59], v[204:207], v[148:151], v[56:59]
ds_read_u16 v131, v131
ds_read_u16 v129, v129
ds_read_b128 v[172:175], v215 offset:48
v_mfma_f32_16x16x32_bf16 v[104:107], v[204:207], v[152:155], v[104:107]
s_waitcnt lgkmcnt(14)
ds_read_b64 v[200:201], v238 offset:5400
s_waitcnt lgkmcnt(14)
ds_read_b64 v[202:203], v239 offset:5400
s_waitcnt lgkmcnt(14)
v_mfma_f32_16x16x32_bf16 v[56:59], v[208:211], v[152:155], v[56:59]
v_exp_f16_sdwa v141, v141 dst_sel:WORD_1 dst_unused:UNUSED_PRESERVE src0_sel:WORD_1
v_mfma_f32_16x16x32_bf16 v[104:107], v[208:211], v[156:159], v[104:107]
ds_read_u16 v134, v134
s_waitcnt lgkmcnt(14)
ds_read_u16 v132, v132
s_waitcnt lgkmcnt(14)
ds_read_b128 v[144:147], v212 offset:64
s_waitcnt lgkmcnt(14)
v_mfma_f32_16x16x32_bf16 v[60:63], v[192:195], v[160:163], 0
v_fma_mix_f32 v235, v122, v122, v235 op_sel_hi:[1,1,0]
v_cvt_pkrtz_f16_f32 v136, v136, v137
v_fma_mix_f32 v235, v123, v123, v235 op_sel_hi:[1,1,0]
v_cvt_pkrtz_f16_f32 v137, v138, v139
v_lshrrev_b64 v[136:137], 2, v[136:137]
v_and_b32_sdwa v138, s47, v136 dst_sel:DWORD dst_unused:UNUSED_PAD src0_sel:DWORD src1_sel:WORD_1
v_and_b32 v136, s47, v136
v_exp_f16_sdwa v143, v143 dst_sel:WORD_1 dst_unused:UNUSED_PRESERVE src0_sel:WORD_1
ds_read_b64 v[204:205], v238 offset:800
s_waitcnt lgkmcnt(14)
ds_read_b64 v[206:207], v239 offset:800
s_waitcnt lgkmcnt(14)
ds_read_b128 v[148:151], v213 offset:64
s_waitcnt lgkmcnt(14)
v_mfma_f32_16x16x32_bf16 v[108:111], v[192:195], v[164:167], 0
v_and_b32_sdwa v139, s47, v137 dst_sel:DWORD dst_unused:UNUSED_PAD src0_sel:DWORD src1_sel:WORD_1
v_and_b32_e64 v137, s47, v137
v_pk_add_f16 v141, v141, 1.0 op_sel_hi:[1,0]
v_pk_add_f16 v143, v143, 1.0 op_sel_hi:[1,0]
v_rcp_f16_sdwa v141, v141 dst_sel:WORD_0 dst_unused:UNUSED_PRESERVE src0_sel:WORD_0
s_waitcnt lgkmcnt(11)
v_mfma_f32_16x16x32_bf16 v[60:63], v[196:199], v[164:167], v[60:63]
ds_read_u16 v135, v135
ds_read_u16 v133, v133
ds_read_b128 v[152:155], v214 offset:64
ds_read_b64 v[208:209], v238 offset:3200
v_mfma_f32_16x16x32_bf16 v[108:111], v[196:199], v[168:171], v[108:111]
v_rcp_f16_sdwa v143, v143 dst_sel:WORD_0 dst_unused:UNUSED_PRESERVE src0_sel:WORD_0
v_rcp_f16_sdwa v141, v141 dst_sel:WORD_1 dst_unused:UNUSED_PRESERVE src0_sel:WORD_1
v_rcp_f16_sdwa v143, v143 dst_sel:WORD_1 dst_unused:UNUSED_PRESERVE src0_sel:WORD_1
s_waitcnt lgkmcnt(14)
ds_read_b64 v[210:211], v239 offset:3200
s_waitcnt lgkmcnt(14)
ds_read_b128 v[156:159], v215 offset:64
v_pk_mul_f16 v140, v140, v141
v_pk_mul_f16 v142, v142, v143
s_waitcnt lgkmcnt(12)
v_mfma_f32_16x16x32_bf16 v[60:63], v[200:203], v[168:171], v[60:63]
ds_read_b64 v[192:193], v238 offset:5600
ds_read_b64 v[194:195], v239 offset:5600
v_mfma_f32_16x16x32_bf16 v[108:111], v[200:203], v[172:175], v[108:111]
v_fma_mix_f32 v235, v140, v140, v235 op_sel_hi:[1,1,0]
ds_read_u16 v138, v138
s_waitcnt lgkmcnt(14)
ds_read_u16 v136, v136
v_fma_mix_f32 v235, v142, v142, v235 op_sel_hi:[1,1,0]
s_waitcnt lgkmcnt(14)
ds_read_b128 v[160:163], v212 offset:80
s_waitcnt lgkmcnt(14)
ds_read_b64 v[196:197], v238 offset:1000
s_waitcnt lgkmcnt(14)
ds_read_b64 v[198:199], v239 offset:1000
s_waitcnt lgkmcnt(14)
v_mfma_f32_16x16x32_bf16 v[64:67], v[204:207], v[144:147], 0
v_fma_mix_f32 v235, v140, v140, v235 op_sel:[1,1,0] op_sel_hi:[1,1,0]
ds_read_u16 v139, v139
s_waitcnt lgkmcnt(14)
v_mfma_f32_16x16x32_bf16 v[112:115], v[204:207], v[148:151], 0
ds_read_u16 v137, v137
s_waitcnt lgkmcnt(14)
ds_read_b128 v[164:167], v213 offset:80
v_fma_mix_f32 v235, v142, v142, v235 op_sel:[1,1,0] op_sel_hi:[1,1,0]
s_nop 0
v_fma_mix_f32 v235, v128, v128, v235 op_sel_hi:[1,1,0]
s_waitcnt lgkmcnt(14)
ds_read_b128 v[168:171], v214 offset:80
v_fma_mix_f32 v235, v129, v129, v235 op_sel_hi:[1,1,0]
s_waitcnt lgkmcnt(14)
ds_read_b64 v[200:201], v238 offset:3400
v_fma_mix_f32 v235, v130, v130, v235 op_sel_hi:[1,1,0]
s_waitcnt lgkmcnt(13)
v_mfma_f32_16x16x32_bf16 v[64:67], v[208:211], v[148:151], v[64:67]
ds_read_b64 v[202:203], v239 offset:3400
v_fma_mix_f32 v235, v131, v131, v235 op_sel_hi:[1,1,0]
v_mfma_f32_16x16x32_bf16 v[112:115], v[208:211], v[152:155], v[112:115]
ds_read_b128 v[172:175], v215 offset:80
s_waitcnt lgkmcnt(14)
ds_read_b64 v[204:205], v238 offset:5800
s_waitcnt lgkmcnt(14)
ds_read_b64 v[206:207], v239 offset:5800
s_waitcnt lgkmcnt(14)
v_mfma_f32_16x16x32_bf16 v[64:67], v[192:195], v[152:155], v[64:67]
v_fma_mix_f32 v235, v132, v132, v235 op_sel_hi:[1,1,0]
v_mfma_f32_16x16x32_bf16 v[112:115], v[192:195], v[156:159], v[112:115]
ds_read_b128 v[144:147], v212 offset:96
v_fma_mix_f32 v235, v133, v133, v235 op_sel_hi:[1,1,0]
s_waitcnt lgkmcnt(14)
ds_read_b64 v[208:209], v238 offset:1200
s_waitcnt lgkmcnt(14)
ds_read_b64 v[210:211], v239 offset:1200
v_fma_mix_f32 v235, v134, v134, v235 op_sel_hi:[1,1,0]
s_waitcnt lgkmcnt(14)
ds_read_b128 v[148:151], v213 offset:96
v_fma_mix_f32 v235, v135, v135, v235 op_sel_hi:[1,1,0]
s_waitcnt lgkmcnt(13)
v_mfma_f32_16x16x32_bf16 v[68:71], v[196:199], v[160:163], 0
ds_read_b128 v[152:155], v214 offset:96
ds_read_b64 v[192:193], v238 offset:3600
s_waitcnt lgkmcnt(14)
ds_read_b64 v[194:195], v239 offset:3600
s_waitcnt lgkmcnt(13)
v_mfma_f32_16x16x32_bf16 v[116:119], v[196:199], v[164:167], 0
ds_read_b128 v[156:159], v215 offset:96
ds_read_b64 v[196:197], v238 offset:6000
s_waitcnt lgkmcnt(14)
ds_read_b64 v[198:199], v239 offset:6000
s_waitcnt lgkmcnt(13)
v_mfma_f32_16x16x32_bf16 v[68:71], v[200:203], v[164:167], v[68:71]
ds_read_b128 v[160:163], v212 offset:112
v_fma_mix_f32 v235, v136, v136, v235 op_sel_hi:[1,1,0]
v_mfma_f32_16x16x32_bf16 v[116:119], v[200:203], v[168:171], v[116:119]
ds_read_b64 v[200:201], v238 offset:1400
s_waitcnt lgkmcnt(14)
ds_read_b64 v[202:203], v239 offset:1400
s_waitcnt lgkmcnt(13)
v_mfma_f32_16x16x32_bf16 v[68:71], v[204:207], v[168:171], v[68:71]
ds_read_b128 v[164:167], v213 offset:112
v_fma_mix_f32 v235, v137, v137, v235 op_sel_hi:[1,1,0]
v_mfma_f32_16x16x32_bf16 v[116:119], v[204:207], v[172:175], v[116:119]
ds_read_b128 v[168:171], v214 offset:112
s_waitcnt lgkmcnt(14)
ds_read_b64 v[204:205], v238 offset:3800
s_waitcnt lgkmcnt(13)
v_mfma_f32_16x16x32_bf16 v[72:75], v[208:211], v[144:147], 0
ds_read_b64 v[206:207], v239 offset:3800
ds_read_b128 v[172:175], v215 offset:112
s_waitcnt lgkmcnt(14)
v_mfma_f32_16x16x32_bf16 v[120:123], v[208:211], v[148:151], 0
v_fma_mix_f32 v235, v138, v138, v235 op_sel_hi:[1,1,0]
ds_read_b64 v[208:209], v238 offset:6200
v_fma_mix_f32 v235, v139, v139, v235 op_sel_hi:[1,1,0]
s_waitcnt lgkmcnt(14)
ds_read_b64 v[210:211], v239 offset:6200
s_waitcnt lgkmcnt(13)
v_mfma_f32_16x16x32_bf16 v[72:75], v[192:195], v[148:151], v[72:75]
ds_read_b128 v[144:147], v212 offset:128
ds_read_b128 v[148:151], v213 offset:128
v_mfma_f32_16x16x32_bf16 v[120:123], v[192:195], v[152:155], v[120:123]
s_waitcnt lgkmcnt(14)
ds_read_b64 v[192:193], v238 offset:1600
s_waitcnt lgkmcnt(14)
ds_read_b64 v[194:195], v239 offset:1600
s_waitcnt lgkmcnt(14)
v_mfma_f32_16x16x32_bf16 v[72:75], v[196:199], v[152:155], v[72:75]
ds_read_b128 v[152:155], v214 offset:128
v_mfma_f32_16x16x32_bf16 v[120:123], v[196:199], v[156:159], v[120:123]
s_waitcnt lgkmcnt(14)
ds_read_b64 v[196:197], v238 offset:4000
s_waitcnt lgkmcnt(14)
ds_read_b64 v[198:199], v239 offset:4000
s_waitcnt lgkmcnt(14)
v_mfma_f32_16x16x32_bf16 v[76:79], v[200:203], v[160:163], 0
ds_read_b128 v[156:159], v215 offset:128
s_waitcnt lgkmcnt(14)
v_mfma_f32_16x16x32_bf16 v[124:127], v[200:203], v[164:167], 0
ds_read_b64 v[200:201], v238 offset:6400
s_waitcnt lgkmcnt(14)
ds_read_b64 v[202:203], v239 offset:6400
s_waitcnt lgkmcnt(13)
v_mfma_f32_16x16x32_bf16 v[76:79], v[204:207], v[164:167], v[76:79]
ds_read_b128 v[160:163], v212 offset:144
ds_read_b128 v[164:167], v213 offset:144
v_mfma_f32_16x16x32_bf16 v[124:127], v[204:207], v[168:171], v[124:127]
s_waitcnt lgkmcnt(14)
ds_read_b64 v[204:205], v238 offset:1800
s_waitcnt lgkmcnt(14)
ds_read_b64 v[206:207], v239 offset:1800
s_waitcnt lgkmcnt(14)
v_mfma_f32_16x16x32_bf16 v[76:79], v[208:211], v[168:171], v[76:79]
ds_read_b128 v[168:171], v214 offset:144
v_mfma_f32_16x16x32_bf16 v[124:127], v[208:211], v[172:175], v[124:127]
s_waitcnt lgkmcnt(14)
ds_read_b64 v[208:209], v238 offset:4200
s_waitcnt lgkmcnt(14)
ds_read_b64 v[210:211], v239 offset:4200
s_waitcnt lgkmcnt(13)
v_mfma_f32_16x16x32_bf16 v[80:83], v[192:195], v[144:147], 0
ds_read_b128 v[172:175], v215 offset:144
ds_read_b128 v[144:147], v212 offset:160
v_mfma_f32_16x16x32_bf16 v[128:131], v[192:195], v[148:151], 0
s_waitcnt lgkmcnt(14)
ds_read_b64 v[192:193], v238 offset:6600
s_waitcnt lgkmcnt(14)
ds_read_b64 v[194:195], v239 offset:6600
s_waitcnt lgkmcnt(14)
v_mfma_f32_16x16x32_bf16 v[80:83], v[196:199], v[148:151], v[80:83]
ds_read_b128 v[148:151], v213 offset:160
v_mfma_f32_16x16x32_bf16 v[128:131], v[196:199], v[152:155], v[128:131]
s_waitcnt lgkmcnt(14)
ds_read_b64 v[196:197], v238 offset:2000
s_waitcnt lgkmcnt(14)
ds_read_b64 v[198:199], v239 offset:2000
s_waitcnt lgkmcnt(14)
v_mfma_f32_16x16x32_bf16 v[80:83], v[200:203], v[152:155], v[80:83]
ds_read_b128 v[152:155], v214 offset:160
v_mfma_f32_16x16x32_bf16 v[128:131], v[200:203], v[156:159], v[128:131]
s_waitcnt lgkmcnt(14)
ds_read_b64 v[200:201], v238 offset:4400
s_waitcnt lgkmcnt(14)
ds_read_b64 v[202:203], v239 offset:4400
s_waitcnt lgkmcnt(13)
v_mfma_f32_16x16x32_bf16 v[84:87], v[204:207], v[160:163], 0
ds_read_b128 v[156:159], v215 offset:160
ds_read_b128 v[160:163], v212 offset:176
v_mfma_f32_16x16x32_bf16 v[132:135], v[204:207], v[164:167], 0
s_waitcnt lgkmcnt(14)
ds_read_b64 v[204:205], v238 offset:6800
s_waitcnt lgkmcnt(14)
ds_read_b64 v[206:207], v239 offset:6800
s_waitcnt lgkmcnt(14)
v_mfma_f32_16x16x32_bf16 v[84:87], v[208:211], v[164:167], v[84:87]
ds_read_b128 v[164:167], v213 offset:176
v_mfma_f32_16x16x32_bf16 v[132:135], v[208:211], v[168:171], v[132:135]
s_waitcnt lgkmcnt(14)
ds_read_b64 v[208:209], v238 offset:2200
s_waitcnt lgkmcnt(14)
ds_read_b64 v[210:211], v239 offset:2200
s_waitcnt lgkmcnt(13)
v_mfma_f32_16x16x32_bf16 v[84:87], v[192:195], v[168:171], v[84:87]
ds_read_b128 v[168:171], v214 offset:176
v_mfma_f32_16x16x32_bf16 v[132:135], v[192:195], v[172:175], v[132:135]
ds_read_b64 v[192:193], v238 offset:4600
s_waitcnt lgkmcnt(14)
ds_read_b64 v[194:195], v239 offset:4600
s_waitcnt lgkmcnt(13)
v_mfma_f32_16x16x32_bf16 v[88:91], v[196:199], v[144:147], 0
ds_read_b128 v[172:175], v215 offset:176
v_mfma_f32_16x16x32_bf16 v[136:139], v[196:199], v[148:151], 0
ds_read_b64 v[196:197], v238 offset:7000
s_waitcnt lgkmcnt(14)
ds_read_b64 v[198:199], v239 offset:7000
s_waitcnt lgkmcnt(13)
v_mfma_f32_16x16x32_bf16 v[88:91], v[200:203], v[148:151], v[88:91]
v_mfma_f32_16x16x32_bf16 v[136:139], v[200:203], v[152:155], v[136:139]
s_waitcnt lgkmcnt(9)
v_mfma_f32_16x16x32_bf16 v[88:91], v[204:207], v[152:155], v[88:91]
v_mfma_f32_16x16x32_bf16 v[136:139], v[204:207], v[156:159], v[136:139]
s_waitcnt lgkmcnt(6)
v_mfma_f32_16x16x32_bf16 v[92:95], v[208:211], v[160:163], 0
v_mfma_f32_16x16x32_bf16 v[140:143], v[208:211], v[164:167], 0
s_waitcnt lgkmcnt(3)
v_mfma_f32_16x16x32_bf16 v[92:95], v[192:195], v[164:167], v[92:95]
v_mfma_f32_16x16x32_bf16 v[140:143], v[192:195], v[168:171], v[140:143]
s_waitcnt lgkmcnt(0)
v_mfma_f32_16x16x32_bf16 v[92:95], v[196:199], v[168:171], v[92:95]
v_mfma_f32_16x16x32_bf16 v[140:143], v[196:199], v[172:175], v[140:143]
v_mov_b32 v223, 1
v_add_u32 v222, s83, v247
s_nop 7
s_mov_b64 exec, 1
ds_add_u32 v222, v223 offset:24
s_mov_b64 exec, -1
v_pk_mul_f32 v[242:243], v[48:49], v[48:49]
v_pk_add_f32 v[240:241], v[48:49], v[50:51]
v_pk_fma_f32 v[242:243], v[50:51], v[50:51], v[242:243]
v_pk_mul_f32 v[218:219], v[96:97], v[96:97]
v_pk_add_f32 v[216:217], v[96:97], v[98:99]
v_pk_fma_f32 v[218:219], v[98:99], v[98:99], v[218:219]
v_pk_fma_f32 v[242:243], v[52:53], v[52:53], v[242:243]
v_pk_add_f32 v[240:241], v[240:241], v[52:53]
v_pk_fma_f32 v[242:243], v[54:55], v[54:55], v[242:243]
v_pk_add_f32 v[240:241], v[240:241], v[54:55]
v_pk_fma_f32 v[218:219], v[100:101], v[100:101], v[218:219]
v_pk_add_f32 v[216:217], v[216:217], v[100:101]
v_pk_fma_f32 v[218:219], v[102:103], v[102:103], v[218:219]
v_pk_add_f32 v[216:217], v[216:217], v[102:103]
v_pk_fma_f32 v[242:243], v[56:57], v[56:57], v[242:243]
v_pk_add_f32 v[240:241], v[240:241], v[56:57]
v_pk_fma_f32 v[242:243], v[58:59], v[58:59], v[242:243]
v_pk_add_f32 v[240:241], v[240:241], v[58:59]
v_pk_fma_f32 v[218:219], v[104:105], v[104:105], v[218:219]
v_pk_add_f32 v[216:217], v[216:217], v[104:105]
v_pk_fma_f32 v[218:219], v[106:107], v[106:107], v[218:219]
v_pk_add_f32 v[216:217], v[216:217], v[106:107]
v_pk_fma_f32 v[242:243], v[60:61], v[60:61], v[242:243]
v_pk_add_f32 v[240:241], v[240:241], v[60:61]
v_pk_fma_f32 v[242:243], v[62:63], v[62:63], v[242:243]
v_pk_add_f32 v[240:241], v[240:241], v[62:63]
v_pk_fma_f32 v[218:219], v[108:109], v[108:109], v[218:219]
v_pk_add_f32 v[216:217], v[216:217], v[108:109]
v_pk_fma_f32 v[218:219], v[110:111], v[110:111], v[218:219]
v_pk_add_f32 v[216:217], v[216:217], v[110:111]
v_pk_fma_f32 v[242:243], v[64:65], v[64:65], v[242:243]
v_pk_add_f32 v[240:241], v[240:241], v[64:65]
v_pk_fma_f32 v[242:243], v[66:67], v[66:67], v[242:243]
v_pk_add_f32 v[240:241], v[240:241], v[66:67]
v_pk_fma_f32 v[218:219], v[112:113], v[112:113], v[218:219]
v_pk_add_f32 v[216:217], v[216:217], v[112:113]
v_pk_fma_f32 v[218:219], v[114:115], v[114:115], v[218:219]
v_pk_add_f32 v[216:217], v[216:217], v[114:115]
v_pk_fma_f32 v[242:243], v[68:69], v[68:69], v[242:243]
v_pk_add_f32 v[240:241], v[240:241], v[68:69]
v_pk_fma_f32 v[242:243], v[70:71], v[70:71], v[242:243]
v_pk_add_f32 v[240:241], v[240:241], v[70:71]
v_pk_fma_f32 v[218:219], v[116:117], v[116:117], v[218:219]
v_pk_add_f32 v[216:217], v[216:217], v[116:117]
v_pk_fma_f32 v[218:219], v[118:119], v[118:119], v[218:219]
v_pk_add_f32 v[216:217], v[216:217], v[118:119]
v_pk_fma_f32 v[242:243], v[72:73], v[72:73], v[242:243]
v_pk_add_f32 v[240:241], v[240:241], v[72:73]
v_pk_fma_f32 v[242:243], v[74:75], v[74:75], v[242:243]
v_pk_add_f32 v[240:241], v[240:241], v[74:75]
v_pk_fma_f32 v[218:219], v[120:121], v[120:121], v[218:219]
v_pk_add_f32 v[216:217], v[216:217], v[120:121]
v_pk_fma_f32 v[218:219], v[122:123], v[122:123], v[218:219]
v_pk_add_f32 v[216:217], v[216:217], v[122:123]
v_pk_fma_f32 v[242:243], v[76:77], v[76:77], v[242:243]
v_pk_add_f32 v[240:241], v[240:241], v[76:77]
v_pk_fma_f32 v[242:243], v[78:79], v[78:79], v[242:243]
v_pk_add_f32 v[240:241], v[240:241], v[78:79]
v_pk_fma_f32 v[218:219], v[124:125], v[124:125], v[218:219]
v_pk_add_f32 v[216:217], v[216:217], v[124:125]
v_pk_fma_f32 v[218:219], v[126:127], v[126:127], v[218:219]
v_pk_add_f32 v[216:217], v[216:217], v[126:127]
v_pk_fma_f32 v[242:243], v[80:81], v[80:81], v[242:243]
v_pk_add_f32 v[240:241], v[240:241], v[80:81]
v_pk_fma_f32 v[242:243], v[82:83], v[82:83], v[242:243]
v_pk_add_f32 v[240:241], v[240:241], v[82:83]
v_pk_fma_f32 v[218:219], v[128:129], v[128:129], v[218:219]
v_pk_add_f32 v[216:217], v[216:217], v[128:129]
v_pk_fma_f32 v[218:219], v[130:131], v[130:131], v[218:219]
v_pk_add_f32 v[216:217], v[216:217], v[130:131]
v_pk_fma_f32 v[242:243], v[84:85], v[84:85], v[242:243]
v_pk_add_f32 v[240:241], v[240:241], v[84:85]
v_pk_fma_f32 v[242:243], v[86:87], v[86:87], v[242:243]
v_pk_add_f32 v[240:241], v[240:241], v[86:87]
v_pk_fma_f32 v[218:219], v[132:133], v[132:133], v[218:219]
v_pk_add_f32 v[216:217], v[216:217], v[132:133]
v_pk_fma_f32 v[218:219], v[134:135], v[134:135], v[218:219]
v_pk_add_f32 v[216:217], v[216:217], v[134:135]
v_pk_fma_f32 v[242:243], v[88:89], v[88:89], v[242:243]
v_pk_add_f32 v[240:241], v[240:241], v[88:89]
v_pk_fma_f32 v[242:243], v[90:91], v[90:91], v[242:243]
v_pk_add_f32 v[240:241], v[240:241], v[90:91]
v_pk_fma_f32 v[218:219], v[136:137], v[136:137], v[218:219]
v_pk_add_f32 v[216:217], v[216:217], v[136:137]
v_pk_fma_f32 v[218:219], v[138:139], v[138:139], v[218:219]
v_pk_add_f32 v[216:217], v[216:217], v[138:139]
v_pk_fma_f32 v[242:243], v[92:93], v[92:93], v[242:243]
v_pk_add_f32 v[240:241], v[240:241], v[92:93]
v_pk_fma_f32 v[242:243], v[94:95], v[94:95], v[242:243]
v_pk_add_f32 v[240:241], v[240:241], v[94:95]
v_pk_fma_f32 v[218:219], v[140:141], v[140:141], v[218:219]
v_pk_add_f32 v[216:217], v[216:217], v[140:141]
v_pk_fma_f32 v[218:219], v[142:143], v[142:143], v[218:219]
v_pk_add_f32 v[216:217], v[216:217], v[142:143]
v_add_f32 v218, v218, v219
v_add_f32 v216, v216, v217
s_nop 1
v_permlane32_swap_b32 v216, v218
v_add_f32_e64 v216, v216, v218
v_mul_f32 v216, 1009429163, v216
v_mov_b32_e64 v218, v216
s_nop 1
v_permlane32_swap_b32 v216, v218
v_fma_f32 v218, -v216, v216, v218
v_max_f32_e64 v218, 0, v218
v_add_f32 v218, 925353388, v218
v_rsq_f32 v218, v218
v_add_f32 v240, v240, v241
v_mul_f32 v220, 3203396952, v218
v_mul_f32 v221, 3203396952, v218
v_mul_f32 v218, v216, v220
v_mul_f32 v219, v216, v220
v_add_f32 v242, v242, v243
s_nop 1
v_permlane32_swap_b32 v240, v242
v_add_f32 v240, v240, v242
v_mul_f32 v240, 1009429163, v240
v_mov_b32_e64 v242, v240
s_nop 1
v_permlane32_swap_b32 v240, v242
v_fma_f32 v242, -v240, v240, v242
v_max_f32_e64 v242, 0, v242
v_add_f32 v242, 925353388, v242
v_rsq_f32 v242, v242
s_nop 0
v_mul_f32 v244, 3203396952, v242
v_mul_f32 v245, 3203396952, v242
v_mul_f32 v242, v240, v244
v_mul_f32 v243, v240, v244
v_pk_fma_f32 v[48:49], v[48:49], v[244:245], v[242:243] neg_lo:[0,0,1] neg_hi:[0,0,1]
v_pk_fma_f32 v[50:51], v[50:51], v[244:245], v[242:243] neg_lo:[0,0,1] neg_hi:[0,0,1]
v_cvt_pk_bf16_f32 v48, v48, v49
v_cvt_pk_bf16_f32 v49, v50, v51
v_pk_fma_f32 v[52:53], v[52:53], v[244:245], v[242:243] neg_lo:[0,0,1] neg_hi:[0,0,1]
v_pk_fma_f32 v[54:55], v[54:55], v[244:245], v[242:243] neg_lo:[0,0,1] neg_hi:[0,0,1]
v_cvt_pk_bf16_f32 v50, v52, v53
v_cvt_pk_bf16_f32 v51, v54, v55
v_pk_fma_f32 v[56:57], v[56:57], v[244:245], v[242:243] neg_lo:[0,0,1] neg_hi:[0,0,1]
v_pk_fma_f32 v[58:59], v[58:59], v[244:245], v[242:243] neg_lo:[0,0,1] neg_hi:[0,0,1]
v_cvt_pk_bf16_f32 v52, v56, v57
v_cvt_pk_bf16_f32 v53, v58, v59
v_pk_fma_f32 v[60:61], v[60:61], v[244:245], v[242:243] neg_lo:[0,0,1] neg_hi:[0,0,1]
v_pk_fma_f32 v[62:63], v[62:63], v[244:245], v[242:243] neg_lo:[0,0,1] neg_hi:[0,0,1]
v_cvt_pk_bf16_f32 v54, v60, v61
v_cvt_pk_bf16_f32 v55, v62, v63
v_pk_fma_f32 v[64:65], v[64:65], v[244:245], v[242:243] neg_lo:[0,0,1] neg_hi:[0,0,1]
v_pk_fma_f32 v[66:67], v[66:67], v[244:245], v[242:243] neg_lo:[0,0,1] neg_hi:[0,0,1]
v_cvt_pk_bf16_f32 v56, v64, v65
v_cvt_pk_bf16_f32 v57, v66, v67
v_pk_fma_f32 v[68:69], v[68:69], v[244:245], v[242:243] neg_lo:[0,0,1] neg_hi:[0,0,1]
v_pk_fma_f32 v[70:71], v[70:71], v[244:245], v[242:243] neg_lo:[0,0,1] neg_hi:[0,0,1]
v_cvt_pk_bf16_f32 v58, v68, v69
v_cvt_pk_bf16_f32 v59, v70, v71
v_pk_fma_f32 v[72:73], v[72:73], v[244:245], v[242:243] neg_lo:[0,0,1] neg_hi:[0,0,1]
v_pk_fma_f32 v[74:75], v[74:75], v[244:245], v[242:243] neg_lo:[0,0,1] neg_hi:[0,0,1]
v_cvt_pk_bf16_f32 v60, v72, v73
v_cvt_pk_bf16_f32 v61, v74, v75
v_pk_fma_f32 v[76:77], v[76:77], v[244:245], v[242:243] neg_lo:[0,0,1] neg_hi:[0,0,1]
v_pk_fma_f32 v[78:79], v[78:79], v[244:245], v[242:243] neg_lo:[0,0,1] neg_hi:[0,0,1]
v_cvt_pk_bf16_f32 v62, v76, v77
v_cvt_pk_bf16_f32 v63, v78, v79
v_pk_fma_f32 v[80:81], v[80:81], v[244:245], v[242:243] neg_lo:[0,0,1] neg_hi:[0,0,1]
v_pk_fma_f32 v[82:83], v[82:83], v[244:245], v[242:243] neg_lo:[0,0,1] neg_hi:[0,0,1]
v_cvt_pk_bf16_f32 v64, v80, v81
v_cvt_pk_bf16_f32 v65, v82, v83
v_pk_fma_f32 v[84:85], v[84:85], v[244:245], v[242:243] neg_lo:[0,0,1] neg_hi:[0,0,1]
v_pk_fma_f32 v[86:87], v[86:87], v[244:245], v[242:243] neg_lo:[0,0,1] neg_hi:[0,0,1]
v_cvt_pk_bf16_f32 v66, v84, v85
v_cvt_pk_bf16_f32 v67, v86, v87
v_pk_fma_f32 v[88:89], v[88:89], v[244:245], v[242:243] neg_lo:[0,0,1] neg_hi:[0,0,1]
v_pk_fma_f32 v[90:91], v[90:91], v[244:245], v[242:243] neg_lo:[0,0,1] neg_hi:[0,0,1]
v_cvt_pk_bf16_f32 v68, v88, v89
v_cvt_pk_bf16_f32 v69, v90, v91
v_pk_fma_f32 v[92:93], v[92:93], v[244:245], v[242:243] neg_lo:[0,0,1] neg_hi:[0,0,1]
v_pk_fma_f32 v[94:95], v[94:95], v[244:245], v[242:243] neg_lo:[0,0,1] neg_hi:[0,0,1]
v_cvt_pk_bf16_f32 v70, v92, v93
v_cvt_pk_bf16_f32 v71, v94, v95
v_pk_fma_f32 v[96:97], v[96:97], v[220:221], v[218:219] neg_lo:[0,0,1] neg_hi:[0,0,1]
ds_read_b128 v[176:179], v250
v_cvt_pk_bf16_f32 v72, v96, v97
v_pk_fma_f32 v[98:99], v[98:99], v[220:221], v[218:219] neg_lo:[0,0,1] neg_hi:[0,0,1]
v_pk_fma_f32 v[100:101], v[100:101], v[220:221], v[218:219] neg_lo:[0,0,1] neg_hi:[0,0,1]
v_cvt_pk_bf16_f32 v73, v98, v99
v_cvt_pk_bf16_f32 v74, v100, v101
v_pk_fma_f32 v[102:103], v[102:103], v[220:221], v[218:219] neg_lo:[0,0,1] neg_hi:[0,0,1]
v_pk_fma_f32 v[104:105], v[104:105], v[220:221], v[218:219] neg_lo:[0,0,1] neg_hi:[0,0,1]
v_cvt_pk_bf16_f32 v75, v102, v103
v_cvt_pk_bf16_f32 v76, v104, v105
v_pk_fma_f32 v[106:107], v[106:107], v[220:221], v[218:219] neg_lo:[0,0,1] neg_hi:[0,0,1]
v_pk_fma_f32 v[108:109], v[108:109], v[220:221], v[218:219] neg_lo:[0,0,1] neg_hi:[0,0,1]
v_cvt_pk_bf16_f32 v77, v106, v107
v_cvt_pk_bf16_f32 v78, v108, v109
v_pk_fma_f32 v[110:111], v[110:111], v[220:221], v[218:219] neg_lo:[0,0,1] neg_hi:[0,0,1]
v_pk_fma_f32 v[112:113], v[112:113], v[220:221], v[218:219] neg_lo:[0,0,1] neg_hi:[0,0,1]
v_cvt_pk_bf16_f32 v79, v110, v111
v_cvt_pk_bf16_f32 v80, v112, v113
v_pk_fma_f32 v[114:115], v[114:115], v[220:221], v[218:219] neg_lo:[0,0,1] neg_hi:[0,0,1]
v_pk_fma_f32 v[116:117], v[116:117], v[220:221], v[218:219] neg_lo:[0,0,1] neg_hi:[0,0,1]
v_cvt_pk_bf16_f32 v81, v114, v115
v_cvt_pk_bf16_f32 v82, v116, v117
v_pk_fma_f32 v[118:119], v[118:119], v[220:221], v[218:219] neg_lo:[0,0,1] neg_hi:[0,0,1]
v_pk_fma_f32 v[120:121], v[120:121], v[220:221], v[218:219] neg_lo:[0,0,1] neg_hi:[0,0,1]
ds_read_b128 v[180:183], v250 offset:1024
v_cvt_pk_bf16_f32 v83, v118, v119
v_cvt_pk_bf16_f32 v84, v120, v121
v_pk_fma_f32 v[122:123], v[122:123], v[220:221], v[218:219] neg_lo:[0,0,1] neg_hi:[0,0,1]
v_pk_fma_f32 v[124:125], v[124:125], v[220:221], v[218:219] neg_lo:[0,0,1] neg_hi:[0,0,1]
v_cvt_pk_bf16_f32 v85, v122, v123
v_cvt_pk_bf16_f32 v86, v124, v125
v_pk_fma_f32 v[126:127], v[126:127], v[220:221], v[218:219] neg_lo:[0,0,1] neg_hi:[0,0,1]
v_pk_fma_f32 v[128:129], v[128:129], v[220:221], v[218:219] neg_lo:[0,0,1] neg_hi:[0,0,1]
v_cvt_pk_bf16_f32 v87, v126, v127
v_cvt_pk_bf16_f32 v88, v128, v129
v_pk_fma_f32 v[130:131], v[130:131], v[220:221], v[218:219] neg_lo:[0,0,1] neg_hi:[0,0,1]
v_pk_fma_f32 v[132:133], v[132:133], v[220:221], v[218:219] neg_lo:[0,0,1] neg_hi:[0,0,1]
v_cvt_pk_bf16_f32 v89, v130, v131
v_cvt_pk_bf16_f32 v90, v132, v133
v_pk_fma_f32 v[134:135], v[134:135], v[220:221], v[218:219] neg_lo:[0,0,1] neg_hi:[0,0,1]
v_pk_fma_f32 v[136:137], v[136:137], v[220:221], v[218:219] neg_lo:[0,0,1] neg_hi:[0,0,1]
v_cvt_pk_bf16_f32 v91, v134, v135
v_cvt_pk_bf16_f32 v92, v136, v137
v_pk_fma_f32 v[138:139], v[138:139], v[220:221], v[218:219] neg_lo:[0,0,1] neg_hi:[0,0,1]
v_pk_fma_f32 v[140:141], v[140:141], v[220:221], v[218:219] neg_lo:[0,0,1] neg_hi:[0,0,1]
v_cvt_pk_bf16_f32 v93, v138, v139
v_cvt_pk_bf16_f32 v94, v140, v141
v_pk_fma_f32 v[142:143], v[142:143], v[220:221], v[218:219] neg_lo:[0,0,1] neg_hi:[0,0,1]
ds_read_b128 v[184:187], v250 offset:2048
v_cvt_pk_bf16_f32 v95, v142, v143
v_cndmask_b32 v216, 0, v255, s[50:51]
v_and_b32 v216, 1006648320, v216
v_cndmask_b32 v217, 0, v255, s[52:53]
v_and_b32 v217, 1006648320, v217
v_cndmask_b32 v218, 0, v255, s[54:55]
v_and_b32 v218, 1006648320, v218
v_cndmask_b32 v219, 0, v255, s[56:57]
v_and_b32 v219, 1006648320, v219
v_cndmask_b32 v220, 0, v255, s[58:59]
v_and_b32 v220, 1006648320, v220
v_cndmask_b32 v221, 0, v255, s[60:61]
v_and_b32 v221, 1006648320, v221
v_cndmask_b32 v222, 0, v255, s[62:63]
v_and_b32 v222, 1006648320, v222
v_cndmask_b32 v223, 0, v255, s[64:65]
v_and_b32 v223, 1006648320, v223
s_waitcnt lgkmcnt(1)
v_mfma_f32_32x32x16_bf16 v[144:159], v[48:51], v[176:179], 0
s_cmp_lt_u32 s40, 4
s_cbranch_scc0 Lbk
s_setprio 2
Lbk:
ds_read_b128 v[188:191], v250 offset:3072
v_mfma_f32_32x32x16_bf16 v[160:175], v[72:75], v[176:179], 0
ds_read_b128 v[176:179], v250 offset:4096
v_mfma_f32_32x32x16_bf16 v[144:159], v[52:55], v[180:183], v[144:159]
v_mfma_f32_32x32x16_bf16 v[160:175], v[76:79], v[180:183], v[160:175]
ds_read_b128 v[180:183], v250 offset:5120
s_waitcnt lgkmcnt(3)
v_mfma_f32_32x32x16_bf16 v[144:159], v[56:59], v[184:187], v[144:159]
v_mfma_f32_32x32x16_bf16 v[160:175], v[80:83], v[184:187], v[160:175]
ds_read_b128 v[184:187], v250 offset:6144
s_waitcnt lgkmcnt(2)
v_mfma_f32_32x32x16_bf16 v[144:159], v[60:63], v[188:191], v[144:159]
v_mfma_f32_32x32x16_bf16 v[160:175], v[84:87], v[188:191], v[160:175]
ds_read_b128 v[188:191], v250 offset:7168
v_mfma_f32_32x32x16_bf16 v[144:159], v[64:67], v[176:179], v[144:159]
v_mfma_f32_32x32x16_bf16 v[160:175], v[88:91], v[176:179], v[160:175]
ds_read_b128 v[176:179], v250 offset:8192
s_waitcnt lgkmcnt(2)
v_mfma_f32_32x32x16_bf16 v[144:159], v[68:71], v[180:183], v[144:159]
v_mfma_f32_32x32x16_bf16 v[160:175], v[92:95], v[180:183], v[160:175]
ds_read_b128 v[180:183], v250 offset:9216
s_nop 9
v_cvt_pkrtz_f16_f32 v144, v144, v145
v_mfma_f32_32x32x16_bf16 v[112:127], v[48:51], v[184:187], 0
v_cvt_pkrtz_f16_f32 v145, v146, v147
v_lshrrev_b64 v[144:145], 2, v[144:145]
v_and_b32_sdwa v146, s47, v144 dst_sel:DWORD dst_unused:UNUSED_PAD src0_sel:DWORD src1_sel:WORD_1
v_and_b32_e64 v144, s47, v144
v_cvt_pk_f16_f32 v156, v156, v157
v_cvt_pk_f16_f32 v158, v158, v159
v_mfma_f32_32x32x16_bf16 v[128:143], v[72:75], v[184:187], 0
ds_read_u16 v146, v146
ds_read_u16 v144, v144
v_pk_fma_f16 v157, v156, v156, s48
v_and_b32_sdwa v147, s47, v145 dst_sel:DWORD dst_unused:UNUSED_PAD src0_sel:DWORD src1_sel:WORD_1
v_and_b32_e64 v145, s47, v145
v_pk_fma_f16 v159, v158, v158, s48
v_pk_mul_f16 v157, v156, v157
v_pk_mul_f16 v159, v158, v159
v_cvt_pkrtz_f16_f32 v148, v148, v149
v_cvt_pkrtz_f16_f32 v149, v150, v151
v_lshrrev_b64 v[148:149], 2, v[148:149]
ds_read_u16 v147, v147
ds_read_u16 v145, v145
v_and_b32_sdwa v150, s47, v148 dst_sel:DWORD dst_unused:UNUSED_PAD src0_sel:DWORD src1_sel:WORD_1
v_and_b32 v148, s47, v148
v_exp_f16_sdwa v157, v157 dst_sel:WORD_0 dst_unused:UNUSED_PRESERVE src0_sel:WORD_0
s_waitcnt lgkmcnt(4)
v_mfma_f32_32x32x16_bf16 v[112:127], v[52:55], v[188:191], v[112:127]
ds_read_u16 v150, v150
ds_read_u16 v148, v148
v_exp_f16_sdwa v159, v159 dst_sel:WORD_0 dst_unused:UNUSED_PRESERVE src0_sel:WORD_0
v_and_b32_sdwa v151, s47, v149 dst_sel:DWORD dst_unused:UNUSED_PAD src0_sel:DWORD src1_sel:WORD_1
v_and_b32_e64 v149, s47, v149
v_exp_f16_sdwa v157, v157 dst_sel:WORD_1 dst_unused:UNUSED_PRESERVE src0_sel:WORD_1
v_cvt_pkrtz_f16_f32 v152, v152, v153
v_cvt_pkrtz_f16_f32 v153, v154, v155
v_lshrrev_b64 v[152:153], 2, v[152:153]
v_and_b32_sdwa v154, s47, v152 dst_sel:DWORD dst_unused:UNUSED_PAD src0_sel:DWORD src1_sel:WORD_1
v_and_b32_e64 v152, s47, v152
ds_read_u16 v151, v151
ds_read_u16 v149, v149
ds_read_u16 v154, v154
ds_read_u16 v152, v152
v_mfma_f32_32x32x16_bf16 v[128:143], v[76:79], v[188:191], v[128:143]
v_exp_f16_sdwa v159, v159 dst_sel:WORD_1 dst_unused:UNUSED_PRESERVE src0_sel:WORD_1
v_and_b32_sdwa v155, s47, v153 dst_sel:DWORD dst_unused:UNUSED_PAD src0_sel:DWORD src1_sel:WORD_1
v_and_b32_e64 v153, s47, v153
v_pk_add_f16 v157, v157, 1.0 op_sel_hi:[1,0]
v_pk_add_f16 v159, v159, 1.0 op_sel_hi:[1,0]
v_rcp_f16_sdwa v157, v157 dst_sel:WORD_0 dst_unused:UNUSED_PRESERVE src0_sel:WORD_0
v_mfma_f32_32x32x16_bf16 v[112:127], v[56:59], v[176:179], v[112:127]
ds_read_b128 v[184:187], v250 offset:10240
ds_read_u16 v155, v155
ds_read_u16 v153, v153
v_rcp_f16_sdwa v159, v159 dst_sel:WORD_0 dst_unused:UNUSED_PRESERVE src0_sel:WORD_0
v_rcp_f16_sdwa v157, v157 dst_sel:WORD_1 dst_unused:UNUSED_PRESERVE src0_sel:WORD_1
v_mfma_f32_32x32x16_bf16 v[128:143], v[80:83], v[176:179], v[128:143]
v_rcp_f16_sdwa v159, v159 dst_sel:WORD_1 dst_unused:UNUSED_PRESERVE src0_sel:WORD_1
v_pk_mul_f16 v156, v156, v157
v_pk_mul_f16 v158, v158, v159
v_fma_mix_f32 v224, v156, v156, v224 op_sel_hi:[1,1,0]
v_mfma_f32_32x32x16_bf16 v[112:127], v[60:63], v[180:183], v[112:127]
ds_read_b128 v[188:191], v250 offset:11264
v_fma_mix_f32 v224, v158, v158, v224 op_sel_hi:[1,1,0]
v_cvt_pkrtz_f16_f32 v160, v160, v161
v_fma_mix_f32 v224, v156, v156, v224 op_sel:[1,1,0] op_sel_hi:[1,1,0]
v_cvt_pkrtz_f16_f32 v161, v162, v163
v_fma_mix_f32 v224, v158, v158, v224 op_sel:[1,1,0] op_sel_hi:[1,1,0]
v_lshrrev_b64 v[160:161], 2, v[160:161]
s_waitcnt lgkmcnt(7)
v_fma_mix_f32 v224, v144, v144, v224 op_sel_hi:[1,1,0]
v_and_b32_sdwa v162, s47, v160 dst_sel:DWORD dst_unused:UNUSED_PAD src0_sel:DWORD src1_sel:WORD_1
v_fma_mix_f32 v224, v145, v145, v224 op_sel_hi:[1,1,0]
v_and_b32 v160, s47, v160
v_fma_mix_f32 v224, v146, v146, v224 op_sel_hi:[1,1,0]
v_cvt_pk_f16_f32 v172, v172, v173
v_fma_mix_f32 v224, v147, v147, v224 op_sel_hi:[1,1,0]
v_cvt_pk_f16_f32 v174, v174, v175
v_mfma_f32_32x32x16_bf16 v[128:143], v[84:87], v[180:183], v[128:143]
ds_read_u16 v162, v162
ds_read_u16 v160, v160
v_pk_fma_f16 v173, v172, v172, s48
v_fma_mix_f32 v224, v148, v148, v224 op_sel_hi:[1,1,0]
v_and_b32_sdwa v163, s47, v161 dst_sel:DWORD dst_unused:UNUSED_PAD src0_sel:DWORD src1_sel:WORD_1
s_waitcnt lgkmcnt(6)
v_fma_mix_f32 v224, v149, v149, v224 op_sel_hi:[1,1,0]
v_and_b32 v161, s47, v161
v_pk_fma_f16 v175, v174, v174, s48
v_pk_mul_f16 v173, v172, v173
v_pk_mul_f16 v175, v174, v175
v_fma_mix_f32 v224, v150, v150, v224 op_sel_hi:[1,1,0]
v_cvt_pkrtz_f16_f32 v164, v164, v165
v_fma_mix_f32 v224, v151, v151, v224 op_sel_hi:[1,1,0]
ds_read_u16 v163, v163
ds_read_u16 v161, v161
ds_read_b128 v[176:179], v250 offset:12288
v_cvt_pkrtz_f16_f32 v165, v166, v167
v_lshrrev_b64 v[164:165], 2, v[164:165]
v_and_b32_sdwa v166, s47, v164 dst_sel:DWORD dst_unused:UNUSED_PAD src0_sel:DWORD src1_sel:WORD_1
v_and_b32 v164, s47, v164
v_exp_f16_sdwa v173, v173 dst_sel:WORD_0 dst_unused:UNUSED_PRESERVE src0_sel:WORD_0
s_waitcnt lgkmcnt(6)
v_mfma_f32_32x32x16_bf16 v[112:127], v[64:67], v[184:187], v[112:127]
ds_read_u16 v166, v166
ds_read_u16 v164, v164
v_fma_mix_f32 v224, v152, v152, v224 op_sel_hi:[1,1,0]
v_exp_f16_sdwa v175, v175 dst_sel:WORD_0 dst_unused:UNUSED_PRESERVE src0_sel:WORD_0
v_fma_mix_f32 v224, v153, v153, v224 op_sel_hi:[1,1,0]
v_and_b32_sdwa v167, s47, v165 dst_sel:DWORD dst_unused:UNUSED_PAD src0_sel:DWORD src1_sel:WORD_1
v_and_b32_e64 v165, s47, v165
v_exp_f16_sdwa v173, v173 dst_sel:WORD_1 dst_unused:UNUSED_PRESERVE src0_sel:WORD_1
v_fma_mix_f32 v224, v154, v154, v224 op_sel_hi:[1,1,0]
v_cvt_pkrtz_f16_f32 v168, v168, v169
v_fma_mix_f32 v224, v155, v155, v224 op_sel_hi:[1,1,0]
v_cvt_pkrtz_f16_f32 v169, v170, v171
v_lshrrev_b64 v[168:169], 2, v[168:169]
ds_read_u16 v167, v167
ds_read_u16 v165, v165
v_and_b32_sdwa v170, s47, v168 dst_sel:DWORD dst_unused:UNUSED_PAD src0_sel:DWORD src1_sel:WORD_1
v_and_b32_e64 v168, s47, v168
v_mfma_f32_32x32x16_bf16 v[128:143], v[88:91], v[184:187], v[128:143]
ds_read_u16 v170, v170
ds_read_u16 v168, v168
v_exp_f16_sdwa v175, v175 dst_sel:WORD_1 dst_unused:UNUSED_PRESERVE src0_sel:WORD_1
v_and_b32_sdwa v171, s47, v169 dst_sel:DWORD dst_unused:UNUSED_PAD src0_sel:DWORD src1_sel:WORD_1
v_and_b32 v169, s47, v169
v_pk_add_f16 v173, v173, 1.0 op_sel_hi:[1,0]
v_pk_add_f16 v175, v175, 1.0 op_sel_hi:[1,0]
v_rcp_f16_sdwa v173, v173 dst_sel:WORD_0 dst_unused:UNUSED_PRESERVE src0_sel:WORD_0
s_waitcnt lgkmcnt(6)
v_mfma_f32_32x32x16_bf16 v[112:127], v[68:71], v[188:191], v[112:127]
ds_read_b128 v[180:183], v250 offset:13312
ds_read_u16 v171, v171
ds_read_u16 v169, v169
v_rcp_f16_sdwa v175, v175 dst_sel:WORD_0 dst_unused:UNUSED_PRESERVE src0_sel:WORD_0
v_rcp_f16_sdwa v173, v173 dst_sel:WORD_1 dst_unused:UNUSED_PRESERVE src0_sel:WORD_1
v_mfma_f32_32x32x16_bf16 v[128:143], v[92:95], v[188:191], v[128:143]
v_rcp_f16_sdwa v175, v175 dst_sel:WORD_1 dst_unused:UNUSED_PRESERVE src0_sel:WORD_1
v_pk_mul_f16 v172, v172, v173
v_pk_mul_f16 v174, v174, v175
v_fma_mix_f32 v224, v172, v172, v224 op_sel_hi:[1,1,0]
v_mfma_f32_32x32x16_bf16 v[96:111], v[48:51], v[176:179], 0
ds_read_b128 v[184:187], v250 offset:14336
v_fma_mix_f32 v224, v174, v174, v224 op_sel_hi:[1,1,0]
v_cvt_pkrtz_f16_f32 v112, v112, v113
v_fma_mix_f32 v224, v172, v172, v224 op_sel:[1,1,0] op_sel_hi:[1,1,0]
v_cvt_pkrtz_f16_f32 v113, v114, v115
v_fma_mix_f32 v224, v174, v174, v224 op_sel:[1,1,0] op_sel_hi:[1,1,0]
v_lshrrev_b64 v[112:113], 2, v[112:113]
v_fma_mix_f32 v224, v160, v160, v224 op_sel_hi:[1,1,0]
v_and_b32_sdwa v114, s47, v112 dst_sel:DWORD dst_unused:UNUSED_PAD src0_sel:DWORD src1_sel:WORD_1
v_fma_mix_f32 v224, v161, v161, v224 op_sel_hi:[1,1,0]
v_and_b32_e64 v112, s47, v112
v_fma_mix_f32 v224, v162, v162, v224 op_sel_hi:[1,1,0]
v_cvt_pk_f16_f32 v124, v124, v125
v_fma_mix_f32 v224, v163, v163, v224 op_sel_hi:[1,1,0]
v_cvt_pk_f16_f32 v126, v126, v127
v_mfma_f32_32x32x16_bf16 v[144:159], v[176:179], v[72:75], 0
ds_read_u16 v114, v114
ds_read_u16 v112, v112
v_pk_fma_f16 v125, v124, v124, s48
s_waitcnt lgkmcnt(5)
v_fma_mix_f32 v224, v164, v164, v224 op_sel_hi:[1,1,0]
v_and_b32_sdwa v115, s47, v113 dst_sel:DWORD dst_unused:UNUSED_PAD src0_sel:DWORD src1_sel:WORD_1
v_fma_mix_f32 v224, v165, v165, v224 op_sel_hi:[1,1,0]
v_and_b32 v113, s47, v113
v_pk_fma_f16 v127, v126, v126, s48
v_pk_mul_f16 v125, v124, v125
v_pk_mul_f16 v127, v126, v127
v_fma_mix_f32 v224, v166, v166, v224 op_sel_hi:[1,1,0]
v_cvt_pkrtz_f16_f32 v116, v116, v117
v_fma_mix_f32 v224, v167, v167, v224 op_sel_hi:[1,1,0]
ds_read_u16 v115, v115
ds_read_u16 v113, v113
ds_read_b128 v[188:191], v250 offset:15360
v_cvt_pkrtz_f16_f32 v117, v118, v119
v_lshrrev_b64 v[116:117], 2, v[116:117]
v_and_b32_sdwa v118, s47, v116 dst_sel:DWORD dst_unused:UNUSED_PAD src0_sel:DWORD src1_sel:WORD_1
v_and_b32_e64 v116, s47, v116
v_exp_f16_sdwa v125, v125 dst_sel:WORD_0 dst_unused:UNUSED_PRESERVE src0_sel:WORD_0
v_mfma_f32_32x32x16_bf16 v[96:111], v[52:55], v[180:183], v[96:111]
ds_read_u16 v118, v118
ds_read_u16 v116, v116
v_fma_mix_f32 v224, v168, v168, v224 op_sel_hi:[1,1,0]
v_exp_f16_sdwa v127, v127 dst_sel:WORD_0 dst_unused:UNUSED_PRESERVE src0_sel:WORD_0
s_waitcnt lgkmcnt(7)
v_fma_mix_f32 v224, v169, v169, v224 op_sel_hi:[1,1,0]
v_and_b32_sdwa v119, s47, v117 dst_sel:DWORD dst_unused:UNUSED_PAD src0_sel:DWORD src1_sel:WORD_1
v_and_b32 v117, s47, v117
v_exp_f16_sdwa v125, v125 dst_sel:WORD_1 dst_unused:UNUSED_PRESERVE src0_sel:WORD_1
v_fma_mix_f32 v224, v170, v170, v224 op_sel_hi:[1,1,0]
v_cvt_pkrtz_f16_f32 v120, v120, v121
v_fma_mix_f32 v224, v171, v171, v224 op_sel_hi:[1,1,0]
v_cvt_pkrtz_f16_f32 v121, v122, v123
v_lshrrev_b64 v[120:121], 2, v[120:121]
ds_read_u16 v119, v119
ds_read_u16 v117, v117
v_and_b32_sdwa v122, s47, v120 dst_sel:DWORD dst_unused:UNUSED_PAD src0_sel:DWORD src1_sel:WORD_1
v_and_b32_e64 v120, s47, v120
v_mfma_f32_32x32x16_bf16 v[144:159], v[180:183], v[76:79], v[144:159]
ds_read_u16 v122, v122
ds_read_u16 v120, v120
v_exp_f16_sdwa v127, v127 dst_sel:WORD_1 dst_unused:UNUSED_PRESERVE src0_sel:WORD_1
v_and_b32_sdwa v123, s47, v121 dst_sel:DWORD dst_unused:UNUSED_PAD src0_sel:DWORD src1_sel:WORD_1
v_and_b32_e64 v121, s47, v121
v_pk_add_f16 v125, v125, 1.0 op_sel_hi:[1,0]
v_pk_add_f16 v127, v127, 1.0 op_sel_hi:[1,0]
v_rcp_f16_sdwa v125, v125 dst_sel:WORD_0 dst_unused:UNUSED_PRESERVE src0_sel:WORD_0
v_mfma_f32_32x32x16_bf16 v[96:111], v[56:59], v[184:187], v[96:111]
ds_read_b128 v[176:179], v250 offset:16384
ds_read_u16 v123, v123
ds_read_u16 v121, v121
v_rcp_f16_sdwa v127, v127 dst_sel:WORD_0 dst_unused:UNUSED_PRESERVE src0_sel:WORD_0
v_rcp_f16_sdwa v125, v125 dst_sel:WORD_1 dst_unused:UNUSED_PRESERVE src0_sel:WORD_1
v_mfma_f32_32x32x16_bf16 v[144:159], v[184:187], v[80:83], v[144:159]
v_rcp_f16_sdwa v127, v127 dst_sel:WORD_1 dst_unused:UNUSED_PRESERVE src0_sel:WORD_1
v_pk_mul_f16 v124, v124, v125
v_pk_mul_f16 v126, v126, v127
v_fma_mix_f32 v225, v124, v124, v225 op_sel_hi:[1,1,0]
s_waitcnt lgkmcnt(7)
v_mfma_f32_32x32x16_bf16 v[96:111], v[60:63], v[188:191], v[96:111]
ds_read_b128 v[180:183], v250 offset:17408
v_fma_mix_f32 v225, v126, v126, v225 op_sel_hi:[1,1,0]
v_cvt_pkrtz_f16_f32 v128, v128, v129
v_fma_mix_f32 v225, v124, v124, v225 op_sel:[1,1,0] op_sel_hi:[1,1,0]
v_cvt_pkrtz_f16_f32 v129, v130, v131
v_fma_mix_f32 v225, v126, v126, v225 op_sel:[1,1,0] op_sel_hi:[1,1,0]
v_lshrrev_b64 v[128:129], 2, v[128:129]
v_fma_mix_f32 v225, v112, v112, v225 op_sel_hi:[1,1,0]
v_and_b32_sdwa v130, s47, v128 dst_sel:DWORD dst_unused:UNUSED_PAD src0_sel:DWORD src1_sel:WORD_1
v_fma_mix_f32 v225, v113, v113, v225 op_sel_hi:[1,1,0]
v_and_b32 v128, s47, v128
v_fma_mix_f32 v225, v114, v114, v225 op_sel_hi:[1,1,0]
v_cvt_pk_f16_f32 v140, v140, v141
v_fma_mix_f32 v225, v115, v115, v225 op_sel_hi:[1,1,0]
v_cvt_pk_f16_f32 v142, v142, v143
v_mfma_f32_32x32x16_bf16 v[144:159], v[188:191], v[84:87], v[144:159]
ds_read_u16 v130, v130
ds_read_u16 v128, v128
v_pk_fma_f16 v141, v140, v140, s48
v_fma_mix_f32 v225, v116, v116, v225 op_sel_hi:[1,1,0]
v_and_b32_sdwa v131, s47, v129 dst_sel:DWORD dst_unused:UNUSED_PAD src0_sel:DWORD src1_sel:WORD_1
s_waitcnt lgkmcnt(5)
v_fma_mix_f32 v225, v117, v117, v225 op_sel_hi:[1,1,0]
v_and_b32 v129, s47, v129
v_pk_fma_f16 v143, v142, v142, s48
v_pk_mul_f16 v141, v140, v141
v_pk_mul_f16 v143, v142, v143
v_fma_mix_f32 v225, v118, v118, v225 op_sel_hi:[1,1,0]
v_cvt_pkrtz_f16_f32 v132, v132, v133
v_fma_mix_f32 v225, v119, v119, v225 op_sel_hi:[1,1,0]
ds_read_u16 v131, v131
ds_read_u16 v129, v129
ds_read_b128 v[184:187], v250 offset:18432
v_cvt_pkrtz_f16_f32 v133, v134, v135
v_lshrrev_b64 v[132:133], 2, v[132:133]
v_and_b32_sdwa v134, s47, v132 dst_sel:DWORD dst_unused:UNUSED_PAD src0_sel:DWORD src1_sel:WORD_1
v_and_b32_e64 v132, s47, v132
v_exp_f16_sdwa v141, v141 dst_sel:WORD_0 dst_unused:UNUSED_PRESERVE src0_sel:WORD_0
v_mfma_f32_32x32x16_bf16 v[96:111], v[64:67], v[176:179], v[96:111]
ds_read_u16 v134, v134
ds_read_u16 v132, v132
v_fma_mix_f32 v225, v120, v120, v225 op_sel_hi:[1,1,0]
v_exp_f16_sdwa v143, v143 dst_sel:WORD_0 dst_unused:UNUSED_PRESERVE src0_sel:WORD_0
s_waitcnt lgkmcnt(7)
v_fma_mix_f32 v225, v121, v121, v225 op_sel_hi:[1,1,0]
v_and_b32_sdwa v135, s47, v133 dst_sel:DWORD dst_unused:UNUSED_PAD src0_sel:DWORD src1_sel:WORD_1
v_and_b32 v133, s47, v133
v_exp_f16_sdwa v141, v141 dst_sel:WORD_1 dst_unused:UNUSED_PRESERVE src0_sel:WORD_1
v_fma_mix_f32 v225, v122, v122, v225 op_sel_hi:[1,1,0]
v_cvt_pkrtz_f16_f32 v136, v136, v137
v_fma_mix_f32 v225, v123, v123, v225 op_sel_hi:[1,1,0]
v_cvt_pkrtz_f16_f32 v137, v138, v139
v_lshrrev_b64 v[136:137], 2, v[136:137]
ds_read_u16 v135, v135
ds_read_u16 v133, v133
v_and_b32_sdwa v138, s47, v136 dst_sel:DWORD dst_unused:UNUSED_PAD src0_sel:DWORD src1_sel:WORD_1
v_and_b32_e64 v136, s47, v136
v_mfma_f32_32x32x16_bf16 v[144:159], v[176:179], v[88:91], v[144:159]
ds_read_u16 v138, v138
ds_read_u16 v136, v136
v_exp_f16_sdwa v143, v143 dst_sel:WORD_1 dst_unused:UNUSED_PRESERVE src0_sel:WORD_1
v_and_b32_sdwa v139, s47, v137 dst_sel:DWORD dst_unused:UNUSED_PAD src0_sel:DWORD src1_sel:WORD_1
v_and_b32_e64 v137, s47, v137
v_pk_add_f16 v141, v141, 1.0 op_sel_hi:[1,0]
v_pk_add_f16 v143, v143, 1.0 op_sel_hi:[1,0]
v_rcp_f16_sdwa v141, v141 dst_sel:WORD_0 dst_unused:UNUSED_PRESERVE src0_sel:WORD_0
v_mfma_f32_32x32x16_bf16 v[96:111], v[68:71], v[180:183], v[96:111]
ds_read_b128 v[188:191], v250 offset:19456
ds_read_u16 v139, v139
ds_read_u16 v137, v137
v_rcp_f16_sdwa v143, v143 dst_sel:WORD_0 dst_unused:UNUSED_PRESERVE src0_sel:WORD_0
v_rcp_f16_sdwa v141, v141 dst_sel:WORD_1 dst_unused:UNUSED_PRESERVE src0_sel:WORD_1
v_mfma_f32_32x32x16_bf16 v[144:159], v[180:183], v[92:95], v[144:159]
v_rcp_f16_sdwa v143, v143 dst_sel:WORD_1 dst_unused:UNUSED_PRESERVE src0_sel:WORD_1
v_pk_mul_f16 v140, v140, v141
v_pk_mul_f16 v142, v142, v143
v_fma_mix_f32 v225, v140, v140, v225 op_sel_hi:[1,1,0]
s_waitcnt lgkmcnt(7)
v_mfma_f32_32x32x16_bf16 v[160:175], v[48:51], v[184:187], 0
ds_read_b128 v[176:179], v250 offset:20480
v_fma_mix_f32 v225, v142, v142, v225 op_sel_hi:[1,1,0]
v_cvt_pkrtz_f16_f32 v96, v96, v97
v_fma_mix_f32 v225, v140, v140, v225 op_sel:[1,1,0] op_sel_hi:[1,1,0]
v_cvt_pkrtz_f16_f32 v97, v98, v99
v_fma_mix_f32 v225, v142, v142, v225 op_sel:[1,1,0] op_sel_hi:[1,1,0]
v_lshrrev_b64 v[96:97], 2, v[96:97]
v_fma_mix_f32 v225, v128, v128, v225 op_sel_hi:[1,1,0]
v_and_b32_sdwa v98, s47, v96 dst_sel:DWORD dst_unused:UNUSED_PAD src0_sel:DWORD src1_sel:WORD_1
v_fma_mix_f32 v225, v129, v129, v225 op_sel_hi:[1,1,0]
v_and_b32 v96, s47, v96
v_fma_mix_f32 v225, v130, v130, v225 op_sel_hi:[1,1,0]
v_cvt_pk_f16_f32 v108, v108, v109
v_fma_mix_f32 v225, v131, v131, v225 op_sel_hi:[1,1,0]
v_cvt_pk_f16_f32 v110, v110, v111
v_mfma_f32_32x32x16_bf16 v[112:127], v[184:187], v[72:75], 0
ds_read_u16 v98, v98
ds_read_u16 v96, v96
v_pk_fma_f16 v109, v108, v108, s48
v_fma_mix_f32 v225, v132, v132, v225 op_sel_hi:[1,1,0]
v_and_b32_sdwa v99, s47, v97 dst_sel:DWORD dst_unused:UNUSED_PAD src0_sel:DWORD src1_sel:WORD_1
s_waitcnt lgkmcnt(5)
v_fma_mix_f32 v225, v133, v133, v225 op_sel_hi:[1,1,0]
v_and_b32 v97, s47, v97
v_pk_fma_f16 v111, v110, v110, s48
v_pk_mul_f16 v109, v108, v109
v_pk_mul_f16 v111, v110, v111
v_fma_mix_f32 v225, v134, v134, v225 op_sel_hi:[1,1,0]
v_cvt_pkrtz_f16_f32 v100, v100, v101
v_fma_mix_f32 v225, v135, v135, v225 op_sel_hi:[1,1,0]
ds_read_u16 v99, v99
ds_read_u16 v97, v97
ds_read_b128 v[180:183], v250 offset:21504
v_cvt_pkrtz_f16_f32 v101, v102, v103
v_lshrrev_b64 v[100:101], 2, v[100:101]
v_and_b32_sdwa v102, s47, v100 dst_sel:DWORD dst_unused:UNUSED_PAD src0_sel:DWORD src1_sel:WORD_1
v_and_b32_e64 v100, s47, v100
v_exp_f16_sdwa v109, v109 dst_sel:WORD_0 dst_unused:UNUSED_PRESERVE src0_sel:WORD_0
v_mfma_f32_32x32x16_bf16 v[160:175], v[52:55], v[188:191], v[160:175]
ds_read_u16 v102, v102
ds_read_u16 v100, v100
v_fma_mix_f32 v225, v136, v136, v225 op_sel_hi:[1,1,0]
v_exp_f16_sdwa v111, v111 dst_sel:WORD_0 dst_unused:UNUSED_PRESERVE src0_sel:WORD_0
s_waitcnt lgkmcnt(7)
v_fma_mix_f32 v225, v137, v137, v225 op_sel_hi:[1,1,0]
v_and_b32_sdwa v103, s47, v101 dst_sel:DWORD dst_unused:UNUSED_PAD src0_sel:DWORD src1_sel:WORD_1
v_and_b32 v101, s47, v101
v_exp_f16_sdwa v109, v109 dst_sel:WORD_1 dst_unused:UNUSED_PRESERVE src0_sel:WORD_1
v_fma_mix_f32 v225, v138, v138, v225 op_sel_hi:[1,1,0]
v_cvt_pkrtz_f16_f32 v104, v104, v105
v_fma_mix_f32 v225, v139, v139, v225 op_sel_hi:[1,1,0]
v_cvt_pkrtz_f16_f32 v105, v106, v107
v_lshrrev_b64 v[104:105], 2, v[104:105]
ds_read_u16 v103, v103
ds_read_u16 v101, v101
v_and_b32_sdwa v106, s47, v104 dst_sel:DWORD dst_unused:UNUSED_PAD src0_sel:DWORD src1_sel:WORD_1
v_and_b32_e64 v104, s47, v104
v_mfma_f32_32x32x16_bf16 v[112:127], v[188:191], v[76:79], v[112:127]
ds_read_u16 v106, v106
ds_read_u16 v104, v104
v_exp_f16_sdwa v111, v111 dst_sel:WORD_1 dst_unused:UNUSED_PRESERVE src0_sel:WORD_1
v_and_b32_sdwa v107, s47, v105 dst_sel:DWORD dst_unused:UNUSED_PAD src0_sel:DWORD src1_sel:WORD_1
v_and_b32_e64 v105, s47, v105
v_pk_add_f16 v109, v109, 1.0 op_sel_hi:[1,0]
v_pk_add_f16 v111, v111, 1.0 op_sel_hi:[1,0]
v_rcp_f16_sdwa v109, v109 dst_sel:WORD_0 dst_unused:UNUSED_PRESERVE src0_sel:WORD_0
v_mfma_f32_32x32x16_bf16 v[160:175], v[56:59], v[176:179], v[160:175]
ds_read_b128 v[184:187], v250 offset:22528
ds_read_u16 v107, v107
ds_read_u16 v105, v105
v_rcp_f16_sdwa v111, v111 dst_sel:WORD_0 dst_unused:UNUSED_PRESERVE src0_sel:WORD_0
v_rcp_f16_sdwa v109, v109 dst_sel:WORD_1 dst_unused:UNUSED_PRESERVE src0_sel:WORD_1
v_mfma_f32_32x32x16_bf16 v[112:127], v[176:179], v[80:83], v[112:127]
v_rcp_f16_sdwa v111, v111 dst_sel:WORD_1 dst_unused:UNUSED_PRESERVE src0_sel:WORD_1
v_pk_mul_f16 v108, v108, v109
v_pk_mul_f16 v110, v110, v111
v_fma_mix_f32 v226, v108, v108, v226 op_sel_hi:[1,1,0]
s_waitcnt lgkmcnt(7)
v_mfma_f32_32x32x16_bf16 v[160:175], v[60:63], v[180:183], v[160:175]
ds_read_b128 v[188:191], v250 offset:23552
v_fma_mix_f32 v226, v110, v110, v226 op_sel_hi:[1,1,0]
v_cvt_pkrtz_f16_f32 v144, v144, v145
v_fma_mix_f32 v226, v108, v108, v226 op_sel:[1,1,0] op_sel_hi:[1,1,0]
v_cvt_pkrtz_f16_f32 v145, v146, v147
v_fma_mix_f32 v226, v110, v110, v226 op_sel:[1,1,0] op_sel_hi:[1,1,0]
v_lshrrev_b64 v[144:145], 2, v[144:145]
v_fma_mix_f32 v226, v96, v96, v226 op_sel_hi:[1,1,0]
v_and_b32_sdwa v146, s47, v144 dst_sel:DWORD dst_unused:UNUSED_PAD src0_sel:DWORD src1_sel:WORD_1
v_fma_mix_f32 v226, v97, v97, v226 op_sel_hi:[1,1,0]
v_and_b32 v144, s47, v144
v_fma_mix_f32 v226, v98, v98, v226 op_sel_hi:[1,1,0]
v_cvt_pk_f16_f32 v156, v156, v157
v_fma_mix_f32 v226, v99, v99, v226 op_sel_hi:[1,1,0]
v_cvt_pk_f16_f32 v158, v158, v159
v_mfma_f32_32x32x16_bf16 v[112:127], v[180:183], v[84:87], v[112:127]
ds_read_u16_d16_hi v146, v146
ds_read_u16 v144, v144
v_pk_fma_f16 v157, v156, v156, s48
v_fma_mix_f32 v226, v100, v100, v226 op_sel_hi:[1,1,0]
v_and_b32_sdwa v147, s47, v145 dst_sel:DWORD dst_unused:UNUSED_PAD src0_sel:DWORD src1_sel:WORD_1
s_waitcnt lgkmcnt(5)
v_fma_mix_f32 v226, v101, v101, v226 op_sel_hi:[1,1,0]
v_and_b32 v145, s47, v145
v_pk_fma_f16 v159, v158, v158, s48
v_pk_mul_f16 v157, v156, v157
v_fma_mix_f32 v226, v102, v102, v226 op_sel_hi:[1,1,0]
v_cvt_pkrtz_f16_f32 v148, v148, v149
v_fma_mix_f32 v226, v103, v103, v226 op_sel_hi:[1,1,0]
v_cvt_pkrtz_f16_f32 v149, v150, v151
ds_read_u16_d16_hi v147, v147
ds_read_u16 v145, v145
ds_read_b128 v[176:179], v250 offset:24576
v_lshrrev_b64 v[148:149], 2, v[148:149]
v_and_b32_sdwa v150, s47, v148 dst_sel:DWORD dst_unused:UNUSED_PAD src0_sel:DWORD src1_sel:WORD_1
v_and_b32_e64 v148, s47, v148
v_pk_mul_f16 v159, v158, v159
v_exp_f16_sdwa v157, v157 dst_sel:WORD_0 dst_unused:UNUSED_PRESERVE src0_sel:WORD_0
v_mfma_f32_32x32x16_bf16 v[160:175], v[64:67], v[184:187], v[160:175]
ds_read_u16_d16_hi v150, v150
ds_read_u16 v148, v148
v_fma_mix_f32 v226, v104, v104, v226 op_sel_hi:[1,1,0]
v_and_b32_sdwa v151, s47, v149 dst_sel:DWORD dst_unused:UNUSED_PAD src0_sel:DWORD src1_sel:WORD_1
s_waitcnt lgkmcnt(7)
v_fma_mix_f32 v226, v105, v105, v226 op_sel_hi:[1,1,0]
v_and_b32 v149, s47, v149
v_exp_f16_sdwa v159, v159 dst_sel:WORD_0 dst_unused:UNUSED_PRESERVE src0_sel:WORD_0
v_fma_mix_f32 v226, v106, v106, v226 op_sel_hi:[1,1,0]
v_cvt_pkrtz_f16_f32 v152, v152, v153
v_fma_mix_f32 v226, v107, v107, v226 op_sel_hi:[1,1,0]
v_cvt_pkrtz_f16_f32 v153, v154, v155
v_lshrrev_b64 v[152:153], 2, v[152:153]
ds_read_u16_d16_hi v151, v151
ds_read_u16 v149, v149
v_and_b32_sdwa v154, s47, v152 dst_sel:DWORD dst_unused:UNUSED_PAD src0_sel:DWORD src1_sel:WORD_1
v_and_b32_e64 v152, s47, v152
v_exp_f16_sdwa v157, v157 dst_sel:WORD_1 dst_unused:UNUSED_PRESERVE src0_sel:WORD_1
v_mfma_f32_32x32x16_bf16 v[112:127], v[184:187], v[88:91], v[112:127]
ds_read_u16_d16_hi v154, v154
ds_read_u16 v152, v152
ds_read_b128 v[180:183], v250 offset:25600
v_and_b32_sdwa v155, s47, v153 dst_sel:DWORD dst_unused:UNUSED_PAD src0_sel:DWORD src1_sel:WORD_1
v_and_b32_e64 v153, s47, v153
v_exp_f16_sdwa v159, v159 dst_sel:WORD_1 dst_unused:UNUSED_PRESERVE src0_sel:WORD_1
v_pk_add_f16 v157, v157, 1.0 op_sel_hi:[1,0]
v_mfma_f32_32x32x16_bf16 v[160:175], v[68:71], v[188:191], v[160:175]
ds_read_u16_d16_hi v155, v155
ds_read_u16 v153, v153
v_pk_add_f16 v159, v159, 1.0 op_sel_hi:[1,0]
v_rcp_f16_sdwa v157, v157 dst_sel:WORD_0 dst_unused:UNUSED_PRESERVE src0_sel:WORD_0
v_rcp_f16_sdwa v159, v159 dst_sel:WORD_0 dst_unused:UNUSED_PRESERVE src0_sel:WORD_0
v_mfma_f32_32x32x16_bf16 v[112:127], v[188:191], v[92:95], v[112:127]
ds_read_b128 v[184:187], v250 offset:26624
v_rcp_f16_sdwa v157, v157 dst_sel:WORD_1 dst_unused:UNUSED_PRESERVE src0_sel:WORD_1
v_rcp_f16_sdwa v159, v159 dst_sel:WORD_1 dst_unused:UNUSED_PRESERVE src0_sel:WORD_1
v_pk_mul_f16 v6, v156, v157
s_waitcnt lgkmcnt(8)
v_mfma_f32_32x32x16_bf16 v[128:143], v[48:51], v[176:179], 0
v_pk_mul_f16 v7, v158, v159
v_lshl_add_u64 v[0:1], v[144:145], 0, v[146:147]
v_cvt_pkrtz_f16_f32 v160, v160, v161
v_cvt_pkrtz_f16_f32 v161, v162, v163
v_lshrrev_b64 v[160:161], 2, v[160:161]
v_and_b32_sdwa v162, s47, v160 dst_sel:DWORD dst_unused:UNUSED_PAD src0_sel:DWORD src1_sel:WORD_1
v_and_b32 v160, s47, v160
v_cvt_pk_f16_f32 v172, v172, v173
v_cvt_pk_f16_f32 v174, v174, v175
v_mfma_f32_32x32x16_bf16 v[96:111], v[176:179], v[72:75], 0
ds_read_u16 v162, v162
ds_read_u16 v160, v160
v_pk_fma_f16 v173, v172, v172, s48
v_and_b32_sdwa v163, s47, v161 dst_sel:DWORD dst_unused:UNUSED_PAD src0_sel:DWORD src1_sel:WORD_1
v_and_b32 v161, s47, v161
v_pk_fma_f16 v175, v174, v174, s48
v_pk_mul_f16 v173, v172, v173
v_pk_mul_f16 v175, v174, v175
s_waitcnt lgkmcnt(6)
v_lshl_add_u64 v[4:5], v[148:149], 0, v[150:151]
v_cvt_pkrtz_f16_f32 v164, v164, v165
v_cvt_pkrtz_f16_f32 v165, v166, v167
ds_read_u16 v163, v163
ds_read_u16 v161, v161
ds_read_b128 v[188:191], v250 offset:27648
v_lshrrev_b64 v[164:165], 2, v[164:165]
v_and_b32_sdwa v166, s47, v164 dst_sel:DWORD dst_unused:UNUSED_PAD src0_sel:DWORD src1_sel:WORD_1
v_and_b32 v164, s47, v164
v_exp_f16_sdwa v173, v173 dst_sel:WORD_0 dst_unused:UNUSED_PRESERVE src0_sel:WORD_0
s_waitcnt lgkmcnt(7)
v_mfma_f32_32x32x16_bf16 v[128:143], v[52:55], v[180:183], v[128:143]
ds_read_u16 v166, v166
ds_read_u16 v164, v164
v_exp_f16_sdwa v175, v175 dst_sel:WORD_0 dst_unused:UNUSED_PRESERVE src0_sel:WORD_0
v_and_b32_sdwa v167, s47, v165 dst_sel:DWORD dst_unused:UNUSED_PAD src0_sel:DWORD src1_sel:WORD_1
v_and_b32 v165, s47, v165
v_exp_f16_sdwa v173, v173 dst_sel:WORD_1 dst_unused:UNUSED_PRESERVE src0_sel:WORD_1
s_waitcnt lgkmcnt(7)
v_lshl_add_u64 v[2:3], v[152:153], 0, v[154:155]
v_cvt_pkrtz_f16_f32 v168, v168, v169
v_cvt_pkrtz_f16_f32 v169, v170, v171
v_lshrrev_b64 v[168:169], 2, v[168:169]
v_and_b32_sdwa v170, s47, v168 dst_sel:DWORD dst_unused:UNUSED_PAD src0_sel:DWORD src1_sel:WORD_1
ds_read_u16 v167, v167
ds_read_u16 v165, v165
v_and_b32_e64 v168, s47, v168
v_mfma_f32_32x32x16_bf16 v[96:111], v[180:183], v[76:79], v[96:111]
ds_read_u16 v170, v170
ds_read_u16 v168, v168
v_exp_f16_sdwa v175, v175 dst_sel:WORD_1 dst_unused:UNUSED_PRESERVE src0_sel:WORD_1
v_and_b32_sdwa v171, s47, v169 dst_sel:DWORD dst_unused:UNUSED_PAD src0_sel:DWORD src1_sel:WORD_1
v_and_b32_e64 v169, s47, v169
v_mfma_f32_32x32x16_f16 v[144:159], v[0:3], v[216:219], 0
ds_read_b128 v[176:179], v250 offset:28672
ds_read_u16 v171, v171
ds_read_u16 v169, v169
v_pk_add_f16 v173, v173, 1.0 op_sel_hi:[1,0]
v_pk_add_f16 v175, v175, 1.0 op_sel_hi:[1,0]
v_rcp_f16_sdwa v173, v173 dst_sel:WORD_0 dst_unused:UNUSED_PRESERVE src0_sel:WORD_0
v_mfma_f32_32x32x16_f16 v[144:159], v[4:7], v[220:223], v[144:159]
v_permlane16_swap_b32 v0, v4
v_permlane16_swap_b32 v1, v5
v_permlane16_swap_b32 v2, v6
v_permlane16_swap_b32 v3, v7
v_rcp_f16_sdwa v175, v175 dst_sel:WORD_0 dst_unused:UNUSED_PRESERVE src0_sel:WORD_0
v_mfma_f32_32x32x16_bf16 v[128:143], v[56:59], v[184:187], v[128:143]
v_rcp_f16_sdwa v173, v173 dst_sel:WORD_1 dst_unused:UNUSED_PRESERVE src0_sel:WORD_1
v_rcp_f16_sdwa v175, v175 dst_sel:WORD_1 dst_unused:UNUSED_PRESERVE src0_sel:WORD_1
s_nop 3
v_fmac_f32 v226, v144, v144
v_mfma_f32_32x32x16_bf16 v[96:111], v[184:187], v[80:83], v[96:111]
ds_read_b128 v[180:183], v250 offset:29696
v_pk_mul_f16 v172, v172, v173
v_fmac_f32_e64 v226, v145, v145
v_pk_mul_f16 v174, v174, v175
v_fmac_f32 v226, v146, v146
v_fmac_f32 v226, v147, v147
v_fma_mix_f32 v227, v172, v172, v227 op_sel_hi:[1,1,0]
v_fmac_f32 v226, v148, v148
v_fmac_f32 v226, v149, v149
v_fma_mix_f32 v227, v174, v174, v227 op_sel_hi:[1,1,0]
s_waitcnt lgkmcnt(6)
v_mfma_f32_32x32x16_bf16 v[128:143], v[60:63], v[188:191], v[128:143]
v_fmac_f32 v226, v150, v150
v_fma_mix_f32 v227, v172, v172, v227 op_sel:[1,1,0] op_sel_hi:[1,1,0]
v_fmac_f32 v226, v151, v151
v_fmac_f32 v226, v152, v152
v_fma_mix_f32 v227, v174, v174, v227 op_sel:[1,1,0] op_sel_hi:[1,1,0]
v_fmac_f32_e64 v226, v153, v153
v_fma_mix_f32 v227, v160, v160, v227 op_sel_hi:[1,1,0]
v_fmac_f32_e64 v226, v154, v154
v_fma_mix_f32 v227, v161, v161, v227 op_sel_hi:[1,1,0]
v_cvt_pkrtz_f16_f32 v112, v112, v113
v_fma_mix_f32 v227, v162, v162, v227 op_sel_hi:[1,1,0]
v_cvt_pkrtz_f16_f32 v113, v114, v115
v_fma_mix_f32 v227, v163, v163, v227 op_sel_hi:[1,1,0]
v_lshrrev_b64 v[112:113], 2, v[112:113]
v_and_b32_sdwa v114, s47, v112 dst_sel:DWORD dst_unused:UNUSED_PAD src0_sel:DWORD src1_sel:WORD_1
v_and_b32_e64 v112, s47, v112
v_cvt_pk_f16_f32 v124, v124, v125
v_fmac_f32_e64 v226, v155, v155
v_cvt_pk_f16_f32 v126, v126, v127
v_fmac_f32 v226, v156, v156
v_fmac_f32 v226, v157, v157
v_mfma_f32_32x32x16_bf16 v[96:111], v[188:191], v[84:87], v[96:111]
ds_read_u16_d16_hi v114, v114
ds_read_u16 v112, v112
v_pk_fma_f16 v125, v124, v124, s48
v_fmac_f32_e64 v226, v158, v158
v_fma_mix_f32 v227, v164, v164, v227 op_sel_hi:[1,1,0]
v_and_b32_sdwa v115, s47, v113 dst_sel:DWORD dst_unused:UNUSED_PAD src0_sel:DWORD src1_sel:WORD_1
v_fma_mix_f32 v227, v165, v165, v227 op_sel_hi:[1,1,0]
v_and_b32 v113, s47, v113
v_fmac_f32 v226, v159, v159
v_pk_fma_f16 v127, v126, v126, s48
v_pk_mul_f16 v125, v124, v125
v_fma_mix_f32 v227, v166, v166, v227 op_sel_hi:[1,1,0]
v_cvt_pkrtz_f16_f32 v116, v116, v117
v_fma_mix_f32 v227, v167, v167, v227 op_sel_hi:[1,1,0]
ds_read_u16_d16_hi v115, v115
ds_read_u16 v113, v113
ds_read_b128 v[184:187], v250 offset:30720
v_cvt_pkrtz_f16_f32 v117, v118, v119
v_lshrrev_b64 v[116:117], 2, v[116:117]
v_and_b32_sdwa v118, s47, v116 dst_sel:DWORD dst_unused:UNUSED_PAD src0_sel:DWORD src1_sel:WORD_1
v_and_b32 v116, s47, v116
v_pk_mul_f16 v127, v126, v127
v_exp_f16_sdwa v125, v125 dst_sel:WORD_0 dst_unused:UNUSED_PRESERVE src0_sel:WORD_0
s_waitcnt lgkmcnt(5)
v_mfma_f32_32x32x16_bf16 v[128:143], v[64:67], v[176:179], v[128:143]
ds_read_u16_d16_hi v118, v118
ds_read_u16 v116, v116
v_fma_mix_f32 v227, v168, v168, v227 op_sel_hi:[1,1,0]
v_and_b32_sdwa v119, s47, v117 dst_sel:DWORD dst_unused:UNUSED_PAD src0_sel:DWORD src1_sel:WORD_1
v_fma_mix_f32 v227, v169, v169, v227 op_sel_hi:[1,1,0]
v_and_b32_e64 v117, s47, v117
v_exp_f16_sdwa v127, v127 dst_sel:WORD_0 dst_unused:UNUSED_PRESERVE src0_sel:WORD_0
v_fma_mix_f32 v227, v170, v170, v227 op_sel_hi:[1,1,0]
v_cvt_pkrtz_f16_f32 v120, v120, v121
v_fma_mix_f32 v227, v171, v171, v227 op_sel_hi:[1,1,0]
v_cvt_pkrtz_f16_f32 v121, v122, v123
v_lshrrev_b64 v[120:121], 2, v[120:121]
ds_read_u16_d16_hi v119, v119
ds_read_u16 v117, v117
v_and_b32_sdwa v122, s47, v120 dst_sel:DWORD dst_unused:UNUSED_PAD src0_sel:DWORD src1_sel:WORD_1
v_and_b32_e64 v120, s47, v120
v_exp_f16_sdwa v125, v125 dst_sel:WORD_1 dst_unused:UNUSED_PRESERVE src0_sel:WORD_1
v_mfma_f32_32x32x16_bf16 v[96:111], v[176:179], v[88:91], v[96:111]
ds_read_u16_d16_hi v122, v122
ds_read_u16 v120, v120
ds_read_b128 v[188:191], v250 offset:31744
v_and_b32_sdwa v123, s47, v121 dst_sel:DWORD dst_unused:UNUSED_PAD src0_sel:DWORD src1_sel:WORD_1
v_and_b32_e64 v121, s47, v121
v_exp_f16_sdwa v127, v127 dst_sel:WORD_1 dst_unused:UNUSED_PRESERVE src0_sel:WORD_1
v_pk_add_f16 v125, v125, 1.0 op_sel_hi:[1,0]
v_mfma_f32_32x32x16_bf16 v[128:143], v[68:71], v[180:183], v[128:143]
ds_read_u16_d16_hi v123, v123
ds_read_u16 v121, v121
v_pk_add_f16 v127, v127, 1.0 op_sel_hi:[1,0]
v_rcp_f16_sdwa v125, v125 dst_sel:WORD_0 dst_unused:UNUSED_PRESERVE src0_sel:WORD_0
v_rcp_f16_sdwa v127, v127 dst_sel:WORD_0 dst_unused:UNUSED_PRESERVE src0_sel:WORD_0
v_mfma_f32_32x32x16_bf16 v[96:111], v[180:183], v[92:95], v[96:111]
ds_read_b128 v[176:179], v250 offset:32768
v_rcp_f16_sdwa v125, v125 dst_sel:WORD_1 dst_unused:UNUSED_PRESERVE src0_sel:WORD_1
v_rcp_f16_sdwa v127, v127 dst_sel:WORD_1 dst_unused:UNUSED_PRESERVE src0_sel:WORD_1
s_cmp_lg_u32 s40, 0
s_cbranch_scc1 Lpix
v_and_b32 v244, 0x3ff, v250
buffer_load_dword v245, v244, s[28:31], 0 offen
buffer_load_dword v245, v244, s[24:27], 0 offen
v_mov_b32 v244, 0
Lpi:
buffer_load_dword v245, v244, s[36:39], 0 offen sc1
s_waitcnt vmcnt(0)
v_readfirstlane_b32 s43, v245
s_cmp_eq_u32 s76, 0
s_cbranch_scc1 Lpix
s_sub_u32 s76, s76, 1
s_cmp_lt_u32 s43, 256
s_cbranch_scc1 Lpi
Lpix:
s_waitcnt lgkmcnt(8)
v_mfma_f32_32x32x16_bf16 v[144:159], v[48:51], v[184:187], 0
v_pk_mul_f16 v14, v124, v125
v_pk_mul_f16 v15, v126, v127
v_lshl_add_u64 v[8:9], v[112:113], 0, v[114:115]
v_cvt_pkrtz_f16_f32 v128, v128, v129
v_cvt_pkrtz_f16_f32 v129, v130, v131
v_lshrrev_b64 v[128:129], 2, v[128:129]
v_and_b32_sdwa v130, s47, v128 dst_sel:DWORD dst_unused:UNUSED_PAD src0_sel:DWORD src1_sel:WORD_1
v_and_b32_e64 v128, s47, v128
v_cvt_pk_f16_f32 v140, v140, v141
v_cvt_pk_f16_f32 v142, v142, v143
v_mfma_f32_32x32x16_bf16 v[160:175], v[184:187], v[72:75], 0
ds_read_u16 v130, v130
ds_read_u16 v128, v128
v_pk_fma_f16 v141, v140, v140, s48
v_and_b32_sdwa v131, s47, v129 dst_sel:DWORD dst_unused:UNUSED_PAD src0_sel:DWORD src1_sel:WORD_1
v_and_b32 v129, s47, v129
v_pk_fma_f16 v143, v142, v142, s48
v_pk_mul_f16 v141, v140, v141
v_pk_mul_f16 v143, v142, v143
s_waitcnt lgkmcnt(6)
v_lshl_add_u64 v[12:13], v[116:117], 0, v[118:119]
v_cvt_pkrtz_f16_f32 v132, v132, v133
v_cvt_pkrtz_f16_f32 v133, v134, v135
ds_read_u16 v131, v131
ds_read_u16 v129, v129
ds_read_b128 v[180:183], v250 offset:33792
v_lshrrev_b64 v[132:133], 2, v[132:133]
v_and_b32_sdwa v134, s47, v132 dst_sel:DWORD dst_unused:UNUSED_PAD src0_sel:DWORD src1_sel:WORD_1
v_and_b32 v132, s47, v132
v_exp_f16_sdwa v141, v141 dst_sel:WORD_0 dst_unused:UNUSED_PRESERVE src0_sel:WORD_0
s_waitcnt lgkmcnt(7)
v_mfma_f32_32x32x16_bf16 v[144:159], v[52:55], v[188:191], v[144:159]
ds_read_u16 v134, v134
ds_read_u16 v132, v132
v_exp_f16_sdwa v143, v143 dst_sel:WORD_0 dst_unused:UNUSED_PRESERVE src0_sel:WORD_0
v_and_b32_sdwa v135, s47, v133 dst_sel:DWORD dst_unused:UNUSED_PAD src0_sel:DWORD src1_sel:WORD_1
v_and_b32 v133, s47, v133
v_exp_f16_sdwa v141, v141 dst_sel:WORD_1 dst_unused:UNUSED_PRESERVE src0_sel:WORD_1
s_waitcnt lgkmcnt(7)
v_lshl_add_u64 v[10:11], v[120:121], 0, v[122:123]
v_cvt_pkrtz_f16_f32 v136, v136, v137
v_cvt_pkrtz_f16_f32 v137, v138, v139
v_lshrrev_b64 v[136:137], 2, v[136:137]
v_and_b32_sdwa v138, s47, v136 dst_sel:DWORD dst_unused:UNUSED_PAD src0_sel:DWORD src1_sel:WORD_1
ds_read_u16 v135, v135
ds_read_u16 v133, v133
v_and_b32_e64 v136, s47, v136
v_mfma_f32_32x32x16_bf16 v[160:175], v[188:191], v[76:79], v[160:175]
ds_read_u16 v138, v138
ds_read_u16 v136, v136
v_exp_f16_sdwa v143, v143 dst_sel:WORD_1 dst_unused:UNUSED_PRESERVE src0_sel:WORD_1
v_and_b32_sdwa v139, s47, v137 dst_sel:DWORD dst_unused:UNUSED_PAD src0_sel:DWORD src1_sel:WORD_1
v_and_b32_e64 v137, s47, v137
v_mfma_f32_32x32x16_f16 v[112:127], v[8:11], v[216:219], 0
ds_read_b128 v[184:187], v250 offset:34816
ds_read_u16 v139, v139
ds_read_u16 v137, v137
v_pk_add_f16 v141, v141, 1.0 op_sel_hi:[1,0]
v_pk_add_f16 v143, v143, 1.0 op_sel_hi:[1,0]
v_rcp_f16_sdwa v141, v141 dst_sel:WORD_0 dst_unused:UNUSED_PRESERVE src0_sel:WORD_0
v_mfma_f32_32x32x16_f16 v[112:127], v[12:15], v[220:223], v[112:127]
v_permlane16_swap_b32 v8, v12
v_permlane16_swap_b32 v9, v13
v_permlane16_swap_b32 v10, v14
v_permlane16_swap_b32 v11, v15
v_rcp_f16_sdwa v143, v143 dst_sel:WORD_0 dst_unused:UNUSED_PRESERVE src0_sel:WORD_0
v_mfma_f32_32x32x16_bf16 v[144:159], v[56:59], v[176:179], v[144:159]
v_rcp_f16_sdwa v141, v141 dst_sel:WORD_1 dst_unused:UNUSED_PRESERVE src0_sel:WORD_1
v_rcp_f16_sdwa v143, v143 dst_sel:WORD_1 dst_unused:UNUSED_PRESERVE src0_sel:WORD_1
s_nop 3
v_fmac_f32 v227, v112, v112
v_mfma_f32_32x32x16_bf16 v[160:175], v[176:179], v[80:83], v[160:175]
ds_read_b128 v[188:191], v250 offset:35840
v_pk_mul_f16 v140, v140, v141
v_fmac_f32_e64 v227, v113, v113
v_pk_mul_f16 v142, v142, v143
v_fmac_f32 v227, v114, v114
v_fmac_f32 v227, v115, v115
v_fma_mix_f32 v228, v140, v140, v228 op_sel_hi:[1,1,0]
v_fmac_f32 v227, v116, v116
v_fmac_f32 v227, v117, v117
v_fma_mix_f32 v228, v142, v142, v228 op_sel_hi:[1,1,0]
s_waitcnt lgkmcnt(6)
v_mfma_f32_32x32x16_bf16 v[144:159], v[60:63], v[180:183], v[144:159]
v_fmac_f32 v227, v118, v118
v_fma_mix_f32 v228, v140, v140, v228 op_sel:[1,1,0] op_sel_hi:[1,1,0]
v_fmac_f32 v227, v119, v119
v_fmac_f32 v227, v120, v120
v_fma_mix_f32 v228, v142, v142, v228 op_sel:[1,1,0] op_sel_hi:[1,1,0]
v_fmac_f32_e64 v227, v121, v121
v_fma_mix_f32 v228, v128, v128, v228 op_sel_hi:[1,1,0]
v_fmac_f32_e64 v227, v122, v122
v_fma_mix_f32 v228, v129, v129, v228 op_sel_hi:[1,1,0]
v_cvt_pkrtz_f16_f32 v96, v96, v97
v_fma_mix_f32 v228, v130, v130, v228 op_sel_hi:[1,1,0]
v_cvt_pkrtz_f16_f32 v97, v98, v99
v_fma_mix_f32 v228, v131, v131, v228 op_sel_hi:[1,1,0]
v_lshrrev_b64 v[96:97], 2, v[96:97]
v_and_b32_sdwa v98, s47, v96 dst_sel:DWORD dst_unused:UNUSED_PAD src0_sel:DWORD src1_sel:WORD_1
v_and_b32_e64 v96, s47, v96
v_cvt_pk_f16_f32 v108, v108, v109
v_fmac_f32_e64 v227, v123, v123
v_cvt_pk_f16_f32 v110, v110, v111
v_fmac_f32 v227, v124, v124
v_fmac_f32 v227, v125, v125
v_mfma_f32_32x32x16_bf16 v[160:175], v[180:183], v[84:87], v[160:175]
ds_read_u16_d16_hi v98, v98
ds_read_u16 v96, v96
v_pk_fma_f16 v109, v108, v108, s48
v_fmac_f32_e64 v227, v126, v126
v_fma_mix_f32 v228, v132, v132, v228 op_sel_hi:[1,1,0]
v_and_b32_sdwa v99, s47, v97 dst_sel:DWORD dst_unused:UNUSED_PAD src0_sel:DWORD src1_sel:WORD_1
v_fma_mix_f32 v228, v133, v133, v228 op_sel_hi:[1,1,0]
v_and_b32 v97, s47, v97
v_fmac_f32 v227, v127, v127
v_pk_fma_f16 v111, v110, v110, s48
v_pk_mul_f16 v109, v108, v109
v_fma_mix_f32 v228, v134, v134, v228 op_sel_hi:[1,1,0]
v_cvt_pkrtz_f16_f32 v100, v100, v101
v_fma_mix_f32 v228, v135, v135, v228 op_sel_hi:[1,1,0]
ds_read_u16_d16_hi v99, v99
ds_read_u16 v97, v97
ds_read_b128 v[176:179], v250 offset:36864
v_cvt_pkrtz_f16_f32 v101, v102, v103
v_lshrrev_b64 v[100:101], 2, v[100:101]
v_and_b32_sdwa v102, s47, v100 dst_sel:DWORD dst_unused:UNUSED_PAD src0_sel:DWORD src1_sel:WORD_1
v_and_b32 v100, s47, v100
v_pk_mul_f16 v111, v110, v111
v_exp_f16_sdwa v109, v109 dst_sel:WORD_0 dst_unused:UNUSED_PRESERVE src0_sel:WORD_0
s_waitcnt lgkmcnt(5)
v_mfma_f32_32x32x16_bf16 v[144:159], v[64:67], v[184:187], v[144:159]
ds_read_u16_d16_hi v102, v102
ds_read_u16 v100, v100
v_fma_mix_f32 v228, v136, v136, v228 op_sel_hi:[1,1,0]
v_and_b32_sdwa v103, s47, v101 dst_sel:DWORD dst_unused:UNUSED_PAD src0_sel:DWORD src1_sel:WORD_1
v_fma_mix_f32 v228, v137, v137, v228 op_sel_hi:[1,1,0]
v_and_b32_e64 v101, s47, v101
v_exp_f16_sdwa v111, v111 dst_sel:WORD_0 dst_unused:UNUSED_PRESERVE src0_sel:WORD_0
v_fma_mix_f32 v228, v138, v138, v228 op_sel_hi:[1,1,0]
v_cvt_pkrtz_f16_f32 v104, v104, v105
v_fma_mix_f32 v228, v139, v139, v228 op_sel_hi:[1,1,0]
v_cvt_pkrtz_f16_f32 v105, v106, v107
v_lshrrev_b64 v[104:105], 2, v[104:105]
ds_read_u16_d16_hi v103, v103
ds_read_u16 v101, v101
v_and_b32_sdwa v106, s47, v104 dst_sel:DWORD dst_unused:UNUSED_PAD src0_sel:DWORD src1_sel:WORD_1
v_and_b32_e64 v104, s47, v104
v_exp_f16_sdwa v109, v109 dst_sel:WORD_1 dst_unused:UNUSED_PRESERVE src0_sel:WORD_1
v_mfma_f32_32x32x16_bf16 v[160:175], v[184:187], v[88:91], v[160:175]
ds_read_u16_d16_hi v106, v106
ds_read_u16 v104, v104
ds_read_b128 v[180:183], v250 offset:37888
v_and_b32_sdwa v107, s47, v105 dst_sel:DWORD dst_unused:UNUSED_PAD src0_sel:DWORD src1_sel:WORD_1
v_and_b32_e64 v105, s47, v105
v_exp_f16_sdwa v111, v111 dst_sel:WORD_1 dst_unused:UNUSED_PRESERVE src0_sel:WORD_1
v_pk_add_f16 v109, v109, 1.0 op_sel_hi:[1,0]
v_mfma_f32_32x32x16_bf16 v[144:159], v[68:71], v[188:191], v[144:159]
ds_read_u16_d16_hi v107, v107
ds_read_u16 v105, v105
v_pk_add_f16 v111, v111, 1.0 op_sel_hi:[1,0]
v_rcp_f16_sdwa v109, v109 dst_sel:WORD_0 dst_unused:UNUSED_PRESERVE src0_sel:WORD_0
v_rcp_f16_sdwa v111, v111 dst_sel:WORD_0 dst_unused:UNUSED_PRESERVE src0_sel:WORD_0
v_mfma_f32_32x32x16_bf16 v[160:175], v[188:191], v[92:95], v[160:175]
ds_read_b128 v[184:187], v250 offset:38912
v_rcp_f16_sdwa v109, v109 dst_sel:WORD_1 dst_unused:UNUSED_PRESERVE src0_sel:WORD_1
v_rcp_f16_sdwa v111, v111 dst_sel:WORD_1 dst_unused:UNUSED_PRESERVE src0_sel:WORD_1
v_pk_mul_f16 v22, v108, v109
s_waitcnt lgkmcnt(8)
v_mfma_f32_32x32x16_bf16 v[112:127], v[48:51], v[176:179], 0
v_pk_mul_f16 v23, v110, v111
v_lshl_add_u64 v[16:17], v[96:97], 0, v[98:99]
v_cvt_pkrtz_f16_f32 v144, v144, v145
v_cvt_pkrtz_f16_f32 v145, v146, v147
v_lshrrev_b64 v[144:145], 2, v[144:145]
v_and_b32_sdwa v146, s47, v144 dst_sel:DWORD dst_unused:UNUSED_PAD src0_sel:DWORD src1_sel:WORD_1
v_and_b32 v144, s47, v144
v_cvt_pk_f16_f32 v156, v156, v157
v_cvt_pk_f16_f32 v158, v158, v159
v_mfma_f32_32x32x16_bf16 v[128:143], v[176:179], v[72:75], 0
ds_read_u16 v146, v146
ds_read_u16 v144, v144
v_pk_fma_f16 v157, v156, v156, s48
v_and_b32_sdwa v147, s47, v145 dst_sel:DWORD dst_unused:UNUSED_PAD src0_sel:DWORD src1_sel:WORD_1
v_and_b32 v145, s47, v145
v_pk_fma_f16 v159, v158, v158, s48
v_pk_mul_f16 v157, v156, v157
v_pk_mul_f16 v159, v158, v159
s_waitcnt lgkmcnt(6)
v_lshl_add_u64 v[20:21], v[100:101], 0, v[102:103]
v_cvt_pkrtz_f16_f32 v148, v148, v149
v_cvt_pkrtz_f16_f32 v149, v150, v151
ds_read_u16 v147, v147
ds_read_u16 v145, v145
ds_read_b128 v[188:191], v250 offset:39936
v_lshrrev_b64 v[148:149], 2, v[148:149]
v_and_b32_sdwa v150, s47, v148 dst_sel:DWORD dst_unused:UNUSED_PAD src0_sel:DWORD src1_sel:WORD_1
v_and_b32 v148, s47, v148
v_exp_f16_sdwa v157, v157 dst_sel:WORD_0 dst_unused:UNUSED_PRESERVE src0_sel:WORD_0
s_waitcnt lgkmcnt(7)
v_mfma_f32_32x32x16_bf16 v[112:127], v[52:55], v[180:183], v[112:127]
ds_read_u16 v150, v150
ds_read_u16 v148, v148
v_exp_f16_sdwa v159, v159 dst_sel:WORD_0 dst_unused:UNUSED_PRESERVE src0_sel:WORD_0
v_and_b32_sdwa v151, s47, v149 dst_sel:DWORD dst_unused:UNUSED_PAD src0_sel:DWORD src1_sel:WORD_1
v_and_b32 v149, s47, v149
v_exp_f16_sdwa v157, v157 dst_sel:WORD_1 dst_unused:UNUSED_PRESERVE src0_sel:WORD_1
s_waitcnt lgkmcnt(7)
v_lshl_add_u64 v[18:19], v[104:105], 0, v[106:107]
v_cvt_pkrtz_f16_f32 v152, v152, v153
v_cvt_pkrtz_f16_f32 v153, v154, v155
v_lshrrev_b64 v[152:153], 2, v[152:153]
v_and_b32_sdwa v154, s47, v152 dst_sel:DWORD dst_unused:UNUSED_PAD src0_sel:DWORD src1_sel:WORD_1
ds_read_u16 v151, v151
ds_read_u16 v149, v149
v_and_b32_e64 v152, s47, v152
v_mfma_f32_32x32x16_bf16 v[128:143], v[180:183], v[76:79], v[128:143]
ds_read_u16 v154, v154
ds_read_u16 v152, v152
v_exp_f16_sdwa v159, v159 dst_sel:WORD_1 dst_unused:UNUSED_PRESERVE src0_sel:WORD_1
v_and_b32_sdwa v155, s47, v153 dst_sel:DWORD dst_unused:UNUSED_PAD src0_sel:DWORD src1_sel:WORD_1
v_and_b32_e64 v153, s47, v153
v_mfma_f32_32x32x16_f16 v[96:111], v[16:19], v[216:219], 0
ds_read_b128 v[176:179], v250 offset:40960
ds_read_u16 v155, v155
ds_read_u16 v153, v153
v_pk_add_f16 v157, v157, 1.0 op_sel_hi:[1,0]
v_pk_add_f16 v159, v159, 1.0 op_sel_hi:[1,0]
v_rcp_f16_sdwa v157, v157 dst_sel:WORD_0 dst_unused:UNUSED_PRESERVE src0_sel:WORD_0
v_mfma_f32_32x32x16_f16 v[96:111], v[20:23], v[220:223], v[96:111]
v_permlane16_swap_b32 v16, v20
v_permlane16_swap_b32 v17, v21
v_permlane16_swap_b32 v18, v22
v_permlane16_swap_b32 v19, v23
v_rcp_f16_sdwa v159, v159 dst_sel:WORD_0 dst_unused:UNUSED_PRESERVE src0_sel:WORD_0
v_mfma_f32_32x32x16_bf16 v[112:127], v[56:59], v[184:187], v[112:127]
v_rcp_f16_sdwa v157, v157 dst_sel:WORD_1 dst_unused:UNUSED_PRESERVE src0_sel:WORD_1
v_rcp_f16_sdwa v159, v159 dst_sel:WORD_1 dst_unused:UNUSED_PRESERVE src0_sel:WORD_1
s_nop 3
v_fmac_f32 v228, v96, v96
v_mfma_f32_32x32x16_bf16 v[128:143], v[184:187], v[80:83], v[128:143]
ds_read_b128 v[180:183], v250 offset:41984
v_pk_mul_f16 v156, v156, v157
v_fmac_f32_e64 v228, v97, v97
v_pk_mul_f16 v158, v158, v159
v_fmac_f32 v228, v98, v98
v_fmac_f32 v228, v99, v99
v_fma_mix_f32 v229, v156, v156, v229 op_sel_hi:[1,1,0]
v_fmac_f32 v228, v100, v100
v_fmac_f32 v228, v101, v101
v_fma_mix_f32 v229, v158, v158, v229 op_sel_hi:[1,1,0]
s_waitcnt lgkmcnt(6)
v_mfma_f32_32x32x16_bf16 v[112:127], v[60:63], v[188:191], v[112:127]
v_fmac_f32 v228, v102, v102
v_fma_mix_f32 v229, v156, v156, v229 op_sel:[1,1,0] op_sel_hi:[1,1,0]
v_fmac_f32 v228, v103, v103
v_fmac_f32 v228, v104, v104
v_fma_mix_f32 v229, v158, v158, v229 op_sel:[1,1,0] op_sel_hi:[1,1,0]
v_fmac_f32_e64 v228, v105, v105
v_fma_mix_f32 v229, v144, v144, v229 op_sel_hi:[1,1,0]
v_fmac_f32_e64 v228, v106, v106
v_fma_mix_f32 v229, v145, v145, v229 op_sel_hi:[1,1,0]
v_cvt_pkrtz_f16_f32 v160, v160, v161
v_fma_mix_f32 v229, v146, v146, v229 op_sel_hi:[1,1,0]
v_cvt_pkrtz_f16_f32 v161, v162, v163
v_fma_mix_f32 v229, v147, v147, v229 op_sel_hi:[1,1,0]
v_lshrrev_b64 v[160:161], 2, v[160:161]
v_and_b32_sdwa v162, s47, v160 dst_sel:DWORD dst_unused:UNUSED_PAD src0_sel:DWORD src1_sel:WORD_1
v_and_b32_e64 v160, s47, v160
v_cvt_pk_f16_f32 v172, v172, v173
v_fmac_f32_e64 v228, v107, v107
v_cvt_pk_f16_f32 v174, v174, v175
v_fmac_f32 v228, v108, v108
v_fmac_f32 v228, v109, v109
v_mfma_f32_32x32x16_bf16 v[128:143], v[188:191], v[84:87], v[128:143]
ds_read_u16_d16_hi v162, v162
ds_read_u16 v160, v160
v_pk_fma_f16 v173, v172, v172, s48
v_fmac_f32_e64 v228, v110, v110
v_fma_mix_f32 v229, v148, v148, v229 op_sel_hi:[1,1,0]
v_and_b32_sdwa v163, s47, v161 dst_sel:DWORD dst_unused:UNUSED_PAD src0_sel:DWORD src1_sel:WORD_1
v_fma_mix_f32 v229, v149, v149, v229 op_sel_hi:[1,1,0]
v_and_b32 v161, s47, v161
v_fmac_f32 v228, v111, v111
v_pk_fma_f16 v175, v174, v174, s48
v_pk_mul_f16 v173, v172, v173
v_fma_mix_f32 v229, v150, v150, v229 op_sel_hi:[1,1,0]
v_cvt_pkrtz_f16_f32 v164, v164, v165
v_fma_mix_f32 v229, v151, v151, v229 op_sel_hi:[1,1,0]
ds_read_u16_d16_hi v163, v163
ds_read_u16 v161, v161
ds_read_b128 v[184:187], v250 offset:43008
v_cvt_pkrtz_f16_f32 v165, v166, v167
v_lshrrev_b64 v[164:165], 2, v[164:165]
v_and_b32_sdwa v166, s47, v164 dst_sel:DWORD dst_unused:UNUSED_PAD src0_sel:DWORD src1_sel:WORD_1
v_and_b32 v164, s47, v164
v_pk_mul_f16 v175, v174, v175
v_exp_f16_sdwa v173, v173 dst_sel:WORD_0 dst_unused:UNUSED_PRESERVE src0_sel:WORD_0
s_waitcnt lgkmcnt(5)
v_mfma_f32_32x32x16_bf16 v[112:127], v[64:67], v[176:179], v[112:127]
ds_read_u16_d16_hi v166, v166
ds_read_u16 v164, v164
v_fma_mix_f32 v229, v152, v152, v229 op_sel_hi:[1,1,0]
v_and_b32_sdwa v167, s47, v165 dst_sel:DWORD dst_unused:UNUSED_PAD src0_sel:DWORD src1_sel:WORD_1
v_fma_mix_f32 v229, v153, v153, v229 op_sel_hi:[1,1,0]
v_and_b32_e64 v165, s47, v165
v_exp_f16_sdwa v175, v175 dst_sel:WORD_0 dst_unused:UNUSED_PRESERVE src0_sel:WORD_0
v_fma_mix_f32 v229, v154, v154, v229 op_sel_hi:[1,1,0]
v_cvt_pkrtz_f16_f32 v168, v168, v169
v_fma_mix_f32 v229, v155, v155, v229 op_sel_hi:[1,1,0]
v_cvt_pkrtz_f16_f32 v169, v170, v171
v_lshrrev_b64 v[168:169], 2, v[168:169]
ds_read_u16_d16_hi v167, v167
ds_read_u16 v165, v165
v_and_b32_sdwa v170, s47, v168 dst_sel:DWORD dst_unused:UNUSED_PAD src0_sel:DWORD src1_sel:WORD_1
v_and_b32_e64 v168, s47, v168
v_exp_f16_sdwa v173, v173 dst_sel:WORD_1 dst_unused:UNUSED_PRESERVE src0_sel:WORD_1
v_mfma_f32_32x32x16_bf16 v[128:143], v[176:179], v[88:91], v[128:143]
ds_read_u16_d16_hi v170, v170
ds_read_u16 v168, v168
ds_read_b128 v[188:191], v250 offset:44032
v_and_b32_sdwa v171, s47, v169 dst_sel:DWORD dst_unused:UNUSED_PAD src0_sel:DWORD src1_sel:WORD_1
v_and_b32_e64 v169, s47, v169
v_exp_f16_sdwa v175, v175 dst_sel:WORD_1 dst_unused:UNUSED_PRESERVE src0_sel:WORD_1
v_pk_add_f16 v173, v173, 1.0 op_sel_hi:[1,0]
v_mfma_f32_32x32x16_bf16 v[112:127], v[68:71], v[180:183], v[112:127]
ds_read_u16_d16_hi v171, v171
ds_read_u16 v169, v169
v_pk_add_f16 v175, v175, 1.0 op_sel_hi:[1,0]
v_rcp_f16_sdwa v173, v173 dst_sel:WORD_0 dst_unused:UNUSED_PRESERVE src0_sel:WORD_0
v_rcp_f16_sdwa v175, v175 dst_sel:WORD_0 dst_unused:UNUSED_PRESERVE src0_sel:WORD_0
v_mfma_f32_32x32x16_bf16 v[128:143], v[180:183], v[92:95], v[128:143]
ds_read_b128 v[176:179], v250 offset:45056
v_rcp_f16_sdwa v173, v173 dst_sel:WORD_1 dst_unused:UNUSED_PRESERVE src0_sel:WORD_1
v_rcp_f16_sdwa v175, v175 dst_sel:WORD_1 dst_unused:UNUSED_PRESERVE src0_sel:WORD_1
v_pk_mul_f16 v198, v172, v173
s_waitcnt lgkmcnt(8)
v_mfma_f32_32x32x16_bf16 v[96:111], v[48:51], v[184:187], 0
v_pk_mul_f16 v199, v174, v175
v_lshl_add_u64 v[192:193], v[160:161], 0, v[162:163]
v_cvt_pkrtz_f16_f32 v112, v112, v113
v_cvt_pkrtz_f16_f32 v113, v114, v115
v_lshrrev_b64 v[112:113], 2, v[112:113]
v_and_b32_sdwa v114, s47, v112 dst_sel:DWORD dst_unused:UNUSED_PAD src0_sel:DWORD src1_sel:WORD_1
v_and_b32 v112, s47, v112
v_cvt_pk_f16_f32 v124, v124, v125
v_cvt_pk_f16_f32 v126, v126, v127
v_mfma_f32_32x32x16_bf16 v[144:159], v[184:187], v[72:75], 0
ds_read_u16 v114, v114
ds_read_u16 v112, v112
v_pk_fma_f16 v125, v124, v124, s48
v_and_b32_sdwa v115, s47, v113 dst_sel:DWORD dst_unused:UNUSED_PAD src0_sel:DWORD src1_sel:WORD_1
v_and_b32 v113, s47, v113
v_pk_fma_f16 v127, v126, v126, s48
v_pk_mul_f16 v125, v124, v125
v_pk_mul_f16 v127, v126, v127
s_waitcnt lgkmcnt(6)
v_lshl_add_u64 v[196:197], v[164:165], 0, v[166:167]
v_cvt_pkrtz_f16_f32 v116, v116, v117
v_cvt_pkrtz_f16_f32 v117, v118, v119
ds_read_u16 v115, v115
ds_read_u16 v113, v113
ds_read_b128 v[180:183], v250 offset:46080
v_lshrrev_b64 v[116:117], 2, v[116:117]
v_and_b32_sdwa v118, s47, v116 dst_sel:DWORD dst_unused:UNUSED_PAD src0_sel:DWORD src1_sel:WORD_1
v_and_b32 v116, s47, v116
v_exp_f16_sdwa v125, v125 dst_sel:WORD_0 dst_unused:UNUSED_PRESERVE src0_sel:WORD_0
s_waitcnt lgkmcnt(7)
v_mfma_f32_32x32x16_bf16 v[96:111], v[52:55], v[188:191], v[96:111]
ds_read_u16 v118, v118
ds_read_u16 v116, v116
v_exp_f16_sdwa v127, v127 dst_sel:WORD_0 dst_unused:UNUSED_PRESERVE src0_sel:WORD_0
v_and_b32_sdwa v119, s47, v117 dst_sel:DWORD dst_unused:UNUSED_PAD src0_sel:DWORD src1_sel:WORD_1
v_and_b32 v117, s47, v117
v_exp_f16_sdwa v125, v125 dst_sel:WORD_1 dst_unused:UNUSED_PRESERVE src0_sel:WORD_1
s_waitcnt lgkmcnt(7)
v_lshl_add_u64 v[194:195], v[168:169], 0, v[170:171]
v_cvt_pkrtz_f16_f32 v120, v120, v121
v_cvt_pkrtz_f16_f32 v121, v122, v123
v_lshrrev_b64 v[120:121], 2, v[120:121]
v_and_b32_sdwa v122, s47, v120 dst_sel:DWORD dst_unused:UNUSED_PAD src0_sel:DWORD src1_sel:WORD_1
ds_read_u16 v119, v119
ds_read_u16 v117, v117
v_and_b32_e64 v120, s47, v120
v_mfma_f32_32x32x16_bf16 v[144:159], v[188:191], v[76:79], v[144:159]
ds_read_u16 v122, v122
ds_read_u16 v120, v120
v_exp_f16_sdwa v127, v127 dst_sel:WORD_1 dst_unused:UNUSED_PRESERVE src0_sel:WORD_1
v_and_b32_sdwa v123, s47, v121 dst_sel:DWORD dst_unused:UNUSED_PAD src0_sel:DWORD src1_sel:WORD_1
v_and_b32_e64 v121, s47, v121
v_mfma_f32_32x32x16_f16 v[160:175], v[192:195], v[216:219], 0
ds_read_b128 v[184:187], v250 offset:47104
ds_read_u16 v123, v123
ds_read_u16 v121, v121
v_pk_add_f16 v125, v125, 1.0 op_sel_hi:[1,0]
v_pk_add_f16 v127, v127, 1.0 op_sel_hi:[1,0]
v_rcp_f16_sdwa v125, v125 dst_sel:WORD_0 dst_unused:UNUSED_PRESERVE src0_sel:WORD_0
v_mfma_f32_32x32x16_f16 v[160:175], v[196:199], v[220:223], v[160:175]
v_permlane16_swap_b32 v192, v196
v_permlane16_swap_b32 v193, v197
v_permlane16_swap_b32 v194, v198
v_permlane16_swap_b32 v195, v199
v_rcp_f16_sdwa v127, v127 dst_sel:WORD_0 dst_unused:UNUSED_PRESERVE src0_sel:WORD_0
v_mfma_f32_32x32x16_bf16 v[96:111], v[56:59], v[176:179], v[96:111]
v_rcp_f16_sdwa v125, v125 dst_sel:WORD_1 dst_unused:UNUSED_PRESERVE src0_sel:WORD_1
v_rcp_f16_sdwa v127, v127 dst_sel:WORD_1 dst_unused:UNUSED_PRESERVE src0_sel:WORD_1
s_nop 3
v_fmac_f32 v229, v160, v160
v_mfma_f32_32x32x16_bf16 v[144:159], v[176:179], v[80:83], v[144:159]
ds_read_b128 v[188:191], v250 offset:48128
v_pk_mul_f16 v124, v124, v125
v_fmac_f32_e64 v229, v161, v161
v_pk_mul_f16 v126, v126, v127
v_fmac_f32 v229, v162, v162
v_fmac_f32 v229, v163, v163
v_fma_mix_f32 v230, v124, v124, v230 op_sel_hi:[1,1,0]
v_fmac_f32 v229, v164, v164
v_fmac_f32 v229, v165, v165
v_fma_mix_f32 v230, v126, v126, v230 op_sel_hi:[1,1,0]
s_waitcnt lgkmcnt(6)
v_mfma_f32_32x32x16_bf16 v[96:111], v[60:63], v[180:183], v[96:111]
v_fmac_f32 v229, v166, v166
v_fma_mix_f32 v230, v124, v124, v230 op_sel:[1,1,0] op_sel_hi:[1,1,0]
v_fmac_f32 v229, v167, v167
v_fmac_f32 v229, v168, v168
v_fma_mix_f32 v230, v126, v126, v230 op_sel:[1,1,0] op_sel_hi:[1,1,0]
v_fmac_f32_e64 v229, v169, v169
v_fma_mix_f32 v230, v112, v112, v230 op_sel_hi:[1,1,0]
v_fmac_f32_e64 v229, v170, v170
v_fma_mix_f32 v230, v113, v113, v230 op_sel_hi:[1,1,0]
v_cvt_pkrtz_f16_f32 v128, v128, v129
v_fma_mix_f32 v230, v114, v114, v230 op_sel_hi:[1,1,0]
v_cvt_pkrtz_f16_f32 v129, v130, v131
v_fma_mix_f32 v230, v115, v115, v230 op_sel_hi:[1,1,0]
v_lshrrev_b64 v[128:129], 2, v[128:129]
v_and_b32_sdwa v130, s47, v128 dst_sel:DWORD dst_unused:UNUSED_PAD src0_sel:DWORD src1_sel:WORD_1
v_and_b32_e64 v128, s47, v128
v_cvt_pk_f16_f32 v140, v140, v141
v_fmac_f32_e64 v229, v171, v171
v_cvt_pk_f16_f32 v142, v142, v143
v_fmac_f32 v229, v172, v172
v_fmac_f32 v229, v173, v173
v_mfma_f32_32x32x16_bf16 v[144:159], v[180:183], v[84:87], v[144:159]
ds_read_u16_d16_hi v130, v130
ds_read_u16 v128, v128
v_pk_fma_f16 v141, v140, v140, s48
v_fmac_f32_e64 v229, v174, v174
v_fma_mix_f32 v230, v116, v116, v230 op_sel_hi:[1,1,0]
v_and_b32_sdwa v131, s47, v129 dst_sel:DWORD dst_unused:UNUSED_PAD src0_sel:DWORD src1_sel:WORD_1
v_fma_mix_f32 v230, v117, v117, v230 op_sel_hi:[1,1,0]
v_and_b32 v129, s47, v129
v_fmac_f32 v229, v175, v175
v_pk_fma_f16 v143, v142, v142, s48
v_pk_mul_f16 v141, v140, v141
v_fma_mix_f32 v230, v118, v118, v230 op_sel_hi:[1,1,0]
v_cvt_pkrtz_f16_f32 v132, v132, v133
v_fma_mix_f32 v230, v119, v119, v230 op_sel_hi:[1,1,0]
ds_read_u16_d16_hi v131, v131
ds_read_u16 v129, v129
ds_read_b128 v[176:179], v250 offset:49152
v_cvt_pkrtz_f16_f32 v133, v134, v135
v_lshrrev_b64 v[132:133], 2, v[132:133]
v_and_b32_sdwa v134, s47, v132 dst_sel:DWORD dst_unused:UNUSED_PAD src0_sel:DWORD src1_sel:WORD_1
v_and_b32 v132, s47, v132
v_pk_mul_f16 v143, v142, v143
v_exp_f16_sdwa v141, v141 dst_sel:WORD_0 dst_unused:UNUSED_PRESERVE src0_sel:WORD_0
s_waitcnt lgkmcnt(5)
v_mfma_f32_32x32x16_bf16 v[96:111], v[64:67], v[184:187], v[96:111]
ds_read_u16_d16_hi v134, v134
ds_read_u16 v132, v132
v_fma_mix_f32 v230, v120, v120, v230 op_sel_hi:[1,1,0]
v_and_b32_sdwa v135, s47, v133 dst_sel:DWORD dst_unused:UNUSED_PAD src0_sel:DWORD src1_sel:WORD_1
v_fma_mix_f32 v230, v121, v121, v230 op_sel_hi:[1,1,0]
v_and_b32_e64 v133, s47, v133
v_exp_f16_sdwa v143, v143 dst_sel:WORD_0 dst_unused:UNUSED_PRESERVE src0_sel:WORD_0
v_fma_mix_f32 v230, v122, v122, v230 op_sel_hi:[1,1,0]
v_cvt_pkrtz_f16_f32 v136, v136, v137
v_fma_mix_f32 v230, v123, v123, v230 op_sel_hi:[1,1,0]
v_cvt_pkrtz_f16_f32 v137, v138, v139
v_lshrrev_b64 v[136:137], 2, v[136:137]
ds_read_u16_d16_hi v135, v135
ds_read_u16 v133, v133
v_and_b32_sdwa v138, s47, v136 dst_sel:DWORD dst_unused:UNUSED_PAD src0_sel:DWORD src1_sel:WORD_1
v_and_b32_e64 v136, s47, v136
v_exp_f16_sdwa v141, v141 dst_sel:WORD_1 dst_unused:UNUSED_PRESERVE src0_sel:WORD_1
v_mfma_f32_32x32x16_bf16 v[144:159], v[184:187], v[88:91], v[144:159]
ds_read_u16_d16_hi v138, v138
ds_read_u16 v136, v136
ds_read_b128 v[180:183], v250 offset:50176
v_and_b32_sdwa v139, s47, v137 dst_sel:DWORD dst_unused:UNUSED_PAD src0_sel:DWORD src1_sel:WORD_1
v_and_b32_e64 v137, s47, v137
v_exp_f16_sdwa v143, v143 dst_sel:WORD_1 dst_unused:UNUSED_PRESERVE src0_sel:WORD_1
v_pk_add_f16 v141, v141, 1.0 op_sel_hi:[1,0]
v_mfma_f32_32x32x16_bf16 v[96:111], v[68:71], v[188:191], v[96:111]
ds_read_u16_d16_hi v139, v139
ds_read_u16 v137, v137
v_pk_add_f16 v143, v143, 1.0 op_sel_hi:[1,0]
v_rcp_f16_sdwa v141, v141 dst_sel:WORD_0 dst_unused:UNUSED_PRESERVE src0_sel:WORD_0
v_rcp_f16_sdwa v143, v143 dst_sel:WORD_0 dst_unused:UNUSED_PRESERVE src0_sel:WORD_0
v_mfma_f32_32x32x16_bf16 v[144:159], v[188:191], v[92:95], v[144:159]
ds_read_b128 v[184:187], v250 offset:51200
v_rcp_f16_sdwa v141, v141 dst_sel:WORD_1 dst_unused:UNUSED_PRESERVE src0_sel:WORD_1
v_rcp_f16_sdwa v143, v143 dst_sel:WORD_1 dst_unused:UNUSED_PRESERVE src0_sel:WORD_1
v_mov_b32 v239, 0
s_branch Law5
Lax5:
s_sleep 2
Law5:
ds_read_b32 v239, v247 offset:28
s_sub_u32 s76, s76, 1
s_cselect_b32 s44, 4, 0
s_cselect_b32 s76, 0, s76
s_waitcnt lgkmcnt(0)
v_readfirstlane_b32 s43, v239
s_nop 1
s_max_u32 s43, s43, s44
s_cmp_lt_u32 s43, 4
s_cbranch_scc1 Lax5
v_bfe_u32 v237, v250, 4, 6
v_lshrrev_b32_e64 v246, 2, v237
v_mul_u32_u24 v246, 192, v246
v_and_b32_e64 v237, 3, v237
v_lshl_add_u32 v246, v237, 4, v246
v_mfma_f32_32x32x16_bf16 v[160:175], v[48:51], v[176:179], 0
v_permlane32_swap_b32 v224, v225
v_add_f32 v224, v224, v225
v_permlane32_swap_b32 v226, v227
v_add_f32 v226, v226, v227
v_permlane32_swap_b32 v228, v229
v_add_f32 v228, v228, v229
v_pk_mul_f16 v206, v140, v141
v_pk_mul_f16 v207, v142, v143
ds_write_b32 v248, v224 offset:5120
ds_write_b32 v248, v226 offset:5376
ds_write_b32 v248, v228 offset:5632
v_lshl_add_u64 v[200:201], v[128:129], 0, v[130:131]
v_cvt_pkrtz_f16_f32 v96, v96, v97
v_cvt_pkrtz_f16_f32 v97, v98, v99
v_lshrrev_b64 v[96:97], 2, v[96:97]
v_and_b32_sdwa v98, s47, v96 dst_sel:DWORD dst_unused:UNUSED_PAD src0_sel:DWORD src1_sel:WORD_1
v_and_b32_e64 v96, s47, v96
v_cvt_pk_f16_f32 v108, v108, v109
v_cvt_pk_f16_f32 v110, v110, v111
v_mfma_f32_32x32x16_bf16 v[112:127], v[176:179], v[72:75], 0
ds_read_u16 v98, v98
ds_read_u16 v96, v96
v_pk_fma_f16 v109, v108, v108, s48
v_and_b32_sdwa v99, s47, v97 dst_sel:DWORD dst_unused:UNUSED_PAD src0_sel:DWORD src1_sel:WORD_1
v_and_b32_e64 v97, s47, v97
v_pk_fma_f16 v111, v110, v110, s48
v_pk_mul_f16 v109, v108, v109
v_pk_mul_f16 v111, v110, v111
v_lshl_add_u64 v[204:205], v[132:133], 0, v[134:135]
v_cvt_pkrtz_f16_f32 v100, v100, v101
v_cvt_pkrtz_f16_f32 v101, v102, v103
ds_read_u16 v99, v99
ds_read_u16 v97, v97
ds_read_b128 v[188:191], v250 offset:52224
v_lshrrev_b64 v[100:101], 2, v[100:101]
v_and_b32_sdwa v102, s47, v100 dst_sel:DWORD dst_unused:UNUSED_PAD src0_sel:DWORD src1_sel:WORD_1
v_and_b32_e64 v100, s47, v100
v_exp_f16_sdwa v109, v109 dst_sel:WORD_0 dst_unused:UNUSED_PRESERVE src0_sel:WORD_0
v_mfma_f32_32x32x16_bf16 v[160:175], v[52:55], v[180:183], v[160:175]
ds_read_u16 v102, v102
ds_read_u16 v100, v100
s_add_u32 m0, s72, 0
s_add_u32 s43, s82, 0
buffer_load_dwordx4 v246, s[16:19], s43 offen lds
v_exp_f16_sdwa v111, v111 dst_sel:WORD_0 dst_unused:UNUSED_PRESERVE src0_sel:WORD_0
v_and_b32_sdwa v103, s47, v101 dst_sel:DWORD dst_unused:UNUSED_PAD src0_sel:DWORD src1_sel:WORD_1
v_and_b32_e64 v101, s47, v101
v_exp_f16_sdwa v109, v109 dst_sel:WORD_1 dst_unused:UNUSED_PRESERVE src0_sel:WORD_1
v_lshl_add_u64 v[202:203], v[136:137], 0, v[138:139]
v_cvt_pkrtz_f16_f32 v104, v104, v105
v_cvt_pkrtz_f16_f32 v105, v106, v107
v_lshrrev_b64 v[104:105], 2, v[104:105]
v_and_b32_sdwa v106, s47, v104 dst_sel:DWORD dst_unused:UNUSED_PAD src0_sel:DWORD src1_sel:WORD_1
ds_read_u16 v103, v103
ds_read_u16 v101, v101
v_and_b32_e64 v104, s47, v104
v_mfma_f32_32x32x16_bf16 v[112:127], v[180:183], v[76:79], v[112:127]
ds_read_u16 v106, v106
ds_read_u16 v104, v104
v_exp_f16_sdwa v111, v111 dst_sel:WORD_1 dst_unused:UNUSED_PRESERVE src0_sel:WORD_1
v_and_b32_sdwa v107, s47, v105 dst_sel:DWORD dst_unused:UNUSED_PAD src0_sel:DWORD src1_sel:WORD_1
v_and_b32 v105, s47, v105
v_mfma_f32_32x32x16_f16 v[128:143], v[200:203], v[216:219], 0
ds_read_b128 v[176:179], v250 offset:53248
s_waitcnt lgkmcnt(9)
ds_read_u16 v107, v107
ds_read_u16 v105, v105
v_pk_add_f16 v109, v109, 1.0 op_sel_hi:[1,0]
v_pk_add_f16 v111, v111, 1.0 op_sel_hi:[1,0]
v_rcp_f16_sdwa v109, v109 dst_sel:WORD_0 dst_unused:UNUSED_PRESERVE src0_sel:WORD_0
v_mfma_f32_32x32x16_f16 v[128:143], v[204:207], v[220:223], v[128:143]
v_permlane16_swap_b32 v200, v204
v_permlane16_swap_b32 v201, v205
v_permlane16_swap_b32 v202, v206
v_permlane16_swap_b32 v203, v207
v_rcp_f16_sdwa v111, v111 dst_sel:WORD_0 dst_unused:UNUSED_PRESERVE src0_sel:WORD_0
v_mfma_f32_32x32x16_bf16 v[160:175], v[56:59], v[184:187], v[160:175]
v_rcp_f16_sdwa v109, v109 dst_sel:WORD_1 dst_unused:UNUSED_PRESERVE src0_sel:WORD_1
s_add_u32 m0, s72, 1024
s_add_u32 s43, s82, 64
buffer_load_dwordx4 v246, s[16:19], s43 offen lds
v_rcp_f16_sdwa v111, v111 dst_sel:WORD_1 dst_unused:UNUSED_PRESERVE src0_sel:WORD_1
s_nop 0
v_fmac_f32_e64 v230, v128, v128
v_mfma_f32_32x32x16_bf16 v[112:127], v[184:187], v[80:83], v[112:127]
ds_read_b128 v[180:183], v250 offset:54272
v_pk_mul_f16 v108, v108, v109
v_fmac_f32_e64 v230, v129, v129
v_pk_mul_f16 v110, v110, v111
v_fmac_f32 v230, v130, v130
v_fmac_f32 v230, v131, v131
v_fma_mix_f32 v231, v108, v108, v231 op_sel_hi:[1,1,0]
v_fmac_f32 v230, v132, v132
v_fmac_f32 v230, v133, v133
v_fma_mix_f32 v231, v110, v110, v231 op_sel_hi:[1,1,0]
s_waitcnt lgkmcnt(6)
v_mfma_f32_32x32x16_bf16 v[160:175], v[60:63], v[188:191], v[160:175]
v_fmac_f32 v230, v134, v134
v_fma_mix_f32 v231, v108, v108, v231 op_sel:[1,1,0] op_sel_hi:[1,1,0]
v_fmac_f32 v230, v135, v135
v_fmac_f32 v230, v136, v136
v_fma_mix_f32 v231, v110, v110, v231 op_sel:[1,1,0] op_sel_hi:[1,1,0]
v_fmac_f32_e64 v230, v137, v137
v_fma_mix_f32 v231, v96, v96, v231 op_sel_hi:[1,1,0]
v_fmac_f32_e64 v230, v138, v138
v_fma_mix_f32 v231, v97, v97, v231 op_sel_hi:[1,1,0]
v_cvt_pkrtz_f16_f32 v144, v144, v145
v_fma_mix_f32 v231, v98, v98, v231 op_sel_hi:[1,1,0]
v_cvt_pkrtz_f16_f32 v145, v146, v147
v_fma_mix_f32 v231, v99, v99, v231 op_sel_hi:[1,1,0]
v_lshrrev_b64 v[144:145], 2, v[144:145]
v_and_b32_sdwa v146, s47, v144 dst_sel:DWORD dst_unused:UNUSED_PAD src0_sel:DWORD src1_sel:WORD_1
v_and_b32_e64 v144, s47, v144
v_cvt_pk_f16_f32 v156, v156, v157
v_fmac_f32_e64 v230, v139, v139
v_cvt_pk_f16_f32 v158, v158, v159
v_fmac_f32 v230, v140, v140
v_fmac_f32 v230, v141, v141
v_mfma_f32_32x32x16_bf16 v[112:127], v[188:191], v[84:87], v[112:127]
ds_read_u16_d16_hi v146, v146
ds_read_u16 v144, v144
v_pk_fma_f16 v157, v156, v156, s48
v_fmac_f32_e64 v230, v142, v142
v_fma_mix_f32 v231, v100, v100, v231 op_sel_hi:[1,1,0]
v_and_b32_sdwa v147, s47, v145 dst_sel:DWORD dst_unused:UNUSED_PAD src0_sel:DWORD src1_sel:WORD_1
v_fma_mix_f32 v231, v101, v101, v231 op_sel_hi:[1,1,0]
v_and_b32 v145, s47, v145
v_fmac_f32 v230, v143, v143
v_pk_fma_f16 v159, v158, v158, s48
v_pk_mul_f16 v157, v156, v157
v_fma_mix_f32 v231, v102, v102, v231 op_sel_hi:[1,1,0]
v_cvt_pkrtz_f16_f32 v148, v148, v149
v_fma_mix_f32 v231, v103, v103, v231 op_sel_hi:[1,1,0]
ds_read_u16_d16_hi v147, v147
ds_read_u16 v145, v145
ds_read_b128 v[184:187], v250 offset:55296
v_cvt_pkrtz_f16_f32 v149, v150, v151
v_lshrrev_b64 v[148:149], 2, v[148:149]
v_and_b32_sdwa v150, s47, v148 dst_sel:DWORD dst_unused:UNUSED_PAD src0_sel:DWORD src1_sel:WORD_1
v_and_b32 v148, s47, v148
v_pk_mul_f16 v159, v158, v159
v_exp_f16_sdwa v157, v157 dst_sel:WORD_0 dst_unused:UNUSED_PRESERVE src0_sel:WORD_0
s_waitcnt lgkmcnt(5)
v_mfma_f32_32x32x16_bf16 v[160:175], v[64:67], v[176:179], v[160:175]
ds_read_u16_d16_hi v150, v150
ds_read_u16 v148, v148
s_add_u32 m0, s72, 2048
s_add_u32 s43, s82, 128
buffer_load_dwordx4 v246, s[16:19], s43 offen lds
v_fma_mix_f32 v231, v104, v104, v231 op_sel_hi:[1,1,0]
v_and_b32_sdwa v151, s47, v149 dst_sel:DWORD dst_unused:UNUSED_PAD src0_sel:DWORD src1_sel:WORD_1
v_fma_mix_f32 v231, v105, v105, v231 op_sel_hi:[1,1,0]
v_and_b32_e64 v149, s47, v149
v_exp_f16_sdwa v159, v159 dst_sel:WORD_0 dst_unused:UNUSED_PRESERVE src0_sel:WORD_0
v_fma_mix_f32 v231, v106, v106, v231 op_sel_hi:[1,1,0]
v_cvt_pkrtz_f16_f32 v152, v152, v153
v_fma_mix_f32 v231, v107, v107, v231 op_sel_hi:[1,1,0]
v_cvt_pkrtz_f16_f32 v153, v154, v155
v_lshrrev_b64 v[152:153], 2, v[152:153]
ds_read_u16_d16_hi v151, v151
ds_read_u16 v149, v149
v_and_b32_sdwa v154, s47, v152 dst_sel:DWORD dst_unused:UNUSED_PAD src0_sel:DWORD src1_sel:WORD_1
v_and_b32_e64 v152, s47, v152
v_exp_f16_sdwa v157, v157 dst_sel:WORD_1 dst_unused:UNUSED_PRESERVE src0_sel:WORD_1
v_mfma_f32_32x32x16_bf16 v[112:127], v[176:179], v[88:91], v[112:127]
ds_read_u16_d16_hi v154, v154
ds_read_u16 v152, v152
ds_read_b128 v[188:191], v250 offset:56320
v_and_b32_sdwa v155, s47, v153 dst_sel:DWORD dst_unused:UNUSED_PAD src0_sel:DWORD src1_sel:WORD_1
v_and_b32_e64 v153, s47, v153
v_exp_f16_sdwa v159, v159 dst_sel:WORD_1 dst_unused:UNUSED_PRESERVE src0_sel:WORD_1
v_pk_add_f16 v157, v157, 1.0 op_sel_hi:[1,0]
v_mfma_f32_32x32x16_bf16 v[160:175], v[68:71], v[180:183], v[160:175]
ds_read_u16_d16_hi v155, v155
ds_read_u16 v153, v153
v_pk_add_f16 v159, v159, 1.0 op_sel_hi:[1,0]
v_rcp_f16_sdwa v157, v157 dst_sel:WORD_0 dst_unused:UNUSED_PRESERVE src0_sel:WORD_0
v_rcp_f16_sdwa v159, v159 dst_sel:WORD_0 dst_unused:UNUSED_PRESERVE src0_sel:WORD_0
s_add_u32 m0, s72, 3072
s_add_u32 s43, s82, 3072
buffer_load_dwordx4 v246, s[16:19], s43 offen lds
v_mfma_f32_32x32x16_bf16 v[112:127], v[180:183], v[92:95], v[112:127]
ds_read_b128 v[176:179], v250 offset:57344
v_rcp_f16_sdwa v157, v157 dst_sel:WORD_1 dst_unused:UNUSED_PRESERVE src0_sel:WORD_1
v_rcp_f16_sdwa v159, v159 dst_sel:WORD_1 dst_unused:UNUSED_PRESERVE src0_sel:WORD_1
v_pk_mul_f16 v214, v156, v157
s_waitcnt lgkmcnt(7)
v_mfma_f32_32x32x16_bf16 v[128:143], v[48:51], v[184:187], 0
v_pk_mul_f16 v215, v158, v159
v_lshl_add_u64 v[208:209], v[144:145], 0, v[146:147]
v_cvt_pkrtz_f16_f32 v160, v160, v161
v_cvt_pkrtz_f16_f32 v161, v162, v163
v_lshrrev_b64 v[160:161], 2, v[160:161]
v_and_b32_sdwa v162, s47, v160 dst_sel:DWORD dst_unused:UNUSED_PAD src0_sel:DWORD src1_sel:WORD_1
v_and_b32 v160, s47, v160
v_cvt_pk_f16_f32 v172, v172, v173
v_cvt_pk_f16_f32 v174, v174, v175
v_mfma_f32_32x32x16_bf16 v[96:111], v[72:75], v[184:187], 0
ds_read_u16 v162, v162
ds_read_u16 v160, v160
v_pk_fma_f16 v173, v172, v172, s48
v_and_b32_sdwa v163, s47, v161 dst_sel:DWORD dst_unused:UNUSED_PAD src0_sel:DWORD src1_sel:WORD_1
v_and_b32 v161, s47, v161
v_pk_fma_f16 v175, v174, v174, s48
v_pk_mul_f16 v173, v172, v173
v_pk_mul_f16 v175, v174, v175
s_waitcnt lgkmcnt(5)
v_lshl_add_u64 v[212:213], v[148:149], 0, v[150:151]
v_cvt_pkrtz_f16_f32 v164, v164, v165
v_cvt_pkrtz_f16_f32 v165, v166, v167
ds_read_u16 v163, v163
ds_read_u16 v161, v161
ds_read_b128 v[180:183], v250 offset:58368
v_lshrrev_b64 v[164:165], 2, v[164:165]
v_and_b32_sdwa v166, s47, v164 dst_sel:DWORD dst_unused:UNUSED_PAD src0_sel:DWORD src1_sel:WORD_1
v_and_b32_e64 v164, s47, v164
v_exp_f16_sdwa v173, v173 dst_sel:WORD_0 dst_unused:UNUSED_PRESERVE src0_sel:WORD_0
v_mfma_f32_32x32x16_bf16 v[128:143], v[52:55], v[188:191], v[128:143]
ds_read_u16 v166, v166
ds_read_u16 v164, v164
s_add_u32 m0, s72, 4096
s_add_u32 s43, s82, 3136
buffer_load_dwordx4 v246, s[16:19], s43 offen lds
v_exp_f16_sdwa v175, v175 dst_sel:WORD_0 dst_unused:UNUSED_PRESERVE src0_sel:WORD_0
v_and_b32_sdwa v167, s47, v165 dst_sel:DWORD dst_unused:UNUSED_PAD src0_sel:DWORD src1_sel:WORD_1
v_and_b32 v165, s47, v165
v_exp_f16_sdwa v173, v173 dst_sel:WORD_1 dst_unused:UNUSED_PRESERVE src0_sel:WORD_1
s_waitcnt lgkmcnt(7)
v_lshl_add_u64 v[210:211], v[152:153], 0, v[154:155]
v_cvt_pkrtz_f16_f32 v168, v168, v169
v_cvt_pkrtz_f16_f32 v169, v170, v171
v_lshrrev_b64 v[168:169], 2, v[168:169]
v_and_b32_sdwa v170, s47, v168 dst_sel:DWORD dst_unused:UNUSED_PAD src0_sel:DWORD src1_sel:WORD_1
ds_read_u16 v167, v167
ds_read_u16 v165, v165
v_and_b32_e64 v168, s47, v168
v_mfma_f32_32x32x16_bf16 v[96:111], v[76:79], v[188:191], v[96:111]
ds_read_u16 v170, v170
ds_read_u16 v168, v168
v_exp_f16_sdwa v175, v175 dst_sel:WORD_1 dst_unused:UNUSED_PRESERVE src0_sel:WORD_1
v_and_b32_sdwa v171, s47, v169 dst_sel:DWORD dst_unused:UNUSED_PAD src0_sel:DWORD src1_sel:WORD_1
v_and_b32_e64 v169, s47, v169
v_mfma_f32_32x32x16_f16 v[144:159], v[208:211], v[216:219], 0
ds_read_b128 v[184:187], v250 offset:59392
ds_read_u16 v171, v171
ds_read_u16 v169, v169
v_pk_add_f16 v173, v173, 1.0 op_sel_hi:[1,0]
v_pk_add_f16 v175, v175, 1.0 op_sel_hi:[1,0]
v_rcp_f16_sdwa v173, v173 dst_sel:WORD_0 dst_unused:UNUSED_PRESERVE src0_sel:WORD_0
v_mfma_f32_32x32x16_f16 v[144:159], v[212:215], v[220:223], v[144:159]
v_permlane16_swap_b32 v208, v212
v_permlane16_swap_b32 v209, v213
v_permlane16_swap_b32 v210, v214
v_permlane16_swap_b32 v211, v215
v_rcp_f16_sdwa v175, v175 dst_sel:WORD_0 dst_unused:UNUSED_PRESERVE src0_sel:WORD_0
v_mfma_f32_32x32x16_bf16 v[128:143], v[56:59], v[176:179], v[128:143]
v_rcp_f16_sdwa v173, v173 dst_sel:WORD_1 dst_unused:UNUSED_PRESERVE src0_sel:WORD_1
s_add_u32 m0, s72, 6144
s_add_u32 s43, s82, 6144
buffer_load_dwordx4 v246, s[16:19], s43 offen lds
v_rcp_f16_sdwa v175, v175 dst_sel:WORD_1 dst_unused:UNUSED_PRESERVE src0_sel:WORD_1
s_nop 0
v_fmac_f32 v231, v144, v144
v_mfma_f32_32x32x16_bf16 v[96:111], v[80:83], v[176:179], v[96:111]
ds_read_b128 v[188:191], v250 offset:60416
v_pk_mul_f16 v172, v172, v173
v_fmac_f32_e64 v231, v145, v145
v_pk_mul_f16 v174, v174, v175
v_fmac_f32 v231, v146, v146
v_fmac_f32 v231, v147, v147
v_fma_mix_f32 v232, v172, v172, v232 op_sel_hi:[1,1,0]
v_fmac_f32 v231, v148, v148
v_fmac_f32 v231, v149, v149
v_fma_mix_f32 v232, v174, v174, v232 op_sel_hi:[1,1,0]
s_waitcnt lgkmcnt(6)
v_mfma_f32_32x32x16_bf16 v[128:143], v[60:63], v[180:183], v[128:143]
v_fmac_f32 v231, v150, v150
v_fma_mix_f32 v232, v172, v172, v232 op_sel:[1,1,0] op_sel_hi:[1,1,0]
v_fmac_f32 v231, v151, v151
v_fmac_f32 v231, v152, v152
v_fma_mix_f32 v232, v174, v174, v232 op_sel:[1,1,0] op_sel_hi:[1,1,0]
v_fmac_f32_e64 v231, v153, v153
v_fma_mix_f32 v232, v160, v160, v232 op_sel_hi:[1,1,0]
v_fmac_f32_e64 v231, v154, v154
v_fma_mix_f32 v232, v161, v161, v232 op_sel_hi:[1,1,0]
v_cvt_pkrtz_f16_f32 v112, v112, v113
v_fma_mix_f32 v232, v162, v162, v232 op_sel_hi:[1,1,0]
v_cvt_pkrtz_f16_f32 v113, v114, v115
v_fma_mix_f32 v232, v163, v163, v232 op_sel_hi:[1,1,0]
v_lshrrev_b64 v[112:113], 2, v[112:113]
v_and_b32_sdwa v114, s47, v112 dst_sel:DWORD dst_unused:UNUSED_PAD src0_sel:DWORD src1_sel:WORD_1
v_and_b32_e64 v112, s47, v112
v_cvt_pk_f16_f32 v124, v124, v125
v_fmac_f32_e64 v231, v155, v155
v_cvt_pk_f16_f32 v126, v126, v127
v_fmac_f32 v231, v156, v156
v_fmac_f32 v231, v157, v157
v_mfma_f32_32x32x16_bf16 v[96:111], v[84:87], v[180:183], v[96:111]
ds_read_u16_d16_hi v114, v114
ds_read_u16 v112, v112
v_pk_fma_f16 v125, v124, v124, s48
v_fmac_f32_e64 v231, v158, v158
v_fma_mix_f32 v232, v164, v164, v232 op_sel_hi:[1,1,0]
v_and_b32_sdwa v115, s47, v113 dst_sel:DWORD dst_unused:UNUSED_PAD src0_sel:DWORD src1_sel:WORD_1
v_fma_mix_f32 v232, v165, v165, v232 op_sel_hi:[1,1,0]
v_and_b32 v113, s47, v113
v_fmac_f32 v231, v159, v159
s_nop 1
v_permlane32_swap_b32 v230, v231
v_add_f32_e64 v230, v230, v231
v_pk_fma_f16 v127, v126, v126, s48
v_pk_mul_f16 v125, v124, v125
v_fma_mix_f32 v232, v166, v166, v232 op_sel_hi:[1,1,0]
ds_read_u16_d16_hi v115, v115
ds_read_u16 v113, v113
ds_write_b32 v248, v230 offset:8192
ds_read_b128 v[176:179], v250 offset:61440
v_fma_mix_f32 v232, v167, v167, v232 op_sel_hi:[1,1,0]
v_cvt_pkrtz_f16_f32 v116, v116, v117
v_cvt_pkrtz_f16_f32 v117, v118, v119
v_lshrrev_b64 v[116:117], 2, v[116:117]
v_and_b32_sdwa v118, s47, v116 dst_sel:DWORD dst_unused:UNUSED_PAD src0_sel:DWORD src1_sel:WORD_1
v_and_b32 v116, s47, v116
v_pk_mul_f16 v127, v126, v127
v_exp_f16_sdwa v125, v125 dst_sel:WORD_0 dst_unused:UNUSED_PRESERVE src0_sel:WORD_0
s_waitcnt lgkmcnt(6)
v_mfma_f32_32x32x16_bf16 v[128:143], v[64:67], v[184:187], v[128:143]
ds_read_u16_d16_hi v118, v118
ds_read_u16 v116, v116
s_add_u32 m0, s72, 7168
s_add_u32 s43, s82, 6208
buffer_load_dwordx4 v246, s[16:19], s43 offen lds
v_fma_mix_f32 v232, v168, v168, v232 op_sel_hi:[1,1,0]
v_and_b32_sdwa v119, s47, v117 dst_sel:DWORD dst_unused:UNUSED_PAD src0_sel:DWORD src1_sel:WORD_1
v_fma_mix_f32 v232, v169, v169, v232 op_sel_hi:[1,1,0]
v_and_b32_e64 v117, s47, v117
v_exp_f16_sdwa v127, v127 dst_sel:WORD_0 dst_unused:UNUSED_PRESERVE src0_sel:WORD_0
v_fma_mix_f32 v232, v170, v170, v232 op_sel_hi:[1,1,0]
v_cvt_pkrtz_f16_f32 v120, v120, v121
v_fma_mix_f32 v232, v171, v171, v232 op_sel_hi:[1,1,0]
v_cvt_pkrtz_f16_f32 v121, v122, v123
v_lshrrev_b64 v[120:121], 2, v[120:121]
ds_read_u16_d16_hi v119, v119
ds_read_u16 v117, v117
v_and_b32_sdwa v122, s47, v120 dst_sel:DWORD dst_unused:UNUSED_PAD src0_sel:DWORD src1_sel:WORD_1
v_and_b32_e64 v120, s47, v120
v_exp_f16_sdwa v125, v125 dst_sel:WORD_1 dst_unused:UNUSED_PRESERVE src0_sel:WORD_1
v_mfma_f32_32x32x16_bf16 v[96:111], v[88:91], v[184:187], v[96:111]
ds_read_u16_d16_hi v122, v122
ds_read_u16 v120, v120
ds_read_b128 v[180:183], v250 offset:62464
v_and_b32_sdwa v123, s47, v121 dst_sel:DWORD dst_unused:UNUSED_PAD src0_sel:DWORD src1_sel:WORD_1
v_and_b32 v121, s47, v121
v_exp_f16_sdwa v127, v127 dst_sel:WORD_1 dst_unused:UNUSED_PRESERVE src0_sel:WORD_1
v_pk_add_f16 v125, v125, 1.0 op_sel_hi:[1,0]
v_mfma_f32_32x32x16_bf16 v[128:143], v[68:71], v[188:191], v[128:143]
ds_read_u16_d16_hi v123, v123
ds_read_u16 v121, v121
v_pk_add_f16 v127, v127, 1.0 op_sel_hi:[1,0]
v_rcp_f16_sdwa v125, v125 dst_sel:WORD_0 dst_unused:UNUSED_PRESERVE src0_sel:WORD_0
v_rcp_f16_sdwa v127, v127 dst_sel:WORD_0 dst_unused:UNUSED_PRESERVE src0_sel:WORD_0
v_mfma_f32_32x32x16_bf16 v[96:111], v[92:95], v[188:191], v[96:111]
s_waitcnt lgkmcnt(8)
ds_read_b128 v[184:187], v250 offset:63488
v_rcp_f16_sdwa v125, v125 dst_sel:WORD_1 dst_unused:UNUSED_PRESERVE src0_sel:WORD_1
v_rcp_f16_sdwa v127, v127 dst_sel:WORD_1 dst_unused:UNUSED_PRESERVE src0_sel:WORD_1
v_pk_mul_f16 v230, v124, v125
v_mfma_f32_32x32x16_bf16 v[144:159], v[48:51], v[176:179], 0
v_pk_mul_f16 v231, v126, v127
v_lshl_add_u64 v[224:225], v[112:113], 0, v[114:115]
v_cvt_pkrtz_f16_f32 v128, v128, v129
v_cvt_pkrtz_f16_f32 v129, v130, v131
v_lshrrev_b64 v[128:129], 2, v[128:129]
v_and_b32_sdwa v130, s47, v128 dst_sel:DWORD dst_unused:UNUSED_PAD src0_sel:DWORD src1_sel:WORD_1
v_and_b32_e64 v128, s47, v128
v_cvt_pk_f16_f32 v140, v140, v141
v_cvt_pk_f16_f32 v142, v142, v143
v_mfma_f32_32x32x16_bf16 v[160:175], v[176:179], v[72:75], 0
ds_read_u16 v130, v130
ds_read_u16 v128, v128
v_pk_fma_f16 v141, v140, v140, s48
v_and_b32_sdwa v131, s47, v129 dst_sel:DWORD dst_unused:UNUSED_PAD src0_sel:DWORD src1_sel:WORD_1
v_and_b32 v129, s47, v129
v_pk_fma_f16 v143, v142, v142, s48
v_pk_mul_f16 v141, v140, v141
v_pk_mul_f16 v143, v142, v143
s_waitcnt lgkmcnt(6)
v_lshl_add_u64 v[228:229], v[116:117], 0, v[118:119]
v_cvt_pkrtz_f16_f32 v132, v132, v133
v_cvt_pkrtz_f16_f32 v133, v134, v135
ds_read_u16 v131, v131
ds_read_u16 v129, v129
ds_read_b128 v[188:191], v250 offset:64512
v_lshrrev_b64 v[132:133], 2, v[132:133]
v_and_b32_sdwa v134, s47, v132 dst_sel:DWORD dst_unused:UNUSED_PAD src0_sel:DWORD src1_sel:WORD_1
v_and_b32 v132, s47, v132
v_exp_f16_sdwa v141, v141 dst_sel:WORD_0 dst_unused:UNUSED_PRESERVE src0_sel:WORD_0
s_waitcnt lgkmcnt(7)
v_mfma_f32_32x32x16_bf16 v[144:159], v[52:55], v[180:183], v[144:159]
ds_read_u16 v134, v134
ds_read_u16 v132, v132
v_exp_f16_sdwa v143, v143 dst_sel:WORD_0 dst_unused:UNUSED_PRESERVE src0_sel:WORD_0
v_and_b32_sdwa v135, s47, v133 dst_sel:DWORD dst_unused:UNUSED_PAD src0_sel:DWORD src1_sel:WORD_1
v_and_b32 v133, s47, v133
v_exp_f16_sdwa v141, v141 dst_sel:WORD_1 dst_unused:UNUSED_PRESERVE src0_sel:WORD_1
s_waitcnt lgkmcnt(7)
v_lshl_add_u64 v[226:227], v[120:121], 0, v[122:123]
v_cvt_pkrtz_f16_f32 v136, v136, v137
v_cvt_pkrtz_f16_f32 v137, v138, v139
v_lshrrev_b64 v[136:137], 2, v[136:137]
v_and_b32_sdwa v138, s47, v136 dst_sel:DWORD dst_unused:UNUSED_PAD src0_sel:DWORD src1_sel:WORD_1
ds_read_u16 v135, v135
ds_read_u16 v133, v133
v_and_b32_e64 v136, s47, v136
v_mfma_f32_32x32x16_bf16 v[160:175], v[180:183], v[76:79], v[160:175]
ds_read_u16 v138, v138
ds_read_u16 v136, v136
v_exp_f16_sdwa v143, v143 dst_sel:WORD_1 dst_unused:UNUSED_PRESERVE src0_sel:WORD_1
v_and_b32_sdwa v139, s47, v137 dst_sel:DWORD dst_unused:UNUSED_PAD src0_sel:DWORD src1_sel:WORD_1
v_and_b32_e64 v137, s47, v137
v_mfma_f32_32x32x16_f16 v[112:127], v[224:227], v[216:219], 0
ds_read_b128 v[176:179], v251
ds_read_u16 v139, v139
ds_read_u16 v137, v137
v_pk_add_f16 v141, v141, 1.0 op_sel_hi:[1,0]
v_pk_add_f16 v143, v143, 1.0 op_sel_hi:[1,0]
v_rcp_f16_sdwa v141, v141 dst_sel:WORD_0 dst_unused:UNUSED_PRESERVE src0_sel:WORD_0
v_mfma_f32_32x32x16_f16 v[112:127], v[228:231], v[220:223], v[112:127]
v_permlane16_swap_b32 v224, v228
v_permlane16_swap_b32 v225, v229
v_permlane16_swap_b32 v226, v230
v_permlane16_swap_b32 v227, v231
v_rcp_f16_sdwa v143, v143 dst_sel:WORD_0 dst_unused:UNUSED_PRESERVE src0_sel:WORD_0
v_mfma_f32_32x32x16_bf16 v[144:159], v[56:59], v[184:187], v[144:159]
v_rcp_f16_sdwa v141, v141 dst_sel:WORD_1 dst_unused:UNUSED_PRESERVE src0_sel:WORD_1
v_rcp_f16_sdwa v143, v143 dst_sel:WORD_1 dst_unused:UNUSED_PRESERVE src0_sel:WORD_1
s_nop 3
v_fmac_f32 v232, v112, v112
v_mfma_f32_32x32x16_bf16 v[160:175], v[184:187], v[80:83], v[160:175]
ds_read_b128 v[180:183], v251 offset:1024
v_pk_mul_f16 v140, v140, v141
v_fmac_f32_e64 v232, v113, v113
v_pk_mul_f16 v142, v142, v143
v_fmac_f32 v232, v114, v114
v_fmac_f32 v232, v115, v115
v_fma_mix_f32 v233, v140, v140, v233 op_sel_hi:[1,1,0]
v_fmac_f32 v232, v116, v116
v_fmac_f32 v232, v117, v117
v_fma_mix_f32 v233, v142, v142, v233 op_sel_hi:[1,1,0]
s_waitcnt lgkmcnt(6)
v_mfma_f32_32x32x16_bf16 v[144:159], v[60:63], v[188:191], v[144:159]
v_fmac_f32 v232, v118, v118
v_fma_mix_f32 v233, v140, v140, v233 op_sel:[1,1,0] op_sel_hi:[1,1,0]
v_fmac_f32 v232, v119, v119
v_fmac_f32 v232, v120, v120
v_fma_mix_f32 v233, v142, v142, v233 op_sel:[1,1,0] op_sel_hi:[1,1,0]
v_fmac_f32_e64 v232, v121, v121
v_fma_mix_f32 v233, v128, v128, v233 op_sel_hi:[1,1,0]
v_fmac_f32_e64 v232, v122, v122
v_fma_mix_f32 v233, v129, v129, v233 op_sel_hi:[1,1,0]
v_cvt_pkrtz_f16_f32 v96, v96, v97
v_fma_mix_f32 v233, v130, v130, v233 op_sel_hi:[1,1,0]
v_cvt_pkrtz_f16_f32 v97, v98, v99
v_fma_mix_f32 v233, v131, v131, v233 op_sel_hi:[1,1,0]
v_lshrrev_b64 v[96:97], 2, v[96:97]
v_and_b32_sdwa v98, s47, v96 dst_sel:DWORD dst_unused:UNUSED_PAD src0_sel:DWORD src1_sel:WORD_1
v_and_b32_e64 v96, s47, v96
v_cvt_pk_f16_f32 v108, v108, v109
v_fmac_f32_e64 v232, v123, v123
v_cvt_pk_f16_f32 v110, v110, v111
v_fmac_f32 v232, v124, v124
v_fmac_f32 v232, v125, v125
v_mfma_f32_32x32x16_bf16 v[160:175], v[188:191], v[84:87], v[160:175]
ds_read_u16 v98, v98
ds_read_u16 v96, v96
v_pk_fma_f16 v109, v108, v108, s48
v_fmac_f32_e64 v232, v126, v126
v_fma_mix_f32 v233, v132, v132, v233 op_sel_hi:[1,1,0]
v_and_b32_sdwa v99, s47, v97 dst_sel:DWORD dst_unused:UNUSED_PAD src0_sel:DWORD src1_sel:WORD_1
v_fma_mix_f32 v233, v133, v133, v233 op_sel_hi:[1,1,0]
v_and_b32 v97, s47, v97
v_fmac_f32 v232, v127, v127
v_pk_fma_f16 v111, v110, v110, s48
v_pk_mul_f16 v109, v108, v109
v_pk_mul_f16 v111, v110, v111
v_fma_mix_f32 v233, v134, v134, v233 op_sel_hi:[1,1,0]
v_cvt_pkrtz_f16_f32 v100, v100, v101
ds_read_u16 v99, v99
ds_read_u16 v97, v97
ds_read_b128 v[184:187], v251 offset:2048
v_fma_mix_f32 v233, v135, v135, v233 op_sel_hi:[1,1,0]
v_cvt_pkrtz_f16_f32 v101, v102, v103
v_lshrrev_b64 v[100:101], 2, v[100:101]
v_and_b32_sdwa v102, s47, v100 dst_sel:DWORD dst_unused:UNUSED_PAD src0_sel:DWORD src1_sel:WORD_1
v_and_b32 v100, s47, v100
v_exp_f16_sdwa v109, v109 dst_sel:WORD_0 dst_unused:UNUSED_PRESERVE src0_sel:WORD_0
s_waitcnt lgkmcnt(5)
v_mfma_f32_32x32x16_bf16 v[144:159], v[64:67], v[176:179], v[144:159]
ds_read_u16 v102, v102
ds_read_u16 v100, v100
v_fma_mix_f32 v233, v136, v136, v233 op_sel_hi:[1,1,0]
v_exp_f16_sdwa v111, v111 dst_sel:WORD_0 dst_unused:UNUSED_PRESERVE src0_sel:WORD_0
v_fma_mix_f32 v233, v137, v137, v233 op_sel_hi:[1,1,0]
v_and_b32_sdwa v103, s47, v101 dst_sel:DWORD dst_unused:UNUSED_PAD src0_sel:DWORD src1_sel:WORD_1
v_and_b32_e64 v101, s47, v101
v_exp_f16_sdwa v109, v109 dst_sel:WORD_1 dst_unused:UNUSED_PRESERVE src0_sel:WORD_1
v_fma_mix_f32 v233, v138, v138, v233 op_sel_hi:[1,1,0]
v_cvt_pkrtz_f16_f32 v104, v104, v105
v_fma_mix_f32 v233, v139, v139, v233 op_sel_hi:[1,1,0]
v_cvt_pkrtz_f16_f32 v105, v106, v107
v_lshrrev_b64 v[104:105], 2, v[104:105]
ds_read_u16 v103, v103
ds_read_u16 v101, v101
v_and_b32_sdwa v106, s47, v104 dst_sel:DWORD dst_unused:UNUSED_PAD src0_sel:DWORD src1_sel:WORD_1
v_and_b32_e64 v104, s47, v104
v_mfma_f32_32x32x16_bf16 v[160:175], v[176:179], v[88:91], v[160:175]
ds_read_u16 v106, v106
ds_read_u16 v104, v104
v_exp_f16_sdwa v111, v111 dst_sel:WORD_1 dst_unused:UNUSED_PRESERVE src0_sel:WORD_1
v_and_b32_sdwa v107, s47, v105 dst_sel:DWORD dst_unused:UNUSED_PAD src0_sel:DWORD src1_sel:WORD_1
v_and_b32_e64 v105, s47, v105
v_pk_add_f16 v109, v109, 1.0 op_sel_hi:[1,0]
v_pk_add_f16 v111, v111, 1.0 op_sel_hi:[1,0]
v_rcp_f16_sdwa v109, v109 dst_sel:WORD_0 dst_unused:UNUSED_PRESERVE src0_sel:WORD_0
v_mfma_f32_32x32x16_bf16 v[144:159], v[68:71], v[180:183], v[144:159]
ds_read_b128 v[188:191], v251 offset:3072
ds_read_u16 v107, v107
ds_read_u16 v105, v105
v_rcp_f16_sdwa v111, v111 dst_sel:WORD_0 dst_unused:UNUSED_PRESERVE src0_sel:WORD_0
v_rcp_f16_sdwa v109, v109 dst_sel:WORD_1 dst_unused:UNUSED_PRESERVE src0_sel:WORD_1
v_mfma_f32_32x32x16_bf16 v[160:175], v[180:183], v[92:95], v[160:175]
v_rcp_f16_sdwa v111, v111 dst_sel:WORD_1 dst_unused:UNUSED_PRESERVE src0_sel:WORD_1
v_pk_mul_f16 v108, v108, v109
v_pk_mul_f16 v110, v110, v111
v_fma_mix_f32 v233, v108, v108, v233 op_sel_hi:[1,1,0]
s_waitcnt lgkmcnt(6)
v_mfma_f32_32x32x16_bf16 v[112:127], v[48:51], v[184:187], 0
ds_read_b128 v[176:179], v251 offset:4096
v_fma_mix_f32 v233, v110, v110, v233 op_sel_hi:[1,1,0]
v_bfe_u32 v237, v250, 4, 6
v_min_u32 v237, 47, v237
v_lshlrev_b32_e64 v244, 5, v237
v_add_u32 v244, 95232, v244
v_add_u32 v245, 2304, v244
v_cmp_gt_u32 vcc, 24, v237
s_nop 1
v_cndmask_b32 v244, v245, v244, vcc
v_lshlrev_b32 v237, 13, v237
v_add_u32 v245, 4096, v237
v_fma_mix_f32 v233, v108, v108, v233 op_sel:[1,1,0] op_sel_hi:[1,1,0]
v_cvt_pkrtz_f16_f32 v144, v144, v145
v_fma_mix_f32 v233, v110, v110, v233 op_sel:[1,1,0] op_sel_hi:[1,1,0]
v_cvt_pkrtz_f16_f32 v145, v146, v147
v_fma_mix_f32 v233, v96, v96, v233 op_sel_hi:[1,1,0]
v_lshrrev_b64 v[144:145], 2, v[144:145]
v_fma_mix_f32 v233, v97, v97, v233 op_sel_hi:[1,1,0]
v_and_b32_sdwa v146, s47, v144 dst_sel:DWORD dst_unused:UNUSED_PAD src0_sel:DWORD src1_sel:WORD_1
v_fma_mix_f32 v233, v98, v98, v233 op_sel_hi:[1,1,0]
v_and_b32_e64 v144, s47, v144
v_fma_mix_f32 v233, v99, v99, v233 op_sel_hi:[1,1,0]
v_cvt_pk_f16_f32 v156, v156, v157
v_cvt_pk_f16_f32 v158, v158, v159
v_mfma_f32_32x32x16_bf16 v[128:143], v[184:187], v[72:75], 0
ds_read_u16 v146, v146
ds_read_u16 v144, v144
v_pk_fma_f16 v157, v156, v156, s48
v_fma_mix_f32 v233, v100, v100, v233 op_sel_hi:[1,1,0]
v_and_b32_sdwa v147, s47, v145 dst_sel:DWORD dst_unused:UNUSED_PAD src0_sel:DWORD src1_sel:WORD_1
s_waitcnt lgkmcnt(3)
v_fma_mix_f32 v233, v101, v101, v233 op_sel_hi:[1,1,0]
v_and_b32 v145, s47, v145
v_pk_fma_f16 v159, v158, v158, s48
v_pk_mul_f16 v157, v156, v157
v_pk_mul_f16 v159, v158, v159
v_fma_mix_f32 v233, v102, v102, v233 op_sel_hi:[1,1,0]
v_cvt_pkrtz_f16_f32 v148, v148, v149
v_fma_mix_f32 v233, v103, v103, v233 op_sel_hi:[1,1,0]
ds_read_u16 v147, v147
ds_read_u16 v145, v145
ds_read_b128 v[180:183], v251 offset:5120
v_cvt_pkrtz_f16_f32 v149, v150, v151
v_lshrrev_b64 v[148:149], 2, v[148:149]
v_and_b32_sdwa v150, s47, v148 dst_sel:DWORD dst_unused:UNUSED_PAD src0_sel:DWORD src1_sel:WORD_1
v_and_b32_e64 v148, s47, v148
v_exp_f16_sdwa v157, v157 dst_sel:WORD_0 dst_unused:UNUSED_PRESERVE src0_sel:WORD_0
v_mfma_f32_32x32x16_bf16 v[112:127], v[52:55], v[188:191], v[112:127]
ds_read_u16 v150, v150
ds_read_u16 v148, v148
v_fma_mix_f32 v233, v104, v104, v233 op_sel_hi:[1,1,0]
v_exp_f16_sdwa v159, v159 dst_sel:WORD_0 dst_unused:UNUSED_PRESERVE src0_sel:WORD_0
v_fma_mix_f32 v233, v105, v105, v233 op_sel_hi:[1,1,0]
v_and_b32_sdwa v151, s47, v149 dst_sel:DWORD dst_unused:UNUSED_PAD src0_sel:DWORD src1_sel:WORD_1
v_and_b32_e64 v149, s47, v149
v_exp_f16_sdwa v157, v157 dst_sel:WORD_1 dst_unused:UNUSED_PRESERVE src0_sel:WORD_1
v_fma_mix_f32 v233, v106, v106, v233 op_sel_hi:[1,1,0]
v_cvt_pkrtz_f16_f32 v152, v152, v153
v_fma_mix_f32 v233, v107, v107, v233 op_sel_hi:[1,1,0]
v_cvt_pkrtz_f16_f32 v153, v154, v155
v_lshrrev_b64 v[152:153], 2, v[152:153]
ds_read_u16 v151, v151
ds_read_u16 v149, v149
v_and_b32_sdwa v154, s47, v152 dst_sel:DWORD dst_unused:UNUSED_PAD src0_sel:DWORD src1_sel:WORD_1
v_and_b32_e64 v152, s47, v152
v_mfma_f32_32x32x16_bf16 v[128:143], v[188:191], v[76:79], v[128:143]
ds_read_u16 v154, v154
ds_read_u16 v152, v152
v_exp_f16_sdwa v159, v159 dst_sel:WORD_1 dst_unused:UNUSED_PRESERVE src0_sel:WORD_1
v_and_b32_sdwa v155, s47, v153 dst_sel:DWORD dst_unused:UNUSED_PAD src0_sel:DWORD src1_sel:WORD_1
v_and_b32 v153, s47, v153
v_pk_add_f16 v157, v157, 1.0 op_sel_hi:[1,0]
v_pk_add_f16 v159, v159, 1.0 op_sel_hi:[1,0]
v_rcp_f16_sdwa v157, v157 dst_sel:WORD_0 dst_unused:UNUSED_PRESERVE src0_sel:WORD_0
s_waitcnt lgkmcnt(6)
v_mfma_f32_32x32x16_bf16 v[112:127], v[56:59], v[176:179], v[112:127]
ds_read_b128 v[184:187], v251 offset:6144
ds_read_u16 v155, v155
ds_read_u16 v153, v153
v_rcp_f16_sdwa v159, v159 dst_sel:WORD_0 dst_unused:UNUSED_PRESERVE src0_sel:WORD_0
v_rcp_f16_sdwa v157, v157 dst_sel:WORD_1 dst_unused:UNUSED_PRESERVE src0_sel:WORD_1
v_mfma_f32_32x32x16_bf16 v[128:143], v[176:179], v[80:83], v[128:143]
v_rcp_f16_sdwa v159, v159 dst_sel:WORD_1 dst_unused:UNUSED_PRESERVE src0_sel:WORD_1
v_pk_mul_f16 v156, v156, v157
v_pk_mul_f16 v158, v158, v159
v_fma_mix_f32 v234, v156, v156, v234 op_sel_hi:[1,1,0]
v_mfma_f32_32x32x16_bf16 v[112:127], v[60:63], v[180:183], v[112:127]
ds_read_b128 v[188:191], v251 offset:7168
v_fma_mix_f32 v234, v158, v158, v234 op_sel_hi:[1,1,0]
v_permlane32_swap_b32 v232, v233
v_add_f32_e64 v232, v232, v233
s_setprio 1
ds_write_b32 v248, v232 offset:8448
v_fma_mix_f32 v234, v156, v156, v234 op_sel:[1,1,0] op_sel_hi:[1,1,0]
v_cvt_pkrtz_f16_f32 v160, v160, v161
v_fma_mix_f32 v234, v158, v158, v234 op_sel:[1,1,0] op_sel_hi:[1,1,0]
v_cvt_pkrtz_f16_f32 v161, v162, v163
v_fma_mix_f32 v234, v144, v144, v234 op_sel_hi:[1,1,0]
v_lshrrev_b64 v[160:161], 2, v[160:161]
v_fma_mix_f32 v234, v145, v145, v234 op_sel_hi:[1,1,0]
v_and_b32_sdwa v162, s47, v160 dst_sel:DWORD dst_unused:UNUSED_PAD src0_sel:DWORD src1_sel:WORD_1
v_fma_mix_f32 v234, v146, v146, v234 op_sel_hi:[1,1,0]
v_and_b32_e64 v160, s47, v160
v_fma_mix_f32 v234, v147, v147, v234 op_sel_hi:[1,1,0]
v_cvt_pk_f16_f32 v172, v172, v173
v_cvt_pk_f16_f32 v174, v174, v175
v_mfma_f32_32x32x16_bf16 v[128:143], v[180:183], v[84:87], v[128:143]
ds_read_u16_d16_hi v162, v162
ds_read_u16 v160, v160
v_pk_fma_f16 v173, v172, v172, s48
s_waitcnt lgkmcnt(6)
v_fma_mix_f32 v234, v148, v148, v234 op_sel_hi:[1,1,0]
v_and_b32_sdwa v163, s47, v161 dst_sel:DWORD dst_unused:UNUSED_PAD src0_sel:DWORD src1_sel:WORD_1
v_fma_mix_f32 v234, v149, v149, v234 op_sel_hi:[1,1,0]
v_and_b32 v161, s47, v161
v_pk_fma_f16 v175, v174, v174, s48
v_pk_mul_f16 v173, v172, v173
v_fma_mix_f32 v234, v150, v150, v234 op_sel_hi:[1,1,0]
v_cvt_pkrtz_f16_f32 v164, v164, v165
v_fma_mix_f32 v234, v151, v151, v234 op_sel_hi:[1,1,0]
v_cvt_pkrtz_f16_f32 v165, v166, v167
ds_read_u16_d16_hi v163, v163
ds_read_u16 v161, v161
v_lshrrev_b64 v[164:165], 2, v[164:165]
v_and_b32_sdwa v166, s47, v164 dst_sel:DWORD dst_unused:UNUSED_PAD src0_sel:DWORD src1_sel:WORD_1
v_and_b32_e64 v164, s47, v164
v_pk_mul_f16 v175, v174, v175
v_exp_f16_sdwa v173, v173 dst_sel:WORD_0 dst_unused:UNUSED_PRESERVE src0_sel:WORD_0
v_mfma_f32_32x32x16_bf16 v[112:127], v[64:67], v[184:187], v[112:127]
ds_read_u16_d16_hi v166, v166
ds_read_u16 v164, v164
v_fma_mix_f32 v234, v152, v152, v234 op_sel_hi:[1,1,0]
v_and_b32_sdwa v167, s47, v165 dst_sel:DWORD dst_unused:UNUSED_PAD src0_sel:DWORD src1_sel:WORD_1
s_waitcnt lgkmcnt(6)
v_fma_mix_f32 v234, v153, v153, v234 op_sel_hi:[1,1,0]
v_and_b32 v165, s47, v165
v_exp_f16_sdwa v175, v175 dst_sel:WORD_0 dst_unused:UNUSED_PRESERVE src0_sel:WORD_0
v_fma_mix_f32 v234, v154, v154, v234 op_sel_hi:[1,1,0]
v_cvt_pkrtz_f16_f32 v168, v168, v169
v_fma_mix_f32 v234, v155, v155, v234 op_sel_hi:[1,1,0]
v_cvt_pkrtz_f16_f32 v169, v170, v171
v_lshrrev_b64 v[168:169], 2, v[168:169]
ds_read_u16_d16_hi v167, v167
ds_read_u16 v165, v165
v_and_b32_sdwa v170, s47, v168 dst_sel:DWORD dst_unused:UNUSED_PAD src0_sel:DWORD src1_sel:WORD_1
v_and_b32_e64 v168, s47, v168
v_exp_f16_sdwa v173, v173 dst_sel:WORD_1 dst_unused:UNUSED_PRESERVE src0_sel:WORD_1
v_mfma_f32_32x32x16_bf16 v[128:143], v[184:187], v[88:91], v[128:143]
ds_read_u16_d16_hi v170, v170
ds_read_u16 v168, v168
v_and_b32_sdwa v171, s47, v169 dst_sel:DWORD dst_unused:UNUSED_PAD src0_sel:DWORD src1_sel:WORD_1
v_and_b32_e64 v169, s47, v169
v_exp_f16_sdwa v175, v175 dst_sel:WORD_1 dst_unused:UNUSED_PRESERVE src0_sel:WORD_1
v_pk_add_f16 v173, v173, 1.0 op_sel_hi:[1,0]
v_mfma_f32_32x32x16_bf16 v[112:127], v[68:71], v[188:191], v[112:127]
ds_read_u16_d16_hi v171, v171
ds_read_u16 v169, v169
v_pk_add_f16 v175, v175, 1.0 op_sel_hi:[1,0]
v_rcp_f16_sdwa v173, v173 dst_sel:WORD_0 dst_unused:UNUSED_PRESERVE src0_sel:WORD_0
v_rcp_f16_sdwa v175, v175 dst_sel:WORD_0 dst_unused:UNUSED_PRESERVE src0_sel:WORD_0
v_mfma_f32_32x32x16_bf16 v[128:143], v[188:191], v[92:95], v[128:143]
v_rcp_f16_sdwa v173, v173 dst_sel:WORD_1 dst_unused:UNUSED_PRESERVE src0_sel:WORD_1
v_rcp_f16_sdwa v175, v175 dst_sel:WORD_1 dst_unused:UNUSED_PRESERVE src0_sel:WORD_1
v_pk_mul_f16 v102, v172, v173
v_pk_mul_f16 v103, v174, v175
s_waitcnt lgkmcnt(5)
v_lshl_add_u64 v[96:97], v[160:161], 0, v[162:163]
s_waitcnt lgkmcnt(4)
v_lshl_add_u64 v[100:101], v[164:165], 0, v[166:167]
ds_read_b128 v[176:179], v250
ds_read_b128 v[180:183], v250 offset:1024
ds_read_b128 v[184:187], v250 offset:2048
s_nop 0
v_cvt_pkrtz_f16_f32 v128, v128, v129
v_cvt_pkrtz_f16_f32 v129, v130, v131
v_lshrrev_b64 v[128:129], 2, v[128:129]
v_and_b32_sdwa v130, s47, v128 dst_sel:DWORD dst_unused:UNUSED_PAD src0_sel:DWORD src1_sel:WORD_1
v_and_b32 v128, s47, v128
v_cvt_pk_f16_f32 v140, v140, v141
v_cvt_pk_f16_f32 v142, v142, v143
v_pk_fma_f16 v141, v140, v140, s48
v_and_b32_sdwa v131, s47, v129 dst_sel:DWORD dst_unused:UNUSED_PAD src0_sel:DWORD src1_sel:WORD_1
v_and_b32_e64 v129, s47, v129
v_pk_fma_f16 v143, v142, v142, s48
ds_read_u16_d16_hi v130, v130
ds_read_u16 v128, v128
ds_read_u16_d16_hi v131, v131
ds_read_u16 v129, v129
v_pk_mul_f16 v141, v140, v141
v_cvt_pkrtz_f16_f32 v132, v132, v133
v_cvt_pkrtz_f16_f32 v133, v134, v135
v_lshrrev_b64 v[132:133], 2, v[132:133]
v_and_b32_sdwa v134, s47, v132 dst_sel:DWORD dst_unused:UNUSED_PAD src0_sel:DWORD src1_sel:WORD_1
v_and_b32_e64 v132, s47, v132
v_pk_mul_f16 v143, v142, v143
v_exp_f16_sdwa v141, v141 dst_sel:WORD_0 dst_unused:UNUSED_PRESERVE src0_sel:WORD_0
v_and_b32_sdwa v135, s47, v133 dst_sel:DWORD dst_unused:UNUSED_PAD src0_sel:DWORD src1_sel:WORD_1
v_and_b32 v133, s47, v133
v_exp_f16_sdwa v143, v143 dst_sel:WORD_0 dst_unused:UNUSED_PRESERVE src0_sel:WORD_0
s_waitcnt lgkmcnt(6)
v_lshl_add_u64 v[98:99], v[168:169], 0, v[170:171]
ds_read_u16_d16_hi v134, v134
ds_read_u16 v132, v132
ds_read_u16_d16_hi v135, v135
ds_read_u16 v133, v133
v_cvt_pkrtz_f16_f32 v136, v136, v137
v_cvt_pkrtz_f16_f32 v137, v138, v139
v_lshrrev_b64 v[136:137], 2, v[136:137]
v_and_b32_sdwa v138, s47, v136 dst_sel:DWORD dst_unused:UNUSED_PAD src0_sel:DWORD src1_sel:WORD_1
v_and_b32_e64 v136, s47, v136
v_exp_f16_sdwa v141, v141 dst_sel:WORD_1 dst_unused:UNUSED_PRESERVE src0_sel:WORD_1
v_mfma_f32_32x32x16_f16 v[160:175], v[96:99], v[216:219], 0
ds_read_u16_d16_hi v138, v138
ds_read_u16 v136, v136
v_and_b32_sdwa v139, s47, v137 dst_sel:DWORD dst_unused:UNUSED_PAD src0_sel:DWORD src1_sel:WORD_1
v_and_b32_e64 v137, s47, v137
v_exp_f16_sdwa v143, v143 dst_sel:WORD_1 dst_unused:UNUSED_PRESERVE src0_sel:WORD_1
v_pk_add_f16 v141, v141, 1.0 op_sel_hi:[1,0]
v_mfma_f32_32x32x16_f16 v[160:175], v[100:103], v[220:223], v[160:175]
ds_read_u16_d16_hi v139, v139
ds_read_u16 v137, v137
v_pk_add_f16 v143, v143, 1.0 op_sel_hi:[1,0]
v_permlane16_swap_b32 v96, v100
v_permlane16_swap_b32 v97, v101
v_permlane16_swap_b32 v98, v102
v_permlane16_swap_b32 v99, v103
v_rcp_f16_sdwa v141, v141 dst_sel:WORD_0 dst_unused:UNUSED_PRESERVE src0_sel:WORD_0
v_rcp_f16_sdwa v143, v143 dst_sel:WORD_0 dst_unused:UNUSED_PRESERVE src0_sel:WORD_0
v_rcp_f16_sdwa v141, v141 dst_sel:WORD_1 dst_unused:UNUSED_PRESERVE src0_sel:WORD_1
s_nop 1
v_fmac_f32 v234, v160, v160
v_fmac_f32 v234, v161, v161
v_fmac_f32 v234, v162, v162
ds_read_b128 v[188:191], v250 offset:3072
v_rcp_f16_sdwa v143, v143 dst_sel:WORD_1 dst_unused:UNUSED_PRESERVE src0_sel:WORD_1
v_fmac_f32 v234, v163, v163
v_fmac_f32 v234, v164, v164
v_fmac_f32 v234, v165, v165
v_mfma_f32_32x32x16_bf16 v[144:159], v[176:179], v[72:75], 0
s_waitcnt lgkmcnt(7)
ds_read_b128 v[176:179], v250 offset:4096
v_fmac_f32_e64 v234, v166, v166
v_pk_mul_f16 v110, v140, v141
v_fmac_f32 v234, v167, v167
v_fmac_f32 v234, v168, v168
v_pk_mul_f16 v111, v142, v143
v_fmac_f32_e64 v234, v169, v169
v_lshl_add_u64 v[104:105], v[128:129], 0, v[130:131]
v_fmac_f32_e64 v234, v170, v170
v_cvt_pkrtz_f16_f32 v112, v112, v113
v_cvt_pkrtz_f16_f32 v113, v114, v115
v_lshrrev_b64 v[112:113], 2, v[112:113]
v_and_b32_sdwa v114, s47, v112 dst_sel:DWORD dst_unused:UNUSED_PAD src0_sel:DWORD src1_sel:WORD_1
v_and_b32_e64 v112, s47, v112
v_cvt_pk_f16_f32 v124, v124, v125
v_fmac_f32_e64 v234, v171, v171
v_cvt_pk_f16_f32 v126, v126, v127
v_fmac_f32 v234, v172, v172
v_fmac_f32 v234, v173, v173
v_mfma_f32_32x32x16_bf16 v[144:159], v[180:183], v[76:79], v[144:159]
ds_read_u16 v114, v114
ds_read_u16 v112, v112
ds_read_b128 v[180:183], v250 offset:5120
v_pk_fma_f16 v125, v124, v124, s48
v_fmac_f32_e64 v234, v174, v174
v_and_b32_sdwa v115, s47, v113 dst_sel:DWORD dst_unused:UNUSED_PAD src0_sel:DWORD src1_sel:WORD_1
v_and_b32_e64 v113, s47, v113
v_fmac_f32 v234, v175, v175
v_pk_fma_f16 v127, v126, v126, s48
v_pk_mul_f16 v125, v124, v125
v_pk_mul_f16 v127, v126, v127
s_waitcnt lgkmcnt(6)
v_lshl_add_u64 v[108:109], v[132:133], 0, v[134:135]
v_cvt_pkrtz_f16_f32 v116, v116, v117
ds_read_u16 v115, v115
ds_read_u16 v113, v113
v_cvt_pkrtz_f16_f32 v117, v118, v119
v_lshrrev_b64 v[116:117], 2, v[116:117]
v_and_b32_sdwa v118, s47, v116 dst_sel:DWORD dst_unused:UNUSED_PAD src0_sel:DWORD src1_sel:WORD_1
v_and_b32_e64 v116, s47, v116
v_exp_f16_sdwa v125, v125 dst_sel:WORD_0 dst_unused:UNUSED_PRESERVE src0_sel:WORD_0
v_mfma_f32_32x32x16_bf16 v[144:159], v[184:187], v[80:83], v[144:159]
ds_read_u16 v118, v118
ds_read_u16 v116, v116
ds_read_b128 v[184:187], v250 offset:6144
v_exp_f16_sdwa v127, v127 dst_sel:WORD_0 dst_unused:UNUSED_PRESERVE src0_sel:WORD_0
v_and_b32_sdwa v119, s47, v117 dst_sel:DWORD dst_unused:UNUSED_PAD src0_sel:DWORD src1_sel:WORD_1
v_and_b32 v117, s47, v117
v_exp_f16_sdwa v125, v125 dst_sel:WORD_1 dst_unused:UNUSED_PRESERVE src0_sel:WORD_1
s_waitcnt lgkmcnt(7)
v_lshl_add_u64 v[106:107], v[136:137], 0, v[138:139]
v_cvt_pkrtz_f16_f32 v120, v120, v121
v_cvt_pkrtz_f16_f32 v121, v122, v123
v_lshrrev_b64 v[120:121], 2, v[120:121]
v_and_b32_sdwa v122, s47, v120 dst_sel:DWORD dst_unused:UNUSED_PAD src0_sel:DWORD src1_sel:WORD_1
ds_read_u16 v119, v119
ds_read_u16 v117, v117
v_and_b32_e64 v120, s47, v120
v_mfma_f32_32x32x16_bf16 v[144:159], v[188:191], v[84:87], v[144:159]
ds_read_u16 v122, v122
ds_read_u16 v120, v120
ds_read_b128 v[188:191], v250 offset:7168
s_waitcnt vmcnt(0)
v_exp_f16_sdwa v127, v127 dst_sel:WORD_1 dst_unused:UNUSED_PRESERVE src0_sel:WORD_1
v_and_b32_sdwa v123, s47, v121 dst_sel:DWORD dst_unused:UNUSED_PAD src0_sel:DWORD src1_sel:WORD_1
v_mfma_f32_32x32x16_f16 v[128:143], v[104:107], v[216:219], 0
v_and_b32 v121, s47, v121
v_pk_add_f16 v125, v125, 1.0 op_sel_hi:[1,0]
v_pk_add_f16 v127, v127, 1.0 op_sel_hi:[1,0]
v_rcp_f16_sdwa v125, v125 dst_sel:WORD_0 dst_unused:UNUSED_PRESERVE src0_sel:WORD_0
v_mfma_f32_32x32x16_f16 v[128:143], v[108:111], v[220:223], v[128:143]
ds_read_u16 v123, v123
ds_read_u16 v121, v121
v_permlane16_swap_b32 v104, v108
v_permlane16_swap_b32 v105, v109
v_permlane16_swap_b32 v106, v110
v_permlane16_swap_b32 v107, v111
v_mfma_f32_32x32x16_bf16 v[144:159], v[176:179], v[88:91], v[144:159]
ds_read_b128 v[176:179], v250 offset:8192
v_rcp_f16_sdwa v127, v127 dst_sel:WORD_0 dst_unused:UNUSED_PRESERVE src0_sel:WORD_0
v_rcp_f16_sdwa v125, v125 dst_sel:WORD_1 dst_unused:UNUSED_PRESERVE src0_sel:WORD_1
v_rcp_f16_sdwa v127, v127 dst_sel:WORD_1 dst_unused:UNUSED_PRESERVE src0_sel:WORD_1
s_waitcnt lgkmcnt(8)
v_mfma_f32_32x32x16_bf16 v[144:159], v[180:183], v[92:95], v[144:159]
ds_read_b128 v[180:183], v250 offset:9216
v_fmac_f32 v235, v128, v128
v_pk_mul_f16 v124, v124, v125
v_fmac_f32_e64 v235, v129, v129
v_pk_mul_f16 v126, v126, v127
v_fmac_f32 v235, v130, v130
v_fmac_f32 v235, v131, v131
v_fmac_f32 v235, v132, v132
v_fmac_f32 v235, v133, v133
v_mfma_f32_32x32x16_bf16 v[160:175], v[184:187], v[72:75], 0
ds_read_b128 v[184:187], v250 offset:10240
v_permlane16_swap_b32 v48, v52
v_permlane16_swap_b32 v49, v53
v_permlane16_swap_b32 v50, v54
v_permlane16_swap_b32 v51, v55
v_permlane16_swap_b32 v56, v60
v_permlane16_swap_b32 v57, v61
v_permlane16_swap_b32 v58, v62
v_permlane16_swap_b32 v59, v63
v_permlane16_swap_b32 v64, v68
v_permlane16_swap_b32 v65, v69
v_permlane16_swap_b32 v66, v70
v_permlane16_swap_b32 v67, v71
v_permlane16_swap_b32 v24, v28
v_permlane16_swap_b32 v25, v29
v_permlane16_swap_b32 v26, v30
v_permlane16_swap_b32 v27, v31
v_permlane16_swap_b32 v32, v36
v_permlane16_swap_b32 v33, v37
v_permlane16_swap_b32 v34, v38
v_permlane16_swap_b32 v35, v39
v_permlane16_swap_b32 v40, v44
v_permlane16_swap_b32 v41, v45
v_permlane16_swap_b32 v42, v46
v_permlane16_swap_b32 v43, v47
v_fmac_f32 v235, v134, v134
v_fmac_f32 v235, v135, v135
v_fmac_f32 v235, v136, v136
v_fmac_f32 v235, v137, v137
v_fmac_f32_e64 v235, v138, v138
v_cvt_pkrtz_f16_f32 v144, v144, v145
v_cvt_pkrtz_f16_f32 v145, v146, v147
v_lshrrev_b64 v[144:145], 2, v[144:145]
v_and_b32_sdwa v146, s47, v144 dst_sel:DWORD dst_unused:UNUSED_PAD src0_sel:DWORD src1_sel:WORD_1
v_and_b32_e64 v144, s47, v144
v_cvt_pk_f16_f32 v156, v156, v157
v_fmac_f32_e64 v235, v139, v139
v_cvt_pk_f16_f32 v158, v158, v159
v_fmac_f32_e64 v235, v140, v140
v_fmac_f32 v235, v141, v141
s_waitcnt lgkmcnt(0)
v_mfma_f32_32x32x16_bf16 v[160:175], v[188:191], v[76:79], v[160:175]
ds_read_u16_d16_hi v146, v146
ds_read_u16 v144, v144
ds_read_b128 v[188:191], v250 offset:11264
v_pk_fma_f16 v157, v156, v156, s48
v_fmac_f32_e64 v235, v142, v142
v_and_b32_sdwa v147, s47, v145 dst_sel:DWORD dst_unused:UNUSED_PAD src0_sel:DWORD src1_sel:WORD_1
v_and_b32 v145, s47, v145
v_fmac_f32 v235, v143, v143
v_fma_mix_f32 v235, v124, v124, v235 op_sel_hi:[1,1,0]
v_pk_fma_f16 v159, v158, v158, s48
v_fma_mix_f32 v235, v126, v126, v235 op_sel_hi:[1,1,0]
v_pk_mul_f16 v157, v156, v157
v_fma_mix_f32 v235, v124, v124, v235 op_sel:[1,1,0] op_sel_hi:[1,1,0]
ds_read_u16_d16_hi v147, v147
ds_read_u16 v145, v145
v_fma_mix_f32 v235, v126, v126, v235 op_sel:[1,1,0] op_sel_hi:[1,1,0]
v_cvt_pkrtz_f16_f32 v148, v148, v149
v_fma_mix_f32 v235, v112, v112, v235 op_sel_hi:[1,1,0]
v_cvt_pkrtz_f16_f32 v149, v150, v151
v_fma_mix_f32 v235, v113, v113, v235 op_sel_hi:[1,1,0]
v_lshrrev_b64 v[148:149], 2, v[148:149]
v_fma_mix_f32 v235, v114, v114, v235 op_sel_hi:[1,1,0]
v_and_b32_sdwa v150, s47, v148 dst_sel:DWORD dst_unused:UNUSED_PAD src0_sel:DWORD src1_sel:WORD_1
v_fma_mix_f32 v235, v115, v115, v235 op_sel_hi:[1,1,0]
v_and_b32_e64 v148, s47, v148
v_fma_mix_f32 v235, v116, v116, v235 op_sel_hi:[1,1,0]
v_pk_mul_f16 v159, v158, v159
v_fma_mix_f32 v235, v117, v117, v235 op_sel_hi:[1,1,0]
v_exp_f16_sdwa v157, v157 dst_sel:WORD_0 dst_unused:UNUSED_PRESERVE src0_sel:WORD_0
v_fma_mix_f32 v235, v118, v118, v235 op_sel_hi:[1,1,0]
v_mfma_f32_32x32x16_bf16 v[160:175], v[176:179], v[80:83], v[160:175]
v_fma_mix_f32 v235, v119, v119, v235 op_sel_hi:[1,1,0]
v_and_b32_sdwa v151, s47, v149 dst_sel:DWORD dst_unused:UNUSED_PAD src0_sel:DWORD src1_sel:WORD_1
v_fma_mix_f32 v235, v120, v120, v235 op_sel_hi:[1,1,0]
v_and_b32_e64 v149, s47, v149
v_fma_mix_f32 v235, v121, v121, v235 op_sel_hi:[1,1,0]
v_exp_f16_sdwa v159, v159 dst_sel:WORD_0 dst_unused:UNUSED_PRESERVE src0_sel:WORD_0
v_fma_mix_f32 v235, v122, v122, v235 op_sel_hi:[1,1,0]
ds_read_u16_d16_hi v150, v150
ds_read_u16 v148, v148
ds_read_u16_d16_hi v151, v151
ds_read_u16 v149, v149
v_fma_mix_f32 v235, v123, v123, v235 op_sel_hi:[1,1,0]
v_cvt_pkrtz_f16_f32 v152, v152, v153
s_nop 0
v_permlane32_swap_b32 v234, v235
v_add_f32_e64 v234, v234, v235
v_cvt_pkrtz_f16_f32 v153, v154, v155
v_lshrrev_b64 v[152:153], 2, v[152:153]
v_and_b32_sdwa v154, s47, v152 dst_sel:DWORD dst_unused:UNUSED_PAD src0_sel:DWORD src1_sel:WORD_1
v_and_b32_e64 v152, s47, v152
v_exp_f16_sdwa v157, v157 dst_sel:WORD_1 dst_unused:UNUSED_PRESERVE src0_sel:WORD_1
v_mfma_f32_32x32x16_bf16 v[160:175], v[180:183], v[84:87], v[160:175]
ds_write_b32 v248, v234 offset:8704
s_setprio 3
v_mov_b32_e64 v238, 1
s_waitcnt lgkmcnt(0)
s_nop 9
s_mov_b64 exec, 1
ds_add_rtn_u32 v239, v247, v238 offset:0
s_mov_b64 exec, -1
s_waitcnt lgkmcnt(0)
v_readfirstlane_b32 s43, v239
s_nop 1
s_cmp_lg_u32 s43, 7
s_cbranch_scc1 Lnopub
ds_read_b128 v[128:131], v244
ds_read_b128 v[132:135], v244 offset:16
ds_read_b128 v[136:139], v244 offset:9216
ds_read_b128 v[140:143], v244 offset:9232
ds_read_b128 v[112:115], v244 offset:18432
ds_read_b128 v[116:119], v244 offset:18448
ds_read_b128 v[120:123], v244 offset:27648
ds_read_b128 v[124:127], v244 offset:27664
ds_read_b128 v[216:219], v244 offset:36864
ds_read_b128 v[220:223], v244 offset:36880
s_waitcnt lgkmcnt(7)
v_add_f32 v128, v128, v136
v_add_f32 v129, v129, v137
v_add_f32 v130, v130, v138
v_add_f32 v131, v131, v139
s_waitcnt lgkmcnt(6)
v_add_f32 v132, v132, v140
v_add_f32 v133, v133, v141
v_add_f32 v134, v134, v142
v_add_f32 v135, v135, v143
ds_read_b128 v[136:139], v244 offset:46080
ds_read_b128 v[140:143], v244 offset:46096
s_waitcnt lgkmcnt(7)
v_add_f32 v128, v128, v112
v_add_f32 v129, v129, v113
v_add_f32 v130, v130, v114
v_add_f32 v131, v131, v115
s_waitcnt lgkmcnt(6)
v_add_f32 v132, v132, v116
v_add_f32 v133, v133, v117
v_add_f32 v134, v134, v118
v_add_f32 v135, v135, v119
ds_read_b128 v[112:115], v244 offset:55296
ds_read_b128 v[116:119], v244 offset:55312
s_waitcnt lgkmcnt(7)
v_add_f32 v128, v128, v120
v_add_f32 v129, v129, v121
v_add_f32 v130, v130, v122
v_add_f32 v131, v131, v123
s_waitcnt lgkmcnt(6)
v_add_f32 v132, v132, v124
v_add_f32 v133, v133, v125
v_add_f32 v134, v134, v126
v_add_f32 v135, v135, v127
ds_read_b128 v[120:123], v244 offset:64512
ds_read_b128 v[124:127], v244 offset:64528
s_waitcnt lgkmcnt(7)
v_add_f32 v128, v128, v216
v_add_f32 v129, v129, v217
v_add_f32 v130, v130, v218
v_add_f32 v131, v131, v219
s_waitcnt lgkmcnt(6)
v_add_f32 v132, v132, v220
v_add_f32 v133, v133, v221
v_add_f32 v134, v134, v222
v_add_f32 v135, v135, v223
s_waitcnt lgkmcnt(5)
v_add_f32 v128, v128, v136
v_add_f32 v129, v129, v137
v_add_f32 v130, v130, v138
v_add_f32 v131, v131, v139
s_waitcnt lgkmcnt(4)
v_add_f32 v132, v132, v140
v_add_f32 v133, v133, v141
v_add_f32 v134, v134, v142
v_add_f32 v135, v135, v143
s_waitcnt lgkmcnt(3)
v_add_f32 v128, v128, v112
v_add_f32 v129, v129, v113
v_add_f32 v130, v130, v114
v_add_f32 v131, v131, v115
s_waitcnt lgkmcnt(2)
v_add_f32 v132, v132, v116
v_add_f32 v133, v133, v117
v_add_f32 v134, v134, v118
v_add_f32 v135, v135, v119
s_waitcnt lgkmcnt(1)
v_add_f32 v128, v128, v120
v_add_f32 v129, v129, v121
v_add_f32 v130, v130, v122
v_add_f32 v131, v131, v123
s_waitcnt lgkmcnt(0)
v_add_f32 v132, v132, v124
v_add_f32 v133, v133, v125
v_add_f32 v134, v134, v126
v_add_f32 v135, v135, v127
v_min_u32 v216, -2, v128
v_min_u32 v217, -2, v129
v_min_u32 v218, -2, v130
v_min_u32 v219, -2, v131
v_min_u32 v220, -2, v132
v_min_u32 v221, -2, v133
v_min_u32_e64 v222, -2, v134
v_min_u32 v223, -2, v135
s_lshl_b32 s43, s2, 4
buffer_store_dwordx4 v[216:219], v237, s[32:35], s43 offen sc1
buffer_store_dwordx4 v[220:223], v245, s[32:35], s43 offen sc1
ds_write_b32 v247, v238 offset:4
s_waitcnt lgkmcnt(0)
s_nop 1
Lnopub:
s_mov_b32 s77, 0
v_bfe_u32 v244, v250, 8, 2
v_lshlrev_b32 v244, 3, v244
s_cmp_lg_u32 s40, 0
s_cbranch_scc1 Lnorole
v_subrev_u32 v245, 16384, v250
v_lshrrev_b32_e64 v240, 1, v245
v_add_u32 v240, v240, v245
s_cmp_lt_u32 s2, 96
s_cselect_b32 s77, 1, 2
s_cbranch_scc1 Lred
s_and_b32 s44, s2, 7
s_lshl_b32 s44, s44, 11
s_add_u32 s44, s44, 393216
s_waitcnt lgkmcnt(0)
buffer_load_dwordx2 v[128:129], v240, s[32:35], s44 offen sc1
buffer_load_dwordx2 v[130:131], v240, s[32:35], s44 offen offset:8 sc1
buffer_load_dwordx2 v[132:133], v240, s[32:35], s44 offen offset:16 sc1
v_lshrrev_b32_e64 v241, 1, v240
buffer_load_dword v135, v241, s[24:27], 0 offen
buffer_load_dword v137, v241, s[24:27], 0 offen offset:4
buffer_load_dword v139, v241, s[24:27], 0 offen offset:8
s_branch Lnorole
Lred:
s_lshl_b32 s44, s2, 12
s_waitcnt vmcnt(4)
buffer_load_dwordx4 v[128:131], v245, s[32:35], s44 offen sc1
s_waitcnt vmcnt(3)
buffer_load_dwordx4 v[132:135], v245, s[32:35], s44 offen offset:1024 sc1
s_waitcnt vmcnt(2)
buffer_load_dwordx4 v[136:139], v245, s[32:35], s44 offen offset:2048 sc1
buffer_load_dwordx4 v[140:143], v245, s[32:35], s44 offen offset:3072 sc1
Lnorole:
s_setprio 0
ds_read_u16_d16_hi v154, v154
ds_read_u16 v152, v152
v_and_b32_sdwa v155, s47, v153 dst_sel:DWORD dst_unused:UNUSED_PAD src0_sel:DWORD src1_sel:WORD_1
v_and_b32_e64 v153, s47, v153
v_exp_f16_sdwa v159, v159 dst_sel:WORD_1 dst_unused:UNUSED_PRESERVE src0_sel:WORD_1
v_pk_add_f16 v157, v157, 1.0 op_sel_hi:[1,0]
v_mfma_f32_32x32x16_bf16 v[160:175], v[184:187], v[88:91], v[160:175]
ds_read_u16_d16_hi v155, v155
ds_read_u16 v153, v153
v_pk_add_f16 v159, v159, 1.0 op_sel_hi:[1,0]
v_rcp_f16_sdwa v157, v157 dst_sel:WORD_0 dst_unused:UNUSED_PRESERVE src0_sel:WORD_0
v_rcp_f16_sdwa v159, v159 dst_sel:WORD_0 dst_unused:UNUSED_PRESERVE src0_sel:WORD_0
v_mfma_f32_32x32x16_bf16 v[160:175], v[188:191], v[92:95], v[160:175]
ds_read_b128 v[176:179], v250 offset:55296
ds_read_b128 v[180:183], v250 offset:56320
ds_read_b128 v[184:187], v250 offset:57344
v_rcp_f16_sdwa v157, v157 dst_sel:WORD_1 dst_unused:UNUSED_PRESERVE src0_sel:WORD_1
v_rcp_f16_sdwa v159, v159 dst_sel:WORD_1 dst_unused:UNUSED_PRESERVE src0_sel:WORD_1
s_waitcnt lgkmcnt(7)
v_pk_mul_f16 v118, v156, v157
v_pk_mul_f16 v119, v158, v159
v_lshl_add_u64 v[112:113], v[144:145], 0, v[146:147]
v_lshl_add_u64 v[116:117], v[148:149], 0, v[150:151]
ds_read_b128 v[188:191], v250 offset:58368
s_nop 0
v_permlane16_swap_b32 v112, v116
v_cvt_pkrtz_f16_f32 v160, v160, v161
v_cvt_pkrtz_f16_f32 v161, v162, v163
v_lshrrev_b64 v[160:161], 2, v[160:161]
v_and_b32_sdwa v162, s47, v160 dst_sel:DWORD dst_unused:UNUSED_PAD src0_sel:DWORD src1_sel:WORD_1
v_and_b32 v160, s47, v160
v_cvt_pk_f16_f32 v172, v172, v173
v_cvt_pk_f16_f32 v174, v174, v175
v_pk_fma_f16 v173, v172, v172, s48
v_and_b32_sdwa v163, s47, v161 dst_sel:DWORD dst_unused:UNUSED_PAD src0_sel:DWORD src1_sel:WORD_1
v_and_b32_e64 v161, s47, v161
v_pk_fma_f16 v175, v174, v174, s48
ds_read_u16_d16_hi v162, v162
ds_read_u16 v160, v160
ds_read_u16_d16_hi v163, v163
ds_read_u16 v161, v161
v_pk_mul_f16 v173, v172, v173
s_cmp_eq_u32 s77, 0
s_cbranch_scc1 Lpp1
s_call_b64 s[78:79], Lpolln
Lpp1:
v_cvt_pkrtz_f16_f32 v164, v164, v165
v_cvt_pkrtz_f16_f32 v165, v166, v167
v_lshrrev_b64 v[164:165], 2, v[164:165]
v_and_b32_sdwa v166, s47, v164 dst_sel:DWORD dst_unused:UNUSED_PAD src0_sel:DWORD src1_sel:WORD_1
v_and_b32 v164, s47, v164
v_pk_mul_f16 v175, v174, v175
v_exp_f16_sdwa v173, v173 dst_sel:WORD_0 dst_unused:UNUSED_PRESERVE src0_sel:WORD_0
v_and_b32_sdwa v167, s47, v165 dst_sel:DWORD dst_unused:UNUSED_PAD src0_sel:DWORD src1_sel:WORD_1
v_and_b32 v165, s47, v165
v_exp_f16_sdwa v175, v175 dst_sel:WORD_0 dst_unused:UNUSED_PRESERVE src0_sel:WORD_0
s_waitcnt lgkmcnt(6)
v_lshl_add_u64 v[114:115], v[152:153], 0, v[154:155]
ds_read_u16_d16_hi v166, v166
ds_read_u16 v164, v164
ds_read_u16_d16_hi v167, v167
ds_read_u16 v165, v165
v_cvt_pkrtz_f16_f32 v168, v168, v169
v_cvt_pkrtz_f16_f32 v169, v170, v171
v_lshrrev_b64 v[168:169], 2, v[168:169]
v_and_b32_sdwa v170, s47, v168 dst_sel:DWORD dst_unused:UNUSED_PAD src0_sel:DWORD src1_sel:WORD_1
v_and_b32_e64 v168, s47, v168
v_exp_f16_sdwa v173, v173 dst_sel:WORD_1 dst_unused:UNUSED_PRESERVE src0_sel:WORD_1
v_mfma_f32_32x32x16_bf16 v[144:159], v[176:179], v[72:75], 0
ds_read_u16_d16_hi v170, v170
ds_read_u16 v168, v168
ds_read_b128 v[176:179], v250 offset:59392
v_permlane16_swap_b32 v113, v117
v_permlane16_swap_b32 v114, v118
v_permlane16_swap_b32 v115, v119
s_cmp_eq_u32 s77, 0
s_cbranch_scc1 Lpp2
s_nop 5
s_call_b64 s[78:79], Lpolln
Lpp2:
v_and_b32_sdwa v171, s47, v169 dst_sel:DWORD dst_unused:UNUSED_PAD src0_sel:DWORD src1_sel:WORD_1
v_and_b32_e64 v169, s47, v169
v_exp_f16_sdwa v175, v175 dst_sel:WORD_1 dst_unused:UNUSED_PRESERVE src0_sel:WORD_1
v_mfma_f32_32x32x16_bf16 v[144:159], v[180:183], v[76:79], v[144:159]
ds_read_u16_d16_hi v171, v171
ds_read_u16 v169, v169
s_waitcnt lgkmcnt(10)
ds_read_b128 v[180:183], v250 offset:60416
v_pk_add_f16 v173, v173, 1.0 op_sel_hi:[1,0]
v_pk_add_f16 v175, v175, 1.0 op_sel_hi:[1,0]
v_rcp_f16_sdwa v173, v173 dst_sel:WORD_0 dst_unused:UNUSED_PRESERVE src0_sel:WORD_0
v_mfma_f32_32x32x16_bf16 v[144:159], v[184:187], v[80:83], v[144:159]
v_rcp_f16_sdwa v175, v175 dst_sel:WORD_0 dst_unused:UNUSED_PRESERVE src0_sel:WORD_0
v_rcp_f16_sdwa v173, v173 dst_sel:WORD_1 dst_unused:UNUSED_PRESERVE src0_sel:WORD_1
v_rcp_f16_sdwa v175, v175 dst_sel:WORD_1 dst_unused:UNUSED_PRESERVE src0_sel:WORD_1
v_mfma_f32_32x32x16_bf16 v[144:159], v[188:191], v[84:87], v[144:159]
v_pk_mul_f16 v222, v172, v173
v_pk_mul_f16 v223, v174, v175
s_waitcnt lgkmcnt(8)
v_lshl_add_u64 v[216:217], v[160:161], 0, v[162:163]
s_waitcnt lgkmcnt(6)
v_lshl_add_u64 v[220:221], v[164:165], 0, v[166:167]
s_waitcnt lgkmcnt(3)
v_mfma_f32_32x32x16_bf16 v[144:159], v[176:179], v[88:91], v[144:159]
s_cmp_eq_u32 s77, 0
s_cbranch_scc1 Lpp3
s_nop 11
s_call_b64 s[78:79], Lpolln
Lpp3:
s_waitcnt lgkmcnt(0)
v_mfma_f32_32x32x16_bf16 v[144:159], v[180:183], v[92:95], v[144:159]
s_mul_i32 s43, s40, 96
buffer_load_dwordx2 v[176:177], v244, s[28:31], s43 offen
buffer_load_dwordx2 v[178:179], v244, s[28:31], s43 offen offset:32
buffer_load_dwordx2 v[180:181], v244, s[28:31], s43 offen offset:64
v_mov_b32 v249, 0
s_branch Law6
Lax6:
s_sleep 2
Law6:
ds_read_b32 v249, v247 offset:4
s_sub_u32 s76, s76, 1
s_cselect_b32 s44, 1, 0
s_cselect_b32 s76, 0, s76
s_waitcnt lgkmcnt(0)
v_readfirstlane_b32 s43, v249
s_nop 1
s_max_u32 s43, s43, s44
s_cmp_lt_u32 s43, 1
s_cbranch_scc1 Lax6
s_add_u32 m0, s72, 5120
s_add_u32 s43, s82, 3200
buffer_load_dwordx4 v246, s[16:19], s43 offen lds
s_add_u32 m0, s72, 8192
s_add_u32 s43, s82, 6272
buffer_load_dwordx4 v246, s[16:19], s43 offen lds
v_lshl_add_u64 v[218:219], v[168:169], 0, v[170:171]
v_cvt_pkrtz_f16_f32 v144, v144, v145
v_cvt_pkrtz_f16_f32 v145, v146, v147
v_lshrrev_b64 v[144:145], 2, v[144:145]
v_and_b32_sdwa v146, s47, v144 dst_sel:DWORD dst_unused:UNUSED_PAD src0_sel:DWORD src1_sel:WORD_1
v_and_b32_e64 v144, s47, v144
v_cvt_pk_f16_f32 v156, v156, v157
v_cvt_pk_f16_f32 v158, v158, v159
v_pk_fma_f16 v157, v156, v156, s48
v_and_b32_sdwa v147, s47, v145 dst_sel:DWORD dst_unused:UNUSED_PAD src0_sel:DWORD src1_sel:WORD_1
v_and_b32 v145, s47, v145
v_pk_fma_f16 v159, v158, v158, s48
ds_read_u16_d16_hi v146, v146
ds_read_u16 v144, v144
s_cmp_eq_u32 s77, 0
s_cbranch_scc1 Lpp4
s_call_b64 s[78:79], Lpolln
Lpp4:
ds_read_u16_d16_hi v147, v147
ds_read_u16 v145, v145
v_pk_mul_f16 v157, v156, v157
v_cvt_pkrtz_f16_f32 v148, v148, v149
v_cvt_pkrtz_f16_f32 v149, v150, v151
v_lshrrev_b64 v[148:149], 2, v[148:149]
v_and_b32_sdwa v150, s47, v148 dst_sel:DWORD dst_unused:UNUSED_PAD src0_sel:DWORD src1_sel:WORD_1
v_and_b32_e64 v148, s47, v148
v_pk_mul_f16 v159, v158, v159
v_exp_f16_sdwa v157, v157 dst_sel:WORD_0 dst_unused:UNUSED_PRESERVE src0_sel:WORD_0
v_and_b32_sdwa v151, s47, v149 dst_sel:DWORD dst_unused:UNUSED_PAD src0_sel:DWORD src1_sel:WORD_1
v_and_b32_e64 v149, s47, v149
v_exp_f16_sdwa v159, v159 dst_sel:WORD_0 dst_unused:UNUSED_PRESERVE src0_sel:WORD_0
v_cvt_pkrtz_f16_f32 v152, v152, v153
ds_read_u16_d16_hi v150, v150
ds_read_u16 v148, v148
ds_read_u16_d16_hi v151, v151
ds_read_u16 v149, v149
s_cmp_eq_u32 s77, 0
s_cbranch_scc1 Lpp5
s_call_b64 s[78:79], Lpolln
Lpp5:
s_setprio 3
v_cvt_pkrtz_f16_f32 v153, v154, v155
v_lshrrev_b64 v[152:153], 2, v[152:153]
v_and_b32_sdwa v154, s47, v152 dst_sel:DWORD dst_unused:UNUSED_PAD src0_sel:DWORD src1_sel:WORD_1
v_and_b32_e64 v152, s47, v152
v_exp_f16_sdwa v157, v157 dst_sel:WORD_1 dst_unused:UNUSED_PRESERVE src0_sel:WORD_1
v_permlane16_swap_b32 v216, v220
v_permlane16_swap_b32 v217, v221
v_permlane16_swap_b32 v218, v222
v_permlane16_swap_b32 v219, v223
v_and_b32_sdwa v155, s47, v153 dst_sel:DWORD dst_unused:UNUSED_PAD src0_sel:DWORD src1_sel:WORD_1
ds_read_u16_d16_hi v154, v154
ds_read_u16 v152, v152
v_and_b32_e64 v153, s47, v153
v_exp_f16_sdwa v159, v159 dst_sel:WORD_1 dst_unused:UNUSED_PRESERVE src0_sel:WORD_1
v_pk_add_f16 v157, v157, 1.0 op_sel_hi:[1,0]
v_pk_add_f16 v159, v159, 1.0 op_sel_hi:[1,0]
v_rcp_f16_sdwa v157, v157 dst_sel:WORD_0 dst_unused:UNUSED_PRESERVE src0_sel:WORD_0
v_rcp_f16_sdwa v159, v159 dst_sel:WORD_0 dst_unused:UNUSED_PRESERVE src0_sel:WORD_0
v_rcp_f16_sdwa v157, v157 dst_sel:WORD_1 dst_unused:UNUSED_PRESERVE src0_sel:WORD_1
ds_read_u16_d16_hi v155, v155
ds_read_u16 v153, v153
v_bfe_u32 v190, v250, 4, 6
v_lshl_add_u32 v186, v190, 4, s72
s_mul_i32 s43, s40, 3
s_add_u32 s43, s43, 0
s_and_b32 s44, s43, 1
s_mul_i32 s44, s44, 3064
s_mul_i32 s43, s43, 3072
s_sub_u32 s43, s43, s44
s_add_u32 s43, s43, 90112
v_lshl_add_u32 v173, v190, 4, s43
s_mul_i32 s43, s40, 3
s_add_u32 s43, s43, 1
s_and_b32 s44, s43, 1
s_mul_i32 s44, s44, 3064
s_mul_i32 s43, s43, 3072
s_sub_u32 s43, s43, s44
s_add_u32 s43, s43, 90112
v_lshl_add_u32 v174, v190, 4, s43
s_mul_i32 s43, s40, 3
s_add_u32 s43, s43, 2
s_and_b32 s44, s43, 1
s_mul_i32 s44, s44, 3064
s_mul_i32 s43, s43, 3072
s_sub_u32 s43, s43, s44
s_add_u32 s43, s43, 90112
v_lshl_add_u32 v175, v190, 4, s43
v_lshl_add_u32 v187, v244, 2, s72
v_and_b32_e64 v189, 3, v190
v_bfe_u32 v191, v190, 2, 1
v_lshl_add_u32 v189, v191, 3, v189
v_bfe_u32 v191, v190, 3, 1
v_lshl_add_u32 v189, v191, 2, v189
v_bfe_u32 v191, v190, 4, 1
v_lshl_add_u32 v189, v191, 6, v189
v_bfe_u32 v191, v190, 5, 1
v_lshl_add_u32 v189, v191, 5, v189
v_lshlrev_b32_e64 v189, 4, v189
v_add_u32 v248, 16384, v189
v_add_u32 v249, 53248, v189
v_min_u32 v189, 11, v190
s_mul_i32 s43, s40, 12
v_add_u32 v189, s43, v189
v_cmp_gt_u32 vcc, 64, v189
v_lshlrev_b32_e64 v189, 2, v189
v_add_u32 v172, 93312, v189
v_add_u32 v191, 16128, v189
v_add_u32 v189, 7680, v189
v_cndmask_b32 v189, v189, v191, vcc
v_add_u32 v188, s72, v244
v_lshrrev_b32_e64 v191, 3, v190
v_mul_u32_u24 v191, 9120, v191
v_mul_u32_u24 v190, 12, v190
v_add_u32 v191, v191, v190
v_add_u32 v191, 93184, v191
ds_read_b64_tr_b16 v[72:73], v186
ds_read_b64_tr_b16 v[74:75], v186 offset:8
ds_read_b64_tr_b16 v[84:85], v186 offset:3072
s_waitcnt lgkmcnt(6)
ds_read_b64_tr_b16 v[86:87], v186 offset:3080
ds_read_b64_tr_b16 v[160:161], v186 offset:6144
ds_read_b64_tr_b16 v[162:163], v186 offset:6152
s_cmp_eq_u32 s77, 0
s_cbranch_scc1 Lpp6
s_call_b64 s[78:79], Lpolln
Lpp6:
ds_read_b64_tr_b16 v[76:77], v186 offset:1024
ds_read_b64_tr_b16 v[78:79], v186 offset:1032
ds_read_b64_tr_b16 v[88:89], v186 offset:4096
ds_read_b64_tr_b16 v[90:91], v186 offset:4104
ds_read_b64_tr_b16 v[164:165], v186 offset:7168
ds_read_b64_tr_b16 v[166:167], v186 offset:7176
v_rcp_f16_sdwa v159, v159 dst_sel:WORD_1 dst_unused:UNUSED_PRESERVE src0_sel:WORD_1
v_pk_mul_f16 v238, v156, v157
v_pk_mul_f16 v239, v158, v159
v_lshl_add_u64 v[232:233], v[144:145], 0, v[146:147]
v_lshl_add_u64 v[236:237], v[148:149], 0, v[150:151]
s_waitcnt lgkmcnt(12)
ds_read_b64_tr_b16 v[80:81], v186 offset:2048
ds_read_b64_tr_b16 v[82:83], v186 offset:2056
s_waitcnt vmcnt(4) lgkmcnt(13)
v_mfma_f32_16x16x16_bf16 v[120:123], v[72:73], v[176:177], 0
v_lshlrev_b32 v182, 16, v72
v_and_b32 v183, 4294901760, v72
s_waitcnt lgkmcnt(12)
v_mfma_f32_16x16x16_bf16 v[124:127], v[74:75], v[176:177], 0
v_cvt_pk_f16_f32 v72, v182, v183
v_lshlrev_b32 v184, 16, v73
s_waitcnt vmcnt(3) lgkmcnt(11)
v_mfma_f32_16x16x16_bf16 v[120:123], v[84:85], v[178:179], v[120:123]
v_and_b32 v185, 4294901760, v73
v_cvt_pk_f16_f32 v73, v184, v185
s_waitcnt lgkmcnt(10)
v_mfma_f32_16x16x16_bf16 v[124:127], v[86:87], v[178:179], v[124:127]
v_lshlrev_b32_e64 v182, 16, v74
v_and_b32 v183, 4294901760, v74
s_waitcnt vmcnt(2) lgkmcnt(8)
v_mfma_f32_16x16x16_bf16 v[120:123], v[160:161], v[180:181], v[120:123]
v_cvt_pk_f16_f32 v74, v182, v183
v_lshlrev_b32 v184, 16, v75
v_mfma_f32_16x16x16_bf16 v[124:127], v[162:163], v[180:181], v[124:127]
s_setprio 2
s_cmp_eq_u32 s77, 0
s_cbranch_scc1 Lpp7
s_nop 6
s_call_b64 s[78:79], Lpolln
Lpp7:
v_and_b32 v185, 4294901760, v75
v_cvt_pk_f16_f32 v75, v184, v185
v_lshlrev_b32_e64 v182, 16, v84
v_and_b32 v183, 4294901760, v84
v_lshlrev_b32 v184, 16, v85
v_and_b32 v185, 4294901760, v85
v_lshl_add_u64 v[234:235], v[152:153], 0, v[154:155]
v_permlane16_swap_b32 v232, v236
s_mov_b32 exec_lo, 65537
s_mov_b32 exec_hi, 65537
ds_write_b128 v187, v[120:123] offset:3200
ds_write_b128 v187, v[124:127] offset:3216
s_mov_b64 exec, -1
v_cvt_pk_f16_f32 v84, v182, v183
v_cvt_pk_f16_f32 v85, v184, v185
v_lshlrev_b32 v182, 16, v86
v_and_b32 v183, 4294901760, v86
v_cvt_pk_f16_f32 v86, v182, v183
v_lshlrev_b32_e64 v184, 16, v87
v_and_b32 v185, 4294901760, v87
v_cvt_pk_f16_f32 v87, v184, v185
v_lshlrev_b32_e64 v182, 16, v160
v_and_b32 v183, 4294901760, v160
v_cvt_pk_f16_f32 v160, v182, v183
v_lshlrev_b32_e64 v184, 16, v161
v_and_b32 v185, 4294901760, v161
v_cvt_pk_f16_f32 v161, v184, v185
v_lshlrev_b32_e64 v182, 16, v162
v_and_b32 v183, 4294901760, v162
v_cvt_pk_f16_f32 v162, v182, v183
s_cmp_eq_u32 s77, 0
s_cbranch_scc1 Lpp8
s_call_b64 s[78:79], Lpolln
Lpp8:
v_lshlrev_b32 v184, 16, v163
v_and_b32 v185, 4294901760, v163
v_cvt_pk_f16_f32 v163, v184, v185
s_waitcnt lgkmcnt(9)
v_mfma_f32_16x16x16_bf16 v[120:123], v[76:77], v[176:177], 0
v_lshlrev_b32_e64 v182, 16, v76
v_and_b32 v183, 4294901760, v76
s_waitcnt lgkmcnt(8)
v_mfma_f32_16x16x16_bf16 v[124:127], v[78:79], v[176:177], 0
v_cvt_pk_f16_f32 v76, v182, v183
v_lshlrev_b32 v184, 16, v77
s_waitcnt lgkmcnt(7)
v_mfma_f32_16x16x16_bf16 v[120:123], v[88:89], v[178:179], v[120:123]
v_and_b32 v185, 4294901760, v77
v_cvt_pk_f16_f32 v77, v184, v185
s_waitcnt lgkmcnt(6)
v_mfma_f32_16x16x16_bf16 v[124:127], v[90:91], v[178:179], v[124:127]
v_lshlrev_b32_e64 v182, 16, v78
v_and_b32 v183, 4294901760, v78
s_waitcnt lgkmcnt(5)
v_mfma_f32_16x16x16_bf16 v[120:123], v[164:165], v[180:181], v[120:123]
v_cvt_pk_f16_f32 v78, v182, v183
v_permlane16_swap_b32 v233, v237
s_waitcnt lgkmcnt(4)
v_mfma_f32_16x16x16_bf16 v[124:127], v[166:167], v[180:181], v[124:127]
s_setprio 1
v_permlane16_swap_b32 v234, v238
v_permlane16_swap_b32 v235, v239
v_lshlrev_b32 v184, 16, v79
v_and_b32 v185, 4294901760, v79
v_cvt_pk_f16_f32 v79, v184, v185
v_lshlrev_b32 v182, 16, v88
v_and_b32 v183, 4294901760, v88
v_cvt_pk_f16_f32 v88, v182, v183
s_nop 0
s_mov_b32 exec_lo, 65537
s_mov_b32 exec_hi, 65537
ds_write_b128 v187, v[120:123] offset:3328
ds_write_b128 v187, v[124:127] offset:3344
s_mov_b64 exec, -1
v_lshlrev_b32 v184, 16, v89
v_and_b32 v185, 4294901760, v89
v_cvt_pk_f16_f32 v89, v184, v185
s_cmp_eq_u32 s77, 0
s_cbranch_scc1 Lpp9
s_call_b64 s[78:79], Lpolln
Lpp9:
v_lshlrev_b32_e64 v182, 16, v90
v_and_b32 v183, 4294901760, v90
v_cvt_pk_f16_f32 v90, v182, v183
s_waitcnt vmcnt(0)
ds_read_b64_tr_b16 v[92:93], v186 offset:5120
ds_read_b64_tr_b16 v[94:95], v186 offset:5128
ds_read_b64_tr_b16 v[168:169], v186 offset:8192
ds_read_b64_tr_b16 v[170:171], v186 offset:8200
v_lshlrev_b32_e64 v184, 16, v91
v_and_b32 v185, 4294901760, v91
v_cvt_pk_f16_f32 v91, v184, v185
v_lshlrev_b32_e64 v182, 16, v164
v_and_b32 v183, 4294901760, v164
v_cvt_pk_f16_f32 v164, v182, v183
v_lshlrev_b32_e64 v184, 16, v165
v_and_b32 v185, 4294901760, v165
v_cvt_pk_f16_f32 v165, v184, v185
v_lshlrev_b32_e64 v182, 16, v166
v_and_b32 v183, 4294901760, v166
v_cvt_pk_f16_f32 v166, v182, v183
v_lshlrev_b32 v184, 16, v167
v_and_b32 v185, 4294901760, v167
v_cvt_pk_f16_f32 v167, v184, v185
s_waitcnt lgkmcnt(9)
v_mfma_f32_16x16x16_bf16 v[120:123], v[80:81], v[176:177], 0
v_lshlrev_b32 v182, 16, v80
v_and_b32 v183, 4294901760, v80
s_waitcnt lgkmcnt(8)
v_mfma_f32_16x16x16_bf16 v[124:127], v[82:83], v[176:177], 0
v_cvt_pk_f16_f32 v80, v182, v183
v_lshlrev_b32 v184, 16, v81
s_waitcnt lgkmcnt(3)
v_mfma_f32_16x16x16_bf16 v[120:123], v[92:93], v[178:179], v[120:123]
v_and_b32 v185, 4294901760, v81
v_cvt_pk_f16_f32 v81, v184, v185
s_waitcnt lgkmcnt(1)
v_mfma_f32_16x16x16_bf16 v[124:127], v[94:95], v[178:179], v[124:127]
v_lshlrev_b32 v182, 16, v82
v_and_b32 v183, 4294901760, v82
v_mfma_f32_16x16x16_bf16 v[120:123], v[168:169], v[180:181], v[120:123]
v_cvt_pk_f16_f32 v82, v182, v183
v_lshlrev_b32_e64 v184, 16, v83
s_waitcnt lgkmcnt(0)
v_mfma_f32_16x16x16_bf16 v[124:127], v[170:171], v[180:181], v[124:127]
s_cmp_eq_u32 s77, 0
s_cbranch_scc1 Lpp10
s_nop 7
s_call_b64 s[78:79], Lpolln
Lpp10:
s_setprio 0
v_and_b32 v185, 4294901760, v83
v_cvt_pk_f16_f32 v83, v184, v185
v_lshlrev_b32_e64 v182, 16, v92
v_and_b32 v183, 4294901760, v92
v_cvt_pk_f16_f32 v92, v182, v183
v_lshlrev_b32_e64 v184, 16, v93
v_and_b32 v185, 4294901760, v93
v_cvt_pk_f16_f32 v93, v184, v185
s_mov_b32 exec_lo, 65537
s_mov_b32 exec_hi, 65537
ds_write_b128 v187, v[120:123] offset:3456
ds_write_b128 v187, v[124:127] offset:3472
s_mov_b64 exec, -1
ds_read_b128 v[120:123], v248
ds_read_b128 v[124:127], v248 offset:2048
v_lshlrev_b32 v182, 16, v94
v_and_b32 v183, 4294901760, v94
v_cvt_pk_f16_f32 v94, v182, v183
v_lshlrev_b32_e64 v184, 16, v95
v_and_b32 v185, 4294901760, v95
v_cvt_pk_f16_f32 v95, v184, v185
s_cmp_eq_u32 s77, 0
s_cbranch_scc1 Lpp11
s_call_b64 s[78:79], Lpolln
Lpp11:
v_lshlrev_b32 v182, 16, v168
v_and_b32 v183, 4294901760, v168
v_cvt_pk_f16_f32 v168, v182, v183
v_lshlrev_b32_e64 v184, 16, v169
v_and_b32 v185, 4294901760, v169
v_cvt_pk_f16_f32 v169, v184, v185
v_lshlrev_b32_e64 v182, 16, v170
v_and_b32 v183, 4294901760, v170
v_cvt_pk_f16_f32 v170, v182, v183
v_lshlrev_b32_e64 v184, 16, v171
v_and_b32 v185, 4294901760, v171
v_cvt_pk_f16_f32 v171, v184, v185
s_cmp_eq_u32 s77, 0
s_cbranch_scc1 Lpp12
s_call_b64 s[78:79], Lpolln
Lpp12:
s_waitcnt lgkmcnt(0)
s_barrier
s_setprio 2
ds_read_b32 v176, v172
ds_read_b32 v177, v172 offset:9216
ds_read_b32 v178, v172 offset:18432
ds_read_b32 v179, v172 offset:27648
ds_read_b32 v180, v172 offset:36864
ds_read_b32 v181, v172 offset:46080
ds_read_b32 v182, v172 offset:55296
ds_read_b32 v183, v172 offset:64512
v_mfma_f32_16x16x32_bf16 v[144:147], v[120:123], v[48:51], 0
s_cmp_eq_u32 s77, 0
s_cbranch_scc1 Lpp13
s_nop 7
s_call_b64 s[78:79], Lpolln
Lpp13:
v_mfma_f32_16x16x32_bf16 v[148:151], v[120:123], v[52:55], 0
v_mfma_f32_16x16x32_bf16 v[152:155], v[120:123], v[24:27], 0
ds_read_b128 v[120:123], v248 offset:4096
v_mfma_f32_16x16x32_bf16 v[144:147], v[124:127], v[56:59], v[144:147]
s_waitcnt lgkmcnt(7)
v_add_f32 v176, v176, v177
v_mfma_f32_16x16x32_bf16 v[148:151], v[124:127], v[60:63], v[148:151]
s_waitcnt lgkmcnt(6)
v_add_f32 v176, v176, v178
s_waitcnt lgkmcnt(5)
v_add_f32 v176, v176, v179
s_cmp_eq_u32 s77, 0
s_cbranch_scc1 Lpp14
s_nop 3
s_call_b64 s[78:79], Lpolln
Lpp14:
s_waitcnt lgkmcnt(4)
v_add_f32 v176, v176, v180
s_waitcnt lgkmcnt(3)
v_add_f32 v176, v176, v181
s_waitcnt lgkmcnt(2)
v_add_f32 v176, v176, v182
s_waitcnt lgkmcnt(1)
v_add_f32 v176, v176, v183
ds_write_b32 v189, v176
v_mfma_f32_16x16x32_bf16 v[152:155], v[124:127], v[32:35], v[152:155]
ds_read_b128 v[124:127], v248 offset:256
s_waitcnt lgkmcnt(2)
v_mfma_f32_16x16x32_bf16 v[144:147], v[120:123], v[64:67], v[144:147]
v_mfma_f32_16x16x32_bf16 v[148:151], v[120:123], v[68:71], v[148:151]
s_cmp_eq_u32 s77, 0
s_cbranch_scc1 Lpp15
s_nop 7
s_call_b64 s[78:79], Lpolln
Lpp15:
v_mfma_f32_16x16x32_bf16 v[152:155], v[120:123], v[40:43], v[152:155]
ds_read_b128 v[120:123], v248 offset:2304
s_nop 2
v_cvt_pk_f16_f32 v144, v144, v145
v_cvt_pk_f16_f32 v146, v146, v147
v_pk_fma_f16 v145, v144, v144, s48
v_pk_fma_f16 v147, v146, v146, s48
v_cvt_pkrtz_f16_f32 v148, v148, v149
v_cvt_pkrtz_f16_f32 v149, v150, v151
v_lshrrev_b64 v[148:149], 2, v[148:149]
v_and_b32_sdwa v150, s47, v148 dst_sel:DWORD dst_unused:UNUSED_PAD src0_sel:DWORD src1_sel:WORD_1
v_and_b32 v148, s47, v148
s_waitcnt lgkmcnt(1)
v_mfma_f32_16x16x32_bf16 v[156:159], v[124:127], v[48:51], 0
ds_read_u16_d16_hi v150, v150
ds_read_u16 v148, v148
v_mfma_f32_16x16x32_bf16 v[176:179], v[124:127], v[52:55], 0
s_cmp_eq_u32 s77, 0
s_cbranch_scc1 Lpp16
s_nop 7
s_call_b64 s[78:79], Lpolln
Lpp16:
v_and_b32_sdwa v151, s47, v149 dst_sel:DWORD dst_unused:UNUSED_PAD src0_sel:DWORD src1_sel:WORD_1
v_and_b32 v149, s47, v149
v_mfma_f32_16x16x32_bf16 v[180:183], v[124:127], v[24:27], 0
ds_read_b128 v[124:127], v248 offset:4352
ds_read_u16_d16_hi v151, v151
s_waitcnt lgkmcnt(4)
v_mfma_f32_16x16x32_bf16 v[156:159], v[120:123], v[56:59], v[156:159]
ds_read_u16 v149, v149
v_pk_mul_f16 v145, v144, v145
v_mfma_f32_16x16x32_bf16 v[176:179], v[120:123], v[60:63], v[176:179]
v_pk_mul_f16 v147, v146, v147
v_cvt_pkrtz_f16_f32 v152, v152, v153
v_cvt_pkrtz_f16_f32 v153, v154, v155
v_lshrrev_b64 v[152:153], 2, v[152:153]
v_and_b32_sdwa v154, s47, v152 dst_sel:DWORD dst_unused:UNUSED_PAD src0_sel:DWORD src1_sel:WORD_1
v_and_b32_e64 v152, s47, v152
v_exp_f16_sdwa v145, v145 dst_sel:WORD_0 dst_unused:UNUSED_PRESERVE src0_sel:WORD_0
v_mfma_f32_16x16x32_bf16 v[180:183], v[120:123], v[32:35], v[180:183]
ds_read_u16_d16_hi v154, v154
ds_read_u16 v152, v152
s_cmp_eq_u32 s77, 0
s_cbranch_scc1 Lpp17
s_nop 5
s_call_b64 s[78:79], Lpolln
Lpp17:
v_exp_f16_sdwa v147, v147 dst_sel:WORD_0 dst_unused:UNUSED_PRESERVE src0_sel:WORD_0
v_and_b32_sdwa v155, s47, v153 dst_sel:DWORD dst_unused:UNUSED_PAD src0_sel:DWORD src1_sel:WORD_1
v_and_b32 v153, s47, v153
v_exp_f16_sdwa v145, v145 dst_sel:WORD_1 dst_unused:UNUSED_PRESERVE src0_sel:WORD_1
s_waitcnt lgkmcnt(4)
v_mfma_f32_16x16x32_bf16 v[156:159], v[124:127], v[64:67], v[156:159]
ds_read_u16_d16_hi v155, v155
ds_read_u16 v153, v153
v_mfma_f32_16x16x32_bf16 v[176:179], v[124:127], v[68:71], v[176:179]
v_exp_f16_sdwa v147, v147 dst_sel:WORD_1 dst_unused:UNUSED_PRESERVE src0_sel:WORD_1
v_mfma_f32_16x16x32_bf16 v[180:183], v[124:127], v[40:43], v[180:183]
v_pk_add_f16 v145, v145, 1.0 op_sel_hi:[1,0]
v_pk_add_f16 v147, v147, 1.0 op_sel_hi:[1,0]
s_cmp_eq_u32 s77, 0
s_cbranch_scc1 Lpp18
s_nop 5
s_call_b64 s[78:79], Lpolln
Lpp18:
v_rcp_f16_sdwa v145, v145 dst_sel:WORD_0 dst_unused:UNUSED_PRESERVE src0_sel:WORD_0
v_rcp_f16_sdwa v147, v147 dst_sel:WORD_0 dst_unused:UNUSED_PRESERVE src0_sel:WORD_0
v_cvt_pkrtz_f16_f32 v156, v156, v157
v_cvt_pkrtz_f16_f32 v157, v158, v159
v_lshrrev_b64 v[156:157], 2, v[156:157]
v_and_b32_sdwa v158, s47, v156 dst_sel:DWORD dst_unused:UNUSED_PAD src0_sel:DWORD src1_sel:WORD_1
v_and_b32_e64 v156, s47, v156
v_rcp_f16_sdwa v145, v145 dst_sel:WORD_1 dst_unused:UNUSED_PRESERVE src0_sel:WORD_1
v_and_b32_sdwa v159, s47, v157 dst_sel:DWORD dst_unused:UNUSED_PAD src0_sel:DWORD src1_sel:WORD_1
v_and_b32_e64 v157, s47, v157
v_rcp_f16_sdwa v147, v147 dst_sel:WORD_1 dst_unused:UNUSED_PRESERVE src0_sel:WORD_1
v_cvt_pkrtz_f16_f32 v176, v176, v177
v_cvt_pkrtz_f16_f32 v177, v178, v179
ds_read_u16_d16_hi v158, v158
ds_read_u16 v156, v156
ds_read_u16_d16_hi v159, v159
ds_read_u16 v157, v157
v_lshrrev_b64 v[176:177], 2, v[176:177]
v_and_b32_sdwa v178, s47, v176 dst_sel:DWORD dst_unused:UNUSED_PAD src0_sel:DWORD src1_sel:WORD_1
v_and_b32_e64 v176, s47, v176
v_pk_mul_f16 v144, v144, v145
v_and_b32_sdwa v179, s47, v177 dst_sel:DWORD dst_unused:UNUSED_PAD src0_sel:DWORD src1_sel:WORD_1
v_and_b32_e64 v177, s47, v177
v_pk_mul_f16 v145, v146, v147
s_waitcnt lgkmcnt(5)
v_lshl_add_u64 v[148:149], v[148:149], 0, v[150:151]
v_cvt_pkrtz_f16_f32 v180, v180, v181
ds_read_u16_d16_hi v178, v178
ds_read_u16 v176, v176
s_cmp_eq_u32 s77, 0
s_cbranch_scc1 Lpp19
s_call_b64 s[78:79], Lpolln
Lpp19:
ds_read_u16_d16_hi v179, v179
ds_read_u16 v177, v177
v_cvt_pkrtz_f16_f32 v181, v182, v183
v_lshrrev_b64 v[180:181], 2, v[180:181]
v_and_b32_sdwa v182, s47, v180 dst_sel:DWORD dst_unused:UNUSED_PAD src0_sel:DWORD src1_sel:WORD_1
v_and_b32_e64 v180, s47, v180
v_and_b32_sdwa v183, s47, v181 dst_sel:DWORD dst_unused:UNUSED_PAD src0_sel:DWORD src1_sel:WORD_1
v_and_b32 v181, s47, v181
s_waitcnt lgkmcnt(8)
v_lshl_add_u64 v[152:153], v[152:153], 0, v[154:155]
ds_read_u16_d16_hi v182, v182
ds_read_u16 v180, v180
ds_read_u16_d16_hi v183, v183
ds_read_u16 v181, v181
s_cmp_eq_u32 s77, 0
s_cbranch_scc1 Lpp20
s_call_b64 s[78:79], Lpolln
Lpp20:
s_cmp_eq_u32 s77, 0
s_cbranch_scc1 Lpp21
s_call_b64 s[78:79], Lpolln
Lpp21:
ds_read_b128 v[120:123], v248 offset:6144
s_waitcnt lgkmcnt(9)
v_lshl_add_u64 v[146:147], v[156:157], 0, v[158:159]
s_waitcnt lgkmcnt(5)
v_lshl_add_u64 v[150:151], v[176:177], 0, v[178:179]
s_waitcnt lgkmcnt(1)
v_lshl_add_u64 v[154:155], v[180:181], 0, v[182:183]
s_cmp_lg_u32 s40, 0
s_cbranch_scc1 Lspinx
s_setprio 3
Lspin:
s_cmp_eq_u32 s77, 0
s_cbranch_scc1 Lspiny
s_cmp_eq_u32 s76, 0
s_cbranch_scc1 Lspiny
s_sub_u32 s76, s76, 1
s_call_b64 s[78:79], Lpoll
s_branch Lspin
Lspiny:
ds_write_b32 v191, v128
ds_write_b32 v191, v129 offset:4
ds_write_b32 v191, v130 offset:8
s_waitcnt lgkmcnt(0)
Lspinx:
s_waitcnt lgkmcnt(0)
s_barrier
ds_read_b64 v[240:241], v188 offset:3072
ds_read_b64 v[242:243], v188 offset:3104
ds_read_b64 v[244:245], v188 offset:3136
ds_read_b128 v[128:131], v254 offset:8192
ds_read_b128 v[132:135], v254 offset:8208
ds_read_b128 v[136:139], v254 offset:8320
ds_read_b128 v[140:143], v254 offset:8336
s_waitcnt lgkmcnt(6)
v_pk_mul_f16 v72, v72, v240
v_pk_mul_f16 v73, v73, v241
v_and_b32 v72, s49, v72
v_and_b32 v73, s49, v73
s_waitcnt lgkmcnt(4)
v_pk_mul_f16 v74, v74, v240
v_pk_mul_f16 v75, v75, v241
v_and_b32 v74, s49, v74
v_and_b32 v75, s49, v75
v_pk_mul_f16 v76, v76, v240
v_pk_mul_f16 v77, v77, v241
v_and_b32 v76, s49, v76
v_and_b32 v77, s49, v77
v_pk_mul_f16 v78, v78, v240
v_pk_mul_f16 v79, v79, v241
ds_write_b64 v173, v[72:73]
ds_write_b64 v173, v[74:75] offset:3072
v_and_b32 v78, s49, v78
v_and_b32 v79, s49, v79
v_pk_mul_f16 v80, v80, v240
v_pk_mul_f16 v81, v81, v241
v_and_b32 v80, s49, v80
v_and_b32 v81, s49, v81
v_pk_mul_f16 v82, v82, v240
v_pk_mul_f16 v83, v83, v241
ds_write_b64 v173, v[76:77] offset:1024
ds_write_b64 v173, v[78:79] offset:4096
v_and_b32 v82, s49, v82
v_and_b32 v83, s49, v83
v_pk_mul_f16 v84, v84, v242
v_pk_mul_f16 v85, v85, v243
v_and_b32 v84, s49, v84
v_and_b32 v85, s49, v85
v_pk_mul_f16 v86, v86, v242
v_pk_mul_f16 v87, v87, v243
ds_write_b64 v173, v[80:81] offset:2048
ds_write_b64 v173, v[82:83] offset:5120
v_and_b32 v86, s49, v86
v_and_b32 v87, s49, v87
v_pk_mul_f16 v88, v88, v242
v_pk_mul_f16 v89, v89, v243
v_and_b32 v88, s49, v88
v_and_b32 v89, s49, v89
v_pk_mul_f16 v90, v90, v242
v_pk_mul_f16 v91, v91, v243
ds_write_b64 v174, v[84:85]
ds_write_b64 v174, v[86:87] offset:3072
v_and_b32 v90, s49, v90
v_and_b32 v91, s49, v91
v_pk_mul_f16 v92, v92, v242
v_pk_mul_f16 v93, v93, v243
v_and_b32 v92, s49, v92
v_and_b32 v93, s49, v93
v_pk_mul_f16 v94, v94, v242
v_pk_mul_f16 v95, v95, v243
ds_write_b64 v174, v[88:89] offset:1024
ds_write_b64 v174, v[90:91] offset:4096
v_and_b32 v94, s49, v94
v_and_b32 v95, s49, v95
v_pk_mul_f16 v160, v160, v244
v_pk_mul_f16 v161, v161, v245
v_and_b32 v160, s49, v160
v_and_b32 v161, s49, v161
v_pk_mul_f16 v162, v162, v244
v_pk_mul_f16 v163, v163, v245
ds_write_b64 v174, v[92:93] offset:2048
s_waitcnt lgkmcnt(6)
ds_write_b64 v174, v[94:95] offset:5120
v_and_b32 v162, s49, v162
v_and_b32_e64 v163, s49, v163
v_pk_mul_f16 v164, v164, v244
v_pk_mul_f16 v165, v165, v245
v_and_b32 v164, s49, v164
v_and_b32 v165, s49, v165
v_pk_mul_f16 v166, v166, v244
v_pk_mul_f16 v167, v167, v245
ds_write_b64 v175, v[160:161]
ds_write_b64 v175, v[162:163] offset:3072
v_and_b32 v166, s49, v166
v_and_b32 v167, s49, v167
v_pk_mul_f16 v168, v168, v244
v_pk_mul_f16 v169, v169, v245
v_and_b32 v168, s49, v168
v_and_b32 v169, s49, v169
v_pk_mul_f16 v170, v170, v244
v_pk_mul_f16 v171, v171, v245
ds_write_b64 v175, v[164:165] offset:1024
ds_write_b64 v175, v[166:167] offset:4096
v_and_b32_e64 v170, s49, v170
v_and_b32 v171, s49, v171
ds_write_b64 v175, v[168:169] offset:2048
ds_write_b64 v175, v[170:171] offset:5120
ds_read_b128 v[240:243], v254
ds_read_b128 v[244:247], v254 offset:16
s_waitcnt lgkmcnt(0)
s_barrier
ds_read_b128 v[124:127], v251 offset:20480
ds_read_b128 v[184:187], v251 offset:23552
ds_read_b128 v[188:191], v251 offset:21504
ds_read_b128 v[160:163], v251 offset:24576
buffer_load_dwordx4 v[164:167], v253, s[4:7], s71 offen
buffer_load_dwordx4 v[168:171], v253, s[4:7], s71 offen offset:64
v_mfma_f32_16x16x32_bf16 v[172:175], v[120:123], v[48:51], 0
s_setprio 3
v_mfma_f32_16x16x32_bf16 v[156:159], v[120:123], v[52:55], 0
v_mfma_f32_16x16x32_bf16 v[176:179], v[120:123], v[24:27], 0
ds_read_b128 v[120:123], v251 offset:22528
s_waitcnt lgkmcnt(4)
v_mfma_f32_16x16x32_f16 v[72:75], v[124:127], v[4:7], v[128:131]
v_mfma_f32_16x16x32_f16 v[128:131], v[124:127], v[0:3], v[128:131]
ds_read_b128 v[124:127], v248 offset:8192
s_waitcnt lgkmcnt(4)
v_mfma_f32_16x16x32_f16 v[76:79], v[184:187], v[4:7], v[132:135]
v_mfma_f32_16x16x32_f16 v[132:135], v[184:187], v[0:3], v[132:135]
ds_read_b128 v[184:187], v251 offset:25600
s_waitcnt lgkmcnt(4)
v_mfma_f32_16x16x32_f16 v[80:83], v[188:191], v[4:7], v[136:139]
v_mfma_f32_16x16x32_f16 v[136:139], v[188:191], v[0:3], v[136:139]
ds_read_b128 v[188:191], v251 offset:26624
s_waitcnt lgkmcnt(4)
v_mfma_f32_16x16x32_f16 v[84:87], v[160:163], v[4:7], v[140:143]
v_mfma_f32_16x16x32_f16 v[140:143], v[160:163], v[0:3], v[140:143]
ds_read_b128 v[160:163], v251 offset:29696
s_waitcnt lgkmcnt(4)
v_mfma_f32_16x16x32_f16 v[88:91], v[120:123], v[4:7], v[240:243]
s_waitcnt lgkmcnt(3)
v_mfma_f32_16x16x32_bf16 v[172:175], v[124:127], v[56:59], v[172:175]
v_mfma_f32_16x16x32_f16 v[240:243], v[120:123], v[0:3], v[240:243]
ds_read_b128 v[120:123], v251 offset:27648
s_waitcnt lgkmcnt(3)
v_mfma_f32_16x16x32_f16 v[92:95], v[184:187], v[4:7], v[244:247]
v_mfma_f32_16x16x32_f16 v[244:247], v[184:187], v[0:3], v[244:247]
ds_read_b128 v[184:187], v251 offset:30720
v_mfma_f32_16x16x32_bf16 v[156:159], v[124:127], v[60:63], v[156:159]
s_waitcnt lgkmcnt(3)
v_mfma_f32_16x16x32_f16 v[72:75], v[188:191], v[12:15], v[72:75]
v_mfma_f32_16x16x32_f16 v[128:131], v[188:191], v[8:11], v[128:131]
ds_read_b128 v[188:191], v251 offset:28672
s_waitcnt lgkmcnt(3)
v_mfma_f32_16x16x32_f16 v[76:79], v[160:163], v[12:15], v[76:79]
v_mfma_f32_16x16x32_bf16 v[176:179], v[124:127], v[32:35], v[176:179]
ds_read_b128 v[124:127], v248 offset:10240
v_mfma_f32_16x16x32_f16 v[132:135], v[160:163], v[8:11], v[132:135]
ds_read_b128 v[160:163], v251 offset:31744
s_waitcnt lgkmcnt(4)
v_mfma_f32_16x16x32_f16 v[80:83], v[120:123], v[12:15], v[80:83]
v_mfma_f32_16x16x32_f16 v[136:139], v[120:123], v[8:11], v[136:139]
ds_read_b128 v[120:123], v251 offset:32768
s_setprio 2
s_waitcnt lgkmcnt(4)
v_mfma_f32_16x16x32_f16 v[84:87], v[184:187], v[12:15], v[84:87]
v_mfma_f32_16x16x32_f16 v[140:143], v[184:187], v[8:11], v[140:143]
ds_read_b128 v[184:187], v248 offset:6400
s_waitcnt lgkmcnt(4)
v_mfma_f32_16x16x32_f16 v[88:91], v[188:191], v[12:15], v[88:91]
s_waitcnt lgkmcnt(3)
v_mfma_f32_16x16x32_bf16 v[172:175], v[124:127], v[64:67], v[172:175]
v_mfma_f32_16x16x32_bf16 v[156:159], v[124:127], v[68:71], v[156:159]
v_mfma_f32_16x16x32_f16 v[240:243], v[188:191], v[8:11], v[240:243]
ds_read_b128 v[188:191], v251 offset:33792
s_nop 4
v_cvt_pk_f16_f32 v172, v172, v173
s_waitcnt lgkmcnt(3)
v_mfma_f32_16x16x32_f16 v[92:95], v[160:163], v[12:15], v[92:95]
v_cvt_pk_f16_f32 v174, v174, v175
v_cvt_pkrtz_f16_f32 v156, v156, v157
v_mfma_f32_16x16x32_f16 v[244:247], v[160:163], v[8:11], v[244:247]
ds_read_b128 v[160:163], v251 offset:36864
v_cvt_pkrtz_f16_f32 v157, v158, v159
v_mfma_f32_16x16x32_bf16 v[176:179], v[124:127], v[40:43], v[176:179]
ds_read_b128 v[124:127], v251 offset:35840
v_lshrrev_b64 v[156:157], 2, v[156:157]
s_waitcnt lgkmcnt(3)
v_mfma_f32_16x16x32_f16 v[72:75], v[120:123], v[20:23], v[72:75]
v_and_b32_sdwa v158, s47, v156 dst_sel:DWORD dst_unused:UNUSED_PAD src0_sel:DWORD src1_sel:WORD_1
v_and_b32 v156, s47, v156
v_mfma_f32_16x16x32_f16 v[128:131], v[120:123], v[16:19], v[128:131]
ds_read_b128 v[120:123], v251 offset:34816
ds_read_u16_d16_hi v158, v158
v_mfma_f32_16x16x32_bf16 v[180:183], v[184:187], v[48:51], 0
ds_read_u16 v156, v156
v_pk_fma_f16 v173, v172, v172, s48
s_waitcnt lgkmcnt(5)
v_mfma_f32_16x16x32_f16 v[80:83], v[188:191], v[20:23], v[80:83]
v_and_b32_sdwa v159, s47, v157 dst_sel:DWORD dst_unused:UNUSED_PAD src0_sel:DWORD src1_sel:WORD_1
v_and_b32_e64 v157, s47, v157
v_mfma_f32_16x16x32_f16 v[136:139], v[188:191], v[16:19], v[136:139]
ds_read_b128 v[188:191], v252 offset:4096
ds_read_u16_d16_hi v159, v159
s_waitcnt lgkmcnt(5)
v_mfma_f32_16x16x32_f16 v[76:79], v[124:127], v[20:23], v[76:79]
ds_read_u16 v157, v157
v_pk_fma_f16 v175, v174, v174, s48
v_mfma_f32_16x16x32_f16 v[132:135], v[124:127], v[16:19], v[132:135]
ds_read_b128 v[124:127], v251 offset:37888
v_pk_mul_f16 v173, v172, v173
v_mfma_f32_16x16x32_bf16 v[0:3], v[184:187], v[52:55], 0
v_pk_mul_f16 v175, v174, v175
v_cvt_pkrtz_f16_f32 v176, v176, v177
v_mfma_f32_16x16x32_f16 v[84:87], v[160:163], v[20:23], v[84:87]
v_cvt_pkrtz_f16_f32 v177, v178, v179
v_lshrrev_b64 v[176:177], 2, v[176:177]
v_mfma_f32_16x16x32_f16 v[140:143], v[160:163], v[16:19], v[140:143]
ds_read_b128 v[160:163], v252 offset:7168
v_and_b32_sdwa v178, s47, v176 dst_sel:DWORD dst_unused:UNUSED_PAD src0_sel:DWORD src1_sel:WORD_1
s_waitcnt lgkmcnt(7)
v_mfma_f32_16x16x32_f16 v[88:91], v[120:123], v[20:23], v[88:91]
v_and_b32 v176, s47, v176
v_exp_f16_sdwa v173, v173 dst_sel:WORD_0 dst_unused:UNUSED_PRESERVE src0_sel:WORD_0
v_mfma_f32_16x16x32_bf16 v[4:7], v[184:187], v[24:27], 0
ds_read_b128 v[184:187], v248 offset:8448
ds_read_u16_d16_hi v178, v178
v_mfma_f32_16x16x32_f16 v[240:243], v[120:123], v[16:19], v[240:243]
ds_read_b128 v[120:123], v252 offset:5120
ds_read_u16 v176, v176
s_waitcnt lgkmcnt(8)
v_mfma_f32_16x16x32_f16 v[72:75], v[188:191], v[100:103], v[72:75]
s_setprio 1
v_exp_f16_sdwa v175, v175 dst_sel:WORD_0 dst_unused:UNUSED_PRESERVE src0_sel:WORD_0
v_mfma_f32_16x16x32_f16 v[128:131], v[188:191], v[96:99], v[128:131]
ds_read_b128 v[188:191], v252 offset:6144
v_and_b32_sdwa v179, s47, v177 dst_sel:DWORD dst_unused:UNUSED_PAD src0_sel:DWORD src1_sel:WORD_1
s_waitcnt lgkmcnt(6)
v_mfma_f32_16x16x32_f16 v[92:95], v[124:127], v[20:23], v[92:95]
v_mov_b32 v20, 0
v_mov_b32_e64 v21, 0
v_mfma_f32_16x16x32_f16 v[244:247], v[124:127], v[16:19], v[244:247]
ds_read_b128 v[124:127], v252 offset:8192
v_mov_b32 v16, 0
s_waitcnt lgkmcnt(5)
v_mfma_f32_16x16x32_bf16 v[180:183], v[184:187], v[56:59], v[180:183]
v_mov_b32_e64 v17, 0
v_cndmask_b32 v18, 0, v255, s[88:89]
v_cndmask_b32 v19, 0, v255, s[90:91]
v_mfma_f32_16x16x32_bf16 v[0:3], v[184:187], v[60:63], v[0:3]
v_and_b32 v177, s47, v177
v_exp_f16_sdwa v173, v173 dst_sel:WORD_1 dst_unused:UNUSED_PRESERVE src0_sel:WORD_1
v_mfma_f32_16x16x32_f16 v[76:79], v[160:163], v[100:103], v[76:79]
ds_read_u16_d16_hi v179, v179
ds_read_u16 v177, v177
v_mfma_f32_16x16x32_f16 v[132:135], v[160:163], v[96:99], v[132:135]
ds_read_b128 v[160:163], v252 offset:9216
v_exp_f16_sdwa v175, v175 dst_sel:WORD_1 dst_unused:UNUSED_PRESERVE src0_sel:WORD_1
s_waitcnt lgkmcnt(6)
v_mfma_f32_16x16x32_f16 v[80:83], v[120:123], v[100:103], v[80:83]
v_pk_add_f16 v173, v173, 1.0 op_sel_hi:[1,0]
v_pk_add_f16 v175, v175, 1.0 op_sel_hi:[1,0]
v_mfma_f32_16x16x32_bf16 v[4:7], v[184:187], v[32:35], v[4:7]
ds_read_b128 v[184:187], v248 offset:10496
v_rcp_f16_sdwa v173, v173 dst_sel:WORD_0 dst_unused:UNUSED_PRESERVE src0_sel:WORD_0
v_mfma_f32_16x16x32_f16 v[136:139], v[120:123], v[96:99], v[136:139]
ds_read_b128 v[120:123], v252 offset:10240
v_rcp_f16_sdwa v175, v175 dst_sel:WORD_0 dst_unused:UNUSED_PRESERVE src0_sel:WORD_0
s_waitcnt lgkmcnt(5)
v_mfma_f32_16x16x32_f16 v[84:87], v[124:127], v[100:103], v[84:87]
v_rcp_f16_sdwa v173, v173 dst_sel:WORD_1 dst_unused:UNUSED_PRESERVE src0_sel:WORD_1
v_mfma_f32_16x16x32_f16 v[140:143], v[124:127], v[96:99], v[140:143]
ds_read_b128 v[124:127], v252 offset:13312
v_rcp_f16_sdwa v175, v175 dst_sel:WORD_1 dst_unused:UNUSED_PRESERVE src0_sel:WORD_1
v_mfma_f32_16x16x32_f16 v[88:91], v[188:191], v[100:103], v[88:91]
v_mfma_f32_16x16x32_f16 v[240:243], v[188:191], v[96:99], v[240:243]
ds_read_b128 v[188:191], v248 offset:12288
s_waitcnt lgkmcnt(3)
v_mfma_f32_16x16x32_bf16 v[180:183], v[184:187], v[64:67], v[180:183]
v_mfma_f32_16x16x32_f16 v[92:95], v[160:163], v[100:103], v[92:95]
v_pk_mul_f16 v172, v172, v173
v_mfma_f32_16x16x32_bf16 v[0:3], v[184:187], v[68:71], v[0:3]
s_nop 4
v_cvt_pk_f16_f32 v180, v180, v181
v_mfma_f32_16x16x32_f16 v[244:247], v[160:163], v[96:99], v[244:247]
ds_read_b128 v[160:163], v252 offset:14336
v_cvt_pk_f16_f32 v182, v182, v183
s_waitcnt lgkmcnt(3)
v_mfma_f32_16x16x32_f16 v[72:75], v[120:123], v[108:111], v[72:75]
v_pk_fma_f16 v181, v180, v180, s48
v_cvt_pkrtz_f16_f32 v0, v0, v1
v_mfma_f32_16x16x32_f16 v[128:131], v[120:123], v[104:107], v[128:131]
ds_read_b128 v[120:123], v252 offset:12288
v_cvt_pkrtz_f16_f32 v1, v2, v3
v_mfma_f32_16x16x32_bf16 v[4:7], v[184:187], v[40:43], v[4:7]
ds_read_b128 v[184:187], v252 offset:11264
v_lshrrev_b64 v[0:1], 2, v[0:1]
s_waitcnt lgkmcnt(3)
v_mfma_f32_16x16x32_f16 v[76:79], v[124:127], v[108:111], v[76:79]
v_and_b32_sdwa v2, s47, v0 dst_sel:DWORD dst_unused:UNUSED_PAD src0_sel:DWORD src1_sel:WORD_1
v_and_b32 v0, s47, v0
v_mfma_f32_16x16x32_f16 v[132:135], v[124:127], v[104:107], v[132:135]
ds_read_b128 v[124:127], v252 offset:15360
s_setprio 0
ds_read_u16_d16_hi v2, v2
v_mfma_f32_16x16x32_bf16 v[8:11], v[188:191], v[48:51], 0
ds_read_u16 v0, v0
v_and_b32_sdwa v3, s47, v1 dst_sel:DWORD dst_unused:UNUSED_PAD src0_sel:DWORD src1_sel:WORD_1
s_waitcnt lgkmcnt(5)
v_mfma_f32_16x16x32_f16 v[84:87], v[160:163], v[108:111], v[84:87]
v_and_b32 v1, s47, v1
v_pk_fma_f16 v183, v182, v182, s48
v_mfma_f32_16x16x32_f16 v[140:143], v[160:163], v[104:107], v[140:143]
ds_read_b128 v[160:163], v251 offset:41984
ds_read_u16_d16_hi v3, v3
s_waitcnt lgkmcnt(5)
v_mfma_f32_16x16x32_f16 v[80:83], v[184:187], v[108:111], v[80:83]
ds_read_u16 v1, v1
v_pk_mul_f16 v181, v180, v181
v_mfma_f32_16x16x32_f16 v[136:139], v[184:187], v[104:107], v[136:139]
ds_read_b128 v[184:187], v251 offset:38912
v_pk_mul_f16 v183, v182, v183
v_mfma_f32_16x16x32_bf16 v[12:15], v[188:191], v[52:55], 0
v_cvt_pkrtz_f16_f32 v4, v4, v5
v_cvt_pkrtz_f16_f32 v5, v6, v7
v_mfma_f32_16x16x32_f16 v[88:91], v[120:123], v[108:111], v[88:91]
v_lshrrev_b64 v[4:5], 2, v[4:5]
v_and_b32_sdwa v6, s47, v4 dst_sel:DWORD dst_unused:UNUSED_PAD src0_sel:DWORD src1_sel:WORD_1
v_mfma_f32_16x16x32_f16 v[240:243], v[120:123], v[104:107], v[240:243]
ds_read_b128 v[120:123], v251 offset:39936
v_and_b32 v4, s47, v4
s_waitcnt lgkmcnt(7)
v_mfma_f32_16x16x32_f16 v[92:95], v[124:127], v[108:111], v[92:95]
ds_read_u16_d16_hi v6, v6
ds_read_u16 v4, v4
v_mfma_f32_16x16x32_bf16 v[96:99], v[188:191], v[24:27], 0
ds_read_b128 v[188:191], v248 offset:14336
v_pk_mul_f16 v173, v174, v175
v_mfma_f32_16x16x32_f16 v[244:247], v[124:127], v[104:107], v[244:247]
ds_read_b128 v[124:127], v251 offset:43008
buffer_load_dwordx4 v[100:103], v253, s[4:7], s71 offen offset:128
buffer_load_dwordx4 v[104:107], v253, s[4:7], s71 offen offset:192
s_waitcnt lgkmcnt(8)
v_mfma_f32_16x16x32_f16 v[76:79], v[160:163], v[196:199], v[76:79]
v_exp_f16_sdwa v181, v181 dst_sel:WORD_0 dst_unused:UNUSED_PRESERVE src0_sel:WORD_0
v_mfma_f32_16x16x32_f16 v[132:135], v[160:163], v[192:195], v[132:135]
ds_read_b128 v[160:163], v251 offset:44032
v_lshl_add_u64 v[156:157], v[156:157], 0, v[158:159]
s_waitcnt lgkmcnt(6)
v_mfma_f32_16x16x32_f16 v[72:75], v[184:187], v[196:199], v[72:75]
v_exp_f16_sdwa v183, v183 dst_sel:WORD_0 dst_unused:UNUSED_PRESERVE src0_sel:WORD_0
v_mfma_f32_16x16x32_f16 v[128:131], v[184:187], v[192:195], v[128:131]
ds_read_b128 v[184:187], v251 offset:40960
v_and_b32_sdwa v7, s47, v5 dst_sel:DWORD dst_unused:UNUSED_PAD src0_sel:DWORD src1_sel:WORD_1
s_waitcnt lgkmcnt(6)
v_mfma_f32_16x16x32_f16 v[80:83], v[120:123], v[196:199], v[80:83]
v_and_b32 v5, s47, v5
v_exp_f16_sdwa v181, v181 dst_sel:WORD_1 dst_unused:UNUSED_PRESERVE src0_sel:WORD_1
v_mfma_f32_16x16x32_f16 v[136:139], v[120:123], v[192:195], v[136:139]
ds_read_b128 v[120:123], v251 offset:45056
ds_read_u16_d16_hi v7, v7
ds_read_u16 v5, v5
s_waitcnt lgkmcnt(6)
v_mfma_f32_16x16x32_bf16 v[8:11], v[188:191], v[56:59], v[8:11]
v_lshl_add_u64 v[176:177], v[176:177], 0, v[178:179]
v_exp_f16_sdwa v183, v183 dst_sel:WORD_1 dst_unused:UNUSED_PRESERVE src0_sel:WORD_1
v_mfma_f32_16x16x32_bf16 v[12:15], v[188:191], v[60:63], v[12:15]
v_pk_add_f16 v181, v181, 1.0 op_sel_hi:[1,0]
v_pk_add_f16 v183, v183, 1.0 op_sel_hi:[1,0]
s_waitcnt lgkmcnt(5)
v_mfma_f32_16x16x32_f16 v[84:87], v[124:127], v[196:199], v[84:87]
v_rcp_f16_sdwa v181, v181 dst_sel:WORD_0 dst_unused:UNUSED_PRESERVE src0_sel:WORD_0
v_mfma_f32_16x16x32_f16 v[140:143], v[124:127], v[192:195], v[140:143]
ds_read_b128 v[124:127], v251 offset:48128
v_rcp_f16_sdwa v183, v183 dst_sel:WORD_0 dst_unused:UNUSED_PRESERVE src0_sel:WORD_0
v_mfma_f32_16x16x32_bf16 v[96:99], v[188:191], v[32:35], v[96:99]
ds_read_b128 v[188:191], v248 offset:16384
v_rcp_f16_sdwa v181, v181 dst_sel:WORD_1 dst_unused:UNUSED_PRESERVE src0_sel:WORD_1
s_waitcnt lgkmcnt(5)
v_mfma_f32_16x16x32_f16 v[88:91], v[184:187], v[196:199], v[88:91]
s_setprio 3
v_mfma_f32_16x16x32_f16 v[240:243], v[184:187], v[192:195], v[240:243]
ds_read_b128 v[184:187], v251 offset:46080
v_rcp_f16_sdwa v183, v183 dst_sel:WORD_1 dst_unused:UNUSED_PRESERVE src0_sel:WORD_1
v_mfma_f32_16x16x32_f16 v[92:95], v[160:163], v[196:199], v[92:95]
v_mfma_f32_16x16x32_f16 v[244:247], v[160:163], v[192:195], v[244:247]
ds_read_b128 v[160:163], v248 offset:12544
s_waitcnt lgkmcnt(4)
v_mfma_f32_16x16x32_f16 v[72:75], v[120:123], v[204:207], v[72:75]
s_waitcnt lgkmcnt(2)
v_mfma_f32_16x16x32_bf16 v[8:11], v[188:191], v[64:67], v[8:11]
v_pk_mul_f16 v174, v180, v181
v_mfma_f32_16x16x32_bf16 v[12:15], v[188:191], v[68:71], v[12:15]
v_mfma_f32_16x16x32_f16 v[128:131], v[120:123], v[200:203], v[128:131]
ds_read_b128 v[120:123], v251 offset:47104
v_pk_mul_f16 v175, v182, v183
v_mfma_f32_16x16x32_f16 v[76:79], v[124:127], v[204:207], v[76:79]
s_nop 1
v_cvt_pkrtz_f16_f32 v8, v8, v9
v_cvt_pkrtz_f16_f32 v9, v10, v11
v_mfma_f32_16x16x32_f16 v[132:135], v[124:127], v[200:203], v[132:135]
ds_read_b128 v[124:127], v251 offset:50176
v_lshrrev_b64 v[8:9], 2, v[8:9]
v_mfma_f32_16x16x32_bf16 v[96:99], v[188:191], v[40:43], v[96:99]
ds_read_b128 v[188:191], v251 offset:49152
v_and_b32_sdwa v10, s47, v8 dst_sel:DWORD dst_unused:UNUSED_PAD src0_sel:DWORD src1_sel:WORD_1
s_waitcnt lgkmcnt(3)
v_mfma_f32_16x16x32_f16 v[80:83], v[184:187], v[204:207], v[80:83]
v_and_b32_e64 v8, s47, v8
v_and_b32_sdwa v11, s47, v9 dst_sel:DWORD dst_unused:UNUSED_PAD src0_sel:DWORD src1_sel:WORD_1
v_mfma_f32_16x16x32_f16 v[136:139], v[184:187], v[200:203], v[136:139]
ds_read_b128 v[184:187], v251 offset:51200
ds_read_u16_d16_hi v10, v10
v_mfma_f32_16x16x32_bf16 v[108:111], v[160:163], v[48:51], 0
ds_read_u16 v8, v8
v_and_b32_e64 v9, s47, v9
s_waitcnt lgkmcnt(5)
v_mfma_f32_16x16x32_f16 v[88:91], v[120:123], v[204:207], v[88:91]
ds_read_u16_d16_hi v11, v11
ds_read_u16 v9, v9
v_mfma_f32_16x16x32_f16 v[240:243], v[120:123], v[200:203], v[240:243]
ds_read_b128 v[120:123], v251 offset:52224
v_cvt_pkrtz_f16_f32 v12, v12, v13
s_waitcnt lgkmcnt(6)
v_mfma_f32_16x16x32_f16 v[84:87], v[188:191], v[204:207], v[84:87]
v_cvt_pkrtz_f16_f32 v13, v14, v15
v_lshrrev_b64 v[12:13], 2, v[12:13]
v_mfma_f32_16x16x32_f16 v[140:143], v[188:191], v[200:203], v[140:143]
ds_read_b128 v[188:191], v251 offset:54272
v_and_b32_sdwa v14, s47, v12 dst_sel:DWORD dst_unused:UNUSED_PAD src0_sel:DWORD src1_sel:WORD_1
v_mfma_f32_16x16x32_bf16 v[192:195], v[160:163], v[52:55], 0
v_and_b32_e64 v12, s47, v12
v_and_b32_sdwa v15, s47, v13 dst_sel:DWORD dst_unused:UNUSED_PAD src0_sel:DWORD src1_sel:WORD_1
v_mfma_f32_16x16x32_f16 v[92:95], v[124:127], v[204:207], v[92:95]
ds_read_u16_d16_hi v14, v14
ds_read_u16 v12, v12
v_mfma_f32_16x16x32_f16 v[244:247], v[124:127], v[200:203], v[244:247]
ds_read_b128 v[124:127], v251 offset:55296
buffer_load_dwordx4 v[200:203], v253, s[4:7], s71 offen offset:256
buffer_load_dwordx4 v[204:207], v253, s[4:7], s71 offen offset:320
s_waitcnt lgkmcnt(9)
v_mfma_f32_16x16x32_f16 v[72:75], v[184:187], v[212:215], v[72:75]
v_and_b32 v13, s47, v13
v_lshl_add_u64 v[158:159], v[0:1], 0, v[2:3]
v_mfma_f32_16x16x32_bf16 v[196:199], v[160:163], v[24:27], 0
ds_read_b128 v[160:163], v248 offset:14592
ds_read_u16_d16_hi v15, v15
v_mfma_f32_16x16x32_f16 v[128:131], v[184:187], v[208:211], v[128:131]
ds_read_b128 v[184:187], v248 offset:16640
s_setprio 2
ds_read_u16 v13, v13
v_cvt_pkrtz_f16_f32 v96, v96, v97
v_cvt_pkrtz_f16_f32 v97, v98, v99
v_lshrrev_b64 v[96:97], 2, v[96:97]
s_waitcnt lgkmcnt(8)
v_mfma_f32_16x16x32_f16 v[80:83], v[120:123], v[212:215], v[80:83]
v_and_b32_sdwa v98, s47, v96 dst_sel:DWORD dst_unused:UNUSED_PAD src0_sel:DWORD src1_sel:WORD_1
v_and_b32 v96, s47, v96
s_waitcnt lgkmcnt(7)
v_mfma_f32_16x16x32_f16 v[76:79], v[188:191], v[212:215], v[76:79]
ds_read_u16_d16_hi v98, v98
ds_read_u16 v96, v96
v_mfma_f32_16x16x32_f16 v[132:135], v[188:191], v[208:211], v[132:135]
ds_read_b128 v[188:191], v251 offset:53248
v_and_b32_sdwa v99, s47, v97 dst_sel:DWORD dst_unused:UNUSED_PAD src0_sel:DWORD src1_sel:WORD_1
v_mfma_f32_16x16x32_f16 v[136:139], v[120:123], v[208:211], v[136:139]
ds_read_b128 v[120:123], v251 offset:57344
v_and_b32_e64 v97, s47, v97
v_lshl_add_u64 v[178:179], v[4:5], 0, v[6:7]
ds_read_u16_d16_hi v99, v99
ds_read_u16 v97, v97
s_waitcnt lgkmcnt(10)
v_mfma_f32_16x16x32_f16 v[84:87], v[124:127], v[212:215], v[84:87]
s_waitcnt lgkmcnt(9)
v_mfma_f32_16x16x32_bf16 v[108:111], v[160:163], v[56:59], v[108:111]
v_mfma_f32_16x16x32_bf16 v[192:195], v[160:163], v[60:63], v[192:195]
v_mfma_f32_16x16x32_bf16 v[196:199], v[160:163], v[32:35], v[196:199]
ds_read_b128 v[160:163], v251 offset:56320
v_mfma_f32_16x16x32_f16 v[140:143], v[124:127], v[208:211], v[140:143]
ds_read_b128 v[124:127], v248 offset:18432
s_waitcnt lgkmcnt(9)
v_mfma_f32_16x16x32_bf16 v[108:111], v[184:187], v[64:67], v[108:111]
v_mfma_f32_16x16x32_bf16 v[192:195], v[184:187], v[68:71], v[192:195]
v_mfma_f32_16x16x32_bf16 v[196:199], v[184:187], v[40:43], v[196:199]
ds_read_b128 v[184:187], v251 offset:60416
s_nop 4
v_cvt_pk_f16_f32 v108, v108, v109
v_cvt_pk_f16_f32 v110, v110, v111
v_pk_fma_f16 v109, v108, v108, s48
v_pk_fma_f16 v111, v110, v110, s48
v_cvt_pkrtz_f16_f32 v192, v192, v193
v_cvt_pkrtz_f16_f32 v193, v194, v195
s_waitcnt lgkmcnt(6)
v_mfma_f32_16x16x32_f16 v[88:91], v[188:191], v[212:215], v[88:91]
v_lshrrev_b64 v[192:193], 2, v[192:193]
v_and_b32_sdwa v194, s47, v192 dst_sel:DWORD dst_unused:UNUSED_PAD src0_sel:DWORD src1_sel:WORD_1
v_mfma_f32_16x16x32_f16 v[240:243], v[188:191], v[208:211], v[240:243]
ds_read_b128 v[188:191], v251 offset:58368
v_and_b32 v192, s47, v192
s_waitcnt lgkmcnt(6)
v_mfma_f32_16x16x32_f16 v[72:75], v[120:123], v[228:231], v[72:75]
s_setprio 1
ds_read_u16_d16_hi v194, v194
ds_read_u16 v192, v192
v_mfma_f32_16x16x32_f16 v[128:131], v[120:123], v[224:227], v[128:131]
ds_read_b128 v[120:123], v248 offset:20480
v_and_b32_sdwa v195, s47, v193 dst_sel:DWORD dst_unused:UNUSED_PAD src0_sel:DWORD src1_sel:WORD_1
v_and_b32 v193, s47, v193
v_pk_mul_f16 v109, v108, v109
v_pk_mul_f16 v111, v110, v111
s_waitcnt lgkmcnt(6)
v_mfma_f32_16x16x32_f16 v[92:95], v[160:163], v[212:215], v[92:95]
ds_read_u16_d16_hi v195, v195
ds_read_u16 v193, v193
v_mfma_f32_16x16x32_f16 v[244:247], v[160:163], v[208:211], v[244:247]
ds_read_b128 v[160:163], v251 offset:61440
v_cvt_pkrtz_f16_f32 v196, v196, v197
s_waitcnt lgkmcnt(8)
v_mfma_f32_16x16x32_bf16 v[208:211], v[124:127], v[48:51], 0
v_cvt_pkrtz_f16_f32 v197, v198, v199
v_lshrrev_b64 v[196:197], 2, v[196:197]
s_waitcnt lgkmcnt(7)
v_mfma_f32_16x16x32_f16 v[76:79], v[184:187], v[228:231], v[76:79]
v_and_b32_sdwa v198, s47, v196 dst_sel:DWORD dst_unused:UNUSED_PAD src0_sel:DWORD src1_sel:WORD_1
v_and_b32 v196, s47, v196
v_mfma_f32_16x16x32_bf16 v[212:215], v[124:127], v[52:55], 0
ds_read_u16_d16_hi v198, v198
ds_read_u16 v196, v196
v_mfma_f32_16x16x32_f16 v[132:135], v[184:187], v[224:227], v[132:135]
ds_read_b128 v[184:187], v251 offset:62464
v_lshl_add_u64 v[8:9], v[8:9], 0, v[10:11]
s_waitcnt lgkmcnt(9)
v_mfma_f32_16x16x32_f16 v[80:83], v[188:191], v[228:231], v[80:83]
v_exp_f16_sdwa v109, v109 dst_sel:WORD_0 dst_unused:UNUSED_PRESERVE src0_sel:WORD_0
v_mfma_f32_16x16x32_bf16 v[180:183], v[124:127], v[24:27], 0
ds_read_b128 v[124:127], v251 offset:59392
v_exp_f16_sdwa v111, v111 dst_sel:WORD_0 dst_unused:UNUSED_PRESERVE src0_sel:WORD_0
v_mfma_f32_16x16x32_f16 v[136:139], v[188:191], v[224:227], v[136:139]
ds_read_b128 v[188:191], v248 offset:22528
v_and_b32_sdwa v199, s47, v197 dst_sel:DWORD dst_unused:UNUSED_PAD src0_sel:DWORD src1_sel:WORD_1
s_waitcnt lgkmcnt(8)
v_mfma_f32_16x16x32_bf16 v[208:211], v[120:123], v[56:59], v[208:211]
v_and_b32 v197, s47, v197
v_lshl_add_u64 v[12:13], v[12:13], 0, v[14:15]
v_mfma_f32_16x16x32_bf16 v[212:215], v[120:123], v[60:63], v[212:215]
ds_read_u16_d16_hi v199, v199
ds_read_u16 v197, v197
s_waitcnt lgkmcnt(7)
v_mfma_f32_16x16x32_f16 v[84:87], v[160:163], v[228:231], v[84:87]
v_exp_f16_sdwa v109, v109 dst_sel:WORD_1 dst_unused:UNUSED_PRESERVE src0_sel:WORD_1
v_mfma_f32_16x16x32_f16 v[140:143], v[160:163], v[224:227], v[140:143]
ds_read_b128 v[160:163], v251 offset:8192
v_exp_f16_sdwa v111, v111 dst_sel:WORD_1 dst_unused:UNUSED_PRESERVE src0_sel:WORD_1
v_mfma_f32_16x16x32_bf16 v[180:183], v[120:123], v[32:35], v[180:183]
ds_read_b128 v[120:123], v251 offset:11264
v_lshl_add_u64 v[96:97], v[96:97], 0, v[98:99]
s_waitcnt lgkmcnt(6)
v_mfma_f32_16x16x32_f16 v[92:95], v[184:187], v[228:231], v[92:95]
s_setprio 0
v_pk_add_f16 v109, v109, 1.0 op_sel_hi:[1,0]
v_pk_add_f16 v111, v111, 1.0 op_sel_hi:[1,0]
s_waitcnt lgkmcnt(5)
v_mfma_f32_16x16x32_f16 v[88:91], v[124:127], v[228:231], v[88:91]
v_rcp_f16_sdwa v109, v109 dst_sel:WORD_0 dst_unused:UNUSED_PRESERVE src0_sel:WORD_0
v_mfma_f32_16x16x32_f16 v[240:243], v[124:127], v[224:227], v[240:243]
ds_read_b128 v[124:127], v251 offset:9216
v_rcp_f16_sdwa v111, v111 dst_sel:WORD_0 dst_unused:UNUSED_PRESERVE src0_sel:WORD_0
v_mfma_f32_16x16x32_f16 v[244:247], v[184:187], v[224:227], v[244:247]
ds_read_b128 v[184:187], v248 offset:18688
v_rcp_f16_sdwa v109, v109 dst_sel:WORD_1 dst_unused:UNUSED_PRESERVE src0_sel:WORD_1
s_waitcnt lgkmcnt(6)
v_mfma_f32_16x16x32_bf16 v[208:211], v[188:191], v[64:67], v[208:211]
v_rcp_f16_sdwa v111, v111 dst_sel:WORD_1 dst_unused:UNUSED_PRESERVE src0_sel:WORD_1
s_waitcnt lgkmcnt(3)
v_mfma_f32_16x16x32_f16 v[72:75], v[160:163], v[116:119], v[72:75]
v_mfma_f32_16x16x32_f16 v[128:131], v[160:163], v[112:115], v[128:131]
ds_read_b128 v[160:163], v251 offset:10240
s_nop 2
v_cvt_pk_f16_f32 v208, v208, v209
v_mfma_f32_16x16x32_bf16 v[212:215], v[188:191], v[68:71], v[212:215]
v_cvt_pk_f16_f32 v210, v210, v211
v_pk_fma_f16 v209, v208, v208, s48
s_waitcnt lgkmcnt(3)
v_mfma_f32_16x16x32_f16 v[76:79], v[120:123], v[116:119], v[76:79]
v_pk_fma_f16 v211, v210, v210, s48
v_pk_mul_f16 v209, v208, v209
v_mfma_f32_16x16x32_f16 v[132:135], v[120:123], v[112:115], v[132:135]
ds_read_b128 v[120:123], v251 offset:13312
v_cvt_pkrtz_f16_f32 v212, v212, v213
v_mfma_f32_16x16x32_bf16 v[180:183], v[188:191], v[40:43], v[180:183]
ds_read_b128 v[188:191], v251 offset:12288
v_cvt_pkrtz_f16_f32 v213, v214, v215
s_waitcnt lgkmcnt(3)
v_mfma_f32_16x16x32_f16 v[80:83], v[124:127], v[116:119], v[80:83]
v_lshrrev_b64 v[212:213], 2, v[212:213]
v_and_b32_sdwa v214, s47, v212 dst_sel:DWORD dst_unused:UNUSED_PAD src0_sel:DWORD src1_sel:WORD_1
v_mfma_f32_16x16x32_bf16 v[0:3], v[184:187], v[48:51], 0
v_and_b32 v212, s47, v212
v_and_b32_sdwa v215, s47, v213 dst_sel:DWORD dst_unused:UNUSED_PAD src0_sel:DWORD src1_sel:WORD_1
v_mfma_f32_16x16x32_f16 v[136:139], v[124:127], v[112:115], v[136:139]
ds_read_b128 v[124:127], v248 offset:20736
ds_read_u16_d16_hi v214, v214
v_mfma_f32_16x16x32_bf16 v[4:7], v[184:187], v[52:55], 0
ds_read_u16 v212, v212
v_and_b32 v213, s47, v213
s_waitcnt lgkmcnt(5)
v_mfma_f32_16x16x32_f16 v[88:91], v[160:163], v[116:119], v[88:91]
ds_read_u16_d16_hi v215, v215
ds_read_u16 v213, v213
s_waitcnt lgkmcnt(5)
v_mfma_f32_16x16x32_f16 v[84:87], v[188:191], v[116:119], v[84:87]
v_pk_mul_f16 v10, v108, v109
v_pk_mul_f16 v211, v210, v211
v_mfma_f32_16x16x32_f16 v[140:143], v[188:191], v[112:115], v[140:143]
ds_read_b128 v[188:191], v251 offset:17408
s_setprio 3
v_cvt_pkrtz_f16_f32 v180, v180, v181
v_mfma_f32_16x16x32_bf16 v[224:227], v[184:187], v[24:27], 0
ds_read_b128 v[184:187], v251 offset:14336
v_cvt_pkrtz_f16_f32 v181, v182, v183
v_mfma_f32_16x16x32_f16 v[240:243], v[160:163], v[112:115], v[240:243]
ds_read_b128 v[160:163], v248 offset:22784
v_lshrrev_b64 v[180:181], 2, v[180:181]
v_mfma_f32_16x16x32_f16 v[92:95], v[120:123], v[116:119], v[92:95]
v_and_b32_sdwa v182, s47, v180 dst_sel:DWORD dst_unused:UNUSED_PAD src0_sel:DWORD src1_sel:WORD_1
v_and_b32 v180, s47, v180
s_waitcnt lgkmcnt(7)
v_mfma_f32_16x16x32_bf16 v[0:3], v[124:127], v[56:59], v[0:3]
ds_read_u16_d16_hi v182, v182
ds_read_u16 v180, v180
v_mfma_f32_16x16x32_f16 v[244:247], v[120:123], v[112:115], v[244:247]
ds_read_b128 v[120:123], v251 offset:15360
v_pk_mul_f16 v11, v110, v111
s_waitcnt vmcnt(5)
v_mfma_f32_16x16x32_bf16 v[128:131], v[18:21], v[164:167], v[128:131]
v_exp_f16_sdwa v209, v209 dst_sel:WORD_0 dst_unused:UNUSED_PRESERVE src0_sel:WORD_0
v_mfma_f32_16x16x32_bf16 v[132:135], v[16:19], v[164:167], v[132:135]
v_lshl_add_u64 v[14:15], v[192:193], 0, v[194:195]
v_exp_f16_sdwa v211, v211 dst_sel:WORD_0 dst_unused:UNUSED_PRESERVE src0_sel:WORD_0
s_waitcnt vmcnt(4)
v_mfma_f32_16x16x32_bf16 v[136:139], v[18:21], v[168:171], v[136:139]
v_and_b32_sdwa v183, s47, v181 dst_sel:DWORD dst_unused:UNUSED_PAD src0_sel:DWORD src1_sel:WORD_1
v_and_b32 v181, s47, v181
v_mfma_f32_16x16x32_bf16 v[140:143], v[16:19], v[168:171], v[140:143]
ds_read_u16_d16_hi v183, v183
ds_read_u16 v181, v181
s_waitcnt lgkmcnt(6)
v_mfma_f32_16x16x32_f16 v[72:75], v[184:187], v[220:223], v[72:75]
v_exp_f16_sdwa v209, v209 dst_sel:WORD_1 dst_unused:UNUSED_PRESERVE src0_sel:WORD_1
v_mfma_f32_16x16x32_bf16 v[4:7], v[124:127], v[60:63], v[4:7]
v_lshl_add_u64 v[98:99], v[196:197], 0, v[198:199]
v_exp_f16_sdwa v211, v211 dst_sel:WORD_1 dst_unused:UNUSED_PRESERVE src0_sel:WORD_1
v_mfma_f32_16x16x32_f16 v[128:131], v[184:187], v[216:219], v[128:131]
ds_read_b128 v[184:187], v251 offset:16384
v_pk_add_f16 v209, v209, 1.0 op_sel_hi:[1,0]
v_mfma_f32_16x16x32_bf16 v[224:227], v[124:127], v[32:35], v[224:227]
ds_read_b128 v[124:127], v251 offset:18432
v_pk_add_f16 v211, v211, 1.0 op_sel_hi:[1,0]
v_mfma_f32_16x16x32_f16 v[76:79], v[188:191], v[220:223], v[76:79]
v_rcp_f16_sdwa v209, v209 dst_sel:WORD_0 dst_unused:UNUSED_PRESERVE src0_sel:WORD_0
v_mfma_f32_16x16x32_f16 v[132:135], v[188:191], v[216:219], v[132:135]
ds_read_b128 v[188:191], v248 offset:24576
v_rcp_f16_sdwa v211, v211 dst_sel:WORD_0 dst_unused:UNUSED_PRESERVE src0_sel:WORD_0
s_waitcnt lgkmcnt(5)
v_mfma_f32_16x16x32_bf16 v[0:3], v[160:163], v[64:67], v[0:3]
v_rcp_f16_sdwa v209, v209 dst_sel:WORD_1 dst_unused:UNUSED_PRESERVE src0_sel:WORD_1
v_mfma_f32_16x16x32_f16 v[80:83], v[120:123], v[220:223], v[80:83]
v_rcp_f16_sdwa v211, v211 dst_sel:WORD_1 dst_unused:UNUSED_PRESERVE src0_sel:WORD_1
v_mfma_f32_16x16x32_f16 v[136:139], v[120:123], v[216:219], v[136:139]
ds_read_b128 v[120:123], v251 offset:63488
s_nop 2
v_cvt_pkrtz_f16_f32 v0, v0, v1
v_mfma_f32_16x16x32_bf16 v[4:7], v[160:163], v[68:71], v[4:7]
v_cvt_pkrtz_f16_f32 v1, v2, v3
v_lshrrev_b64 v[0:1], 2, v[0:1]
s_waitcnt lgkmcnt(2)
v_mfma_f32_16x16x32_f16 v[84:87], v[124:127], v[220:223], v[84:87]
s_setprio 2
v_and_b32_sdwa v2, s47, v0 dst_sel:DWORD dst_unused:UNUSED_PAD src0_sel:DWORD src1_sel:WORD_1
v_and_b32_e64 v0, s47, v0
v_mfma_f32_16x16x32_f16 v[140:143], v[124:127], v[216:219], v[140:143]
ds_read_b128 v[124:127], v252 offset:1024
ds_read_u16_d16_hi v2, v2
v_mfma_f32_16x16x32_bf16 v[224:227], v[160:163], v[40:43], v[224:227]
ds_read_b128 v[160:163], v251 offset:19456
ds_read_u16 v0, v0
v_mfma_f32_16x16x32_f16 v[88:91], v[184:187], v[220:223], v[88:91]
v_and_b32_sdwa v3, s47, v1 dst_sel:DWORD dst_unused:UNUSED_PAD src0_sel:DWORD src1_sel:WORD_1
v_and_b32_e64 v1, s47, v1
v_mfma_f32_16x16x32_f16 v[240:243], v[184:187], v[216:219], v[240:243]
ds_read_b128 v[184:187], v248 offset:26624
ds_read_u16_d16_hi v3, v3
s_waitcnt lgkmcnt(7)
v_mfma_f32_16x16x32_bf16 v[228:231], v[188:191], v[48:51], 0
ds_read_u16 v1, v1
v_cvt_pkrtz_f16_f32 v4, v4, v5
v_mfma_f32_16x16x32_bf16 v[112:115], v[188:191], v[52:55], 0
v_cvt_pkrtz_f16_f32 v5, v6, v7
v_lshrrev_b64 v[4:5], 2, v[4:5]
s_waitcnt vmcnt(3)
v_mfma_f32_16x16x32_bf16 v[240:243], v[18:21], v[100:103], v[240:243]
v_and_b32_sdwa v6, s47, v4 dst_sel:DWORD dst_unused:UNUSED_PAD src0_sel:DWORD src1_sel:WORD_1
v_and_b32 v4, s47, v4
s_waitcnt vmcnt(2)
v_mfma_f32_16x16x32_bf16 v[72:75], v[18:21], v[104:107], v[72:75]
ds_read_u16_d16_hi v6, v6
ds_read_u16 v4, v4
v_mfma_f32_16x16x32_bf16 v[76:79], v[16:19], v[104:107], v[76:79]
v_pk_mul_f16 v208, v208, v209
v_and_b32_sdwa v7, s47, v5 dst_sel:DWORD dst_unused:UNUSED_PAD src0_sel:DWORD src1_sel:WORD_1
s_waitcnt lgkmcnt(6)
v_mfma_f32_16x16x32_f16 v[92:95], v[160:163], v[220:223], v[92:95]
v_and_b32 v5, s47, v5
v_pk_mul_f16 v209, v210, v211
v_mfma_f32_16x16x32_f16 v[244:247], v[160:163], v[216:219], v[244:247]
ds_read_b128 v[160:163], v252 offset:2048
ds_read_u16_d16_hi v7, v7
v_mfma_f32_16x16x32_bf16 v[244:247], v[16:19], v[100:103], v[244:247]
ds_read_u16 v5, v5
v_lshl_add_u64 v[212:213], v[212:213], 0, v[214:215]
v_mfma_f32_16x16x32_f16 v[72:75], v[120:123], v[236:239], v[72:75]
v_cvt_pkrtz_f16_f32 v224, v224, v225
v_cvt_pkrtz_f16_f32 v225, v226, v227
v_mfma_f32_16x16x32_bf16 v[116:119], v[188:191], v[24:27], 0
ds_read_b128 v[188:191], v251 offset:64512
v_lshrrev_b64 v[224:225], 2, v[224:225]
v_mfma_f32_16x16x32_f16 v[128:131], v[120:123], v[232:235], v[128:131]
ds_read_b128 v[120:123], v248 offset:28672
s_nop 0
v_cvt_pk_bf16_f32 v72, v72, v73
v_mfma_f32_16x16x32_f16 v[76:79], v[124:127], v[236:239], v[76:79]
v_cvt_pk_bf16_f32 v73, v74, v75
v_and_b32_sdwa v226, s47, v224 dst_sel:DWORD dst_unused:UNUSED_PAD src0_sel:DWORD src1_sel:WORD_1
s_waitcnt lgkmcnt(7)
v_mfma_f32_16x16x32_bf16 v[228:231], v[184:187], v[56:59], v[228:231]
v_and_b32_e64 v224, s47, v224
v_cvt_pk_bf16_f32 v128, v128, v129
v_mfma_f32_16x16x32_f16 v[132:135], v[124:127], v[232:235], v[132:135]
ds_read_b128 v[124:127], v252
v_cvt_pk_bf16_f32 v129, v130, v131
v_mfma_f32_16x16x32_bf16 v[112:115], v[184:187], v[60:63], v[112:115]
v_cvt_pk_bf16_f32 v74, v76, v77
v_cvt_pk_bf16_f32 v75, v78, v79
v_mfma_f32_16x16x32_bf16 v[116:119], v[184:187], v[32:35], v[116:119]
ds_read_b128 v[76:79], v254 offset:8208
s_nop 0
v_cvt_pk_bf16_f32 v130, v132, v133
v_cvt_pk_bf16_f32 v131, v134, v135
s_setprio 1
ds_read_b128 v[132:135], v254 offset:8192
ds_read_b128 v[184:187], v252 offset:3072
s_waitcnt lgkmcnt(8)
v_mfma_f32_16x16x32_f16 v[84:87], v[160:163], v[236:239], v[84:87]
ds_read_u16_d16_hi v226, v226
ds_read_u16 v224, v224
s_waitcnt lgkmcnt(7)
v_mfma_f32_16x16x32_f16 v[80:83], v[188:191], v[236:239], v[80:83]
v_and_b32_sdwa v227, s47, v225 dst_sel:DWORD dst_unused:UNUSED_PAD src0_sel:DWORD src1_sel:WORD_1
v_and_b32_e64 v225, s47, v225
v_mfma_f32_16x16x32_f16 v[136:139], v[188:191], v[232:235], v[136:139]
ds_read_b128 v[188:191], v251 offset:8192
ds_read_u16_d16_hi v227, v227
v_mfma_f32_16x16x32_f16 v[140:143], v[160:163], v[232:235], v[140:143]
ds_read_b128 v[160:163], v248 offset:24832
ds_read_u16 v225, v225
s_waitcnt lgkmcnt(10)
v_mfma_f32_16x16x32_bf16 v[228:231], v[120:123], v[64:67], v[228:231]
v_lshl_add_u64 v[180:181], v[180:181], 0, v[182:183]
v_cvt_pk_bf16_f32 v136, v136, v137
v_cvt_pk_bf16_f32 v137, v138, v139
s_waitcnt lgkmcnt(9)
v_mfma_f32_16x16x32_f16 v[88:91], v[124:127], v[236:239], v[88:91]
v_cvt_pk_bf16_f32 v138, v140, v141
v_cvt_pk_bf16_f32 v139, v142, v143
v_mfma_f32_16x16x32_f16 v[240:243], v[124:127], v[232:235], v[240:243]
ds_read_b128 v[140:143], v254 offset:8320
ds_read_b128 v[124:127], v248 offset:26880
v_mfma_f32_16x16x32_bf16 v[112:115], v[120:123], v[68:71], v[112:115]
v_cvt_pk_f16_f32 v228, v228, v229
v_cvt_pk_f16_f32 v230, v230, v231
s_waitcnt lgkmcnt(8)
v_mfma_f32_16x16x32_f16 v[92:95], v[184:187], v[236:239], v[92:95]
v_pk_fma_f16 v229, v228, v228, s48
v_cvt_pk_bf16_f32 v240, v240, v241
v_cvt_pk_bf16_f32 v241, v242, v243
v_mfma_f32_16x16x32_f16 v[244:247], v[184:187], v[232:235], v[244:247]
ds_read_b128 v[184:187], v251 offset:9216
v_cvt_pkrtz_f16_f32 v112, v112, v113
v_mfma_f32_16x16x32_bf16 v[116:119], v[120:123], v[40:43], v[116:119]
ds_read_b128 v[120:123], v251 offset:11264
v_cvt_pkrtz_f16_f32 v113, v114, v115
s_waitcnt vmcnt(1)
v_mfma_f32_16x16x32_bf16 v[80:83], v[18:21], v[200:203], v[80:83]
v_lshrrev_b64 v[112:113], 2, v[112:113]
v_cvt_pk_bf16_f32 v242, v244, v245
v_cvt_pk_bf16_f32 v243, v246, v247
v_mfma_f32_16x16x32_bf16 v[84:87], v[16:19], v[200:203], v[84:87]
ds_read_b128 v[244:247], v254
v_and_b32_sdwa v114, s47, v112 dst_sel:DWORD dst_unused:UNUSED_PAD src0_sel:DWORD src1_sel:WORD_1
s_waitcnt vmcnt(0)
v_mfma_f32_16x16x32_bf16 v[88:91], v[18:21], v[204:207], v[88:91]
v_cvt_pk_bf16_f32 v80, v80, v81
v_cvt_pk_bf16_f32 v81, v82, v83
v_mfma_f32_16x16x32_bf16 v[92:95], v[16:19], v[204:207], v[92:95]
v_and_b32_e64 v112, s47, v112
v_cvt_pk_bf16_f32 v82, v84, v85
v_cvt_pk_bf16_f32 v83, v86, v87
s_waitcnt lgkmcnt(5)
v_mfma_f32_16x16x32_f16 v[164:167], v[188:191], v[152:155], v[132:135]
ds_read_b128 v[84:87], v254 offset:8336
v_cvt_pk_bf16_f32 v88, v88, v89
v_cvt_pk_bf16_f32 v89, v90, v91
v_mfma_f32_16x16x32_bf16 v[108:111], v[160:163], v[48:51], 0
v_cvt_pk_bf16_f32 v90, v92, v93
v_cvt_pk_bf16_f32 v91, v94, v95
v_mfma_f32_16x16x32_f16 v[168:171], v[188:191], v[148:151], v[132:135]
ds_read_b128 v[92:95], v254 offset:16
buffer_store_dwordx4 v[128:131], v253, s[8:11], s71 offen sc1
buffer_store_dwordx4 v[136:139], v253, s[8:11], s71 offen offset:64 sc1
v_mfma_f32_16x16x32_f16 v[132:135], v[188:191], v[144:147], v[132:135]
ds_read_b128 v[188:191], v251 offset:12288
ds_read_u16_d16_hi v114, v114
v_mfma_f32_16x16x32_bf16 v[192:195], v[160:163], v[52:55], 0
ds_read_u16 v112, v112
v_and_b32_sdwa v115, s47, v113 dst_sel:DWORD dst_unused:UNUSED_PAD src0_sel:DWORD src1_sel:WORD_1
s_waitcnt lgkmcnt(5)
v_mfma_f32_16x16x32_f16 v[216:219], v[120:123], v[152:155], v[76:79]
s_setprio 0
v_and_b32_e64 v113, s47, v113
v_pk_fma_f16 v231, v230, v230, s48
v_mfma_f32_16x16x32_bf16 v[196:199], v[160:163], v[24:27], 0
ds_read_b128 v[160:163], v248 offset:28928
ds_read_u16_d16_hi v115, v115
v_mfma_f32_16x16x32_f16 v[220:223], v[120:123], v[148:151], v[76:79]
ds_read_u16 v113, v113
v_pk_mul_f16 v229, v228, v229
v_mfma_f32_16x16x32_f16 v[76:79], v[120:123], v[144:147], v[76:79]
ds_read_b128 v[120:123], v251 offset:10240
v_pk_mul_f16 v231, v230, v231
v_mfma_f32_16x16x32_bf16 v[108:111], v[124:127], v[56:59], v[108:111]
v_cvt_pkrtz_f16_f32 v116, v116, v117
v_cvt_pkrtz_f16_f32 v117, v118, v119
v_mfma_f32_16x16x32_f16 v[100:103], v[184:187], v[152:155], v[140:143]
v_lshrrev_b64 v[116:117], 2, v[116:117]
v_and_b32_sdwa v118, s47, v116 dst_sel:DWORD dst_unused:UNUSED_PAD src0_sel:DWORD src1_sel:WORD_1
v_mfma_f32_16x16x32_bf16 v[192:195], v[124:127], v[60:63], v[192:195]
v_and_b32_e64 v116, s47, v116
v_lshl_add_u64 v[210:211], v[0:1], 0, v[2:3]
v_mfma_f32_16x16x32_f16 v[104:107], v[184:187], v[148:151], v[140:143]
ds_read_u16_d16_hi v118, v118
ds_read_u16 v116, v116
v_exp_f16_sdwa v229, v229 dst_sel:WORD_0 dst_unused:UNUSED_PRESERVE src0_sel:WORD_0
v_mfma_f32_16x16x32_f16 v[140:143], v[184:187], v[144:147], v[140:143]
ds_read_b128 v[184:187], v251 offset:13312
v_exp_f16_sdwa v231, v231 dst_sel:WORD_0 dst_unused:UNUSED_PRESERVE src0_sel:WORD_0
v_mfma_f32_16x16x32_bf16 v[196:199], v[124:127], v[32:35], v[196:199]
ds_read_b128 v[124:127], v248 offset:30720
v_and_b32_sdwa v119, s47, v117 dst_sel:DWORD dst_unused:UNUSED_PAD src0_sel:DWORD src1_sel:WORD_1
s_waitcnt lgkmcnt(7)
v_mfma_f32_16x16x32_f16 v[232:235], v[188:191], v[152:155], v[84:87]
v_and_b32 v117, s47, v117
v_lshl_add_u64 v[214:215], v[4:5], 0, v[6:7]
v_mfma_f32_16x16x32_f16 v[236:239], v[188:191], v[148:151], v[84:87]
ds_read_u16_d16_hi v119, v119
ds_read_u16 v117, v117
v_mfma_f32_16x16x32_bf16 v[108:111], v[160:163], v[64:67], v[108:111]
v_exp_f16_sdwa v229, v229 dst_sel:WORD_1 dst_unused:UNUSED_PRESERVE src0_sel:WORD_1
v_mfma_f32_16x16x32_f16 v[84:87], v[188:191], v[144:147], v[84:87]
ds_read_b128 v[188:191], v251 offset:14336
v_exp_f16_sdwa v231, v231 dst_sel:WORD_1 dst_unused:UNUSED_PRESERVE src0_sel:WORD_1
v_mfma_f32_16x16x32_bf16 v[192:195], v[160:163], v[68:71], v[192:195]
v_lshl_add_u64 v[182:183], v[224:225], 0, v[226:227]
v_pk_add_f16 v229, v229, 1.0 op_sel_hi:[1,0]
s_waitcnt lgkmcnt(6)
v_mfma_f32_16x16x32_f16 v[200:203], v[120:123], v[152:155], v[244:247]
s_setprio 3
v_pk_add_f16 v231, v231, 1.0 op_sel_hi:[1,0]
v_rcp_f16_sdwa v229, v229 dst_sel:WORD_0 dst_unused:UNUSED_PRESERVE src0_sel:WORD_0
v_mfma_f32_16x16x32_f16 v[204:207], v[120:123], v[148:151], v[244:247]
v_rcp_f16_sdwa v231, v231 dst_sel:WORD_0 dst_unused:UNUSED_PRESERVE src0_sel:WORD_0
v_mfma_f32_16x16x32_bf16 v[196:199], v[160:163], v[40:43], v[196:199]
ds_read_b128 v[160:163], v248 offset:32768
v_cvt_pkrtz_f16_f32 v192, v192, v193
v_mfma_f32_16x16x32_f16 v[244:247], v[120:123], v[144:147], v[244:247]
ds_read_b128 v[120:123], v251 offset:17408
v_cvt_pkrtz_f16_f32 v193, v194, v195
s_waitcnt lgkmcnt(4)
v_mfma_f32_16x16x32_bf16 v[128:131], v[124:127], v[48:51], 0
v_lshrrev_b64 v[192:193], 2, v[192:193]
v_and_b32_sdwa v194, s47, v192 dst_sel:DWORD dst_unused:UNUSED_PAD src0_sel:DWORD src1_sel:WORD_1
v_mfma_f32_16x16x32_f16 v[4:7], v[184:187], v[152:155], v[92:95]
v_and_b32 v192, s47, v192
v_cvt_pk_f16_f32 v108, v108, v109
v_mfma_f32_16x16x32_f16 v[224:227], v[184:187], v[148:151], v[92:95]
ds_read_u16_d16_hi v194, v194
ds_read_u16 v192, v192
v_mfma_f32_16x16x32_bf16 v[136:139], v[124:127], v[52:55], 0
v_rcp_f16_sdwa v229, v229 dst_sel:WORD_1 dst_unused:UNUSED_PRESERVE src0_sel:WORD_1
v_mfma_f32_16x16x32_f16 v[92:95], v[184:187], v[144:147], v[92:95]
ds_read_b128 v[184:187], v251 offset:15360
v_cvt_pk_f16_f32 v110, v110, v111
v_mfma_f32_16x16x32_bf16 v[0:3], v[124:127], v[24:27], 0
ds_read_b128 v[124:127], v248 offset:34816
v_pk_fma_f16 v109, v108, v108, s48
s_waitcnt lgkmcnt(5)
v_mfma_f32_16x16x32_f16 v[164:167], v[188:191], v[176:179], v[164:167]
v_rcp_f16_sdwa v231, v231 dst_sel:WORD_1 dst_unused:UNUSED_PRESERVE src0_sel:WORD_1
v_mfma_f32_16x16x32_f16 v[168:171], v[188:191], v[156:159], v[168:171]
v_and_b32_sdwa v195, s47, v193 dst_sel:DWORD dst_unused:UNUSED_PAD src0_sel:DWORD src1_sel:WORD_1
v_and_b32 v193, s47, v193
v_mfma_f32_16x16x32_bf16 v[128:131], v[160:163], v[56:59], v[128:131]
ds_read_u16_d16_hi v195, v195
ds_read_u16 v193, v193
v_pk_fma_f16 v111, v110, v110, s48
v_mfma_f32_16x16x32_f16 v[132:135], v[188:191], v[172:175], v[132:135]
ds_read_b128 v[188:191], v251 offset:18432
v_pk_mul_f16 v109, v108, v109
v_pk_mul_f16 v228, v228, v229
v_mfma_f32_16x16x32_bf16 v[136:139], v[160:163], v[60:63], v[136:139]
v_pk_mul_f16 v111, v110, v111
v_cvt_pkrtz_f16_f32 v196, v196, v197
s_waitcnt lgkmcnt(6)
v_mfma_f32_16x16x32_f16 v[216:219], v[120:123], v[176:179], v[216:219]
v_cvt_pkrtz_f16_f32 v197, v198, v199
v_lshrrev_b64 v[196:197], 2, v[196:197]
v_and_b32_sdwa v198, s47, v196 dst_sel:DWORD dst_unused:UNUSED_PAD src0_sel:DWORD src1_sel:WORD_1
v_and_b32 v196, s47, v196
v_pk_mul_f16 v229, v230, v231
v_exp_f16_sdwa v109, v109 dst_sel:WORD_0 dst_unused:UNUSED_PRESERVE src0_sel:WORD_0
v_lshl_add_u64 v[112:113], v[112:113], 0, v[114:115]
v_mfma_f32_16x16x32_f16 v[220:223], v[120:123], v[156:159], v[220:223]
ds_read_u16_d16_hi v198, v198
ds_read_u16 v196, v196
s_setprio 2
v_mfma_f32_16x16x32_bf16 v[0:3], v[160:163], v[32:35], v[0:3]
ds_read_b128 v[160:163], v248 offset:30976
v_exp_f16_sdwa v111, v111 dst_sel:WORD_0 dst_unused:UNUSED_PRESERVE src0_sel:WORD_0
v_and_b32_sdwa v199, s47, v197 dst_sel:DWORD dst_unused:UNUSED_PAD src0_sel:DWORD src1_sel:WORD_1
v_and_b32_e64 v197, s47, v197
v_mfma_f32_16x16x32_f16 v[76:79], v[120:123], v[172:175], v[76:79]
ds_read_u16_d16_hi v199, v199
ds_read_u16 v197, v197
ds_read_b128 v[120:123], v251 offset:16384
s_waitcnt lgkmcnt(7)
v_mfma_f32_16x16x32_bf16 v[128:131], v[124:127], v[64:67], v[128:131]
v_exp_f16_sdwa v109, v109 dst_sel:WORD_1 dst_unused:UNUSED_PRESERVE src0_sel:WORD_1
v_mfma_f32_16x16x32_f16 v[100:103], v[184:187], v[176:179], v[100:103]
v_lshl_add_u64 v[116:117], v[116:117], 0, v[118:119]
v_exp_f16_sdwa v111, v111 dst_sel:WORD_1 dst_unused:UNUSED_PRESERVE src0_sel:WORD_1
v_mfma_f32_16x16x32_f16 v[104:107], v[184:187], v[156:159], v[104:107]
v_pk_add_f16 v109, v109, 1.0 op_sel_hi:[1,0]
v_pk_add_f16 v111, v111, 1.0 op_sel_hi:[1,0]
v_mfma_f32_16x16x32_bf16 v[136:139], v[124:127], v[68:71], v[136:139]
v_rcp_f16_sdwa v109, v109 dst_sel:WORD_0 dst_unused:UNUSED_PRESERVE src0_sel:WORD_0
v_mfma_f32_16x16x32_f16 v[140:143], v[184:187], v[172:175], v[140:143]
ds_read_b128 v[184:187], v251 offset:19456
v_rcp_f16_sdwa v111, v111 dst_sel:WORD_0 dst_unused:UNUSED_PRESERVE src0_sel:WORD_0
v_mfma_f32_16x16x32_bf16 v[0:3], v[124:127], v[40:43], v[0:3]
ds_read_b128 v[124:127], v248 offset:33024
v_cvt_pkrtz_f16_f32 v128, v128, v129
s_waitcnt lgkmcnt(6)
v_mfma_f32_16x16x32_f16 v[232:235], v[188:191], v[176:179], v[232:235]
v_cvt_pkrtz_f16_f32 v129, v130, v131
v_lshrrev_b64 v[128:129], 2, v[128:129]
v_mfma_f32_16x16x32_f16 v[236:239], v[188:191], v[156:159], v[236:239]
v_and_b32_sdwa v130, s47, v128 dst_sel:DWORD dst_unused:UNUSED_PAD src0_sel:DWORD src1_sel:WORD_1
v_and_b32_e64 v128, s47, v128
s_waitcnt lgkmcnt(4)
v_mfma_f32_16x16x32_bf16 v[144:147], v[160:163], v[48:51], 0
ds_read_u16_d16_hi v130, v130
ds_read_u16 v128, v128
v_mfma_f32_16x16x32_f16 v[84:87], v[188:191], v[172:175], v[84:87]
ds_read_b128 v[188:191], v248 offset:35072
v_rcp_f16_sdwa v109, v109 dst_sel:WORD_1 dst_unused:UNUSED_PRESERVE src0_sel:WORD_1
v_mfma_f32_16x16x32_bf16 v[148:151], v[160:163], v[52:55], 0
v_and_b32_sdwa v131, s47, v129 dst_sel:DWORD dst_unused:UNUSED_PAD src0_sel:DWORD src1_sel:WORD_1
v_and_b32_e64 v129, s47, v129
s_waitcnt lgkmcnt(5)
v_mfma_f32_16x16x32_f16 v[200:203], v[120:123], v[176:179], v[200:203]
s_setprio 1
buffer_store_dwordx4 v[240:243], v253, s[8:11], s71 offen offset:128 sc1
buffer_store_dwordx4 v[72:75], v253, s[8:11], s71 offen offset:192 sc1
ds_read_u16_d16_hi v131, v131
v_mfma_f32_16x16x32_f16 v[204:207], v[120:123], v[156:159], v[204:207]
ds_read_u16 v129, v129
v_rcp_f16_sdwa v111, v111 dst_sel:WORD_1 dst_unused:UNUSED_PRESERVE src0_sel:WORD_1
v_mfma_f32_16x16x32_bf16 v[152:155], v[160:163], v[24:27], 0
ds_read_b128 v[160:163], v251 offset:23552
v_cvt_pkrtz_f16_f32 v136, v136, v137
v_mfma_f32_16x16x32_f16 v[244:247], v[120:123], v[172:175], v[244:247]
ds_read_b128 v[120:123], v249
buffer_load_dwordx4 v[240:243], v253, s[4:7], s70 offen
buffer_load_dwordx4 v[72:75], v253, s[4:7], s70 offen offset:64
s_waitcnt lgkmcnt(7)
v_mfma_f32_16x16x32_bf16 v[144:147], v[124:127], v[56:59], v[144:147]
v_cvt_pkrtz_f16_f32 v137, v138, v139
v_lshrrev_b64 v[136:137], 2, v[136:137]
v_mfma_f32_16x16x32_f16 v[4:7], v[184:187], v[176:179], v[4:7]
ds_read_b128 v[176:179], v251 offset:20480
v_and_b32_sdwa v138, s47, v136 dst_sel:DWORD dst_unused:UNUSED_PAD src0_sel:DWORD src1_sel:WORD_1
v_and_b32 v136, s47, v136
v_mfma_f32_16x16x32_f16 v[224:227], v[184:187], v[156:159], v[224:227]
ds_read_u16_d16_hi v138, v138
ds_read_u16 v136, v136
v_pk_mul_f16 v230, v108, v109
v_mfma_f32_16x16x32_bf16 v[148:151], v[124:127], v[60:63], v[148:151]
v_and_b32_sdwa v139, s47, v137 dst_sel:DWORD dst_unused:UNUSED_PAD src0_sel:DWORD src1_sel:WORD_1
v_and_b32_e64 v137, s47, v137
v_pk_mul_f16 v231, v110, v111
v_mfma_f32_16x16x32_f16 v[92:95], v[184:187], v[172:175], v[92:95]
ds_read_u16_d16_hi v139, v139
ds_read_u16 v137, v137
ds_read_b128 v[184:187], v251 offset:24576
v_lshl_add_u64 v[114:115], v[192:193], 0, v[194:195]
v_mfma_f32_16x16x32_bf16 v[152:155], v[124:127], v[32:35], v[152:155]
ds_read_b128 v[124:127], v251 offset:21504
buffer_load_dwordx4 v[172:175], v253, s[4:7], s70 offen offset:128
buffer_load_dwordx4 v[156:159], v253, s[4:7], s70 offen offset:192
s_waitcnt lgkmcnt(6)
v_mfma_f32_16x16x32_f16 v[164:167], v[176:179], v[96:99], v[164:167]
v_cvt_pkrtz_f16_f32 v0, v0, v1
v_cvt_pkrtz_f16_f32 v1, v2, v3
v_lshrrev_b64 v[0:1], 2, v[0:1]
v_and_b32_sdwa v2, s47, v0 dst_sel:DWORD dst_unused:UNUSED_PAD src0_sel:DWORD src1_sel:WORD_1
v_and_b32 v0, s47, v0
v_mfma_f32_16x16x32_f16 v[168:171], v[176:179], v[12:15], v[168:171]
ds_read_u16_d16_hi v2, v2
ds_read_u16 v0, v0
v_and_b32_sdwa v3, s47, v1 dst_sel:DWORD dst_unused:UNUSED_PAD src0_sel:DWORD src1_sel:WORD_1
v_and_b32_e64 v1, s47, v1
v_mfma_f32_16x16x32_bf16 v[144:147], v[188:191], v[64:67], v[144:147]
ds_read_u16_d16_hi v3, v3
ds_read_u16 v1, v1
v_mfma_f32_16x16x32_f16 v[132:135], v[176:179], v[8:11], v[132:135]
ds_read_b128 v[176:179], v249 offset:2048
v_lshl_add_u64 v[118:119], v[196:197], 0, v[198:199]
v_mfma_f32_16x16x32_bf16 v[148:151], v[188:191], v[68:71], v[148:151]
s_nop 1
v_cvt_pk_f16_f32 v144, v144, v145
v_mfma_f32_16x16x32_f16 v[216:219], v[160:163], v[96:99], v[216:219]
s_setprio 0
v_cvt_pk_f16_f32 v146, v146, v147
v_pk_fma_f16 v145, v144, v144, s48
v_mfma_f32_16x16x32_f16 v[220:223], v[160:163], v[12:15], v[220:223]
v_cvt_pkrtz_f16_f32 v148, v148, v149
v_cvt_pkrtz_f16_f32 v149, v150, v151
v_mfma_f32_16x16x32_bf16 v[152:155], v[188:191], v[40:43], v[152:155]
ds_read_b128 v[188:191], v251 offset:22528
v_lshrrev_b64 v[148:149], 2, v[148:149]
v_mfma_f32_16x16x32_f16 v[76:79], v[160:163], v[8:11], v[76:79]
ds_read_b128 v[160:163], v251 offset:25600
v_and_b32_sdwa v150, s47, v148 dst_sel:DWORD dst_unused:UNUSED_PAD src0_sel:DWORD src1_sel:WORD_1
v_mfma_f32_16x16x32_bf16 v[108:111], v[120:123], v[48:51], 0
v_and_b32 v148, s47, v148
v_and_b32_sdwa v151, s47, v149 dst_sel:DWORD dst_unused:UNUSED_PAD src0_sel:DWORD src1_sel:WORD_1
s_waitcnt lgkmcnt(6)
v_mfma_f32_16x16x32_f16 v[100:103], v[124:127], v[96:99], v[100:103]
ds_read_u16_d16_hi v150, v150
ds_read_u16 v148, v148
v_mfma_f32_16x16x32_f16 v[104:107], v[124:127], v[12:15], v[104:107]
v_and_b32_e64 v149, s47, v149
v_pk_fma_f16 v147, v146, v146, s48
v_mfma_f32_16x16x32_bf16 v[192:195], v[120:123], v[52:55], 0
ds_read_u16_d16_hi v151, v151
ds_read_u16 v149, v149
v_mfma_f32_16x16x32_f16 v[140:143], v[124:127], v[8:11], v[140:143]
ds_read_b128 v[124:127], v251 offset:26624
v_pk_mul_f16 v145, v144, v145
v_mfma_f32_16x16x32_f16 v[232:235], v[184:187], v[96:99], v[232:235]
v_pk_mul_f16 v147, v146, v147
v_cvt_pkrtz_f16_f32 v152, v152, v153
v_mfma_f32_16x16x32_bf16 v[196:199], v[120:123], v[24:27], 0
ds_read_b128 v[120:123], v249 offset:4096
v_cvt_pkrtz_f16_f32 v153, v154, v155
v_mfma_f32_16x16x32_f16 v[236:239], v[184:187], v[12:15], v[236:239]
v_lshrrev_b64 v[152:153], 2, v[152:153]
v_and_b32_sdwa v154, s47, v152 dst_sel:DWORD dst_unused:UNUSED_PAD src0_sel:DWORD src1_sel:WORD_1
s_waitcnt lgkmcnt(7)
v_mfma_f32_16x16x32_bf16 v[108:111], v[176:179], v[56:59], v[108:111]
v_and_b32 v152, s47, v152
v_lshl_add_u64 v[128:129], v[128:129], 0, v[130:131]
v_mfma_f32_16x16x32_f16 v[84:87], v[184:187], v[8:11], v[84:87]
ds_read_b128 v[184:187], v249 offset:256
ds_read_u16_d16_hi v154, v154
v_mfma_f32_16x16x32_f16 v[200:203], v[188:191], v[96:99], v[200:203]
s_setprio 3
ds_read_u16 v152, v152
v_exp_f16_sdwa v145, v145 dst_sel:WORD_0 dst_unused:UNUSED_PRESERVE src0_sel:WORD_0
v_mfma_f32_16x16x32_bf16 v[192:195], v[176:179], v[60:63], v[192:195]
v_exp_f16_sdwa v147, v147 dst_sel:WORD_0 dst_unused:UNUSED_PRESERVE src0_sel:WORD_0
v_mfma_f32_16x16x32_f16 v[204:207], v[188:191], v[12:15], v[204:207]
v_and_b32_sdwa v155, s47, v153 dst_sel:DWORD dst_unused:UNUSED_PAD src0_sel:DWORD src1_sel:WORD_1
v_and_b32 v153, s47, v153
v_mfma_f32_16x16x32_bf16 v[196:199], v[176:179], v[32:35], v[196:199]
ds_read_b128 v[176:179], v251 offset:29696
ds_read_u16_d16_hi v155, v155
v_mfma_f32_16x16x32_f16 v[244:247], v[188:191], v[8:11], v[244:247]
ds_read_b128 v[188:191], v251 offset:27648
ds_read_u16 v153, v153
s_waitcnt lgkmcnt(8)
v_mfma_f32_16x16x32_f16 v[4:7], v[160:163], v[96:99], v[4:7]
v_lshl_add_u64 v[136:137], v[136:137], 0, v[138:139]
v_exp_f16_sdwa v145, v145 dst_sel:WORD_1 dst_unused:UNUSED_PRESERVE src0_sel:WORD_1
s_waitcnt lgkmcnt(7)
v_mfma_f32_16x16x32_bf16 v[108:111], v[120:123], v[64:67], v[108:111]
v_exp_f16_sdwa v147, v147 dst_sel:WORD_1 dst_unused:UNUSED_PRESERVE src0_sel:WORD_1
v_mfma_f32_16x16x32_f16 v[224:227], v[160:163], v[12:15], v[224:227]
v_lshl_add_u64 v[0:1], v[0:1], 0, v[2:3]
v_pk_add_f16 v145, v145, 1.0 op_sel_hi:[1,0]
v_mfma_f32_16x16x32_bf16 v[192:195], v[120:123], v[68:71], v[192:195]
v_pk_add_f16 v147, v147, 1.0 op_sel_hi:[1,0]
v_rcp_f16_sdwa v145, v145 dst_sel:WORD_0 dst_unused:UNUSED_PRESERVE src0_sel:WORD_0
v_mfma_f32_16x16x32_f16 v[92:95], v[160:163], v[8:11], v[92:95]
ds_read_b128 v[160:163], v249 offset:2304
v_rcp_f16_sdwa v147, v147 dst_sel:WORD_0 dst_unused:UNUSED_PRESERVE src0_sel:WORD_0
v_mfma_f32_16x16x32_f16 v[164:167], v[124:127], v[180:183], v[164:167]
s_nop 1
v_cvt_pkrtz_f16_f32 v192, v192, v193
v_cvt_pkrtz_f16_f32 v193, v194, v195
v_mfma_f32_16x16x32_bf16 v[196:199], v[120:123], v[40:43], v[196:199]
ds_read_b128 v[120:123], v251 offset:30720
v_lshrrev_b64 v[192:193], 2, v[192:193]
v_mfma_f32_16x16x32_f16 v[168:171], v[124:127], v[212:215], v[168:171]
v_and_b32_sdwa v194, s47, v192 dst_sel:DWORD dst_unused:UNUSED_PAD src0_sel:DWORD src1_sel:WORD_1
v_and_b32 v192, s47, v192
s_waitcnt lgkmcnt(3)
v_mfma_f32_16x16x32_bf16 v[8:11], v[184:187], v[48:51], 0
ds_read_u16_d16_hi v194, v194
ds_read_u16 v192, v192
v_mfma_f32_16x16x32_f16 v[132:135], v[124:127], v[208:211], v[132:135]
ds_read_b128 v[124:127], v249 offset:4352
s_setprio 2
v_cvt_pk_f16_f32 v108, v108, v109
v_mfma_f32_16x16x32_f16 v[216:219], v[176:179], v[180:183], v[216:219]
v_rcp_f16_sdwa v145, v145 dst_sel:WORD_1 dst_unused:UNUSED_PRESERVE src0_sel:WORD_1
v_mfma_f32_16x16x32_bf16 v[12:15], v[184:187], v[52:55], 0
v_cvt_pk_f16_f32 v110, v110, v111
v_pk_fma_f16 v109, v108, v108, s48
v_mfma_f32_16x16x32_f16 v[220:223], v[176:179], v[212:215], v[220:223]
v_rcp_f16_sdwa v147, v147 dst_sel:WORD_1 dst_unused:UNUSED_PRESERVE src0_sel:WORD_1
v_mfma_f32_16x16x32_bf16 v[96:99], v[184:187], v[24:27], 0
ds_read_b128 v[184:187], v251 offset:28672
v_and_b32_sdwa v195, s47, v193 dst_sel:DWORD dst_unused:UNUSED_PAD src0_sel:DWORD src1_sel:WORD_1
v_mfma_f32_16x16x32_f16 v[76:79], v[176:179], v[208:211], v[76:79]
ds_read_b128 v[176:179], v251 offset:31744
v_and_b32 v193, s47, v193
v_mfma_f32_16x16x32_f16 v[100:103], v[188:191], v[180:183], v[100:103]
buffer_store_dwordx4 v[80:83], v253, s[8:11], s71 offen offset:256 sc1
buffer_store_dwordx4 v[88:91], v253, s[8:11], s71 offen offset:320 sc1
buffer_load_dwordx4 v[80:83], v253, s[4:7], s70 offen offset:256
buffer_load_dwordx4 v[88:91], v253, s[4:7], s70 offen offset:320
s_waitcnt lgkmcnt(5)
v_mfma_f32_16x16x32_bf16 v[8:11], v[160:163], v[56:59], v[8:11]
ds_read_u16_d16_hi v195, v195
ds_read_u16 v193, v193
v_pk_fma_f16 v111, v110, v110, s48
v_mfma_f32_16x16x32_f16 v[104:107], v[188:191], v[212:215], v[104:107]
v_pk_mul_f16 v109, v108, v109
v_pk_mul_f16 v130, v144, v145
v_mfma_f32_16x16x32_bf16 v[12:15], v[160:163], v[60:63], v[12:15]
v_pk_mul_f16 v111, v110, v111
v_cvt_pkrtz_f16_f32 v196, v196, v197
v_mfma_f32_16x16x32_f16 v[140:143], v[188:191], v[208:211], v[140:143]
ds_read_b128 v[188:191], v249 offset:6144
v_cvt_pkrtz_f16_f32 v197, v198, v199
v_lshrrev_b64 v[196:197], 2, v[196:197]
v_and_b32_sdwa v198, s47, v196 dst_sel:DWORD dst_unused:UNUSED_PAD src0_sel:DWORD src1_sel:WORD_1
v_and_b32_e64 v196, s47, v196
v_pk_mul_f16 v131, v146, v147
v_exp_f16_sdwa v109, v109 dst_sel:WORD_0 dst_unused:UNUSED_PRESERVE src0_sel:WORD_0
v_mfma_f32_16x16x32_f16 v[232:235], v[120:123], v[180:183], v[232:235]
ds_read_u16_d16_hi v198, v198
ds_read_u16 v196, v196
v_lshl_add_u64 v[138:139], v[148:149], 0, v[150:151]
v_mfma_f32_16x16x32_bf16 v[96:99], v[160:163], v[32:35], v[96:99]
ds_read_b128 v[160:163], v251 offset:32768
v_exp_f16_sdwa v111, v111 dst_sel:WORD_0 dst_unused:UNUSED_PRESERVE src0_sel:WORD_0
v_mfma_f32_16x16x32_f16 v[236:239], v[120:123], v[212:215], v[236:239]
v_and_b32_sdwa v199, s47, v197 dst_sel:DWORD dst_unused:UNUSED_PAD src0_sel:DWORD src1_sel:WORD_1
v_and_b32_e64 v197, s47, v197
s_waitcnt lgkmcnt(5)
v_mfma_f32_16x16x32_bf16 v[8:11], v[124:127], v[64:67], v[8:11]
ds_read_u16_d16_hi v199, v199
ds_read_u16 v197, v197
v_mfma_f32_16x16x32_f16 v[84:87], v[120:123], v[208:211], v[84:87]
ds_read_b128 v[120:123], v249 offset:8192
v_exp_f16_sdwa v109, v109 dst_sel:WORD_1 dst_unused:UNUSED_PRESERVE src0_sel:WORD_1
s_setprio 1
v_mfma_f32_16x16x32_f16 v[200:203], v[184:187], v[180:183], v[200:203]
v_lshl_add_u64 v[2:3], v[152:153], 0, v[154:155]
v_exp_f16_sdwa v111, v111 dst_sel:WORD_1 dst_unused:UNUSED_PRESERVE src0_sel:WORD_1
v_mfma_f32_16x16x32_bf16 v[12:15], v[124:127], v[68:71], v[12:15]
v_pk_add_f16 v109, v109, 1.0 op_sel_hi:[1,0]
v_pk_add_f16 v111, v111, 1.0 op_sel_hi:[1,0]
v_mfma_f32_16x16x32_f16 v[204:207], v[184:187], v[212:215], v[204:207]
v_rcp_f16_sdwa v109, v109 dst_sel:WORD_0 dst_unused:UNUSED_PRESERVE src0_sel:WORD_0
v_mfma_f32_16x16x32_bf16 v[96:99], v[124:127], v[40:43], v[96:99]
ds_read_b128 v[124:127], v251 offset:35840
v_rcp_f16_sdwa v111, v111 dst_sel:WORD_0 dst_unused:UNUSED_PRESERVE src0_sel:WORD_0
v_mfma_f32_16x16x32_f16 v[244:247], v[184:187], v[208:211], v[244:247]
ds_read_b128 v[184:187], v251 offset:33792
v_cvt_pkrtz_f16_f32 v8, v8, v9
v_mfma_f32_16x16x32_f16 v[4:7], v[176:179], v[180:183], v[4:7]
v_cvt_pkrtz_f16_f32 v9, v10, v11
v_lshrrev_b64 v[8:9], 2, v[8:9]
s_waitcnt lgkmcnt(4)
v_mfma_f32_16x16x32_bf16 v[144:147], v[188:191], v[48:51], 0
v_and_b32_sdwa v10, s47, v8 dst_sel:DWORD dst_unused:UNUSED_PAD src0_sel:DWORD src1_sel:WORD_1
v_and_b32 v8, s47, v8
v_mfma_f32_16x16x32_f16 v[224:227], v[176:179], v[212:215], v[224:227]
ds_read_u16_d16_hi v10, v10
ds_read_u16 v8, v8
v_mfma_f32_16x16x32_bf16 v[148:151], v[188:191], v[52:55], 0
v_rcp_f16_sdwa v109, v109 dst_sel:WORD_1 dst_unused:UNUSED_PRESERVE src0_sel:WORD_1
v_mfma_f32_16x16x32_f16 v[92:95], v[176:179], v[208:211], v[92:95]
ds_read_b128 v[176:179], v249 offset:10240
v_and_b32_sdwa v11, s47, v9 dst_sel:DWORD dst_unused:UNUSED_PAD src0_sel:DWORD src1_sel:WORD_1
v_mfma_f32_16x16x32_f16 v[164:167], v[160:163], v[116:119], v[164:167]
v_and_b32_e64 v9, s47, v9
v_rcp_f16_sdwa v111, v111 dst_sel:WORD_1 dst_unused:UNUSED_PRESERVE src0_sel:WORD_1
v_mfma_f32_16x16x32_bf16 v[152:155], v[188:191], v[24:27], 0
ds_read_b128 v[188:191], v251 offset:36864
ds_read_u16_d16_hi v11, v11
v_mfma_f32_16x16x32_f16 v[168:171], v[160:163], v[112:115], v[168:171]
ds_read_u16 v9, v9
v_cvt_pkrtz_f16_f32 v12, v12, v13
s_waitcnt lgkmcnt(6)
v_mfma_f32_16x16x32_bf16 v[144:147], v[120:123], v[56:59], v[144:147]
v_cvt_pkrtz_f16_f32 v13, v14, v15
v_lshrrev_b64 v[12:13], 2, v[12:13]
v_mfma_f32_16x16x32_f16 v[132:135], v[160:163], v[228:231], v[132:135]
ds_read_b128 v[160:163], v249 offset:6400
v_and_b32_sdwa v14, s47, v12 dst_sel:DWORD dst_unused:UNUSED_PAD src0_sel:DWORD src1_sel:WORD_1
v_and_b32 v12, s47, v12
v_mfma_f32_16x16x32_f16 v[216:219], v[124:127], v[116:119], v[216:219]
ds_read_u16_d16_hi v14, v14
ds_read_u16 v12, v12
s_setprio 0
v_pk_mul_f16 v108, v108, v109
v_mfma_f32_16x16x32_bf16 v[148:151], v[120:123], v[60:63], v[148:151]
v_and_b32_sdwa v15, s47, v13 dst_sel:DWORD dst_unused:UNUSED_PAD src0_sel:DWORD src1_sel:WORD_1
v_and_b32 v13, s47, v13
v_pk_mul_f16 v109, v110, v111
v_mfma_f32_16x16x32_f16 v[220:223], v[124:127], v[112:115], v[220:223]
ds_read_u16_d16_hi v15, v15
ds_read_u16 v13, v13
v_lshl_add_u64 v[192:193], v[192:193], 0, v[194:195]
v_mfma_f32_16x16x32_bf16 v[152:155], v[120:123], v[32:35], v[152:155]
ds_read_b128 v[120:123], v251 offset:34816
v_cvt_pkrtz_f16_f32 v96, v96, v97
v_mfma_f32_16x16x32_f16 v[76:79], v[124:127], v[228:231], v[76:79]
ds_read_b128 v[124:127], v251 offset:37888
v_cvt_pkrtz_f16_f32 v97, v98, v99
v_lshrrev_b64 v[96:97], 2, v[96:97]
v_and_b32_sdwa v98, s47, v96 dst_sel:DWORD dst_unused:UNUSED_PAD src0_sel:DWORD src1_sel:WORD_1
v_and_b32_e64 v96, s47, v96
v_mfma_f32_16x16x32_f16 v[100:103], v[184:187], v[116:119], v[100:103]
ds_read_u16_d16_hi v98, v98
ds_read_u16 v96, v96
v_and_b32_sdwa v99, s47, v97 dst_sel:DWORD dst_unused:UNUSED_PAD src0_sel:DWORD src1_sel:WORD_1
v_and_b32 v97, s47, v97
s_waitcnt lgkmcnt(8)
v_mfma_f32_16x16x32_bf16 v[144:147], v[176:179], v[64:67], v[144:147]
ds_read_u16_d16_hi v99, v99
ds_read_u16 v97, v97
v_mfma_f32_16x16x32_f16 v[104:107], v[184:187], v[112:115], v[104:107]
v_lshl_add_u64 v[196:197], v[196:197], 0, v[198:199]
v_mfma_f32_16x16x32_f16 v[140:143], v[184:187], v[228:231], v[140:143]
ds_read_b128 v[184:187], v249 offset:8448
s_nop 1
v_cvt_pk_f16_f32 v144, v144, v145
v_mfma_f32_16x16x32_bf16 v[148:151], v[176:179], v[68:71], v[148:151]
v_cvt_pk_f16_f32 v146, v146, v147
v_pk_fma_f16 v145, v144, v144, s48
v_mfma_f32_16x16x32_f16 v[232:235], v[188:191], v[116:119], v[232:235]
v_pk_fma_f16 v147, v146, v146, s48
v_pk_mul_f16 v145, v144, v145
v_mfma_f32_16x16x32_bf16 v[152:155], v[176:179], v[40:43], v[152:155]
ds_read_b128 v[176:179], v251 offset:38912
s_nop 0
v_cvt_pkrtz_f16_f32 v148, v148, v149
v_mfma_f32_16x16x32_f16 v[236:239], v[188:191], v[112:115], v[236:239]
v_cvt_pkrtz_f16_f32 v149, v150, v151
v_lshrrev_b64 v[148:149], 2, v[148:149]
v_mfma_f32_16x16x32_f16 v[84:87], v[188:191], v[228:231], v[84:87]
ds_read_b128 v[188:191], v249 offset:10496
v_and_b32_sdwa v150, s47, v148 dst_sel:DWORD dst_unused:UNUSED_PAD src0_sel:DWORD src1_sel:WORD_1
v_mfma_f32_16x16x32_bf16 v[208:211], v[160:163], v[48:51], 0
s_setprio 3
v_and_b32_e64 v148, s47, v148
v_and_b32_sdwa v151, s47, v149 dst_sel:DWORD dst_unused:UNUSED_PAD src0_sel:DWORD src1_sel:WORD_1
s_waitcnt lgkmcnt(6)
v_mfma_f32_16x16x32_f16 v[200:203], v[120:123], v[116:119], v[200:203]
ds_read_u16_d16_hi v150, v150
ds_read_u16 v148, v148
v_mfma_f32_16x16x32_bf16 v[212:215], v[160:163], v[52:55], 0
v_and_b32_e64 v149, s47, v149
v_pk_mul_f16 v147, v146, v147
v_mfma_f32_16x16x32_f16 v[204:207], v[120:123], v[112:115], v[204:207]
ds_read_u16_d16_hi v151, v151
ds_read_u16 v149, v149
v_mfma_f32_16x16x32_f16 v[244:247], v[120:123], v[228:231], v[244:247]
ds_read_b128 v[120:123], v251 offset:39936
v_cvt_pkrtz_f16_f32 v152, v152, v153
v_mfma_f32_16x16x32_bf16 v[180:183], v[160:163], v[24:27], 0
ds_read_b128 v[160:163], v251 offset:41984
v_cvt_pkrtz_f16_f32 v153, v154, v155
v_mfma_f32_16x16x32_f16 v[4:7], v[124:127], v[116:119], v[4:7]
v_lshrrev_b64 v[152:153], 2, v[152:153]
v_and_b32_sdwa v154, s47, v152 dst_sel:DWORD dst_unused:UNUSED_PAD src0_sel:DWORD src1_sel:WORD_1
s_waitcnt lgkmcnt(7)
v_mfma_f32_16x16x32_bf16 v[208:211], v[184:187], v[56:59], v[208:211]
v_and_b32 v152, s47, v152
v_lshl_add_u64 v[110:111], v[8:9], 0, v[10:11]
v_mfma_f32_16x16x32_f16 v[224:227], v[124:127], v[112:115], v[224:227]
ds_read_u16_d16_hi v154, v154
ds_read_u16 v152, v152
v_mfma_f32_16x16x32_f16 v[92:95], v[124:127], v[228:231], v[92:95]
ds_read_b128 v[124:127], v249 offset:12288
v_exp_f16_sdwa v145, v145 dst_sel:WORD_0 dst_unused:UNUSED_PRESERVE src0_sel:WORD_0
v_mfma_f32_16x16x32_bf16 v[212:215], v[184:187], v[60:63], v[212:215]
v_exp_f16_sdwa v147, v147 dst_sel:WORD_0 dst_unused:UNUSED_PRESERVE src0_sel:WORD_0
s_waitcnt vmcnt(7)
v_mfma_f32_16x16x32_bf16 v[132:135], v[18:21], v[240:243], v[132:135]
v_and_b32_sdwa v155, s47, v153 dst_sel:DWORD dst_unused:UNUSED_PAD src0_sel:DWORD src1_sel:WORD_1
v_and_b32_e64 v153, s47, v153
v_mfma_f32_16x16x32_bf16 v[76:79], v[16:19], v[240:243], v[76:79]
ds_read_u16_d16_hi v155, v155
ds_read_u16 v153, v153
s_waitcnt vmcnt(6)
v_mfma_f32_16x16x32_bf16 v[140:143], v[18:21], v[72:75], v[140:143]
v_lshl_add_u64 v[194:195], v[12:13], 0, v[14:15]
v_exp_f16_sdwa v145, v145 dst_sel:WORD_1 dst_unused:UNUSED_PRESERVE src0_sel:WORD_1
v_mfma_f32_16x16x32_bf16 v[84:87], v[16:19], v[72:75], v[84:87]
buffer_load_dwordx4 v[228:231], v253, s[4:7], s69 offen
buffer_load_dwordx4 v[112:115], v253, s[4:7], s69 offen offset:64
v_exp_f16_sdwa v147, v147 dst_sel:WORD_1 dst_unused:UNUSED_PRESERVE src0_sel:WORD_1
v_mfma_f32_16x16x32_f16 v[164:167], v[176:179], v[0:3], v[164:167]
v_lshl_add_u64 v[198:199], v[96:97], 0, v[98:99]
v_pk_add_f16 v145, v145, 1.0 op_sel_hi:[1,0]
v_mfma_f32_16x16x32_bf16 v[180:183], v[184:187], v[32:35], v[180:183]
ds_read_b128 v[184:187], v251 offset:43008
v_pk_add_f16 v147, v147, 1.0 op_sel_hi:[1,0]
v_mfma_f32_16x16x32_f16 v[168:171], v[176:179], v[136:139], v[168:171]
v_rcp_f16_sdwa v145, v145 dst_sel:WORD_0 dst_unused:UNUSED_PRESERVE src0_sel:WORD_0
v_mfma_f32_16x16x32_f16 v[132:135], v[176:179], v[128:131], v[132:135]
ds_read_b128 v[176:179], v249 offset:14336
v_rcp_f16_sdwa v147, v147 dst_sel:WORD_0 dst_unused:UNUSED_PRESERVE src0_sel:WORD_0
s_waitcnt lgkmcnt(4)
v_mfma_f32_16x16x32_bf16 v[208:211], v[188:191], v[64:67], v[208:211]
s_setprio 2
v_rcp_f16_sdwa v145, v145 dst_sel:WORD_1 dst_unused:UNUSED_PRESERVE src0_sel:WORD_1
v_mfma_f32_16x16x32_f16 v[216:219], v[160:163], v[0:3], v[216:219]
v_rcp_f16_sdwa v147, v147 dst_sel:WORD_1 dst_unused:UNUSED_PRESERVE src0_sel:WORD_1
v_mfma_f32_16x16x32_bf16 v[212:215], v[188:191], v[68:71], v[212:215]
s_nop 2
v_cvt_pk_f16_f32 v208, v208, v209
v_cvt_pk_f16_f32 v210, v210, v211
v_mfma_f32_16x16x32_f16 v[220:223], v[160:163], v[136:139], v[220:223]
v_pk_fma_f16 v209, v208, v208, s48
v_pk_fma_f16 v211, v210, v210, s48
v_mfma_f32_16x16x32_f16 v[76:79], v[160:163], v[128:131], v[76:79]
ds_read_b128 v[160:163], v251 offset:44032
v_cvt_pkrtz_f16_f32 v212, v212, v213
v_mfma_f32_16x16x32_bf16 v[180:183], v[188:191], v[40:43], v[180:183]
ds_read_b128 v[188:191], v251 offset:40960
v_cvt_pkrtz_f16_f32 v213, v214, v215
v_mfma_f32_16x16x32_f16 v[100:103], v[120:123], v[0:3], v[100:103]
v_lshrrev_b64 v[212:213], 2, v[212:213]
v_and_b32_sdwa v214, s47, v212 dst_sel:DWORD dst_unused:UNUSED_PAD src0_sel:DWORD src1_sel:WORD_1
v_mfma_f32_16x16x32_bf16 v[116:119], v[124:127], v[48:51], 0
v_and_b32 v212, s47, v212
v_and_b32_sdwa v215, s47, v213 dst_sel:DWORD dst_unused:UNUSED_PAD src0_sel:DWORD src1_sel:WORD_1
v_mfma_f32_16x16x32_f16 v[104:107], v[120:123], v[136:139], v[104:107]
ds_read_u16_d16_hi v214, v214
ds_read_u16 v212, v212
v_mfma_f32_16x16x32_f16 v[140:143], v[120:123], v[128:131], v[140:143]
ds_read_b128 v[120:123], v249 offset:16384
v_and_b32 v213, s47, v213
v_mfma_f32_16x16x32_bf16 v[240:243], v[124:127], v[52:55], 0
ds_read_u16_d16_hi v215, v215
ds_read_u16 v213, v213
s_waitcnt lgkmcnt(7)
v_mfma_f32_16x16x32_f16 v[232:235], v[184:187], v[0:3], v[232:235]
v_pk_mul_f16 v209, v208, v209
v_pk_mul_f16 v144, v144, v145
v_mfma_f32_16x16x32_bf16 v[72:75], v[124:127], v[24:27], 0
ds_read_b128 v[124:127], v251 offset:45056
v_pk_mul_f16 v211, v210, v211
v_mfma_f32_16x16x32_f16 v[236:239], v[184:187], v[136:139], v[236:239]
v_cvt_pkrtz_f16_f32 v180, v180, v181
v_cvt_pkrtz_f16_f32 v181, v182, v183
v_mfma_f32_16x16x32_f16 v[84:87], v[184:187], v[128:131], v[84:87]
ds_read_b128 v[184:187], v249 offset:12544
v_lshrrev_b64 v[180:181], 2, v[180:181]
v_mfma_f32_16x16x32_bf16 v[116:119], v[176:179], v[56:59], v[116:119]
s_setprio 1
v_and_b32_sdwa v182, s47, v180 dst_sel:DWORD dst_unused:UNUSED_PAD src0_sel:DWORD src1_sel:WORD_1
v_and_b32_e64 v180, s47, v180
s_waitcnt lgkmcnt(7)
v_mfma_f32_16x16x32_f16 v[200:203], v[188:191], v[0:3], v[200:203]
ds_read_u16_d16_hi v182, v182
ds_read_u16 v180, v180
v_mfma_f32_16x16x32_bf16 v[240:243], v[176:179], v[60:63], v[240:243]
v_pk_mul_f16 v145, v146, v147
v_exp_f16_sdwa v209, v209 dst_sel:WORD_0 dst_unused:UNUSED_PRESERVE src0_sel:WORD_0
v_mfma_f32_16x16x32_f16 v[204:207], v[188:191], v[136:139], v[204:207]
v_lshl_add_u64 v[148:149], v[148:149], 0, v[150:151]
v_exp_f16_sdwa v211, v211 dst_sel:WORD_0 dst_unused:UNUSED_PRESERVE src0_sel:WORD_0
v_mfma_f32_16x16x32_f16 v[244:247], v[188:191], v[128:131], v[244:247]
ds_read_b128 v[188:191], v251 offset:46080
v_and_b32_sdwa v183, s47, v181 dst_sel:DWORD dst_unused:UNUSED_PAD src0_sel:DWORD src1_sel:WORD_1
v_mfma_f32_16x16x32_bf16 v[72:75], v[176:179], v[32:35], v[72:75]
ds_read_b128 v[176:179], v251 offset:48128
v_and_b32 v181, s47, v181
v_mfma_f32_16x16x32_f16 v[4:7], v[160:163], v[0:3], v[4:7]
ds_read_u16_d16_hi v183, v183
ds_read_u16 v181, v181
s_waitcnt lgkmcnt(8)
v_mfma_f32_16x16x32_bf16 v[116:119], v[120:123], v[64:67], v[116:119]
v_exp_f16_sdwa v209, v209 dst_sel:WORD_1 dst_unused:UNUSED_PRESERVE src0_sel:WORD_1
v_mfma_f32_16x16x32_f16 v[224:227], v[160:163], v[136:139], v[224:227]
v_lshl_add_u64 v[152:153], v[152:153], 0, v[154:155]
v_exp_f16_sdwa v211, v211 dst_sel:WORD_1 dst_unused:UNUSED_PRESERVE src0_sel:WORD_1
v_mfma_f32_16x16x32_f16 v[92:95], v[160:163], v[128:131], v[92:95]
ds_read_b128 v[160:163], v249 offset:14592
v_pk_add_f16 v209, v209, 1.0 op_sel_hi:[1,0]
v_mfma_f32_16x16x32_bf16 v[240:243], v[120:123], v[68:71], v[240:243]
v_pk_add_f16 v211, v211, 1.0 op_sel_hi:[1,0]
v_rcp_f16_sdwa v209, v209 dst_sel:WORD_0 dst_unused:UNUSED_PRESERVE src0_sel:WORD_0
s_waitcnt vmcnt(7)
v_mfma_f32_16x16x32_bf16 v[244:247], v[18:21], v[172:175], v[244:247]
v_rcp_f16_sdwa v211, v211 dst_sel:WORD_0 dst_unused:UNUSED_PRESERVE src0_sel:WORD_0
v_mfma_f32_16x16x32_bf16 v[92:95], v[16:19], v[172:175], v[92:95]
v_cvt_pkrtz_f16_f32 v116, v116, v117
v_cvt_pkrtz_f16_f32 v117, v118, v119
s_waitcnt vmcnt(6)
v_mfma_f32_16x16x32_bf16 v[168:171], v[18:21], v[156:159], v[168:171]
v_lshrrev_b64 v[116:117], 2, v[116:117]
v_and_b32_sdwa v118, s47, v116 dst_sel:DWORD dst_unused:UNUSED_PAD src0_sel:DWORD src1_sel:WORD_1
v_mfma_f32_16x16x32_bf16 v[220:223], v[16:19], v[156:159], v[220:223]
v_and_b32 v116, s47, v116
v_rcp_f16_sdwa v209, v209 dst_sel:WORD_1 dst_unused:UNUSED_PRESERVE src0_sel:WORD_1
s_waitcnt lgkmcnt(1)
v_mfma_f32_16x16x32_f16 v[164:167], v[124:127], v[196:199], v[164:167]
ds_read_u16_d16_hi v118, v118
ds_read_u16 v116, v116
v_mfma_f32_16x16x32_bf16 v[72:75], v[120:123], v[40:43], v[72:75]
ds_read_b128 v[120:123], v251 offset:49152
v_and_b32_sdwa v119, s47, v117 dst_sel:DWORD dst_unused:UNUSED_PAD src0_sel:DWORD src1_sel:WORD_1
v_mfma_f32_16x16x32_f16 v[168:171], v[124:127], v[192:195], v[168:171]
v_and_b32 v117, s47, v117
v_rcp_f16_sdwa v211, v211 dst_sel:WORD_1 dst_unused:UNUSED_PRESERVE src0_sel:WORD_1
v_mfma_f32_16x16x32_f16 v[132:135], v[124:127], v[108:111], v[132:135]
ds_read_b128 v[124:127], v249 offset:16640
ds_read_u16_d16_hi v119, v119
v_mfma_f32_16x16x32_bf16 v[8:11], v[184:187], v[48:51], 0
s_setprio 0
ds_read_u16 v117, v117
v_cvt_pkrtz_f16_f32 v240, v240, v241
v_mfma_f32_16x16x32_f16 v[216:219], v[176:179], v[196:199], v[216:219]
v_cvt_pkrtz_f16_f32 v241, v242, v243
v_lshrrev_b64 v[240:241], 2, v[240:241]
v_mfma_f32_16x16x32_bf16 v[12:15], v[184:187], v[52:55], 0
v_and_b32_sdwa v242, s47, v240 dst_sel:DWORD dst_unused:UNUSED_PAD src0_sel:DWORD src1_sel:WORD_1
v_and_b32_e64 v240, s47, v240
v_mfma_f32_16x16x32_f16 v[220:223], v[176:179], v[192:195], v[220:223]
ds_read_u16_d16_hi v242, v242
ds_read_u16 v240, v240
v_mfma_f32_16x16x32_f16 v[76:79], v[176:179], v[108:111], v[76:79]
ds_read_b128 v[176:179], v251 offset:50176
v_pk_mul_f16 v146, v208, v209
v_mfma_f32_16x16x32_bf16 v[96:99], v[184:187], v[24:27], 0
ds_read_b128 v[184:187], v251 offset:47104
v_and_b32_sdwa v243, s47, v241 dst_sel:DWORD dst_unused:UNUSED_PAD src0_sel:DWORD src1_sel:WORD_1
v_mfma_f32_16x16x32_f16 v[100:103], v[188:191], v[196:199], v[100:103]
v_and_b32 v241, s47, v241
v_pk_mul_f16 v147, v210, v211
v_mfma_f32_16x16x32_f16 v[104:107], v[188:191], v[192:195], v[104:107]
ds_read_u16_d16_hi v243, v243
ds_read_u16 v241, v241
s_waitcnt lgkmcnt(8)
v_mfma_f32_16x16x32_bf16 v[8:11], v[160:163], v[56:59], v[8:11]
v_lshl_add_u64 v[150:151], v[212:213], 0, v[214:215]
v_cvt_pkrtz_f16_f32 v72, v72, v73
v_mfma_f32_16x16x32_f16 v[140:143], v[188:191], v[108:111], v[140:143]
ds_read_b128 v[188:191], v249 offset:18432
v_cvt_pkrtz_f16_f32 v73, v74, v75
v_mfma_f32_16x16x32_bf16 v[12:15], v[160:163], v[60:63], v[12:15]
v_lshrrev_b64 v[72:73], 2, v[72:73]
v_and_b32_sdwa v74, s47, v72 dst_sel:DWORD dst_unused:UNUSED_PAD src0_sel:DWORD src1_sel:WORD_1
v_mfma_f32_16x16x32_f16 v[232:235], v[120:123], v[196:199], v[232:235]
v_and_b32_e64 v72, s47, v72
v_and_b32_sdwa v75, s47, v73 dst_sel:DWORD dst_unused:UNUSED_PAD src0_sel:DWORD src1_sel:WORD_1
v_mfma_f32_16x16x32_f16 v[236:239], v[120:123], v[192:195], v[236:239]
ds_read_u16_d16_hi v74, v74
ds_read_u16 v72, v72
v_mfma_f32_16x16x32_bf16 v[96:99], v[160:163], v[32:35], v[96:99]
ds_read_b128 v[160:163], v251 offset:51200
v_and_b32_e64 v73, s47, v73
v_mfma_f32_16x16x32_f16 v[84:87], v[120:123], v[108:111], v[84:87]
ds_read_b128 v[120:123], v249 offset:20480
ds_read_u16_d16_hi v75, v75
ds_read_u16 v73, v73
s_setprio 3
v_mfma_f32_16x16x32_bf16 v[8:11], v[124:127], v[64:67], v[8:11]
v_lshl_add_u64 v[154:155], v[180:181], 0, v[182:183]
s_waitcnt lgkmcnt(9)
v_mfma_f32_16x16x32_f16 v[200:203], v[184:187], v[196:199], v[200:203]
v_mfma_f32_16x16x32_f16 v[204:207], v[184:187], v[192:195], v[204:207]
s_nop 3
v_cvt_pk_f16_f32 v8, v8, v9
v_mfma_f32_16x16x32_bf16 v[12:15], v[124:127], v[68:71], v[12:15]
v_cvt_pk_f16_f32 v10, v10, v11
v_pk_fma_f16 v9, v8, v8, s48
v_mfma_f32_16x16x32_f16 v[244:247], v[184:187], v[108:111], v[244:247]
ds_read_b128 v[184:187], v249 offset:22528
v_pk_fma_f16 v11, v10, v10, s48
v_mfma_f32_16x16x32_bf16 v[96:99], v[124:127], v[40:43], v[96:99]
ds_read_b128 v[124:127], v251 offset:54272
s_nop 0
v_cvt_pkrtz_f16_f32 v12, v12, v13
v_mfma_f32_16x16x32_f16 v[4:7], v[176:179], v[196:199], v[4:7]
v_cvt_pkrtz_f16_f32 v13, v14, v15
v_lshrrev_b64 v[12:13], 2, v[12:13]
v_mfma_f32_16x16x32_f16 v[224:227], v[176:179], v[192:195], v[224:227]
buffer_load_dwordx4 v[128:131], v250, s[32:35], s80 offen
s_add_u32 s46, s80, 2097152
buffer_load_dwordx4 v[136:139], v250, s[32:35], s46 offen
v_and_b32_sdwa v14, s47, v12 dst_sel:DWORD dst_unused:UNUSED_PAD src0_sel:DWORD src1_sel:WORD_1
s_waitcnt lgkmcnt(5)
v_mfma_f32_16x16x32_bf16 v[0:3], v[188:191], v[48:51], 0
v_and_b32 v12, s47, v12
v_and_b32_sdwa v15, s47, v13 dst_sel:DWORD dst_unused:UNUSED_PAD src0_sel:DWORD src1_sel:WORD_1
v_mfma_f32_16x16x32_f16 v[92:95], v[176:179], v[108:111], v[92:95]
ds_read_b128 v[176:179], v251 offset:52224
ds_read_u16_d16_hi v14, v14
v_mfma_f32_16x16x32_bf16 v[172:175], v[188:191], v[52:55], 0
ds_read_u16 v12, v12
v_and_b32_e64 v13, s47, v13
v_mfma_f32_16x16x32_f16 v[164:167], v[160:163], v[152:155], v[164:167]
ds_read_u16_d16_hi v15, v15
ds_read_u16 v13, v13
v_mfma_f32_16x16x32_bf16 v[156:159], v[188:191], v[24:27], 0
ds_read_b128 v[188:191], v249 offset:18688
v_pk_mul_f16 v9, v8, v9
v_mfma_f32_16x16x32_f16 v[168:171], v[160:163], v[148:151], v[168:171]
s_setprio 2
v_pk_mul_f16 v11, v10, v11
v_cvt_pkrtz_f16_f32 v96, v96, v97
s_waitcnt lgkmcnt(6)
v_mfma_f32_16x16x32_bf16 v[0:3], v[120:123], v[56:59], v[0:3]
v_cvt_pkrtz_f16_f32 v97, v98, v99
v_lshrrev_b64 v[96:97], 2, v[96:97]
v_mfma_f32_16x16x32_f16 v[132:135], v[160:163], v[144:147], v[132:135]
ds_read_b128 v[160:163], v251 offset:55296
v_and_b32_sdwa v98, s47, v96 dst_sel:DWORD dst_unused:UNUSED_PAD src0_sel:DWORD src1_sel:WORD_1
v_mfma_f32_16x16x32_bf16 v[172:175], v[120:123], v[60:63], v[172:175]
v_and_b32_e64 v96, s47, v96
v_lshl_add_u64 v[116:117], v[116:117], 0, v[118:119]
v_mfma_f32_16x16x32_f16 v[216:219], v[124:127], v[152:155], v[216:219]
ds_read_u16_d16_hi v98, v98
ds_read_u16 v96, v96
v_exp_f16_sdwa v9, v9 dst_sel:WORD_0 dst_unused:UNUSED_PRESERVE src0_sel:WORD_0
v_mfma_f32_16x16x32_bf16 v[156:159], v[120:123], v[32:35], v[156:159]
ds_read_b128 v[120:123], v249 offset:20736
v_exp_f16_sdwa v11, v11 dst_sel:WORD_0 dst_unused:UNUSED_PRESERVE src0_sel:WORD_0
v_mfma_f32_16x16x32_f16 v[220:223], v[124:127], v[148:151], v[220:223]
v_and_b32_sdwa v99, s47, v97 dst_sel:DWORD dst_unused:UNUSED_PAD src0_sel:DWORD src1_sel:WORD_1
v_and_b32_e64 v97, s47, v97
v_mfma_f32_16x16x32_bf16 v[0:3], v[184:187], v[64:67], v[0:3]
ds_read_u16_d16_hi v99, v99
ds_read_u16 v97, v97
v_lshl_add_u64 v[240:241], v[240:241], 0, v[242:243]
v_mfma_f32_16x16x32_f16 v[76:79], v[124:127], v[144:147], v[76:79]
ds_read_b128 v[124:127], v251 offset:53248
v_exp_f16_sdwa v9, v9 dst_sel:WORD_1 dst_unused:UNUSED_PRESERVE src0_sel:WORD_1
v_mfma_f32_16x16x32_bf16 v[172:175], v[184:187], v[68:71], v[172:175]
v_exp_f16_sdwa v11, v11 dst_sel:WORD_1 dst_unused:UNUSED_PRESERVE src0_sel:WORD_1
s_waitcnt lgkmcnt(7)
v_mfma_f32_16x16x32_f16 v[100:103], v[176:179], v[152:155], v[100:103]
v_lshl_add_u64 v[72:73], v[72:73], 0, v[74:75]
v_pk_add_f16 v9, v9, 1.0 op_sel_hi:[1,0]
v_mfma_f32_16x16x32_bf16 v[156:159], v[184:187], v[40:43], v[156:159]
ds_read_b128 v[184:187], v249 offset:22784
v_pk_add_f16 v11, v11, 1.0 op_sel_hi:[1,0]
v_mfma_f32_16x16x32_f16 v[104:107], v[176:179], v[148:151], v[104:107]
s_setprio 1
v_rcp_f16_sdwa v9, v9 dst_sel:WORD_0 dst_unused:UNUSED_PRESERVE src0_sel:WORD_0
v_mfma_f32_16x16x32_bf16 v[208:211], v[188:191], v[48:51], 0
v_rcp_f16_sdwa v11, v11 dst_sel:WORD_0 dst_unused:UNUSED_PRESERVE src0_sel:WORD_0
v_mfma_f32_16x16x32_f16 v[140:143], v[176:179], v[144:147], v[140:143]
ds_read_b128 v[176:179], v251 offset:56320
v_cvt_pkrtz_f16_f32 v172, v172, v173
v_mfma_f32_16x16x32_bf16 v[212:215], v[188:191], v[52:55], 0
v_cvt_pkrtz_f16_f32 v173, v174, v175
v_lshrrev_b64 v[172:173], 2, v[172:173]
s_waitcnt lgkmcnt(4)
v_mfma_f32_16x16x32_f16 v[232:235], v[160:163], v[152:155], v[232:235]
v_and_b32_sdwa v174, s47, v172 dst_sel:DWORD dst_unused:UNUSED_PAD src0_sel:DWORD src1_sel:WORD_1
v_and_b32 v172, s47, v172
v_cvt_pk_f16_f32 v0, v0, v1
v_mfma_f32_16x16x32_bf16 v[180:183], v[188:191], v[24:27], 0
ds_read_u16_d16_hi v174, v174
ds_read_u16 v172, v172
ds_read_b128 v[188:191], v249 offset:24576
v_rcp_f16_sdwa v9, v9 dst_sel:WORD_1 dst_unused:UNUSED_PRESERVE src0_sel:WORD_1
v_mfma_f32_16x16x32_f16 v[236:239], v[160:163], v[148:151], v[236:239]
v_cvt_pk_f16_f32 v2, v2, v3
v_pk_fma_f16 v1, v0, v0, s48
v_rcp_f16_sdwa v11, v11 dst_sel:WORD_1 dst_unused:UNUSED_PRESERVE src0_sel:WORD_1
s_add_u32 s46, s80, 4194304
buffer_load_dwordx4 v[108:111], v250, s[32:35], s46 offen
s_add_u32 s46, s80, 6291456
buffer_load_dwordx4 v[192:195], v250, s[32:35], s46 offen
v_mfma_f32_16x16x32_bf16 v[208:211], v[120:123], v[56:59], v[208:211]
v_and_b32_sdwa v175, s47, v173 dst_sel:DWORD dst_unused:UNUSED_PAD src0_sel:DWORD src1_sel:WORD_1
v_and_b32_e64 v173, s47, v173
v_pk_fma_f16 v3, v2, v2, s48
v_mfma_f32_16x16x32_f16 v[84:87], v[160:163], v[144:147], v[84:87]
ds_read_u16_d16_hi v175, v175
ds_read_u16 v173, v173
ds_read_b128 v[160:163], v251 offset:57344
v_pk_mul_f16 v1, v0, v1
v_pk_mul_f16 v118, v8, v9
v_mfma_f32_16x16x32_bf16 v[212:215], v[120:123], v[60:63], v[212:215]
v_pk_mul_f16 v3, v2, v3
buffer_load_dwordx4 v[196:199], v253, s[4:7], s69 offen offset:128
s_waitcnt lgkmcnt(6)
v_mfma_f32_16x16x32_f16 v[200:203], v[124:127], v[152:155], v[200:203]
v_cvt_pkrtz_f16_f32 v156, v156, v157
v_cvt_pkrtz_f16_f32 v157, v158, v159
v_lshrrev_b64 v[156:157], 2, v[156:157]
v_and_b32_sdwa v158, s47, v156 dst_sel:DWORD dst_unused:UNUSED_PAD src0_sel:DWORD src1_sel:WORD_1
v_and_b32 v156, s47, v156
v_pk_mul_f16 v119, v10, v11
v_exp_f16_sdwa v1, v1 dst_sel:WORD_0 dst_unused:UNUSED_PRESERVE src0_sel:WORD_0
v_lshl_add_u64 v[242:243], v[12:13], 0, v[14:15]
v_mfma_f32_16x16x32_bf16 v[180:183], v[120:123], v[32:35], v[180:183]
ds_read_u16_d16_hi v158, v158
ds_read_u16 v156, v156
ds_read_b128 v[120:123], v249 offset:26624
v_mfma_f32_16x16x32_f16 v[204:207], v[124:127], v[148:151], v[204:207]
v_exp_f16_sdwa v3, v3 dst_sel:WORD_0 dst_unused:UNUSED_PRESERVE src0_sel:WORD_0
v_and_b32_sdwa v159, s47, v157 dst_sel:DWORD dst_unused:UNUSED_PAD src0_sel:DWORD src1_sel:WORD_1
v_and_b32 v157, s47, v157
v_mfma_f32_16x16x32_bf16 v[208:211], v[184:187], v[64:67], v[208:211]
ds_read_u16_d16_hi v159, v159
ds_read_u16 v157, v157
s_setprio 0
v_mfma_f32_16x16x32_f16 v[244:247], v[124:127], v[144:147], v[244:247]
ds_read_b128 v[124:127], v251 offset:60416
v_exp_f16_sdwa v1, v1 dst_sel:WORD_1 dst_unused:UNUSED_PRESERVE src0_sel:WORD_1
v_mfma_f32_16x16x32_bf16 v[212:215], v[184:187], v[68:71], v[212:215]
v_lshl_add_u64 v[74:75], v[96:97], 0, v[98:99]
v_exp_f16_sdwa v3, v3 dst_sel:WORD_1 dst_unused:UNUSED_PRESERVE src0_sel:WORD_1
v_mfma_f32_16x16x32_f16 v[4:7], v[176:179], v[152:155], v[4:7]
v_pk_add_f16 v1, v1, 1.0 op_sel_hi:[1,0]
v_pk_add_f16 v3, v3, 1.0 op_sel_hi:[1,0]
v_mfma_f32_16x16x32_bf16 v[180:183], v[184:187], v[40:43], v[180:183]
ds_read_b128 v[184:187], v249 offset:28672
v_rcp_f16_sdwa v1, v1 dst_sel:WORD_0 dst_unused:UNUSED_PRESERVE src0_sel:WORD_0
v_mfma_f32_16x16x32_f16 v[224:227], v[176:179], v[148:151], v[224:227]
v_rcp_f16_sdwa v3, v3 dst_sel:WORD_0 dst_unused:UNUSED_PRESERVE src0_sel:WORD_0
s_waitcnt lgkmcnt(6)
v_mfma_f32_16x16x32_bf16 v[8:11], v[188:191], v[48:51], 0
v_cvt_pkrtz_f16_f32 v208, v208, v209
v_cvt_pkrtz_f16_f32 v209, v210, v211
v_mfma_f32_16x16x32_f16 v[92:95], v[176:179], v[144:147], v[92:95]
ds_read_b128 v[176:179], v251 offset:58368
v_lshrrev_b64 v[208:209], 2, v[208:209]
s_waitcnt vmcnt(8)
v_mfma_f32_16x16x32_bf16 v[104:107], v[18:21], v[80:83], v[104:107]
v_and_b32_sdwa v210, s47, v208 dst_sel:DWORD dst_unused:UNUSED_PAD src0_sel:DWORD src1_sel:WORD_1
v_and_b32 v208, s47, v208
v_mfma_f32_16x16x32_bf16 v[236:239], v[16:19], v[80:83], v[236:239]
ds_read_u16_d16_hi v210, v210
ds_read_u16 v208, v208
s_waitcnt vmcnt(7)
v_mfma_f32_16x16x32_bf16 v[204:207], v[18:21], v[88:91], v[204:207]
v_rcp_f16_sdwa v1, v1 dst_sel:WORD_1 dst_unused:UNUSED_PRESERVE src0_sel:WORD_1
v_mfma_f32_16x16x32_bf16 v[224:227], v[16:19], v[88:91], v[224:227]
v_and_b32_sdwa v211, s47, v209 dst_sel:DWORD dst_unused:UNUSED_PAD src0_sel:DWORD src1_sel:WORD_1
v_and_b32_e64 v209, s47, v209
v_mfma_f32_16x16x32_bf16 v[12:15], v[188:191], v[52:55], 0
ds_read_u16_d16_hi v211, v211
ds_read_u16 v209, v209
v_mfma_f32_16x16x32_f16 v[164:167], v[160:163], v[72:75], v[164:167]
v_rcp_f16_sdwa v3, v3 dst_sel:WORD_1 dst_unused:UNUSED_PRESERVE src0_sel:WORD_1
v_mfma_f32_16x16x32_bf16 v[96:99], v[188:191], v[24:27], 0
ds_read_b128 v[188:191], v249 offset:24832
v_cvt_pkrtz_f16_f32 v212, v212, v213
v_mfma_f32_16x16x32_f16 v[168:171], v[160:163], v[240:243], v[168:171]
s_setprio 3
v_cvt_pkrtz_f16_f32 v213, v214, v215
v_lshrrev_b64 v[212:213], 2, v[212:213]
s_waitcnt lgkmcnt(5)
v_mfma_f32_16x16x32_bf16 v[8:11], v[120:123], v[56:59], v[8:11]
v_and_b32_sdwa v214, s47, v212 dst_sel:DWORD dst_unused:UNUSED_PAD src0_sel:DWORD src1_sel:WORD_1
v_and_b32_e64 v212, s47, v212
v_mfma_f32_16x16x32_f16 v[132:135], v[160:163], v[116:119], v[132:135]
ds_read_b128 v[160:163], v251 offset:61440
ds_read_u16_d16_hi v214, v214
ds_read_u16 v212, v212
v_pk_mul_f16 v0, v0, v1
v_mfma_f32_16x16x32_bf16 v[12:15], v[120:123], v[60:63], v[12:15]
v_and_b32_sdwa v215, s47, v213 dst_sel:DWORD dst_unused:UNUSED_PAD src0_sel:DWORD src1_sel:WORD_1
v_and_b32_e64 v213, s47, v213
v_mfma_f32_16x16x32_f16 v[216:219], v[124:127], v[72:75], v[216:219]
ds_read_u16_d16_hi v215, v215
ds_read_u16 v213, v213
v_pk_mul_f16 v1, v2, v3
v_lshl_add_u64 v[172:173], v[172:173], 0, v[174:175]
v_mfma_f32_16x16x32_bf16 v[96:99], v[120:123], v[32:35], v[96:99]
ds_read_b128 v[120:123], v249 offset:26880
v_cvt_pkrtz_f16_f32 v180, v180, v181
v_cvt_pkrtz_f16_f32 v181, v182, v183
v_lshrrev_b64 v[180:181], 2, v[180:181]
v_and_b32_sdwa v182, s47, v180 dst_sel:DWORD dst_unused:UNUSED_PAD src0_sel:DWORD src1_sel:WORD_1
v_and_b32_e64 v180, s47, v180
v_mfma_f32_16x16x32_f16 v[220:223], v[124:127], v[240:243], v[220:223]
ds_read_u16_d16_hi v182, v182
ds_read_u16 v180, v180
v_and_b32_sdwa v183, s47, v181 dst_sel:DWORD dst_unused:UNUSED_PAD src0_sel:DWORD src1_sel:WORD_1
v_and_b32 v181, s47, v181
v_mfma_f32_16x16x32_bf16 v[8:11], v[184:187], v[64:67], v[8:11]
ds_read_u16_d16_hi v183, v183
ds_read_u16 v181, v181
s_add_u32 s46, s80, 8388608
buffer_load_dwordx4 v[144:147], v250, s[32:35], s46 offen
s_add_u32 s46, s80, 10485760
buffer_load_dwordx4 v[148:151], v250, s[32:35], s46 offen
v_mfma_f32_16x16x32_f16 v[76:79], v[124:127], v[116:119], v[76:79]
s_waitcnt lgkmcnt(9)
ds_read_b128 v[124:127], v251 offset:59392
v_lshl_add_u64 v[156:157], v[156:157], 0, v[158:159]
v_mfma_f32_16x16x32_bf16 v[12:15], v[184:187], v[68:71], v[12:15]
v_cvt_pk_f16_f32 v8, v8, v9
v_cvt_pk_f16_f32 v10, v10, v11
v_mfma_f32_16x16x32_f16 v[100:103], v[176:179], v[72:75], v[100:103]
v_pk_fma_f16 v9, v8, v8, s48
v_pk_fma_f16 v11, v10, v10, s48
v_mfma_f32_16x16x32_bf16 v[96:99], v[184:187], v[40:43], v[96:99]
ds_read_b128 v[184:187], v249 offset:28928
s_nop 0
v_cvt_pkrtz_f16_f32 v12, v12, v13
v_mfma_f32_16x16x32_f16 v[104:107], v[176:179], v[240:243], v[104:107]
s_setprio 2
v_cvt_pkrtz_f16_f32 v13, v14, v15
v_lshrrev_b64 v[12:13], 2, v[12:13]
v_mfma_f32_16x16x32_bf16 v[152:155], v[188:191], v[48:51], 0
v_and_b32_sdwa v14, s47, v12 dst_sel:DWORD dst_unused:UNUSED_PAD src0_sel:DWORD src1_sel:WORD_1
v_and_b32_e64 v12, s47, v12
v_mfma_f32_16x16x32_f16 v[140:143], v[176:179], v[116:119], v[140:143]
ds_read_b128 v[176:179], v251 offset:62464
ds_read_u16_d16_hi v14, v14
v_mfma_f32_16x16x32_bf16 v[80:83], v[188:191], v[52:55], 0
ds_read_u16 v12, v12
v_and_b32_sdwa v15, s47, v13 dst_sel:DWORD dst_unused:UNUSED_PAD src0_sel:DWORD src1_sel:WORD_1
v_mfma_f32_16x16x32_f16 v[232:235], v[160:163], v[72:75], v[232:235]
v_and_b32 v13, s47, v13
v_pk_mul_f16 v9, v8, v9
v_mfma_f32_16x16x32_bf16 v[88:91], v[188:191], v[24:27], 0
ds_read_b128 v[188:191], v249 offset:30720
s_waitcnt lgkmcnt(8)
ds_read_u16_d16_hi v15, v15
v_mfma_f32_16x16x32_f16 v[236:239], v[160:163], v[240:243], v[236:239]
ds_read_u16 v13, v13
v_pk_mul_f16 v11, v10, v11
v_mfma_f32_16x16x32_bf16 v[152:155], v[120:123], v[56:59], v[152:155]
v_cvt_pkrtz_f16_f32 v96, v96, v97
v_cvt_pkrtz_f16_f32 v97, v98, v99
v_mfma_f32_16x16x32_f16 v[84:87], v[160:163], v[116:119], v[84:87]
ds_read_b128 v[160:163], v251 offset:63488
v_lshrrev_b64 v[96:97], 2, v[96:97]
v_mfma_f32_16x16x32_bf16 v[80:83], v[120:123], v[60:63], v[80:83]
v_and_b32_sdwa v98, s47, v96 dst_sel:DWORD dst_unused:UNUSED_PAD src0_sel:DWORD src1_sel:WORD_1
v_and_b32 v96, s47, v96
s_waitcnt lgkmcnt(7)
v_mfma_f32_16x16x32_f16 v[200:203], v[124:127], v[72:75], v[200:203]
ds_read_u16_d16_hi v98, v98
ds_read_u16 v96, v96
v_lshl_add_u64 v[2:3], v[208:209], 0, v[210:211]
v_exp_f16_sdwa v9, v9 dst_sel:WORD_0 dst_unused:UNUSED_PRESERVE src0_sel:WORD_0
v_mfma_f32_16x16x32_bf16 v[88:91], v[120:123], v[32:35], v[88:91]
ds_read_b128 v[120:123], v249 offset:32768
v_exp_f16_sdwa v11, v11 dst_sel:WORD_0 dst_unused:UNUSED_PRESERVE src0_sel:WORD_0
v_mfma_f32_16x16x32_f16 v[204:207], v[124:127], v[240:243], v[204:207]
s_setprio 1
v_and_b32_sdwa v99, s47, v97 dst_sel:DWORD dst_unused:UNUSED_PAD src0_sel:DWORD src1_sel:WORD_1
v_and_b32_e64 v97, s47, v97
v_mfma_f32_16x16x32_bf16 v[152:155], v[184:187], v[64:67], v[152:155]
ds_read_u16_d16_hi v99, v99
ds_read_u16 v97, v97
v_lshl_add_u64 v[174:175], v[212:213], 0, v[214:215]
v_mfma_f32_16x16x32_f16 v[244:247], v[124:127], v[116:119], v[244:247]
ds_read_b128 v[124:127], v252 offset:1024
v_exp_f16_sdwa v9, v9 dst_sel:WORD_1 dst_unused:UNUSED_PRESERVE src0_sel:WORD_1
v_mfma_f32_16x16x32_bf16 v[80:83], v[184:187], v[68:71], v[80:83]
v_exp_f16_sdwa v11, v11 dst_sel:WORD_1 dst_unused:UNUSED_PRESERVE src0_sel:WORD_1
s_waitcnt lgkmcnt(7)
v_mfma_f32_16x16x32_f16 v[4:7], v[176:179], v[72:75], v[4:7]
v_lshl_add_u64 v[158:159], v[180:181], 0, v[182:183]
v_pk_add_f16 v9, v9, 1.0 op_sel_hi:[1,0]
v_mfma_f32_16x16x32_bf16 v[88:91], v[184:187], v[40:43], v[88:91]
ds_read_b128 v[184:187], v249 offset:34816
v_pk_add_f16 v11, v11, 1.0 op_sel_hi:[1,0]
v_mfma_f32_16x16x32_f16 v[224:227], v[176:179], v[240:243], v[224:227]
v_rcp_f16_sdwa v9, v9 dst_sel:WORD_0 dst_unused:UNUSED_PRESERVE src0_sel:WORD_0
v_mfma_f32_16x16x32_bf16 v[208:211], v[188:191], v[48:51], 0
v_rcp_f16_sdwa v11, v11 dst_sel:WORD_0 dst_unused:UNUSED_PRESERVE src0_sel:WORD_0
v_mfma_f32_16x16x32_f16 v[92:95], v[176:179], v[116:119], v[92:95]
ds_read_b128 v[176:179], v251 offset:64512
v_cvt_pkrtz_f16_f32 v80, v80, v81
v_mfma_f32_16x16x32_bf16 v[212:215], v[188:191], v[52:55], 0
v_cvt_pkrtz_f16_f32 v81, v82, v83
v_lshrrev_b64 v[80:81], 2, v[80:81]
s_waitcnt lgkmcnt(5)
v_mfma_f32_16x16x32_f16 v[164:167], v[160:163], v[156:159], v[164:167]
v_and_b32_sdwa v82, s47, v80 dst_sel:DWORD dst_unused:UNUSED_PAD src0_sel:DWORD src1_sel:WORD_1
v_and_b32 v80, s47, v80
v_cvt_pk_f16_f32 v152, v152, v153
v_mfma_f32_16x16x32_bf16 v[180:183], v[188:191], v[24:27], 0
ds_read_u16_d16_hi v82, v82
ds_read_u16 v80, v80
ds_read_b128 v[188:191], v249 offset:30976
v_rcp_f16_sdwa v9, v9 dst_sel:WORD_1 dst_unused:UNUSED_PRESERVE src0_sel:WORD_1
s_setprio 0
v_mfma_f32_16x16x32_f16 v[168:171], v[160:163], v[172:175], v[168:171]
v_cvt_pk_f16_f32 v154, v154, v155
v_pk_fma_f16 v153, v152, v152, s48
v_rcp_f16_sdwa v11, v11 dst_sel:WORD_1 dst_unused:UNUSED_PRESERVE src0_sel:WORD_1
v_mfma_f32_16x16x32_bf16 v[208:211], v[120:123], v[56:59], v[208:211]
v_and_b32_sdwa v83, s47, v81 dst_sel:DWORD dst_unused:UNUSED_PAD src0_sel:DWORD src1_sel:WORD_1
v_and_b32 v81, s47, v81
v_pk_fma_f16 v155, v154, v154, s48
v_mfma_f32_16x16x32_f16 v[132:135], v[160:163], v[0:3], v[132:135]
ds_read_u16_d16_hi v83, v83
ds_read_u16 v81, v81
ds_read_b128 v[160:163], v252 offset:2048
v_pk_mul_f16 v153, v152, v153
v_pk_mul_f16 v8, v8, v9
v_mfma_f32_16x16x32_bf16 v[212:215], v[120:123], v[60:63], v[212:215]
v_pk_mul_f16 v155, v154, v155
v_cvt_pkrtz_f16_f32 v88, v88, v89
s_waitcnt lgkmcnt(6)
v_mfma_f32_16x16x32_f16 v[216:219], v[124:127], v[156:159], v[216:219]
v_cvt_pkrtz_f16_f32 v89, v90, v91
v_lshrrev_b64 v[88:89], 2, v[88:89]
v_and_b32_sdwa v90, s47, v88 dst_sel:DWORD dst_unused:UNUSED_PAD src0_sel:DWORD src1_sel:WORD_1
v_and_b32 v88, s47, v88
v_pk_mul_f16 v9, v10, v11
v_exp_f16_sdwa v153, v153 dst_sel:WORD_0 dst_unused:UNUSED_PRESERVE src0_sel:WORD_0
v_lshl_add_u64 v[12:13], v[12:13], 0, v[14:15]
v_mfma_f32_16x16x32_bf16 v[180:183], v[120:123], v[32:35], v[180:183]
ds_read_u16_d16_hi v90, v90
ds_read_u16 v88, v88
v_mfma_f32_16x16x32_f16 v[220:223], v[124:127], v[172:175], v[220:223]
ds_read_b128 v[120:123], v249 offset:35072
v_exp_f16_sdwa v155, v155 dst_sel:WORD_0 dst_unused:UNUSED_PRESERVE src0_sel:WORD_0
v_and_b32_sdwa v91, s47, v89 dst_sel:DWORD dst_unused:UNUSED_PAD src0_sel:DWORD src1_sel:WORD_1
v_and_b32_e64 v89, s47, v89
v_mfma_f32_16x16x32_bf16 v[208:211], v[184:187], v[64:67], v[208:211]
ds_read_u16_d16_hi v91, v91
ds_read_u16 v89, v89
s_waitcnt vmcnt(5)
v_permlane16_swap_b32 v128, v136
v_permlane16_swap_b32 v129, v137
v_permlane16_swap_b32 v130, v138
v_permlane16_swap_b32 v131, v139
s_waitcnt vmcnt(3)
v_permlane16_swap_b32 v108, v192
v_permlane16_swap_b32 v109, v193
v_permlane16_swap_b32 v110, v194
v_permlane16_swap_b32 v111, v195
v_mfma_f32_16x16x32_f16 v[76:79], v[124:127], v[0:3], v[76:79]
v_exp_f16_sdwa v153, v153 dst_sel:WORD_1 dst_unused:UNUSED_PRESERVE src0_sel:WORD_1
v_mfma_f32_16x16x32_bf16 v[212:215], v[184:187], v[68:71], v[212:215]
ds_read_b128 v[124:127], v252 offset:3072
v_lshl_add_u64 v[96:97], v[96:97], 0, v[98:99]
v_mfma_f32_16x16x32_f16 v[100:103], v[176:179], v[156:159], v[100:103]
v_exp_f16_sdwa v155, v155 dst_sel:WORD_1 dst_unused:UNUSED_PRESERVE src0_sel:WORD_1
v_mfma_f32_16x16x32_bf16 v[180:183], v[184:187], v[40:43], v[180:183]
s_setprio 3
v_pk_add_f16 v153, v153, 1.0 op_sel_hi:[1,0]
v_pk_add_f16 v155, v155, 1.0 op_sel_hi:[1,0]
v_mfma_f32_16x16x32_f16 v[104:107], v[176:179], v[172:175], v[104:107]
ds_read_b128 v[184:187], v248
v_rcp_f16_sdwa v153, v153 dst_sel:WORD_0 dst_unused:UNUSED_PRESERVE src0_sel:WORD_0
s_waitcnt lgkmcnt(4)
v_mfma_f32_16x16x32_bf16 v[116:119], v[188:191], v[48:51], 0
ds_read_b128 v[48:51], v252
v_rcp_f16_sdwa v155, v155 dst_sel:WORD_0 dst_unused:UNUSED_PRESERVE src0_sel:WORD_0
v_mfma_f32_16x16x32_f16 v[140:143], v[176:179], v[0:3], v[140:143]
ds_read_b128 v[176:179], v252 offset:4096
v_cvt_pkrtz_f16_f32 v208, v208, v209
v_mfma_f32_16x16x32_bf16 v[240:243], v[188:191], v[52:55], 0
ds_read_b128 v[52:55], v249 offset:33024
v_cvt_pkrtz_f16_f32 v209, v210, v211
v_mfma_f32_16x16x32_f16 v[232:235], v[160:163], v[156:159], v[232:235]
v_lshrrev_b64 v[208:209], 2, v[208:209]
v_and_b32_sdwa v210, s47, v208 dst_sel:DWORD dst_unused:UNUSED_PAD src0_sel:DWORD src1_sel:WORD_1
v_and_b32_e64 v208, s47, v208
v_mfma_f32_16x16x32_bf16 v[72:75], v[188:191], v[24:27], 0
ds_read_u16_d16_hi v210, v210
ds_read_u16 v208, v208
v_rcp_f16_sdwa v153, v153 dst_sel:WORD_1 dst_unused:UNUSED_PRESERVE src0_sel:WORD_1
v_mfma_f32_16x16x32_f16 v[236:239], v[160:163], v[172:175], v[236:239]
ds_read_b128 v[188:191], v248 offset:2048
v_and_b32_sdwa v211, s47, v209 dst_sel:DWORD dst_unused:UNUSED_PAD src0_sel:DWORD src1_sel:WORD_1
v_and_b32_e64 v209, s47, v209
v_rcp_f16_sdwa v155, v155 dst_sel:WORD_1 dst_unused:UNUSED_PRESERVE src0_sel:WORD_1
ds_read_u16_d16_hi v211, v211
ds_read_u16 v209, v209
s_waitcnt lgkmcnt(5)
v_mfma_f32_16x16x32_bf16 v[116:119], v[52:55], v[56:59], v[116:119]
s_waitcnt vmcnt(0)
v_permlane16_swap_b32 v144, v148
v_permlane16_swap_b32 v145, v149
v_permlane16_swap_b32 v146, v150
v_permlane16_swap_b32 v147, v151
v_mfma_f32_16x16x32_f16 v[84:87], v[160:163], v[0:3], v[84:87]
v_cvt_pkrtz_f16_f32 v212, v212, v213
v_cvt_pkrtz_f16_f32 v213, v214, v215
v_lshrrev_b64 v[212:213], 2, v[212:213]
v_and_b32_sdwa v214, s47, v212 dst_sel:DWORD dst_unused:UNUSED_PAD src0_sel:DWORD src1_sel:WORD_1
v_and_b32_e64 v212, s47, v212
v_pk_mul_f16 v10, v152, v153
v_mfma_f32_16x16x32_bf16 v[240:243], v[52:55], v[60:63], v[240:243]
ds_read_u16_d16_hi v214, v214
ds_read_u16 v212, v212
ds_read_b128 v[160:163], v252 offset:7168
v_mfma_f32_16x16x32_f16 v[200:203], v[48:51], v[156:159], v[200:203]
v_and_b32_sdwa v215, s47, v213 dst_sel:DWORD dst_unused:UNUSED_PAD src0_sel:DWORD src1_sel:WORD_1
v_and_b32_e64 v213, s47, v213
v_pk_mul_f16 v11, v154, v155
v_lshl_add_u64 v[14:15], v[80:81], 0, v[82:83]
v_mfma_f32_16x16x32_bf16 v[72:75], v[52:55], v[32:35], v[72:75]
ds_read_u16_d16_hi v215, v215
ds_read_u16 v213, v213
s_setprio 2
v_cvt_pkrtz_f16_f32 v180, v180, v181
v_cvt_pkrtz_f16_f32 v181, v182, v183
v_lshrrev_b64 v[180:181], 2, v[180:181]
v_and_b32_sdwa v182, s47, v180 dst_sel:DWORD dst_unused:UNUSED_PAD src0_sel:DWORD src1_sel:WORD_1
v_and_b32 v180, s47, v180
v_mfma_f32_16x16x32_f16 v[204:207], v[48:51], v[172:175], v[204:207]
ds_read_u16_d16_hi v182, v182
ds_read_u16 v180, v180
ds_read_b128 v[52:55], v248 offset:4096
v_and_b32_sdwa v183, s47, v181 dst_sel:DWORD dst_unused:UNUSED_PAD src0_sel:DWORD src1_sel:WORD_1
v_and_b32_e64 v181, s47, v181
v_mfma_f32_16x16x32_bf16 v[116:119], v[120:123], v[64:67], v[116:119]
ds_read_u16_d16_hi v183, v183
ds_read_u16 v181, v181
v_mfma_f32_16x16x32_f16 v[244:247], v[48:51], v[0:3], v[244:247]
s_waitcnt lgkmcnt(10)
ds_read_b128 v[48:51], v252 offset:5120
v_lshl_add_u64 v[98:99], v[88:89], 0, v[90:91]
v_mfma_f32_16x16x32_bf16 v[240:243], v[120:123], v[68:71], v[240:243]
s_nop 0
v_cvt_pk_f16_f32 v116, v116, v117
v_mfma_f32_16x16x32_f16 v[4:7], v[124:127], v[156:159], v[4:7]
v_cvt_pk_f16_f32 v118, v118, v119
v_pk_fma_f16 v117, v116, v116, s48
v_mfma_f32_16x16x32_bf16 v[72:75], v[120:123], v[40:43], v[72:75]
ds_read_b128 v[120:123], v248 offset:256
s_nop 0
v_cvt_pkrtz_f16_f32 v240, v240, v241
v_mfma_f32_16x16x32_f16 v[224:227], v[124:127], v[172:175], v[224:227]
v_cvt_pkrtz_f16_f32 v241, v242, v243
v_lshrrev_b64 v[240:241], 2, v[240:241]
v_mfma_f32_16x16x32_bf16 v[24:27], v[184:187], v[28:31], 0
v_and_b32_sdwa v242, s47, v240 dst_sel:DWORD dst_unused:UNUSED_PAD src0_sel:DWORD src1_sel:WORD_1
v_and_b32 v240, s47, v240
v_mfma_f32_16x16x32_f16 v[92:95], v[124:127], v[0:3], v[92:95]
ds_read_b128 v[124:127], v252 offset:8192
ds_read_u16_d16_hi v242, v242
v_mfma_f32_16x16x32_bf16 v[164:167], v[18:21], v[228:231], v[164:167]
ds_read_u16 v240, v240
v_and_b32_sdwa v243, s47, v241 dst_sel:DWORD dst_unused:UNUSED_PAD src0_sel:DWORD src1_sel:WORD_1
v_mfma_f32_16x16x32_bf16 v[216:219], v[16:19], v[228:231], v[216:219]
v_and_b32 v241, s47, v241
v_pk_fma_f16 v119, v118, v118, s48
v_mfma_f32_16x16x32_bf16 v[100:103], v[18:21], v[112:115], v[100:103]
s_waitcnt lgkmcnt(8)
ds_read_u16_d16_hi v243, v243
ds_read_u16 v241, v241
v_mfma_f32_16x16x32_bf16 v[232:235], v[16:19], v[112:115], v[232:235]
v_pk_mul_f16 v117, v116, v117
v_pk_mul_f16 v119, v118, v119
v_mfma_f32_16x16x32_bf16 v[56:59], v[184:187], v[128:131], 0
v_cvt_pkrtz_f16_f32 v72, v72, v73
v_cvt_pkrtz_f16_f32 v73, v74, v75
v_mfma_f32_16x16x32_f16 v[164:167], v[176:179], v[96:99], v[164:167]
s_setprio 1
v_lshrrev_b64 v[72:73], 2, v[72:73]
v_and_b32_sdwa v74, s47, v72 dst_sel:DWORD dst_unused:UNUSED_PAD src0_sel:DWORD src1_sel:WORD_1
v_mfma_f32_16x16x32_bf16 v[60:63], v[184:187], v[136:139], 0
ds_read_b128 v[184:187], v248 offset:2304
v_and_b32 v72, s47, v72
v_mfma_f32_16x16x32_f16 v[168:171], v[176:179], v[12:15], v[168:171]
ds_read_u16_d16_hi v74, v74
ds_read_u16 v72, v72
v_mfma_f32_16x16x32_bf16 v[24:27], v[188:191], v[36:39], v[24:27]
v_lshl_add_u64 v[208:209], v[208:209], 0, v[210:211]
v_exp_f16_sdwa v117, v117 dst_sel:WORD_0 dst_unused:UNUSED_PRESERVE src0_sel:WORD_0
v_mfma_f32_16x16x32_f16 v[132:135], v[176:179], v[8:11], v[132:135]
ds_read_b128 v[176:179], v252 offset:6144
v_exp_f16_sdwa v119, v119 dst_sel:WORD_0 dst_unused:UNUSED_PRESERVE src0_sel:WORD_0
v_mfma_f32_16x16x32_bf16 v[56:59], v[188:191], v[108:111], v[56:59]
v_and_b32_sdwa v75, s47, v73 dst_sel:DWORD dst_unused:UNUSED_PAD src0_sel:DWORD src1_sel:WORD_1
v_and_b32 v73, s47, v73
v_mfma_f32_16x16x32_f16 v[216:219], v[160:163], v[96:99], v[216:219]
ds_read_u16_d16_hi v75, v75
s_waitcnt lgkmcnt(7)
ds_read_u16 v73, v73
v_mfma_f32_16x16x32_bf16 v[60:63], v[188:191], v[192:195], v[60:63]
ds_read_b128 v[188:191], v248 offset:4352
v_lshl_add_u64 v[212:213], v[212:213], 0, v[214:215]
v_mfma_f32_16x16x32_f16 v[220:223], v[160:163], v[12:15], v[220:223]
v_exp_f16_sdwa v117, v117 dst_sel:WORD_1 dst_unused:UNUSED_PRESERVE src0_sel:WORD_1
v_mfma_f32_16x16x32_bf16 v[24:27], v[52:55], v[44:47], v[24:27]
v_exp_f16_sdwa v119, v119 dst_sel:WORD_1 dst_unused:UNUSED_PRESERVE src0_sel:WORD_1
v_mfma_f32_16x16x32_f16 v[76:79], v[160:163], v[8:11], v[76:79]
ds_read_b128 v[160:163], v252 offset:9216
v_lshl_add_u64 v[180:181], v[180:181], 0, v[182:183]
v_mfma_f32_16x16x32_bf16 v[56:59], v[52:55], v[144:147], v[56:59]
v_pk_add_f16 v117, v117, 1.0 op_sel_hi:[1,0]
v_pk_add_f16 v119, v119, 1.0 op_sel_hi:[1,0]
v_mfma_f32_16x16x32_f16 v[100:103], v[48:51], v[96:99], v[100:103]
s_setprio 0
v_rcp_f16_sdwa v117, v117 dst_sel:WORD_0 dst_unused:UNUSED_PRESERVE src0_sel:WORD_0
v_mfma_f32_16x16x32_bf16 v[60:63], v[52:55], v[148:151], v[60:63]
ds_read_b128 v[52:55], v248 offset:6144
v_rcp_f16_sdwa v119, v119 dst_sel:WORD_0 dst_unused:UNUSED_PRESERVE src0_sel:WORD_0
v_mfma_f32_16x16x32_f16 v[104:107], v[48:51], v[12:15], v[104:107]
v_cvt_pkrtz_f16_f32 v24, v24, v25
v_cvt_pkrtz_f16_f32 v25, v26, v27
v_mfma_f32_16x16x32_bf16 v[32:35], v[120:123], v[28:31], 0
v_lshrrev_b64 v[24:25], 2, v[24:25]
v_and_b32_sdwa v26, s47, v24 dst_sel:DWORD dst_unused:UNUSED_PAD src0_sel:DWORD src1_sel:WORD_1
v_mfma_f32_16x16x32_f16 v[140:143], v[48:51], v[8:11], v[140:143]
ds_read_b128 v[48:51], v252 offset:10240
v_and_b32 v24, s47, v24
v_mfma_f32_16x16x32_bf16 v[152:155], v[120:123], v[128:131], 0
ds_read_u16_d16_hi v26, v26
ds_read_u16 v24, v24
v_mfma_f32_16x16x32_f16 v[232:235], v[124:127], v[96:99], v[232:235]
v_rcp_f16_sdwa v117, v117 dst_sel:WORD_1 dst_unused:UNUSED_PRESERVE src0_sel:WORD_1
v_mfma_f32_16x16x32_bf16 v[80:83], v[120:123], v[136:139], 0
ds_read_b128 v[120:123], v248 offset:8192
v_and_b32_sdwa v27, s47, v25 dst_sel:DWORD dst_unused:UNUSED_PAD src0_sel:DWORD src1_sel:WORD_1
v_mfma_f32_16x16x32_f16 v[236:239], v[124:127], v[12:15], v[236:239]
v_and_b32 v25, s47, v25
v_rcp_f16_sdwa v119, v119 dst_sel:WORD_1 dst_unused:UNUSED_PRESERVE src0_sel:WORD_1
s_waitcnt lgkmcnt(4)
v_mfma_f32_16x16x32_bf16 v[32:35], v[184:187], v[36:39], v[32:35]
ds_read_u16_d16_hi v27, v27
ds_read_u16 v25, v25
v_mfma_f32_16x16x32_f16 v[84:87], v[124:127], v[8:11], v[84:87]
v_cvt_pkrtz_f16_f32 v56, v56, v57
v_cvt_pkrtz_f16_f32 v57, v58, v59
v_lshrrev_b64 v[56:57], 2, v[56:57]
v_and_b32_sdwa v58, s47, v56 dst_sel:DWORD dst_unused:UNUSED_PAD src0_sel:DWORD src1_sel:WORD_1
v_and_b32_e64 v56, s47, v56
v_pk_mul_f16 v210, v116, v117
v_mfma_f32_16x16x32_bf16 v[152:155], v[184:187], v[108:111], v[152:155]
ds_read_u16_d16_hi v58, v58
ds_read_u16 v56, v56
ds_read_b128 v[124:127], v252 offset:13312
v_mfma_f32_16x16x32_f16 v[200:203], v[176:179], v[96:99], v[200:203]
v_and_b32_sdwa v59, s47, v57 dst_sel:DWORD dst_unused:UNUSED_PAD src0_sel:DWORD src1_sel:WORD_1
v_and_b32_e64 v57, s47, v57
v_pk_mul_f16 v211, v118, v119
v_lshl_add_u64 v[214:215], v[240:241], 0, v[242:243]
v_mfma_f32_16x16x32_bf16 v[80:83], v[184:187], v[192:195], v[80:83]
ds_read_u16_d16_hi v59, v59
ds_read_u16 v57, v57
s_setprio 3
v_cvt_pkrtz_f16_f32 v60, v60, v61
v_cvt_pkrtz_f16_f32 v61, v62, v63
v_lshrrev_b64 v[60:61], 2, v[60:61]
v_and_b32_sdwa v62, s47, v60 dst_sel:DWORD dst_unused:UNUSED_PAD src0_sel:DWORD src1_sel:WORD_1
v_and_b32 v60, s47, v60
v_mfma_f32_16x16x32_f16 v[204:207], v[176:179], v[12:15], v[204:207]
ds_read_u16_d16_hi v62, v62
ds_read_u16 v60, v60
ds_read_b128 v[184:187], v248 offset:10240
v_and_b32_sdwa v63, s47, v61 dst_sel:DWORD dst_unused:UNUSED_PAD src0_sel:DWORD src1_sel:WORD_1
v_and_b32 v61, s47, v61
v_mfma_f32_16x16x32_bf16 v[32:35], v[188:191], v[44:47], v[32:35]
ds_read_u16_d16_hi v63, v63
s_waitcnt lgkmcnt(9)
ds_read_u16 v61, v61
v_mfma_f32_16x16x32_f16 v[244:247], v[176:179], v[8:11], v[244:247]
ds_read_b128 v[176:179], v252 offset:11264
v_lshl_add_u64 v[182:183], v[72:73], 0, v[74:75]
v_mfma_f32_16x16x32_bf16 v[152:155], v[188:191], v[144:147], v[152:155]
s_nop 0
v_cvt_pk_f16_f32 v32, v32, v33
v_mfma_f32_16x16x32_f16 v[4:7], v[160:163], v[96:99], v[4:7]
v_cvt_pk_f16_f32 v34, v34, v35
v_pk_fma_f16 v33, v32, v32, s48
v_mfma_f32_16x16x32_bf16 v[80:83], v[188:191], v[148:151], v[80:83]
ds_read_b128 v[188:191], v248 offset:6400
s_nop 0
v_cvt_pkrtz_f16_f32 v152, v152, v153
v_mfma_f32_16x16x32_f16 v[224:227], v[160:163], v[12:15], v[224:227]
v_cvt_pkrtz_f16_f32 v153, v154, v155
v_lshrrev_b64 v[152:153], 2, v[152:153]
v_mfma_f32_16x16x32_bf16 v[88:91], v[52:55], v[28:31], 0
v_and_b32_sdwa v154, s47, v152 dst_sel:DWORD dst_unused:UNUSED_PAD src0_sel:DWORD src1_sel:WORD_1
v_and_b32_e64 v152, s47, v152
v_mfma_f32_16x16x32_f16 v[92:95], v[160:163], v[8:11], v[92:95]
ds_read_b128 v[160:163], v252 offset:14336
ds_read_u16_d16_hi v154, v154
v_mfma_f32_16x16x32_bf16 v[64:67], v[52:55], v[128:131], 0
ds_read_u16 v152, v152
v_and_b32_sdwa v155, s47, v153 dst_sel:DWORD dst_unused:UNUSED_PAD src0_sel:DWORD src1_sel:WORD_1
v_mfma_f32_16x16x32_f16 v[164:167], v[48:51], v[180:183], v[164:167]
s_setprio 2
v_and_b32_e64 v153, s47, v153
v_pk_fma_f16 v35, v34, v34, s48
v_mfma_f32_16x16x32_bf16 v[68:71], v[52:55], v[136:139], 0
s_waitcnt lgkmcnt(8)
ds_read_b128 v[52:55], v248 offset:8448
ds_read_u16_d16_hi v155, v155
v_mfma_f32_16x16x32_f16 v[168:171], v[48:51], v[212:215], v[168:171]
ds_read_u16 v153, v153
v_pk_mul_f16 v33, v32, v33
v_mfma_f32_16x16x32_bf16 v[88:91], v[120:123], v[36:39], v[88:91]
v_pk_mul_f16 v35, v34, v35
v_cvt_pkrtz_f16_f32 v80, v80, v81
v_mfma_f32_16x16x32_f16 v[132:135], v[48:51], v[208:211], v[132:135]
ds_read_b128 v[48:51], v252 offset:12288
v_cvt_pkrtz_f16_f32 v81, v82, v83
v_mfma_f32_16x16x32_bf16 v[64:67], v[120:123], v[108:111], v[64:67]
v_lshrrev_b64 v[80:81], 2, v[80:81]
v_and_b32_sdwa v82, s47, v80 dst_sel:DWORD dst_unused:UNUSED_PAD src0_sel:DWORD src1_sel:WORD_1
v_mfma_f32_16x16x32_f16 v[216:219], v[124:127], v[180:183], v[216:219]
v_and_b32_e64 v80, s47, v80
v_lshl_add_u64 v[24:25], v[24:25], 0, v[26:27]
v_exp_f16_sdwa v33, v33 dst_sel:WORD_0 dst_unused:UNUSED_PRESERVE src0_sel:WORD_0
v_mfma_f32_16x16x32_bf16 v[68:71], v[120:123], v[192:195], v[68:71]
ds_read_u16_d16_hi v82, v82
ds_read_u16 v80, v80
v_mfma_f32_16x16x32_f16 v[220:223], v[124:127], v[212:215], v[220:223]
ds_read_b128 v[120:123], v248 offset:10496
v_exp_f16_sdwa v35, v35 dst_sel:WORD_0 dst_unused:UNUSED_PRESERVE src0_sel:WORD_0
v_and_b32_sdwa v83, s47, v81 dst_sel:DWORD dst_unused:UNUSED_PAD src0_sel:DWORD src1_sel:WORD_1
v_and_b32_e64 v81, s47, v81
s_waitcnt lgkmcnt(8)
v_mfma_f32_16x16x32_bf16 v[88:91], v[184:187], v[44:47], v[88:91]
ds_read_u16_d16_hi v83, v83
ds_read_u16 v81, v81
v_lshl_add_u64 v[56:57], v[56:57], 0, v[58:59]
v_mfma_f32_16x16x32_f16 v[76:79], v[124:127], v[208:211], v[76:79]
v_exp_f16_sdwa v33, v33 dst_sel:WORD_1 dst_unused:UNUSED_PRESERVE src0_sel:WORD_1
v_mfma_f32_16x16x32_bf16 v[64:67], v[184:187], v[144:147], v[64:67]
ds_read_b128 v[124:127], v252 offset:15360
s_setprio 1
v_exp_f16_sdwa v35, v35 dst_sel:WORD_1 dst_unused:UNUSED_PRESERVE src0_sel:WORD_1
v_mfma_f32_16x16x32_f16 v[100:103], v[176:179], v[180:183], v[100:103]
v_lshl_add_u64 v[60:61], v[60:61], 0, v[62:63]
v_pk_add_f16 v33, v33, 1.0 op_sel_hi:[1,0]
v_mfma_f32_16x16x32_bf16 v[68:71], v[184:187], v[148:151], v[68:71]
ds_read_b128 v[184:187], v248 offset:12288
v_pk_add_f16 v35, v35, 1.0 op_sel_hi:[1,0]
v_mfma_f32_16x16x32_f16 v[104:107], v[176:179], v[212:215], v[104:107]
v_rcp_f16_sdwa v33, v33 dst_sel:WORD_0 dst_unused:UNUSED_PRESERVE src0_sel:WORD_0
v_mfma_f32_16x16x32_bf16 v[40:43], v[188:191], v[28:31], 0
v_rcp_f16_sdwa v35, v35 dst_sel:WORD_0 dst_unused:UNUSED_PRESERVE src0_sel:WORD_0
v_mfma_f32_16x16x32_f16 v[140:143], v[176:179], v[208:211], v[140:143]
ds_read_b128 v[176:179], v251 offset:8192
v_cvt_pkrtz_f16_f32 v64, v64, v65
v_mfma_f32_16x16x32_bf16 v[0:3], v[188:191], v[128:131], 0
v_cvt_pkrtz_f16_f32 v65, v66, v67
v_lshrrev_b64 v[64:65], 2, v[64:65]
v_mfma_f32_16x16x32_f16 v[232:235], v[160:163], v[180:183], v[232:235]
v_and_b32_sdwa v66, s47, v64 dst_sel:DWORD dst_unused:UNUSED_PAD src0_sel:DWORD src1_sel:WORD_1
v_and_b32_e64 v64, s47, v64
v_cvt_pk_f16_f32 v88, v88, v89
v_mfma_f32_16x16x32_bf16 v[172:175], v[188:191], v[136:139], 0
ds_read_u16_d16_hi v66, v66
ds_read_u16 v64, v64
v_rcp_f16_sdwa v33, v33 dst_sel:WORD_1 dst_unused:UNUSED_PRESERVE src0_sel:WORD_1
v_mfma_f32_16x16x32_f16 v[236:239], v[160:163], v[212:215], v[236:239]
v_cvt_pk_f16_f32 v90, v90, v91
v_pk_fma_f16 v89, v88, v88, s48
v_rcp_f16_sdwa v35, v35 dst_sel:WORD_1 dst_unused:UNUSED_PRESERVE src0_sel:WORD_1
s_waitcnt lgkmcnt(3)
v_mfma_f32_16x16x32_bf16 v[40:43], v[52:55], v[36:39], v[40:43]
ds_read_b128 v[188:191], v248 offset:14336
v_and_b32_sdwa v67, s47, v65 dst_sel:DWORD dst_unused:UNUSED_PAD src0_sel:DWORD src1_sel:WORD_1
v_and_b32 v65, s47, v65
v_pk_fma_f16 v91, v90, v90, s48
v_mfma_f32_16x16x32_f16 v[84:87], v[160:163], v[208:211], v[84:87]
ds_read_u16_d16_hi v67, v67
ds_read_u16 v65, v65
ds_read_b128 v[160:163], v251 offset:11264
v_pk_mul_f16 v89, v88, v89
v_pk_mul_f16 v26, v32, v33
v_mfma_f32_16x16x32_bf16 v[0:3], v[52:55], v[108:111], v[0:3]
s_setprio 0
v_pk_mul_f16 v91, v90, v91
v_cvt_pkrtz_f16_f32 v68, v68, v69
v_mfma_f32_16x16x32_f16 v[200:203], v[48:51], v[180:183], v[200:203]
v_cvt_pkrtz_f16_f32 v69, v70, v71
v_lshrrev_b64 v[68:69], 2, v[68:69]
v_and_b32_sdwa v70, s47, v68 dst_sel:DWORD dst_unused:UNUSED_PAD src0_sel:DWORD src1_sel:WORD_1
v_and_b32 v68, s47, v68
v_pk_mul_f16 v27, v34, v35
v_exp_f16_sdwa v89, v89 dst_sel:WORD_0 dst_unused:UNUSED_PRESERVE src0_sel:WORD_0
v_lshl_add_u64 v[58:59], v[152:153], 0, v[154:155]
v_mfma_f32_16x16x32_bf16 v[172:175], v[52:55], v[192:195], v[172:175]
ds_read_u16_d16_hi v70, v70
ds_read_u16 v68, v68
v_mfma_f32_16x16x32_f16 v[204:207], v[48:51], v[212:215], v[204:207]
ds_read_b128 v[52:55], v248 offset:16384
v_exp_f16_sdwa v91, v91 dst_sel:WORD_0 dst_unused:UNUSED_PRESERVE src0_sel:WORD_0
v_and_b32_sdwa v71, s47, v69 dst_sel:DWORD dst_unused:UNUSED_PAD src0_sel:DWORD src1_sel:WORD_1
v_and_b32_e64 v69, s47, v69
v_mfma_f32_16x16x32_bf16 v[40:43], v[120:123], v[44:47], v[40:43]
ds_read_u16_d16_hi v71, v71
ds_read_u16 v69, v69
v_mfma_f32_16x16x32_f16 v[244:247], v[48:51], v[208:211], v[244:247]
v_cvt_pk_bf16_f32 v132, v132, v133
v_cvt_pk_bf16_f32 v133, v134, v135
v_cvt_pk_bf16_f32 v134, v76, v77
v_cvt_pk_bf16_f32 v135, v78, v79
v_cvt_pk_bf16_f32 v168, v168, v169
v_cvt_pk_bf16_f32 v169, v170, v171
v_cvt_pk_bf16_f32 v170, v220, v221
v_cvt_pk_bf16_f32 v171, v222, v223
v_cvt_pk_bf16_f32 v164, v164, v165
v_cvt_pk_bf16_f32 v165, v166, v167
v_cvt_pk_bf16_f32 v166, v216, v217
v_cvt_pk_bf16_f32 v167, v218, v219
v_exp_f16_sdwa v89, v89 dst_sel:WORD_1 dst_unused:UNUSED_PRESERVE src0_sel:WORD_1
v_cvt_pk_bf16_f32 v140, v140, v141
v_cvt_pk_bf16_f32 v141, v142, v143
v_cvt_pk_bf16_f32 v142, v84, v85
v_cvt_pk_bf16_f32 v143, v86, v87
v_cvt_pk_bf16_f32 v104, v104, v105
ds_read_b128 v[76:79], v254 offset:8192
ds_read_b128 v[220:223], v254 offset:8208
ds_read_b128 v[48:51], v251 offset:9216
v_cvt_pk_bf16_f32 v105, v106, v107
v_cvt_pk_bf16_f32 v106, v236, v237
v_cvt_pk_bf16_f32 v107, v238, v239
v_cvt_pk_bf16_f32 v100, v100, v101
v_cvt_pk_bf16_f32 v101, v102, v103
v_cvt_pk_bf16_f32 v102, v232, v233
v_cvt_pk_bf16_f32 v103, v234, v235
v_mfma_f32_16x16x32_bf16 v[0:3], v[120:123], v[144:147], v[0:3]
s_waitcnt lgkmcnt(5)
ds_read_b128 v[84:87], v254 offset:8320
ds_read_b128 v[236:239], v254 offset:8336
v_mfma_f32_16x16x32_f16 v[4:7], v[124:127], v[180:183], v[4:7]
v_lshl_add_u64 v[62:63], v[80:81], 0, v[82:83]
v_exp_f16_sdwa v91, v91 dst_sel:WORD_1 dst_unused:UNUSED_PRESERVE src0_sel:WORD_1
v_cvt_pk_bf16_f32 v244, v244, v245
v_cvt_pk_bf16_f32 v245, v246, v247
v_cvt_pk_bf16_f32 v204, v204, v205
v_cvt_pk_bf16_f32 v205, v206, v207
v_mfma_f32_16x16x32_bf16 v[172:175], v[120:123], v[148:151], v[172:175]
v_pk_add_f16 v89, v89, 1.0 op_sel_hi:[1,0]
v_pk_add_f16 v91, v91, 1.0 op_sel_hi:[1,0]
v_mfma_f32_16x16x32_f16 v[224:227], v[124:127], v[212:215], v[224:227]
ds_read_b128 v[120:123], v248 offset:12544
v_rcp_f16_sdwa v89, v89 dst_sel:WORD_0 dst_unused:UNUSED_PRESERVE src0_sel:WORD_0
v_mfma_f32_16x16x32_bf16 v[156:159], v[184:187], v[28:31], 0
v_rcp_f16_sdwa v91, v91 dst_sel:WORD_0 dst_unused:UNUSED_PRESERVE src0_sel:WORD_0
v_mfma_f32_16x16x32_f16 v[92:95], v[124:127], v[208:211], v[92:95]
s_nop 2
v_cvt_pk_bf16_f32 v206, v224, v225
v_cvt_pk_bf16_f32 v207, v226, v227
v_mfma_f32_16x16x32_bf16 v[200:203], v[18:21], v[196:199], v[200:203]
ds_read_b128 v[224:227], v254 offset:16
ds_read_b128 v[124:127], v251 offset:12288
v_mfma_f32_16x16x32_bf16 v[4:7], v[16:19], v[196:199], v[4:7]
v_cvt_pkrtz_f16_f32 v40, v40, v41
v_cvt_pk_bf16_f32 v246, v92, v93
v_cvt_pk_bf16_f32 v247, v94, v95
v_mfma_f32_16x16x32_bf16 v[228:231], v[184:187], v[128:131], 0
ds_read_b128 v[92:95], v254
v_cvt_pk_bf16_f32 v200, v200, v201
v_cvt_pk_bf16_f32 v201, v202, v203
s_setprio 3
v_cvt_pk_bf16_f32 v202, v4, v5
v_cvt_pk_bf16_f32 v203, v6, v7
s_waitcnt lgkmcnt(4)
v_mfma_f32_16x16x32_f16 v[116:119], v[176:179], v[60:63], v[76:79]
v_cvt_pkrtz_f16_f32 v41, v42, v43
v_lshrrev_b64 v[40:41], 2, v[40:41]
v_and_b32_sdwa v42, s47, v40 dst_sel:DWORD dst_unused:UNUSED_PAD src0_sel:DWORD src1_sel:WORD_1
v_and_b32_e64 v40, s47, v40
v_mfma_f32_16x16x32_bf16 v[112:115], v[184:187], v[136:139], 0
ds_read_u16_d16_hi v42, v42
ds_read_u16 v40, v40
v_rcp_f16_sdwa v89, v89 dst_sel:WORD_1 dst_unused:UNUSED_PRESERVE src0_sel:WORD_1
buffer_store_dwordx4 v[132:135], v253, s[8:11], s70 offen sc1
buffer_store_dwordx4 v[140:143], v253, s[8:11], s70 offen offset:64 sc1
v_mfma_f32_16x16x32_f16 v[240:243], v[176:179], v[56:59], v[76:79]
ds_read_b128 v[184:187], v248 offset:14592
v_and_b32_sdwa v43, s47, v41 dst_sel:DWORD dst_unused:UNUSED_PAD src0_sel:DWORD src1_sel:WORD_1
v_and_b32_e64 v41, s47, v41
v_rcp_f16_sdwa v91, v91 dst_sel:WORD_1 dst_unused:UNUSED_PRESERVE src0_sel:WORD_1
v_mfma_f32_16x16x32_bf16 v[156:159], v[188:191], v[36:39], v[156:159]
ds_read_u16_d16_hi v43, v43
ds_read_u16 v41, v41
v_mfma_f32_16x16x32_f16 v[76:79], v[176:179], v[24:27], v[76:79]
v_cvt_pkrtz_f16_f32 v0, v0, v1
v_cvt_pkrtz_f16_f32 v1, v2, v3
v_lshrrev_b64 v[0:1], 2, v[0:1]
v_and_b32_sdwa v2, s47, v0 dst_sel:DWORD dst_unused:UNUSED_PAD src0_sel:DWORD src1_sel:WORD_1
v_and_b32_e64 v0, s47, v0
v_pk_mul_f16 v88, v88, v89
v_mfma_f32_16x16x32_bf16 v[228:231], v[188:191], v[108:111], v[228:231]
ds_read_u16_d16_hi v2, v2
ds_read_u16 v0, v0
ds_read_b128 v[176:179], v251 offset:10240
v_mfma_f32_16x16x32_f16 v[72:75], v[160:163], v[60:63], v[220:223]
v_and_b32_sdwa v3, s47, v1 dst_sel:DWORD dst_unused:UNUSED_PAD src0_sel:DWORD src1_sel:WORD_1
v_and_b32_e64 v1, s47, v1
v_pk_mul_f16 v89, v90, v91
v_lshl_add_u64 v[64:65], v[64:65], 0, v[66:67]
v_mfma_f32_16x16x32_bf16 v[112:115], v[188:191], v[192:195], v[112:115]
ds_read_u16_d16_hi v3, v3
ds_read_u16 v1, v1
v_cvt_pkrtz_f16_f32 v172, v172, v173
v_cvt_pkrtz_f16_f32 v173, v174, v175
v_lshrrev_b64 v[172:173], 2, v[172:173]
v_and_b32_sdwa v174, s47, v172 dst_sel:DWORD dst_unused:UNUSED_PAD src0_sel:DWORD src1_sel:WORD_1
v_and_b32 v172, s47, v172
v_mfma_f32_16x16x32_f16 v[8:11], v[160:163], v[56:59], v[220:223]
ds_read_u16_d16_hi v174, v174
s_waitcnt lgkmcnt(7)
ds_read_u16 v172, v172
ds_read_b128 v[188:191], v248 offset:16640
v_and_b32_sdwa v175, s47, v173 dst_sel:DWORD dst_unused:UNUSED_PAD src0_sel:DWORD src1_sel:WORD_1
v_and_b32_e64 v173, s47, v173
v_mfma_f32_16x16x32_bf16 v[156:159], v[52:55], v[44:47], v[156:159]
ds_read_u16_d16_hi v175, v175
ds_read_u16 v173, v173
v_mfma_f32_16x16x32_f16 v[220:223], v[160:163], v[24:27], v[220:223]
ds_read_b128 v[160:163], v251 offset:13312
s_setprio 2
v_lshl_add_u64 v[68:69], v[68:69], 0, v[70:71]
v_mfma_f32_16x16x32_bf16 v[228:231], v[52:55], v[144:147], v[228:231]
s_nop 0
v_cvt_pk_f16_f32 v156, v156, v157
v_mfma_f32_16x16x32_f16 v[12:15], v[48:51], v[60:63], v[84:87]
v_cvt_pk_f16_f32 v158, v158, v159
v_pk_fma_f16 v157, v156, v156, s48
v_mfma_f32_16x16x32_bf16 v[112:115], v[52:55], v[148:151], v[112:115]
ds_read_b128 v[52:55], v248 offset:18432
s_nop 0
v_cvt_pkrtz_f16_f32 v228, v228, v229
v_mfma_f32_16x16x32_f16 v[96:99], v[48:51], v[56:59], v[84:87]
v_cvt_pkrtz_f16_f32 v229, v230, v231
v_lshrrev_b64 v[228:229], 2, v[228:229]
v_mfma_f32_16x16x32_bf16 v[32:35], v[120:123], v[28:31], 0
v_and_b32_sdwa v230, s47, v228 dst_sel:DWORD dst_unused:UNUSED_PAD src0_sel:DWORD src1_sel:WORD_1
v_and_b32 v228, s47, v228
v_mfma_f32_16x16x32_f16 v[84:87], v[48:51], v[24:27], v[84:87]
ds_read_b128 v[48:51], v251 offset:14336
ds_read_u16_d16_hi v230, v230
v_mfma_f32_16x16x32_bf16 v[152:155], v[120:123], v[128:131], 0
s_waitcnt lgkmcnt(9)
ds_read_u16 v228, v228
v_and_b32_sdwa v231, s47, v229 dst_sel:DWORD dst_unused:UNUSED_PAD src0_sel:DWORD src1_sel:WORD_1
v_mfma_f32_16x16x32_f16 v[208:211], v[124:127], v[60:63], v[236:239]
v_and_b32 v229, s47, v229
v_pk_fma_f16 v159, v158, v158, s48
v_mfma_f32_16x16x32_bf16 v[80:83], v[120:123], v[136:139], 0
ds_read_b128 v[120:123], v248 offset:20480
ds_read_u16_d16_hi v231, v231
v_mfma_f32_16x16x32_f16 v[212:215], v[124:127], v[56:59], v[236:239]
ds_read_u16 v229, v229
v_pk_mul_f16 v157, v156, v157
v_mfma_f32_16x16x32_bf16 v[32:35], v[184:187], v[36:39], v[32:35]
v_pk_mul_f16 v159, v158, v159
v_cvt_pkrtz_f16_f32 v112, v112, v113
v_mfma_f32_16x16x32_f16 v[236:239], v[124:127], v[24:27], v[236:239]
ds_read_b128 v[124:127], v251 offset:17408
s_setprio 1
v_cvt_pkrtz_f16_f32 v113, v114, v115
v_mfma_f32_16x16x32_bf16 v[152:155], v[184:187], v[108:111], v[152:155]
v_lshrrev_b64 v[112:113], 2, v[112:113]
v_and_b32_sdwa v114, s47, v112 dst_sel:DWORD dst_unused:UNUSED_PAD src0_sel:DWORD src1_sel:WORD_1
v_mfma_f32_16x16x32_f16 v[180:183], v[176:179], v[60:63], v[92:95]
v_and_b32 v112, s47, v112
v_lshl_add_u64 v[90:91], v[40:41], 0, v[42:43]
v_exp_f16_sdwa v157, v157 dst_sel:WORD_0 dst_unused:UNUSED_PRESERVE src0_sel:WORD_0
v_mfma_f32_16x16x32_bf16 v[80:83], v[184:187], v[192:195], v[80:83]
ds_read_u16_d16_hi v114, v114
s_waitcnt lgkmcnt(7)
ds_read_u16 v112, v112
v_mfma_f32_16x16x32_f16 v[196:199], v[176:179], v[56:59], v[92:95]
ds_read_b128 v[184:187], v248 offset:22528
v_exp_f16_sdwa v159, v159 dst_sel:WORD_0 dst_unused:UNUSED_PRESERVE src0_sel:WORD_0
v_and_b32_sdwa v115, s47, v113 dst_sel:DWORD dst_unused:UNUSED_PAD src0_sel:DWORD src1_sel:WORD_1
v_and_b32 v113, s47, v113
v_mfma_f32_16x16x32_bf16 v[32:35], v[188:191], v[44:47], v[32:35]
ds_read_u16_d16_hi v115, v115
ds_read_u16 v113, v113
v_lshl_add_u64 v[66:67], v[0:1], 0, v[2:3]
v_mfma_f32_16x16x32_f16 v[92:95], v[176:179], v[24:27], v[92:95]
v_exp_f16_sdwa v157, v157 dst_sel:WORD_1 dst_unused:UNUSED_PRESERVE src0_sel:WORD_1
v_mfma_f32_16x16x32_bf16 v[152:155], v[188:191], v[144:147], v[152:155]
ds_read_b128 v[176:179], v251 offset:15360
v_exp_f16_sdwa v159, v159 dst_sel:WORD_1 dst_unused:UNUSED_PRESERVE src0_sel:WORD_1
v_mfma_f32_16x16x32_f16 v[216:219], v[160:163], v[60:63], v[224:227]
v_lshl_add_u64 v[70:71], v[172:173], 0, v[174:175]
v_pk_add_f16 v157, v157, 1.0 op_sel_hi:[1,0]
v_mfma_f32_16x16x32_bf16 v[80:83], v[188:191], v[148:151], v[80:83]
ds_read_b128 v[188:191], v248 offset:18688
v_pk_add_f16 v159, v159, 1.0 op_sel_hi:[1,0]
v_mfma_f32_16x16x32_f16 v[232:235], v[160:163], v[56:59], v[224:227]
v_rcp_f16_sdwa v157, v157 dst_sel:WORD_0 dst_unused:UNUSED_PRESERVE src0_sel:WORD_0
v_mfma_f32_16x16x32_bf16 v[4:7], v[52:55], v[28:31], 0
v_rcp_f16_sdwa v159, v159 dst_sel:WORD_0 dst_unused:UNUSED_PRESERVE src0_sel:WORD_0
v_mfma_f32_16x16x32_f16 v[224:227], v[160:163], v[24:27], v[224:227]
s_setprio 0
ds_read_b128 v[160:163], v251 offset:18432
v_cvt_pkrtz_f16_f32 v152, v152, v153
v_mfma_f32_16x16x32_bf16 v[132:135], v[52:55], v[128:131], 0
v_cvt_pkrtz_f16_f32 v153, v154, v155
v_lshrrev_b64 v[152:153], 2, v[152:153]
v_mfma_f32_16x16x32_f16 v[116:119], v[48:51], v[68:71], v[116:119]
v_and_b32_sdwa v154, s47, v152 dst_sel:DWORD dst_unused:UNUSED_PAD src0_sel:DWORD src1_sel:WORD_1
v_and_b32_e64 v152, s47, v152
v_cvt_pk_f16_f32 v32, v32, v33
v_mfma_f32_16x16x32_bf16 v[140:143], v[52:55], v[136:139], 0
ds_read_u16_d16_hi v154, v154
s_waitcnt lgkmcnt(5)
ds_read_u16 v152, v152
v_rcp_f16_sdwa v157, v157 dst_sel:WORD_1 dst_unused:UNUSED_PRESERVE src0_sel:WORD_1
v_mfma_f32_16x16x32_f16 v[240:243], v[48:51], v[64:67], v[240:243]
v_cvt_pk_f16_f32 v34, v34, v35
v_pk_fma_f16 v33, v32, v32, s48
v_rcp_f16_sdwa v159, v159 dst_sel:WORD_1 dst_unused:UNUSED_PRESERVE src0_sel:WORD_1
v_mfma_f32_16x16x32_bf16 v[4:7], v[120:123], v[36:39], v[4:7]
ds_read_b128 v[52:55], v248 offset:20736
v_and_b32_sdwa v155, s47, v153 dst_sel:DWORD dst_unused:UNUSED_PAD src0_sel:DWORD src1_sel:WORD_1
v_and_b32_e64 v153, s47, v153
v_pk_fma_f16 v35, v34, v34, s48
v_mfma_f32_16x16x32_f16 v[76:79], v[48:51], v[88:91], v[76:79]
ds_read_u16_d16_hi v155, v155
ds_read_u16 v153, v153
buffer_store_dwordx4 v[244:247], v253, s[8:11], s70 offen offset:128 sc1
buffer_store_dwordx4 v[168:171], v253, s[8:11], s70 offen offset:192 sc1
ds_read_b128 v[48:51], v251 offset:16384
v_pk_mul_f16 v33, v32, v33
v_pk_mul_f16 v156, v156, v157
v_mfma_f32_16x16x32_bf16 v[132:135], v[120:123], v[108:111], v[132:135]
v_pk_mul_f16 v35, v34, v35
v_cvt_pkrtz_f16_f32 v80, v80, v81
v_mfma_f32_16x16x32_f16 v[72:75], v[124:127], v[68:71], v[72:75]
v_cvt_pkrtz_f16_f32 v81, v82, v83
v_lshrrev_b64 v[80:81], 2, v[80:81]
v_and_b32_sdwa v82, s47, v80 dst_sel:DWORD dst_unused:UNUSED_PAD src0_sel:DWORD src1_sel:WORD_1
v_and_b32_e64 v80, s47, v80
v_pk_mul_f16 v157, v158, v159
v_exp_f16_sdwa v33, v33 dst_sel:WORD_0 dst_unused:UNUSED_PRESERVE src0_sel:WORD_0
v_lshl_add_u64 v[228:229], v[228:229], 0, v[230:231]
v_mfma_f32_16x16x32_bf16 v[140:143], v[120:123], v[192:195], v[140:143]
ds_read_u16_d16_hi v82, v82
ds_read_u16 v80, v80
v_mfma_f32_16x16x32_f16 v[8:11], v[124:127], v[64:67], v[8:11]
ds_read_b128 v[120:123], v248 offset:22784
v_exp_f16_sdwa v35, v35 dst_sel:WORD_0 dst_unused:UNUSED_PRESERVE src0_sel:WORD_0
v_and_b32_sdwa v83, s47, v81 dst_sel:DWORD dst_unused:UNUSED_PAD src0_sel:DWORD src1_sel:WORD_1
v_and_b32_e64 v81, s47, v81
v_mfma_f32_16x16x32_bf16 v[4:7], v[184:187], v[44:47], v[4:7]
ds_read_u16_d16_hi v83, v83
ds_read_u16 v81, v81
v_mfma_f32_16x16x32_f16 v[220:223], v[124:127], v[88:91], v[220:223]
v_exp_f16_sdwa v33, v33 dst_sel:WORD_1 dst_unused:UNUSED_PRESERVE src0_sel:WORD_1
s_setprio 3
s_waitcnt lgkmcnt(6)
ds_read_b128 v[124:127], v251 offset:19456
v_mfma_f32_16x16x32_bf16 v[132:135], v[184:187], v[144:147], v[132:135]
v_lshl_add_u64 v[112:113], v[112:113], 0, v[114:115]
v_exp_f16_sdwa v35, v35 dst_sel:WORD_1 dst_unused:UNUSED_PRESERVE src0_sel:WORD_1
v_mfma_f32_16x16x32_f16 v[12:15], v[176:179], v[68:71], v[12:15]
v_pk_add_f16 v33, v33, 1.0 op_sel_hi:[1,0]
v_pk_add_f16 v35, v35, 1.0 op_sel_hi:[1,0]
v_mfma_f32_16x16x32_bf16 v[140:143], v[184:187], v[148:151], v[140:143]
ds_read_b128 v[184:187], v248 offset:24576
v_rcp_f16_sdwa v33, v33 dst_sel:WORD_0 dst_unused:UNUSED_PRESERVE src0_sel:WORD_0
v_mfma_f32_16x16x32_f16 v[96:99], v[176:179], v[64:67], v[96:99]
v_rcp_f16_sdwa v35, v35 dst_sel:WORD_0 dst_unused:UNUSED_PRESERVE src0_sel:WORD_0
v_mfma_f32_16x16x32_bf16 v[40:43], v[188:191], v[28:31], 0
v_cvt_pkrtz_f16_f32 v4, v4, v5
v_cvt_pkrtz_f16_f32 v5, v6, v7
v_mfma_f32_16x16x32_f16 v[84:87], v[176:179], v[88:91], v[84:87]
ds_read_b128 v[176:179], v251 offset:20480
v_lshrrev_b64 v[4:5], 2, v[4:5]
v_mfma_f32_16x16x32_bf16 v[0:3], v[188:191], v[128:131], 0
v_and_b32_sdwa v6, s47, v4 dst_sel:DWORD dst_unused:UNUSED_PAD src0_sel:DWORD src1_sel:WORD_1
v_and_b32_e64 v4, s47, v4
v_mfma_f32_16x16x32_f16 v[208:211], v[160:163], v[68:71], v[208:211]
ds_read_u16_d16_hi v6, v6
ds_read_u16 v4, v4
v_mfma_f32_16x16x32_bf16 v[172:175], v[188:191], v[136:139], 0
v_rcp_f16_sdwa v33, v33 dst_sel:WORD_1 dst_unused:UNUSED_PRESERVE src0_sel:WORD_1
v_mfma_f32_16x16x32_f16 v[212:215], v[160:163], v[64:67], v[212:215]
ds_read_b128 v[188:191], v248 offset:26624
v_and_b32_sdwa v7, s47, v5 dst_sel:DWORD dst_unused:UNUSED_PAD src0_sel:DWORD src1_sel:WORD_1
v_and_b32 v5, s47, v5
v_rcp_f16_sdwa v35, v35 dst_sel:WORD_1 dst_unused:UNUSED_PRESERVE src0_sel:WORD_1
v_mfma_f32_16x16x32_bf16 v[40:43], v[52:55], v[36:39], v[40:43]
ds_read_u16_d16_hi v7, v7
ds_read_u16 v5, v5
v_mfma_f32_16x16x32_f16 v[236:239], v[160:163], v[88:91], v[236:239]
s_setprio 2
v_cvt_pkrtz_f16_f32 v132, v132, v133
v_cvt_pkrtz_f16_f32 v133, v134, v135
v_lshrrev_b64 v[132:133], 2, v[132:133]
v_and_b32_sdwa v134, s47, v132 dst_sel:DWORD dst_unused:UNUSED_PAD src0_sel:DWORD src1_sel:WORD_1
v_and_b32 v132, s47, v132
v_pk_mul_f16 v158, v32, v33
v_mfma_f32_16x16x32_bf16 v[0:3], v[52:55], v[108:111], v[0:3]
ds_read_u16_d16_hi v134, v134
s_waitcnt lgkmcnt(6)
ds_read_u16 v132, v132
ds_read_b128 v[160:163], v251 offset:23552
v_mfma_f32_16x16x32_f16 v[180:183], v[48:51], v[68:71], v[180:183]
v_and_b32_sdwa v135, s47, v133 dst_sel:DWORD dst_unused:UNUSED_PAD src0_sel:DWORD src1_sel:WORD_1
v_and_b32_e64 v133, s47, v133
v_pk_mul_f16 v159, v34, v35
v_lshl_add_u64 v[230:231], v[152:153], 0, v[154:155]
v_mfma_f32_16x16x32_bf16 v[172:175], v[52:55], v[192:195], v[172:175]
ds_read_u16_d16_hi v135, v135
ds_read_u16 v133, v133
v_cvt_pkrtz_f16_f32 v140, v140, v141
v_cvt_pkrtz_f16_f32 v141, v142, v143
v_lshrrev_b64 v[140:141], 2, v[140:141]
v_and_b32_sdwa v142, s47, v140 dst_sel:DWORD dst_unused:UNUSED_PAD src0_sel:DWORD src1_sel:WORD_1
v_and_b32_e64 v140, s47, v140
v_mfma_f32_16x16x32_f16 v[196:199], v[48:51], v[64:67], v[196:199]
ds_read_u16_d16_hi v142, v142
ds_read_u16 v140, v140
ds_read_b128 v[52:55], v248 offset:28672
v_and_b32_sdwa v143, s47, v141 dst_sel:DWORD dst_unused:UNUSED_PAD src0_sel:DWORD src1_sel:WORD_1
v_and_b32_e64 v141, s47, v141
v_mfma_f32_16x16x32_bf16 v[40:43], v[120:123], v[44:47], v[40:43]
ds_read_u16_d16_hi v143, v143
ds_read_u16 v141, v141
v_mfma_f32_16x16x32_f16 v[92:95], v[48:51], v[88:91], v[92:95]
s_waitcnt lgkmcnt(10)
ds_read_b128 v[48:51], v251 offset:21504
v_lshl_add_u64 v[114:115], v[80:81], 0, v[82:83]
v_mfma_f32_16x16x32_bf16 v[0:3], v[120:123], v[144:147], v[0:3]
s_nop 0
v_cvt_pk_f16_f32 v40, v40, v41
v_mfma_f32_16x16x32_f16 v[216:219], v[124:127], v[68:71], v[216:219]
v_cvt_pk_f16_f32 v42, v42, v43
v_pk_fma_f16 v41, v40, v40, s48
v_mfma_f32_16x16x32_bf16 v[172:175], v[120:123], v[148:151], v[172:175]
ds_read_b128 v[120:123], v248 offset:24832
s_nop 0
v_cvt_pkrtz_f16_f32 v0, v0, v1
v_mfma_f32_16x16x32_f16 v[232:235], v[124:127], v[64:67], v[232:235]
v_cvt_pkrtz_f16_f32 v1, v2, v3
v_lshrrev_b64 v[0:1], 2, v[0:1]
v_mfma_f32_16x16x32_bf16 v[24:27], v[184:187], v[28:31], 0
s_setprio 1
v_and_b32_sdwa v2, s47, v0 dst_sel:DWORD dst_unused:UNUSED_PAD src0_sel:DWORD src1_sel:WORD_1
v_and_b32_e64 v0, s47, v0
v_mfma_f32_16x16x32_f16 v[224:227], v[124:127], v[88:91], v[224:227]
ds_read_b128 v[124:127], v251 offset:24576
ds_read_u16_d16_hi v2, v2
v_mfma_f32_16x16x32_bf16 v[56:59], v[184:187], v[128:131], 0
ds_read_u16 v0, v0
v_and_b32_sdwa v3, s47, v1 dst_sel:DWORD dst_unused:UNUSED_PAD src0_sel:DWORD src1_sel:WORD_1
v_mfma_f32_16x16x32_f16 v[116:119], v[176:179], v[112:115], v[116:119]
v_and_b32 v1, s47, v1
v_pk_fma_f16 v43, v42, v42, s48
v_mfma_f32_16x16x32_bf16 v[60:63], v[184:187], v[136:139], 0
s_waitcnt lgkmcnt(8)
ds_read_b128 v[184:187], v248 offset:26880
ds_read_u16_d16_hi v3, v3
v_mfma_f32_16x16x32_f16 v[240:243], v[176:179], v[228:231], v[240:243]
ds_read_u16 v1, v1
v_pk_mul_f16 v41, v40, v41
v_mfma_f32_16x16x32_bf16 v[24:27], v[188:191], v[36:39], v[24:27]
v_pk_mul_f16 v43, v42, v43
v_cvt_pkrtz_f16_f32 v172, v172, v173
v_mfma_f32_16x16x32_f16 v[76:79], v[176:179], v[156:159], v[76:79]
ds_read_b128 v[176:179], v251 offset:22528
v_cvt_pkrtz_f16_f32 v173, v174, v175
v_mfma_f32_16x16x32_bf16 v[56:59], v[188:191], v[108:111], v[56:59]
v_lshrrev_b64 v[172:173], 2, v[172:173]
v_and_b32_sdwa v174, s47, v172 dst_sel:DWORD dst_unused:UNUSED_PAD src0_sel:DWORD src1_sel:WORD_1
v_mfma_f32_16x16x32_f16 v[72:75], v[160:163], v[112:115], v[72:75]
v_and_b32_e64 v172, s47, v172
v_lshl_add_u64 v[4:5], v[4:5], 0, v[6:7]
v_exp_f16_sdwa v41, v41 dst_sel:WORD_0 dst_unused:UNUSED_PRESERVE src0_sel:WORD_0
v_mfma_f32_16x16x32_bf16 v[60:63], v[188:191], v[192:195], v[60:63]
ds_read_u16_d16_hi v174, v174
ds_read_u16 v172, v172
buffer_store_dwordx4 v[104:107], v253, s[8:11], s70 offen offset:256 sc1
buffer_store_dwordx4 v[204:207], v253, s[8:11], s70 offen offset:320 sc1
v_mfma_f32_16x16x32_f16 v[8:11], v[160:163], v[228:231], v[8:11]
ds_read_b128 v[188:191], v248 offset:28928
v_exp_f16_sdwa v43, v43 dst_sel:WORD_0 dst_unused:UNUSED_PRESERVE src0_sel:WORD_0
v_and_b32_sdwa v175, s47, v173 dst_sel:DWORD dst_unused:UNUSED_PAD src0_sel:DWORD src1_sel:WORD_1
v_and_b32_e64 v173, s47, v173
s_waitcnt lgkmcnt(8)
v_mfma_f32_16x16x32_bf16 v[24:27], v[52:55], v[44:47], v[24:27]
ds_read_u16_d16_hi v175, v175
ds_read_u16 v173, v173
s_setprio 0
v_lshl_add_u64 v[132:133], v[132:133], 0, v[134:135]
v_mfma_f32_16x16x32_f16 v[220:223], v[160:163], v[156:159], v[220:223]
v_exp_f16_sdwa v41, v41 dst_sel:WORD_1 dst_unused:UNUSED_PRESERVE src0_sel:WORD_1
v_mfma_f32_16x16x32_bf16 v[56:59], v[52:55], v[144:147], v[56:59]
ds_read_b128 v[160:163], v251 offset:25600
v_exp_f16_sdwa v43, v43 dst_sel:WORD_1 dst_unused:UNUSED_PRESERVE src0_sel:WORD_1
v_mfma_f32_16x16x32_f16 v[12:15], v[48:51], v[112:115], v[12:15]
v_lshl_add_u64 v[140:141], v[140:141], 0, v[142:143]
v_pk_add_f16 v41, v41, 1.0 op_sel_hi:[1,0]
v_mfma_f32_16x16x32_bf16 v[60:63], v[52:55], v[148:151], v[60:63]
ds_read_b128 v[52:55], v248 offset:30720
v_pk_add_f16 v43, v43, 1.0 op_sel_hi:[1,0]
v_mfma_f32_16x16x32_f16 v[96:99], v[48:51], v[228:231], v[96:99]
v_rcp_f16_sdwa v41, v41 dst_sel:WORD_0 dst_unused:UNUSED_PRESERVE src0_sel:WORD_0
v_mfma_f32_16x16x32_bf16 v[244:247], v[120:123], v[28:31], 0
v_rcp_f16_sdwa v43, v43 dst_sel:WORD_0 dst_unused:UNUSED_PRESERVE src0_sel:WORD_0
v_mfma_f32_16x16x32_f16 v[84:87], v[48:51], v[156:159], v[84:87]
ds_read_b128 v[48:51], v251 offset:26624
v_cvt_pkrtz_f16_f32 v56, v56, v57
v_mfma_f32_16x16x32_bf16 v[168:171], v[120:123], v[128:131], 0
v_cvt_pkrtz_f16_f32 v57, v58, v59
v_lshrrev_b64 v[56:57], 2, v[56:57]
v_mfma_f32_16x16x32_f16 v[208:211], v[124:127], v[112:115], v[208:211]
v_and_b32_sdwa v58, s47, v56 dst_sel:DWORD dst_unused:UNUSED_PAD src0_sel:DWORD src1_sel:WORD_1
v_and_b32_e64 v56, s47, v56
v_cvt_pk_f16_f32 v24, v24, v25
v_mfma_f32_16x16x32_bf16 v[32:35], v[120:123], v[136:139], 0
ds_read_u16_d16_hi v58, v58
ds_read_u16 v56, v56
v_rcp_f16_sdwa v41, v41 dst_sel:WORD_1 dst_unused:UNUSED_PRESERVE src0_sel:WORD_1
v_mfma_f32_16x16x32_f16 v[212:215], v[124:127], v[228:231], v[212:215]
v_cvt_pk_f16_f32 v26, v26, v27
v_pk_fma_f16 v25, v24, v24, s48
v_rcp_f16_sdwa v43, v43 dst_sel:WORD_1 dst_unused:UNUSED_PRESERVE src0_sel:WORD_1
s_waitcnt lgkmcnt(3)
v_mfma_f32_16x16x32_bf16 v[244:247], v[184:187], v[36:39], v[244:247]
ds_read_b128 v[120:123], v248 offset:32768
s_setprio 3
v_and_b32_sdwa v59, s47, v57 dst_sel:DWORD dst_unused:UNUSED_PAD src0_sel:DWORD src1_sel:WORD_1
v_and_b32_e64 v57, s47, v57
v_pk_fma_f16 v27, v26, v26, s48
v_mfma_f32_16x16x32_f16 v[236:239], v[124:127], v[156:159], v[236:239]
ds_read_u16_d16_hi v59, v59
ds_read_u16 v57, v57
ds_read_b128 v[124:127], v251 offset:29696
v_pk_mul_f16 v25, v24, v25
v_pk_mul_f16 v6, v40, v41
v_mfma_f32_16x16x32_bf16 v[168:171], v[184:187], v[108:111], v[168:171]
v_pk_mul_f16 v27, v26, v27
buffer_load_dwordx4 v[152:155], v253, s[4:7], s69 offen offset:192
v_mfma_f32_16x16x32_f16 v[180:183], v[176:179], v[112:115], v[180:183]
v_cvt_pkrtz_f16_f32 v60, v60, v61
v_cvt_pkrtz_f16_f32 v61, v62, v63
v_lshrrev_b64 v[60:61], 2, v[60:61]
v_and_b32_sdwa v62, s47, v60 dst_sel:DWORD dst_unused:UNUSED_PAD src0_sel:DWORD src1_sel:WORD_1
v_and_b32_e64 v60, s47, v60
v_pk_mul_f16 v7, v42, v43
v_exp_f16_sdwa v25, v25 dst_sel:WORD_0 dst_unused:UNUSED_PRESERVE src0_sel:WORD_0
v_lshl_add_u64 v[134:135], v[0:1], 0, v[2:3]
v_mfma_f32_16x16x32_bf16 v[32:35], v[184:187], v[192:195], v[32:35]
ds_read_u16_d16_hi v62, v62
ds_read_u16 v60, v60
v_mfma_f32_16x16x32_f16 v[196:199], v[176:179], v[228:231], v[196:199]
ds_read_b128 v[184:187], v248 offset:34816
v_exp_f16_sdwa v27, v27 dst_sel:WORD_0 dst_unused:UNUSED_PRESERVE src0_sel:WORD_0
v_and_b32_sdwa v63, s47, v61 dst_sel:DWORD dst_unused:UNUSED_PAD src0_sel:DWORD src1_sel:WORD_1
v_and_b32_e64 v61, s47, v61
v_mfma_f32_16x16x32_bf16 v[244:247], v[188:191], v[44:47], v[244:247]
ds_read_u16_d16_hi v63, v63
ds_read_u16 v61, v61
v_mfma_f32_16x16x32_f16 v[92:95], v[176:179], v[156:159], v[92:95]
v_exp_f16_sdwa v25, v25 dst_sel:WORD_1 dst_unused:UNUSED_PRESERVE src0_sel:WORD_1
v_mfma_f32_16x16x32_bf16 v[168:171], v[188:191], v[144:147], v[168:171]
ds_read_b128 v[176:179], v251 offset:27648
v_lshl_add_u64 v[142:143], v[172:173], 0, v[174:175]
v_mfma_f32_16x16x32_f16 v[216:219], v[160:163], v[112:115], v[216:219]
v_exp_f16_sdwa v27, v27 dst_sel:WORD_1 dst_unused:UNUSED_PRESERVE src0_sel:WORD_1
v_mfma_f32_16x16x32_bf16 v[32:35], v[188:191], v[148:151], v[32:35]
v_pk_add_f16 v25, v25, 1.0 op_sel_hi:[1,0]
v_pk_add_f16 v27, v27, 1.0 op_sel_hi:[1,0]
v_mfma_f32_16x16x32_f16 v[232:235], v[160:163], v[228:231], v[232:235]
ds_read_b128 v[188:191], v248 offset:30976
s_setprio 2
v_rcp_f16_sdwa v25, v25 dst_sel:WORD_0 dst_unused:UNUSED_PRESERVE src0_sel:WORD_0
v_mfma_f32_16x16x32_bf16 v[80:83], v[52:55], v[28:31], 0
v_rcp_f16_sdwa v27, v27 dst_sel:WORD_0 dst_unused:UNUSED_PRESERVE src0_sel:WORD_0
v_mfma_f32_16x16x32_f16 v[224:227], v[160:163], v[156:159], v[224:227]
ds_read_b128 v[160:163], v251 offset:30720
v_cvt_pkrtz_f16_f32 v244, v244, v245
v_mfma_f32_16x16x32_bf16 v[88:91], v[52:55], v[128:131], 0
v_cvt_pkrtz_f16_f32 v245, v246, v247
v_lshrrev_b64 v[244:245], 2, v[244:245]
s_waitcnt lgkmcnt(4)
v_mfma_f32_16x16x32_f16 v[116:119], v[48:51], v[140:143], v[116:119]
v_and_b32_sdwa v246, s47, v244 dst_sel:DWORD dst_unused:UNUSED_PAD src0_sel:DWORD src1_sel:WORD_1
v_and_b32_e64 v244, s47, v244
v_mfma_f32_16x16x32_bf16 v[64:67], v[52:55], v[136:139], 0
ds_read_u16_d16_hi v246, v246
ds_read_u16 v244, v244
v_rcp_f16_sdwa v25, v25 dst_sel:WORD_1 dst_unused:UNUSED_PRESERVE src0_sel:WORD_1
v_mfma_f32_16x16x32_f16 v[240:243], v[48:51], v[132:135], v[240:243]
ds_read_b128 v[52:55], v248 offset:33024
v_and_b32_sdwa v247, s47, v245 dst_sel:DWORD dst_unused:UNUSED_PAD src0_sel:DWORD src1_sel:WORD_1
v_and_b32_e64 v245, s47, v245
v_rcp_f16_sdwa v27, v27 dst_sel:WORD_1 dst_unused:UNUSED_PRESERVE src0_sel:WORD_1
v_mfma_f32_16x16x32_bf16 v[80:83], v[120:123], v[36:39], v[80:83]
ds_read_u16_d16_hi v247, v247
ds_read_u16 v245, v245
v_mfma_f32_16x16x32_f16 v[76:79], v[48:51], v[4:7], v[76:79]
v_cvt_pkrtz_f16_f32 v168, v168, v169
v_cvt_pkrtz_f16_f32 v169, v170, v171
v_lshrrev_b64 v[168:169], 2, v[168:169]
v_and_b32_sdwa v170, s47, v168 dst_sel:DWORD dst_unused:UNUSED_PAD src0_sel:DWORD src1_sel:WORD_1
v_and_b32_e64 v168, s47, v168
v_pk_mul_f16 v24, v24, v25
v_mfma_f32_16x16x32_bf16 v[88:91], v[120:123], v[108:111], v[88:91]
ds_read_u16_d16_hi v170, v170
ds_read_u16 v168, v168
ds_read_b128 v[48:51], v251 offset:28672
v_mfma_f32_16x16x32_f16 v[72:75], v[124:127], v[140:143], v[72:75]
v_and_b32_sdwa v171, s47, v169 dst_sel:DWORD dst_unused:UNUSED_PAD src0_sel:DWORD src1_sel:WORD_1
v_and_b32_e64 v169, s47, v169
v_pk_mul_f16 v25, v26, v27
v_lshl_add_u64 v[56:57], v[56:57], 0, v[58:59]
v_mfma_f32_16x16x32_bf16 v[64:67], v[120:123], v[192:195], v[64:67]
ds_read_u16_d16_hi v171, v171
ds_read_u16 v169, v169
v_cvt_pkrtz_f16_f32 v32, v32, v33
v_cvt_pkrtz_f16_f32 v33, v34, v35
v_lshrrev_b64 v[32:33], 2, v[32:33]
v_and_b32_sdwa v34, s47, v32 dst_sel:DWORD dst_unused:UNUSED_PAD src0_sel:DWORD src1_sel:WORD_1
v_and_b32_e64 v32, s47, v32
v_mfma_f32_16x16x32_f16 v[8:11], v[124:127], v[132:135], v[8:11]
ds_read_u16_d16_hi v34, v34
s_waitcnt lgkmcnt(8)
ds_read_u16 v32, v32
ds_read_b128 v[120:123], v248 offset:35072
s_setprio 1
buffer_store_dwordx4 v[164:167], v253, s[8:11], s69 offen sc1
buffer_store_dwordx4 v[100:103], v253, s[8:11], s69 offen offset:64 sc1
v_and_b32_sdwa v35, s47, v33 dst_sel:DWORD dst_unused:UNUSED_PAD src0_sel:DWORD src1_sel:WORD_1
v_and_b32 v33, s47, v33
v_mfma_f32_16x16x32_bf16 v[80:83], v[184:187], v[44:47], v[80:83]
ds_read_u16_d16_hi v35, v35
ds_read_u16 v33, v33
v_mfma_f32_16x16x32_f16 v[220:223], v[124:127], v[4:7], v[220:223]
ds_read_b128 v[124:127], v251 offset:31744
v_lshl_add_u64 v[60:61], v[60:61], 0, v[62:63]
v_mfma_f32_16x16x32_bf16 v[88:91], v[184:187], v[144:147], v[88:91]
s_nop 1
v_cvt_pk_f16_f32 v80, v80, v81
v_mfma_f32_16x16x32_f16 v[12:15], v[176:179], v[140:143], v[12:15]
v_cvt_pk_f16_f32 v82, v82, v83
v_pk_fma_f16 v81, v80, v80, s48
v_mfma_f32_16x16x32_bf16 v[64:67], v[184:187], v[148:151], v[64:67]
ds_read_b128 v[184:187], v249
v_cvt_pkrtz_f16_f32 v88, v88, v89
v_mfma_f32_16x16x32_f16 v[96:99], v[176:179], v[132:135], v[96:99]
v_cvt_pkrtz_f16_f32 v89, v90, v91
v_lshrrev_b64 v[88:89], 2, v[88:89]
v_mfma_f32_16x16x32_bf16 v[68:71], v[188:191], v[28:31], 0
v_and_b32_sdwa v90, s47, v88 dst_sel:DWORD dst_unused:UNUSED_PAD src0_sel:DWORD src1_sel:WORD_1
v_and_b32 v88, s47, v88
v_mfma_f32_16x16x32_f16 v[84:87], v[176:179], v[4:7], v[84:87]
ds_read_b128 v[176:179], v251 offset:32768
s_waitcnt lgkmcnt(8)
ds_read_u16_d16_hi v90, v90
v_mfma_f32_16x16x32_bf16 v[104:107], v[188:191], v[128:131], 0
ds_read_u16 v88, v88
v_and_b32_sdwa v91, s47, v89 dst_sel:DWORD dst_unused:UNUSED_PAD src0_sel:DWORD src1_sel:WORD_1
v_mfma_f32_16x16x32_f16 v[208:211], v[160:163], v[140:143], v[208:211]
v_and_b32 v89, s47, v89
v_pk_fma_f16 v83, v82, v82, s48
v_mfma_f32_16x16x32_bf16 v[204:207], v[188:191], v[136:139], 0
ds_read_b128 v[188:191], v249 offset:2048
ds_read_u16_d16_hi v91, v91
v_mfma_f32_16x16x32_f16 v[212:215], v[160:163], v[132:135], v[212:215]
s_setprio 0
ds_read_u16 v89, v89
v_pk_mul_f16 v81, v80, v81
v_mfma_f32_16x16x32_bf16 v[68:71], v[52:55], v[36:39], v[68:71]
v_pk_mul_f16 v83, v82, v83
v_cvt_pkrtz_f16_f32 v64, v64, v65
v_mfma_f32_16x16x32_f16 v[236:239], v[160:163], v[4:7], v[236:239]
ds_read_b128 v[160:163], v251 offset:35840
v_cvt_pkrtz_f16_f32 v65, v66, v67
v_mfma_f32_16x16x32_bf16 v[104:107], v[52:55], v[108:111], v[104:107]
buffer_load_dwordx4 v[40:43], v253, s[4:7], s69 offen offset:256
buffer_load_dwordx4 v[0:3], v253, s[4:7], s69 offen offset:320
v_lshrrev_b64 v[64:65], 2, v[64:65]
v_mfma_f32_16x16x32_f16 v[180:183], v[48:51], v[140:143], v[180:183]
v_and_b32_sdwa v66, s47, v64 dst_sel:DWORD dst_unused:UNUSED_PAD src0_sel:DWORD src1_sel:WORD_1
v_and_b32 v64, s47, v64
v_lshl_add_u64 v[26:27], v[244:245], 0, v[246:247]
v_exp_f16_sdwa v81, v81 dst_sel:WORD_0 dst_unused:UNUSED_PRESERVE src0_sel:WORD_0
v_mfma_f32_16x16x32_bf16 v[204:207], v[52:55], v[192:195], v[204:207]
ds_read_u16_d16_hi v66, v66
s_waitcnt lgkmcnt(7)
ds_read_u16 v64, v64
v_mfma_f32_16x16x32_f16 v[196:199], v[48:51], v[132:135], v[196:199]
ds_read_b128 v[52:55], v249 offset:4096
v_exp_f16_sdwa v83, v83 dst_sel:WORD_0 dst_unused:UNUSED_PRESERVE src0_sel:WORD_0
v_and_b32_sdwa v67, s47, v65 dst_sel:DWORD dst_unused:UNUSED_PAD src0_sel:DWORD src1_sel:WORD_1
v_and_b32_e64 v65, s47, v65
v_mfma_f32_16x16x32_bf16 v[68:71], v[120:123], v[44:47], v[68:71]
ds_read_u16_d16_hi v67, v67
ds_read_u16 v65, v65
v_lshl_add_u64 v[58:59], v[168:169], 0, v[170:171]
v_mfma_f32_16x16x32_f16 v[92:95], v[48:51], v[4:7], v[92:95]
v_exp_f16_sdwa v81, v81 dst_sel:WORD_1 dst_unused:UNUSED_PRESERVE src0_sel:WORD_1
v_mfma_f32_16x16x32_bf16 v[104:107], v[120:123], v[144:147], v[104:107]
ds_read_b128 v[48:51], v251 offset:33792
v_exp_f16_sdwa v83, v83 dst_sel:WORD_1 dst_unused:UNUSED_PRESERVE src0_sel:WORD_1
v_mfma_f32_16x16x32_f16 v[216:219], v[124:127], v[140:143], v[216:219]
v_lshl_add_u64 v[62:63], v[32:33], 0, v[34:35]
v_pk_add_f16 v81, v81, 1.0 op_sel_hi:[1,0]
v_mfma_f32_16x16x32_bf16 v[204:207], v[120:123], v[148:151], v[204:207]
ds_read_b128 v[120:123], v249 offset:256
v_pk_add_f16 v83, v83, 1.0 op_sel_hi:[1,0]
v_mfma_f32_16x16x32_f16 v[232:235], v[124:127], v[132:135], v[232:235]
s_setprio 3
v_rcp_f16_sdwa v81, v81 dst_sel:WORD_0 dst_unused:UNUSED_PRESERVE src0_sel:WORD_0
v_mfma_f32_16x16x32_bf16 v[172:175], v[184:187], v[28:31], 0
v_rcp_f16_sdwa v83, v83 dst_sel:WORD_0 dst_unused:UNUSED_PRESERVE src0_sel:WORD_0
v_mfma_f32_16x16x32_f16 v[224:227], v[124:127], v[4:7], v[224:227]
ds_read_b128 v[124:127], v251 offset:36864
v_cvt_pkrtz_f16_f32 v104, v104, v105
v_mfma_f32_16x16x32_bf16 v[156:159], v[184:187], v[128:131], 0
v_cvt_pkrtz_f16_f32 v105, v106, v107
v_lshrrev_b64 v[104:105], 2, v[104:105]
v_mfma_f32_16x16x32_f16 v[116:119], v[176:179], v[60:63], v[116:119]
v_and_b32_sdwa v106, s47, v104 dst_sel:DWORD dst_unused:UNUSED_PAD src0_sel:DWORD src1_sel:WORD_1
v_and_b32_e64 v104, s47, v104
v_cvt_pk_f16_f32 v68, v68, v69
v_mfma_f32_16x16x32_bf16 v[228:231], v[184:187], v[136:139], 0
ds_read_u16_d16_hi v106, v106
s_waitcnt lgkmcnt(5)
ds_read_u16 v104, v104
v_rcp_f16_sdwa v81, v81 dst_sel:WORD_1 dst_unused:UNUSED_PRESERVE src0_sel:WORD_1
v_mfma_f32_16x16x32_f16 v[240:243], v[176:179], v[56:59], v[240:243]
v_cvt_pk_f16_f32 v70, v70, v71
v_pk_fma_f16 v69, v68, v68, s48
v_rcp_f16_sdwa v83, v83 dst_sel:WORD_1 dst_unused:UNUSED_PRESERVE src0_sel:WORD_1
v_mfma_f32_16x16x32_bf16 v[172:175], v[188:191], v[36:39], v[172:175]
ds_read_b128 v[184:187], v249 offset:2304
v_and_b32_sdwa v107, s47, v105 dst_sel:DWORD dst_unused:UNUSED_PAD src0_sel:DWORD src1_sel:WORD_1
v_and_b32_e64 v105, s47, v105
v_pk_fma_f16 v71, v70, v70, s48
v_mfma_f32_16x16x32_f16 v[76:79], v[176:179], v[24:27], v[76:79]
ds_read_u16_d16_hi v107, v107
ds_read_u16 v105, v105
ds_read_b128 v[176:179], v251 offset:34816
v_pk_mul_f16 v69, v68, v69
v_pk_mul_f16 v80, v80, v81
v_mfma_f32_16x16x32_bf16 v[156:159], v[188:191], v[108:111], v[156:159]
v_pk_mul_f16 v71, v70, v71
v_cvt_pkrtz_f16_f32 v204, v204, v205
v_mfma_f32_16x16x32_f16 v[72:75], v[160:163], v[60:63], v[72:75]
v_cvt_pkrtz_f16_f32 v205, v206, v207
v_lshrrev_b64 v[204:205], 2, v[204:205]
v_and_b32_sdwa v206, s47, v204 dst_sel:DWORD dst_unused:UNUSED_PAD src0_sel:DWORD src1_sel:WORD_1
v_and_b32_e64 v204, s47, v204
v_pk_mul_f16 v81, v82, v83
v_exp_f16_sdwa v69, v69 dst_sel:WORD_0 dst_unused:UNUSED_PRESERVE src0_sel:WORD_0
v_lshl_add_u64 v[88:89], v[88:89], 0, v[90:91]
v_mfma_f32_16x16x32_bf16 v[228:231], v[188:191], v[192:195], v[228:231]
ds_read_u16_d16_hi v206, v206
ds_read_u16 v204, v204
v_mfma_f32_16x16x32_f16 v[8:11], v[160:163], v[56:59], v[8:11]
s_setprio 2
ds_read_b128 v[188:191], v249 offset:4352
v_exp_f16_sdwa v71, v71 dst_sel:WORD_0 dst_unused:UNUSED_PRESERVE src0_sel:WORD_0
v_and_b32_sdwa v207, s47, v205 dst_sel:DWORD dst_unused:UNUSED_PAD src0_sel:DWORD src1_sel:WORD_1
v_and_b32_e64 v205, s47, v205
v_mfma_f32_16x16x32_bf16 v[172:175], v[52:55], v[44:47], v[172:175]
ds_read_u16_d16_hi v207, v207
ds_read_u16 v205, v205
v_mfma_f32_16x16x32_f16 v[220:223], v[160:163], v[24:27], v[220:223]
v_exp_f16_sdwa v69, v69 dst_sel:WORD_1 dst_unused:UNUSED_PRESERVE src0_sel:WORD_1
v_mfma_f32_16x16x32_bf16 v[156:159], v[52:55], v[144:147], v[156:159]
s_waitcnt lgkmcnt(6)
ds_read_b128 v[160:163], v251 offset:37888
buffer_store_dwordx4 v[200:203], v253, s[8:11], s69 offen offset:128 sc1
v_lshl_add_u64 v[64:65], v[64:65], 0, v[66:67]
v_mfma_f32_16x16x32_f16 v[12:15], v[48:51], v[60:63], v[12:15]
v_exp_f16_sdwa v71, v71 dst_sel:WORD_1 dst_unused:UNUSED_PRESERVE src0_sel:WORD_1
v_mfma_f32_16x16x32_bf16 v[228:231], v[52:55], v[148:151], v[228:231]
v_pk_add_f16 v69, v69, 1.0 op_sel_hi:[1,0]
v_pk_add_f16 v71, v71, 1.0 op_sel_hi:[1,0]
v_mfma_f32_16x16x32_f16 v[96:99], v[48:51], v[56:59], v[96:99]
ds_read_b128 v[52:55], v249 offset:6144
v_rcp_f16_sdwa v69, v69 dst_sel:WORD_0 dst_unused:UNUSED_PRESERVE src0_sel:WORD_0
v_mfma_f32_16x16x32_bf16 v[112:115], v[120:123], v[28:31], 0
v_rcp_f16_sdwa v71, v71 dst_sel:WORD_0 dst_unused:UNUSED_PRESERVE src0_sel:WORD_0
v_mfma_f32_16x16x32_f16 v[84:87], v[48:51], v[24:27], v[84:87]
ds_read_b128 v[48:51], v251 offset:38912
v_cvt_pkrtz_f16_f32 v172, v172, v173
v_mfma_f32_16x16x32_bf16 v[164:167], v[120:123], v[128:131], 0
v_cvt_pkrtz_f16_f32 v173, v174, v175
v_lshrrev_b64 v[172:173], 2, v[172:173]
v_mfma_f32_16x16x32_f16 v[208:211], v[124:127], v[60:63], v[208:211]
v_and_b32_sdwa v174, s47, v172 dst_sel:DWORD dst_unused:UNUSED_PAD src0_sel:DWORD src1_sel:WORD_1
v_and_b32_e64 v172, s47, v172
v_mfma_f32_16x16x32_bf16 v[100:103], v[120:123], v[136:139], 0
ds_read_u16_d16_hi v174, v174
ds_read_u16 v172, v172
v_rcp_f16_sdwa v69, v69 dst_sel:WORD_1 dst_unused:UNUSED_PRESERVE src0_sel:WORD_1
s_setprio 1
v_mfma_f32_16x16x32_f16 v[212:215], v[124:127], v[56:59], v[212:215]
ds_read_b128 v[120:123], v249 offset:8192
v_and_b32_sdwa v175, s47, v173 dst_sel:DWORD dst_unused:UNUSED_PAD src0_sel:DWORD src1_sel:WORD_1
v_and_b32 v173, s47, v173
v_rcp_f16_sdwa v71, v71 dst_sel:WORD_1 dst_unused:UNUSED_PRESERVE src0_sel:WORD_1
v_mfma_f32_16x16x32_bf16 v[112:115], v[184:187], v[36:39], v[112:115]
ds_read_u16_d16_hi v175, v175
ds_read_u16 v173, v173
v_mfma_f32_16x16x32_f16 v[236:239], v[124:127], v[24:27], v[236:239]
v_cvt_pkrtz_f16_f32 v156, v156, v157
v_cvt_pkrtz_f16_f32 v157, v158, v159
v_lshrrev_b64 v[156:157], 2, v[156:157]
v_and_b32_sdwa v158, s47, v156 dst_sel:DWORD dst_unused:UNUSED_PAD src0_sel:DWORD src1_sel:WORD_1
v_and_b32 v156, s47, v156
v_pk_mul_f16 v82, v68, v69
v_mfma_f32_16x16x32_bf16 v[164:167], v[184:187], v[108:111], v[164:167]
ds_read_u16_d16_hi v158, v158
s_waitcnt lgkmcnt(6)
ds_read_u16 v156, v156
ds_read_b128 v[124:127], v251 offset:41984
buffer_load_dwordx4 v[244:247], v253, s[4:7], s68 offen
buffer_load_dwordx4 v[168:171], v253, s[4:7], s68 offen offset:64
v_mfma_f32_16x16x32_f16 v[180:183], v[176:179], v[60:63], v[180:183]
v_and_b32_sdwa v159, s47, v157 dst_sel:DWORD dst_unused:UNUSED_PAD src0_sel:DWORD src1_sel:WORD_1
v_and_b32_e64 v157, s47, v157
v_pk_mul_f16 v83, v70, v71
v_lshl_add_u64 v[90:91], v[104:105], 0, v[106:107]
v_mfma_f32_16x16x32_bf16 v[100:103], v[184:187], v[192:195], v[100:103]
ds_read_u16_d16_hi v159, v159
ds_read_u16 v157, v157
v_cvt_pkrtz_f16_f32 v228, v228, v229
v_cvt_pkrtz_f16_f32 v229, v230, v231
v_lshrrev_b64 v[228:229], 2, v[228:229]
v_and_b32_sdwa v230, s47, v228 dst_sel:DWORD dst_unused:UNUSED_PAD src0_sel:DWORD src1_sel:WORD_1
v_and_b32_e64 v228, s47, v228
v_mfma_f32_16x16x32_f16 v[196:199], v[176:179], v[56:59], v[196:199]
ds_read_u16_d16_hi v230, v230
ds_read_u16 v228, v228
ds_read_b128 v[184:187], v249 offset:10240
v_and_b32_sdwa v231, s47, v229 dst_sel:DWORD dst_unused:UNUSED_PAD src0_sel:DWORD src1_sel:WORD_1
v_and_b32 v229, s47, v229
v_mfma_f32_16x16x32_bf16 v[112:115], v[188:191], v[44:47], v[112:115]
ds_read_u16_d16_hi v231, v231
ds_read_u16 v229, v229
v_mfma_f32_16x16x32_f16 v[92:95], v[176:179], v[24:27], v[92:95]
s_waitcnt lgkmcnt(10)
ds_read_b128 v[176:179], v251 offset:39936
v_lshl_add_u64 v[66:67], v[204:205], 0, v[206:207]
v_mfma_f32_16x16x32_bf16 v[164:167], v[188:191], v[144:147], v[164:167]
s_nop 0
v_cvt_pk_f16_f32 v112, v112, v113
v_mfma_f32_16x16x32_f16 v[216:219], v[160:163], v[60:63], v[216:219]
v_cvt_pk_f16_f32 v114, v114, v115
v_pk_fma_f16 v113, v112, v112, s48
v_mfma_f32_16x16x32_bf16 v[100:103], v[188:191], v[148:151], v[100:103]
s_setprio 0
ds_read_b128 v[188:191], v249 offset:6400
v_cvt_pkrtz_f16_f32 v164, v164, v165
v_mfma_f32_16x16x32_f16 v[232:235], v[160:163], v[56:59], v[232:235]
v_cvt_pkrtz_f16_f32 v165, v166, v167
v_lshrrev_b64 v[164:165], 2, v[164:165]
v_mfma_f32_16x16x32_bf16 v[32:35], v[52:55], v[28:31], 0
v_and_b32_sdwa v166, s47, v164 dst_sel:DWORD dst_unused:UNUSED_PAD src0_sel:DWORD src1_sel:WORD_1
v_and_b32_e64 v164, s47, v164
v_mfma_f32_16x16x32_f16 v[224:227], v[160:163], v[24:27], v[224:227]
ds_read_b128 v[160:163], v251 offset:43008
ds_read_u16_d16_hi v166, v166
v_mfma_f32_16x16x32_bf16 v[4:7], v[52:55], v[128:131], 0
ds_read_u16 v164, v164
v_and_b32_sdwa v167, s47, v165 dst_sel:DWORD dst_unused:UNUSED_PAD src0_sel:DWORD src1_sel:WORD_1
v_mfma_f32_16x16x32_f16 v[116:119], v[48:51], v[64:67], v[116:119]
v_and_b32 v165, s47, v165
v_pk_fma_f16 v115, v114, v114, s48
v_mfma_f32_16x16x32_bf16 v[132:135], v[52:55], v[136:139], 0
s_waitcnt lgkmcnt(8)
ds_read_b128 v[52:55], v249 offset:8448
ds_read_u16_d16_hi v167, v167
v_mfma_f32_16x16x32_f16 v[240:243], v[48:51], v[88:91], v[240:243]
ds_read_u16 v165, v165
v_pk_mul_f16 v113, v112, v113
v_mfma_f32_16x16x32_bf16 v[32:35], v[120:123], v[36:39], v[32:35]
v_pk_mul_f16 v115, v114, v115
v_cvt_pkrtz_f16_f32 v100, v100, v101
v_mfma_f32_16x16x32_f16 v[76:79], v[48:51], v[80:83], v[76:79]
ds_read_b128 v[48:51], v251 offset:40960
v_cvt_pkrtz_f16_f32 v101, v102, v103
v_mfma_f32_16x16x32_bf16 v[4:7], v[120:123], v[108:111], v[4:7]
v_lshrrev_b64 v[100:101], 2, v[100:101]
v_and_b32_sdwa v102, s47, v100 dst_sel:DWORD dst_unused:UNUSED_PAD src0_sel:DWORD src1_sel:WORD_1
v_mfma_f32_16x16x32_f16 v[72:75], v[124:127], v[64:67], v[72:75]
v_and_b32 v100, s47, v100
v_lshl_add_u64 v[172:173], v[172:173], 0, v[174:175]
v_exp_f16_sdwa v113, v113 dst_sel:WORD_0 dst_unused:UNUSED_PRESERVE src0_sel:WORD_0
v_mfma_f32_16x16x32_bf16 v[132:135], v[120:123], v[192:195], v[132:135]
ds_read_u16_d16_hi v102, v102
ds_read_u16 v100, v100
s_setprio 3
v_mfma_f32_16x16x32_f16 v[8:11], v[124:127], v[88:91], v[8:11]
ds_read_b128 v[120:123], v249 offset:10496
v_exp_f16_sdwa v115, v115 dst_sel:WORD_0 dst_unused:UNUSED_PRESERVE src0_sel:WORD_0
v_and_b32_sdwa v103, s47, v101 dst_sel:DWORD dst_unused:UNUSED_PAD src0_sel:DWORD src1_sel:WORD_1
v_and_b32 v101, s47, v101
s_waitcnt lgkmcnt(8)
v_mfma_f32_16x16x32_bf16 v[32:35], v[184:187], v[44:47], v[32:35]
ds_read_u16_d16_hi v103, v103
ds_read_u16 v101, v101
v_lshl_add_u64 v[156:157], v[156:157], 0, v[158:159]
v_mfma_f32_16x16x32_f16 v[220:223], v[124:127], v[80:83], v[220:223]
v_exp_f16_sdwa v113, v113 dst_sel:WORD_1 dst_unused:UNUSED_PRESERVE src0_sel:WORD_1
v_mfma_f32_16x16x32_bf16 v[4:7], v[184:187], v[144:147], v[4:7]
ds_read_b128 v[124:127], v251 offset:44032
v_exp_f16_sdwa v115, v115 dst_sel:WORD_1 dst_unused:UNUSED_PRESERVE src0_sel:WORD_1
v_mfma_f32_16x16x32_f16 v[12:15], v[176:179], v[64:67], v[12:15]
v_lshl_add_u64 v[228:229], v[228:229], 0, v[230:231]
v_pk_add_f16 v113, v113, 1.0 op_sel_hi:[1,0]
v_mfma_f32_16x16x32_bf16 v[132:135], v[184:187], v[148:151], v[132:135]
ds_read_b128 v[184:187], v249 offset:12288
v_pk_add_f16 v115, v115, 1.0 op_sel_hi:[1,0]
v_mfma_f32_16x16x32_f16 v[96:99], v[176:179], v[88:91], v[96:99]
v_rcp_f16_sdwa v113, v113 dst_sel:WORD_0 dst_unused:UNUSED_PRESERVE src0_sel:WORD_0
v_mfma_f32_16x16x32_bf16 v[140:143], v[188:191], v[28:31], 0
v_rcp_f16_sdwa v115, v115 dst_sel:WORD_0 dst_unused:UNUSED_PRESERVE src0_sel:WORD_0
v_mfma_f32_16x16x32_f16 v[84:87], v[176:179], v[80:83], v[84:87]
ds_read_b128 v[176:179], v251 offset:45056
v_cvt_pkrtz_f16_f32 v4, v4, v5
v_mfma_f32_16x16x32_bf16 v[200:203], v[188:191], v[128:131], 0
v_cvt_pkrtz_f16_f32 v5, v6, v7
v_lshrrev_b64 v[4:5], 2, v[4:5]
v_mfma_f32_16x16x32_f16 v[208:211], v[160:163], v[64:67], v[208:211]
v_and_b32_sdwa v6, s47, v4 dst_sel:DWORD dst_unused:UNUSED_PAD src0_sel:DWORD src1_sel:WORD_1
v_and_b32 v4, s47, v4
v_cvt_pk_f16_f32 v32, v32, v33
s_setprio 2
ds_read_u16_d16_hi v6, v6
ds_read_u16 v4, v4
v_mfma_f32_16x16x32_bf16 v[68:71], v[188:191], v[136:139], 0
v_rcp_f16_sdwa v113, v113 dst_sel:WORD_1 dst_unused:UNUSED_PRESERVE src0_sel:WORD_1
v_mfma_f32_16x16x32_f16 v[212:215], v[160:163], v[88:91], v[212:215]
v_cvt_pk_f16_f32 v34, v34, v35
v_pk_fma_f16 v33, v32, v32, s48
v_rcp_f16_sdwa v115, v115 dst_sel:WORD_1 dst_unused:UNUSED_PRESERVE src0_sel:WORD_1
s_waitcnt lgkmcnt(4)
v_mfma_f32_16x16x32_bf16 v[140:143], v[52:55], v[36:39], v[140:143]
ds_read_b128 v[188:191], v249 offset:14336
v_and_b32_sdwa v7, s47, v5 dst_sel:DWORD dst_unused:UNUSED_PAD src0_sel:DWORD src1_sel:WORD_1
v_and_b32 v5, s47, v5
v_pk_fma_f16 v35, v34, v34, s48
v_mfma_f32_16x16x32_f16 v[236:239], v[160:163], v[80:83], v[236:239]
ds_read_u16_d16_hi v7, v7
ds_read_u16 v5, v5
ds_read_b128 v[160:163], v251 offset:48128
v_pk_mul_f16 v33, v32, v33
v_pk_mul_f16 v174, v112, v113
v_mfma_f32_16x16x32_bf16 v[200:203], v[52:55], v[108:111], v[200:203]
v_pk_mul_f16 v35, v34, v35
buffer_load_dwordx4 v[104:107], v253, s[4:7], s68 offen offset:128
buffer_load_dwordx4 v[204:207], v253, s[4:7], s68 offen offset:192
v_mfma_f32_16x16x32_f16 v[180:183], v[48:51], v[64:67], v[180:183]
v_cvt_pkrtz_f16_f32 v132, v132, v133
v_cvt_pkrtz_f16_f32 v133, v134, v135
v_lshrrev_b64 v[132:133], 2, v[132:133]
v_and_b32_sdwa v134, s47, v132 dst_sel:DWORD dst_unused:UNUSED_PAD src0_sel:DWORD src1_sel:WORD_1
v_and_b32_e64 v132, s47, v132
v_pk_mul_f16 v175, v114, v115
v_exp_f16_sdwa v33, v33 dst_sel:WORD_0 dst_unused:UNUSED_PRESERVE src0_sel:WORD_0
v_lshl_add_u64 v[158:159], v[164:165], 0, v[166:167]
v_mfma_f32_16x16x32_bf16 v[68:71], v[52:55], v[192:195], v[68:71]
ds_read_u16_d16_hi v134, v134
ds_read_u16 v132, v132
v_mfma_f32_16x16x32_f16 v[196:199], v[48:51], v[88:91], v[196:199]
ds_read_b128 v[52:55], v249 offset:16384
v_exp_f16_sdwa v35, v35 dst_sel:WORD_0 dst_unused:UNUSED_PRESERVE src0_sel:WORD_0
v_and_b32_sdwa v135, s47, v133 dst_sel:DWORD dst_unused:UNUSED_PAD src0_sel:DWORD src1_sel:WORD_1
v_and_b32_e64 v133, s47, v133
v_mfma_f32_16x16x32_bf16 v[140:143], v[120:123], v[44:47], v[140:143]
ds_read_u16_d16_hi v135, v135
ds_read_u16 v133, v133
v_mfma_f32_16x16x32_f16 v[92:95], v[48:51], v[80:83], v[92:95]
v_exp_f16_sdwa v33, v33 dst_sel:WORD_1 dst_unused:UNUSED_PRESERVE src0_sel:WORD_1
v_mfma_f32_16x16x32_bf16 v[200:203], v[120:123], v[144:147], v[200:203]
ds_read_b128 v[48:51], v251 offset:46080
v_lshl_add_u64 v[230:231], v[100:101], 0, v[102:103]
v_mfma_f32_16x16x32_f16 v[216:219], v[124:127], v[64:67], v[216:219]
v_exp_f16_sdwa v35, v35 dst_sel:WORD_1 dst_unused:UNUSED_PRESERVE src0_sel:WORD_1
s_setprio 1
v_mfma_f32_16x16x32_bf16 v[68:71], v[120:123], v[148:151], v[68:71]
v_pk_add_f16 v33, v33, 1.0 op_sel_hi:[1,0]
v_pk_add_f16 v35, v35, 1.0 op_sel_hi:[1,0]
v_mfma_f32_16x16x32_f16 v[232:235], v[124:127], v[88:91], v[232:235]
ds_read_b128 v[120:123], v249 offset:12544
v_rcp_f16_sdwa v33, v33 dst_sel:WORD_0 dst_unused:UNUSED_PRESERVE src0_sel:WORD_0
s_waitcnt lgkmcnt(6)
v_mfma_f32_16x16x32_bf16 v[24:27], v[184:187], v[28:31], 0
v_rcp_f16_sdwa v35, v35 dst_sel:WORD_0 dst_unused:UNUSED_PRESERVE src0_sel:WORD_0
v_mfma_f32_16x16x32_f16 v[224:227], v[124:127], v[80:83], v[224:227]
ds_read_b128 v[124:127], v251 offset:49152
v_cvt_pkrtz_f16_f32 v140, v140, v141
v_mfma_f32_16x16x32_bf16 v[56:59], v[184:187], v[128:131], 0
v_cvt_pkrtz_f16_f32 v141, v142, v143
v_lshrrev_b64 v[140:141], 2, v[140:141]
v_mfma_f32_16x16x32_f16 v[116:119], v[176:179], v[228:231], v[116:119]
v_and_b32_sdwa v142, s47, v140 dst_sel:DWORD dst_unused:UNUSED_PAD src0_sel:DWORD src1_sel:WORD_1
v_and_b32_e64 v140, s47, v140
v_mfma_f32_16x16x32_bf16 v[60:63], v[184:187], v[136:139], 0
ds_read_u16_d16_hi v142, v142
ds_read_u16 v140, v140
v_rcp_f16_sdwa v33, v33 dst_sel:WORD_1 dst_unused:UNUSED_PRESERVE src0_sel:WORD_1
v_mfma_f32_16x16x32_f16 v[240:243], v[176:179], v[156:159], v[240:243]
ds_read_b128 v[184:187], v249 offset:14592
v_and_b32_sdwa v143, s47, v141 dst_sel:DWORD dst_unused:UNUSED_PAD src0_sel:DWORD src1_sel:WORD_1
v_and_b32_e64 v141, s47, v141
v_rcp_f16_sdwa v35, v35 dst_sel:WORD_1 dst_unused:UNUSED_PRESERVE src0_sel:WORD_1
v_mfma_f32_16x16x32_bf16 v[24:27], v[188:191], v[36:39], v[24:27]
ds_read_u16_d16_hi v143, v143
ds_read_u16 v141, v141
v_mfma_f32_16x16x32_f16 v[76:79], v[176:179], v[172:175], v[76:79]
v_cvt_pkrtz_f16_f32 v200, v200, v201
v_cvt_pkrtz_f16_f32 v201, v202, v203
v_lshrrev_b64 v[200:201], 2, v[200:201]
v_and_b32_sdwa v202, s47, v200 dst_sel:DWORD dst_unused:UNUSED_PAD src0_sel:DWORD src1_sel:WORD_1
v_and_b32_e64 v200, s47, v200
v_pk_mul_f16 v32, v32, v33
v_mfma_f32_16x16x32_bf16 v[56:59], v[188:191], v[108:111], v[56:59]
ds_read_u16_d16_hi v202, v202
ds_read_u16 v200, v200
ds_read_b128 v[176:179], v251 offset:47104
v_mfma_f32_16x16x32_f16 v[72:75], v[160:163], v[228:231], v[72:75]
v_and_b32_sdwa v203, s47, v201 dst_sel:DWORD dst_unused:UNUSED_PAD src0_sel:DWORD src1_sel:WORD_1
v_and_b32_e64 v201, s47, v201
v_pk_mul_f16 v33, v34, v35
v_lshl_add_u64 v[4:5], v[4:5], 0, v[6:7]
v_mfma_f32_16x16x32_bf16 v[60:63], v[188:191], v[192:195], v[60:63]
s_waitcnt lgkmcnt(7)
ds_read_u16_d16_hi v203, v203
ds_read_u16 v201, v201
s_setprio 0
v_cvt_pkrtz_f16_f32 v68, v68, v69
v_cvt_pkrtz_f16_f32 v69, v70, v71
v_lshrrev_b64 v[68:69], 2, v[68:69]
v_and_b32_sdwa v70, s47, v68 dst_sel:DWORD dst_unused:UNUSED_PAD src0_sel:DWORD src1_sel:WORD_1
v_and_b32_e64 v68, s47, v68
v_mfma_f32_16x16x32_f16 v[8:11], v[160:163], v[156:159], v[8:11]
ds_read_u16_d16_hi v70, v70
ds_read_u16 v68, v68
ds_read_b128 v[188:191], v249 offset:16640
v_and_b32_sdwa v71, s47, v69 dst_sel:DWORD dst_unused:UNUSED_PAD src0_sel:DWORD src1_sel:WORD_1
v_and_b32_e64 v69, s47, v69
v_mfma_f32_16x16x32_bf16 v[24:27], v[52:55], v[44:47], v[24:27]
ds_read_u16_d16_hi v71, v71
ds_read_u16 v69, v69
v_mfma_f32_16x16x32_f16 v[220:223], v[160:163], v[172:175], v[220:223]
ds_read_b128 v[160:163], v251 offset:50176
v_lshl_add_u64 v[132:133], v[132:133], 0, v[134:135]
v_mfma_f32_16x16x32_bf16 v[56:59], v[52:55], v[144:147], v[56:59]
s_nop 1
v_cvt_pk_f16_f32 v24, v24, v25
v_mfma_f32_16x16x32_f16 v[12:15], v[48:51], v[228:231], v[12:15]
v_cvt_pk_f16_f32 v26, v26, v27
v_pk_fma_f16 v25, v24, v24, s48
v_mfma_f32_16x16x32_bf16 v[60:63], v[52:55], v[148:151], v[60:63]
s_waitcnt lgkmcnt(9)
ds_read_b128 v[52:55], v249 offset:18432
v_cvt_pkrtz_f16_f32 v56, v56, v57
v_mfma_f32_16x16x32_f16 v[96:99], v[48:51], v[156:159], v[96:99]
v_cvt_pkrtz_f16_f32 v57, v58, v59
v_lshrrev_b64 v[56:57], 2, v[56:57]
v_mfma_f32_16x16x32_bf16 v[112:115], v[120:123], v[28:31], 0
v_and_b32_sdwa v58, s47, v56 dst_sel:DWORD dst_unused:UNUSED_PAD src0_sel:DWORD src1_sel:WORD_1
v_and_b32_e64 v56, s47, v56
v_mfma_f32_16x16x32_f16 v[84:87], v[48:51], v[172:175], v[84:87]
ds_read_b128 v[48:51], v251 offset:51200
ds_read_u16_d16_hi v58, v58
v_mfma_f32_16x16x32_bf16 v[164:167], v[120:123], v[128:131], 0
ds_read_u16 v56, v56
v_and_b32_sdwa v59, s47, v57 dst_sel:DWORD dst_unused:UNUSED_PAD src0_sel:DWORD src1_sel:WORD_1
v_mfma_f32_16x16x32_f16 v[208:211], v[124:127], v[228:231], v[208:211]
s_setprio 3
v_and_b32_e64 v57, s47, v57
v_pk_fma_f16 v27, v26, v26, s48
v_mfma_f32_16x16x32_bf16 v[100:103], v[120:123], v[136:139], 0
ds_read_b128 v[120:123], v249 offset:20480
ds_read_u16_d16_hi v59, v59
v_mfma_f32_16x16x32_f16 v[212:215], v[124:127], v[156:159], v[212:215]
s_waitcnt lgkmcnt(10)
ds_read_u16 v57, v57
v_pk_mul_f16 v25, v24, v25
v_mfma_f32_16x16x32_bf16 v[112:115], v[184:187], v[36:39], v[112:115]
v_pk_mul_f16 v27, v26, v27
v_cvt_pkrtz_f16_f32 v60, v60, v61
v_mfma_f32_16x16x32_f16 v[236:239], v[124:127], v[172:175], v[236:239]
ds_read_b128 v[124:127], v251 offset:54272
v_cvt_pkrtz_f16_f32 v61, v62, v63
v_mfma_f32_16x16x32_bf16 v[164:167], v[184:187], v[108:111], v[164:167]
buffer_load_dwordx4 v[80:83], v253, s[4:7], s68 offen offset:256
buffer_load_dwordx4 v[88:91], v253, s[4:7], s68 offen offset:320
v_lshrrev_b64 v[60:61], 2, v[60:61]
v_mfma_f32_16x16x32_f16 v[180:183], v[176:179], v[228:231], v[180:183]
v_and_b32_sdwa v62, s47, v60 dst_sel:DWORD dst_unused:UNUSED_PAD src0_sel:DWORD src1_sel:WORD_1
v_and_b32_e64 v60, s47, v60
v_lshl_add_u64 v[34:35], v[140:141], 0, v[142:143]
v_exp_f16_sdwa v25, v25 dst_sel:WORD_0 dst_unused:UNUSED_PRESERVE src0_sel:WORD_0
v_mfma_f32_16x16x32_bf16 v[100:103], v[184:187], v[192:195], v[100:103]
ds_read_u16_d16_hi v62, v62
ds_read_u16 v60, v60
v_mfma_f32_16x16x32_f16 v[196:199], v[176:179], v[156:159], v[196:199]
ds_read_b128 v[184:187], v249 offset:22528
v_exp_f16_sdwa v27, v27 dst_sel:WORD_0 dst_unused:UNUSED_PRESERVE src0_sel:WORD_0
v_and_b32_sdwa v63, s47, v61 dst_sel:DWORD dst_unused:UNUSED_PAD src0_sel:DWORD src1_sel:WORD_1
v_and_b32 v61, s47, v61
s_waitcnt lgkmcnt(8)
v_mfma_f32_16x16x32_bf16 v[112:115], v[188:191], v[44:47], v[112:115]
ds_read_u16_d16_hi v63, v63
ds_read_u16 v61, v61
v_lshl_add_u64 v[6:7], v[200:201], 0, v[202:203]
v_mfma_f32_16x16x32_f16 v[92:95], v[176:179], v[172:175], v[92:95]
v_exp_f16_sdwa v25, v25 dst_sel:WORD_1 dst_unused:UNUSED_PRESERVE src0_sel:WORD_1
v_mfma_f32_16x16x32_bf16 v[164:167], v[188:191], v[144:147], v[164:167]
ds_read_b128 v[176:179], v251 offset:52224
v_exp_f16_sdwa v27, v27 dst_sel:WORD_1 dst_unused:UNUSED_PRESERVE src0_sel:WORD_1
v_mfma_f32_16x16x32_f16 v[216:219], v[160:163], v[228:231], v[216:219]
s_setprio 2
v_lshl_add_u64 v[134:135], v[68:69], 0, v[70:71]
v_pk_add_f16 v25, v25, 1.0 op_sel_hi:[1,0]
v_mfma_f32_16x16x32_bf16 v[100:103], v[188:191], v[148:151], v[100:103]
ds_read_b128 v[188:191], v249 offset:18688
v_pk_add_f16 v27, v27, 1.0 op_sel_hi:[1,0]
v_mfma_f32_16x16x32_f16 v[232:235], v[160:163], v[156:159], v[232:235]
v_rcp_f16_sdwa v25, v25 dst_sel:WORD_0 dst_unused:UNUSED_PRESERVE src0_sel:WORD_0
v_mfma_f32_16x16x32_bf16 v[64:67], v[52:55], v[28:31], 0
v_rcp_f16_sdwa v27, v27 dst_sel:WORD_0 dst_unused:UNUSED_PRESERVE src0_sel:WORD_0
v_mfma_f32_16x16x32_f16 v[224:227], v[160:163], v[172:175], v[224:227]
ds_read_b128 v[160:163], v251 offset:55296
v_cvt_pkrtz_f16_f32 v164, v164, v165
s_waitcnt vmcnt(11)
v_mfma_f32_16x16x32_bf16 v[76:79], v[18:21], v[152:155], v[76:79]
v_cvt_pkrtz_f16_f32 v165, v166, v167
v_lshrrev_b64 v[164:165], 2, v[164:165]
v_mfma_f32_16x16x32_bf16 v[220:223], v[16:19], v[152:155], v[220:223]
v_and_b32_sdwa v166, s47, v164 dst_sel:DWORD dst_unused:UNUSED_PAD src0_sel:DWORD src1_sel:WORD_1
v_and_b32_e64 v164, s47, v164
v_mfma_f32_16x16x32_bf16 v[140:143], v[52:55], v[128:131], 0
ds_read_u16_d16_hi v166, v166
ds_read_u16 v164, v164
v_mfma_f32_16x16x32_f16 v[116:119], v[48:51], v[132:135], v[116:119]
v_cvt_pk_f16_f32 v112, v112, v113
v_rcp_f16_sdwa v25, v25 dst_sel:WORD_1 dst_unused:UNUSED_PRESERVE src0_sel:WORD_1
v_mfma_f32_16x16x32_bf16 v[200:203], v[52:55], v[136:139], 0
v_cvt_pk_f16_f32 v114, v114, v115
v_pk_fma_f16 v113, v112, v112, s48
v_mfma_f32_16x16x32_f16 v[240:243], v[48:51], v[4:7], v[240:243]
s_waitcnt lgkmcnt(3)
ds_read_b128 v[52:55], v249 offset:20736
v_rcp_f16_sdwa v27, v27 dst_sel:WORD_1 dst_unused:UNUSED_PRESERVE src0_sel:WORD_1
v_mfma_f32_16x16x32_bf16 v[64:67], v[120:123], v[36:39], v[64:67]
v_and_b32_sdwa v167, s47, v165 dst_sel:DWORD dst_unused:UNUSED_PAD src0_sel:DWORD src1_sel:WORD_1
v_and_b32 v165, s47, v165
v_pk_fma_f16 v115, v114, v114, s48
v_mfma_f32_16x16x32_f16 v[76:79], v[48:51], v[32:35], v[76:79]
ds_read_u16_d16_hi v167, v167
ds_read_u16 v165, v165
ds_read_b128 v[48:51], v251 offset:53248
v_pk_mul_f16 v113, v112, v113
v_pk_mul_f16 v24, v24, v25
v_mfma_f32_16x16x32_bf16 v[140:143], v[120:123], v[108:111], v[140:143]
v_pk_mul_f16 v115, v114, v115
s_setprio 1
v_cvt_pkrtz_f16_f32 v100, v100, v101
v_mfma_f32_16x16x32_f16 v[72:75], v[124:127], v[132:135], v[72:75]
v_cvt_pkrtz_f16_f32 v101, v102, v103
v_lshrrev_b64 v[100:101], 2, v[100:101]
v_and_b32_sdwa v102, s47, v100 dst_sel:DWORD dst_unused:UNUSED_PAD src0_sel:DWORD src1_sel:WORD_1
v_and_b32 v100, s47, v100
v_pk_mul_f16 v25, v26, v27
v_exp_f16_sdwa v113, v113 dst_sel:WORD_0 dst_unused:UNUSED_PRESERVE src0_sel:WORD_0
v_lshl_add_u64 v[56:57], v[56:57], 0, v[58:59]
v_mfma_f32_16x16x32_bf16 v[200:203], v[120:123], v[192:195], v[200:203]
ds_read_u16_d16_hi v102, v102
ds_read_u16 v100, v100
v_mfma_f32_16x16x32_f16 v[8:11], v[124:127], v[4:7], v[8:11]
ds_read_b128 v[120:123], v249 offset:22784
v_exp_f16_sdwa v115, v115 dst_sel:WORD_0 dst_unused:UNUSED_PRESERVE src0_sel:WORD_0
v_and_b32_sdwa v103, s47, v101 dst_sel:DWORD dst_unused:UNUSED_PAD src0_sel:DWORD src1_sel:WORD_1
v_and_b32_e64 v101, s47, v101
v_mfma_f32_16x16x32_bf16 v[64:67], v[184:187], v[44:47], v[64:67]
ds_read_u16_d16_hi v103, v103
ds_read_u16 v101, v101
v_mfma_f32_16x16x32_f16 v[220:223], v[124:127], v[32:35], v[220:223]
v_exp_f16_sdwa v113, v113 dst_sel:WORD_1 dst_unused:UNUSED_PRESERVE src0_sel:WORD_1
v_mfma_f32_16x16x32_bf16 v[140:143], v[184:187], v[144:147], v[140:143]
ds_read_b128 v[124:127], v251 offset:56320
v_lshl_add_u64 v[60:61], v[60:61], 0, v[62:63]
v_mfma_f32_16x16x32_f16 v[12:15], v[176:179], v[132:135], v[12:15]
v_exp_f16_sdwa v115, v115 dst_sel:WORD_1 dst_unused:UNUSED_PRESERVE src0_sel:WORD_1
v_mfma_f32_16x16x32_bf16 v[200:203], v[184:187], v[148:151], v[200:203]
v_pk_add_f16 v113, v113, 1.0 op_sel_hi:[1,0]
v_pk_add_f16 v115, v115, 1.0 op_sel_hi:[1,0]
v_mfma_f32_16x16x32_f16 v[96:99], v[176:179], v[4:7], v[96:99]
ds_read_b128 v[184:187], v249 offset:24576
v_rcp_f16_sdwa v113, v113 dst_sel:WORD_0 dst_unused:UNUSED_PRESERVE src0_sel:WORD_0
v_mfma_f32_16x16x32_bf16 v[68:71], v[188:191], v[28:31], 0
v_rcp_f16_sdwa v115, v115 dst_sel:WORD_0 dst_unused:UNUSED_PRESERVE src0_sel:WORD_0
v_mfma_f32_16x16x32_f16 v[84:87], v[176:179], v[32:35], v[84:87]
ds_read_b128 v[176:179], v251 offset:57344
v_cvt_pkrtz_f16_f32 v64, v64, v65
v_mfma_f32_16x16x32_bf16 v[172:175], v[188:191], v[128:131], 0
s_setprio 0
v_cvt_pkrtz_f16_f32 v65, v66, v67
v_lshrrev_b64 v[64:65], 2, v[64:65]
s_waitcnt lgkmcnt(4)
v_mfma_f32_16x16x32_f16 v[208:211], v[160:163], v[132:135], v[208:211]
v_and_b32_sdwa v66, s47, v64 dst_sel:DWORD dst_unused:UNUSED_PAD src0_sel:DWORD src1_sel:WORD_1
v_and_b32_e64 v64, s47, v64
v_mfma_f32_16x16x32_bf16 v[156:159], v[188:191], v[136:139], 0
ds_read_u16_d16_hi v66, v66
ds_read_u16 v64, v64
v_rcp_f16_sdwa v113, v113 dst_sel:WORD_1 dst_unused:UNUSED_PRESERVE src0_sel:WORD_1
v_mfma_f32_16x16x32_f16 v[212:215], v[160:163], v[4:7], v[212:215]
ds_read_b128 v[188:191], v249 offset:26624
v_and_b32_sdwa v67, s47, v65 dst_sel:DWORD dst_unused:UNUSED_PAD src0_sel:DWORD src1_sel:WORD_1
v_and_b32_e64 v65, s47, v65
v_rcp_f16_sdwa v115, v115 dst_sel:WORD_1 dst_unused:UNUSED_PRESERVE src0_sel:WORD_1
v_mfma_f32_16x16x32_bf16 v[68:71], v[52:55], v[36:39], v[68:71]
ds_read_u16_d16_hi v67, v67
ds_read_u16 v65, v65
v_mfma_f32_16x16x32_f16 v[236:239], v[160:163], v[32:35], v[236:239]
v_cvt_pkrtz_f16_f32 v140, v140, v141
v_cvt_pkrtz_f16_f32 v141, v142, v143
v_lshrrev_b64 v[140:141], 2, v[140:141]
v_and_b32_sdwa v142, s47, v140 dst_sel:DWORD dst_unused:UNUSED_PAD src0_sel:DWORD src1_sel:WORD_1
v_and_b32_e64 v140, s47, v140
v_pk_mul_f16 v26, v112, v113
v_mfma_f32_16x16x32_bf16 v[172:175], v[52:55], v[108:111], v[172:175]
ds_read_u16_d16_hi v142, v142
ds_read_u16 v140, v140
ds_read_b128 v[160:163], v251 offset:60416
v_mfma_f32_16x16x32_f16 v[180:183], v[48:51], v[132:135], v[180:183]
v_and_b32_sdwa v143, s47, v141 dst_sel:DWORD dst_unused:UNUSED_PAD src0_sel:DWORD src1_sel:WORD_1
v_and_b32_e64 v141, s47, v141
v_pk_mul_f16 v27, v114, v115
v_lshl_add_u64 v[58:59], v[164:165], 0, v[166:167]
v_mfma_f32_16x16x32_bf16 v[156:159], v[52:55], v[192:195], v[156:159]
ds_read_u16_d16_hi v143, v143
ds_read_u16 v141, v141
v_cvt_pkrtz_f16_f32 v200, v200, v201
v_cvt_pkrtz_f16_f32 v201, v202, v203
v_lshrrev_b64 v[200:201], 2, v[200:201]
v_and_b32_sdwa v202, s47, v200 dst_sel:DWORD dst_unused:UNUSED_PAD src0_sel:DWORD src1_sel:WORD_1
v_and_b32 v200, s47, v200
v_mfma_f32_16x16x32_f16 v[196:199], v[48:51], v[4:7], v[196:199]
ds_read_u16_d16_hi v202, v202
s_waitcnt lgkmcnt(8)
ds_read_u16 v200, v200
ds_read_b128 v[52:55], v249 offset:28672
v_and_b32_sdwa v203, s47, v201 dst_sel:DWORD dst_unused:UNUSED_PAD src0_sel:DWORD src1_sel:WORD_1
v_and_b32_e64 v201, s47, v201
v_mfma_f32_16x16x32_bf16 v[68:71], v[120:123], v[44:47], v[68:71]
ds_read_u16_d16_hi v203, v203
ds_read_u16 v201, v201
v_mfma_f32_16x16x32_f16 v[92:95], v[48:51], v[32:35], v[92:95]
ds_read_b128 v[48:51], v251 offset:58368
s_setprio 3
v_lshl_add_u64 v[62:63], v[100:101], 0, v[102:103]
v_mfma_f32_16x16x32_bf16 v[172:175], v[120:123], v[144:147], v[172:175]
s_nop 0
v_cvt_pk_f16_f32 v68, v68, v69
v_mfma_f32_16x16x32_f16 v[216:219], v[124:127], v[132:135], v[216:219]
v_cvt_pk_f16_f32 v70, v70, v71
v_pk_fma_f16 v69, v68, v68, s48
v_mfma_f32_16x16x32_bf16 v[156:159], v[120:123], v[148:151], v[156:159]
ds_read_b128 v[120:123], v249 offset:24832
s_nop 0
v_cvt_pkrtz_f16_f32 v172, v172, v173
v_mfma_f32_16x16x32_f16 v[232:235], v[124:127], v[4:7], v[232:235]
v_cvt_pkrtz_f16_f32 v173, v174, v175
v_lshrrev_b64 v[172:173], 2, v[172:173]
v_mfma_f32_16x16x32_bf16 v[228:231], v[184:187], v[28:31], 0
v_and_b32_sdwa v174, s47, v172 dst_sel:DWORD dst_unused:UNUSED_PAD src0_sel:DWORD src1_sel:WORD_1
v_and_b32 v172, s47, v172
v_mfma_f32_16x16x32_f16 v[224:227], v[124:127], v[32:35], v[224:227]
ds_read_b128 v[124:127], v251 offset:61440
s_waitcnt lgkmcnt(8)
ds_read_u16_d16_hi v174, v174
s_waitcnt vmcnt(8)
v_mfma_f32_16x16x32_bf16 v[84:87], v[18:21], v[40:43], v[84:87]
ds_read_u16 v172, v172
v_and_b32_sdwa v175, s47, v173 dst_sel:DWORD dst_unused:UNUSED_PAD src0_sel:DWORD src1_sel:WORD_1
v_mfma_f32_16x16x32_bf16 v[236:239], v[16:19], v[40:43], v[236:239]
v_and_b32 v173, s47, v173
v_pk_fma_f16 v71, v70, v70, s48
s_waitcnt vmcnt(7)
v_mfma_f32_16x16x32_bf16 v[92:95], v[18:21], v[0:3], v[92:95]
ds_read_u16_d16_hi v175, v175
ds_read_u16 v173, v173
v_mfma_f32_16x16x32_bf16 v[224:227], v[16:19], v[0:3], v[224:227]
v_pk_mul_f16 v69, v68, v69
v_pk_mul_f16 v71, v70, v71
v_mfma_f32_16x16x32_bf16 v[152:155], v[184:187], v[128:131], 0
v_cvt_pkrtz_f16_f32 v156, v156, v157
v_cvt_pkrtz_f16_f32 v157, v158, v159
v_mfma_f32_16x16x32_f16 v[116:119], v[176:179], v[60:63], v[116:119]
v_lshrrev_b64 v[156:157], 2, v[156:157]
v_and_b32_sdwa v158, s47, v156 dst_sel:DWORD dst_unused:UNUSED_PAD src0_sel:DWORD src1_sel:WORD_1
v_mfma_f32_16x16x32_bf16 v[112:115], v[184:187], v[136:139], 0
ds_read_b128 v[184:187], v249 offset:26880
v_and_b32_e64 v156, s47, v156
v_mfma_f32_16x16x32_f16 v[240:243], v[176:179], v[56:59], v[240:243]
ds_read_u16_d16_hi v158, v158
ds_read_u16 v156, v156
v_mfma_f32_16x16x32_bf16 v[228:231], v[188:191], v[36:39], v[228:231]
v_lshl_add_u64 v[64:65], v[64:65], 0, v[66:67]
v_exp_f16_sdwa v69, v69 dst_sel:WORD_0 dst_unused:UNUSED_PRESERVE src0_sel:WORD_0
v_mfma_f32_16x16x32_f16 v[76:79], v[176:179], v[24:27], v[76:79]
s_waitcnt lgkmcnt(7)
ds_read_b128 v[176:179], v251 offset:59392
s_setprio 2
v_exp_f16_sdwa v71, v71 dst_sel:WORD_0 dst_unused:UNUSED_PRESERVE src0_sel:WORD_0
v_mfma_f32_16x16x32_bf16 v[152:155], v[188:191], v[108:111], v[152:155]
v_and_b32_sdwa v159, s47, v157 dst_sel:DWORD dst_unused:UNUSED_PAD src0_sel:DWORD src1_sel:WORD_1
v_and_b32_e64 v157, s47, v157
v_mfma_f32_16x16x32_f16 v[72:75], v[160:163], v[60:63], v[72:75]
ds_read_u16_d16_hi v159, v159
ds_read_u16 v157, v157
v_mfma_f32_16x16x32_bf16 v[112:115], v[188:191], v[192:195], v[112:115]
ds_read_b128 v[188:191], v249 offset:28928
v_lshl_add_u64 v[140:141], v[140:141], 0, v[142:143]
v_mfma_f32_16x16x32_f16 v[8:11], v[160:163], v[56:59], v[8:11]
v_exp_f16_sdwa v69, v69 dst_sel:WORD_1 dst_unused:UNUSED_PRESERVE src0_sel:WORD_1
v_mfma_f32_16x16x32_bf16 v[228:231], v[52:55], v[44:47], v[228:231]
v_exp_f16_sdwa v71, v71 dst_sel:WORD_1 dst_unused:UNUSED_PRESERVE src0_sel:WORD_1
v_mfma_f32_16x16x32_f16 v[220:223], v[160:163], v[24:27], v[220:223]
ds_read_b128 v[160:163], v251 offset:62464
v_lshl_add_u64 v[200:201], v[200:201], 0, v[202:203]
v_mfma_f32_16x16x32_bf16 v[152:155], v[52:55], v[144:147], v[152:155]
v_pk_add_f16 v69, v69, 1.0 op_sel_hi:[1,0]
v_pk_add_f16 v71, v71, 1.0 op_sel_hi:[1,0]
v_mfma_f32_16x16x32_f16 v[12:15], v[48:51], v[60:63], v[12:15]
v_rcp_f16_sdwa v69, v69 dst_sel:WORD_0 dst_unused:UNUSED_PRESERVE src0_sel:WORD_0
v_mfma_f32_16x16x32_bf16 v[112:115], v[52:55], v[148:151], v[112:115]
ds_read_b128 v[52:55], v249 offset:30720
v_rcp_f16_sdwa v71, v71 dst_sel:WORD_0 dst_unused:UNUSED_PRESERVE src0_sel:WORD_0
v_mfma_f32_16x16x32_f16 v[96:99], v[48:51], v[56:59], v[96:99]
v_cvt_pkrtz_f16_f32 v152, v152, v153
v_cvt_pkrtz_f16_f32 v153, v154, v155
v_mfma_f32_16x16x32_bf16 v[164:167], v[120:123], v[28:31], 0
v_lshrrev_b64 v[152:153], 2, v[152:153]
v_and_b32_sdwa v154, s47, v152 dst_sel:DWORD dst_unused:UNUSED_PAD src0_sel:DWORD src1_sel:WORD_1
v_mfma_f32_16x16x32_f16 v[84:87], v[48:51], v[24:27], v[84:87]
ds_read_b128 v[48:51], v251 offset:63488
s_setprio 1
v_and_b32_e64 v152, s47, v152
v_mfma_f32_16x16x32_bf16 v[100:103], v[120:123], v[128:131], 0
ds_read_u16_d16_hi v154, v154
s_waitcnt lgkmcnt(5)
ds_read_u16 v152, v152
v_mfma_f32_16x16x32_f16 v[208:211], v[124:127], v[60:63], v[208:211]
v_cvt_pk_f16_f32 v228, v228, v229
v_rcp_f16_sdwa v69, v69 dst_sel:WORD_1 dst_unused:UNUSED_PRESERVE src0_sel:WORD_1
v_mfma_f32_16x16x32_bf16 v[32:35], v[120:123], v[136:139], 0
v_cvt_pk_f16_f32 v230, v230, v231
v_pk_fma_f16 v229, v228, v228, s48
v_mfma_f32_16x16x32_f16 v[212:215], v[124:127], v[56:59], v[212:215]
ds_read_b128 v[120:123], v249 offset:32768
v_rcp_f16_sdwa v71, v71 dst_sel:WORD_1 dst_unused:UNUSED_PRESERVE src0_sel:WORD_1
v_mfma_f32_16x16x32_bf16 v[164:167], v[184:187], v[36:39], v[164:167]
v_and_b32_sdwa v155, s47, v153 dst_sel:DWORD dst_unused:UNUSED_PAD src0_sel:DWORD src1_sel:WORD_1
v_and_b32_e64 v153, s47, v153
v_pk_fma_f16 v231, v230, v230, s48
v_mfma_f32_16x16x32_f16 v[236:239], v[124:127], v[24:27], v[236:239]
ds_read_u16_d16_hi v155, v155
ds_read_u16 v153, v153
ds_read_b128 v[124:127], v252 offset:1024
v_pk_mul_f16 v229, v228, v229
v_pk_mul_f16 v66, v68, v69
v_mfma_f32_16x16x32_bf16 v[100:103], v[184:187], v[108:111], v[100:103]
v_pk_mul_f16 v231, v230, v231
v_cvt_pkrtz_f16_f32 v112, v112, v113
v_mfma_f32_16x16x32_f16 v[180:183], v[176:179], v[60:63], v[180:183]
v_cvt_pkrtz_f16_f32 v113, v114, v115
v_lshrrev_b64 v[112:113], 2, v[112:113]
v_and_b32_sdwa v114, s47, v112 dst_sel:DWORD dst_unused:UNUSED_PAD src0_sel:DWORD src1_sel:WORD_1
v_and_b32_e64 v112, s47, v112
v_pk_mul_f16 v67, v70, v71
v_exp_f16_sdwa v229, v229 dst_sel:WORD_0 dst_unused:UNUSED_PRESERVE src0_sel:WORD_0
v_lshl_add_u64 v[142:143], v[172:173], 0, v[174:175]
v_mfma_f32_16x16x32_bf16 v[32:35], v[184:187], v[192:195], v[32:35]
ds_read_u16_d16_hi v114, v114
ds_read_u16 v112, v112
v_mfma_f32_16x16x32_f16 v[196:199], v[176:179], v[56:59], v[196:199]
ds_read_b128 v[184:187], v249 offset:34816
v_exp_f16_sdwa v231, v231 dst_sel:WORD_0 dst_unused:UNUSED_PRESERVE src0_sel:WORD_0
v_and_b32_sdwa v115, s47, v113 dst_sel:DWORD dst_unused:UNUSED_PAD src0_sel:DWORD src1_sel:WORD_1
v_and_b32_e64 v113, s47, v113
s_waitcnt lgkmcnt(6)
v_mfma_f32_16x16x32_bf16 v[164:167], v[188:191], v[44:47], v[164:167]
ds_read_u16_d16_hi v115, v115
ds_read_u16 v113, v113
v_mfma_f32_16x16x32_f16 v[92:95], v[176:179], v[24:27], v[92:95]
v_exp_f16_sdwa v229, v229 dst_sel:WORD_1 dst_unused:UNUSED_PRESERVE src0_sel:WORD_1
s_setprio 0
ds_read_b128 v[176:179], v251 offset:64512
v_mfma_f32_16x16x32_bf16 v[100:103], v[188:191], v[144:147], v[100:103]
v_lshl_add_u64 v[202:203], v[156:157], 0, v[158:159]
v_exp_f16_sdwa v231, v231 dst_sel:WORD_1 dst_unused:UNUSED_PRESERVE src0_sel:WORD_1
v_mfma_f32_16x16x32_f16 v[216:219], v[160:163], v[60:63], v[216:219]
v_pk_add_f16 v229, v229, 1.0 op_sel_hi:[1,0]
v_pk_add_f16 v231, v231, 1.0 op_sel_hi:[1,0]
v_mfma_f32_16x16x32_bf16 v[32:35], v[188:191], v[148:151], v[32:35]
ds_read_b128 v[188:191], v249 offset:30976
v_rcp_f16_sdwa v229, v229 dst_sel:WORD_0 dst_unused:UNUSED_PRESERVE src0_sel:WORD_0
v_mfma_f32_16x16x32_f16 v[232:235], v[160:163], v[56:59], v[232:235]
v_rcp_f16_sdwa v231, v231 dst_sel:WORD_0 dst_unused:UNUSED_PRESERVE src0_sel:WORD_0
v_mfma_f32_16x16x32_bf16 v[4:7], v[52:55], v[28:31], 0
v_cvt_pkrtz_f16_f32 v164, v164, v165
v_cvt_pkrtz_f16_f32 v165, v166, v167
v_mfma_f32_16x16x32_f16 v[224:227], v[160:163], v[24:27], v[224:227]
ds_read_b128 v[160:163], v252 offset:2048
v_lshrrev_b64 v[164:165], 2, v[164:165]
s_waitcnt vmcnt(5)
v_mfma_f32_16x16x32_bf16 v[240:243], v[18:21], v[244:247], v[240:243]
v_and_b32_sdwa v166, s47, v164 dst_sel:DWORD dst_unused:UNUSED_PAD src0_sel:DWORD src1_sel:WORD_1
v_and_b32_e64 v164, s47, v164
v_mfma_f32_16x16x32_bf16 v[8:11], v[16:19], v[244:247], v[8:11]
ds_read_u16_d16_hi v166, v166
ds_read_u16 v164, v164
s_waitcnt vmcnt(4)
v_mfma_f32_16x16x32_bf16 v[96:99], v[18:21], v[168:171], v[96:99]
v_rcp_f16_sdwa v229, v229 dst_sel:WORD_1 dst_unused:UNUSED_PRESERVE src0_sel:WORD_1
v_mfma_f32_16x16x32_bf16 v[212:215], v[16:19], v[168:171], v[212:215]
v_and_b32_sdwa v167, s47, v165 dst_sel:DWORD dst_unused:UNUSED_PAD src0_sel:DWORD src1_sel:WORD_1
v_and_b32 v165, s47, v165
v_mfma_f32_16x16x32_bf16 v[132:135], v[52:55], v[128:131], 0
ds_read_u16_d16_hi v167, v167
ds_read_u16 v165, v165
v_mfma_f32_16x16x32_f16 v[116:119], v[48:51], v[200:203], v[116:119]
v_rcp_f16_sdwa v231, v231 dst_sel:WORD_1 dst_unused:UNUSED_PRESERVE src0_sel:WORD_1
v_mfma_f32_16x16x32_bf16 v[40:43], v[52:55], v[136:139], 0
s_waitcnt lgkmcnt(5)
ds_read_b128 v[52:55], v249 offset:33024
v_cvt_pkrtz_f16_f32 v100, v100, v101
v_mfma_f32_16x16x32_f16 v[240:243], v[48:51], v[140:143], v[240:243]
v_cvt_pkrtz_f16_f32 v101, v102, v103
v_lshrrev_b64 v[100:101], 2, v[100:101]
v_mfma_f32_16x16x32_bf16 v[4:7], v[120:123], v[36:39], v[4:7]
v_and_b32_sdwa v102, s47, v100 dst_sel:DWORD dst_unused:UNUSED_PAD src0_sel:DWORD src1_sel:WORD_1
v_and_b32 v100, s47, v100
v_mfma_f32_16x16x32_f16 v[76:79], v[48:51], v[64:67], v[76:79]
s_setprio 3
ds_read_u16_d16_hi v102, v102
ds_read_u16 v100, v100
ds_read_b128 v[48:51], v252
v_pk_mul_f16 v228, v228, v229
v_mfma_f32_16x16x32_bf16 v[132:135], v[120:123], v[108:111], v[132:135]
v_and_b32_sdwa v103, s47, v101 dst_sel:DWORD dst_unused:UNUSED_PAD src0_sel:DWORD src1_sel:WORD_1
v_and_b32_e64 v101, s47, v101
v_mfma_f32_16x16x32_f16 v[72:75], v[124:127], v[200:203], v[72:75]
ds_read_u16_d16_hi v103, v103
ds_read_u16 v101, v101
v_pk_mul_f16 v229, v230, v231
v_lshl_add_u64 v[152:153], v[152:153], 0, v[154:155]
v_mfma_f32_16x16x32_bf16 v[40:43], v[120:123], v[192:195], v[40:43]
v_cvt_pkrtz_f16_f32 v32, v32, v33
v_cvt_pkrtz_f16_f32 v33, v34, v35
v_lshrrev_b64 v[32:33], 2, v[32:33]
v_and_b32_sdwa v34, s47, v32 dst_sel:DWORD dst_unused:UNUSED_PAD src0_sel:DWORD src1_sel:WORD_1
v_and_b32_e64 v32, s47, v32
v_mfma_f32_16x16x32_f16 v[8:11], v[124:127], v[140:143], v[8:11]
ds_read_u16_d16_hi v34, v34
ds_read_u16 v32, v32
ds_read_b128 v[120:123], v249 offset:35072
v_and_b32_sdwa v35, s47, v33 dst_sel:DWORD dst_unused:UNUSED_PAD src0_sel:DWORD src1_sel:WORD_1
v_and_b32 v33, s47, v33
v_mfma_f32_16x16x32_bf16 v[4:7], v[184:187], v[44:47], v[4:7]
ds_read_u16_d16_hi v35, v35
s_waitcnt lgkmcnt(9)
ds_read_u16 v33, v33
v_mfma_f32_16x16x32_f16 v[220:223], v[124:127], v[64:67], v[220:223]
ds_read_b128 v[124:127], v252 offset:3072
v_lshl_add_u64 v[112:113], v[112:113], 0, v[114:115]
v_mfma_f32_16x16x32_bf16 v[132:135], v[184:187], v[144:147], v[132:135]
s_nop 0
v_cvt_pk_f16_f32 v4, v4, v5
v_mfma_f32_16x16x32_f16 v[12:15], v[176:179], v[200:203], v[12:15]
v_cvt_pk_f16_f32 v6, v6, v7
v_pk_fma_f16 v5, v4, v4, s48
v_mfma_f32_16x16x32_bf16 v[40:43], v[184:187], v[148:151], v[40:43]
ds_read_b128 v[184:187], v252 offset:4096
s_nop 0
v_cvt_pkrtz_f16_f32 v132, v132, v133
v_mfma_f32_16x16x32_f16 v[96:99], v[176:179], v[140:143], v[96:99]
v_cvt_pkrtz_f16_f32 v133, v134, v135
v_lshrrev_b64 v[132:133], 2, v[132:133]
v_mfma_f32_16x16x32_bf16 v[0:3], v[188:191], v[28:31], 0
v_and_b32_sdwa v134, s47, v132 dst_sel:DWORD dst_unused:UNUSED_PAD src0_sel:DWORD src1_sel:WORD_1
v_and_b32 v132, s47, v132
v_mfma_f32_16x16x32_f16 v[84:87], v[176:179], v[64:67], v[84:87]
s_setprio 2
ds_read_u16_d16_hi v134, v134
ds_read_u16 v132, v132
v_mfma_f32_16x16x32_bf16 v[68:71], v[188:191], v[128:131], 0
v_and_b32_sdwa v135, s47, v133 dst_sel:DWORD dst_unused:UNUSED_PAD src0_sel:DWORD src1_sel:WORD_1
v_and_b32 v133, s47, v133
v_mfma_f32_16x16x32_f16 v[208:211], v[160:163], v[200:203], v[208:211]
ds_read_u16_d16_hi v135, v135
s_waitcnt lgkmcnt(8)
ds_read_u16 v133, v133
v_mfma_f32_16x16x32_bf16 v[172:175], v[188:191], v[136:139], 0
v_pk_fma_f16 v7, v6, v6, s48
v_pk_mul_f16 v5, v4, v5
v_mfma_f32_16x16x32_f16 v[212:215], v[160:163], v[140:143], v[212:215]
ds_read_b128 v[176:179], v252 offset:7168
v_pk_mul_f16 v7, v6, v7
v_mfma_f32_16x16x32_bf16 v[0:3], v[52:55], v[36:39], v[0:3]
v_cvt_pkrtz_f16_f32 v40, v40, v41
v_cvt_pkrtz_f16_f32 v41, v42, v43
v_mfma_f32_16x16x32_f16 v[236:239], v[160:163], v[64:67], v[236:239]
v_lshrrev_b64 v[40:41], 2, v[40:41]
v_and_b32_sdwa v42, s47, v40 dst_sel:DWORD dst_unused:UNUSED_PAD src0_sel:DWORD src1_sel:WORD_1
v_mfma_f32_16x16x32_bf16 v[68:71], v[52:55], v[108:111], v[68:71]
v_and_b32_e64 v40, s47, v40
v_lshl_add_u64 v[230:231], v[164:165], 0, v[166:167]
v_mfma_f32_16x16x32_f16 v[180:183], v[48:51], v[200:203], v[180:183]
ds_read_u16_d16_hi v42, v42
ds_read_u16 v40, v40
v_exp_f16_sdwa v5, v5 dst_sel:WORD_0 dst_unused:UNUSED_PRESERVE src0_sel:WORD_0
v_mfma_f32_16x16x32_bf16 v[172:175], v[52:55], v[192:195], v[172:175]
v_exp_f16_sdwa v7, v7 dst_sel:WORD_0 dst_unused:UNUSED_PRESERVE src0_sel:WORD_0
v_mfma_f32_16x16x32_f16 v[196:199], v[48:51], v[140:143], v[196:199]
v_and_b32_sdwa v43, s47, v41 dst_sel:DWORD dst_unused:UNUSED_PAD src0_sel:DWORD src1_sel:WORD_1
v_and_b32_e64 v41, s47, v41
s_waitcnt lgkmcnt(5)
v_mfma_f32_16x16x32_bf16 v[0:3], v[120:123], v[44:47], v[0:3]
ds_read_u16_d16_hi v43, v43
ds_read_u16 v41, v41
v_lshl_add_u64 v[154:155], v[100:101], 0, v[102:103]
s_setprio 1
v_mfma_f32_16x16x32_f16 v[92:95], v[48:51], v[64:67], v[92:95]
v_exp_f16_sdwa v5, v5 dst_sel:WORD_1 dst_unused:UNUSED_PRESERVE src0_sel:WORD_1
v_mfma_f32_16x16x32_bf16 v[68:71], v[120:123], v[144:147], v[68:71]
ds_read_b128 v[188:191], v252 offset:5120
v_exp_f16_sdwa v7, v7 dst_sel:WORD_1 dst_unused:UNUSED_PRESERVE src0_sel:WORD_1
v_mfma_f32_16x16x32_f16 v[216:219], v[124:127], v[200:203], v[216:219]
v_lshl_add_u64 v[114:115], v[32:33], 0, v[34:35]
v_pk_add_f16 v5, v5, 1.0 op_sel_hi:[1,0]
v_mfma_f32_16x16x32_bf16 v[172:175], v[120:123], v[148:151], v[172:175]
v_pk_add_f16 v7, v7, 1.0 op_sel_hi:[1,0]
v_rcp_f16_sdwa v5, v5 dst_sel:WORD_0 dst_unused:UNUSED_PRESERVE src0_sel:WORD_0
v_mfma_f32_16x16x32_f16 v[232:235], v[124:127], v[140:143], v[232:235]
ds_read_b128 v[160:163], v252 offset:8192
v_rcp_f16_sdwa v7, v7 dst_sel:WORD_0 dst_unused:UNUSED_PRESERVE src0_sel:WORD_0
v_mfma_f32_16x16x32_f16 v[224:227], v[124:127], v[64:67], v[224:227]
v_cvt_pkrtz_f16_f32 v68, v68, v69
v_cvt_pkrtz_f16_f32 v69, v70, v71
s_waitcnt vmcnt(3)
v_mfma_f32_16x16x32_bf16 v[196:199], v[18:21], v[104:107], v[196:199]
v_lshrrev_b64 v[68:69], 2, v[68:69]
v_and_b32_sdwa v70, s47, v68 dst_sel:DWORD dst_unused:UNUSED_PAD src0_sel:DWORD src1_sel:WORD_1
v_mfma_f32_16x16x32_bf16 v[232:235], v[16:19], v[104:107], v[232:235]
v_and_b32_e64 v68, s47, v68
v_cvt_pk_f16_f32 v0, v0, v1
s_waitcnt vmcnt(2)
v_mfma_f32_16x16x32_bf16 v[116:119], v[18:21], v[204:207], v[116:119]
ds_read_u16_d16_hi v70, v70
ds_read_u16 v68, v68
v_mfma_f32_16x16x32_bf16 v[72:75], v[16:19], v[204:207], v[72:75]
v_rcp_f16_sdwa v5, v5 dst_sel:WORD_1 dst_unused:UNUSED_PRESERVE src0_sel:WORD_1
v_mfma_f32_16x16x32_f16 v[116:119], v[184:187], v[112:115], v[116:119]
v_cvt_pk_f16_f32 v2, v2, v3
v_pk_fma_f16 v1, v0, v0, s48
v_mfma_f32_16x16x32_f16 v[240:243], v[184:187], v[152:155], v[240:243]
v_rcp_f16_sdwa v7, v7 dst_sel:WORD_1 dst_unused:UNUSED_PRESERVE src0_sel:WORD_1
s_setprio 0
v_and_b32_sdwa v71, s47, v69 dst_sel:DWORD dst_unused:UNUSED_PAD src0_sel:DWORD src1_sel:WORD_1
v_and_b32 v69, s47, v69
v_pk_fma_f16 v3, v2, v2, s48
v_mfma_f32_16x16x32_f16 v[76:79], v[184:187], v[228:231], v[76:79]
ds_read_u16_d16_hi v71, v71
ds_read_u16 v69, v69
ds_read_b128 v[52:55], v252 offset:6144
v_pk_mul_f16 v1, v0, v1
v_pk_mul_f16 v4, v4, v5
v_pk_mul_f16 v3, v2, v3
s_waitcnt lgkmcnt(5)
v_mfma_f32_16x16x32_f16 v[72:75], v[176:179], v[112:115], v[72:75]
v_cvt_pkrtz_f16_f32 v172, v172, v173
v_cvt_pkrtz_f16_f32 v173, v174, v175
v_lshrrev_b64 v[172:173], 2, v[172:173]
v_and_b32_sdwa v174, s47, v172 dst_sel:DWORD dst_unused:UNUSED_PAD src0_sel:DWORD src1_sel:WORD_1
v_and_b32 v172, s47, v172
v_pk_mul_f16 v5, v6, v7
v_exp_f16_sdwa v1, v1 dst_sel:WORD_0 dst_unused:UNUSED_PRESERVE src0_sel:WORD_0
v_lshl_add_u64 v[132:133], v[132:133], 0, v[134:135]
v_mfma_f32_16x16x32_f16 v[8:11], v[176:179], v[152:155], v[8:11]
ds_read_u16_d16_hi v174, v174
ds_read_u16 v172, v172
v_exp_f16_sdwa v3, v3 dst_sel:WORD_0 dst_unused:UNUSED_PRESERVE src0_sel:WORD_0
v_and_b32_sdwa v175, s47, v173 dst_sel:DWORD dst_unused:UNUSED_PAD src0_sel:DWORD src1_sel:WORD_1
v_and_b32 v173, s47, v173
v_mfma_f32_16x16x32_f16 v[220:223], v[176:179], v[228:231], v[220:223]
ds_read_u16_d16_hi v175, v175
ds_read_u16 v173, v173
v_exp_f16_sdwa v1, v1 dst_sel:WORD_1 dst_unused:UNUSED_PRESERVE src0_sel:WORD_1
v_mfma_f32_16x16x32_f16 v[12:15], v[188:191], v[112:115], v[12:15]
ds_read_b128 v[48:51], v252 offset:9216
v_lshl_add_u64 v[40:41], v[40:41], 0, v[42:43]
v_exp_f16_sdwa v3, v3 dst_sel:WORD_1 dst_unused:UNUSED_PRESERVE src0_sel:WORD_1
v_mfma_f32_16x16x32_f16 v[96:99], v[188:191], v[152:155], v[96:99]
v_pk_add_f16 v1, v1, 1.0 op_sel_hi:[1,0]
v_pk_add_f16 v3, v3, 1.0 op_sel_hi:[1,0]
s_setprio 3
v_rcp_f16_sdwa v1, v1 dst_sel:WORD_0 dst_unused:UNUSED_PRESERVE src0_sel:WORD_0
v_mfma_f32_16x16x32_f16 v[84:87], v[188:191], v[228:231], v[84:87]
ds_read_b128 v[120:123], v252 offset:10240
v_rcp_f16_sdwa v3, v3 dst_sel:WORD_0 dst_unused:UNUSED_PRESERVE src0_sel:WORD_0
v_mfma_f32_16x16x32_f16 v[208:211], v[160:163], v[112:115], v[208:211]
ds_read_b128 v[124:127], v252 offset:13312
v_rcp_f16_sdwa v1, v1 dst_sel:WORD_1 dst_unused:UNUSED_PRESERVE src0_sel:WORD_1
v_mfma_f32_16x16x32_f16 v[212:215], v[160:163], v[152:155], v[212:215]
v_rcp_f16_sdwa v3, v3 dst_sel:WORD_1 dst_unused:UNUSED_PRESERVE src0_sel:WORD_1
v_mfma_f32_16x16x32_f16 v[236:239], v[160:163], v[228:231], v[236:239]
ds_read_b128 v[184:187], v252 offset:11264
v_pk_mul_f16 v6, v0, v1
s_waitcnt lgkmcnt(6)
v_mfma_f32_16x16x32_f16 v[180:183], v[52:55], v[112:115], v[180:183]
v_pk_mul_f16 v7, v2, v3
v_lshl_add_u64 v[134:135], v[68:69], 0, v[70:71]
v_mfma_f32_16x16x32_f16 v[196:199], v[52:55], v[152:155], v[196:199]
ds_read_b128 v[176:179], v252 offset:14336
s_setprio 2
ds_read_b128 v[188:191], v252 offset:12288
v_mfma_f32_16x16x32_f16 v[92:95], v[52:55], v[228:231], v[92:95]
s_waitcnt lgkmcnt(5)
v_lshl_add_u64 v[42:43], v[172:173], 0, v[174:175]
ds_read_b128 v[160:163], v252 offset:15360
v_mfma_f32_16x16x32_f16 v[216:219], v[48:51], v[112:115], v[216:219]
v_mfma_f32_16x16x32_f16 v[232:235], v[48:51], v[152:155], v[232:235]
v_mfma_f32_16x16x32_f16 v[224:227], v[48:51], v[228:231], v[224:227]
s_waitcnt vmcnt(1)
v_mfma_f32_16x16x32_bf16 v[12:15], v[18:21], v[80:83], v[12:15]
v_mfma_f32_16x16x32_bf16 v[208:211], v[16:19], v[80:83], v[208:211]
s_waitcnt vmcnt(0)
v_mfma_f32_16x16x32_bf16 v[180:183], v[18:21], v[88:91], v[180:183]
v_mfma_f32_16x16x32_bf16 v[216:219], v[16:19], v[88:91], v[216:219]
s_waitcnt lgkmcnt(2)
v_mfma_f32_16x16x32_f16 v[116:119], v[120:123], v[40:43], v[116:119]
v_mfma_f32_16x16x32_f16 v[240:243], v[120:123], v[132:135], v[240:243]
v_mfma_f32_16x16x32_f16 v[76:79], v[120:123], v[4:7], v[76:79]
s_nop 5
v_cvt_pk_bf16_f32 v116, v116, v117
v_mfma_f32_16x16x32_f16 v[72:75], v[124:127], v[40:43], v[72:75]
s_setprio 1
v_cvt_pk_bf16_f32 v117, v118, v119
v_cvt_pk_bf16_f32 v240, v240, v241
v_mfma_f32_16x16x32_f16 v[8:11], v[124:127], v[132:135], v[8:11]
v_cvt_pk_bf16_f32 v76, v76, v77
v_cvt_pk_bf16_f32 v77, v78, v79
v_mfma_f32_16x16x32_f16 v[220:223], v[124:127], v[4:7], v[220:223]
v_cvt_pk_bf16_f32 v241, v242, v243
v_cvt_pk_bf16_f32 v118, v72, v73
v_mfma_f32_16x16x32_f16 v[12:15], v[184:187], v[40:43], v[12:15]
s_nop 1
v_cvt_pk_bf16_f32 v242, v8, v9
v_cvt_pk_bf16_f32 v243, v10, v11
v_mfma_f32_16x16x32_f16 v[96:99], v[184:187], v[132:135], v[96:99]
v_cvt_pk_bf16_f32 v78, v220, v221
v_cvt_pk_bf16_f32 v79, v222, v223
v_mfma_f32_16x16x32_f16 v[84:87], v[184:187], v[4:7], v[84:87]
v_cvt_pk_bf16_f32 v119, v74, v75
v_cvt_pk_bf16_f32 v12, v12, v13
v_mfma_f32_16x16x32_f16 v[208:211], v[176:179], v[40:43], v[208:211]
s_nop 1
v_cvt_pk_bf16_f32 v96, v96, v97
v_cvt_pk_bf16_f32 v97, v98, v99
v_mfma_f32_16x16x32_f16 v[212:215], v[176:179], v[132:135], v[212:215]
v_cvt_pk_bf16_f32 v84, v84, v85
v_cvt_pk_bf16_f32 v85, v86, v87
v_mfma_f32_16x16x32_f16 v[236:239], v[176:179], v[4:7], v[236:239]
v_cvt_pk_bf16_f32 v13, v14, v15
v_cvt_pk_bf16_f32 v14, v208, v209
v_cvt_pk_bf16_f32 v15, v210, v211
s_waitcnt lgkmcnt(0)
v_mfma_f32_16x16x32_f16 v[180:183], v[188:191], v[40:43], v[180:183]
v_cvt_pk_bf16_f32 v98, v212, v213
v_cvt_pk_bf16_f32 v99, v214, v215
v_mfma_f32_16x16x32_f16 v[196:199], v[188:191], v[132:135], v[196:199]
v_cvt_pk_bf16_f32 v86, v236, v237
v_cvt_pk_bf16_f32 v87, v238, v239
v_mfma_f32_16x16x32_f16 v[92:95], v[188:191], v[4:7], v[92:95]
s_nop 1
v_cvt_pk_bf16_f32 v180, v180, v181
v_cvt_pk_bf16_f32 v181, v182, v183
v_mfma_f32_16x16x32_f16 v[216:219], v[160:163], v[40:43], v[216:219]
v_cvt_pk_bf16_f32 v196, v196, v197
v_cvt_pk_bf16_f32 v197, v198, v199
v_mfma_f32_16x16x32_f16 v[232:235], v[160:163], v[132:135], v[232:235]
v_cvt_pk_bf16_f32 v92, v92, v93
v_cvt_pk_bf16_f32 v93, v94, v95
s_setprio 0
v_mfma_f32_16x16x32_f16 v[224:227], v[160:163], v[4:7], v[224:227]
s_nop 0
v_cvt_pk_bf16_f32 v182, v216, v217
v_cvt_pk_bf16_f32 v183, v218, v219
s_nop 0
v_cvt_pk_bf16_f32 v198, v232, v233
v_cvt_pk_bf16_f32 v199, v234, v235
s_nop 1
v_cvt_pk_bf16_f32 v94, v224, v225
v_cvt_pk_bf16_f32 v95, v226, v227
buffer_store_dwordx4 v[76:79], v253, s[8:11], s69 offen offset:192 sc1
buffer_store_dwordx4 v[84:87], v253, s[8:11], s69 offen offset:256 sc1
buffer_store_dwordx4 v[92:95], v253, s[8:11], s69 offen offset:320 sc1
buffer_store_dwordx4 v[240:243], v253, s[8:11], s68 offen sc1
buffer_store_dwordx4 v[96:99], v253, s[8:11], s68 offen offset:64 sc1
buffer_store_dwordx4 v[196:199], v253, s[8:11], s68 offen offset:128 sc1
buffer_store_dwordx4 v[116:119], v253, s[8:11], s68 offen offset:192 sc1
buffer_store_dwordx4 v[12:15], v253, s[8:11], s68 offen offset:256 sc1
buffer_store_dwordx4 v[180:183], v253, s[8:11], s68 offen offset:320 sc1
s_endpgm
Lpolln:
s_getreg_b32 s43, hwreg(HW_REG_IB_STS, 0, 4)
s_cmp_eq_u32 s43, 0
s_cbranch_scc1 Lpoll
s_setpc_b64 s[78:79]
Lpoll:
s_waitcnt vmcnt(0)
s_cmp_eq_u32 s77, 2
s_cbranch_scc1 LpollC
v_max_u32 v241, v128, v129
v_max3_u32 v241, v241, v130, v131
v_max3_u32 v241, v241, v132, v133
v_max3_u32 v241, v241, v134, v135
v_max3_u32 v241, v241, v136, v137
v_max3_u32 v241, v241, v138, v139
v_max3_u32 v241, v241, v140, v141
v_max3_u32 v241, v241, v142, v143
v_cmp_eq_u32 vcc, -1, v241
s_nop 4
s_cbranch_vccz LpollR
s_lshl_b32 s44, s2, 12
buffer_load_dwordx4 v[128:131], v245, s[32:35], s44 offen sc1
buffer_load_dwordx4 v[132:135], v245, s[32:35], s44 offen offset:1024 sc1
buffer_load_dwordx4 v[136:139], v245, s[32:35], s44 offen offset:2048 sc1
buffer_load_dwordx4 v[140:143], v245, s[32:35], s44 offen offset:3072 sc1
s_setpc_b64 s[78:79]
LpollR:
v_add_f32 v128, v128, v132
v_add_f32 v140, v136, v140
v_add_f32 v140, v128, v140
v_add_f32 v129, v129, v133
v_add_f32 v141, v137, v141
v_add_f32 v141, v129, v141
v_add_f32 v130, v130, v134
v_add_f32 v142, v138, v142
v_add_f32 v142, v130, v142
v_add_f32 v131, v131, v135
v_add_f32 v143, v139, v143
v_add_f32 v143, v131, v143
v_permlane32_swap_b32 v140, v141
s_nop 0
v_permlane32_swap_b32 v142, v143
v_add_f32 v140, v140, v141
v_add_f32_e64 v142, v142, v143
v_bfe_u32 v241, v245, 4, 4
v_lshlrev_b32 v241, 11, v241
v_permlane16_swap_b32 v140, v142
v_add_f32 v140, v140, v142
v_bfe_u32 v242, v245, 8, 1
v_lshl_add_u32 v241, v242, 3, v241
v_add_f32_dpp v140, v140, v140 row_ror:8 row_mask:0xf bank_mask:0xf
v_bfe_u32 v242, v245, 9, 1
v_lshl_add_u32 v241, v242, 2, v241
v_add_f32_dpp v140, v140, v140 row_ror:4 row_mask:0xf bank_mask:0xf
s_lshl_b32 s44, s2, 4
s_add_u32 s44, s44, 393216
v_add_f32_dpp v140, v140, v140 row_ror:2 row_mask:0xf bank_mask:0xf
s_mov_b32 s43, 1083289508
v_mov_b32 v242, 897988541
v_add_f32_dpp v140, v140, v140 row_ror:1 row_mask:0xf bank_mask:0xf
v_fma_f32 v140, v140, s43, v242
v_sqrt_f32_e64 v140, v140
s_mov_b32 exec_lo, 16711935
s_mov_b32 exec_hi, 16711935
v_min_u32_e64 v140, -2, v140
buffer_store_dword v140, v241, s[32:35], s44 offen sc1
s_mov_b64 exec, -1
s_mov_b32 s77, 2
s_and_b32 s44, s2, 7
s_lshl_b32 s44, s44, 11
s_add_u32 s44, s44, 393216
buffer_load_dwordx2 v[128:129], v240, s[32:35], s44 offen sc1
buffer_load_dwordx2 v[130:131], v240, s[32:35], s44 offen offset:8 sc1
buffer_load_dwordx2 v[132:133], v240, s[32:35], s44 offen offset:16 sc1
v_lshrrev_b32 v241, 1, v240
buffer_load_dword v135, v241, s[24:27], 0 offen
buffer_load_dword v137, v241, s[24:27], 0 offen offset:4
buffer_load_dword v139, v241, s[24:27], 0 offen offset:8
s_setpc_b64 s[78:79]
LpollC:
v_max3_u32 v241, v128, v129, v130
v_max3_u32 v241, v241, v131, v132
v_max_u32 v241, v241, v133
v_cmp_eq_u32 vcc, -1, v241
s_nop 4
s_cbranch_vccz LpollS
s_and_b32 s44, s2, 7
s_lshl_b32 s44, s44, 11
s_add_u32 s44, s44, 393216
buffer_load_dwordx2 v[128:129], v240, s[32:35], s44 offen sc1
buffer_load_dwordx2 v[130:131], v240, s[32:35], s44 offen offset:8 sc1
buffer_load_dwordx2 v[132:133], v240, s[32:35], s44 offen offset:16 sc1
s_setpc_b64 s[78:79]
LpollS:
v_add_f32 v243, v128, v129
v_add_f32 v243, v243, v130
v_add_f32 v243, v243, v131
v_add_f32 v243, v243, v132
v_add_f32 v243, v243, v133
v_lshlrev_b32_e64 v134, 16, v135
v_and_b32 v135, 4294901760, v135
v_add_f32_dpp v243, v243, v243 row_ror:8 row_mask:0xf bank_mask:0xf
v_lshlrev_b32_e64 v136, 16, v137
v_and_b32 v137, 4294901760, v137
v_add_f32_dpp v243, v243, v243 row_ror:4 row_mask:0xf bank_mask:0xf
v_lshlrev_b32_e64 v138, 16, v139
v_and_b32 v139, 4294901760, v139
v_add_f32_dpp v243, v243, v243 row_ror:2 row_mask:0xf bank_mask:0xf
v_mul_f32 v128, v128, v134
v_mul_f32 v129, v129, v135
v_add_f32_dpp v243, v243, v243 row_ror:1 row_mask:0xf bank_mask:0xf
v_mov_b32 v241, v243
v_mul_f32 v130, v130, v136
v_mul_f32 v131, v131, v137
v_permlane16_swap_b32 v243, v241
v_add_f32 v243, v243, v241
v_mov_b32 v241, v243
v_mul_f32 v132, v132, v138
v_mul_f32 v133, v133, v139
v_permlane32_swap_b32 v243, v241
v_add_f32 v243, v243, v241
v_mov_b32 v242, 3036348137
s_mov_b32 s43, 3131020332
v_fma_f32 v243, v243, s43, v242
v_rcp_f32_e64 v243, v243
s_mov_b32 s43, 3221808330
v_fma_f32 v128, v128, v243, s43
v_fma_f32 v129, v129, v243, s43
v_fma_f32 v130, v130, v243, s43
v_fma_f32 v131, v131, v243, s43
v_fma_f32 v132, v132, v243, s43
v_fma_f32 v133, v133, v243, s43
v_cvt_pk_f16_f32 v128, v128, v129
v_cvt_pk_f16_f32 v129, v130, v131
v_cvt_pk_f16_f32 v130, v132, v133
s_mov_b32 s77, 0
s_nop 1
s_setpc_b64 s[78:79]
Lend:
s_endpgm

.section .rodata,"a"
.p2align 6
.amdhsa_kernel standalone__modern_conv_block_convnext_v2__vision_kernel
  .amdhsa_next_free_vgpr 256
  .amdhsa_next_free_sgpr 102
  .amdhsa_accum_offset 256
  .amdhsa_group_segment_fixed_size 0
  .amdhsa_kernarg_size 72
  .amdhsa_user_sgpr_count 2
  .amdhsa_user_sgpr_kernarg_segment_ptr 1
  .amdhsa_system_sgpr_workgroup_id_x 1
.end_amdhsa_kernel
```

```asm
; @launch grid=(256,1,1) block=(512,1,1) lds=163840
.amdgcn_target "amdgcn-amd-amdhsa--gfx950"
.text
.globl standalone__modern_conv_block_convnext_v2__vision_kernel
.p2align 8
.type standalone__modern_conv_block_convnext_v2__vision_kernel,@function
standalone__modern_conv_block_convnext_v2__vision_kernel:
s_cmp_ge_u32 s2, 256
s_cbranch_scc1 Lend
s_load_dwordx16 s[80:95], s[0:1], 0
s_load_dwordx2 s[96:97], s[0:1], 64
v_mov_b32 v119, v0
v_and_b32 v118, 63, v0
v_lshrrev_b32 v120, 6, v0
s_nop 0
v_readfirstlane_b32 s40, v120
s_getpc_b64 s[74:75]
Lpc:
s_lshr_b32 s43, s2, 3
s_and_b32 s43, s43, 15
s_lshl_b32 s43, s43, 13
v_lshrrev_b32_e64 v122, 3, v0
v_lshl_add_u32 v122, v122, 7, s43
v_min_u32 v122, Lend-Lpc, v122
global_load_dword v112, v122, s[74:75]
s_and_b32 s43, s2, 7
s_lshr_b32 s44, s2, 3
s_and_b32 s41, s43, 3
s_lshl_b32 s41, s41, 2
s_and_b32 s45, s44, 3
s_add_u32 s41, s41, s45
s_lshr_b32 s42, s43, 2
s_lshl_b32 s42, s42, 3
s_lshr_b32 s45, s44, 2
s_add_u32 s42, s42, s45
s_lshl_b32 s41, s41, 5
s_lshl_b32 s42, s42, 5
s_and_b32 s43, s40, 3
s_mul_i32 s43, s43, 1536
s_add_u32 s67, s43, 90112
s_mul_i32 s44, s41, 192
s_add_u32 s43, s43, s44
s_sub_u32 s43, s43, 192
v_lshl_add_u32 v121, v118, 4, s43
v_add_u32 v123, 896, v121
v_mov_b32 v122, 2147483648
s_mov_b32 s44, 98304
v_cmp_gt_u32 vcc, s44, v121
s_nop 1
v_cndmask_b32 v236, v122, v121, vcc
v_cmp_gt_u32 vcc, s44, v123
s_nop 1
v_cndmask_b32 v237, v122, v123, vcc
s_mul_i32 s66, s42, 98304
v_min_u32 v128, 215, v119
v_lshlrev_b32_e64 v130, 3, v128
v_lshlrev_b32 v250, 4, v118
s_waitcnt lgkmcnt(0)
s_mov_b32 s4, s80
s_and_b32 s5, s81, 65535
s_mov_b32 s6, 50331648
s_mov_b32 s7, 131072
s_cmp_ge_u32 s40, 4
s_cbranch_scc1 Lrowb
s_mov_b32 s20, s82
s_and_b32 s21, s83, 65535
s_mov_b32 s22, 1728
s_mov_b32 s23, 131072
buffer_load_dwordx2 v[126:127], v130, s[20:23], 0 offen
s_add_u32 m0, s67, 0
s_sub_u32 s45, s66, 98304
s_cmp_eq_u32 s42, 0
s_cselect_b32 s45, 1073741824, s45
buffer_load_dwordx4 v236, s[4:7], s45 offen lds
s_add_u32 m0, s67, 6592
s_nop 0
buffer_load_dwordx4 v236, s[4:7], s66 offen lds
s_add_u32 m0, s67, 13200
s_add_u32 s66, s66, 98304
buffer_load_dwordx4 v236, s[4:7], s66 offen lds
s_add_u32 m0, s67, 19792
s_add_u32 s66, s66, 98304
buffer_load_dwordx4 v236, s[4:7], s66 offen lds
s_add_u32 m0, s67, 26400
s_add_u32 s66, s66, 98304
buffer_load_dwordx4 v236, s[4:7], s66 offen lds
s_add_u32 m0, s67, 32992
s_add_u32 s66, s66, 98304
buffer_load_dwordx4 v236, s[4:7], s66 offen lds
s_add_u32 m0, s67, 39600
s_add_u32 s66, s66, 98304
buffer_load_dwordx4 v236, s[4:7], s66 offen lds
s_add_u32 m0, s67, 46192
s_add_u32 s66, s66, 98304
buffer_load_dwordx4 v236, s[4:7], s66 offen lds
s_add_u32 m0, s67, 52736
s_add_u32 s66, s66, 98304
buffer_load_dwordx4 v236, s[4:7], s66 offen lds
s_add_u32 m0, s67, 59328
s_add_u32 s66, s66, 98304
buffer_load_dwordx4 v236, s[4:7], s66 offen lds
s_branch Lsetup
Lrowb:
s_add_u32 m0, s67, 896
s_sub_u32 s45, s66, 98304
s_cmp_eq_u32 s42, 0
s_cselect_b32 s45, 1073741824, s45
buffer_load_dwordx4 v237, s[4:7], s45 offen lds
s_add_u32 m0, s67, 7488
s_nop 0
buffer_load_dwordx4 v237, s[4:7], s66 offen lds
s_add_u32 m0, s67, 14096
s_add_u32 s66, s66, 98304
buffer_load_dwordx4 v237, s[4:7], s66 offen lds
s_add_u32 m0, s67, 20688
s_add_u32 s66, s66, 98304
buffer_load_dwordx4 v237, s[4:7], s66 offen lds
s_add_u32 m0, s67, 27296
s_add_u32 s66, s66, 98304
buffer_load_dwordx4 v237, s[4:7], s66 offen lds
s_add_u32 m0, s67, 33888
s_add_u32 s66, s66, 98304
buffer_load_dwordx4 v237, s[4:7], s66 offen lds
s_add_u32 m0, s67, 40496
s_add_u32 s66, s66, 98304
buffer_load_dwordx4 v237, s[4:7], s66 offen lds
s_add_u32 m0, s67, 47088
s_add_u32 s66, s66, 98304
buffer_load_dwordx4 v237, s[4:7], s66 offen lds
s_add_u32 m0, s67, 53632
s_add_u32 s66, s66, 98304
buffer_load_dwordx4 v237, s[4:7], s66 offen lds
s_add_u32 m0, s67, 60224
s_add_u32 s66, s66, 98304
buffer_load_dwordx4 v237, s[4:7], s66 offen lds
s_mov_b32 s12, s84
s_and_b32 s13, s85, 65535
s_mov_b32 s14, 73728
s_mov_b32 s15, 131072
v_lshrrev_b32 v115, 2, v118
v_mul_u32_u24 v115, 768, v115
v_and_b32_e64 v125, 3, v118
v_lshl_add_u32 v115, v125, 4, v115
s_and_b32 s43, s40, 3
s_add_u32 s43, s43, 0
s_mul_i32 s44, s43, 43
s_lshr_b32 s44, s44, 8
s_lshl_b32 s46, s43, 10
s_add_u32 m0, s46, 16384
s_mul_i32 s46, s44, 6
s_sub_u32 s43, s43, s46
s_mul_i32 s43, s43, 12288
s_lshl_b32 s44, s44, 6
s_add_u32 s43, s43, s44
buffer_load_dwordx4 v115, s[12:15], s43 offen lds
s_and_b32 s43, s40, 3
s_add_u32 s43, s43, 4
s_mul_i32 s44, s43, 43
s_lshr_b32 s44, s44, 8
s_lshl_b32 s46, s43, 10
s_add_u32 m0, s46, 16384
s_mul_i32 s46, s44, 6
s_sub_u32 s43, s43, s46
s_mul_i32 s43, s43, 12288
s_lshl_b32 s44, s44, 6
s_add_u32 s43, s43, s44
buffer_load_dwordx4 v115, s[12:15], s43 offen lds
s_and_b32 s43, s40, 3
s_add_u32 s43, s43, 8
s_mul_i32 s44, s43, 43
s_lshr_b32 s44, s44, 8
s_lshl_b32 s46, s43, 10
s_add_u32 m0, s46, 16384
s_mul_i32 s46, s44, 6
s_sub_u32 s43, s43, s46
s_mul_i32 s43, s43, 12288
s_lshl_b32 s44, s44, 6
s_add_u32 s43, s43, s44
buffer_load_dwordx4 v115, s[12:15], s43 offen lds
s_and_b32 s43, s40, 3
s_add_u32 s43, s43, 12
s_mul_i32 s44, s43, 43
s_lshr_b32 s44, s44, 8
s_lshl_b32 s46, s43, 10
s_add_u32 m0, s46, 16384
s_mul_i32 s46, s44, 6
s_sub_u32 s43, s43, s46
s_mul_i32 s43, s43, 12288
s_lshl_b32 s44, s44, 6
s_add_u32 s43, s43, s44
buffer_load_dwordx4 v115, s[12:15], s43 offen lds
s_and_b32 s43, s40, 3
s_add_u32 s43, s43, 16
s_mul_i32 s44, s43, 43
s_lshr_b32 s44, s44, 8
s_lshl_b32 s46, s43, 10
s_add_u32 m0, s46, 16384
s_mul_i32 s46, s44, 6
s_sub_u32 s43, s43, s46
s_mul_i32 s43, s43, 12288
s_lshl_b32 s44, s44, 6
s_add_u32 s43, s43, s44
buffer_load_dwordx4 v115, s[12:15], s43 offen lds
s_and_b32 s43, s40, 3
s_add_u32 s43, s43, 20
s_mul_i32 s44, s43, 43
s_lshr_b32 s44, s44, 8
s_lshl_b32 s46, s43, 10
s_add_u32 m0, s46, 16384
s_mul_i32 s46, s44, 6
s_sub_u32 s43, s43, s46
s_mul_i32 s43, s43, 12288
s_lshl_b32 s44, s44, 6
s_add_u32 s43, s43, s44
buffer_load_dwordx4 v115, s[12:15], s43 offen lds
v_bfe_u32 v141, v250, 4, 6
v_and_b32 v140, 15, v141
v_lshlrev_b32 v140, 7, v140
v_lshrrev_b32 v141, 4, v141
v_mul_u32_u24 v141, 98304, v141
s_sub_u32 s43, s67, -8000
s_mul_i32 s44, s41, 192
s_add_u32 s43, s43, s44
v_add3_u32 v140, v140, v141, s43
s_mov_b32 m0, 163840
s_add_u32 s44, s66, 393216
buffer_load_dword v140, s[4:7], s66 offen lds
buffer_load_dword v140, s[4:7], s44 offen lds
s_waitcnt vmcnt(8)
s_barrier
s_setprio 0
s_and_b32 s43, s40, 3
s_add_u32 s43, s43, 24
s_mul_i32 s44, s43, 43
s_lshr_b32 s44, s44, 8
s_lshl_b32 s46, s43, 10
s_add_u32 m0, s46, 16384
s_mul_i32 s46, s44, 6
s_sub_u32 s43, s43, s46
s_mul_i32 s43, s43, 12288
s_lshl_b32 s44, s44, 6
s_add_u32 s43, s43, s44
buffer_load_dwordx4 v115, s[12:15], s43 offen lds
s_and_b32 s43, s40, 3
s_add_u32 s43, s43, 28
s_mul_i32 s44, s43, 43
s_lshr_b32 s44, s44, 8
s_lshl_b32 s46, s43, 10
s_add_u32 m0, s46, 16384
s_mul_i32 s46, s44, 6
s_sub_u32 s43, s43, s46
s_mul_i32 s43, s43, 12288
s_lshl_b32 s44, s44, 6
s_add_u32 s43, s43, s44
buffer_load_dwordx4 v115, s[12:15], s43 offen lds
s_and_b32 s43, s40, 3
s_add_u32 s43, s43, 32
s_mul_i32 s44, s43, 43
s_lshr_b32 s44, s44, 8
s_lshl_b32 s46, s43, 10
s_add_u32 m0, s46, 16384
s_mul_i32 s46, s44, 6
s_sub_u32 s43, s43, s46
s_mul_i32 s43, s43, 12288
s_lshl_b32 s44, s44, 6
s_add_u32 s43, s43, s44
buffer_load_dwordx4 v115, s[12:15], s43 offen lds
s_and_b32 s43, s40, 3
s_add_u32 s43, s43, 36
s_mul_i32 s44, s43, 43
s_lshr_b32 s44, s44, 8
s_lshl_b32 s46, s43, 10
s_add_u32 m0, s46, 16384
s_mul_i32 s46, s44, 6
s_sub_u32 s43, s43, s46
s_mul_i32 s43, s43, 12288
s_lshl_b32 s44, s44, 6
s_add_u32 s43, s43, s44
buffer_load_dwordx4 v115, s[12:15], s43 offen lds
s_and_b32 s43, s40, 3
s_add_u32 s43, s43, 40
s_mul_i32 s44, s43, 43
s_lshr_b32 s44, s44, 8
s_lshl_b32 s46, s43, 10
s_add_u32 m0, s46, 16384
s_mul_i32 s46, s44, 6
s_sub_u32 s43, s43, s46
s_mul_i32 s43, s43, 12288
s_lshl_b32 s44, s44, 6
s_add_u32 s43, s43, s44
buffer_load_dwordx4 v115, s[12:15], s43 offen lds
s_and_b32 s43, s40, 3
s_add_u32 s43, s43, 44
s_mul_i32 s44, s43, 43
s_lshr_b32 s44, s44, 8
s_lshl_b32 s46, s43, 10
s_add_u32 m0, s46, 16384
s_mul_i32 s46, s44, 6
s_sub_u32 s43, s43, s46
s_mul_i32 s43, s43, 12288
s_lshl_b32 s44, s44, 6
s_add_u32 s43, s43, s44
buffer_load_dwordx4 v115, s[12:15], s43 offen lds
s_and_b32 s43, s40, 3
s_add_u32 s43, s43, 48
s_mul_i32 s44, s43, 43
s_lshr_b32 s44, s44, 8
s_lshl_b32 s46, s43, 10
s_add_u32 m0, s46, 16384
s_mul_i32 s46, s44, 6
s_sub_u32 s43, s43, s46
s_mul_i32 s43, s43, 12288
s_lshl_b32 s44, s44, 6
s_add_u32 s43, s43, s44
buffer_load_dwordx4 v115, s[12:15], s43 offen lds
s_and_b32 s43, s40, 3
s_add_u32 s43, s43, 52
s_mul_i32 s44, s43, 43
s_lshr_b32 s44, s44, 8
s_lshl_b32 s46, s43, 10
s_add_u32 m0, s46, 16384
s_mul_i32 s46, s44, 6
s_sub_u32 s43, s43, s46
s_mul_i32 s43, s43, 12288
s_lshl_b32 s44, s44, 6
s_add_u32 s43, s43, s44
buffer_load_dwordx4 v115, s[12:15], s43 offen lds
s_and_b32 s43, s40, 3
s_add_u32 s43, s43, 56
s_mul_i32 s44, s43, 43
s_lshr_b32 s44, s44, 8
s_lshl_b32 s46, s43, 10
s_add_u32 m0, s46, 16384
s_mul_i32 s46, s44, 6
s_sub_u32 s43, s43, s46
s_mul_i32 s43, s43, 12288
s_lshl_b32 s44, s44, 6
s_add_u32 s43, s43, s44
buffer_load_dwordx4 v115, s[12:15], s43 offen lds
s_and_b32 s43, s40, 3
s_add_u32 s43, s43, 60
s_mul_i32 s44, s43, 43
s_lshr_b32 s44, s44, 8
s_lshl_b32 s46, s43, 10
s_add_u32 m0, s46, 16384
s_mul_i32 s46, s44, 6
s_sub_u32 s43, s43, s46
s_mul_i32 s43, s43, 12288
s_lshl_b32 s44, s44, 6
s_add_u32 s43, s43, s44
buffer_load_dwordx4 v115, s[12:15], s43 offen lds
s_and_b32 s43, s40, 3
s_add_u32 s43, s43, 64
s_mul_i32 s44, s43, 43
s_lshr_b32 s44, s44, 8
s_lshl_b32 s46, s43, 10
s_add_u32 m0, s46, 16384
s_mul_i32 s46, s44, 6
s_sub_u32 s43, s43, s46
s_mul_i32 s43, s43, 12288
s_lshl_b32 s44, s44, 6
s_add_u32 s43, s43, s44
buffer_load_dwordx4 v115, s[12:15], s43 offen lds
s_and_b32 s43, s40, 3
s_add_u32 s43, s43, 68
s_mul_i32 s44, s43, 43
s_lshr_b32 s44, s44, 8
s_lshl_b32 s46, s43, 10
s_add_u32 m0, s46, 16384
s_mul_i32 s46, s44, 6
s_sub_u32 s43, s43, s46
s_mul_i32 s43, s43, 12288
s_lshl_b32 s44, s44, 6
s_add_u32 s43, s43, s44
buffer_load_dwordx4 v115, s[12:15], s43 offen lds
Lsetup:
s_mov_b32 s16, s86
s_and_b32 s17, s87, 65535
s_mov_b32 s18, 73728
s_mov_b32 s19, 131072
s_mov_b32 s24, s88
s_and_b32 s25, s89, 65535
s_mov_b32 s26, 768
s_mov_b32 s27, 131072
s_mov_b32 s28, s90
s_and_b32 s29, s91, 65535
s_mov_b32 s30, 768
s_mov_b32 s31, 131072
s_mov_b32 s8, s92
s_and_b32 s9, s93, 65535
s_mov_b32 s10, 50331648
s_mov_b32 s11, 131072
s_mov_b32 s36, s94
s_and_b32 s37, s95, 65535
s_mov_b32 s38, 256
s_mov_b32 s39, 131072
s_mov_b32 s32, s96
s_and_b32 s33, s97, 65535
s_mov_b32 s34, 83886080
s_mov_b32 s35, 131072
v_lshlrev_b32_e64 v250, 4, v118
v_add_u32 v250, 16384, v250
v_lshlrev_b32_e64 v251, 4, v118
v_add_u32 v251, 81920, v251
v_lshlrev_b32_e64 v252, 4, v118
v_add_u32 v252, 147456, v252
s_lshl_b32 s73, s2, 3
s_add_u32 s73, s73, s40
s_lshl_b32 s80, s73, 10
s_add_u32 s80, s80, 4177920
s_mul_i32 s73, s73, 16
s_add_u32 s73, s73, 1048576
s_mov_b32 s48, 1156203754
s_mov_b32 s49, 4294508536
s_mov_b32 s47, 16382
v_and_b32 v131, 15, v118
v_lshrrev_b32 v132, 4, v118
v_and_b32_e64 v133, 3, v131
v_mul_u32_u24 v134, 13200, v133
v_lshrrev_b32_e64 v133, 2, v131
v_lshl_add_u32 v133, v133, 1, v132
v_mul_u32_u24 v133, 192, v133
s_sub_u32 s43, s67, 90112
v_add3_u32 v246, v133, v134, s43
v_bfe_u32 v133, v131, 2, 1
v_sub_u32 v133, v132, v133
v_lshrrev_b32 v134, 3, v131
v_and_b32_e64 v135, 3, v131
v_lshl_add_u32 v135, v134, 2, v135
v_lshlrev_b32_e64 v136, 6, v133
v_lshl_add_u32 v136, v135, 3, v136
v_add_u32 v136, 156040, v136
v_mov_b32 v137, 156032
v_cmp_gt_u32 vcc, 3, v133
s_nop 1
v_cndmask_b32 v136, v137, v136, vcc
v_cmp_eq_u32 vcc, 0, v134
s_nop 1
v_cndmask_b32 v238, v137, v136, vcc
v_cndmask_b32 v239, v136, v137, vcc
v_lshrrev_b32 v133, 2, v131
v_bfe_u32 v135, v131, 1, 1
v_cmp_eq_u32 vcc, v133, v132
s_nop 1
v_cndmask_b32 v135, 8, v135, vcc
v_cmp_eq_u32 s[88:89], 0, v135
v_cmp_eq_u32 s[90:91], 1, v135
v_lshlrev_b32 v254, 5, v132
v_add_u32 v254, 7936, v254
v_lshlrev_b32 v253, 4, v132
v_and_b32 v131, 31, v118
v_lshrrev_b32_e64 v132, 5, v118
v_bfe_u32 v133, v131, 2, 1
v_bfe_u32 v134, v131, 3, 1
v_bfe_u32 v135, v131, 1, 1
v_lshrrev_b32 v136, 4, v131
v_lshl_add_u32 v135, v136, 1, v135
v_lshl_add_u32 v135, v134, 2, v135
v_cmp_eq_u32 vcc, v133, v132
s_nop 1
v_cndmask_b32 v135, 8, v135, vcc
v_cmp_eq_u32 s[50:51], 0, v135
v_cmp_eq_u32 s[52:53], 1, v135
v_cmp_eq_u32 s[54:55], 2, v135
v_cmp_eq_u32 s[56:57], 3, v135
v_cmp_eq_u32 s[58:59], 4, v135
v_cmp_eq_u32 s[60:61], 5, v135
v_cmp_eq_u32 s[62:63], 6, v135
v_cmp_eq_u32 s[64:65], 7, v135
v_and_b32 v136, 1, v131
v_lshlrev_b32 v136, 4, v136
v_mov_b32 v255, 16256
v_lshlrev_b32 v255, v136, v255
v_and_b32 v137, 19, v131
v_lshl_add_u32 v137, v133, 3, v137
v_lshl_add_u32 v137, v134, 2, v137
v_lshlrev_b32_e64 v137, 2, v137
v_lshl_add_u32 v137, v132, 7, v137
s_mul_i32 s82, s40, 9216
s_add_u32 s72, s82, 90112
v_add_u32 v248, s72, v137
v_and_b32 v133, 3, v118
v_mul_u32_u24 v134, 196608, v133
v_bfe_u32 v133, v118, 2, 2
v_mul_u32_u24 v133, 384, v133
v_add3_u32 v253, v253, v133, v134
s_mul_i32 s46, s41, 192
s_add_u32 s46, s46, s67
s_sub_u32 s46, s46, 90112
s_and_b32 s83, s40, 4
s_lshl_b32 s44, s83, 1
s_add_u32 s44, s44, s42
s_add_u32 s43, s44, 0
s_mul_i32 s43, s43, 98304
s_add_u32 s68, s43, s46
s_add_u32 s43, s44, 1
s_mul_i32 s43, s43, 98304
s_add_u32 s69, s43, s46
s_add_u32 s43, s44, 16
s_mul_i32 s43, s43, 98304
s_add_u32 s70, s43, s46
s_add_u32 s43, s44, 17
s_mul_i32 s43, s43, 98304
s_add_u32 s71, s43, s46
s_mov_b32 s92, 2863311530
s_mov_b32 s94, 3435973836
s_mov_b32 s93, 2863311530
s_mov_b32 s95, 3435973836
s_mov_b32 s81, 59328
s_mov_b32 s76, 200000
v_mov_b32 v247, 8128
v_lshrrev_b32 v148, 5, v118
v_lshlrev_b32 v116, 8, v148
v_bfe_u32 v148, v118, 2, 2
v_lshl_add_u32 v116, v148, 6, v116
v_bfe_u32 v148, v118, 4, 1
v_lshl_add_u32 v116, v148, 5, v116
v_and_b32_e64 v148, 1, v118
v_lshl_add_u32 v116, v148, 4, v116
v_bfe_u32 v148, v118, 1, 1
v_lshl_add_u32 v116, v148, 3, v116
s_and_b32 s43, s40, 3
s_lshl_b32 s43, s43, 10
v_add_u32_e64 v117, s43, v250
s_add_u32 s43, s43, 16384
v_add_u32 v116, s43, v116
v_mov_b32 v224, 0
v_mov_b32 v225, 0
v_mov_b32 v226, 0
v_mov_b32 v227, 0
v_mov_b32 v228, 0
v_mov_b32 v229, 0
v_mov_b32 v230, 0
v_mov_b32 v231, 0
v_mov_b32 v232, 0
v_mov_b32 v233, 0
v_mov_b32 v234, 0
v_mov_b32 v235, 0
s_cmp_ge_u32 s40, 4
s_cbranch_scc1 Lwa
v_mov_b32 v65, 0
v_mov_b32 v67, 0
v_mov_b32 v68, 0
v_mov_b32 v70, 0
v_mov_b32 v72, 0
v_mov_b32 v73, 0
v_min_u32 v140, 35, v119
v_mul_u32_u24 v140, 200, v140
v_add_u32 v140, 156032, v140
v_and_b32 v141, 31, v119
v_lshlrev_b32 v141, 3, v141
v_bfe_u32 v142, v119, 5, 1
v_lshl_add_u32 v141, v142, 13, v141
v_add_u32 v141, 7936, v141
v_cmp_gt_u32 vcc, 64, v119
s_nop 1
v_cndmask_b32 v140, v141, v140, vcc
ds_write_b64 v140, v[72:73]
v_lshrrev_b32 v140, 1, v128
v_mul_u32_u24 v141, 57, v140
v_lshrrev_b32 v141, 11, v141
v_mul_u32_u24 v142, 171, v140
v_lshrrev_b32_e64 v142, 11, v142
v_mul_u32_u24 v140, 200, v140
v_mul_u32_u24 v142, 2336, v142
v_mul_u32_u24 v141, 2208, v141
v_sub_u32 v140, v140, v142
v_add_u32 v140, v140, v141
v_and_b32_e64 v141, 1, v128
v_lshl_add_u32 v140, v141, 5, v140
v_add_u32 v140, 156040, v140
v_and_b32 v120, 255, v119
v_lshlrev_b32 v121, 8, v120
v_add_u32 v0, 4, v121
v_cvt_f32_f16 v0, v0
v_add_u32 v1, 12, v121
v_cvt_f32_f16 v1, v1
v_add_u32 v2, 20, v121
v_cvt_f32_f16 v2, v2
v_add_u32 v3, 28, v121
v_cvt_f32_f16 v3, v3
v_add_u32 v4, 36, v121
v_cvt_f32_f16 v4, v4
v_add_u32 v5, 44, v121
v_cvt_f32_f16 v5, v5
v_add_u32 v6, 52, v121
v_cvt_f32_f16 v6, v6
v_add_u32 v7, 60, v121
v_cvt_f32_f16_e64 v7, v7
v_add_u32 v8, 68, v121
v_cvt_f32_f16_e64 v8, v8
v_add_u32 v9, 76, v121
v_cvt_f32_f16_e64 v9, v9
v_add_u32 v10, 84, v121
v_cvt_f32_f16_e64 v10, v10
v_add_u32 v11, 92, v121
v_cvt_f32_f16_e64 v11, v11
v_add_u32 v12, 100, v121
v_cvt_f32_f16_e64 v12, v12
v_add_u32 v13, 108, v121
v_cvt_f32_f16_e64 v13, v13
v_add_u32 v14, 116, v121
v_cvt_f32_f16_e64 v14, v14
v_add_u32 v15, 124, v121
v_cvt_f32_f16_e64 v15, v15
v_add_u32 v16, 132, v121
v_cvt_f32_f16_e64 v16, v16
v_add_u32 v17, 140, v121
v_cvt_f32_f16_e64 v17, v17
v_add_u32 v18, 148, v121
v_cvt_f32_f16_e64 v18, v18
v_add_u32 v19, 156, v121
v_cvt_f32_f16_e64 v19, v19
v_add_u32 v20, 164, v121
v_cvt_f32_f16_e64 v20, v20
v_add_u32 v21, 172, v121
v_cvt_f32_f16_e64 v21, v21
v_add_u32 v22, 180, v121
v_cvt_f32_f16_e64 v22, v22
v_add_u32 v23, 188, v121
v_cvt_f32_f16_e64 v23, v23
v_add_u32 v24, 196, v121
v_cvt_f32_f16_e64 v24, v24
v_add_u32 v25, 204, v121
v_cvt_f32_f16_e64 v25, v25
v_add_u32 v26, 212, v121
v_cvt_f32_f16_e64 v26, v26
v_add_u32 v27, 220, v121
v_cvt_f32_f16_e64 v27, v27
v_add_u32 v28, 228, v121
v_cvt_f32_f16_e64 v28, v28
v_add_u32 v29, 236, v121
v_cvt_f32_f16_e64 v29, v29
v_add_u32 v30, 244, v121
v_cvt_f32_f16_e64 v30, v30
v_add_u32 v31, 252, v121
v_cvt_f32_f16_e64 v31, v31
v_fmaak_f32 v32, v0, v0, 0x409d30fc
v_mul_f32_e64 v32, v0, v32
v_fmaak_f32 v33, v1, v1, 0x409d30fc
v_mul_f32_e64 v33, v1, v33
v_fmaak_f32 v34, v2, v2, 0x409d30fc
v_mul_f32_e64 v34, v2, v34
v_fmaak_f32 v35, v3, v3, 0x409d30fc
v_mul_f32_e64 v35, v3, v35
v_fmaak_f32 v36, v4, v4, 0x409d30fc
v_mul_f32_e64 v36, v4, v36
v_fmaak_f32 v37, v5, v5, 0x409d30fc
v_mul_f32_e64 v37, v5, v37
v_fmaak_f32 v38, v6, v6, 0x409d30fc
v_mul_f32_e64 v38, v6, v38
v_fmaak_f32 v39, v7, v7, 0x409d30fc
v_mul_f32_e64 v39, v7, v39
v_fmaak_f32 v40, v8, v8, 0x409d30fc
v_mul_f32_e64 v40, v8, v40
v_fmaak_f32 v41, v9, v9, 0x409d30fc
v_mul_f32_e64 v41, v9, v41
v_fmaak_f32 v42, v10, v10, 0x409d30fc
v_mul_f32_e64 v42, v10, v42
v_fmaak_f32 v43, v11, v11, 0x409d30fc
v_mul_f32_e64 v43, v11, v43
v_fmaak_f32 v44, v12, v12, 0x409d30fc
v_mul_f32_e64 v44, v12, v44
v_fmaak_f32 v45, v13, v13, 0x409d30fc
v_mul_f32_e64 v45, v13, v45
v_fmaak_f32 v46, v14, v14, 0x409d30fc
v_mul_f32_e64 v46, v14, v46
v_fmaak_f32 v47, v15, v15, 0x409d30fc
v_mul_f32_e64 v47, v15, v47
v_fmaak_f32 v48, v16, v16, 0x409d30fc
v_mul_f32_e64 v48, v16, v48
v_fmaak_f32 v49, v17, v17, 0x409d30fc
v_mul_f32_e64 v49, v17, v49
v_fmaak_f32 v50, v18, v18, 0x409d30fc
v_mul_f32_e64 v50, v18, v50
v_fmaak_f32 v51, v19, v19, 0x409d30fc
v_mul_f32_e64 v51, v19, v51
v_fmaak_f32 v52, v20, v20, 0x409d30fc
v_mul_f32_e64 v52, v20, v52
v_fmaak_f32 v53, v21, v21, 0x409d30fc
v_mul_f32_e64 v53, v21, v53
v_fmaak_f32 v54, v22, v22, 0x409d30fc
v_mul_f32_e64 v54, v22, v54
v_fmaak_f32 v55, v23, v23, 0x409d30fc
v_mul_f32_e64 v55, v23, v55
v_fmaak_f32 v56, v24, v24, 0x409d30fc
v_mul_f32_e64 v56, v24, v56
v_fmaak_f32 v57, v25, v25, 0x409d30fc
v_mul_f32_e64 v57, v25, v57
v_fmaak_f32 v58, v26, v26, 0x409d30fc
v_mul_f32_e64 v58, v26, v58
v_fmaak_f32 v59, v27, v27, 0x409d30fc
v_mul_f32_e64 v59, v27, v59
v_fmaak_f32 v60, v28, v28, 0x409d30fc
v_mul_f32_e64 v60, v28, v60
v_fmaak_f32 v61, v29, v29, 0x409d30fc
v_mul_f32_e64 v61, v29, v61
v_fmaak_f32 v62, v30, v30, 0x409d30fc
v_mul_f32_e64 v62, v30, v62
v_fmaak_f32 v63, v31, v31, 0x409d30fc
v_mul_f32 v63, v31, v63
v_exp_f32 v32, v32
v_exp_f32 v33, v33
v_exp_f32 v34, v34
v_exp_f32 v35, v35
v_exp_f32 v36, v36
v_exp_f32 v37, v37
v_exp_f32 v38, v38
v_exp_f32 v39, v39
v_exp_f32 v40, v40
v_exp_f32 v41, v41
v_exp_f32 v42, v42
v_exp_f32 v43, v43
v_exp_f32 v44, v44
v_exp_f32 v45, v45
v_exp_f32 v46, v46
v_exp_f32 v47, v47
v_exp_f32 v48, v48
v_exp_f32 v49, v49
v_exp_f32 v50, v50
v_exp_f32 v51, v51
v_exp_f32 v52, v52
v_exp_f32 v53, v53
v_exp_f32 v54, v54
v_exp_f32 v55, v55
v_exp_f32 v56, v56
v_exp_f32 v57, v57
v_exp_f32 v58, v58
v_exp_f32 v59, v59
v_exp_f32 v60, v60
v_exp_f32 v61, v61
v_exp_f32 v62, v62
v_exp_f32 v63, v63
v_add_f32 v32, 1.0, v32
v_add_f32 v33, 1.0, v33
v_add_f32 v34, 1.0, v34
v_add_f32 v35, 1.0, v35
v_add_f32 v36, 1.0, v36
v_add_f32 v37, 1.0, v37
v_add_f32 v38, 1.0, v38
v_add_f32 v39, 1.0, v39
v_add_f32 v40, 1.0, v40
v_add_f32 v41, 1.0, v41
v_add_f32 v42, 1.0, v42
v_add_f32 v43, 1.0, v43
v_add_f32 v44, 1.0, v44
v_add_f32 v45, 1.0, v45
v_add_f32 v46, 1.0, v46
v_add_f32 v47, 1.0, v47
v_add_f32 v48, 1.0, v48
v_add_f32 v49, 1.0, v49
v_add_f32 v50, 1.0, v50
v_add_f32 v51, 1.0, v51
v_add_f32 v52, 1.0, v52
v_add_f32 v53, 1.0, v53
v_add_f32 v54, 1.0, v54
v_add_f32 v55, 1.0, v55
v_add_f32 v56, 1.0, v56
v_add_f32 v57, 1.0, v57
v_add_f32 v58, 1.0, v58
v_add_f32 v59, 1.0, v59
v_add_f32 v60, 1.0, v60
v_add_f32 v61, 1.0, v61
v_add_f32 v62, 1.0, v62
v_add_f32 v63, 1.0, v63
v_rcp_f32 v32, v32
v_rcp_f32 v33, v33
v_rcp_f32 v34, v34
v_rcp_f32 v35, v35
v_rcp_f32 v36, v36
v_rcp_f32 v37, v37
v_rcp_f32 v38, v38
v_rcp_f32 v39, v39
v_rcp_f32 v40, v40
v_rcp_f32 v41, v41
v_rcp_f32 v42, v42
v_rcp_f32 v43, v43
v_rcp_f32 v44, v44
v_rcp_f32 v45, v45
v_rcp_f32 v46, v46
v_rcp_f32 v47, v47
v_rcp_f32 v48, v48
v_rcp_f32 v49, v49
v_rcp_f32 v50, v50
v_rcp_f32 v51, v51
v_rcp_f32 v52, v52
v_rcp_f32 v53, v53
v_rcp_f32 v54, v54
v_rcp_f32 v55, v55
v_rcp_f32 v56, v56
v_rcp_f32 v57, v57
v_rcp_f32 v58, v58
v_rcp_f32 v59, v59
v_rcp_f32 v60, v60
v_rcp_f32 v61, v61
v_rcp_f32 v62, v62
v_rcp_f32 v63, v63
v_mul_f32 v0, v0, v32
v_mul_f32 v1, v1, v33
v_mul_f32 v2, v2, v34
v_mul_f32 v3, v3, v35
v_mul_f32 v4, v4, v36
v_mul_f32 v5, v5, v37
v_mul_f32 v6, v6, v38
v_mul_f32 v7, v7, v39
v_mul_f32 v8, v8, v40
v_mul_f32 v9, v9, v41
v_mul_f32 v10, v10, v42
v_mul_f32 v11, v11, v43
v_mul_f32 v12, v12, v44
v_mul_f32 v13, v13, v45
v_mul_f32 v14, v14, v46
v_mul_f32 v15, v15, v47
v_mul_f32 v16, v16, v48
v_mul_f32 v17, v17, v49
v_mul_f32 v18, v18, v50
v_mul_f32 v19, v19, v51
v_mul_f32 v20, v20, v52
v_mul_f32 v21, v21, v53
v_mul_f32 v22, v22, v54
v_mul_f32 v23, v23, v55
v_mul_f32 v24, v24, v56
v_mul_f32 v25, v25, v57
v_mul_f32 v26, v26, v58
v_mul_f32 v27, v27, v59
v_mul_f32 v28, v28, v60
v_mul_f32 v29, v29, v61
v_mul_f32 v30, v30, v62
v_mul_f32_e64 v31, v31, v63
v_cvt_pk_f16_f32 v32, v0, v1
v_cvt_pk_f16_f32 v33, v2, v3
v_cvt_pk_f16_f32 v34, v4, v5
v_cvt_pk_f16_f32 v35, v6, v7
v_cvt_pk_f16_f32 v36, v8, v9
v_cvt_pk_f16_f32 v37, v10, v11
v_cvt_pk_f16_f32 v38, v12, v13
v_cvt_pk_f16_f32 v39, v14, v15
v_cvt_pk_f16_f32 v40, v16, v17
v_cvt_pk_f16_f32 v41, v18, v19
v_cvt_pk_f16_f32 v42, v20, v21
v_cvt_pk_f16_f32 v43, v22, v23
v_cvt_pk_f16_f32 v44, v24, v25
v_cvt_pk_f16_f32 v45, v26, v27
v_cvt_pk_f16_f32 v46, v28, v29
v_cvt_pk_f16_f32 v47, v30, v31
v_add_u32 v32, 131074, v32
v_and_b32 v32, 4294770684, v32
v_add_u32 v33, 131074, v33
v_and_b32 v33, 4294770684, v33
v_add_u32 v34, 131074, v34
v_and_b32 v34, 4294770684, v34
v_add_u32 v35, 131074, v35
v_and_b32 v35, 4294770684, v35
v_add_u32 v36, 131074, v36
v_and_b32 v36, 4294770684, v36
v_add_u32 v37, 131074, v37
v_and_b32 v37, 4294770684, v37
v_add_u32 v38, 131074, v38
v_and_b32 v38, 4294770684, v38
v_add_u32 v39, 131074, v39
v_and_b32 v39, 4294770684, v39
v_add_u32 v40, 131074, v40
v_and_b32 v40, 4294770684, v40
v_add_u32 v41, 131074, v41
v_and_b32 v41, 4294770684, v41
v_add_u32 v42, 131074, v42
v_and_b32 v42, 4294770684, v42
v_add_u32 v43, 131074, v43
v_and_b32 v43, 4294770684, v43
v_add_u32 v44, 131074, v44
v_and_b32 v44, 4294770684, v44
v_add_u32 v45, 131074, v45
v_and_b32 v45, 4294770684, v45
v_add_u32 v46, 131074, v46
v_and_b32 v46, 4294770684, v46
v_add_u32 v47, 131074, v47
v_and_b32 v47, 4294770684, v47
v_lshlrev_b32 v121, 6, v120
v_bfe_u32 v120, v120, 2, 5
v_cmp_ne_u32 vcc, 31, v120
s_and_saveexec_b64 s[74:75], vcc
ds_write_b128 v121, v[32:35]
ds_write_b128 v121, v[36:39] offset:16
ds_write_b128 v121, v[40:43] offset:32
ds_write_b128 v121, v[44:47] offset:48
s_mov_b64 exec, s[74:75]
s_waitcnt vmcnt(10)
v_and_b32 v64, 65535, v126
ds_write_b64 v140, v[64:65]
v_and_b32 v66, 4294901760, v126
ds_write_b64 v140, v[66:67] offset:8
v_and_b32 v69, 65535, v127
ds_write_b64 v140, v[68:69] offset:16
v_and_b32 v71, 4294901760, v127
ds_write_b64 v140, v[70:71] offset:24
s_waitcnt vmcnt(0) lgkmcnt(0)
s_barrier
Lwa:
s_cmp_lt_u32 s40, 4
s_cbranch_scc1 Lsu1
s_waitcnt vmcnt(14)
v_add_u32 v113, 65536, v116
v_add_u32 v114, 65536, v117
ds_read_b64_tr_b16 v[0:1], v116
ds_read_b64_tr_b16 v[2:3], v116 offset:512
ds_read_b64_tr_b16 v[4:5], v116 offset:4096
ds_read_b64_tr_b16 v[6:7], v116 offset:4608
ds_read_b64_tr_b16 v[8:9], v116 offset:8192
ds_read_b64_tr_b16 v[10:11], v116 offset:8704
ds_read_b64_tr_b16 v[12:13], v116 offset:12288
ds_read_b64_tr_b16 v[14:15], v116 offset:12800
ds_read_b64_tr_b16 v[16:17], v116 offset:16384
ds_read_b64_tr_b16 v[18:19], v116 offset:16896
ds_read_b64_tr_b16 v[20:21], v116 offset:20480
ds_read_b64_tr_b16 v[22:23], v116 offset:20992
s_waitcnt lgkmcnt(10)
ds_write_b128 v117, v[0:3]
s_waitcnt lgkmcnt(9)
ds_write_b128 v117, v[4:7] offset:4096
s_waitcnt lgkmcnt(8)
ds_write_b128 v117, v[8:11] offset:8192
s_waitcnt lgkmcnt(7)
ds_write_b128 v117, v[12:15] offset:12288
s_waitcnt lgkmcnt(6)
ds_write_b128 v117, v[16:19] offset:16384
s_waitcnt lgkmcnt(5)
ds_write_b128 v117, v[20:23] offset:20480
v_mov_b32_e64 v223, 1
s_waitcnt lgkmcnt(0)
s_mov_b64 exec, 1
ds_add_u32 v247, v223 offset:8
s_mov_b64 exec, -1
s_nop 0
v_mov_b32_e64 v223, 0
s_branch Law1
Lax1:
s_sleep 2
Law1:
ds_read_b32 v223, v247 offset:16
s_sub_u32 s76, s76, 1
s_cselect_b32 s44, 4, 0
s_cselect_b32 s76, 0, s76
s_waitcnt lgkmcnt(0)
v_readfirstlane_b32 s43, v223
s_nop 1
s_max_u32 s43, s43, s44
s_cmp_lt_u32 s43, 4
s_cbranch_scc1 Lax1
s_add_u32 s81, s81, 6592
s_cmp_eq_u32 s81, 65920
s_cselect_b32 s81, 0, s81
s_add_u32 s43, s81, s67
s_add_u32 m0, s43, 16
s_add_u32 s66, s66, 98304
buffer_load_dwordx4 v236, s[4:7], s66 offen lds
s_add_u32 m0, s43, 912
s_nop 0
buffer_load_dwordx4 v237, s[4:7], s66 offen lds
s_add_u32 s81, s81, 6592
s_cmp_eq_u32 s81, 65920
s_cselect_b32 s81, 0, s81
s_add_u32 s43, s81, s67
s_add_u32 m0, s43, 16
s_add_u32 s66, s66, 98304
buffer_load_dwordx4 v236, s[4:7], s66 offen lds
s_add_u32 m0, s43, 912
s_nop 0
buffer_load_dwordx4 v237, s[4:7], s66 offen lds
s_add_u32 s81, s81, 6592
s_cmp_eq_u32 s81, 65920
s_cselect_b32 s81, 0, s81
s_add_u32 s43, s81, s67
s_add_u32 m0, s43, 32
s_add_u32 s66, s66, 98304
buffer_load_dwordx4 v236, s[4:7], s66 offen lds
s_add_u32 m0, s43, 928
s_nop 0
buffer_load_dwordx4 v237, s[4:7], s66 offen lds
s_add_u32 s81, s81, 6592
s_cmp_eq_u32 s81, 65920
s_cselect_b32 s81, 0, s81
s_add_u32 s43, s81, s67
s_add_u32 m0, s43, 32
s_add_u32 s66, s66, 98304
buffer_load_dwordx4 v236, s[4:7], s66 offen lds
s_add_u32 m0, s43, 928
s_nop 0
buffer_load_dwordx4 v237, s[4:7], s66 offen lds
s_add_u32 s81, s81, 6592
s_cmp_eq_u32 s81, 65920
s_cselect_b32 s81, 0, s81
s_add_u32 s43, s81, s67
s_add_u32 m0, s43, 48
s_add_u32 s66, s66, 98304
buffer_load_dwordx4 v236, s[4:7], s66 offen lds
s_add_u32 m0, s43, 944
s_nop 0
buffer_load_dwordx4 v237, s[4:7], s66 offen lds
s_add_u32 s81, s81, 6592
s_cmp_eq_u32 s81, 65920
s_cselect_b32 s81, 0, s81
s_add_u32 s43, s81, s67
s_add_u32 m0, s43, 48
s_add_u32 s66, s66, 98304
buffer_load_dwordx4 v236, s[4:7], s66 offen lds
s_add_u32 m0, s43, 944
s_nop 0
buffer_load_dwordx4 v237, s[4:7], s66 offen lds
s_add_u32 s81, s81, 6592
s_cmp_eq_u32 s81, 65920
s_cselect_b32 s81, 0, s81
s_add_u32 s43, s81, s67
s_add_u32 m0, s43, 0
s_add_u32 s66, s66, 98304
buffer_load_dwordx4 v236, s[4:7], s66 offen lds
s_add_u32 m0, s43, 896
s_nop 0
buffer_load_dwordx4 v237, s[4:7], s66 offen lds
s_add_u32 s81, s81, 6592
s_cmp_eq_u32 s81, 65920
s_cselect_b32 s81, 0, s81
s_add_u32 s43, s81, s67
s_add_u32 m0, s43, 0
s_add_u32 s66, s66, 98304
buffer_load_dwordx4 v236, s[4:7], s66 offen lds
s_add_u32 m0, s43, 896
s_nop 0
buffer_load_dwordx4 v237, s[4:7], s66 offen lds
s_waitcnt vmcnt(16)
v_add_u32 v113, 65536, v116
v_add_u32 v114, 65536, v117
ds_read_b64_tr_b16 v[0:1], v116 offset:24576
ds_read_b64_tr_b16 v[2:3], v116 offset:25088
ds_read_b64_tr_b16 v[4:5], v116 offset:28672
ds_read_b64_tr_b16 v[6:7], v116 offset:29184
ds_read_b64_tr_b16 v[8:9], v116 offset:32768
ds_read_b64_tr_b16 v[10:11], v116 offset:33280
ds_read_b64_tr_b16 v[12:13], v116 offset:36864
ds_read_b64_tr_b16 v[14:15], v116 offset:37376
ds_read_b64_tr_b16 v[16:17], v116 offset:40960
ds_read_b64_tr_b16 v[18:19], v116 offset:41472
ds_read_b64_tr_b16 v[20:21], v116 offset:45056
ds_read_b64_tr_b16 v[22:23], v116 offset:45568
ds_read_b64_tr_b16 v[24:25], v116 offset:49152
ds_read_b64_tr_b16 v[26:27], v116 offset:49664
ds_read_b64_tr_b16 v[28:29], v116 offset:53248
s_waitcnt lgkmcnt(14)
ds_read_b64_tr_b16 v[30:31], v116 offset:53760
s_waitcnt lgkmcnt(14)
ds_read_b64_tr_b16 v[32:33], v116 offset:57344
s_waitcnt lgkmcnt(14)
ds_read_b64_tr_b16 v[34:35], v116 offset:57856
s_waitcnt lgkmcnt(14)
ds_read_b64_tr_b16 v[36:37], v116 offset:61440
s_waitcnt lgkmcnt(14)
ds_read_b64_tr_b16 v[38:39], v116 offset:61952
s_waitcnt lgkmcnt(14)
ds_read_b64_tr_b16 v[40:41], v113
s_waitcnt lgkmcnt(14)
ds_read_b64_tr_b16 v[42:43], v113 offset:512
s_waitcnt lgkmcnt(14)
ds_read_b64_tr_b16 v[44:45], v113 offset:4096
s_waitcnt lgkmcnt(14)
ds_read_b64_tr_b16 v[46:47], v113 offset:4608
s_waitcnt lgkmcnt(14)
ds_write_b128 v117, v[0:3] offset:24576
s_waitcnt lgkmcnt(14)
ds_write_b128 v117, v[4:7] offset:28672
s_waitcnt lgkmcnt(14)
ds_write_b128 v117, v[8:11] offset:32768
s_waitcnt lgkmcnt(14)
ds_write_b128 v117, v[12:15] offset:36864
s_waitcnt lgkmcnt(14)
ds_write_b128 v117, v[16:19] offset:40960
s_waitcnt lgkmcnt(14)
ds_write_b128 v117, v[20:23] offset:45056
s_waitcnt lgkmcnt(14)
ds_write_b128 v117, v[24:27] offset:49152
s_waitcnt lgkmcnt(14)
ds_write_b128 v117, v[28:31] offset:53248
s_waitcnt lgkmcnt(14)
ds_write_b128 v117, v[32:35] offset:57344
s_waitcnt lgkmcnt(14)
s_waitcnt lgkmcnt(13)
ds_write_b128 v117, v[36:39] offset:61440
s_waitcnt lgkmcnt(12)
ds_write_b128 v114, v[40:43]
s_waitcnt lgkmcnt(11)
ds_write_b128 v114, v[44:47] offset:4096
v_mov_b32 v223, 1
s_waitcnt lgkmcnt(0)
s_mov_b64 exec, 1
ds_add_u32 v247, v223 offset:12
s_mov_b64 exec, -1
s_cmp_lg_u32 s40, 7
s_cbranch_scc1 Lnosent
v_bfe_u32 v104, v250, 4, 6
v_mov_b32 v108, -1
v_mov_b32 v109, -1
v_mov_b32 v110, -1
v_mov_b32 v111, -1
v_lshlrev_b32_e64 v100, 12, v104
v_add_u32 v101, 262144, v100
v_cmp_gt_u32 vcc, 32, v104
v_mov_b32 v105, 2147483648
s_nop 0
v_cndmask_b32 v101, v105, v101, vcc
s_lshl_b32 s43, s2, 4
buffer_store_dwordx4 v[108:111], v100, s[32:35], s43 offen sc1
buffer_store_dwordx4 v[108:111], v101, s[32:35], s43 offen sc1
s_add_u32 s43, s43, 393216
s_cmp_lt_u32 s2, 96
s_cselect_b32 s43, s43, 1073741824
v_lshlrev_b32 v103, 11, v104
s_mov_b64 exec, 0xff
buffer_store_dwordx4 v[108:111], v103, s[32:35], s43 offen sc1
s_mov_b64 exec, -1
s_nop 1
Lnosent:
s_setprio 3
s_waitcnt vmcnt(0)
s_cmp_lg_u32 s40, 7
s_cbranch_scc1 Lnoinit
s_waitcnt vmcnt(0)
v_mov_b32 v222, 1
v_mov_b32 v223, 0
s_mov_b64 exec, 1
buffer_atomic_add v222, v223, s[36:39], 0 offen
s_mov_b64 exec, -1
s_nop 1
Lnoinit:
Lsu1:
s_add_u32 s43, s81, 6592
v_add_u32_e64 v212, s43, v246
v_subrev_u32 v222, 65920, v212
v_min_u32_e64 v212, v212, v222
v_add_u32 v212, 90112, v212
v_add_u32_e64 v213, s43, v246
v_add_u32 v213, 6592, v213
v_subrev_u32 v222, 65920, v213
v_min_u32_e64 v213, v213, v222
v_add_u32 v213, 90112, v213
v_add_u32_e64 v214, s43, v246
v_add_u32 v214, 13184, v214
v_add_u32_e64 v222, 16, v214
v_bfi_b32 v214, 48, v222, v214
v_subrev_u32 v222, 65920, v214
v_min_u32_e64 v214, v214, v222
v_add_u32 v214, 90112, v214
v_add_u32_e64 v215, s43, v246
v_add_u32 v215, 19776, v215
v_add_u32_e64 v222, 16, v215
v_bfi_b32 v215, 48, v222, v215
v_subrev_u32 v222, 65920, v215
v_min_u32 v215, v215, v222
v_add_u32 v215, 90112, v215
ds_read_b128 v[144:147], v212
ds_read_b64 v[192:193], v238
ds_read_b64 v[194:195], v239
ds_read_b128 v[148:151], v213
ds_read_b128 v[152:155], v214
ds_read_b64 v[196:197], v238 offset:2400
ds_read_b64 v[198:199], v239 offset:2400
ds_read_b128 v[156:159], v215
ds_read_b64 v[200:201], v238 offset:4800
ds_read_b64 v[202:203], v239 offset:4800
ds_read_b128 v[160:163], v212 offset:16
ds_read_b64 v[204:205], v238 offset:200
ds_read_b64 v[206:207], v239 offset:200
ds_read_b128 v[164:167], v213 offset:16
ds_read_b128 v[168:171], v214 offset:16
s_waitcnt lgkmcnt(14)
ds_read_b64 v[208:209], v238 offset:2600
s_waitcnt lgkmcnt(13)
v_mfma_f32_16x16x32_bf16 v[0:3], v[192:195], v[144:147], 0
ds_read_b64 v[210:211], v239 offset:2600
ds_read_b128 v[172:175], v215 offset:16
s_waitcnt lgkmcnt(14)
v_mfma_f32_16x16x32_bf16 v[48:51], v[192:195], v[148:151], 0
ds_read_b64 v[192:193], v238 offset:5000
s_waitcnt lgkmcnt(14)
ds_read_b64 v[194:195], v239 offset:5000
s_waitcnt lgkmcnt(13)
v_mfma_f32_16x16x32_bf16 v[0:3], v[196:199], v[148:151], v[0:3]
ds_read_b128 v[144:147], v212 offset:32
ds_read_b128 v[148:151], v213 offset:32
v_mfma_f32_16x16x32_bf16 v[48:51], v[196:199], v[152:155], v[48:51]
s_waitcnt lgkmcnt(14)
ds_read_b64 v[196:197], v238 offset:400
s_waitcnt lgkmcnt(14)
ds_read_b64 v[198:199], v239 offset:400
s_waitcnt lgkmcnt(14)
v_mfma_f32_16x16x32_bf16 v[0:3], v[200:203], v[152:155], v[0:3]
ds_read_b128 v[152:155], v214 offset:32
v_mfma_f32_16x16x32_bf16 v[48:51], v[200:203], v[156:159], v[48:51]
s_waitcnt lgkmcnt(14)
ds_read_b64 v[200:201], v238 offset:2800
s_waitcnt lgkmcnt(14)
ds_read_b64 v[202:203], v239 offset:2800
s_waitcnt lgkmcnt(14)
v_mfma_f32_16x16x32_bf16 v[4:7], v[204:207], v[160:163], 0
ds_read_b128 v[156:159], v215 offset:32
s_waitcnt lgkmcnt(14)
v_mfma_f32_16x16x32_bf16 v[52:55], v[204:207], v[164:167], 0
ds_read_b64 v[204:205], v238 offset:5200
s_waitcnt lgkmcnt(14)
ds_read_b64 v[206:207], v239 offset:5200
s_waitcnt lgkmcnt(13)
v_mfma_f32_16x16x32_bf16 v[4:7], v[208:211], v[164:167], v[4:7]
ds_read_b128 v[160:163], v212 offset:48
ds_read_b128 v[164:167], v213 offset:48
v_mfma_f32_16x16x32_bf16 v[52:55], v[208:211], v[168:171], v[52:55]
s_waitcnt lgkmcnt(14)
ds_read_b64 v[208:209], v238 offset:600
s_waitcnt lgkmcnt(14)
ds_read_b64 v[210:211], v239 offset:600
s_waitcnt lgkmcnt(14)
v_mfma_f32_16x16x32_bf16 v[4:7], v[192:195], v[168:171], v[4:7]
ds_read_b128 v[168:171], v214 offset:48
v_mfma_f32_16x16x32_bf16 v[52:55], v[192:195], v[172:175], v[52:55]
s_waitcnt lgkmcnt(14)
ds_read_b64 v[192:193], v238 offset:3000
s_waitcnt lgkmcnt(14)
ds_read_b64 v[194:195], v239 offset:3000
s_waitcnt lgkmcnt(13)
v_mfma_f32_16x16x32_bf16 v[8:11], v[196:199], v[144:147], 0
ds_read_b128 v[172:175], v215 offset:48
ds_read_b128 v[144:147], v212 offset:64
v_mfma_f32_16x16x32_bf16 v[56:59], v[196:199], v[148:151], 0
s_waitcnt lgkmcnt(14)
ds_read_b64 v[196:197], v238 offset:5400
s_waitcnt lgkmcnt(14)
ds_read_b64 v[198:199], v239 offset:5400
s_waitcnt lgkmcnt(14)
v_mfma_f32_16x16x32_bf16 v[8:11], v[200:203], v[148:151], v[8:11]
ds_read_b128 v[148:151], v213 offset:64
v_mfma_f32_16x16x32_bf16 v[56:59], v[200:203], v[152:155], v[56:59]
s_waitcnt lgkmcnt(14)
ds_read_b64 v[200:201], v238 offset:800
s_waitcnt lgkmcnt(14)
ds_read_b64 v[202:203], v239 offset:800
s_waitcnt lgkmcnt(14)
v_mfma_f32_16x16x32_bf16 v[8:11], v[204:207], v[152:155], v[8:11]
ds_read_b128 v[152:155], v214 offset:64
v_mfma_f32_16x16x32_bf16 v[56:59], v[204:207], v[156:159], v[56:59]
s_waitcnt lgkmcnt(14)
ds_read_b64 v[204:205], v238 offset:3200
s_waitcnt lgkmcnt(14)
ds_read_b64 v[206:207], v239 offset:3200
s_waitcnt lgkmcnt(13)
v_mfma_f32_16x16x32_bf16 v[12:15], v[208:211], v[160:163], 0
ds_read_b128 v[156:159], v215 offset:64
ds_read_b128 v[160:163], v212 offset:80
v_mfma_f32_16x16x32_bf16 v[60:63], v[208:211], v[164:167], 0
s_waitcnt lgkmcnt(14)
ds_read_b64 v[208:209], v238 offset:5600
s_waitcnt lgkmcnt(14)
ds_read_b64 v[210:211], v239 offset:5600
s_waitcnt lgkmcnt(14)
v_mfma_f32_16x16x32_bf16 v[12:15], v[192:195], v[164:167], v[12:15]
ds_read_b128 v[164:167], v213 offset:80
v_mfma_f32_16x16x32_bf16 v[60:63], v[192:195], v[168:171], v[60:63]
s_waitcnt lgkmcnt(14)
ds_read_b64 v[192:193], v238 offset:1000
s_waitcnt lgkmcnt(14)
ds_read_b64 v[194:195], v239 offset:1000
s_waitcnt lgkmcnt(13)
v_mfma_f32_16x16x32_bf16 v[12:15], v[196:199], v[168:171], v[12:15]
ds_read_b128 v[168:171], v214 offset:80
v_mfma_f32_16x16x32_bf16 v[60:63], v[196:199], v[172:175], v[60:63]
ds_read_b64 v[196:197], v238 offset:3400
s_waitcnt lgkmcnt(14)
ds_read_b64 v[198:199], v239 offset:3400
s_waitcnt lgkmcnt(13)
v_mfma_f32_16x16x32_bf16 v[16:19], v[200:203], v[144:147], 0
ds_read_b128 v[172:175], v215 offset:80
ds_read_b128 v[144:147], v212 offset:96
v_mfma_f32_16x16x32_bf16 v[64:67], v[200:203], v[148:151], 0
s_waitcnt lgkmcnt(14)
ds_read_b64 v[200:201], v238 offset:5800
s_waitcnt lgkmcnt(14)
ds_read_b64 v[202:203], v239 offset:5800
s_waitcnt lgkmcnt(14)
v_mfma_f32_16x16x32_bf16 v[16:19], v[204:207], v[148:151], v[16:19]
ds_read_b128 v[148:151], v213 offset:96
v_mfma_f32_16x16x32_bf16 v[64:67], v[204:207], v[152:155], v[64:67]
s_waitcnt lgkmcnt(14)
ds_read_b64 v[204:205], v238 offset:1200
s_waitcnt lgkmcnt(14)
ds_read_b64 v[206:207], v239 offset:1200
s_waitcnt lgkmcnt(13)
v_mfma_f32_16x16x32_bf16 v[16:19], v[208:211], v[152:155], v[16:19]
ds_read_b128 v[152:155], v214 offset:96
v_mfma_f32_16x16x32_bf16 v[64:67], v[208:211], v[156:159], v[64:67]
ds_read_b64 v[208:209], v238 offset:3600
s_waitcnt lgkmcnt(14)
ds_read_b64 v[210:211], v239 offset:3600
s_waitcnt lgkmcnt(13)
v_mfma_f32_16x16x32_bf16 v[20:23], v[192:195], v[160:163], 0
ds_read_b128 v[156:159], v215 offset:96
ds_read_b128 v[160:163], v212 offset:112
v_mfma_f32_16x16x32_bf16 v[68:71], v[192:195], v[164:167], 0
s_waitcnt lgkmcnt(14)
ds_read_b64 v[192:193], v238 offset:6000
s_waitcnt lgkmcnt(14)
ds_read_b64 v[194:195], v239 offset:6000
s_waitcnt lgkmcnt(14)
v_mfma_f32_16x16x32_bf16 v[20:23], v[196:199], v[164:167], v[20:23]
ds_read_b128 v[164:167], v213 offset:112
v_mfma_f32_16x16x32_bf16 v[68:71], v[196:199], v[168:171], v[68:71]
s_waitcnt lgkmcnt(14)
ds_read_b64 v[196:197], v238 offset:1400
s_waitcnt lgkmcnt(14)
ds_read_b64 v[198:199], v239 offset:1400
s_waitcnt lgkmcnt(13)
v_mfma_f32_16x16x32_bf16 v[20:23], v[200:203], v[168:171], v[20:23]
ds_read_b128 v[168:171], v214 offset:112
v_mfma_f32_16x16x32_bf16 v[68:71], v[200:203], v[172:175], v[68:71]
ds_read_b64 v[200:201], v238 offset:3800
s_waitcnt lgkmcnt(14)
ds_read_b64 v[202:203], v239 offset:3800
s_waitcnt lgkmcnt(13)
v_mfma_f32_16x16x32_bf16 v[24:27], v[204:207], v[144:147], 0
ds_read_b128 v[172:175], v215 offset:112
ds_read_b128 v[144:147], v212 offset:128
v_mfma_f32_16x16x32_bf16 v[72:75], v[204:207], v[148:151], 0
s_waitcnt lgkmcnt(14)
ds_read_b64 v[204:205], v238 offset:6200
s_waitcnt lgkmcnt(14)
ds_read_b64 v[206:207], v239 offset:6200
s_waitcnt lgkmcnt(14)
v_mfma_f32_16x16x32_bf16 v[24:27], v[208:211], v[148:151], v[24:27]
ds_read_b128 v[148:151], v213 offset:128
v_mfma_f32_16x16x32_bf16 v[72:75], v[208:211], v[152:155], v[72:75]
s_waitcnt lgkmcnt(14)
ds_read_b64 v[208:209], v238 offset:1600
s_waitcnt lgkmcnt(14)
ds_read_b64 v[210:211], v239 offset:1600
s_waitcnt lgkmcnt(13)
v_mfma_f32_16x16x32_bf16 v[24:27], v[192:195], v[152:155], v[24:27]
ds_read_b128 v[152:155], v214 offset:128
v_mfma_f32_16x16x32_bf16 v[72:75], v[192:195], v[156:159], v[72:75]
ds_read_b64 v[192:193], v238 offset:4000
s_waitcnt lgkmcnt(14)
ds_read_b64 v[194:195], v239 offset:4000
s_waitcnt lgkmcnt(13)
v_mfma_f32_16x16x32_bf16 v[28:31], v[196:199], v[160:163], 0
ds_read_b128 v[156:159], v215 offset:128
ds_read_b128 v[160:163], v212 offset:144
v_mfma_f32_16x16x32_bf16 v[76:79], v[196:199], v[164:167], 0
s_waitcnt lgkmcnt(14)
ds_read_b64 v[196:197], v238 offset:6400
s_waitcnt lgkmcnt(14)
ds_read_b64 v[198:199], v239 offset:6400
s_waitcnt lgkmcnt(14)
v_mfma_f32_16x16x32_bf16 v[28:31], v[200:203], v[164:167], v[28:31]
ds_read_b128 v[164:167], v213 offset:144
v_mfma_f32_16x16x32_bf16 v[76:79], v[200:203], v[168:171], v[76:79]
s_waitcnt lgkmcnt(14)
ds_read_b64 v[200:201], v238 offset:1800
s_waitcnt lgkmcnt(14)
ds_read_b64 v[202:203], v239 offset:1800
s_waitcnt lgkmcnt(13)
v_mfma_f32_16x16x32_bf16 v[28:31], v[204:207], v[168:171], v[28:31]
ds_read_b128 v[168:171], v214 offset:144
v_mfma_f32_16x16x32_bf16 v[76:79], v[204:207], v[172:175], v[76:79]
ds_read_b64 v[204:205], v238 offset:4200
s_waitcnt lgkmcnt(14)
ds_read_b64 v[206:207], v239 offset:4200
s_waitcnt lgkmcnt(13)
v_mfma_f32_16x16x32_bf16 v[32:35], v[208:211], v[144:147], 0
ds_read_b128 v[172:175], v215 offset:144
ds_read_b128 v[144:147], v212 offset:160
v_mfma_f32_16x16x32_bf16 v[80:83], v[208:211], v[148:151], 0
s_waitcnt lgkmcnt(14)
ds_read_b64 v[208:209], v238 offset:6600
s_waitcnt lgkmcnt(14)
ds_read_b64 v[210:211], v239 offset:6600
s_waitcnt lgkmcnt(14)
v_mfma_f32_16x16x32_bf16 v[32:35], v[192:195], v[148:151], v[32:35]
ds_read_b128 v[148:151], v213 offset:160
v_mfma_f32_16x16x32_bf16 v[80:83], v[192:195], v[152:155], v[80:83]
s_waitcnt lgkmcnt(14)
ds_read_b64 v[192:193], v238 offset:2000
s_waitcnt lgkmcnt(14)
ds_read_b64 v[194:195], v239 offset:2000
s_waitcnt lgkmcnt(13)
v_mfma_f32_16x16x32_bf16 v[32:35], v[196:199], v[152:155], v[32:35]
ds_read_b128 v[152:155], v214 offset:160
v_mfma_f32_16x16x32_bf16 v[80:83], v[196:199], v[156:159], v[80:83]
ds_read_b64 v[196:197], v238 offset:4400
s_waitcnt lgkmcnt(14)
ds_read_b64 v[198:199], v239 offset:4400
s_waitcnt lgkmcnt(13)
v_mfma_f32_16x16x32_bf16 v[36:39], v[200:203], v[160:163], 0
ds_read_b128 v[156:159], v215 offset:160
ds_read_b128 v[160:163], v212 offset:176
v_mfma_f32_16x16x32_bf16 v[84:87], v[200:203], v[164:167], 0
s_waitcnt lgkmcnt(14)
ds_read_b64 v[200:201], v238 offset:6800
s_waitcnt lgkmcnt(14)
ds_read_b64 v[202:203], v239 offset:6800
s_waitcnt lgkmcnt(14)
v_mfma_f32_16x16x32_bf16 v[36:39], v[204:207], v[164:167], v[36:39]
ds_read_b128 v[164:167], v213 offset:176
v_mfma_f32_16x16x32_bf16 v[84:87], v[204:207], v[168:171], v[84:87]
s_waitcnt lgkmcnt(14)
ds_read_b64 v[204:205], v238 offset:2200
s_waitcnt lgkmcnt(14)
ds_read_b64 v[206:207], v239 offset:2200
s_waitcnt lgkmcnt(13)
v_mfma_f32_16x16x32_bf16 v[36:39], v[208:211], v[168:171], v[36:39]
ds_read_b128 v[168:171], v214 offset:176
v_mfma_f32_16x16x32_bf16 v[84:87], v[208:211], v[172:175], v[84:87]
ds_read_b64 v[208:209], v238 offset:4600
s_waitcnt lgkmcnt(14)
ds_read_b64 v[210:211], v239 offset:4600
s_waitcnt lgkmcnt(13)
v_mfma_f32_16x16x32_bf16 v[40:43], v[192:195], v[144:147], 0
ds_read_b128 v[172:175], v215 offset:176
v_mfma_f32_16x16x32_bf16 v[88:91], v[192:195], v[148:151], 0
ds_read_b64 v[192:193], v238 offset:7000
s_waitcnt lgkmcnt(14)
ds_read_b64 v[194:195], v239 offset:7000
s_waitcnt lgkmcnt(13)
v_mfma_f32_16x16x32_bf16 v[40:43], v[196:199], v[148:151], v[40:43]
v_mfma_f32_16x16x32_bf16 v[88:91], v[196:199], v[152:155], v[88:91]
s_waitcnt lgkmcnt(9)
v_mfma_f32_16x16x32_bf16 v[40:43], v[200:203], v[152:155], v[40:43]
v_mfma_f32_16x16x32_bf16 v[88:91], v[200:203], v[156:159], v[88:91]
s_waitcnt lgkmcnt(6)
v_mfma_f32_16x16x32_bf16 v[44:47], v[204:207], v[160:163], 0
v_mfma_f32_16x16x32_bf16 v[92:95], v[204:207], v[164:167], 0
s_waitcnt lgkmcnt(3)
v_mfma_f32_16x16x32_bf16 v[44:47], v[208:211], v[164:167], v[44:47]
v_mfma_f32_16x16x32_bf16 v[92:95], v[208:211], v[168:171], v[92:95]
s_waitcnt lgkmcnt(0)
v_mfma_f32_16x16x32_bf16 v[44:47], v[192:195], v[168:171], v[44:47]
v_mfma_f32_16x16x32_bf16 v[92:95], v[192:195], v[172:175], v[92:95]
v_mov_b32_e64 v223, 1
v_add_u32 v222, s83, v247
s_nop 7
s_mov_b64 exec, 1
ds_add_u32 v222, v223 offset:16
s_mov_b64 exec, -1
v_pk_mul_f32 v[242:243], v[0:1], v[0:1]
v_pk_add_f32 v[240:241], v[0:1], v[2:3]
v_pk_fma_f32 v[242:243], v[2:3], v[2:3], v[242:243]
v_pk_mul_f32 v[218:219], v[48:49], v[48:49]
v_pk_add_f32 v[216:217], v[48:49], v[50:51]
v_pk_fma_f32 v[218:219], v[50:51], v[50:51], v[218:219]
v_pk_fma_f32 v[242:243], v[4:5], v[4:5], v[242:243]
v_pk_add_f32 v[240:241], v[240:241], v[4:5]
v_pk_fma_f32 v[242:243], v[6:7], v[6:7], v[242:243]
v_pk_add_f32 v[240:241], v[240:241], v[6:7]
v_pk_fma_f32 v[218:219], v[52:53], v[52:53], v[218:219]
v_pk_add_f32 v[216:217], v[216:217], v[52:53]
v_pk_fma_f32 v[218:219], v[54:55], v[54:55], v[218:219]
v_pk_add_f32 v[216:217], v[216:217], v[54:55]
v_pk_fma_f32 v[242:243], v[8:9], v[8:9], v[242:243]
v_pk_add_f32 v[240:241], v[240:241], v[8:9]
v_pk_fma_f32 v[242:243], v[10:11], v[10:11], v[242:243]
v_pk_add_f32 v[240:241], v[240:241], v[10:11]
v_pk_fma_f32 v[218:219], v[56:57], v[56:57], v[218:219]
v_pk_add_f32 v[216:217], v[216:217], v[56:57]
v_pk_fma_f32 v[218:219], v[58:59], v[58:59], v[218:219]
v_pk_add_f32 v[216:217], v[216:217], v[58:59]
v_pk_fma_f32 v[242:243], v[12:13], v[12:13], v[242:243]
v_pk_add_f32 v[240:241], v[240:241], v[12:13]
v_pk_fma_f32 v[242:243], v[14:15], v[14:15], v[242:243]
v_pk_add_f32 v[240:241], v[240:241], v[14:15]
v_pk_fma_f32 v[218:219], v[60:61], v[60:61], v[218:219]
v_pk_add_f32 v[216:217], v[216:217], v[60:61]
v_pk_fma_f32 v[218:219], v[62:63], v[62:63], v[218:219]
v_pk_add_f32 v[216:217], v[216:217], v[62:63]
v_pk_fma_f32 v[242:243], v[16:17], v[16:17], v[242:243]
v_pk_add_f32 v[240:241], v[240:241], v[16:17]
v_pk_fma_f32 v[242:243], v[18:19], v[18:19], v[242:243]
v_pk_add_f32 v[240:241], v[240:241], v[18:19]
v_pk_fma_f32 v[218:219], v[64:65], v[64:65], v[218:219]
v_pk_add_f32 v[216:217], v[216:217], v[64:65]
v_pk_fma_f32 v[218:219], v[66:67], v[66:67], v[218:219]
v_pk_add_f32 v[216:217], v[216:217], v[66:67]
v_pk_fma_f32 v[242:243], v[20:21], v[20:21], v[242:243]
v_pk_add_f32 v[240:241], v[240:241], v[20:21]
v_pk_fma_f32 v[242:243], v[22:23], v[22:23], v[242:243]
v_pk_add_f32 v[240:241], v[240:241], v[22:23]
v_pk_fma_f32 v[218:219], v[68:69], v[68:69], v[218:219]
v_pk_add_f32 v[216:217], v[216:217], v[68:69]
v_pk_fma_f32 v[218:219], v[70:71], v[70:71], v[218:219]
v_pk_add_f32 v[216:217], v[216:217], v[70:71]
v_pk_fma_f32 v[242:243], v[24:25], v[24:25], v[242:243]
v_pk_add_f32 v[240:241], v[240:241], v[24:25]
v_pk_fma_f32 v[242:243], v[26:27], v[26:27], v[242:243]
v_pk_add_f32 v[240:241], v[240:241], v[26:27]
v_pk_fma_f32 v[218:219], v[72:73], v[72:73], v[218:219]
v_pk_add_f32 v[216:217], v[216:217], v[72:73]
v_pk_fma_f32 v[218:219], v[74:75], v[74:75], v[218:219]
v_pk_add_f32 v[216:217], v[216:217], v[74:75]
v_pk_fma_f32 v[242:243], v[28:29], v[28:29], v[242:243]
v_pk_add_f32 v[240:241], v[240:241], v[28:29]
v_pk_fma_f32 v[242:243], v[30:31], v[30:31], v[242:243]
v_pk_add_f32 v[240:241], v[240:241], v[30:31]
v_pk_fma_f32 v[218:219], v[76:77], v[76:77], v[218:219]
v_pk_add_f32 v[216:217], v[216:217], v[76:77]
v_pk_fma_f32 v[218:219], v[78:79], v[78:79], v[218:219]
v_pk_add_f32 v[216:217], v[216:217], v[78:79]
v_pk_fma_f32 v[242:243], v[32:33], v[32:33], v[242:243]
v_pk_add_f32 v[240:241], v[240:241], v[32:33]
v_pk_fma_f32 v[242:243], v[34:35], v[34:35], v[242:243]
v_pk_add_f32 v[240:241], v[240:241], v[34:35]
v_pk_fma_f32 v[218:219], v[80:81], v[80:81], v[218:219]
v_pk_add_f32 v[216:217], v[216:217], v[80:81]
v_pk_fma_f32 v[218:219], v[82:83], v[82:83], v[218:219]
v_pk_add_f32 v[216:217], v[216:217], v[82:83]
v_pk_fma_f32 v[242:243], v[36:37], v[36:37], v[242:243]
v_pk_add_f32 v[240:241], v[240:241], v[36:37]
v_pk_fma_f32 v[242:243], v[38:39], v[38:39], v[242:243]
v_pk_add_f32 v[240:241], v[240:241], v[38:39]
v_pk_fma_f32 v[218:219], v[84:85], v[84:85], v[218:219]
v_pk_add_f32 v[216:217], v[216:217], v[84:85]
v_pk_fma_f32 v[218:219], v[86:87], v[86:87], v[218:219]
v_pk_add_f32 v[216:217], v[216:217], v[86:87]
v_pk_fma_f32 v[242:243], v[40:41], v[40:41], v[242:243]
v_pk_add_f32 v[240:241], v[240:241], v[40:41]
v_pk_fma_f32 v[242:243], v[42:43], v[42:43], v[242:243]
v_pk_add_f32 v[240:241], v[240:241], v[42:43]
v_pk_fma_f32 v[218:219], v[88:89], v[88:89], v[218:219]
v_pk_add_f32 v[216:217], v[216:217], v[88:89]
v_pk_fma_f32 v[218:219], v[90:91], v[90:91], v[218:219]
v_pk_add_f32 v[216:217], v[216:217], v[90:91]
v_pk_fma_f32 v[242:243], v[44:45], v[44:45], v[242:243]
v_pk_add_f32 v[240:241], v[240:241], v[44:45]
v_pk_fma_f32 v[242:243], v[46:47], v[46:47], v[242:243]
v_pk_add_f32 v[240:241], v[240:241], v[46:47]
v_pk_fma_f32 v[218:219], v[92:93], v[92:93], v[218:219]
v_pk_add_f32 v[216:217], v[216:217], v[92:93]
v_pk_fma_f32 v[218:219], v[94:95], v[94:95], v[218:219]
v_pk_add_f32 v[216:217], v[216:217], v[94:95]
v_add_f32 v218, v218, v219
v_add_f32 v216, v216, v217
s_nop 1
v_permlane32_swap_b32 v216, v218
v_add_f32_e64 v216, v216, v218
v_mul_f32 v216, 1009429163, v216
v_mov_b32_e64 v218, v216
s_nop 1
v_permlane32_swap_b32 v216, v218
v_fma_f32 v218, -v216, v216, v218
v_max_f32_e64 v218, 0, v218
v_add_f32 v218, 925353388, v218
v_rsq_f32 v218, v218
v_add_f32 v240, v240, v241
v_mul_f32 v220, 3203396952, v218
v_mul_f32 v221, 3203396952, v218
v_mul_f32 v218, v216, v220
v_mul_f32 v219, v216, v220
v_add_f32 v242, v242, v243
s_nop 1
v_permlane32_swap_b32 v240, v242
v_add_f32 v240, v240, v242
v_mul_f32 v240, 1009429163, v240
v_mov_b32_e64 v242, v240
s_nop 1
v_permlane32_swap_b32 v240, v242
v_fma_f32 v242, -v240, v240, v242
v_max_f32_e64 v242, 0, v242
v_add_f32 v242, 925353388, v242
v_rsq_f32 v242, v242
s_nop 0
v_mul_f32 v244, 3203396952, v242
v_mul_f32 v245, 3203396952, v242
v_mul_f32 v242, v240, v244
v_mul_f32 v243, v240, v244
v_pk_fma_f32 v[0:1], v[0:1], v[244:245], v[242:243] neg_lo:[0,0,1] neg_hi:[0,0,1]
v_pk_fma_f32 v[2:3], v[2:3], v[244:245], v[242:243] neg_lo:[0,0,1] neg_hi:[0,0,1]
v_cvt_pk_bf16_f32 v0, v0, v1
v_cvt_pk_bf16_f32 v1, v2, v3
v_pk_fma_f32 v[4:5], v[4:5], v[244:245], v[242:243] neg_lo:[0,0,1] neg_hi:[0,0,1]
v_pk_fma_f32 v[6:7], v[6:7], v[244:245], v[242:243] neg_lo:[0,0,1] neg_hi:[0,0,1]
v_cvt_pk_bf16_f32 v2, v4, v5
v_cvt_pk_bf16_f32 v3, v6, v7
v_pk_fma_f32 v[8:9], v[8:9], v[244:245], v[242:243] neg_lo:[0,0,1] neg_hi:[0,0,1]
v_pk_fma_f32 v[10:11], v[10:11], v[244:245], v[242:243] neg_lo:[0,0,1] neg_hi:[0,0,1]
v_cvt_pk_bf16_f32 v4, v8, v9
v_cvt_pk_bf16_f32 v5, v10, v11
v_pk_fma_f32 v[12:13], v[12:13], v[244:245], v[242:243] neg_lo:[0,0,1] neg_hi:[0,0,1]
v_pk_fma_f32 v[14:15], v[14:15], v[244:245], v[242:243] neg_lo:[0,0,1] neg_hi:[0,0,1]
v_cvt_pk_bf16_f32 v6, v12, v13
v_cvt_pk_bf16_f32 v7, v14, v15
v_pk_fma_f32 v[16:17], v[16:17], v[244:245], v[242:243] neg_lo:[0,0,1] neg_hi:[0,0,1]
v_pk_fma_f32 v[18:19], v[18:19], v[244:245], v[242:243] neg_lo:[0,0,1] neg_hi:[0,0,1]
v_cvt_pk_bf16_f32 v8, v16, v17
v_cvt_pk_bf16_f32 v9, v18, v19
v_pk_fma_f32 v[20:21], v[20:21], v[244:245], v[242:243] neg_lo:[0,0,1] neg_hi:[0,0,1]
v_pk_fma_f32 v[22:23], v[22:23], v[244:245], v[242:243] neg_lo:[0,0,1] neg_hi:[0,0,1]
v_cvt_pk_bf16_f32 v10, v20, v21
v_cvt_pk_bf16_f32 v11, v22, v23
v_pk_fma_f32 v[24:25], v[24:25], v[244:245], v[242:243] neg_lo:[0,0,1] neg_hi:[0,0,1]
v_pk_fma_f32 v[26:27], v[26:27], v[244:245], v[242:243] neg_lo:[0,0,1] neg_hi:[0,0,1]
v_cvt_pk_bf16_f32 v12, v24, v25
v_cvt_pk_bf16_f32 v13, v26, v27
v_mov_b32 v223, 0
s_branch Law2
Lax2:
s_sleep 2
Law2:
ds_read_b32 v223, v247 offset:8
s_sub_u32 s76, s76, 1
s_cselect_b32 s44, 4, 0
s_cselect_b32 s76, 0, s76
s_waitcnt lgkmcnt(0)
v_readfirstlane_b32 s43, v223
s_nop 1
s_max_u32 s43, s43, s44
s_cmp_lt_u32 s43, 4
s_cbranch_scc1 Lax2
v_pk_fma_f32 v[28:29], v[28:29], v[244:245], v[242:243] neg_lo:[0,0,1] neg_hi:[0,0,1]
v_pk_fma_f32 v[30:31], v[30:31], v[244:245], v[242:243] neg_lo:[0,0,1] neg_hi:[0,0,1]
v_cvt_pk_bf16_f32 v14, v28, v29
v_cvt_pk_bf16_f32 v15, v30, v31
v_pk_fma_f32 v[32:33], v[32:33], v[244:245], v[242:243] neg_lo:[0,0,1] neg_hi:[0,0,1]
v_pk_fma_f32 v[34:35], v[34:35], v[244:245], v[242:243] neg_lo:[0,0,1] neg_hi:[0,0,1]
v_cvt_pk_bf16_f32 v16, v32, v33
v_cvt_pk_bf16_f32 v17, v34, v35
v_pk_fma_f32 v[36:37], v[36:37], v[244:245], v[242:243] neg_lo:[0,0,1] neg_hi:[0,0,1]
v_pk_fma_f32 v[38:39], v[38:39], v[244:245], v[242:243] neg_lo:[0,0,1] neg_hi:[0,0,1]
v_cvt_pk_bf16_f32 v18, v36, v37
v_cvt_pk_bf16_f32 v19, v38, v39
v_pk_fma_f32 v[40:41], v[40:41], v[244:245], v[242:243] neg_lo:[0,0,1] neg_hi:[0,0,1]
v_pk_fma_f32 v[42:43], v[42:43], v[244:245], v[242:243] neg_lo:[0,0,1] neg_hi:[0,0,1]
v_cvt_pk_bf16_f32 v20, v40, v41
v_cvt_pk_bf16_f32 v21, v42, v43
v_pk_fma_f32 v[44:45], v[44:45], v[244:245], v[242:243] neg_lo:[0,0,1] neg_hi:[0,0,1]
v_pk_fma_f32 v[46:47], v[46:47], v[244:245], v[242:243] neg_lo:[0,0,1] neg_hi:[0,0,1]
v_cvt_pk_bf16_f32 v22, v44, v45
v_cvt_pk_bf16_f32 v23, v46, v47
v_pk_fma_f32 v[48:49], v[48:49], v[220:221], v[218:219] neg_lo:[0,0,1] neg_hi:[0,0,1]
ds_read_b128 v[176:179], v250
v_cvt_pk_bf16_f32 v24, v48, v49
v_pk_fma_f32 v[50:51], v[50:51], v[220:221], v[218:219] neg_lo:[0,0,1] neg_hi:[0,0,1]
v_pk_fma_f32 v[52:53], v[52:53], v[220:221], v[218:219] neg_lo:[0,0,1] neg_hi:[0,0,1]
v_cvt_pk_bf16_f32 v25, v50, v51
v_cvt_pk_bf16_f32 v26, v52, v53
v_pk_fma_f32 v[54:55], v[54:55], v[220:221], v[218:219] neg_lo:[0,0,1] neg_hi:[0,0,1]
v_pk_fma_f32 v[56:57], v[56:57], v[220:221], v[218:219] neg_lo:[0,0,1] neg_hi:[0,0,1]
v_cvt_pk_bf16_f32 v27, v54, v55
v_cvt_pk_bf16_f32 v28, v56, v57
v_pk_fma_f32 v[58:59], v[58:59], v[220:221], v[218:219] neg_lo:[0,0,1] neg_hi:[0,0,1]
v_pk_fma_f32 v[60:61], v[60:61], v[220:221], v[218:219] neg_lo:[0,0,1] neg_hi:[0,0,1]
v_cvt_pk_bf16_f32 v29, v58, v59
v_cvt_pk_bf16_f32 v30, v60, v61
v_pk_fma_f32 v[62:63], v[62:63], v[220:221], v[218:219] neg_lo:[0,0,1] neg_hi:[0,0,1]
v_pk_fma_f32 v[64:65], v[64:65], v[220:221], v[218:219] neg_lo:[0,0,1] neg_hi:[0,0,1]
v_cvt_pk_bf16_f32 v31, v62, v63
v_cvt_pk_bf16_f32 v32, v64, v65
v_pk_fma_f32 v[66:67], v[66:67], v[220:221], v[218:219] neg_lo:[0,0,1] neg_hi:[0,0,1]
v_pk_fma_f32 v[68:69], v[68:69], v[220:221], v[218:219] neg_lo:[0,0,1] neg_hi:[0,0,1]
v_cvt_pk_bf16_f32 v33, v66, v67
v_cvt_pk_bf16_f32 v34, v68, v69
v_pk_fma_f32 v[70:71], v[70:71], v[220:221], v[218:219] neg_lo:[0,0,1] neg_hi:[0,0,1]
v_pk_fma_f32 v[72:73], v[72:73], v[220:221], v[218:219] neg_lo:[0,0,1] neg_hi:[0,0,1]
ds_read_b128 v[180:183], v250 offset:1024
v_cvt_pk_bf16_f32 v35, v70, v71
v_cvt_pk_bf16_f32 v36, v72, v73
v_pk_fma_f32 v[74:75], v[74:75], v[220:221], v[218:219] neg_lo:[0,0,1] neg_hi:[0,0,1]
v_pk_fma_f32 v[76:77], v[76:77], v[220:221], v[218:219] neg_lo:[0,0,1] neg_hi:[0,0,1]
v_cvt_pk_bf16_f32 v37, v74, v75
v_cvt_pk_bf16_f32 v38, v76, v77
v_pk_fma_f32 v[78:79], v[78:79], v[220:221], v[218:219] neg_lo:[0,0,1] neg_hi:[0,0,1]
v_pk_fma_f32 v[80:81], v[80:81], v[220:221], v[218:219] neg_lo:[0,0,1] neg_hi:[0,0,1]
v_cvt_pk_bf16_f32 v39, v78, v79
v_cvt_pk_bf16_f32 v40, v80, v81
v_pk_fma_f32 v[82:83], v[82:83], v[220:221], v[218:219] neg_lo:[0,0,1] neg_hi:[0,0,1]
v_pk_fma_f32 v[84:85], v[84:85], v[220:221], v[218:219] neg_lo:[0,0,1] neg_hi:[0,0,1]
v_cvt_pk_bf16_f32 v41, v82, v83
v_cvt_pk_bf16_f32 v42, v84, v85
v_pk_fma_f32 v[86:87], v[86:87], v[220:221], v[218:219] neg_lo:[0,0,1] neg_hi:[0,0,1]
v_pk_fma_f32 v[88:89], v[88:89], v[220:221], v[218:219] neg_lo:[0,0,1] neg_hi:[0,0,1]
v_cvt_pk_bf16_f32 v43, v86, v87
v_cvt_pk_bf16_f32 v44, v88, v89
v_pk_fma_f32 v[90:91], v[90:91], v[220:221], v[218:219] neg_lo:[0,0,1] neg_hi:[0,0,1]
v_pk_fma_f32 v[92:93], v[92:93], v[220:221], v[218:219] neg_lo:[0,0,1] neg_hi:[0,0,1]
v_cvt_pk_bf16_f32 v45, v90, v91
v_cvt_pk_bf16_f32 v46, v92, v93
v_pk_fma_f32 v[94:95], v[94:95], v[220:221], v[218:219] neg_lo:[0,0,1] neg_hi:[0,0,1]
ds_read_b128 v[184:187], v250 offset:2048
v_cvt_pk_bf16_f32 v47, v94, v95
s_waitcnt lgkmcnt(2)
v_mfma_f32_32x32x16_bf16 v[160:175], v[0:3], v[176:179], 0
ds_read_b128 v[188:191], v250 offset:3072
v_mfma_f32_32x32x16_bf16 v[96:111], v[24:27], v[176:179], 0
ds_read_b128 v[176:179], v250 offset:4096
s_waitcnt lgkmcnt(3)
v_mfma_f32_32x32x16_bf16 v[160:175], v[4:7], v[180:183], v[160:175]
v_mfma_f32_32x32x16_bf16 v[96:111], v[28:31], v[180:183], v[96:111]
ds_read_b128 v[180:183], v250 offset:5120
s_waitcnt lgkmcnt(3)
v_mfma_f32_32x32x16_bf16 v[160:175], v[8:11], v[184:187], v[160:175]
v_mfma_f32_32x32x16_bf16 v[96:111], v[32:35], v[184:187], v[96:111]
ds_read_b128 v[184:187], v250 offset:6144
s_waitcnt lgkmcnt(2)
v_mfma_f32_32x32x16_bf16 v[160:175], v[12:15], v[188:191], v[160:175]
v_mfma_f32_32x32x16_bf16 v[96:111], v[36:39], v[188:191], v[96:111]
ds_read_b128 v[188:191], v250 offset:7168
v_mfma_f32_32x32x16_bf16 v[160:175], v[16:19], v[176:179], v[160:175]
v_mfma_f32_32x32x16_bf16 v[96:111], v[40:43], v[176:179], v[96:111]
ds_read_b128 v[176:179], v250 offset:8192
s_waitcnt lgkmcnt(2)
v_mfma_f32_32x32x16_bf16 v[160:175], v[20:23], v[180:183], v[160:175]
v_mfma_f32_32x32x16_bf16 v[96:111], v[44:47], v[180:183], v[96:111]
ds_read_b128 v[180:183], v250 offset:9216
s_nop 9
v_cvt_pkrtz_f16_f32 v160, v160, v161
v_mfma_f32_32x32x16_bf16 v[112:127], v[0:3], v[184:187], 0
v_cvt_pkrtz_f16_f32 v161, v162, v163
v_lshrrev_b64 v[160:161], 2, v[160:161]
v_and_b32_sdwa v162, s47, v160 dst_sel:DWORD dst_unused:UNUSED_PAD src0_sel:DWORD src1_sel:WORD_1
v_and_b32_e64 v160, s47, v160
v_cvt_pk_f16_f32 v172, v172, v173
v_cvt_pk_f16_f32 v174, v174, v175
v_pk_fma_f16 v173, v172, v172, s48
v_mfma_f32_32x32x16_bf16 v[128:143], v[24:27], v[184:187], 0
ds_read_u16 v162, v162
ds_read_u16 v160, v160
v_and_b32_sdwa v163, s47, v161 dst_sel:DWORD dst_unused:UNUSED_PAD src0_sel:DWORD src1_sel:WORD_1
v_and_b32_e64 v161, s47, v161
v_pk_fma_f16 v175, v174, v174, s48
v_pk_mul_f16 v173, v172, v173
v_pk_mul_f16 v175, v174, v175
v_cvt_pkrtz_f16_f32 v164, v164, v165
v_cvt_pkrtz_f16_f32 v165, v166, v167
v_lshrrev_b64 v[164:165], 2, v[164:165]
ds_read_u16 v163, v163
ds_read_u16 v161, v161
v_and_b32_sdwa v166, s47, v164 dst_sel:DWORD dst_unused:UNUSED_PAD src0_sel:DWORD src1_sel:WORD_1
v_and_b32 v164, s47, v164
v_exp_f16_sdwa v173, v173 dst_sel:WORD_0 dst_unused:UNUSED_PRESERVE src0_sel:WORD_0
s_waitcnt lgkmcnt(4)
v_mfma_f32_32x32x16_bf16 v[112:127], v[4:7], v[188:191], v[112:127]
ds_read_u16 v166, v166
ds_read_u16 v164, v164
v_exp_f16_sdwa v175, v175 dst_sel:WORD_0 dst_unused:UNUSED_PRESERVE src0_sel:WORD_0
v_and_b32_sdwa v167, s47, v165 dst_sel:DWORD dst_unused:UNUSED_PAD src0_sel:DWORD src1_sel:WORD_1
v_and_b32_e64 v165, s47, v165
v_exp_f16_sdwa v173, v173 dst_sel:WORD_1 dst_unused:UNUSED_PRESERVE src0_sel:WORD_1
v_cvt_pkrtz_f16_f32 v168, v168, v169
v_cvt_pkrtz_f16_f32 v169, v170, v171
v_lshrrev_b64 v[168:169], 2, v[168:169]
v_and_b32_sdwa v170, s47, v168 dst_sel:DWORD dst_unused:UNUSED_PAD src0_sel:DWORD src1_sel:WORD_1
v_and_b32_e64 v168, s47, v168
ds_read_u16 v167, v167
ds_read_u16 v165, v165
ds_read_u16 v170, v170
ds_read_u16 v168, v168
v_exp_f16_sdwa v175, v175 dst_sel:WORD_1 dst_unused:UNUSED_PRESERVE src0_sel:WORD_1
v_mfma_f32_32x32x16_bf16 v[128:143], v[28:31], v[188:191], v[128:143]
ds_read_b128 v[184:187], v250 offset:10240
v_and_b32_sdwa v171, s47, v169 dst_sel:DWORD dst_unused:UNUSED_PAD src0_sel:DWORD src1_sel:WORD_1
v_and_b32_e64 v169, s47, v169
v_pk_add_f16 v173, v173, 1.0 op_sel_hi:[1,0]
v_pk_add_f16 v175, v175, 1.0 op_sel_hi:[1,0]
v_rcp_f16_sdwa v173, v173 dst_sel:WORD_0 dst_unused:UNUSED_PRESERVE src0_sel:WORD_0
v_mfma_f32_32x32x16_bf16 v[112:127], v[8:11], v[176:179], v[112:127]
ds_read_u16 v171, v171
ds_read_u16 v169, v169
v_rcp_f16_sdwa v175, v175 dst_sel:WORD_0 dst_unused:UNUSED_PRESERVE src0_sel:WORD_0
v_rcp_f16_sdwa v173, v173 dst_sel:WORD_1 dst_unused:UNUSED_PRESERVE src0_sel:WORD_1
v_rcp_f16_sdwa v175, v175 dst_sel:WORD_1 dst_unused:UNUSED_PRESERVE src0_sel:WORD_1
v_mfma_f32_32x32x16_bf16 v[128:143], v[32:35], v[176:179], v[128:143]
ds_read_b128 v[188:191], v250 offset:11264
v_pk_mul_f16 v172, v172, v173
v_pk_mul_f16 v174, v174, v175
v_fma_mix_f32 v224, v172, v172, v224 op_sel_hi:[1,1,0]
v_cvt_pkrtz_f16_f32 v96, v96, v97
v_fma_mix_f32 v224, v174, v174, v224 op_sel_hi:[1,1,0]
v_mfma_f32_32x32x16_bf16 v[112:127], v[12:15], v[180:183], v[112:127]
v_fma_mix_f32 v224, v172, v172, v224 op_sel:[1,1,0] op_sel_hi:[1,1,0]
v_cvt_pkrtz_f16_f32 v97, v98, v99
v_fma_mix_f32 v224, v174, v174, v224 op_sel:[1,1,0] op_sel_hi:[1,1,0]
v_lshrrev_b64 v[96:97], 2, v[96:97]
s_waitcnt lgkmcnt(7)
v_fma_mix_f32 v224, v160, v160, v224 op_sel_hi:[1,1,0]
v_and_b32_sdwa v98, s47, v96 dst_sel:DWORD dst_unused:UNUSED_PAD src0_sel:DWORD src1_sel:WORD_1
v_fma_mix_f32 v224, v161, v161, v224 op_sel_hi:[1,1,0]
v_and_b32 v96, s47, v96
v_fma_mix_f32 v224, v162, v162, v224 op_sel_hi:[1,1,0]
v_cvt_pk_f16_f32 v108, v108, v109
v_fma_mix_f32 v224, v163, v163, v224 op_sel_hi:[1,1,0]
v_cvt_pk_f16_f32 v110, v110, v111
v_pk_fma_f16 v109, v108, v108, s48
v_mfma_f32_32x32x16_bf16 v[128:143], v[36:39], v[180:183], v[128:143]
ds_read_u16 v98, v98
ds_read_u16 v96, v96
v_fma_mix_f32 v224, v164, v164, v224 op_sel_hi:[1,1,0]
v_and_b32_sdwa v99, s47, v97 dst_sel:DWORD dst_unused:UNUSED_PAD src0_sel:DWORD src1_sel:WORD_1
s_waitcnt lgkmcnt(6)
v_fma_mix_f32 v224, v165, v165, v224 op_sel_hi:[1,1,0]
v_and_b32 v97, s47, v97
v_pk_fma_f16 v111, v110, v110, s48
v_pk_mul_f16 v109, v108, v109
v_pk_mul_f16 v111, v110, v111
v_fma_mix_f32 v224, v166, v166, v224 op_sel_hi:[1,1,0]
v_cvt_pkrtz_f16_f32 v100, v100, v101
v_fma_mix_f32 v224, v167, v167, v224 op_sel_hi:[1,1,0]
ds_read_u16 v99, v99
ds_read_u16 v97, v97
ds_read_b128 v[176:179], v250 offset:12288
v_cvt_pkrtz_f16_f32 v101, v102, v103
v_lshrrev_b64 v[100:101], 2, v[100:101]
v_and_b32_sdwa v102, s47, v100 dst_sel:DWORD dst_unused:UNUSED_PAD src0_sel:DWORD src1_sel:WORD_1
v_and_b32 v100, s47, v100
v_exp_f16_sdwa v109, v109 dst_sel:WORD_0 dst_unused:UNUSED_PRESERVE src0_sel:WORD_0
s_waitcnt lgkmcnt(6)
v_mfma_f32_32x32x16_bf16 v[112:127], v[16:19], v[184:187], v[112:127]
ds_read_u16 v102, v102
ds_read_u16 v100, v100
v_exp_f16_sdwa v111, v111 dst_sel:WORD_0 dst_unused:UNUSED_PRESERVE src0_sel:WORD_0
v_fma_mix_f32 v224, v168, v168, v224 op_sel_hi:[1,1,0]
v_and_b32_sdwa v103, s47, v101 dst_sel:DWORD dst_unused:UNUSED_PAD src0_sel:DWORD src1_sel:WORD_1
v_fma_mix_f32 v224, v169, v169, v224 op_sel_hi:[1,1,0]
v_and_b32_e64 v101, s47, v101
v_exp_f16_sdwa v109, v109 dst_sel:WORD_1 dst_unused:UNUSED_PRESERVE src0_sel:WORD_1
v_fma_mix_f32 v224, v170, v170, v224 op_sel_hi:[1,1,0]
v_cvt_pkrtz_f16_f32 v104, v104, v105
v_fma_mix_f32 v224, v171, v171, v224 op_sel_hi:[1,1,0]
v_cvt_pkrtz_f16_f32 v105, v106, v107
v_lshrrev_b64 v[104:105], 2, v[104:105]
ds_read_u16 v103, v103
ds_read_u16 v101, v101
v_and_b32_sdwa v106, s47, v104 dst_sel:DWORD dst_unused:UNUSED_PAD src0_sel:DWORD src1_sel:WORD_1
v_and_b32_e64 v104, s47, v104
v_exp_f16_sdwa v111, v111 dst_sel:WORD_1 dst_unused:UNUSED_PRESERVE src0_sel:WORD_1
v_mfma_f32_32x32x16_bf16 v[128:143], v[40:43], v[184:187], v[128:143]
ds_read_u16 v106, v106
ds_read_u16 v104, v104
ds_read_b128 v[180:183], v250 offset:13312
v_and_b32_sdwa v107, s47, v105 dst_sel:DWORD dst_unused:UNUSED_PAD src0_sel:DWORD src1_sel:WORD_1
v_and_b32_e64 v105, s47, v105
v_pk_add_f16 v109, v109, 1.0 op_sel_hi:[1,0]
v_pk_add_f16 v111, v111, 1.0 op_sel_hi:[1,0]
v_rcp_f16_sdwa v109, v109 dst_sel:WORD_0 dst_unused:UNUSED_PRESERVE src0_sel:WORD_0
s_waitcnt lgkmcnt(7)
v_mfma_f32_32x32x16_bf16 v[112:127], v[20:23], v[188:191], v[112:127]
ds_read_u16 v107, v107
ds_read_u16 v105, v105
v_rcp_f16_sdwa v111, v111 dst_sel:WORD_0 dst_unused:UNUSED_PRESERVE src0_sel:WORD_0
v_rcp_f16_sdwa v109, v109 dst_sel:WORD_1 dst_unused:UNUSED_PRESERVE src0_sel:WORD_1
v_rcp_f16_sdwa v111, v111 dst_sel:WORD_1 dst_unused:UNUSED_PRESERVE src0_sel:WORD_1
v_mfma_f32_32x32x16_bf16 v[128:143], v[44:47], v[188:191], v[128:143]
ds_read_b128 v[184:187], v250 offset:14336
v_pk_mul_f16 v108, v108, v109
v_pk_mul_f16 v110, v110, v111
v_fma_mix_f32 v224, v108, v108, v224 op_sel_hi:[1,1,0]
s_nop 1
v_cvt_pkrtz_f16_f32 v112, v112, v113
v_fma_mix_f32 v224, v110, v110, v224 op_sel_hi:[1,1,0]
v_mfma_f32_32x32x16_bf16 v[144:159], v[0:3], v[176:179], 0
v_fma_mix_f32 v224, v108, v108, v224 op_sel:[1,1,0] op_sel_hi:[1,1,0]
v_cvt_pkrtz_f16_f32 v113, v114, v115
v_fma_mix_f32 v224, v110, v110, v224 op_sel:[1,1,0] op_sel_hi:[1,1,0]
v_lshrrev_b64 v[112:113], 2, v[112:113]
v_fma_mix_f32 v224, v96, v96, v224 op_sel_hi:[1,1,0]
v_and_b32_sdwa v114, s47, v112 dst_sel:DWORD dst_unused:UNUSED_PAD src0_sel:DWORD src1_sel:WORD_1
v_fma_mix_f32 v224, v97, v97, v224 op_sel_hi:[1,1,0]
v_and_b32_e64 v112, s47, v112
v_fma_mix_f32 v224, v98, v98, v224 op_sel_hi:[1,1,0]
v_cvt_pk_f16_f32 v124, v124, v125
v_fma_mix_f32 v224, v99, v99, v224 op_sel_hi:[1,1,0]
v_cvt_pk_f16_f32 v126, v126, v127
v_pk_fma_f16 v125, v124, v124, s48
v_mfma_f32_32x32x16_bf16 v[160:175], v[24:27], v[176:179], 0
ds_read_u16 v114, v114
ds_read_u16 v112, v112
s_waitcnt lgkmcnt(5)
v_fma_mix_f32 v224, v100, v100, v224 op_sel_hi:[1,1,0]
v_and_b32_sdwa v115, s47, v113 dst_sel:DWORD dst_unused:UNUSED_PAD src0_sel:DWORD src1_sel:WORD_1
v_fma_mix_f32 v224, v101, v101, v224 op_sel_hi:[1,1,0]
v_and_b32 v113, s47, v113
v_pk_fma_f16 v127, v126, v126, s48
v_pk_mul_f16 v125, v124, v125
v_pk_mul_f16 v127, v126, v127
v_fma_mix_f32 v224, v102, v102, v224 op_sel_hi:[1,1,0]
v_cvt_pkrtz_f16_f32 v116, v116, v117
v_fma_mix_f32 v224, v103, v103, v224 op_sel_hi:[1,1,0]
ds_read_u16 v115, v115
ds_read_u16 v113, v113
ds_read_b128 v[188:191], v250 offset:15360
v_cvt_pkrtz_f16_f32 v117, v118, v119
v_lshrrev_b64 v[116:117], 2, v[116:117]
v_and_b32_sdwa v118, s47, v116 dst_sel:DWORD dst_unused:UNUSED_PAD src0_sel:DWORD src1_sel:WORD_1
v_and_b32_e64 v116, s47, v116
v_exp_f16_sdwa v125, v125 dst_sel:WORD_0 dst_unused:UNUSED_PRESERVE src0_sel:WORD_0
v_mfma_f32_32x32x16_bf16 v[144:159], v[4:7], v[180:183], v[144:159]
ds_read_u16 v118, v118
ds_read_u16 v116, v116
v_exp_f16_sdwa v127, v127 dst_sel:WORD_0 dst_unused:UNUSED_PRESERVE src0_sel:WORD_0
v_fma_mix_f32 v224, v104, v104, v224 op_sel_hi:[1,1,0]
v_and_b32_sdwa v119, s47, v117 dst_sel:DWORD dst_unused:UNUSED_PAD src0_sel:DWORD src1_sel:WORD_1
s_waitcnt lgkmcnt(7)
v_fma_mix_f32 v224, v105, v105, v224 op_sel_hi:[1,1,0]
v_and_b32 v117, s47, v117
v_exp_f16_sdwa v125, v125 dst_sel:WORD_1 dst_unused:UNUSED_PRESERVE src0_sel:WORD_1
v_fma_mix_f32 v224, v106, v106, v224 op_sel_hi:[1,1,0]
v_cvt_pkrtz_f16_f32 v120, v120, v121
v_fma_mix_f32 v224, v107, v107, v224 op_sel_hi:[1,1,0]
v_cvt_pkrtz_f16_f32 v121, v122, v123
v_lshrrev_b64 v[120:121], 2, v[120:121]
ds_read_u16 v119, v119
ds_read_u16 v117, v117
v_and_b32_sdwa v122, s47, v120 dst_sel:DWORD dst_unused:UNUSED_PAD src0_sel:DWORD src1_sel:WORD_1
v_and_b32_e64 v120, s47, v120
v_exp_f16_sdwa v127, v127 dst_sel:WORD_1 dst_unused:UNUSED_PRESERVE src0_sel:WORD_1
v_mfma_f32_32x32x16_bf16 v[160:175], v[28:31], v[180:183], v[160:175]
ds_read_u16 v122, v122
ds_read_u16 v120, v120
ds_read_b128 v[176:179], v250 offset:16384
v_and_b32_sdwa v123, s47, v121 dst_sel:DWORD dst_unused:UNUSED_PAD src0_sel:DWORD src1_sel:WORD_1
v_and_b32_e64 v121, s47, v121
v_pk_add_f16 v125, v125, 1.0 op_sel_hi:[1,0]
v_pk_add_f16 v127, v127, 1.0 op_sel_hi:[1,0]
v_rcp_f16_sdwa v125, v125 dst_sel:WORD_0 dst_unused:UNUSED_PRESERVE src0_sel:WORD_0
v_mfma_f32_32x32x16_bf16 v[144:159], v[8:11], v[184:187], v[144:159]
ds_read_u16 v123, v123
ds_read_u16 v121, v121
v_rcp_f16_sdwa v127, v127 dst_sel:WORD_0 dst_unused:UNUSED_PRESERVE src0_sel:WORD_0
v_rcp_f16_sdwa v125, v125 dst_sel:WORD_1 dst_unused:UNUSED_PRESERVE src0_sel:WORD_1
v_rcp_f16_sdwa v127, v127 dst_sel:WORD_1 dst_unused:UNUSED_PRESERVE src0_sel:WORD_1
v_mfma_f32_32x32x16_bf16 v[160:175], v[32:35], v[184:187], v[160:175]
ds_read_b128 v[180:183], v250 offset:17408
v_pk_mul_f16 v124, v124, v125
v_pk_mul_f16 v126, v126, v127
v_fma_mix_f32 v225, v124, v124, v225 op_sel_hi:[1,1,0]
v_cvt_pkrtz_f16_f32 v128, v128, v129
v_fma_mix_f32 v225, v126, v126, v225 op_sel_hi:[1,1,0]
s_waitcnt lgkmcnt(7)
v_mfma_f32_32x32x16_bf16 v[144:159], v[12:15], v[188:191], v[144:159]
v_fma_mix_f32 v225, v124, v124, v225 op_sel:[1,1,0] op_sel_hi:[1,1,0]
v_cvt_pkrtz_f16_f32 v129, v130, v131
v_fma_mix_f32 v225, v126, v126, v225 op_sel:[1,1,0] op_sel_hi:[1,1,0]
v_lshrrev_b64 v[128:129], 2, v[128:129]
v_fma_mix_f32 v225, v112, v112, v225 op_sel_hi:[1,1,0]
v_and_b32_sdwa v130, s47, v128 dst_sel:DWORD dst_unused:UNUSED_PAD src0_sel:DWORD src1_sel:WORD_1
v_fma_mix_f32 v225, v113, v113, v225 op_sel_hi:[1,1,0]
v_and_b32 v128, s47, v128
v_fma_mix_f32 v225, v114, v114, v225 op_sel_hi:[1,1,0]
v_cvt_pk_f16_f32 v140, v140, v141
v_fma_mix_f32 v225, v115, v115, v225 op_sel_hi:[1,1,0]
v_cvt_pk_f16_f32 v142, v142, v143
v_pk_fma_f16 v141, v140, v140, s48
v_mfma_f32_32x32x16_bf16 v[160:175], v[36:39], v[188:191], v[160:175]
ds_read_u16 v130, v130
ds_read_u16 v128, v128
v_fma_mix_f32 v225, v116, v116, v225 op_sel_hi:[1,1,0]
v_and_b32_sdwa v131, s47, v129 dst_sel:DWORD dst_unused:UNUSED_PAD src0_sel:DWORD src1_sel:WORD_1
s_waitcnt lgkmcnt(5)
v_fma_mix_f32 v225, v117, v117, v225 op_sel_hi:[1,1,0]
v_and_b32 v129, s47, v129
v_pk_fma_f16 v143, v142, v142, s48
v_pk_mul_f16 v141, v140, v141
v_pk_mul_f16 v143, v142, v143
v_fma_mix_f32 v225, v118, v118, v225 op_sel_hi:[1,1,0]
v_cvt_pkrtz_f16_f32 v132, v132, v133
v_fma_mix_f32 v225, v119, v119, v225 op_sel_hi:[1,1,0]
ds_read_u16 v131, v131
ds_read_u16 v129, v129
ds_read_b128 v[184:187], v250 offset:18432
v_cvt_pkrtz_f16_f32 v133, v134, v135
v_lshrrev_b64 v[132:133], 2, v[132:133]
v_and_b32_sdwa v134, s47, v132 dst_sel:DWORD dst_unused:UNUSED_PAD src0_sel:DWORD src1_sel:WORD_1
v_and_b32_e64 v132, s47, v132
v_exp_f16_sdwa v141, v141 dst_sel:WORD_0 dst_unused:UNUSED_PRESERVE src0_sel:WORD_0
v_mfma_f32_32x32x16_bf16 v[144:159], v[16:19], v[176:179], v[144:159]
ds_read_u16 v134, v134
ds_read_u16 v132, v132
v_exp_f16_sdwa v143, v143 dst_sel:WORD_0 dst_unused:UNUSED_PRESERVE src0_sel:WORD_0
v_fma_mix_f32 v225, v120, v120, v225 op_sel_hi:[1,1,0]
v_and_b32_sdwa v135, s47, v133 dst_sel:DWORD dst_unused:UNUSED_PAD src0_sel:DWORD src1_sel:WORD_1
s_waitcnt lgkmcnt(7)
v_fma_mix_f32 v225, v121, v121, v225 op_sel_hi:[1,1,0]
v_and_b32 v133, s47, v133
v_exp_f16_sdwa v141, v141 dst_sel:WORD_1 dst_unused:UNUSED_PRESERVE src0_sel:WORD_1
v_fma_mix_f32 v225, v122, v122, v225 op_sel_hi:[1,1,0]
v_cvt_pkrtz_f16_f32 v136, v136, v137
v_fma_mix_f32 v225, v123, v123, v225 op_sel_hi:[1,1,0]
v_cvt_pkrtz_f16_f32 v137, v138, v139
v_lshrrev_b64 v[136:137], 2, v[136:137]
ds_read_u16 v135, v135
ds_read_u16 v133, v133
v_and_b32_sdwa v138, s47, v136 dst_sel:DWORD dst_unused:UNUSED_PAD src0_sel:DWORD src1_sel:WORD_1
v_and_b32_e64 v136, s47, v136
v_exp_f16_sdwa v143, v143 dst_sel:WORD_1 dst_unused:UNUSED_PRESERVE src0_sel:WORD_1
v_mfma_f32_32x32x16_bf16 v[160:175], v[40:43], v[176:179], v[160:175]
ds_read_u16 v138, v138
ds_read_u16 v136, v136
ds_read_b128 v[188:191], v250 offset:19456
v_and_b32_sdwa v139, s47, v137 dst_sel:DWORD dst_unused:UNUSED_PAD src0_sel:DWORD src1_sel:WORD_1
v_and_b32_e64 v137, s47, v137
v_pk_add_f16 v141, v141, 1.0 op_sel_hi:[1,0]
v_pk_add_f16 v143, v143, 1.0 op_sel_hi:[1,0]
v_rcp_f16_sdwa v141, v141 dst_sel:WORD_0 dst_unused:UNUSED_PRESERVE src0_sel:WORD_0
v_mfma_f32_32x32x16_bf16 v[144:159], v[20:23], v[180:183], v[144:159]
ds_read_u16 v139, v139
ds_read_u16 v137, v137
v_rcp_f16_sdwa v143, v143 dst_sel:WORD_0 dst_unused:UNUSED_PRESERVE src0_sel:WORD_0
v_rcp_f16_sdwa v141, v141 dst_sel:WORD_1 dst_unused:UNUSED_PRESERVE src0_sel:WORD_1
v_rcp_f16_sdwa v143, v143 dst_sel:WORD_1 dst_unused:UNUSED_PRESERVE src0_sel:WORD_1
v_mfma_f32_32x32x16_bf16 v[160:175], v[44:47], v[180:183], v[160:175]
ds_read_b128 v[176:179], v250 offset:20480
v_pk_mul_f16 v140, v140, v141
v_pk_mul_f16 v142, v142, v143
v_fma_mix_f32 v225, v140, v140, v225 op_sel_hi:[1,1,0]
s_nop 1
v_cvt_pkrtz_f16_f32 v144, v144, v145
v_fma_mix_f32 v225, v142, v142, v225 op_sel_hi:[1,1,0]
s_waitcnt lgkmcnt(7)
v_mfma_f32_32x32x16_bf16 v[96:111], v[0:3], v[184:187], 0
v_fma_mix_f32 v225, v140, v140, v225 op_sel:[1,1,0] op_sel_hi:[1,1,0]
v_cvt_pkrtz_f16_f32 v145, v146, v147
v_fma_mix_f32 v225, v142, v142, v225 op_sel:[1,1,0] op_sel_hi:[1,1,0]
v_lshrrev_b64 v[144:145], 2, v[144:145]
v_fma_mix_f32 v225, v128, v128, v225 op_sel_hi:[1,1,0]
v_and_b32_sdwa v146, s47, v144 dst_sel:DWORD dst_unused:UNUSED_PAD src0_sel:DWORD src1_sel:WORD_1
v_fma_mix_f32 v225, v129, v129, v225 op_sel_hi:[1,1,0]
v_and_b32_e64 v144, s47, v144
v_fma_mix_f32 v225, v130, v130, v225 op_sel_hi:[1,1,0]
v_cvt_pk_f16_f32 v156, v156, v157
v_fma_mix_f32 v225, v131, v131, v225 op_sel_hi:[1,1,0]
v_cvt_pk_f16_f32 v158, v158, v159
v_pk_fma_f16 v157, v156, v156, s48
v_mfma_f32_32x32x16_bf16 v[112:127], v[24:27], v[184:187], 0
ds_read_u16 v146, v146
ds_read_u16 v144, v144
v_fma_mix_f32 v225, v132, v132, v225 op_sel_hi:[1,1,0]
v_and_b32_sdwa v147, s47, v145 dst_sel:DWORD dst_unused:UNUSED_PAD src0_sel:DWORD src1_sel:WORD_1
s_waitcnt lgkmcnt(5)
v_fma_mix_f32 v225, v133, v133, v225 op_sel_hi:[1,1,0]
v_and_b32 v145, s47, v145
v_pk_fma_f16 v159, v158, v158, s48
v_pk_mul_f16 v157, v156, v157
v_pk_mul_f16 v159, v158, v159
v_fma_mix_f32 v225, v134, v134, v225 op_sel_hi:[1,1,0]
v_cvt_pkrtz_f16_f32 v148, v148, v149
v_fma_mix_f32 v225, v135, v135, v225 op_sel_hi:[1,1,0]
ds_read_u16 v147, v147
ds_read_u16 v145, v145
ds_read_b128 v[180:183], v250 offset:21504
v_cvt_pkrtz_f16_f32 v149, v150, v151
v_lshrrev_b64 v[148:149], 2, v[148:149]
v_and_b32_sdwa v150, s47, v148 dst_sel:DWORD dst_unused:UNUSED_PAD src0_sel:DWORD src1_sel:WORD_1
v_and_b32_e64 v148, s47, v148
v_exp_f16_sdwa v157, v157 dst_sel:WORD_0 dst_unused:UNUSED_PRESERVE src0_sel:WORD_0
v_mfma_f32_32x32x16_bf16 v[96:111], v[4:7], v[188:191], v[96:111]
ds_read_u16 v150, v150
ds_read_u16 v148, v148
v_exp_f16_sdwa v159, v159 dst_sel:WORD_0 dst_unused:UNUSED_PRESERVE src0_sel:WORD_0
v_fma_mix_f32 v225, v136, v136, v225 op_sel_hi:[1,1,0]
v_and_b32_sdwa v151, s47, v149 dst_sel:DWORD dst_unused:UNUSED_PAD src0_sel:DWORD src1_sel:WORD_1
s_waitcnt lgkmcnt(7)
v_fma_mix_f32 v225, v137, v137, v225 op_sel_hi:[1,1,0]
v_and_b32 v149, s47, v149
v_exp_f16_sdwa v157, v157 dst_sel:WORD_1 dst_unused:UNUSED_PRESERVE src0_sel:WORD_1
v_fma_mix_f32 v225, v138, v138, v225 op_sel_hi:[1,1,0]
v_cvt_pkrtz_f16_f32 v152, v152, v153
v_fma_mix_f32 v225, v139, v139, v225 op_sel_hi:[1,1,0]
v_cvt_pkrtz_f16_f32 v153, v154, v155
v_lshrrev_b64 v[152:153], 2, v[152:153]
ds_read_u16 v151, v151
ds_read_u16 v149, v149
v_and_b32_sdwa v154, s47, v152 dst_sel:DWORD dst_unused:UNUSED_PAD src0_sel:DWORD src1_sel:WORD_1
v_and_b32_e64 v152, s47, v152
v_exp_f16_sdwa v159, v159 dst_sel:WORD_1 dst_unused:UNUSED_PRESERVE src0_sel:WORD_1
v_mfma_f32_32x32x16_bf16 v[112:127], v[28:31], v[188:191], v[112:127]
ds_read_u16 v154, v154
ds_read_u16 v152, v152
ds_read_b128 v[184:187], v250 offset:22528
v_and_b32_sdwa v155, s47, v153 dst_sel:DWORD dst_unused:UNUSED_PAD src0_sel:DWORD src1_sel:WORD_1
v_and_b32_e64 v153, s47, v153
v_pk_add_f16 v157, v157, 1.0 op_sel_hi:[1,0]
v_pk_add_f16 v159, v159, 1.0 op_sel_hi:[1,0]
v_rcp_f16_sdwa v157, v157 dst_sel:WORD_0 dst_unused:UNUSED_PRESERVE src0_sel:WORD_0
v_mfma_f32_32x32x16_bf16 v[96:111], v[8:11], v[176:179], v[96:111]
ds_read_u16 v155, v155
ds_read_u16 v153, v153
v_rcp_f16_sdwa v159, v159 dst_sel:WORD_0 dst_unused:UNUSED_PRESERVE src0_sel:WORD_0
v_rcp_f16_sdwa v157, v157 dst_sel:WORD_1 dst_unused:UNUSED_PRESERVE src0_sel:WORD_1
v_rcp_f16_sdwa v159, v159 dst_sel:WORD_1 dst_unused:UNUSED_PRESERVE src0_sel:WORD_1
v_mfma_f32_32x32x16_bf16 v[112:127], v[32:35], v[176:179], v[112:127]
ds_read_b128 v[188:191], v250 offset:23552
v_mov_b32_e64 v223, 0
s_branch Law3
Lax3:
s_sleep 2
Law3:
ds_read_b32 v223, v247 offset:12
s_sub_u32 s76, s76, 1
s_cselect_b32 s44, 4, 0
s_cselect_b32 s76, 0, s76
s_waitcnt lgkmcnt(0)
v_readfirstlane_b32 s43, v223
s_nop 1
s_max_u32 s43, s43, s44
s_cmp_lt_u32 s43, 4
s_cbranch_scc1 Lax3
v_pk_mul_f16 v156, v156, v157
v_pk_mul_f16 v158, v158, v159
v_fma_mix_f32 v226, v156, v156, v226 op_sel_hi:[1,1,0]
v_mfma_f32_32x32x16_bf16 v[96:111], v[12:15], v[180:183], v[96:111]
v_fma_mix_f32 v226, v158, v158, v226 op_sel_hi:[1,1,0]
s_setprio 3
v_cvt_pkrtz_f16_f32 v160, v160, v161
v_fma_mix_f32 v226, v156, v156, v226 op_sel:[1,1,0] op_sel_hi:[1,1,0]
v_cvt_pkrtz_f16_f32 v161, v162, v163
v_fma_mix_f32 v226, v158, v158, v226 op_sel:[1,1,0] op_sel_hi:[1,1,0]
v_lshrrev_b64 v[160:161], 2, v[160:161]
v_fma_mix_f32 v226, v144, v144, v226 op_sel_hi:[1,1,0]
v_and_b32_sdwa v162, s47, v160 dst_sel:DWORD dst_unused:UNUSED_PAD src0_sel:DWORD src1_sel:WORD_1
v_fma_mix_f32 v226, v145, v145, v226 op_sel_hi:[1,1,0]
v_and_b32_e64 v160, s47, v160
v_fma_mix_f32 v226, v146, v146, v226 op_sel_hi:[1,1,0]
v_cvt_pk_f16_f32 v172, v172, v173
v_fma_mix_f32 v226, v147, v147, v226 op_sel_hi:[1,1,0]
v_cvt_pk_f16_f32 v174, v174, v175
v_pk_fma_f16 v173, v172, v172, s48
v_mfma_f32_32x32x16_bf16 v[112:127], v[36:39], v[180:183], v[112:127]
ds_read_u16 v162, v162
ds_read_u16 v160, v160
v_fma_mix_f32 v226, v148, v148, v226 op_sel_hi:[1,1,0]
v_and_b32_sdwa v163, s47, v161 dst_sel:DWORD dst_unused:UNUSED_PAD src0_sel:DWORD src1_sel:WORD_1
v_fma_mix_f32 v226, v149, v149, v226 op_sel_hi:[1,1,0]
v_and_b32_e64 v161, s47, v161
v_pk_fma_f16 v175, v174, v174, s48
v_pk_mul_f16 v173, v172, v173
v_pk_mul_f16 v175, v174, v175
v_fma_mix_f32 v226, v150, v150, v226 op_sel_hi:[1,1,0]
v_cvt_pkrtz_f16_f32 v164, v164, v165
v_fma_mix_f32 v226, v151, v151, v226 op_sel_hi:[1,1,0]
ds_read_u16 v163, v163
ds_read_u16 v161, v161
ds_read_b128 v[176:179], v250 offset:24576
v_cvt_pkrtz_f16_f32 v165, v166, v167
v_lshrrev_b64 v[164:165], 2, v[164:165]
v_and_b32_sdwa v166, s47, v164 dst_sel:DWORD dst_unused:UNUSED_PAD src0_sel:DWORD src1_sel:WORD_1
v_and_b32_e64 v164, s47, v164
v_exp_f16_sdwa v173, v173 dst_sel:WORD_0 dst_unused:UNUSED_PRESERVE src0_sel:WORD_0
v_mfma_f32_32x32x16_bf16 v[96:111], v[16:19], v[184:187], v[96:111]
ds_read_u16 v166, v166
ds_read_u16 v164, v164
v_exp_f16_sdwa v175, v175 dst_sel:WORD_0 dst_unused:UNUSED_PRESERVE src0_sel:WORD_0
v_fma_mix_f32 v226, v152, v152, v226 op_sel_hi:[1,1,0]
v_and_b32_sdwa v167, s47, v165 dst_sel:DWORD dst_unused:UNUSED_PAD src0_sel:DWORD src1_sel:WORD_1
v_fma_mix_f32 v226, v153, v153, v226 op_sel_hi:[1,1,0]
v_and_b32_e64 v165, s47, v165
v_exp_f16_sdwa v173, v173 dst_sel:WORD_1 dst_unused:UNUSED_PRESERVE src0_sel:WORD_1
v_fma_mix_f32 v226, v154, v154, v226 op_sel_hi:[1,1,0]
v_cvt_pkrtz_f16_f32 v168, v168, v169
v_fma_mix_f32 v226, v155, v155, v226 op_sel_hi:[1,1,0]
v_cvt_pkrtz_f16_f32 v169, v170, v171
v_lshrrev_b64 v[168:169], 2, v[168:169]
ds_read_u16 v167, v167
ds_read_u16 v165, v165
v_and_b32_sdwa v170, s47, v168 dst_sel:DWORD dst_unused:UNUSED_PAD src0_sel:DWORD src1_sel:WORD_1
v_and_b32_e64 v168, s47, v168
v_exp_f16_sdwa v175, v175 dst_sel:WORD_1 dst_unused:UNUSED_PRESERVE src0_sel:WORD_1
v_mfma_f32_32x32x16_bf16 v[112:127], v[40:43], v[184:187], v[112:127]
ds_read_u16 v170, v170
ds_read_u16 v168, v168
ds_read_b128 v[180:183], v250 offset:25600
v_and_b32_sdwa v171, s47, v169 dst_sel:DWORD dst_unused:UNUSED_PAD src0_sel:DWORD src1_sel:WORD_1
v_and_b32_e64 v169, s47, v169
v_pk_add_f16 v173, v173, 1.0 op_sel_hi:[1,0]
v_pk_add_f16 v175, v175, 1.0 op_sel_hi:[1,0]
v_rcp_f16_sdwa v173, v173 dst_sel:WORD_0 dst_unused:UNUSED_PRESERVE src0_sel:WORD_0
v_mfma_f32_32x32x16_bf16 v[96:111], v[20:23], v[188:191], v[96:111]
ds_read_u16 v171, v171
ds_read_u16 v169, v169
v_rcp_f16_sdwa v175, v175 dst_sel:WORD_0 dst_unused:UNUSED_PRESERVE src0_sel:WORD_0
v_rcp_f16_sdwa v173, v173 dst_sel:WORD_1 dst_unused:UNUSED_PRESERVE src0_sel:WORD_1
v_rcp_f16_sdwa v175, v175 dst_sel:WORD_1 dst_unused:UNUSED_PRESERVE src0_sel:WORD_1
v_mfma_f32_32x32x16_bf16 v[112:127], v[44:47], v[188:191], v[112:127]
ds_read_b128 v[184:187], v250 offset:26624
v_pk_mul_f16 v172, v172, v173
v_pk_mul_f16 v174, v174, v175
v_fma_mix_f32 v226, v172, v172, v226 op_sel_hi:[1,1,0]
s_nop 1
v_cvt_pkrtz_f16_f32 v96, v96, v97
v_fma_mix_f32 v226, v174, v174, v226 op_sel_hi:[1,1,0]
s_waitcnt lgkmcnt(7)
v_mfma_f32_32x32x16_bf16 v[128:143], v[0:3], v[176:179], 0
v_fma_mix_f32 v226, v172, v172, v226 op_sel:[1,1,0] op_sel_hi:[1,1,0]
v_cvt_pkrtz_f16_f32 v97, v98, v99
v_fma_mix_f32 v226, v174, v174, v226 op_sel:[1,1,0] op_sel_hi:[1,1,0]
v_lshrrev_b64 v[96:97], 2, v[96:97]
v_fma_mix_f32 v226, v160, v160, v226 op_sel_hi:[1,1,0]
v_and_b32_sdwa v98, s47, v96 dst_sel:DWORD dst_unused:UNUSED_PAD src0_sel:DWORD src1_sel:WORD_1
v_fma_mix_f32 v226, v161, v161, v226 op_sel_hi:[1,1,0]
v_and_b32_e64 v96, s47, v96
v_fma_mix_f32 v226, v162, v162, v226 op_sel_hi:[1,1,0]
v_cvt_pk_f16_f32 v108, v108, v109
v_fma_mix_f32 v226, v163, v163, v226 op_sel_hi:[1,1,0]
v_cvt_pk_f16_f32 v110, v110, v111
v_pk_fma_f16 v109, v108, v108, s48
v_mfma_f32_32x32x16_bf16 v[144:159], v[24:27], v[176:179], 0
ds_read_u16 v98, v98
ds_read_u16 v96, v96
v_fma_mix_f32 v226, v164, v164, v226 op_sel_hi:[1,1,0]
v_and_b32_sdwa v99, s47, v97 dst_sel:DWORD dst_unused:UNUSED_PAD src0_sel:DWORD src1_sel:WORD_1
s_waitcnt lgkmcnt(5)
v_fma_mix_f32 v226, v165, v165, v226 op_sel_hi:[1,1,0]
v_and_b32 v97, s47, v97
v_pk_fma_f16 v111, v110, v110, s48
v_pk_mul_f16 v109, v108, v109
v_pk_mul_f16 v111, v110, v111
v_fma_mix_f32 v226, v166, v166, v226 op_sel_hi:[1,1,0]
v_cvt_pkrtz_f16_f32 v100, v100, v101
v_fma_mix_f32 v226, v167, v167, v226 op_sel_hi:[1,1,0]
ds_read_u16 v99, v99
ds_read_u16 v97, v97
ds_read_b128 v[188:191], v250 offset:27648
v_cvt_pkrtz_f16_f32 v101, v102, v103
v_lshrrev_b64 v[100:101], 2, v[100:101]
v_and_b32_sdwa v102, s47, v100 dst_sel:DWORD dst_unused:UNUSED_PAD src0_sel:DWORD src1_sel:WORD_1
v_and_b32_e64 v100, s47, v100
v_exp_f16_sdwa v109, v109 dst_sel:WORD_0 dst_unused:UNUSED_PRESERVE src0_sel:WORD_0
v_mfma_f32_32x32x16_bf16 v[128:143], v[4:7], v[180:183], v[128:143]
ds_read_u16 v102, v102
ds_read_u16 v100, v100
v_exp_f16_sdwa v111, v111 dst_sel:WORD_0 dst_unused:UNUSED_PRESERVE src0_sel:WORD_0
v_fma_mix_f32 v226, v168, v168, v226 op_sel_hi:[1,1,0]
v_and_b32_sdwa v103, s47, v101 dst_sel:DWORD dst_unused:UNUSED_PAD src0_sel:DWORD src1_sel:WORD_1
s_waitcnt lgkmcnt(7)
v_fma_mix_f32 v226, v169, v169, v226 op_sel_hi:[1,1,0]
v_and_b32 v101, s47, v101
v_exp_f16_sdwa v109, v109 dst_sel:WORD_1 dst_unused:UNUSED_PRESERVE src0_sel:WORD_1
v_fma_mix_f32 v226, v170, v170, v226 op_sel_hi:[1,1,0]
v_cvt_pkrtz_f16_f32 v104, v104, v105
v_fma_mix_f32 v226, v171, v171, v226 op_sel_hi:[1,1,0]
v_cvt_pkrtz_f16_f32 v105, v106, v107
v_lshrrev_b64 v[104:105], 2, v[104:105]
ds_read_u16 v103, v103
ds_read_u16 v101, v101
v_and_b32_sdwa v106, s47, v104 dst_sel:DWORD dst_unused:UNUSED_PAD src0_sel:DWORD src1_sel:WORD_1
v_and_b32_e64 v104, s47, v104
v_exp_f16_sdwa v111, v111 dst_sel:WORD_1 dst_unused:UNUSED_PRESERVE src0_sel:WORD_1
v_mfma_f32_32x32x16_bf16 v[144:159], v[28:31], v[180:183], v[144:159]
ds_read_u16 v106, v106
ds_read_u16 v104, v104
ds_read_b128 v[176:179], v250 offset:28672
v_and_b32_sdwa v107, s47, v105 dst_sel:DWORD dst_unused:UNUSED_PAD src0_sel:DWORD src1_sel:WORD_1
v_and_b32_e64 v105, s47, v105
v_pk_add_f16 v109, v109, 1.0 op_sel_hi:[1,0]
v_pk_add_f16 v111, v111, 1.0 op_sel_hi:[1,0]
v_rcp_f16_sdwa v109, v109 dst_sel:WORD_0 dst_unused:UNUSED_PRESERVE src0_sel:WORD_0
v_mfma_f32_32x32x16_bf16 v[128:143], v[8:11], v[184:187], v[128:143]
ds_read_u16 v107, v107
ds_read_u16 v105, v105
v_rcp_f16_sdwa v111, v111 dst_sel:WORD_0 dst_unused:UNUSED_PRESERVE src0_sel:WORD_0
v_rcp_f16_sdwa v109, v109 dst_sel:WORD_1 dst_unused:UNUSED_PRESERVE src0_sel:WORD_1
v_rcp_f16_sdwa v111, v111 dst_sel:WORD_1 dst_unused:UNUSED_PRESERVE src0_sel:WORD_1
v_mfma_f32_32x32x16_bf16 v[144:159], v[32:35], v[184:187], v[144:159]
ds_read_b128 v[180:183], v250 offset:29696
v_pk_mul_f16 v108, v108, v109
v_pk_mul_f16 v110, v110, v111
v_fma_mix_f32 v227, v108, v108, v227 op_sel_hi:[1,1,0]
v_cvt_pkrtz_f16_f32 v112, v112, v113
v_fma_mix_f32 v227, v110, v110, v227 op_sel_hi:[1,1,0]
s_waitcnt lgkmcnt(7)
v_mfma_f32_32x32x16_bf16 v[128:143], v[12:15], v[188:191], v[128:143]
v_fma_mix_f32 v227, v108, v108, v227 op_sel:[1,1,0] op_sel_hi:[1,1,0]
v_cvt_pkrtz_f16_f32 v113, v114, v115
v_fma_mix_f32 v227, v110, v110, v227 op_sel:[1,1,0] op_sel_hi:[1,1,0]
v_lshrrev_b64 v[112:113], 2, v[112:113]
v_fma_mix_f32 v227, v96, v96, v227 op_sel_hi:[1,1,0]
v_and_b32_sdwa v114, s47, v112 dst_sel:DWORD dst_unused:UNUSED_PAD src0_sel:DWORD src1_sel:WORD_1
v_fma_mix_f32 v227, v97, v97, v227 op_sel_hi:[1,1,0]
v_and_b32 v112, s47, v112
v_fma_mix_f32 v227, v98, v98, v227 op_sel_hi:[1,1,0]
v_cvt_pk_f16_f32 v124, v124, v125
v_fma_mix_f32 v227, v99, v99, v227 op_sel_hi:[1,1,0]
v_cvt_pk_f16_f32 v126, v126, v127
v_pk_fma_f16 v125, v124, v124, s48
v_mfma_f32_32x32x16_bf16 v[144:159], v[36:39], v[188:191], v[144:159]
ds_read_u16 v114, v114
ds_read_u16 v112, v112
v_fma_mix_f32 v227, v100, v100, v227 op_sel_hi:[1,1,0]
v_and_b32_sdwa v115, s47, v113 dst_sel:DWORD dst_unused:UNUSED_PAD src0_sel:DWORD src1_sel:WORD_1
s_waitcnt lgkmcnt(5)
v_fma_mix_f32 v227, v101, v101, v227 op_sel_hi:[1,1,0]
v_and_b32 v113, s47, v113
v_pk_fma_f16 v127, v126, v126, s48
v_pk_mul_f16 v125, v124, v125
v_pk_mul_f16 v127, v126, v127
v_fma_mix_f32 v227, v102, v102, v227 op_sel_hi:[1,1,0]
v_cvt_pkrtz_f16_f32 v116, v116, v117
v_fma_mix_f32 v227, v103, v103, v227 op_sel_hi:[1,1,0]
ds_read_u16 v115, v115
ds_read_u16 v113, v113
ds_read_b128 v[184:187], v250 offset:30720
v_cvt_pkrtz_f16_f32 v117, v118, v119
v_lshrrev_b64 v[116:117], 2, v[116:117]
v_and_b32_sdwa v118, s47, v116 dst_sel:DWORD dst_unused:UNUSED_PAD src0_sel:DWORD src1_sel:WORD_1
v_and_b32_e64 v116, s47, v116
v_exp_f16_sdwa v125, v125 dst_sel:WORD_0 dst_unused:UNUSED_PRESERVE src0_sel:WORD_0
v_mfma_f32_32x32x16_bf16 v[128:143], v[16:19], v[176:179], v[128:143]
ds_read_u16 v118, v118
ds_read_u16 v116, v116
v_exp_f16_sdwa v127, v127 dst_sel:WORD_0 dst_unused:UNUSED_PRESERVE src0_sel:WORD_0
v_fma_mix_f32 v227, v104, v104, v227 op_sel_hi:[1,1,0]
v_and_b32_sdwa v119, s47, v117 dst_sel:DWORD dst_unused:UNUSED_PAD src0_sel:DWORD src1_sel:WORD_1
s_waitcnt lgkmcnt(7)
v_fma_mix_f32 v227, v105, v105, v227 op_sel_hi:[1,1,0]
v_and_b32 v117, s47, v117
v_exp_f16_sdwa v125, v125 dst_sel:WORD_1 dst_unused:UNUSED_PRESERVE src0_sel:WORD_1
v_fma_mix_f32 v227, v106, v106, v227 op_sel_hi:[1,1,0]
v_cvt_pkrtz_f16_f32 v120, v120, v121
v_fma_mix_f32 v227, v107, v107, v227 op_sel_hi:[1,1,0]
v_cvt_pkrtz_f16_f32 v121, v122, v123
v_lshrrev_b64 v[120:121], 2, v[120:121]
ds_read_u16 v119, v119
ds_read_u16 v117, v117
v_and_b32_sdwa v122, s47, v120 dst_sel:DWORD dst_unused:UNUSED_PAD src0_sel:DWORD src1_sel:WORD_1
v_and_b32_e64 v120, s47, v120
v_exp_f16_sdwa v127, v127 dst_sel:WORD_1 dst_unused:UNUSED_PRESERVE src0_sel:WORD_1
v_mfma_f32_32x32x16_bf16 v[144:159], v[40:43], v[176:179], v[144:159]
ds_read_u16 v122, v122
ds_read_u16 v120, v120
ds_read_b128 v[188:191], v250 offset:31744
v_and_b32_sdwa v123, s47, v121 dst_sel:DWORD dst_unused:UNUSED_PAD src0_sel:DWORD src1_sel:WORD_1
v_and_b32_e64 v121, s47, v121
v_pk_add_f16 v125, v125, 1.0 op_sel_hi:[1,0]
v_pk_add_f16 v127, v127, 1.0 op_sel_hi:[1,0]
v_rcp_f16_sdwa v125, v125 dst_sel:WORD_0 dst_unused:UNUSED_PRESERVE src0_sel:WORD_0
v_mfma_f32_32x32x16_bf16 v[128:143], v[20:23], v[180:183], v[128:143]
ds_read_u16 v123, v123
ds_read_u16 v121, v121
v_rcp_f16_sdwa v127, v127 dst_sel:WORD_0 dst_unused:UNUSED_PRESERVE src0_sel:WORD_0
v_rcp_f16_sdwa v125, v125 dst_sel:WORD_1 dst_unused:UNUSED_PRESERVE src0_sel:WORD_1
v_rcp_f16_sdwa v127, v127 dst_sel:WORD_1 dst_unused:UNUSED_PRESERVE src0_sel:WORD_1
v_mfma_f32_32x32x16_bf16 v[144:159], v[44:47], v[180:183], v[144:159]
ds_read_b128 v[176:179], v250 offset:32768
v_pk_mul_f16 v124, v124, v125
v_pk_mul_f16 v126, v126, v127
v_fma_mix_f32 v227, v124, v124, v227 op_sel_hi:[1,1,0]
s_nop 1
v_cvt_pkrtz_f16_f32 v128, v128, v129
v_fma_mix_f32 v227, v126, v126, v227 op_sel_hi:[1,1,0]
s_waitcnt lgkmcnt(7)
v_mfma_f32_32x32x16_bf16 v[160:175], v[0:3], v[184:187], 0
v_fma_mix_f32 v227, v124, v124, v227 op_sel:[1,1,0] op_sel_hi:[1,1,0]
v_cvt_pkrtz_f16_f32 v129, v130, v131
v_fma_mix_f32 v227, v126, v126, v227 op_sel:[1,1,0] op_sel_hi:[1,1,0]
v_lshrrev_b64 v[128:129], 2, v[128:129]
v_fma_mix_f32 v227, v112, v112, v227 op_sel_hi:[1,1,0]
v_and_b32_sdwa v130, s47, v128 dst_sel:DWORD dst_unused:UNUSED_PAD src0_sel:DWORD src1_sel:WORD_1
v_fma_mix_f32 v227, v113, v113, v227 op_sel_hi:[1,1,0]
v_and_b32_e64 v128, s47, v128
v_fma_mix_f32 v227, v114, v114, v227 op_sel_hi:[1,1,0]
v_cvt_pk_f16_f32 v140, v140, v141
v_fma_mix_f32 v227, v115, v115, v227 op_sel_hi:[1,1,0]
v_cvt_pk_f16_f32 v142, v142, v143
v_pk_fma_f16 v141, v140, v140, s48
v_mfma_f32_32x32x16_bf16 v[96:111], v[24:27], v[184:187], 0
ds_read_u16 v130, v130
ds_read_u16 v128, v128
v_fma_mix_f32 v227, v116, v116, v227 op_sel_hi:[1,1,0]
v_and_b32_sdwa v131, s47, v129 dst_sel:DWORD dst_unused:UNUSED_PAD src0_sel:DWORD src1_sel:WORD_1
s_waitcnt lgkmcnt(5)
v_fma_mix_f32 v227, v117, v117, v227 op_sel_hi:[1,1,0]
v_and_b32 v129, s47, v129
v_pk_fma_f16 v143, v142, v142, s48
v_pk_mul_f16 v141, v140, v141
v_pk_mul_f16 v143, v142, v143
v_fma_mix_f32 v227, v118, v118, v227 op_sel_hi:[1,1,0]
v_cvt_pkrtz_f16_f32 v132, v132, v133
v_fma_mix_f32 v227, v119, v119, v227 op_sel_hi:[1,1,0]
ds_read_u16 v131, v131
ds_read_u16 v129, v129
ds_read_b128 v[180:183], v250 offset:33792
v_cvt_pkrtz_f16_f32 v133, v134, v135
v_lshrrev_b64 v[132:133], 2, v[132:133]
v_and_b32_sdwa v134, s47, v132 dst_sel:DWORD dst_unused:UNUSED_PAD src0_sel:DWORD src1_sel:WORD_1
v_and_b32_e64 v132, s47, v132
v_exp_f16_sdwa v141, v141 dst_sel:WORD_0 dst_unused:UNUSED_PRESERVE src0_sel:WORD_0
v_mfma_f32_32x32x16_bf16 v[160:175], v[4:7], v[188:191], v[160:175]
ds_read_u16 v134, v134
ds_read_u16 v132, v132
v_exp_f16_sdwa v143, v143 dst_sel:WORD_0 dst_unused:UNUSED_PRESERVE src0_sel:WORD_0
v_fma_mix_f32 v227, v120, v120, v227 op_sel_hi:[1,1,0]
v_and_b32_sdwa v135, s47, v133 dst_sel:DWORD dst_unused:UNUSED_PAD src0_sel:DWORD src1_sel:WORD_1
s_waitcnt lgkmcnt(7)
v_fma_mix_f32 v227, v121, v121, v227 op_sel_hi:[1,1,0]
v_and_b32 v133, s47, v133
v_exp_f16_sdwa v141, v141 dst_sel:WORD_1 dst_unused:UNUSED_PRESERVE src0_sel:WORD_1
v_fma_mix_f32 v227, v122, v122, v227 op_sel_hi:[1,1,0]
v_cvt_pkrtz_f16_f32 v136, v136, v137
v_fma_mix_f32 v227, v123, v123, v227 op_sel_hi:[1,1,0]
v_cvt_pkrtz_f16_f32 v137, v138, v139
v_lshrrev_b64 v[136:137], 2, v[136:137]
ds_read_u16 v135, v135
ds_read_u16 v133, v133
v_and_b32_sdwa v138, s47, v136 dst_sel:DWORD dst_unused:UNUSED_PAD src0_sel:DWORD src1_sel:WORD_1
v_and_b32_e64 v136, s47, v136
v_exp_f16_sdwa v143, v143 dst_sel:WORD_1 dst_unused:UNUSED_PRESERVE src0_sel:WORD_1
v_mfma_f32_32x32x16_bf16 v[96:111], v[28:31], v[188:191], v[96:111]
ds_read_u16 v138, v138
ds_read_u16 v136, v136
ds_read_b128 v[184:187], v250 offset:34816
v_and_b32_sdwa v139, s47, v137 dst_sel:DWORD dst_unused:UNUSED_PAD src0_sel:DWORD src1_sel:WORD_1
v_and_b32_e64 v137, s47, v137
v_pk_add_f16 v141, v141, 1.0 op_sel_hi:[1,0]
v_pk_add_f16 v143, v143, 1.0 op_sel_hi:[1,0]
v_rcp_f16_sdwa v141, v141 dst_sel:WORD_0 dst_unused:UNUSED_PRESERVE src0_sel:WORD_0
v_mfma_f32_32x32x16_bf16 v[160:175], v[8:11], v[176:179], v[160:175]
ds_read_u16 v139, v139
ds_read_u16 v137, v137
v_rcp_f16_sdwa v143, v143 dst_sel:WORD_0 dst_unused:UNUSED_PRESERVE src0_sel:WORD_0
v_rcp_f16_sdwa v141, v141 dst_sel:WORD_1 dst_unused:UNUSED_PRESERVE src0_sel:WORD_1
v_rcp_f16_sdwa v143, v143 dst_sel:WORD_1 dst_unused:UNUSED_PRESERVE src0_sel:WORD_1
v_mfma_f32_32x32x16_bf16 v[96:111], v[32:35], v[176:179], v[96:111]
ds_read_b128 v[188:191], v250 offset:35840
v_pk_mul_f16 v140, v140, v141
v_pk_mul_f16 v142, v142, v143
v_fma_mix_f32 v228, v140, v140, v228 op_sel_hi:[1,1,0]
s_add_u32 s66, s66, 786432
s_sub_u32 s81, s81, 13184
v_bfe_u32 v223, v250, 4, 6
v_and_b32 v222, 15, v223
v_lshlrev_b32 v222, 7, v222
v_lshrrev_b32_e64 v223, 4, v223
v_mul_u32_u24 v223, 98304, v223
s_sub_u32 s43, s67, -8000
s_mul_i32 s44, s41, 192
s_add_u32 s43, s43, s44
v_add3_u32 v222, v222, v223, s43
s_mov_b32 m0, 163840
s_add_u32 s44, s66, 393216
buffer_load_dword v222, s[4:7], s66 offen lds
buffer_load_dword v222, s[4:7], s44 offen lds
v_fma_mix_f32 v228, v142, v142, v228 op_sel_hi:[1,1,0]
s_waitcnt lgkmcnt(6)
v_mfma_f32_32x32x16_bf16 v[160:175], v[12:15], v[180:183], v[160:175]
v_fma_mix_f32 v228, v140, v140, v228 op_sel:[1,1,0] op_sel_hi:[1,1,0]
v_cvt_pkrtz_f16_f32 v144, v144, v145
v_fma_mix_f32 v228, v142, v142, v228 op_sel:[1,1,0] op_sel_hi:[1,1,0]
v_cvt_pkrtz_f16_f32 v145, v146, v147
v_fma_mix_f32 v228, v128, v128, v228 op_sel_hi:[1,1,0]
v_lshrrev_b64 v[144:145], 2, v[144:145]
v_fma_mix_f32 v228, v129, v129, v228 op_sel_hi:[1,1,0]
v_and_b32_sdwa v146, s47, v144 dst_sel:DWORD dst_unused:UNUSED_PAD src0_sel:DWORD src1_sel:WORD_1
v_fma_mix_f32 v228, v130, v130, v228 op_sel_hi:[1,1,0]
v_and_b32_e64 v144, s47, v144
v_fma_mix_f32 v228, v131, v131, v228 op_sel_hi:[1,1,0]
v_cvt_pk_f16_f32 v156, v156, v157
v_cvt_pk_f16_f32 v158, v158, v159
v_pk_fma_f16 v157, v156, v156, s48
v_mfma_f32_32x32x16_bf16 v[96:111], v[36:39], v[180:183], v[96:111]
ds_read_u16 v146, v146
ds_read_u16 v144, v144
v_fma_mix_f32 v228, v132, v132, v228 op_sel_hi:[1,1,0]
v_and_b32_sdwa v147, s47, v145 dst_sel:DWORD dst_unused:UNUSED_PAD src0_sel:DWORD src1_sel:WORD_1
v_fma_mix_f32 v228, v133, v133, v228 op_sel_hi:[1,1,0]
v_and_b32_e64 v145, s47, v145
v_pk_fma_f16 v159, v158, v158, s48
v_pk_mul_f16 v157, v156, v157
v_pk_mul_f16 v159, v158, v159
v_fma_mix_f32 v228, v134, v134, v228 op_sel_hi:[1,1,0]
v_cvt_pkrtz_f16_f32 v148, v148, v149
v_fma_mix_f32 v228, v135, v135, v228 op_sel_hi:[1,1,0]
ds_read_u16 v147, v147
ds_read_u16 v145, v145
ds_read_b128 v[176:179], v250 offset:36864
v_cvt_pkrtz_f16_f32 v149, v150, v151
v_lshrrev_b64 v[148:149], 2, v[148:149]
v_and_b32_sdwa v150, s47, v148 dst_sel:DWORD dst_unused:UNUSED_PAD src0_sel:DWORD src1_sel:WORD_1
v_and_b32 v148, s47, v148
v_exp_f16_sdwa v157, v157 dst_sel:WORD_0 dst_unused:UNUSED_PRESERVE src0_sel:WORD_0
s_waitcnt lgkmcnt(5)
v_mfma_f32_32x32x16_bf16 v[160:175], v[16:19], v[184:187], v[160:175]
ds_read_u16 v150, v150
ds_read_u16 v148, v148
v_exp_f16_sdwa v159, v159 dst_sel:WORD_0 dst_unused:UNUSED_PRESERVE src0_sel:WORD_0
v_fma_mix_f32 v228, v136, v136, v228 op_sel_hi:[1,1,0]
v_and_b32_sdwa v151, s47, v149 dst_sel:DWORD dst_unused:UNUSED_PAD src0_sel:DWORD src1_sel:WORD_1
v_fma_mix_f32 v228, v137, v137, v228 op_sel_hi:[1,1,0]
v_and_b32_e64 v149, s47, v149
v_exp_f16_sdwa v157, v157 dst_sel:WORD_1 dst_unused:UNUSED_PRESERVE src0_sel:WORD_1
v_fma_mix_f32 v228, v138, v138, v228 op_sel_hi:[1,1,0]
v_cvt_pkrtz_f16_f32 v152, v152, v153
v_fma_mix_f32 v228, v139, v139, v228 op_sel_hi:[1,1,0]
v_cvt_pkrtz_f16_f32 v153, v154, v155
v_lshrrev_b64 v[152:153], 2, v[152:153]
ds_read_u16 v151, v151
ds_read_u16 v149, v149
v_and_b32_sdwa v154, s47, v152 dst_sel:DWORD dst_unused:UNUSED_PAD src0_sel:DWORD src1_sel:WORD_1
v_and_b32_e64 v152, s47, v152
v_exp_f16_sdwa v159, v159 dst_sel:WORD_1 dst_unused:UNUSED_PRESERVE src0_sel:WORD_1
v_mfma_f32_32x32x16_bf16 v[96:111], v[40:43], v[184:187], v[96:111]
ds_read_u16 v154, v154
ds_read_u16 v152, v152
ds_read_b128 v[180:183], v250 offset:37888
v_and_b32_sdwa v155, s47, v153 dst_sel:DWORD dst_unused:UNUSED_PAD src0_sel:DWORD src1_sel:WORD_1
v_and_b32_e64 v153, s47, v153
v_pk_add_f16 v157, v157, 1.0 op_sel_hi:[1,0]
v_pk_add_f16 v159, v159, 1.0 op_sel_hi:[1,0]
v_rcp_f16_sdwa v157, v157 dst_sel:WORD_0 dst_unused:UNUSED_PRESERVE src0_sel:WORD_0
v_mfma_f32_32x32x16_bf16 v[160:175], v[20:23], v[188:191], v[160:175]
ds_read_u16 v155, v155
ds_read_u16 v153, v153
v_rcp_f16_sdwa v159, v159 dst_sel:WORD_0 dst_unused:UNUSED_PRESERVE src0_sel:WORD_0
v_rcp_f16_sdwa v157, v157 dst_sel:WORD_1 dst_unused:UNUSED_PRESERVE src0_sel:WORD_1
v_rcp_f16_sdwa v159, v159 dst_sel:WORD_1 dst_unused:UNUSED_PRESERVE src0_sel:WORD_1
v_mfma_f32_32x32x16_bf16 v[96:111], v[44:47], v[188:191], v[96:111]
ds_read_b128 v[184:187], v250 offset:38912
v_pk_mul_f16 v156, v156, v157
v_pk_mul_f16 v158, v158, v159
v_fma_mix_f32 v228, v156, v156, v228 op_sel_hi:[1,1,0]
buffer_store_dwordx4 v[0:3], v250, s[32:35], s80 offen sc1
v_fma_mix_f32 v228, v158, v158, v228 op_sel_hi:[1,1,0]
s_waitcnt lgkmcnt(7)
v_mfma_f32_32x32x16_bf16 v[112:127], v[0:3], v[176:179], 0
v_fma_mix_f32 v228, v156, v156, v228 op_sel:[1,1,0] op_sel_hi:[1,1,0]
v_cvt_pkrtz_f16_f32 v160, v160, v161
v_fma_mix_f32 v228, v158, v158, v228 op_sel:[1,1,0] op_sel_hi:[1,1,0]
v_cvt_pkrtz_f16_f32 v161, v162, v163
v_fma_mix_f32 v228, v144, v144, v228 op_sel_hi:[1,1,0]
v_lshrrev_b64 v[160:161], 2, v[160:161]
v_fma_mix_f32 v228, v145, v145, v228 op_sel_hi:[1,1,0]
v_and_b32_sdwa v162, s47, v160 dst_sel:DWORD dst_unused:UNUSED_PAD src0_sel:DWORD src1_sel:WORD_1
v_fma_mix_f32 v228, v146, v146, v228 op_sel_hi:[1,1,0]
v_and_b32 v160, s47, v160
v_fma_mix_f32 v228, v147, v147, v228 op_sel_hi:[1,1,0]
v_cvt_pk_f16_f32 v172, v172, v173
v_cvt_pk_f16_f32 v174, v174, v175
v_pk_fma_f16 v173, v172, v172, s48
v_mfma_f32_32x32x16_bf16 v[128:143], v[24:27], v[176:179], 0
ds_read_u16 v162, v162
ds_read_u16 v160, v160
v_fma_mix_f32 v228, v148, v148, v228 op_sel_hi:[1,1,0]
v_and_b32_sdwa v163, s47, v161 dst_sel:DWORD dst_unused:UNUSED_PAD src0_sel:DWORD src1_sel:WORD_1
s_waitcnt lgkmcnt(5)
v_fma_mix_f32 v228, v149, v149, v228 op_sel_hi:[1,1,0]
v_and_b32 v161, s47, v161
v_pk_fma_f16 v175, v174, v174, s48
v_pk_mul_f16 v173, v172, v173
v_pk_mul_f16 v175, v174, v175
v_fma_mix_f32 v228, v150, v150, v228 op_sel_hi:[1,1,0]
v_cvt_pkrtz_f16_f32 v164, v164, v165
v_fma_mix_f32 v228, v151, v151, v228 op_sel_hi:[1,1,0]
ds_read_u16 v163, v163
ds_read_u16 v161, v161
ds_read_b128 v[188:191], v250 offset:39936
v_cvt_pkrtz_f16_f32 v165, v166, v167
v_lshrrev_b64 v[164:165], 2, v[164:165]
v_and_b32_sdwa v166, s47, v164 dst_sel:DWORD dst_unused:UNUSED_PAD src0_sel:DWORD src1_sel:WORD_1
v_and_b32_e64 v164, s47, v164
v_exp_f16_sdwa v173, v173 dst_sel:WORD_0 dst_unused:UNUSED_PRESERVE src0_sel:WORD_0
v_mfma_f32_32x32x16_bf16 v[112:127], v[4:7], v[180:183], v[112:127]
ds_read_u16 v166, v166
ds_read_u16 v164, v164
v_fma_mix_f32 v228, v152, v152, v228 op_sel_hi:[1,1,0]
v_exp_f16_sdwa v175, v175 dst_sel:WORD_0 dst_unused:UNUSED_PRESERVE src0_sel:WORD_0
s_waitcnt lgkmcnt(7)
v_fma_mix_f32 v228, v153, v153, v228 op_sel_hi:[1,1,0]
v_and_b32_sdwa v167, s47, v165 dst_sel:DWORD dst_unused:UNUSED_PAD src0_sel:DWORD src1_sel:WORD_1
v_and_b32 v165, s47, v165
v_exp_f16_sdwa v173, v173 dst_sel:WORD_1 dst_unused:UNUSED_PRESERVE src0_sel:WORD_1
v_fma_mix_f32 v228, v154, v154, v228 op_sel_hi:[1,1,0]
v_cvt_pkrtz_f16_f32 v168, v168, v169
v_fma_mix_f32 v228, v155, v155, v228 op_sel_hi:[1,1,0]
v_cvt_pkrtz_f16_f32 v169, v170, v171
v_lshrrev_b64 v[168:169], 2, v[168:169]
ds_read_u16 v167, v167
ds_read_u16 v165, v165
v_and_b32_sdwa v170, s47, v168 dst_sel:DWORD dst_unused:UNUSED_PAD src0_sel:DWORD src1_sel:WORD_1
v_and_b32_e64 v168, s47, v168
v_exp_f16_sdwa v175, v175 dst_sel:WORD_1 dst_unused:UNUSED_PRESERVE src0_sel:WORD_1
v_mfma_f32_32x32x16_bf16 v[128:143], v[28:31], v[180:183], v[128:143]
ds_read_u16 v170, v170
ds_read_u16 v168, v168
ds_read_b128 v[176:179], v250 offset:40960
v_and_b32_sdwa v171, s47, v169 dst_sel:DWORD dst_unused:UNUSED_PAD src0_sel:DWORD src1_sel:WORD_1
v_and_b32_e64 v169, s47, v169
v_pk_add_f16 v173, v173, 1.0 op_sel_hi:[1,0]
v_pk_add_f16 v175, v175, 1.0 op_sel_hi:[1,0]
v_rcp_f16_sdwa v173, v173 dst_sel:WORD_0 dst_unused:UNUSED_PRESERVE src0_sel:WORD_0
v_mfma_f32_32x32x16_bf16 v[112:127], v[8:11], v[184:187], v[112:127]
ds_read_u16 v171, v171
ds_read_u16 v169, v169
v_rcp_f16_sdwa v175, v175 dst_sel:WORD_0 dst_unused:UNUSED_PRESERVE src0_sel:WORD_0
v_rcp_f16_sdwa v173, v173 dst_sel:WORD_1 dst_unused:UNUSED_PRESERVE src0_sel:WORD_1
v_rcp_f16_sdwa v175, v175 dst_sel:WORD_1 dst_unused:UNUSED_PRESERVE src0_sel:WORD_1
v_mfma_f32_32x32x16_bf16 v[128:143], v[32:35], v[184:187], v[128:143]
ds_read_b128 v[180:183], v250 offset:41984
v_pk_mul_f16 v172, v172, v173
v_pk_mul_f16 v174, v174, v175
v_fma_mix_f32 v229, v172, v172, v229 op_sel_hi:[1,1,0]
v_cvt_pkrtz_f16_f32 v96, v96, v97
v_fma_mix_f32 v229, v174, v174, v229 op_sel_hi:[1,1,0]
s_waitcnt lgkmcnt(7)
v_mfma_f32_32x32x16_bf16 v[112:127], v[12:15], v[188:191], v[112:127]
v_fma_mix_f32 v229, v172, v172, v229 op_sel:[1,1,0] op_sel_hi:[1,1,0]
v_cvt_pkrtz_f16_f32 v97, v98, v99
v_fma_mix_f32 v229, v174, v174, v229 op_sel:[1,1,0] op_sel_hi:[1,1,0]
v_lshrrev_b64 v[96:97], 2, v[96:97]
v_fma_mix_f32 v229, v160, v160, v229 op_sel_hi:[1,1,0]
v_and_b32_sdwa v98, s47, v96 dst_sel:DWORD dst_unused:UNUSED_PAD src0_sel:DWORD src1_sel:WORD_1
v_fma_mix_f32 v229, v161, v161, v229 op_sel_hi:[1,1,0]
v_and_b32 v96, s47, v96
v_fma_mix_f32 v229, v162, v162, v229 op_sel_hi:[1,1,0]
v_cvt_pk_f16_f32 v108, v108, v109
v_fma_mix_f32 v229, v163, v163, v229 op_sel_hi:[1,1,0]
v_cvt_pk_f16_f32 v110, v110, v111
v_pk_fma_f16 v109, v108, v108, s48
v_mfma_f32_32x32x16_bf16 v[128:143], v[36:39], v[188:191], v[128:143]
ds_read_u16 v98, v98
ds_read_u16 v96, v96
v_fma_mix_f32 v229, v164, v164, v229 op_sel_hi:[1,1,0]
v_and_b32_sdwa v99, s47, v97 dst_sel:DWORD dst_unused:UNUSED_PAD src0_sel:DWORD src1_sel:WORD_1
s_waitcnt lgkmcnt(5)
v_fma_mix_f32 v229, v165, v165, v229 op_sel_hi:[1,1,0]
v_and_b32 v97, s47, v97
v_pk_fma_f16 v111, v110, v110, s48
v_pk_mul_f16 v109, v108, v109
v_pk_mul_f16 v111, v110, v111
v_fma_mix_f32 v229, v166, v166, v229 op_sel_hi:[1,1,0]
v_cvt_pkrtz_f16_f32 v100, v100, v101
v_fma_mix_f32 v229, v167, v167, v229 op_sel_hi:[1,1,0]
ds_read_u16 v99, v99
ds_read_u16 v97, v97
s_add_u32 s46, s80, 2097152
buffer_store_dwordx4 v[4:7], v250, s[32:35], s46 offen sc1
ds_read_b128 v[184:187], v250 offset:43008
v_cvt_pkrtz_f16_f32 v101, v102, v103
v_lshrrev_b64 v[100:101], 2, v[100:101]
v_and_b32_sdwa v102, s47, v100 dst_sel:DWORD dst_unused:UNUSED_PAD src0_sel:DWORD src1_sel:WORD_1
v_and_b32_e64 v100, s47, v100
v_exp_f16_sdwa v109, v109 dst_sel:WORD_0 dst_unused:UNUSED_PRESERVE src0_sel:WORD_0
v_mfma_f32_32x32x16_bf16 v[112:127], v[16:19], v[176:179], v[112:127]
ds_read_u16 v102, v102
ds_read_u16 v100, v100
v_fma_mix_f32 v229, v168, v168, v229 op_sel_hi:[1,1,0]
v_exp_f16_sdwa v111, v111 dst_sel:WORD_0 dst_unused:UNUSED_PRESERVE src0_sel:WORD_0
s_waitcnt lgkmcnt(7)
v_fma_mix_f32 v229, v169, v169, v229 op_sel_hi:[1,1,0]
v_and_b32_sdwa v103, s47, v101 dst_sel:DWORD dst_unused:UNUSED_PAD src0_sel:DWORD src1_sel:WORD_1
v_and_b32 v101, s47, v101
v_exp_f16_sdwa v109, v109 dst_sel:WORD_1 dst_unused:UNUSED_PRESERVE src0_sel:WORD_1
v_fma_mix_f32 v229, v170, v170, v229 op_sel_hi:[1,1,0]
v_cvt_pkrtz_f16_f32 v104, v104, v105
v_fma_mix_f32 v229, v171, v171, v229 op_sel_hi:[1,1,0]
v_cvt_pkrtz_f16_f32 v105, v106, v107
v_lshrrev_b64 v[104:105], 2, v[104:105]
ds_read_u16 v103, v103
ds_read_u16 v101, v101
v_and_b32_sdwa v106, s47, v104 dst_sel:DWORD dst_unused:UNUSED_PAD src0_sel:DWORD src1_sel:WORD_1
v_and_b32_e64 v104, s47, v104
v_exp_f16_sdwa v111, v111 dst_sel:WORD_1 dst_unused:UNUSED_PRESERVE src0_sel:WORD_1
v_mfma_f32_32x32x16_bf16 v[128:143], v[40:43], v[176:179], v[128:143]
ds_read_u16 v106, v106
ds_read_u16 v104, v104
ds_read_b128 v[188:191], v250 offset:44032
v_and_b32_sdwa v107, s47, v105 dst_sel:DWORD dst_unused:UNUSED_PAD src0_sel:DWORD src1_sel:WORD_1
v_and_b32_e64 v105, s47, v105
v_pk_add_f16 v109, v109, 1.0 op_sel_hi:[1,0]
v_pk_add_f16 v111, v111, 1.0 op_sel_hi:[1,0]
v_rcp_f16_sdwa v109, v109 dst_sel:WORD_0 dst_unused:UNUSED_PRESERVE src0_sel:WORD_0
v_mfma_f32_32x32x16_bf16 v[112:127], v[20:23], v[180:183], v[112:127]
ds_read_u16 v107, v107
ds_read_u16 v105, v105
v_rcp_f16_sdwa v111, v111 dst_sel:WORD_0 dst_unused:UNUSED_PRESERVE src0_sel:WORD_0
v_rcp_f16_sdwa v109, v109 dst_sel:WORD_1 dst_unused:UNUSED_PRESERVE src0_sel:WORD_1
v_rcp_f16_sdwa v111, v111 dst_sel:WORD_1 dst_unused:UNUSED_PRESERVE src0_sel:WORD_1
v_mfma_f32_32x32x16_bf16 v[128:143], v[44:47], v[180:183], v[128:143]
ds_read_b128 v[176:179], v250 offset:45056
v_pk_mul_f16 v108, v108, v109
v_pk_mul_f16 v110, v110, v111
v_fma_mix_f32 v229, v108, v108, v229 op_sel_hi:[1,1,0]
s_nop 1
v_cvt_pkrtz_f16_f32 v112, v112, v113
v_fma_mix_f32 v229, v110, v110, v229 op_sel_hi:[1,1,0]
s_waitcnt lgkmcnt(7)
v_mfma_f32_32x32x16_bf16 v[144:159], v[0:3], v[184:187], 0
v_fma_mix_f32 v229, v108, v108, v229 op_sel:[1,1,0] op_sel_hi:[1,1,0]
v_cvt_pkrtz_f16_f32 v113, v114, v115
v_fma_mix_f32 v229, v110, v110, v229 op_sel:[1,1,0] op_sel_hi:[1,1,0]
v_lshrrev_b64 v[112:113], 2, v[112:113]
v_fma_mix_f32 v229, v96, v96, v229 op_sel_hi:[1,1,0]
v_and_b32_sdwa v114, s47, v112 dst_sel:DWORD dst_unused:UNUSED_PAD src0_sel:DWORD src1_sel:WORD_1
v_fma_mix_f32 v229, v97, v97, v229 op_sel_hi:[1,1,0]
v_and_b32_e64 v112, s47, v112
v_fma_mix_f32 v229, v98, v98, v229 op_sel_hi:[1,1,0]
v_cvt_pk_f16_f32 v124, v124, v125
v_fma_mix_f32 v229, v99, v99, v229 op_sel_hi:[1,1,0]
v_cvt_pk_f16_f32 v126, v126, v127
v_pk_fma_f16 v125, v124, v124, s48
v_mfma_f32_32x32x16_bf16 v[160:175], v[24:27], v[184:187], 0
ds_read_u16 v114, v114
ds_read_u16 v112, v112
v_fma_mix_f32 v229, v100, v100, v229 op_sel_hi:[1,1,0]
v_and_b32_sdwa v115, s47, v113 dst_sel:DWORD dst_unused:UNUSED_PAD src0_sel:DWORD src1_sel:WORD_1
s_waitcnt lgkmcnt(5)
v_fma_mix_f32 v229, v101, v101, v229 op_sel_hi:[1,1,0]
v_and_b32 v113, s47, v113
v_pk_fma_f16 v127, v126, v126, s48
v_pk_mul_f16 v125, v124, v125
v_pk_mul_f16 v127, v126, v127
v_fma_mix_f32 v229, v102, v102, v229 op_sel_hi:[1,1,0]
v_cvt_pkrtz_f16_f32 v116, v116, v117
v_fma_mix_f32 v229, v103, v103, v229 op_sel_hi:[1,1,0]
ds_read_u16 v115, v115
ds_read_u16 v113, v113
ds_read_b128 v[180:183], v250 offset:46080
v_cvt_pkrtz_f16_f32 v117, v118, v119
v_lshrrev_b64 v[116:117], 2, v[116:117]
v_and_b32_sdwa v118, s47, v116 dst_sel:DWORD dst_unused:UNUSED_PAD src0_sel:DWORD src1_sel:WORD_1
v_and_b32_e64 v116, s47, v116
v_exp_f16_sdwa v125, v125 dst_sel:WORD_0 dst_unused:UNUSED_PRESERVE src0_sel:WORD_0
v_mfma_f32_32x32x16_bf16 v[144:159], v[4:7], v[188:191], v[144:159]
ds_read_u16 v118, v118
ds_read_u16 v116, v116
v_fma_mix_f32 v229, v104, v104, v229 op_sel_hi:[1,1,0]
v_exp_f16_sdwa v127, v127 dst_sel:WORD_0 dst_unused:UNUSED_PRESERVE src0_sel:WORD_0
s_waitcnt lgkmcnt(7)
v_fma_mix_f32 v229, v105, v105, v229 op_sel_hi:[1,1,0]
v_and_b32_sdwa v119, s47, v117 dst_sel:DWORD dst_unused:UNUSED_PAD src0_sel:DWORD src1_sel:WORD_1
v_and_b32 v117, s47, v117
v_exp_f16_sdwa v125, v125 dst_sel:WORD_1 dst_unused:UNUSED_PRESERVE src0_sel:WORD_1
v_fma_mix_f32 v229, v106, v106, v229 op_sel_hi:[1,1,0]
v_cvt_pkrtz_f16_f32 v120, v120, v121
v_fma_mix_f32 v229, v107, v107, v229 op_sel_hi:[1,1,0]
v_cvt_pkrtz_f16_f32 v121, v122, v123
v_lshrrev_b64 v[120:121], 2, v[120:121]
ds_read_u16 v119, v119
ds_read_u16 v117, v117
s_add_u32 s46, s80, 4194304
buffer_store_dwordx4 v[8:11], v250, s[32:35], s46 offen sc1
v_and_b32_sdwa v122, s47, v120 dst_sel:DWORD dst_unused:UNUSED_PAD src0_sel:DWORD src1_sel:WORD_1
v_and_b32_e64 v120, s47, v120
v_exp_f16_sdwa v127, v127 dst_sel:WORD_1 dst_unused:UNUSED_PRESERVE src0_sel:WORD_1
v_mfma_f32_32x32x16_bf16 v[160:175], v[28:31], v[188:191], v[160:175]
ds_read_u16 v122, v122
ds_read_u16 v120, v120
ds_read_b128 v[184:187], v250 offset:47104
v_and_b32_sdwa v123, s47, v121 dst_sel:DWORD dst_unused:UNUSED_PAD src0_sel:DWORD src1_sel:WORD_1
v_and_b32_e64 v121, s47, v121
v_pk_add_f16 v125, v125, 1.0 op_sel_hi:[1,0]
v_pk_add_f16 v127, v127, 1.0 op_sel_hi:[1,0]
v_rcp_f16_sdwa v125, v125 dst_sel:WORD_0 dst_unused:UNUSED_PRESERVE src0_sel:WORD_0
v_mfma_f32_32x32x16_bf16 v[144:159], v[8:11], v[176:179], v[144:159]
ds_read_u16 v123, v123
ds_read_u16 v121, v121
v_rcp_f16_sdwa v127, v127 dst_sel:WORD_0 dst_unused:UNUSED_PRESERVE src0_sel:WORD_0
v_rcp_f16_sdwa v125, v125 dst_sel:WORD_1 dst_unused:UNUSED_PRESERVE src0_sel:WORD_1
v_rcp_f16_sdwa v127, v127 dst_sel:WORD_1 dst_unused:UNUSED_PRESERVE src0_sel:WORD_1
v_mfma_f32_32x32x16_bf16 v[160:175], v[32:35], v[176:179], v[160:175]
ds_read_b128 v[188:191], v250 offset:48128
v_pk_mul_f16 v124, v124, v125
v_pk_mul_f16 v126, v126, v127
v_fma_mix_f32 v230, v124, v124, v230 op_sel_hi:[1,1,0]
v_cvt_pkrtz_f16_f32 v128, v128, v129
v_fma_mix_f32 v230, v126, v126, v230 op_sel_hi:[1,1,0]
s_waitcnt lgkmcnt(7)
v_mfma_f32_32x32x16_bf16 v[144:159], v[12:15], v[180:183], v[144:159]
v_fma_mix_f32 v230, v124, v124, v230 op_sel:[1,1,0] op_sel_hi:[1,1,0]
v_cvt_pkrtz_f16_f32 v129, v130, v131
v_fma_mix_f32 v230, v126, v126, v230 op_sel:[1,1,0] op_sel_hi:[1,1,0]
v_lshrrev_b64 v[128:129], 2, v[128:129]
v_fma_mix_f32 v230, v112, v112, v230 op_sel_hi:[1,1,0]
v_and_b32_sdwa v130, s47, v128 dst_sel:DWORD dst_unused:UNUSED_PAD src0_sel:DWORD src1_sel:WORD_1
v_fma_mix_f32 v230, v113, v113, v230 op_sel_hi:[1,1,0]
v_and_b32 v128, s47, v128
v_fma_mix_f32 v230, v114, v114, v230 op_sel_hi:[1,1,0]
v_cvt_pk_f16_f32 v140, v140, v141
v_fma_mix_f32 v230, v115, v115, v230 op_sel_hi:[1,1,0]
v_cvt_pk_f16_f32 v142, v142, v143
v_pk_fma_f16 v141, v140, v140, s48
v_mfma_f32_32x32x16_bf16 v[160:175], v[36:39], v[180:183], v[160:175]
ds_read_u16 v130, v130
ds_read_u16 v128, v128
v_fma_mix_f32 v230, v116, v116, v230 op_sel_hi:[1,1,0]
v_and_b32_sdwa v131, s47, v129 dst_sel:DWORD dst_unused:UNUSED_PAD src0_sel:DWORD src1_sel:WORD_1
s_waitcnt lgkmcnt(5)
v_fma_mix_f32 v230, v117, v117, v230 op_sel_hi:[1,1,0]
v_and_b32 v129, s47, v129
v_pk_fma_f16 v143, v142, v142, s48
v_pk_mul_f16 v141, v140, v141
v_pk_mul_f16 v143, v142, v143
v_fma_mix_f32 v230, v118, v118, v230 op_sel_hi:[1,1,0]
v_cvt_pkrtz_f16_f32 v132, v132, v133
v_fma_mix_f32 v230, v119, v119, v230 op_sel_hi:[1,1,0]
ds_read_u16 v131, v131
ds_read_u16 v129, v129
ds_read_b128 v[176:179], v250 offset:49152
v_cvt_pkrtz_f16_f32 v133, v134, v135
v_lshrrev_b64 v[132:133], 2, v[132:133]
v_and_b32_sdwa v134, s47, v132 dst_sel:DWORD dst_unused:UNUSED_PAD src0_sel:DWORD src1_sel:WORD_1
v_and_b32_e64 v132, s47, v132
v_exp_f16_sdwa v141, v141 dst_sel:WORD_0 dst_unused:UNUSED_PRESERVE src0_sel:WORD_0
v_mfma_f32_32x32x16_bf16 v[144:159], v[16:19], v[184:187], v[144:159]
ds_read_u16 v134, v134
ds_read_u16 v132, v132
v_fma_mix_f32 v230, v120, v120, v230 op_sel_hi:[1,1,0]
v_exp_f16_sdwa v143, v143 dst_sel:WORD_0 dst_unused:UNUSED_PRESERVE src0_sel:WORD_0
s_waitcnt lgkmcnt(7)
v_fma_mix_f32 v230, v121, v121, v230 op_sel_hi:[1,1,0]
v_and_b32_sdwa v135, s47, v133 dst_sel:DWORD dst_unused:UNUSED_PAD src0_sel:DWORD src1_sel:WORD_1
v_and_b32 v133, s47, v133
v_exp_f16_sdwa v141, v141 dst_sel:WORD_1 dst_unused:UNUSED_PRESERVE src0_sel:WORD_1
v_fma_mix_f32 v230, v122, v122, v230 op_sel_hi:[1,1,0]
v_cvt_pkrtz_f16_f32 v136, v136, v137
v_fma_mix_f32 v230, v123, v123, v230 op_sel_hi:[1,1,0]
v_cvt_pkrtz_f16_f32 v137, v138, v139
v_lshrrev_b64 v[136:137], 2, v[136:137]
ds_read_u16 v135, v135
ds_read_u16 v133, v133
v_and_b32_sdwa v138, s47, v136 dst_sel:DWORD dst_unused:UNUSED_PAD src0_sel:DWORD src1_sel:WORD_1
v_and_b32_e64 v136, s47, v136
v_exp_f16_sdwa v143, v143 dst_sel:WORD_1 dst_unused:UNUSED_PRESERVE src0_sel:WORD_1
v_mfma_f32_32x32x16_bf16 v[160:175], v[40:43], v[184:187], v[160:175]
ds_read_u16 v138, v138
ds_read_u16 v136, v136
ds_read_b128 v[180:183], v250 offset:50176
v_and_b32_sdwa v139, s47, v137 dst_sel:DWORD dst_unused:UNUSED_PAD src0_sel:DWORD src1_sel:WORD_1
v_and_b32_e64 v137, s47, v137
v_pk_add_f16 v141, v141, 1.0 op_sel_hi:[1,0]
v_pk_add_f16 v143, v143, 1.0 op_sel_hi:[1,0]
v_rcp_f16_sdwa v141, v141 dst_sel:WORD_0 dst_unused:UNUSED_PRESERVE src0_sel:WORD_0
v_mfma_f32_32x32x16_bf16 v[144:159], v[20:23], v[188:191], v[144:159]
ds_read_u16 v139, v139
ds_read_u16 v137, v137
s_add_u32 s46, s80, 6291456
buffer_store_dwordx4 v[12:15], v250, s[32:35], s46 offen sc1
v_rcp_f16_sdwa v143, v143 dst_sel:WORD_0 dst_unused:UNUSED_PRESERVE src0_sel:WORD_0
v_rcp_f16_sdwa v141, v141 dst_sel:WORD_1 dst_unused:UNUSED_PRESERVE src0_sel:WORD_1
v_rcp_f16_sdwa v143, v143 dst_sel:WORD_1 dst_unused:UNUSED_PRESERVE src0_sel:WORD_1
v_mfma_f32_32x32x16_bf16 v[160:175], v[44:47], v[188:191], v[160:175]
ds_read_b128 v[184:187], v250 offset:51200
v_pk_mul_f16 v140, v140, v141
v_pk_mul_f16 v142, v142, v143
v_fma_mix_f32 v230, v140, v140, v230 op_sel_hi:[1,1,0]
v_cvt_pkrtz_f16_f32 v144, v144, v145
v_fma_mix_f32 v230, v142, v142, v230 op_sel_hi:[1,1,0]
s_waitcnt lgkmcnt(7)
v_mfma_f32_32x32x16_bf16 v[96:111], v[0:3], v[176:179], 0
v_fma_mix_f32 v230, v140, v140, v230 op_sel:[1,1,0] op_sel_hi:[1,1,0]
v_cvt_pkrtz_f16_f32 v145, v146, v147
v_fma_mix_f32 v230, v142, v142, v230 op_sel:[1,1,0] op_sel_hi:[1,1,0]
v_lshrrev_b64 v[144:145], 2, v[144:145]
v_fma_mix_f32 v230, v128, v128, v230 op_sel_hi:[1,1,0]
v_and_b32_sdwa v146, s47, v144 dst_sel:DWORD dst_unused:UNUSED_PAD src0_sel:DWORD src1_sel:WORD_1
v_fma_mix_f32 v230, v129, v129, v230 op_sel_hi:[1,1,0]
v_and_b32 v144, s47, v144
v_fma_mix_f32 v230, v130, v130, v230 op_sel_hi:[1,1,0]
v_cvt_pk_f16_f32 v156, v156, v157
v_fma_mix_f32 v230, v131, v131, v230 op_sel_hi:[1,1,0]
v_cvt_pk_f16_f32 v158, v158, v159
v_pk_fma_f16 v157, v156, v156, s48
v_mfma_f32_32x32x16_bf16 v[112:127], v[24:27], v[176:179], 0
ds_read_u16 v146, v146
ds_read_u16 v144, v144
v_fma_mix_f32 v230, v132, v132, v230 op_sel_hi:[1,1,0]
v_and_b32_sdwa v147, s47, v145 dst_sel:DWORD dst_unused:UNUSED_PAD src0_sel:DWORD src1_sel:WORD_1
s_waitcnt lgkmcnt(5)
v_fma_mix_f32 v230, v133, v133, v230 op_sel_hi:[1,1,0]
v_and_b32 v145, s47, v145
v_pk_fma_f16 v159, v158, v158, s48
v_pk_mul_f16 v157, v156, v157
v_pk_mul_f16 v159, v158, v159
v_fma_mix_f32 v230, v134, v134, v230 op_sel_hi:[1,1,0]
v_cvt_pkrtz_f16_f32 v148, v148, v149
v_fma_mix_f32 v230, v135, v135, v230 op_sel_hi:[1,1,0]
ds_read_u16 v147, v147
ds_read_u16 v145, v145
ds_read_b128 v[188:191], v250 offset:52224
v_cvt_pkrtz_f16_f32 v149, v150, v151
v_lshrrev_b64 v[148:149], 2, v[148:149]
v_and_b32_sdwa v150, s47, v148 dst_sel:DWORD dst_unused:UNUSED_PAD src0_sel:DWORD src1_sel:WORD_1
v_and_b32_e64 v148, s47, v148
v_exp_f16_sdwa v157, v157 dst_sel:WORD_0 dst_unused:UNUSED_PRESERVE src0_sel:WORD_0
v_mfma_f32_32x32x16_bf16 v[96:111], v[4:7], v[180:183], v[96:111]
ds_read_u16 v150, v150
ds_read_u16 v148, v148
v_fma_mix_f32 v230, v136, v136, v230 op_sel_hi:[1,1,0]
v_exp_f16_sdwa v159, v159 dst_sel:WORD_0 dst_unused:UNUSED_PRESERVE src0_sel:WORD_0
s_waitcnt lgkmcnt(7)
v_fma_mix_f32 v230, v137, v137, v230 op_sel_hi:[1,1,0]
v_and_b32_sdwa v151, s47, v149 dst_sel:DWORD dst_unused:UNUSED_PAD src0_sel:DWORD src1_sel:WORD_1
v_and_b32 v149, s47, v149
v_exp_f16_sdwa v157, v157 dst_sel:WORD_1 dst_unused:UNUSED_PRESERVE src0_sel:WORD_1
v_fma_mix_f32 v230, v138, v138, v230 op_sel_hi:[1,1,0]
v_cvt_pkrtz_f16_f32 v152, v152, v153
v_fma_mix_f32 v230, v139, v139, v230 op_sel_hi:[1,1,0]
v_cvt_pkrtz_f16_f32 v153, v154, v155
v_lshrrev_b64 v[152:153], 2, v[152:153]
ds_read_u16 v151, v151
ds_read_u16 v149, v149
v_and_b32_sdwa v154, s47, v152 dst_sel:DWORD dst_unused:UNUSED_PAD src0_sel:DWORD src1_sel:WORD_1
v_and_b32_e64 v152, s47, v152
v_exp_f16_sdwa v159, v159 dst_sel:WORD_1 dst_unused:UNUSED_PRESERVE src0_sel:WORD_1
v_mfma_f32_32x32x16_bf16 v[112:127], v[28:31], v[180:183], v[112:127]
ds_read_u16 v154, v154
ds_read_u16 v152, v152
ds_read_b128 v[176:179], v250 offset:53248
v_and_b32_sdwa v155, s47, v153 dst_sel:DWORD dst_unused:UNUSED_PAD src0_sel:DWORD src1_sel:WORD_1
v_and_b32_e64 v153, s47, v153
v_pk_add_f16 v157, v157, 1.0 op_sel_hi:[1,0]
v_pk_add_f16 v159, v159, 1.0 op_sel_hi:[1,0]
v_rcp_f16_sdwa v157, v157 dst_sel:WORD_0 dst_unused:UNUSED_PRESERVE src0_sel:WORD_0
v_mfma_f32_32x32x16_bf16 v[96:111], v[8:11], v[184:187], v[96:111]
ds_read_u16 v155, v155
ds_read_u16 v153, v153
v_rcp_f16_sdwa v159, v159 dst_sel:WORD_0 dst_unused:UNUSED_PRESERVE src0_sel:WORD_0
v_rcp_f16_sdwa v157, v157 dst_sel:WORD_1 dst_unused:UNUSED_PRESERVE src0_sel:WORD_1
s_add_u32 s46, s80, 8388608
buffer_store_dwordx4 v[16:19], v250, s[32:35], s46 offen sc1
v_rcp_f16_sdwa v159, v159 dst_sel:WORD_1 dst_unused:UNUSED_PRESERVE src0_sel:WORD_1
v_mfma_f32_32x32x16_bf16 v[112:127], v[32:35], v[184:187], v[112:127]
ds_read_b128 v[180:183], v250 offset:54272
v_pk_mul_f16 v156, v156, v157
v_pk_mul_f16 v158, v158, v159
v_fma_mix_f32 v231, v156, v156, v231 op_sel_hi:[1,1,0]
v_cvt_pkrtz_f16_f32 v160, v160, v161
v_fma_mix_f32 v231, v158, v158, v231 op_sel_hi:[1,1,0]
s_waitcnt lgkmcnt(7)
v_mfma_f32_32x32x16_bf16 v[96:111], v[12:15], v[188:191], v[96:111]
v_fma_mix_f32 v231, v156, v156, v231 op_sel:[1,1,0] op_sel_hi:[1,1,0]
v_cvt_pkrtz_f16_f32 v161, v162, v163
v_fma_mix_f32 v231, v158, v158, v231 op_sel:[1,1,0] op_sel_hi:[1,1,0]
v_lshrrev_b64 v[160:161], 2, v[160:161]
v_fma_mix_f32 v231, v144, v144, v231 op_sel_hi:[1,1,0]
v_and_b32_sdwa v162, s47, v160 dst_sel:DWORD dst_unused:UNUSED_PAD src0_sel:DWORD src1_sel:WORD_1
v_fma_mix_f32 v231, v145, v145, v231 op_sel_hi:[1,1,0]
v_and_b32 v160, s47, v160
v_fma_mix_f32 v231, v146, v146, v231 op_sel_hi:[1,1,0]
v_cvt_pk_f16_f32 v172, v172, v173
v_fma_mix_f32 v231, v147, v147, v231 op_sel_hi:[1,1,0]
v_cvt_pk_f16_f32 v174, v174, v175
v_pk_fma_f16 v173, v172, v172, s48
v_mfma_f32_32x32x16_bf16 v[112:127], v[36:39], v[188:191], v[112:127]
ds_read_u16 v162, v162
ds_read_u16 v160, v160
v_fma_mix_f32 v231, v148, v148, v231 op_sel_hi:[1,1,0]
v_and_b32_sdwa v163, s47, v161 dst_sel:DWORD dst_unused:UNUSED_PAD src0_sel:DWORD src1_sel:WORD_1
s_waitcnt lgkmcnt(5)
v_fma_mix_f32 v231, v149, v149, v231 op_sel_hi:[1,1,0]
v_and_b32 v161, s47, v161
v_pk_fma_f16 v175, v174, v174, s48
v_pk_mul_f16 v173, v172, v173
v_pk_mul_f16 v175, v174, v175
v_fma_mix_f32 v231, v150, v150, v231 op_sel_hi:[1,1,0]
v_cvt_pkrtz_f16_f32 v164, v164, v165
v_fma_mix_f32 v231, v151, v151, v231 op_sel_hi:[1,1,0]
ds_read_u16 v163, v163
ds_read_u16 v161, v161
ds_read_b128 v[184:187], v250 offset:55296
v_cvt_pkrtz_f16_f32 v165, v166, v167
v_lshrrev_b64 v[164:165], 2, v[164:165]
v_and_b32_sdwa v166, s47, v164 dst_sel:DWORD dst_unused:UNUSED_PAD src0_sel:DWORD src1_sel:WORD_1
v_and_b32_e64 v164, s47, v164
v_exp_f16_sdwa v173, v173 dst_sel:WORD_0 dst_unused:UNUSED_PRESERVE src0_sel:WORD_0
v_mfma_f32_32x32x16_bf16 v[96:111], v[16:19], v[176:179], v[96:111]
ds_read_u16 v166, v166
ds_read_u16 v164, v164
v_fma_mix_f32 v231, v152, v152, v231 op_sel_hi:[1,1,0]
v_exp_f16_sdwa v175, v175 dst_sel:WORD_0 dst_unused:UNUSED_PRESERVE src0_sel:WORD_0
s_waitcnt lgkmcnt(7)
v_fma_mix_f32 v231, v153, v153, v231 op_sel_hi:[1,1,0]
v_and_b32_sdwa v167, s47, v165 dst_sel:DWORD dst_unused:UNUSED_PAD src0_sel:DWORD src1_sel:WORD_1
v_and_b32 v165, s47, v165
v_exp_f16_sdwa v173, v173 dst_sel:WORD_1 dst_unused:UNUSED_PRESERVE src0_sel:WORD_1
v_fma_mix_f32 v231, v154, v154, v231 op_sel_hi:[1,1,0]
v_cvt_pkrtz_f16_f32 v168, v168, v169
v_fma_mix_f32 v231, v155, v155, v231 op_sel_hi:[1,1,0]
v_cvt_pkrtz_f16_f32 v169, v170, v171
v_lshrrev_b64 v[168:169], 2, v[168:169]
ds_read_u16 v167, v167
ds_read_u16 v165, v165
v_and_b32_sdwa v170, s47, v168 dst_sel:DWORD dst_unused:UNUSED_PAD src0_sel:DWORD src1_sel:WORD_1
v_and_b32_e64 v168, s47, v168
v_exp_f16_sdwa v175, v175 dst_sel:WORD_1 dst_unused:UNUSED_PRESERVE src0_sel:WORD_1
v_mfma_f32_32x32x16_bf16 v[112:127], v[40:43], v[176:179], v[112:127]
ds_read_u16 v170, v170
ds_read_u16 v168, v168
ds_read_b128 v[188:191], v250 offset:56320
v_and_b32_sdwa v171, s47, v169 dst_sel:DWORD dst_unused:UNUSED_PAD src0_sel:DWORD src1_sel:WORD_1
v_and_b32_e64 v169, s47, v169
v_pk_add_f16 v173, v173, 1.0 op_sel_hi:[1,0]
v_pk_add_f16 v175, v175, 1.0 op_sel_hi:[1,0]
v_rcp_f16_sdwa v173, v173 dst_sel:WORD_0 dst_unused:UNUSED_PRESERVE src0_sel:WORD_0
v_mfma_f32_32x32x16_bf16 v[96:111], v[20:23], v[180:183], v[96:111]
ds_read_u16 v171, v171
ds_read_u16 v169, v169
v_rcp_f16_sdwa v175, v175 dst_sel:WORD_0 dst_unused:UNUSED_PRESERVE src0_sel:WORD_0
v_rcp_f16_sdwa v173, v173 dst_sel:WORD_1 dst_unused:UNUSED_PRESERVE src0_sel:WORD_1
v_rcp_f16_sdwa v175, v175 dst_sel:WORD_1 dst_unused:UNUSED_PRESERVE src0_sel:WORD_1
v_mfma_f32_32x32x16_bf16 v[112:127], v[44:47], v[180:183], v[112:127]
ds_read_b128 v[176:179], v250 offset:57344
v_pk_mul_f16 v172, v172, v173
v_pk_mul_f16 v174, v174, v175
v_fma_mix_f32 v231, v172, v172, v231 op_sel_hi:[1,1,0]
s_add_u32 s46, s80, 10485760
buffer_store_dwordx4 v[20:23], v250, s[32:35], s46 offen sc1
v_fma_mix_f32 v231, v174, v174, v231 op_sel_hi:[1,1,0]
s_waitcnt lgkmcnt(7)
v_mfma_f32_32x32x16_bf16 v[128:143], v[0:3], v[184:187], 0
v_fma_mix_f32 v231, v172, v172, v231 op_sel:[1,1,0] op_sel_hi:[1,1,0]
v_cvt_pkrtz_f16_f32 v96, v96, v97
v_fma_mix_f32 v231, v174, v174, v231 op_sel:[1,1,0] op_sel_hi:[1,1,0]
v_cvt_pkrtz_f16_f32 v97, v98, v99
v_fma_mix_f32 v231, v160, v160, v231 op_sel_hi:[1,1,0]
v_lshrrev_b64 v[96:97], 2, v[96:97]
v_fma_mix_f32 v231, v161, v161, v231 op_sel_hi:[1,1,0]
v_and_b32_sdwa v98, s47, v96 dst_sel:DWORD dst_unused:UNUSED_PAD src0_sel:DWORD src1_sel:WORD_1
v_fma_mix_f32 v231, v162, v162, v231 op_sel_hi:[1,1,0]
v_and_b32 v96, s47, v96
v_fma_mix_f32 v231, v163, v163, v231 op_sel_hi:[1,1,0]
v_cvt_pk_f16_f32 v108, v108, v109
v_cvt_pk_f16_f32 v110, v110, v111
v_pk_fma_f16 v109, v108, v108, s48
v_mfma_f32_32x32x16_bf16 v[144:159], v[24:27], v[184:187], 0
ds_read_u16 v98, v98
ds_read_u16 v96, v96
v_fma_mix_f32 v231, v164, v164, v231 op_sel_hi:[1,1,0]
v_and_b32_sdwa v99, s47, v97 dst_sel:DWORD dst_unused:UNUSED_PAD src0_sel:DWORD src1_sel:WORD_1
s_waitcnt lgkmcnt(5)
v_fma_mix_f32 v231, v165, v165, v231 op_sel_hi:[1,1,0]
v_and_b32 v97, s47, v97
v_pk_fma_f16 v111, v110, v110, s48
v_pk_mul_f16 v109, v108, v109
v_pk_mul_f16 v111, v110, v111
v_fma_mix_f32 v231, v166, v166, v231 op_sel_hi:[1,1,0]
v_cvt_pkrtz_f16_f32 v100, v100, v101
v_fma_mix_f32 v231, v167, v167, v231 op_sel_hi:[1,1,0]
ds_read_u16 v99, v99
ds_read_u16 v97, v97
ds_read_b128 v[180:183], v250 offset:58368
v_cvt_pkrtz_f16_f32 v101, v102, v103
v_lshrrev_b64 v[100:101], 2, v[100:101]
v_and_b32_sdwa v102, s47, v100 dst_sel:DWORD dst_unused:UNUSED_PAD src0_sel:DWORD src1_sel:WORD_1
v_and_b32_e64 v100, s47, v100
v_exp_f16_sdwa v109, v109 dst_sel:WORD_0 dst_unused:UNUSED_PRESERVE src0_sel:WORD_0
v_mfma_f32_32x32x16_bf16 v[128:143], v[4:7], v[188:191], v[128:143]
ds_read_u16 v102, v102
ds_read_u16 v100, v100
v_fma_mix_f32 v231, v168, v168, v231 op_sel_hi:[1,1,0]
v_exp_f16_sdwa v111, v111 dst_sel:WORD_0 dst_unused:UNUSED_PRESERVE src0_sel:WORD_0
s_waitcnt lgkmcnt(7)
v_fma_mix_f32 v231, v169, v169, v231 op_sel_hi:[1,1,0]
v_and_b32_sdwa v103, s47, v101 dst_sel:DWORD dst_unused:UNUSED_PAD src0_sel:DWORD src1_sel:WORD_1
v_and_b32 v101, s47, v101
v_exp_f16_sdwa v109, v109 dst_sel:WORD_1 dst_unused:UNUSED_PRESERVE src0_sel:WORD_1
v_fma_mix_f32 v231, v170, v170, v231 op_sel_hi:[1,1,0]
v_cvt_pkrtz_f16_f32 v104, v104, v105
v_fma_mix_f32 v231, v171, v171, v231 op_sel_hi:[1,1,0]
v_cvt_pkrtz_f16_f32 v105, v106, v107
v_lshrrev_b64 v[104:105], 2, v[104:105]
ds_read_u16 v103, v103
ds_read_u16 v101, v101
v_and_b32_sdwa v106, s47, v104 dst_sel:DWORD dst_unused:UNUSED_PAD src0_sel:DWORD src1_sel:WORD_1
v_and_b32_e64 v104, s47, v104
v_exp_f16_sdwa v111, v111 dst_sel:WORD_1 dst_unused:UNUSED_PRESERVE src0_sel:WORD_1
v_mfma_f32_32x32x16_bf16 v[144:159], v[28:31], v[188:191], v[144:159]
ds_read_u16 v106, v106
ds_read_u16 v104, v104
ds_read_b128 v[184:187], v250 offset:59392
v_and_b32_sdwa v107, s47, v105 dst_sel:DWORD dst_unused:UNUSED_PAD src0_sel:DWORD src1_sel:WORD_1
v_and_b32_e64 v105, s47, v105
v_pk_add_f16 v109, v109, 1.0 op_sel_hi:[1,0]
v_pk_add_f16 v111, v111, 1.0 op_sel_hi:[1,0]
v_rcp_f16_sdwa v109, v109 dst_sel:WORD_0 dst_unused:UNUSED_PRESERVE src0_sel:WORD_0
v_mfma_f32_32x32x16_bf16 v[128:143], v[8:11], v[176:179], v[128:143]
ds_read_u16 v107, v107
ds_read_u16 v105, v105
v_rcp_f16_sdwa v111, v111 dst_sel:WORD_0 dst_unused:UNUSED_PRESERVE src0_sel:WORD_0
v_rcp_f16_sdwa v109, v109 dst_sel:WORD_1 dst_unused:UNUSED_PRESERVE src0_sel:WORD_1
v_rcp_f16_sdwa v111, v111 dst_sel:WORD_1 dst_unused:UNUSED_PRESERVE src0_sel:WORD_1
v_mfma_f32_32x32x16_bf16 v[144:159], v[32:35], v[176:179], v[144:159]
ds_read_b128 v[188:191], v250 offset:60416
v_pk_mul_f16 v108, v108, v109
v_pk_mul_f16 v110, v110, v111
v_fma_mix_f32 v232, v108, v108, v232 op_sel_hi:[1,1,0]
v_add_u32_e64 v222, s83, v247
v_mov_b32 v223, 0
s_branch Law4
Lax4:
s_sleep 2
Law4:
ds_read_b32 v223, v222 offset:20
s_sub_u32 s76, s76, 1
s_cselect_b32 s44, 4, 0
s_cselect_b32 s76, 0, s76
s_waitcnt lgkmcnt(0)
v_readfirstlane_b32 s43, v223
s_nop 1
s_max_u32 s43, s43, s44
s_cmp_lt_u32 s43, 4
s_cbranch_scc1 Lax4
v_mfma_f32_32x32x16_bf16 v[128:143], v[12:15], v[180:183], v[128:143]
s_add_u32 s81, s81, 6592
s_cmp_eq_u32 s81, 65920
s_cselect_b32 s81, 0, s81
s_add_u32 s43, s81, s67
s_add_u32 m0, s43, 16
s_add_u32 s66, s66, 98304
buffer_load_dwordx4 v236, s[4:7], s66 offen lds
s_add_u32 m0, s43, 912
s_nop 0
buffer_load_dwordx4 v237, s[4:7], s66 offen lds
v_fma_mix_f32 v232, v110, v110, v232 op_sel_hi:[1,1,0]
v_cvt_pkrtz_f16_f32 v112, v112, v113
v_fma_mix_f32 v232, v108, v108, v232 op_sel:[1,1,0] op_sel_hi:[1,1,0]
v_cvt_pkrtz_f16_f32 v113, v114, v115
v_fma_mix_f32 v232, v110, v110, v232 op_sel:[1,1,0] op_sel_hi:[1,1,0]
v_lshrrev_b64 v[112:113], 2, v[112:113]
v_fma_mix_f32 v232, v96, v96, v232 op_sel_hi:[1,1,0]
v_and_b32_sdwa v114, s47, v112 dst_sel:DWORD dst_unused:UNUSED_PAD src0_sel:DWORD src1_sel:WORD_1
v_fma_mix_f32 v232, v97, v97, v232 op_sel_hi:[1,1,0]
v_and_b32_e64 v112, s47, v112
v_fma_mix_f32 v232, v98, v98, v232 op_sel_hi:[1,1,0]
v_cvt_pk_f16_f32 v124, v124, v125
v_fma_mix_f32 v232, v99, v99, v232 op_sel_hi:[1,1,0]
v_cvt_pk_f16_f32 v126, v126, v127
v_pk_fma_f16 v125, v124, v124, s48
v_mfma_f32_32x32x16_bf16 v[144:159], v[36:39], v[180:183], v[144:159]
ds_read_u16 v114, v114
ds_read_u16 v112, v112
v_fma_mix_f32 v232, v100, v100, v232 op_sel_hi:[1,1,0]
v_and_b32_sdwa v115, s47, v113 dst_sel:DWORD dst_unused:UNUSED_PAD src0_sel:DWORD src1_sel:WORD_1
v_fma_mix_f32 v232, v101, v101, v232 op_sel_hi:[1,1,0]
v_and_b32_e64 v113, s47, v113
v_pk_fma_f16 v127, v126, v126, s48
v_pk_mul_f16 v125, v124, v125
v_pk_mul_f16 v127, v126, v127
v_fma_mix_f32 v232, v102, v102, v232 op_sel_hi:[1,1,0]
v_cvt_pkrtz_f16_f32 v116, v116, v117
v_fma_mix_f32 v232, v103, v103, v232 op_sel_hi:[1,1,0]
ds_read_u16 v115, v115
ds_read_u16 v113, v113
ds_read_b128 v[176:179], v250 offset:61440
v_cvt_pkrtz_f16_f32 v117, v118, v119
v_lshrrev_b64 v[116:117], 2, v[116:117]
v_and_b32_sdwa v118, s47, v116 dst_sel:DWORD dst_unused:UNUSED_PAD src0_sel:DWORD src1_sel:WORD_1
v_and_b32_e64 v116, s47, v116
v_exp_f16_sdwa v125, v125 dst_sel:WORD_0 dst_unused:UNUSED_PRESERVE src0_sel:WORD_0
v_mfma_f32_32x32x16_bf16 v[128:143], v[16:19], v[184:187], v[128:143]
ds_read_u16 v118, v118
ds_read_u16 v116, v116
s_add_u32 s81, s81, 6592
s_cmp_eq_u32 s81, 65920
s_cselect_b32 s81, 0, s81
s_add_u32 s43, s81, s67
s_add_u32 m0, s43, 16
s_add_u32 s66, s66, 98304
buffer_load_dwordx4 v236, s[4:7], s66 offen lds
s_add_u32 m0, s43, 912
s_nop 0
buffer_load_dwordx4 v237, s[4:7], s66 offen lds
v_fma_mix_f32 v232, v104, v104, v232 op_sel_hi:[1,1,0]
v_exp_f16_sdwa v127, v127 dst_sel:WORD_0 dst_unused:UNUSED_PRESERVE src0_sel:WORD_0
v_fma_mix_f32 v232, v105, v105, v232 op_sel_hi:[1,1,0]
v_and_b32_sdwa v119, s47, v117 dst_sel:DWORD dst_unused:UNUSED_PAD src0_sel:DWORD src1_sel:WORD_1
v_and_b32_e64 v117, s47, v117
v_exp_f16_sdwa v125, v125 dst_sel:WORD_1 dst_unused:UNUSED_PRESERVE src0_sel:WORD_1
v_fma_mix_f32 v232, v106, v106, v232 op_sel_hi:[1,1,0]
v_cvt_pkrtz_f16_f32 v120, v120, v121
v_fma_mix_f32 v232, v107, v107, v232 op_sel_hi:[1,1,0]
v_cvt_pkrtz_f16_f32 v121, v122, v123
v_lshrrev_b64 v[120:121], 2, v[120:121]
ds_read_u16 v119, v119
ds_read_u16 v117, v117
v_and_b32_sdwa v122, s47, v120 dst_sel:DWORD dst_unused:UNUSED_PAD src0_sel:DWORD src1_sel:WORD_1
v_and_b32_e64 v120, s47, v120
v_exp_f16_sdwa v127, v127 dst_sel:WORD_1 dst_unused:UNUSED_PRESERVE src0_sel:WORD_1
v_mfma_f32_32x32x16_bf16 v[144:159], v[40:43], v[184:187], v[144:159]
ds_read_u16 v122, v122
ds_read_u16 v120, v120
ds_read_b128 v[180:183], v250 offset:62464
v_and_b32_sdwa v123, s47, v121 dst_sel:DWORD dst_unused:UNUSED_PAD src0_sel:DWORD src1_sel:WORD_1
v_and_b32_e64 v121, s47, v121
v_pk_add_f16 v125, v125, 1.0 op_sel_hi:[1,0]
v_pk_add_f16 v127, v127, 1.0 op_sel_hi:[1,0]
v_rcp_f16_sdwa v125, v125 dst_sel:WORD_0 dst_unused:UNUSED_PRESERVE src0_sel:WORD_0
v_mfma_f32_32x32x16_bf16 v[128:143], v[20:23], v[188:191], v[128:143]
ds_read_u16 v123, v123
ds_read_u16 v121, v121
s_add_u32 s81, s81, 6592
s_cmp_eq_u32 s81, 65920
s_cselect_b32 s81, 0, s81
s_add_u32 s43, s81, s67
s_add_u32 m0, s43, 32
s_add_u32 s66, s66, 98304
buffer_load_dwordx4 v236, s[4:7], s66 offen lds
s_add_u32 m0, s43, 928
s_nop 0
buffer_load_dwordx4 v237, s[4:7], s66 offen lds
v_rcp_f16_sdwa v127, v127 dst_sel:WORD_0 dst_unused:UNUSED_PRESERVE src0_sel:WORD_0
v_rcp_f16_sdwa v125, v125 dst_sel:WORD_1 dst_unused:UNUSED_PRESERVE src0_sel:WORD_1
v_rcp_f16_sdwa v127, v127 dst_sel:WORD_1 dst_unused:UNUSED_PRESERVE src0_sel:WORD_1
v_mfma_f32_32x32x16_bf16 v[144:159], v[44:47], v[188:191], v[144:159]
ds_read_b128 v[184:187], v250 offset:63488
v_pk_mul_f16 v124, v124, v125
v_pk_mul_f16 v126, v126, v127
s_add_u32 s81, s81, 6592
s_cmp_eq_u32 s81, 65920
s_cselect_b32 s81, 0, s81
s_add_u32 s43, s81, s67
s_add_u32 m0, s43, 32
s_add_u32 s66, s66, 98304
buffer_load_dwordx4 v236, s[4:7], s66 offen lds
s_add_u32 m0, s43, 928
s_nop 0
buffer_load_dwordx4 v237, s[4:7], s66 offen lds
v_fma_mix_f32 v232, v124, v124, v232 op_sel_hi:[1,1,0]
v_cvt_pkrtz_f16_f32 v128, v128, v129
s_waitcnt lgkmcnt(7)
v_mfma_f32_32x32x16_bf16 v[160:175], v[0:3], v[176:179], 0
v_fma_mix_f32 v232, v126, v126, v232 op_sel_hi:[1,1,0]
v_cvt_pkrtz_f16_f32 v129, v130, v131
v_fma_mix_f32 v232, v124, v124, v232 op_sel:[1,1,0] op_sel_hi:[1,1,0]
v_lshrrev_b64 v[128:129], 2, v[128:129]
v_fma_mix_f32 v232, v126, v126, v232 op_sel:[1,1,0] op_sel_hi:[1,1,0]
v_and_b32_sdwa v130, s47, v128 dst_sel:DWORD dst_unused:UNUSED_PAD src0_sel:DWORD src1_sel:WORD_1
v_fma_mix_f32 v232, v112, v112, v232 op_sel_hi:[1,1,0]
v_and_b32 v128, s47, v128
v_fma_mix_f32 v232, v113, v113, v232 op_sel_hi:[1,1,0]
v_cvt_pk_f16_f32 v140, v140, v141
v_fma_mix_f32 v232, v114, v114, v232 op_sel_hi:[1,1,0]
v_cvt_pk_f16_f32 v142, v142, v143
v_fma_mix_f32 v232, v115, v115, v232 op_sel_hi:[1,1,0]
v_pk_fma_f16 v141, v140, v140, s48
v_mfma_f32_32x32x16_bf16 v[96:111], v[24:27], v[176:179], 0
ds_read_u16 v130, v130
ds_read_u16 v128, v128
v_fma_mix_f32 v232, v116, v116, v232 op_sel_hi:[1,1,0]
v_and_b32_sdwa v131, s47, v129 dst_sel:DWORD dst_unused:UNUSED_PAD src0_sel:DWORD src1_sel:WORD_1
s_waitcnt lgkmcnt(5)
v_fma_mix_f32 v232, v117, v117, v232 op_sel_hi:[1,1,0]
v_and_b32 v129, s47, v129
v_pk_fma_f16 v143, v142, v142, s48
v_pk_mul_f16 v141, v140, v141
v_pk_mul_f16 v143, v142, v143
v_fma_mix_f32 v232, v118, v118, v232 op_sel_hi:[1,1,0]
v_cvt_pkrtz_f16_f32 v132, v132, v133
v_fma_mix_f32 v232, v119, v119, v232 op_sel_hi:[1,1,0]
ds_read_u16 v131, v131
ds_read_u16 v129, v129
ds_read_b128 v[188:191], v250 offset:64512
s_add_u32 s81, s81, 6592
s_cmp_eq_u32 s81, 65920
s_cselect_b32 s81, 0, s81
s_add_u32 s43, s81, s67
s_add_u32 m0, s43, 48
s_add_u32 s66, s66, 98304
buffer_load_dwordx4 v236, s[4:7], s66 offen lds
s_add_u32 m0, s43, 944
s_nop 0
buffer_load_dwordx4 v237, s[4:7], s66 offen lds
v_cvt_pkrtz_f16_f32 v133, v134, v135
v_lshrrev_b64 v[132:133], 2, v[132:133]
v_and_b32_sdwa v134, s47, v132 dst_sel:DWORD dst_unused:UNUSED_PAD src0_sel:DWORD src1_sel:WORD_1
v_and_b32_e64 v132, s47, v132
v_exp_f16_sdwa v141, v141 dst_sel:WORD_0 dst_unused:UNUSED_PRESERVE src0_sel:WORD_0
v_mfma_f32_32x32x16_bf16 v[160:175], v[4:7], v[180:183], v[160:175]
ds_read_u16 v134, v134
ds_read_u16 v132, v132
v_fma_mix_f32 v232, v120, v120, v232 op_sel_hi:[1,1,0]
v_exp_f16_sdwa v143, v143 dst_sel:WORD_0 dst_unused:UNUSED_PRESERVE src0_sel:WORD_0
s_waitcnt lgkmcnt(7)
v_fma_mix_f32 v232, v121, v121, v232 op_sel_hi:[1,1,0]
v_and_b32_sdwa v135, s47, v133 dst_sel:DWORD dst_unused:UNUSED_PAD src0_sel:DWORD src1_sel:WORD_1
v_and_b32 v133, s47, v133
v_exp_f16_sdwa v141, v141 dst_sel:WORD_1 dst_unused:UNUSED_PRESERVE src0_sel:WORD_1
v_fma_mix_f32 v232, v122, v122, v232 op_sel_hi:[1,1,0]
v_cvt_pkrtz_f16_f32 v136, v136, v137
v_fma_mix_f32 v232, v123, v123, v232 op_sel_hi:[1,1,0]
v_cvt_pkrtz_f16_f32 v137, v138, v139
v_lshrrev_b64 v[136:137], 2, v[136:137]
ds_read_u16 v135, v135
ds_read_u16 v133, v133
v_and_b32_sdwa v138, s47, v136 dst_sel:DWORD dst_unused:UNUSED_PAD src0_sel:DWORD src1_sel:WORD_1
v_and_b32_e64 v136, s47, v136
v_exp_f16_sdwa v143, v143 dst_sel:WORD_1 dst_unused:UNUSED_PRESERVE src0_sel:WORD_1
v_mfma_f32_32x32x16_bf16 v[96:111], v[28:31], v[180:183], v[96:111]
ds_read_u16 v138, v138
ds_read_u16 v136, v136
ds_read_b128 v[176:179], v251
v_and_b32_sdwa v139, s47, v137 dst_sel:DWORD dst_unused:UNUSED_PAD src0_sel:DWORD src1_sel:WORD_1
v_and_b32_e64 v137, s47, v137
v_pk_add_f16 v141, v141, 1.0 op_sel_hi:[1,0]
v_pk_add_f16 v143, v143, 1.0 op_sel_hi:[1,0]
v_rcp_f16_sdwa v141, v141 dst_sel:WORD_0 dst_unused:UNUSED_PRESERVE src0_sel:WORD_0
v_mfma_f32_32x32x16_bf16 v[160:175], v[8:11], v[184:187], v[160:175]
ds_read_u16 v139, v139
ds_read_u16 v137, v137
s_add_u32 s81, s81, 6592
s_cmp_eq_u32 s81, 65920
s_cselect_b32 s81, 0, s81
s_add_u32 s43, s81, s67
s_add_u32 m0, s43, 48
s_add_u32 s66, s66, 98304
buffer_load_dwordx4 v236, s[4:7], s66 offen lds
s_add_u32 m0, s43, 944
s_nop 0
buffer_load_dwordx4 v237, s[4:7], s66 offen lds
v_rcp_f16_sdwa v143, v143 dst_sel:WORD_0 dst_unused:UNUSED_PRESERVE src0_sel:WORD_0
v_rcp_f16_sdwa v141, v141 dst_sel:WORD_1 dst_unused:UNUSED_PRESERVE src0_sel:WORD_1
v_rcp_f16_sdwa v143, v143 dst_sel:WORD_1 dst_unused:UNUSED_PRESERVE src0_sel:WORD_1
v_mfma_f32_32x32x16_bf16 v[96:111], v[32:35], v[184:187], v[96:111]
ds_read_b128 v[180:183], v251 offset:1024
s_add_u32 s81, s81, 6592
s_cmp_eq_u32 s81, 65920
s_cselect_b32 s81, 0, s81
s_add_u32 s43, s81, s67
s_add_u32 m0, s43, 0
s_add_u32 s66, s66, 98304
buffer_load_dwordx4 v236, s[4:7], s66 offen lds
s_add_u32 m0, s43, 896
s_nop 0
buffer_load_dwordx4 v237, s[4:7], s66 offen lds
v_pk_mul_f16 v140, v140, v141
v_pk_mul_f16 v142, v142, v143
v_fma_mix_f32 v233, v140, v140, v233 op_sel_hi:[1,1,0]
v_cvt_pkrtz_f16_f32 v144, v144, v145
s_waitcnt lgkmcnt(7)
v_mfma_f32_32x32x16_bf16 v[160:175], v[12:15], v[188:191], v[160:175]
v_fma_mix_f32 v233, v142, v142, v233 op_sel_hi:[1,1,0]
v_cvt_pkrtz_f16_f32 v145, v146, v147
v_fma_mix_f32 v233, v140, v140, v233 op_sel:[1,1,0] op_sel_hi:[1,1,0]
v_lshrrev_b64 v[144:145], 2, v[144:145]
v_fma_mix_f32 v233, v142, v142, v233 op_sel:[1,1,0] op_sel_hi:[1,1,0]
v_and_b32_sdwa v146, s47, v144 dst_sel:DWORD dst_unused:UNUSED_PAD src0_sel:DWORD src1_sel:WORD_1
v_fma_mix_f32 v233, v128, v128, v233 op_sel_hi:[1,1,0]
v_and_b32 v144, s47, v144
v_fma_mix_f32 v233, v129, v129, v233 op_sel_hi:[1,1,0]
v_cvt_pk_f16_f32 v156, v156, v157
v_fma_mix_f32 v233, v130, v130, v233 op_sel_hi:[1,1,0]
v_cvt_pk_f16_f32 v158, v158, v159
v_fma_mix_f32 v233, v131, v131, v233 op_sel_hi:[1,1,0]
v_pk_fma_f16 v157, v156, v156, s48
v_mfma_f32_32x32x16_bf16 v[96:111], v[36:39], v[188:191], v[96:111]
ds_read_u16 v146, v146
ds_read_u16 v144, v144
v_fma_mix_f32 v233, v132, v132, v233 op_sel_hi:[1,1,0]
v_and_b32_sdwa v147, s47, v145 dst_sel:DWORD dst_unused:UNUSED_PAD src0_sel:DWORD src1_sel:WORD_1
s_waitcnt lgkmcnt(5)
v_fma_mix_f32 v233, v133, v133, v233 op_sel_hi:[1,1,0]
s_add_u32 s81, s81, 6592
s_cmp_eq_u32 s81, 65920
s_cselect_b32 s81, 0, s81
s_add_u32 s43, s81, s67
s_add_u32 m0, s43, 0
s_add_u32 s66, s66, 98304
buffer_load_dwordx4 v236, s[4:7], s66 offen lds
s_add_u32 m0, s43, 896
s_nop 0
buffer_load_dwordx4 v237, s[4:7], s66 offen lds
v_and_b32 v145, s47, v145
v_pk_fma_f16 v159, v158, v158, s48
v_pk_mul_f16 v157, v156, v157
v_pk_mul_f16 v159, v158, v159
v_fma_mix_f32 v233, v134, v134, v233 op_sel_hi:[1,1,0]
v_cvt_pkrtz_f16_f32 v148, v148, v149
v_fma_mix_f32 v233, v135, v135, v233 op_sel_hi:[1,1,0]
ds_read_u16 v147, v147
ds_read_u16 v145, v145
ds_read_b128 v[184:187], v251 offset:2048
v_cvt_pkrtz_f16_f32 v149, v150, v151
v_lshrrev_b64 v[148:149], 2, v[148:149]
v_and_b32_sdwa v150, s47, v148 dst_sel:DWORD dst_unused:UNUSED_PAD src0_sel:DWORD src1_sel:WORD_1
v_and_b32_e64 v148, s47, v148
v_exp_f16_sdwa v157, v157 dst_sel:WORD_0 dst_unused:UNUSED_PRESERVE src0_sel:WORD_0
v_mfma_f32_32x32x16_bf16 v[160:175], v[16:19], v[176:179], v[160:175]
ds_read_u16 v150, v150
ds_read_u16 v148, v148
v_fma_mix_f32 v233, v136, v136, v233 op_sel_hi:[1,1,0]
v_exp_f16_sdwa v159, v159 dst_sel:WORD_0 dst_unused:UNUSED_PRESERVE src0_sel:WORD_0
s_waitcnt lgkmcnt(7)
v_fma_mix_f32 v233, v137, v137, v233 op_sel_hi:[1,1,0]
v_and_b32_sdwa v151, s47, v149 dst_sel:DWORD dst_unused:UNUSED_PAD src0_sel:DWORD src1_sel:WORD_1
v_and_b32 v149, s47, v149
v_exp_f16_sdwa v157, v157 dst_sel:WORD_1 dst_unused:UNUSED_PRESERVE src0_sel:WORD_1
v_fma_mix_f32 v233, v138, v138, v233 op_sel_hi:[1,1,0]
v_cvt_pkrtz_f16_f32 v152, v152, v153
v_fma_mix_f32 v233, v139, v139, v233 op_sel_hi:[1,1,0]
v_cvt_pkrtz_f16_f32 v153, v154, v155
v_lshrrev_b64 v[152:153], 2, v[152:153]
ds_read_u16 v151, v151
ds_read_u16 v149, v149
v_and_b32_sdwa v154, s47, v152 dst_sel:DWORD dst_unused:UNUSED_PAD src0_sel:DWORD src1_sel:WORD_1
v_and_b32_e64 v152, s47, v152
v_exp_f16_sdwa v159, v159 dst_sel:WORD_1 dst_unused:UNUSED_PRESERVE src0_sel:WORD_1
v_mfma_f32_32x32x16_bf16 v[96:111], v[40:43], v[176:179], v[96:111]
ds_read_u16 v154, v154
ds_read_u16 v152, v152
ds_read_b128 v[188:191], v251 offset:3072
v_and_b32_sdwa v155, s47, v153 dst_sel:DWORD dst_unused:UNUSED_PAD src0_sel:DWORD src1_sel:WORD_1
v_and_b32_e64 v153, s47, v153
v_pk_add_f16 v157, v157, 1.0 op_sel_hi:[1,0]
v_pk_add_f16 v159, v159, 1.0 op_sel_hi:[1,0]
v_rcp_f16_sdwa v157, v157 dst_sel:WORD_0 dst_unused:UNUSED_PRESERVE src0_sel:WORD_0
v_mfma_f32_32x32x16_bf16 v[160:175], v[20:23], v[180:183], v[160:175]
ds_read_u16 v155, v155
ds_read_u16 v153, v153
v_rcp_f16_sdwa v159, v159 dst_sel:WORD_0 dst_unused:UNUSED_PRESERVE src0_sel:WORD_0
v_rcp_f16_sdwa v157, v157 dst_sel:WORD_1 dst_unused:UNUSED_PRESERVE src0_sel:WORD_1
v_rcp_f16_sdwa v159, v159 dst_sel:WORD_1 dst_unused:UNUSED_PRESERVE src0_sel:WORD_1
v_mfma_f32_32x32x16_bf16 v[96:111], v[44:47], v[180:183], v[96:111]
ds_read_b128 v[176:179], v251 offset:4096
v_pk_mul_f16 v156, v156, v157
v_pk_mul_f16 v158, v158, v159
v_fma_mix_f32 v233, v156, v156, v233 op_sel_hi:[1,1,0]
s_nop 1
v_cvt_pkrtz_f16_f32 v160, v160, v161
v_fma_mix_f32 v233, v158, v158, v233 op_sel_hi:[1,1,0]
s_waitcnt lgkmcnt(7)
v_mfma_f32_32x32x16_bf16 v[112:127], v[0:3], v[184:187], 0
v_fma_mix_f32 v233, v156, v156, v233 op_sel:[1,1,0] op_sel_hi:[1,1,0]
v_cvt_pkrtz_f16_f32 v161, v162, v163
v_fma_mix_f32 v233, v158, v158, v233 op_sel:[1,1,0] op_sel_hi:[1,1,0]
v_lshrrev_b64 v[160:161], 2, v[160:161]
v_fma_mix_f32 v233, v144, v144, v233 op_sel_hi:[1,1,0]
v_and_b32_sdwa v162, s47, v160 dst_sel:DWORD dst_unused:UNUSED_PAD src0_sel:DWORD src1_sel:WORD_1
v_fma_mix_f32 v233, v145, v145, v233 op_sel_hi:[1,1,0]
v_and_b32_e64 v160, s47, v160
v_fma_mix_f32 v233, v146, v146, v233 op_sel_hi:[1,1,0]
v_cvt_pk_f16_f32 v172, v172, v173
v_fma_mix_f32 v233, v147, v147, v233 op_sel_hi:[1,1,0]
v_cvt_pk_f16_f32 v174, v174, v175
v_pk_fma_f16 v173, v172, v172, s48
v_mfma_f32_32x32x16_bf16 v[128:143], v[24:27], v[184:187], 0
ds_read_u16 v162, v162
ds_read_u16 v160, v160
v_fma_mix_f32 v233, v148, v148, v233 op_sel_hi:[1,1,0]
v_and_b32_sdwa v163, s47, v161 dst_sel:DWORD dst_unused:UNUSED_PAD src0_sel:DWORD src1_sel:WORD_1
s_waitcnt lgkmcnt(5)
v_fma_mix_f32 v233, v149, v149, v233 op_sel_hi:[1,1,0]
v_and_b32 v161, s47, v161
v_pk_fma_f16 v175, v174, v174, s48
v_pk_mul_f16 v173, v172, v173
v_pk_mul_f16 v175, v174, v175
v_fma_mix_f32 v233, v150, v150, v233 op_sel_hi:[1,1,0]
v_cvt_pkrtz_f16_f32 v164, v164, v165
v_fma_mix_f32 v233, v151, v151, v233 op_sel_hi:[1,1,0]
ds_read_u16 v163, v163
ds_read_u16 v161, v161
ds_read_b128 v[180:183], v251 offset:5120
v_cvt_pkrtz_f16_f32 v165, v166, v167
v_lshrrev_b64 v[164:165], 2, v[164:165]
v_and_b32_sdwa v166, s47, v164 dst_sel:DWORD dst_unused:UNUSED_PAD src0_sel:DWORD src1_sel:WORD_1
v_and_b32_e64 v164, s47, v164
v_exp_f16_sdwa v173, v173 dst_sel:WORD_0 dst_unused:UNUSED_PRESERVE src0_sel:WORD_0
v_mfma_f32_32x32x16_bf16 v[112:127], v[4:7], v[188:191], v[112:127]
ds_read_u16 v166, v166
ds_read_u16 v164, v164
v_fma_mix_f32 v233, v152, v152, v233 op_sel_hi:[1,1,0]
v_exp_f16_sdwa v175, v175 dst_sel:WORD_0 dst_unused:UNUSED_PRESERVE src0_sel:WORD_0
s_waitcnt lgkmcnt(7)
v_fma_mix_f32 v233, v153, v153, v233 op_sel_hi:[1,1,0]
v_and_b32_sdwa v167, s47, v165 dst_sel:DWORD dst_unused:UNUSED_PAD src0_sel:DWORD src1_sel:WORD_1
v_and_b32 v165, s47, v165
v_exp_f16_sdwa v173, v173 dst_sel:WORD_1 dst_unused:UNUSED_PRESERVE src0_sel:WORD_1
v_fma_mix_f32 v233, v154, v154, v233 op_sel_hi:[1,1,0]
v_cvt_pkrtz_f16_f32 v168, v168, v169
v_fma_mix_f32 v233, v155, v155, v233 op_sel_hi:[1,1,0]
v_cvt_pkrtz_f16_f32 v169, v170, v171
v_lshrrev_b64 v[168:169], 2, v[168:169]
ds_read_u16 v167, v167
ds_read_u16 v165, v165
v_and_b32_sdwa v170, s47, v168 dst_sel:DWORD dst_unused:UNUSED_PAD src0_sel:DWORD src1_sel:WORD_1
v_and_b32_e64 v168, s47, v168
v_exp_f16_sdwa v175, v175 dst_sel:WORD_1 dst_unused:UNUSED_PRESERVE src0_sel:WORD_1
v_mfma_f32_32x32x16_bf16 v[128:143], v[28:31], v[188:191], v[128:143]
ds_read_u16 v170, v170
ds_read_u16 v168, v168
ds_read_b128 v[184:187], v251 offset:6144
v_and_b32_sdwa v171, s47, v169 dst_sel:DWORD dst_unused:UNUSED_PAD src0_sel:DWORD src1_sel:WORD_1
v_and_b32_e64 v169, s47, v169
v_pk_add_f16 v173, v173, 1.0 op_sel_hi:[1,0]
v_pk_add_f16 v175, v175, 1.0 op_sel_hi:[1,0]
v_rcp_f16_sdwa v173, v173 dst_sel:WORD_0 dst_unused:UNUSED_PRESERVE src0_sel:WORD_0
v_mfma_f32_32x32x16_bf16 v[112:127], v[8:11], v[176:179], v[112:127]
ds_read_u16 v171, v171
ds_read_u16 v169, v169
v_rcp_f16_sdwa v175, v175 dst_sel:WORD_0 dst_unused:UNUSED_PRESERVE src0_sel:WORD_0
v_rcp_f16_sdwa v173, v173 dst_sel:WORD_1 dst_unused:UNUSED_PRESERVE src0_sel:WORD_1
v_rcp_f16_sdwa v175, v175 dst_sel:WORD_1 dst_unused:UNUSED_PRESERVE src0_sel:WORD_1
v_mfma_f32_32x32x16_bf16 v[128:143], v[32:35], v[176:179], v[128:143]
ds_read_b128 v[188:191], v251 offset:7168
v_pk_mul_f16 v172, v172, v173
v_pk_mul_f16 v174, v174, v175
v_fma_mix_f32 v234, v172, v172, v234 op_sel_hi:[1,1,0]
v_cvt_pkrtz_f16_f32 v96, v96, v97
v_fma_mix_f32 v234, v174, v174, v234 op_sel_hi:[1,1,0]
s_waitcnt lgkmcnt(7)
v_mfma_f32_32x32x16_bf16 v[112:127], v[12:15], v[180:183], v[112:127]
v_fma_mix_f32 v234, v172, v172, v234 op_sel:[1,1,0] op_sel_hi:[1,1,0]
v_cvt_pkrtz_f16_f32 v97, v98, v99
v_fma_mix_f32 v234, v174, v174, v234 op_sel:[1,1,0] op_sel_hi:[1,1,0]
v_lshrrev_b64 v[96:97], 2, v[96:97]
v_fma_mix_f32 v234, v160, v160, v234 op_sel_hi:[1,1,0]
v_and_b32_sdwa v98, s47, v96 dst_sel:DWORD dst_unused:UNUSED_PAD src0_sel:DWORD src1_sel:WORD_1
v_fma_mix_f32 v234, v161, v161, v234 op_sel_hi:[1,1,0]
v_and_b32 v96, s47, v96
v_fma_mix_f32 v234, v162, v162, v234 op_sel_hi:[1,1,0]
v_cvt_pk_f16_f32 v108, v108, v109
v_fma_mix_f32 v234, v163, v163, v234 op_sel_hi:[1,1,0]
v_cvt_pk_f16_f32 v110, v110, v111
v_pk_fma_f16 v109, v108, v108, s48
v_mfma_f32_32x32x16_bf16 v[128:143], v[36:39], v[180:183], v[128:143]
ds_read_u16 v98, v98
ds_read_u16 v96, v96
v_fma_mix_f32 v234, v164, v164, v234 op_sel_hi:[1,1,0]
v_and_b32_sdwa v99, s47, v97 dst_sel:DWORD dst_unused:UNUSED_PAD src0_sel:DWORD src1_sel:WORD_1
s_waitcnt lgkmcnt(5)
v_fma_mix_f32 v234, v165, v165, v234 op_sel_hi:[1,1,0]
v_and_b32 v97, s47, v97
v_pk_fma_f16 v111, v110, v110, s48
v_pk_mul_f16 v109, v108, v109
v_pk_mul_f16 v111, v110, v111
v_fma_mix_f32 v234, v166, v166, v234 op_sel_hi:[1,1,0]
v_cvt_pkrtz_f16_f32 v100, v100, v101
v_fma_mix_f32 v234, v167, v167, v234 op_sel_hi:[1,1,0]
ds_read_u16 v99, v99
ds_read_u16 v97, v97
v_cvt_pkrtz_f16_f32 v101, v102, v103
v_lshrrev_b64 v[100:101], 2, v[100:101]
v_and_b32_sdwa v102, s47, v100 dst_sel:DWORD dst_unused:UNUSED_PAD src0_sel:DWORD src1_sel:WORD_1
v_and_b32_e64 v100, s47, v100
v_exp_f16_sdwa v109, v109 dst_sel:WORD_0 dst_unused:UNUSED_PRESERVE src0_sel:WORD_0
v_mfma_f32_32x32x16_bf16 v[112:127], v[16:19], v[184:187], v[112:127]
ds_read_u16 v102, v102
ds_read_u16 v100, v100
v_fma_mix_f32 v234, v168, v168, v234 op_sel_hi:[1,1,0]
v_exp_f16_sdwa v111, v111 dst_sel:WORD_0 dst_unused:UNUSED_PRESERVE src0_sel:WORD_0
s_waitcnt lgkmcnt(6)
v_fma_mix_f32 v234, v169, v169, v234 op_sel_hi:[1,1,0]
v_and_b32_sdwa v103, s47, v101 dst_sel:DWORD dst_unused:UNUSED_PAD src0_sel:DWORD src1_sel:WORD_1
v_and_b32 v101, s47, v101
v_exp_f16_sdwa v109, v109 dst_sel:WORD_1 dst_unused:UNUSED_PRESERVE src0_sel:WORD_1
v_fma_mix_f32 v234, v170, v170, v234 op_sel_hi:[1,1,0]
v_cvt_pkrtz_f16_f32 v104, v104, v105
v_fma_mix_f32 v234, v171, v171, v234 op_sel_hi:[1,1,0]
v_cvt_pkrtz_f16_f32 v105, v106, v107
v_lshrrev_b64 v[104:105], 2, v[104:105]
ds_read_u16 v103, v103
ds_read_u16 v101, v101
v_and_b32_sdwa v106, s47, v104 dst_sel:DWORD dst_unused:UNUSED_PAD src0_sel:DWORD src1_sel:WORD_1
v_and_b32_e64 v104, s47, v104
v_exp_f16_sdwa v111, v111 dst_sel:WORD_1 dst_unused:UNUSED_PRESERVE src0_sel:WORD_1
v_mfma_f32_32x32x16_bf16 v[128:143], v[40:43], v[184:187], v[128:143]
ds_read_u16 v106, v106
ds_read_u16 v104, v104
v_and_b32_sdwa v107, s47, v105 dst_sel:DWORD dst_unused:UNUSED_PAD src0_sel:DWORD src1_sel:WORD_1
v_and_b32_e64 v105, s47, v105
v_pk_add_f16 v109, v109, 1.0 op_sel_hi:[1,0]
v_pk_add_f16 v111, v111, 1.0 op_sel_hi:[1,0]
v_rcp_f16_sdwa v109, v109 dst_sel:WORD_0 dst_unused:UNUSED_PRESERVE src0_sel:WORD_0
v_mfma_f32_32x32x16_bf16 v[112:127], v[20:23], v[188:191], v[112:127]
ds_read_u16 v107, v107
ds_read_u16 v105, v105
v_rcp_f16_sdwa v111, v111 dst_sel:WORD_0 dst_unused:UNUSED_PRESERVE src0_sel:WORD_0
v_rcp_f16_sdwa v109, v109 dst_sel:WORD_1 dst_unused:UNUSED_PRESERVE src0_sel:WORD_1
v_rcp_f16_sdwa v111, v111 dst_sel:WORD_1 dst_unused:UNUSED_PRESERVE src0_sel:WORD_1
v_mfma_f32_32x32x16_bf16 v[128:143], v[44:47], v[188:191], v[128:143]
v_pk_mul_f16 v108, v108, v109
v_pk_mul_f16 v110, v110, v111
v_fma_mix_f32 v234, v108, v108, v234 op_sel_hi:[1,1,0]
s_nop 2
v_cvt_pkrtz_f16_f32 v112, v112, v113
v_fma_mix_f32 v234, v110, v110, v234 op_sel_hi:[1,1,0]
v_cvt_pkrtz_f16_f32 v113, v114, v115
v_fma_mix_f32 v234, v108, v108, v234 op_sel:[1,1,0] op_sel_hi:[1,1,0]
v_lshrrev_b64 v[112:113], 2, v[112:113]
v_fma_mix_f32 v234, v110, v110, v234 op_sel:[1,1,0] op_sel_hi:[1,1,0]
v_and_b32_sdwa v114, s47, v112 dst_sel:DWORD dst_unused:UNUSED_PAD src0_sel:DWORD src1_sel:WORD_1
s_waitcnt lgkmcnt(4)
v_fma_mix_f32 v234, v96, v96, v234 op_sel_hi:[1,1,0]
v_and_b32_e64 v112, s47, v112
v_fma_mix_f32 v234, v97, v97, v234 op_sel_hi:[1,1,0]
v_cvt_pk_f16_f32 v124, v124, v125
v_fma_mix_f32 v234, v98, v98, v234 op_sel_hi:[1,1,0]
v_cvt_pk_f16_f32 v126, v126, v127
v_fma_mix_f32 v234, v99, v99, v234 op_sel_hi:[1,1,0]
v_pk_fma_f16 v125, v124, v124, s48
v_fma_mix_f32 v234, v100, v100, v234 op_sel_hi:[1,1,0]
v_and_b32_sdwa v115, s47, v113 dst_sel:DWORD dst_unused:UNUSED_PAD src0_sel:DWORD src1_sel:WORD_1
v_fma_mix_f32 v234, v101, v101, v234 op_sel_hi:[1,1,0]
v_and_b32_e64 v113, s47, v113
v_pk_fma_f16 v127, v126, v126, s48
ds_read_u16 v114, v114
ds_read_u16 v112, v112
ds_read_u16 v115, v115
ds_read_u16 v113, v113
s_add_u32 s43, s81, 6592
v_add_u32_e64 v212, s43, v246
v_subrev_u32 v222, 65920, v212
v_min_u32_e64 v212, v212, v222
v_add_u32 v212, 90112, v212
v_add_u32_e64 v213, s43, v246
v_add_u32 v213, 6592, v213
v_subrev_u32 v222, 65920, v213
v_min_u32_e64 v213, v213, v222
v_add_u32 v213, 90112, v213
v_add_u32_e64 v214, s43, v246
v_add_u32 v214, 13184, v214
v_add_u32_e64 v222, 16, v214
v_bfi_b32 v214, 48, v222, v214
v_subrev_u32 v222, 65920, v214
v_min_u32_e64 v214, v214, v222
v_add_u32 v214, 90112, v214
v_add_u32_e64 v215, s43, v246
v_add_u32 v215, 19776, v215
v_add_u32_e64 v222, 16, v215
v_bfi_b32 v215, 48, v222, v215
v_subrev_u32 v222, 65920, v215
v_min_u32_e64 v215, v215, v222
v_add_u32 v215, 90112, v215
v_pk_mul_f16 v125, v124, v125
v_pk_mul_f16 v127, v126, v127
v_fma_mix_f32 v234, v102, v102, v234 op_sel_hi:[1,1,0]
v_cvt_pkrtz_f16_f32 v116, v116, v117
v_fma_mix_f32 v234, v103, v103, v234 op_sel_hi:[1,1,0]
v_cvt_pkrtz_f16_f32 v117, v118, v119
v_lshrrev_b64 v[116:117], 2, v[116:117]
v_and_b32_sdwa v118, s47, v116 dst_sel:DWORD dst_unused:UNUSED_PAD src0_sel:DWORD src1_sel:WORD_1
v_and_b32 v116, s47, v116
v_exp_f16_sdwa v125, v125 dst_sel:WORD_0 dst_unused:UNUSED_PRESERVE src0_sel:WORD_0
s_waitcnt lgkmcnt(2)
v_fma_mix_f32 v234, v104, v104, v234 op_sel_hi:[1,1,0]
v_exp_f16_sdwa v127, v127 dst_sel:WORD_0 dst_unused:UNUSED_PRESERVE src0_sel:WORD_0
v_fma_mix_f32 v234, v105, v105, v234 op_sel_hi:[1,1,0]
v_and_b32_sdwa v119, s47, v117 dst_sel:DWORD dst_unused:UNUSED_PAD src0_sel:DWORD src1_sel:WORD_1
v_and_b32 v117, s47, v117
ds_read_u16 v118, v118
ds_read_u16 v116, v116
ds_read_u16 v119, v119
ds_read_u16 v117, v117
s_waitcnt vmcnt(0)
v_exp_f16_sdwa v125, v125 dst_sel:WORD_1 dst_unused:UNUSED_PRESERVE src0_sel:WORD_1
v_fma_mix_f32 v234, v106, v106, v234 op_sel_hi:[1,1,0]
v_cvt_pkrtz_f16_f32 v120, v120, v121
v_fma_mix_f32 v234, v107, v107, v234 op_sel_hi:[1,1,0]
v_cvt_pkrtz_f16_f32 v121, v122, v123
v_lshrrev_b64 v[120:121], 2, v[120:121]
v_and_b32_sdwa v122, s47, v120 dst_sel:DWORD dst_unused:UNUSED_PAD src0_sel:DWORD src1_sel:WORD_1
ds_read_b128 v[144:147], v212
ds_read_b64 v[196:197], v238
ds_read_b64 v[198:199], v239
v_and_b32_e64 v120, s47, v120
v_exp_f16_sdwa v127, v127 dst_sel:WORD_1 dst_unused:UNUSED_PRESERVE src0_sel:WORD_1
v_and_b32_sdwa v123, s47, v121 dst_sel:DWORD dst_unused:UNUSED_PAD src0_sel:DWORD src1_sel:WORD_1
v_and_b32_e64 v121, s47, v121
v_pk_add_f16 v125, v125, 1.0 op_sel_hi:[1,0]
v_pk_add_f16 v127, v127, 1.0 op_sel_hi:[1,0]
v_rcp_f16_sdwa v125, v125 dst_sel:WORD_0 dst_unused:UNUSED_PRESERVE src0_sel:WORD_0
ds_read_u16 v122, v122
ds_read_u16 v120, v120
ds_read_b128 v[148:151], v213
ds_read_b128 v[152:155], v214
ds_read_b64 v[200:201], v238 offset:2400
ds_read_b64 v[202:203], v239 offset:2400
s_waitcnt lgkmcnt(13)
ds_read_b128 v[156:159], v215
ds_read_u16 v123, v123
s_waitcnt lgkmcnt(14)
ds_read_u16 v121, v121
v_rcp_f16_sdwa v127, v127 dst_sel:WORD_0 dst_unused:UNUSED_PRESERVE src0_sel:WORD_0
v_rcp_f16_sdwa v125, v125 dst_sel:WORD_1 dst_unused:UNUSED_PRESERVE src0_sel:WORD_1
v_rcp_f16_sdwa v127, v127 dst_sel:WORD_1 dst_unused:UNUSED_PRESERVE src0_sel:WORD_1
v_pk_mul_f16 v124, v124, v125
v_pk_mul_f16 v126, v126, v127
v_fma_mix_f32 v235, v124, v124, v235 op_sel_hi:[1,1,0]
s_waitcnt lgkmcnt(14)
ds_read_b64 v[204:205], v238 offset:4800
s_waitcnt lgkmcnt(14)
ds_read_b64 v[206:207], v239 offset:4800
v_fma_mix_f32 v235, v126, v126, v235 op_sel_hi:[1,1,0]
v_cvt_pkrtz_f16_f32 v128, v128, v129
v_fma_mix_f32 v235, v124, v124, v235 op_sel:[1,1,0] op_sel_hi:[1,1,0]
v_cvt_pkrtz_f16_f32 v129, v130, v131
v_fma_mix_f32 v235, v126, v126, v235 op_sel:[1,1,0] op_sel_hi:[1,1,0]
v_lshrrev_b64 v[128:129], 2, v[128:129]
v_fma_mix_f32 v235, v112, v112, v235 op_sel_hi:[1,1,0]
s_waitcnt lgkmcnt(11)
v_mfma_f32_16x16x32_bf16 v[48:51], v[196:199], v[144:147], 0
ds_read_b128 v[160:163], v212 offset:16
ds_read_b64 v[208:209], v238 offset:200
ds_read_b64 v[210:211], v239 offset:200
v_fma_mix_f32 v235, v113, v113, v235 op_sel_hi:[1,1,0]
v_and_b32_sdwa v130, s47, v128 dst_sel:DWORD dst_unused:UNUSED_PAD src0_sel:DWORD src1_sel:WORD_1
v_fma_mix_f32 v235, v114, v114, v235 op_sel_hi:[1,1,0]
v_and_b32 v128, s47, v128
v_fma_mix_f32 v235, v115, v115, v235 op_sel_hi:[1,1,0]
v_cvt_pk_f16_f32 v140, v140, v141
v_cvt_pk_f16_f32 v142, v142, v143
ds_read_b128 v[164:167], v213 offset:16
s_waitcnt lgkmcnt(14)
ds_read_b128 v[168:171], v214 offset:16
v_pk_fma_f16 v141, v140, v140, s48
v_fma_mix_f32 v235, v116, v116, v235 op_sel_hi:[1,1,0]
s_waitcnt lgkmcnt(13)
v_mfma_f32_16x16x32_bf16 v[96:99], v[196:199], v[148:151], 0
ds_read_b64 v[192:193], v238 offset:2600
ds_read_b64 v[194:195], v239 offset:2600
v_fma_mix_f32 v235, v117, v117, v235 op_sel_hi:[1,1,0]
v_and_b32_sdwa v131, s47, v129 dst_sel:DWORD dst_unused:UNUSED_PAD src0_sel:DWORD src1_sel:WORD_1
v_and_b32 v129, s47, v129
s_waitcnt lgkmcnt(12)
v_mfma_f32_16x16x32_bf16 v[48:51], v[200:203], v[148:151], v[48:51]
ds_read_b128 v[172:175], v215 offset:16
ds_read_b64 v[196:197], v238 offset:5000
ds_read_b64 v[198:199], v239 offset:5000
v_mfma_f32_16x16x32_bf16 v[96:99], v[200:203], v[152:155], v[96:99]
v_pk_fma_f16 v143, v142, v142, s48
v_pk_mul_f16 v141, v140, v141
v_pk_mul_f16 v143, v142, v143
v_fma_mix_f32 v235, v118, v118, v235 op_sel_hi:[1,1,0]
v_cvt_pkrtz_f16_f32 v132, v132, v133
v_fma_mix_f32 v235, v119, v119, v235 op_sel_hi:[1,1,0]
v_cvt_pkrtz_f16_f32 v133, v134, v135
v_lshrrev_b64 v[132:133], 2, v[132:133]
v_and_b32_sdwa v134, s47, v132 dst_sel:DWORD dst_unused:UNUSED_PAD src0_sel:DWORD src1_sel:WORD_1
s_waitcnt lgkmcnt(14)
ds_read_b128 v[144:147], v212 offset:32
s_waitcnt lgkmcnt(14)
ds_read_b64 v[200:201], v238 offset:400
s_waitcnt lgkmcnt(14)
ds_read_b64 v[202:203], v239 offset:400
v_and_b32 v132, s47, v132
s_waitcnt lgkmcnt(13)
v_mfma_f32_16x16x32_bf16 v[48:51], v[204:207], v[152:155], v[48:51]
ds_read_b128 v[148:151], v213 offset:32
ds_read_b128 v[152:155], v214 offset:32
v_mfma_f32_16x16x32_bf16 v[96:99], v[204:207], v[156:159], v[96:99]
s_waitcnt lgkmcnt(14)
ds_read_b64 v[204:205], v238 offset:2800
s_waitcnt lgkmcnt(14)
ds_read_b64 v[206:207], v239 offset:2800
s_waitcnt lgkmcnt(14)
v_mfma_f32_16x16x32_bf16 v[52:55], v[208:211], v[160:163], 0
v_exp_f16_sdwa v141, v141 dst_sel:WORD_0 dst_unused:UNUSED_PRESERVE src0_sel:WORD_0
s_waitcnt lgkmcnt(13)
v_mfma_f32_16x16x32_bf16 v[100:103], v[208:211], v[164:167], 0
ds_read_b128 v[156:159], v215 offset:32
ds_read_b64 v[208:209], v238 offset:5200
v_fma_mix_f32 v235, v120, v120, v235 op_sel_hi:[1,1,0]
v_exp_f16_sdwa v143, v143 dst_sel:WORD_0 dst_unused:UNUSED_PRESERVE src0_sel:WORD_0
s_waitcnt lgkmcnt(12)
v_mfma_f32_16x16x32_bf16 v[52:55], v[192:195], v[164:167], v[52:55]
ds_read_b64 v[210:211], v239 offset:5200
ds_read_b128 v[160:163], v212 offset:48
v_mfma_f32_16x16x32_bf16 v[100:103], v[192:195], v[168:171], v[100:103]
ds_read_b64 v[192:193], v238 offset:600
s_waitcnt lgkmcnt(14)
ds_read_b64 v[194:195], v239 offset:600
s_waitcnt lgkmcnt(13)
v_mfma_f32_16x16x32_bf16 v[52:55], v[196:199], v[168:171], v[52:55]
ds_read_u16 v130, v130
ds_read_u16 v128, v128
v_mfma_f32_16x16x32_bf16 v[100:103], v[196:199], v[172:175], v[100:103]
s_waitcnt lgkmcnt(14)
ds_read_b128 v[164:167], v213 offset:48
s_waitcnt lgkmcnt(14)
ds_read_b128 v[168:171], v214 offset:48
s_waitcnt lgkmcnt(14)
v_mfma_f32_16x16x32_bf16 v[56:59], v[200:203], v[144:147], 0
ds_read_b64 v[196:197], v238 offset:3000
v_fma_mix_f32 v235, v121, v121, v235 op_sel_hi:[1,1,0]
s_waitcnt lgkmcnt(14)
v_mfma_f32_16x16x32_bf16 v[104:107], v[200:203], v[148:151], 0
ds_read_b64 v[198:199], v239 offset:3000
v_and_b32_sdwa v135, s47, v133 dst_sel:DWORD dst_unused:UNUSED_PAD src0_sel:DWORD src1_sel:WORD_1
v_and_b32 v133, s47, v133
s_waitcnt lgkmcnt(12)
v_mfma_f32_16x16x32_bf16 v[56:59], v[204:207], v[148:151], v[56:59]
ds_read_u16 v131, v131
ds_read_u16 v129, v129
ds_read_b128 v[172:175], v215 offset:48
v_mfma_f32_16x16x32_bf16 v[104:107], v[204:207], v[152:155], v[104:107]
s_waitcnt lgkmcnt(14)
ds_read_b64 v[200:201], v238 offset:5400
s_waitcnt lgkmcnt(14)
ds_read_b64 v[202:203], v239 offset:5400
s_waitcnt lgkmcnt(14)
v_mfma_f32_16x16x32_bf16 v[56:59], v[208:211], v[152:155], v[56:59]
v_exp_f16_sdwa v141, v141 dst_sel:WORD_1 dst_unused:UNUSED_PRESERVE src0_sel:WORD_1
v_mfma_f32_16x16x32_bf16 v[104:107], v[208:211], v[156:159], v[104:107]
ds_read_u16 v134, v134
s_waitcnt lgkmcnt(14)
ds_read_u16 v132, v132
s_waitcnt lgkmcnt(14)
ds_read_b128 v[144:147], v212 offset:64
s_waitcnt lgkmcnt(14)
v_mfma_f32_16x16x32_bf16 v[60:63], v[192:195], v[160:163], 0
v_fma_mix_f32 v235, v122, v122, v235 op_sel_hi:[1,1,0]
v_cvt_pkrtz_f16_f32 v136, v136, v137
v_fma_mix_f32 v235, v123, v123, v235 op_sel_hi:[1,1,0]
v_cvt_pkrtz_f16_f32 v137, v138, v139
v_lshrrev_b64 v[136:137], 2, v[136:137]
v_and_b32_sdwa v138, s47, v136 dst_sel:DWORD dst_unused:UNUSED_PAD src0_sel:DWORD src1_sel:WORD_1
v_and_b32 v136, s47, v136
v_exp_f16_sdwa v143, v143 dst_sel:WORD_1 dst_unused:UNUSED_PRESERVE src0_sel:WORD_1
ds_read_b64 v[204:205], v238 offset:800
s_waitcnt lgkmcnt(14)
ds_read_b64 v[206:207], v239 offset:800
s_waitcnt lgkmcnt(14)
ds_read_b128 v[148:151], v213 offset:64
s_waitcnt lgkmcnt(14)
v_mfma_f32_16x16x32_bf16 v[108:111], v[192:195], v[164:167], 0
v_and_b32_sdwa v139, s47, v137 dst_sel:DWORD dst_unused:UNUSED_PAD src0_sel:DWORD src1_sel:WORD_1
v_and_b32 v137, s47, v137
v_pk_add_f16 v141, v141, 1.0 op_sel_hi:[1,0]
v_pk_add_f16 v143, v143, 1.0 op_sel_hi:[1,0]
v_rcp_f16_sdwa v141, v141 dst_sel:WORD_0 dst_unused:UNUSED_PRESERVE src0_sel:WORD_0
s_waitcnt lgkmcnt(11)
v_mfma_f32_16x16x32_bf16 v[60:63], v[196:199], v[164:167], v[60:63]
ds_read_u16 v135, v135
ds_read_u16 v133, v133
ds_read_b128 v[152:155], v214 offset:64
ds_read_b64 v[208:209], v238 offset:3200
v_mfma_f32_16x16x32_bf16 v[108:111], v[196:199], v[168:171], v[108:111]
v_rcp_f16_sdwa v143, v143 dst_sel:WORD_0 dst_unused:UNUSED_PRESERVE src0_sel:WORD_0
v_rcp_f16_sdwa v141, v141 dst_sel:WORD_1 dst_unused:UNUSED_PRESERVE src0_sel:WORD_1
v_rcp_f16_sdwa v143, v143 dst_sel:WORD_1 dst_unused:UNUSED_PRESERVE src0_sel:WORD_1
s_waitcnt lgkmcnt(14)
ds_read_b64 v[210:211], v239 offset:3200
s_waitcnt lgkmcnt(14)
ds_read_b128 v[156:159], v215 offset:64
v_pk_mul_f16 v140, v140, v141
v_pk_mul_f16 v142, v142, v143
s_waitcnt lgkmcnt(12)
v_mfma_f32_16x16x32_bf16 v[60:63], v[200:203], v[168:171], v[60:63]
ds_read_b64 v[192:193], v238 offset:5600
ds_read_b64 v[194:195], v239 offset:5600
v_mfma_f32_16x16x32_bf16 v[108:111], v[200:203], v[172:175], v[108:111]
v_fma_mix_f32 v235, v140, v140, v235 op_sel_hi:[1,1,0]
ds_read_u16 v138, v138
s_waitcnt lgkmcnt(14)
ds_read_u16 v136, v136
v_fma_mix_f32 v235, v142, v142, v235 op_sel_hi:[1,1,0]
s_waitcnt lgkmcnt(14)
ds_read_b128 v[160:163], v212 offset:80
s_waitcnt lgkmcnt(14)
ds_read_b64 v[196:197], v238 offset:1000
s_waitcnt lgkmcnt(14)
ds_read_b64 v[198:199], v239 offset:1000
s_waitcnt lgkmcnt(14)
v_mfma_f32_16x16x32_bf16 v[64:67], v[204:207], v[144:147], 0
v_fma_mix_f32 v235, v140, v140, v235 op_sel:[1,1,0] op_sel_hi:[1,1,0]
ds_read_u16 v139, v139
s_waitcnt lgkmcnt(14)
v_mfma_f32_16x16x32_bf16 v[112:115], v[204:207], v[148:151], 0
ds_read_u16 v137, v137
s_waitcnt lgkmcnt(14)
ds_read_b128 v[164:167], v213 offset:80
v_fma_mix_f32 v235, v142, v142, v235 op_sel:[1,1,0] op_sel_hi:[1,1,0]
s_nop 0
v_fma_mix_f32 v235, v128, v128, v235 op_sel_hi:[1,1,0]
s_waitcnt lgkmcnt(14)
ds_read_b128 v[168:171], v214 offset:80
v_fma_mix_f32 v235, v129, v129, v235 op_sel_hi:[1,1,0]
s_waitcnt lgkmcnt(14)
ds_read_b64 v[200:201], v238 offset:3400
v_fma_mix_f32 v235, v130, v130, v235 op_sel_hi:[1,1,0]
s_waitcnt lgkmcnt(13)
v_mfma_f32_16x16x32_bf16 v[64:67], v[208:211], v[148:151], v[64:67]
ds_read_b64 v[202:203], v239 offset:3400
v_fma_mix_f32 v235, v131, v131, v235 op_sel_hi:[1,1,0]
v_mfma_f32_16x16x32_bf16 v[112:115], v[208:211], v[152:155], v[112:115]
ds_read_b128 v[172:175], v215 offset:80
s_waitcnt lgkmcnt(14)
ds_read_b64 v[204:205], v238 offset:5800
s_waitcnt lgkmcnt(14)
ds_read_b64 v[206:207], v239 offset:5800
s_waitcnt lgkmcnt(14)
v_mfma_f32_16x16x32_bf16 v[64:67], v[192:195], v[152:155], v[64:67]
v_fma_mix_f32 v235, v132, v132, v235 op_sel_hi:[1,1,0]
v_mfma_f32_16x16x32_bf16 v[112:115], v[192:195], v[156:159], v[112:115]
ds_read_b128 v[144:147], v212 offset:96
v_fma_mix_f32 v235, v133, v133, v235 op_sel_hi:[1,1,0]
s_waitcnt lgkmcnt(14)
ds_read_b64 v[208:209], v238 offset:1200
s_waitcnt lgkmcnt(14)
ds_read_b64 v[210:211], v239 offset:1200
v_fma_mix_f32 v235, v134, v134, v235 op_sel_hi:[1,1,0]
s_waitcnt lgkmcnt(14)
ds_read_b128 v[148:151], v213 offset:96
v_fma_mix_f32 v235, v135, v135, v235 op_sel_hi:[1,1,0]
s_waitcnt lgkmcnt(13)
v_mfma_f32_16x16x32_bf16 v[68:71], v[196:199], v[160:163], 0
ds_read_b128 v[152:155], v214 offset:96
ds_read_b64 v[192:193], v238 offset:3600
s_waitcnt lgkmcnt(14)
ds_read_b64 v[194:195], v239 offset:3600
s_waitcnt lgkmcnt(13)
v_mfma_f32_16x16x32_bf16 v[116:119], v[196:199], v[164:167], 0
ds_read_b128 v[156:159], v215 offset:96
ds_read_b64 v[196:197], v238 offset:6000
s_waitcnt lgkmcnt(14)
ds_read_b64 v[198:199], v239 offset:6000
s_waitcnt lgkmcnt(13)
v_mfma_f32_16x16x32_bf16 v[68:71], v[200:203], v[164:167], v[68:71]
ds_read_b128 v[160:163], v212 offset:112
v_fma_mix_f32 v235, v136, v136, v235 op_sel_hi:[1,1,0]
v_mfma_f32_16x16x32_bf16 v[116:119], v[200:203], v[168:171], v[116:119]
ds_read_b64 v[200:201], v238 offset:1400
s_waitcnt lgkmcnt(14)
ds_read_b64 v[202:203], v239 offset:1400
s_waitcnt lgkmcnt(13)
v_mfma_f32_16x16x32_bf16 v[68:71], v[204:207], v[168:171], v[68:71]
ds_read_b128 v[164:167], v213 offset:112
v_fma_mix_f32 v235, v137, v137, v235 op_sel_hi:[1,1,0]
v_mfma_f32_16x16x32_bf16 v[116:119], v[204:207], v[172:175], v[116:119]
ds_read_b128 v[168:171], v214 offset:112
s_waitcnt lgkmcnt(14)
ds_read_b64 v[204:205], v238 offset:3800
s_waitcnt lgkmcnt(13)
v_mfma_f32_16x16x32_bf16 v[72:75], v[208:211], v[144:147], 0
ds_read_b64 v[206:207], v239 offset:3800
ds_read_b128 v[172:175], v215 offset:112
s_waitcnt lgkmcnt(14)
v_mfma_f32_16x16x32_bf16 v[120:123], v[208:211], v[148:151], 0
v_fma_mix_f32 v235, v138, v138, v235 op_sel_hi:[1,1,0]
ds_read_b64 v[208:209], v238 offset:6200
v_fma_mix_f32 v235, v139, v139, v235 op_sel_hi:[1,1,0]
s_waitcnt lgkmcnt(14)
ds_read_b64 v[210:211], v239 offset:6200
s_waitcnt lgkmcnt(13)
v_mfma_f32_16x16x32_bf16 v[72:75], v[192:195], v[148:151], v[72:75]
ds_read_b128 v[144:147], v212 offset:128
ds_read_b128 v[148:151], v213 offset:128
v_mfma_f32_16x16x32_bf16 v[120:123], v[192:195], v[152:155], v[120:123]
s_waitcnt lgkmcnt(14)
ds_read_b64 v[192:193], v238 offset:1600
s_waitcnt lgkmcnt(14)
ds_read_b64 v[194:195], v239 offset:1600
s_waitcnt lgkmcnt(14)
v_mfma_f32_16x16x32_bf16 v[72:75], v[196:199], v[152:155], v[72:75]
ds_read_b128 v[152:155], v214 offset:128
v_mfma_f32_16x16x32_bf16 v[120:123], v[196:199], v[156:159], v[120:123]
s_waitcnt lgkmcnt(14)
ds_read_b64 v[196:197], v238 offset:4000
s_waitcnt lgkmcnt(14)
ds_read_b64 v[198:199], v239 offset:4000
s_waitcnt lgkmcnt(14)
v_mfma_f32_16x16x32_bf16 v[76:79], v[200:203], v[160:163], 0
ds_read_b128 v[156:159], v215 offset:128
s_waitcnt lgkmcnt(14)
v_mfma_f32_16x16x32_bf16 v[124:127], v[200:203], v[164:167], 0
ds_read_b64 v[200:201], v238 offset:6400
s_waitcnt lgkmcnt(14)
ds_read_b64 v[202:203], v239 offset:6400
s_waitcnt lgkmcnt(13)
v_mfma_f32_16x16x32_bf16 v[76:79], v[204:207], v[164:167], v[76:79]
ds_read_b128 v[160:163], v212 offset:144
ds_read_b128 v[164:167], v213 offset:144
v_mfma_f32_16x16x32_bf16 v[124:127], v[204:207], v[168:171], v[124:127]
s_waitcnt lgkmcnt(14)
ds_read_b64 v[204:205], v238 offset:1800
s_waitcnt lgkmcnt(14)
ds_read_b64 v[206:207], v239 offset:1800
s_waitcnt lgkmcnt(14)
v_mfma_f32_16x16x32_bf16 v[76:79], v[208:211], v[168:171], v[76:79]
ds_read_b128 v[168:171], v214 offset:144
v_mfma_f32_16x16x32_bf16 v[124:127], v[208:211], v[172:175], v[124:127]
s_waitcnt lgkmcnt(14)
ds_read_b64 v[208:209], v238 offset:4200
s_waitcnt lgkmcnt(14)
ds_read_b64 v[210:211], v239 offset:4200
s_waitcnt lgkmcnt(13)
v_mfma_f32_16x16x32_bf16 v[80:83], v[192:195], v[144:147], 0
ds_read_b128 v[172:175], v215 offset:144
ds_read_b128 v[144:147], v212 offset:160
v_mfma_f32_16x16x32_bf16 v[128:131], v[192:195], v[148:151], 0
s_waitcnt lgkmcnt(14)
ds_read_b64 v[192:193], v238 offset:6600
s_waitcnt lgkmcnt(14)
ds_read_b64 v[194:195], v239 offset:6600
s_waitcnt lgkmcnt(14)
v_mfma_f32_16x16x32_bf16 v[80:83], v[196:199], v[148:151], v[80:83]
ds_read_b128 v[148:151], v213 offset:160
v_mfma_f32_16x16x32_bf16 v[128:131], v[196:199], v[152:155], v[128:131]
s_waitcnt lgkmcnt(14)
ds_read_b64 v[196:197], v238 offset:2000
s_waitcnt lgkmcnt(14)
ds_read_b64 v[198:199], v239 offset:2000
s_waitcnt lgkmcnt(14)
v_mfma_f32_16x16x32_bf16 v[80:83], v[200:203], v[152:155], v[80:83]
ds_read_b128 v[152:155], v214 offset:160
v_mfma_f32_16x16x32_bf16 v[128:131], v[200:203], v[156:159], v[128:131]
s_waitcnt lgkmcnt(14)
ds_read_b64 v[200:201], v238 offset:4400
s_waitcnt lgkmcnt(14)
ds_read_b64 v[202:203], v239 offset:4400
s_waitcnt lgkmcnt(13)
v_mfma_f32_16x16x32_bf16 v[84:87], v[204:207], v[160:163], 0
ds_read_b128 v[156:159], v215 offset:160
ds_read_b128 v[160:163], v212 offset:176
v_mfma_f32_16x16x32_bf16 v[132:135], v[204:207], v[164:167], 0
s_waitcnt lgkmcnt(14)
ds_read_b64 v[204:205], v238 offset:6800
s_waitcnt lgkmcnt(14)
ds_read_b64 v[206:207], v239 offset:6800
s_waitcnt lgkmcnt(14)
v_mfma_f32_16x16x32_bf16 v[84:87], v[208:211], v[164:167], v[84:87]
ds_read_b128 v[164:167], v213 offset:176
v_mfma_f32_16x16x32_bf16 v[132:135], v[208:211], v[168:171], v[132:135]
s_waitcnt lgkmcnt(14)
ds_read_b64 v[208:209], v238 offset:2200
s_waitcnt lgkmcnt(14)
ds_read_b64 v[210:211], v239 offset:2200
s_waitcnt lgkmcnt(13)
v_mfma_f32_16x16x32_bf16 v[84:87], v[192:195], v[168:171], v[84:87]
ds_read_b128 v[168:171], v214 offset:176
v_mfma_f32_16x16x32_bf16 v[132:135], v[192:195], v[172:175], v[132:135]
ds_read_b64 v[192:193], v238 offset:4600
s_waitcnt lgkmcnt(14)
ds_read_b64 v[194:195], v239 offset:4600
s_waitcnt lgkmcnt(13)
v_mfma_f32_16x16x32_bf16 v[88:91], v[196:199], v[144:147], 0
ds_read_b128 v[172:175], v215 offset:176
v_mfma_f32_16x16x32_bf16 v[136:139], v[196:199], v[148:151], 0
ds_read_b64 v[196:197], v238 offset:7000
s_waitcnt lgkmcnt(14)
ds_read_b64 v[198:199], v239 offset:7000
s_waitcnt lgkmcnt(13)
v_mfma_f32_16x16x32_bf16 v[88:91], v[200:203], v[148:151], v[88:91]
v_mfma_f32_16x16x32_bf16 v[136:139], v[200:203], v[152:155], v[136:139]
s_waitcnt lgkmcnt(9)
v_mfma_f32_16x16x32_bf16 v[88:91], v[204:207], v[152:155], v[88:91]
v_mfma_f32_16x16x32_bf16 v[136:139], v[204:207], v[156:159], v[136:139]
s_waitcnt lgkmcnt(6)
v_mfma_f32_16x16x32_bf16 v[92:95], v[208:211], v[160:163], 0
v_mfma_f32_16x16x32_bf16 v[140:143], v[208:211], v[164:167], 0
s_waitcnt lgkmcnt(3)
v_mfma_f32_16x16x32_bf16 v[92:95], v[192:195], v[164:167], v[92:95]
v_mfma_f32_16x16x32_bf16 v[140:143], v[192:195], v[168:171], v[140:143]
s_waitcnt lgkmcnt(0)
v_mfma_f32_16x16x32_bf16 v[92:95], v[196:199], v[168:171], v[92:95]
v_mfma_f32_16x16x32_bf16 v[140:143], v[196:199], v[172:175], v[140:143]
v_mov_b32_e64 v223, 1
v_add_u32 v222, s83, v247
s_nop 7
s_mov_b64 exec, 1
ds_add_u32 v222, v223 offset:24
s_mov_b64 exec, -1
v_pk_mul_f32 v[242:243], v[48:49], v[48:49]
v_pk_add_f32 v[240:241], v[48:49], v[50:51]
v_pk_fma_f32 v[242:243], v[50:51], v[50:51], v[242:243]
v_pk_mul_f32 v[218:219], v[96:97], v[96:97]
v_pk_add_f32 v[216:217], v[96:97], v[98:99]
v_pk_fma_f32 v[218:219], v[98:99], v[98:99], v[218:219]
v_pk_fma_f32 v[242:243], v[52:53], v[52:53], v[242:243]
v_pk_add_f32 v[240:241], v[240:241], v[52:53]
v_pk_fma_f32 v[242:243], v[54:55], v[54:55], v[242:243]
v_pk_add_f32 v[240:241], v[240:241], v[54:55]
v_pk_fma_f32 v[218:219], v[100:101], v[100:101], v[218:219]
v_pk_add_f32 v[216:217], v[216:217], v[100:101]
v_pk_fma_f32 v[218:219], v[102:103], v[102:103], v[218:219]
v_pk_add_f32 v[216:217], v[216:217], v[102:103]
v_pk_fma_f32 v[242:243], v[56:57], v[56:57], v[242:243]
v_pk_add_f32 v[240:241], v[240:241], v[56:57]
v_pk_fma_f32 v[242:243], v[58:59], v[58:59], v[242:243]
v_pk_add_f32 v[240:241], v[240:241], v[58:59]
v_pk_fma_f32 v[218:219], v[104:105], v[104:105], v[218:219]
v_pk_add_f32 v[216:217], v[216:217], v[104:105]
v_pk_fma_f32 v[218:219], v[106:107], v[106:107], v[218:219]
v_pk_add_f32 v[216:217], v[216:217], v[106:107]
v_pk_fma_f32 v[242:243], v[60:61], v[60:61], v[242:243]
v_pk_add_f32 v[240:241], v[240:241], v[60:61]
v_pk_fma_f32 v[242:243], v[62:63], v[62:63], v[242:243]
v_pk_add_f32 v[240:241], v[240:241], v[62:63]
v_pk_fma_f32 v[218:219], v[108:109], v[108:109], v[218:219]
v_pk_add_f32 v[216:217], v[216:217], v[108:109]
v_pk_fma_f32 v[218:219], v[110:111], v[110:111], v[218:219]
v_pk_add_f32 v[216:217], v[216:217], v[110:111]
v_pk_fma_f32 v[242:243], v[64:65], v[64:65], v[242:243]
v_pk_add_f32 v[240:241], v[240:241], v[64:65]
v_pk_fma_f32 v[242:243], v[66:67], v[66:67], v[242:243]
v_pk_add_f32 v[240:241], v[240:241], v[66:67]
v_pk_fma_f32 v[218:219], v[112:113], v[112:113], v[218:219]
v_pk_add_f32 v[216:217], v[216:217], v[112:113]
v_pk_fma_f32 v[218:219], v[114:115], v[114:115], v[218:219]
v_pk_add_f32 v[216:217], v[216:217], v[114:115]
v_pk_fma_f32 v[242:243], v[68:69], v[68:69], v[242:243]
v_pk_add_f32 v[240:241], v[240:241], v[68:69]
v_pk_fma_f32 v[242:243], v[70:71], v[70:71], v[242:243]
v_pk_add_f32 v[240:241], v[240:241], v[70:71]
v_pk_fma_f32 v[218:219], v[116:117], v[116:117], v[218:219]
v_pk_add_f32 v[216:217], v[216:217], v[116:117]
v_pk_fma_f32 v[218:219], v[118:119], v[118:119], v[218:219]
v_pk_add_f32 v[216:217], v[216:217], v[118:119]
v_pk_fma_f32 v[242:243], v[72:73], v[72:73], v[242:243]
v_pk_add_f32 v[240:241], v[240:241], v[72:73]
v_pk_fma_f32 v[242:243], v[74:75], v[74:75], v[242:243]
v_pk_add_f32 v[240:241], v[240:241], v[74:75]
v_pk_fma_f32 v[218:219], v[120:121], v[120:121], v[218:219]
v_pk_add_f32 v[216:217], v[216:217], v[120:121]
v_pk_fma_f32 v[218:219], v[122:123], v[122:123], v[218:219]
v_pk_add_f32 v[216:217], v[216:217], v[122:123]
v_pk_fma_f32 v[242:243], v[76:77], v[76:77], v[242:243]
v_pk_add_f32 v[240:241], v[240:241], v[76:77]
v_pk_fma_f32 v[242:243], v[78:79], v[78:79], v[242:243]
v_pk_add_f32 v[240:241], v[240:241], v[78:79]
v_pk_fma_f32 v[218:219], v[124:125], v[124:125], v[218:219]
v_pk_add_f32 v[216:217], v[216:217], v[124:125]
v_pk_fma_f32 v[218:219], v[126:127], v[126:127], v[218:219]
v_pk_add_f32 v[216:217], v[216:217], v[126:127]
v_pk_fma_f32 v[242:243], v[80:81], v[80:81], v[242:243]
v_pk_add_f32 v[240:241], v[240:241], v[80:81]
v_pk_fma_f32 v[242:243], v[82:83], v[82:83], v[242:243]
v_pk_add_f32 v[240:241], v[240:241], v[82:83]
v_pk_fma_f32 v[218:219], v[128:129], v[128:129], v[218:219]
v_pk_add_f32 v[216:217], v[216:217], v[128:129]
v_pk_fma_f32 v[218:219], v[130:131], v[130:131], v[218:219]
v_pk_add_f32 v[216:217], v[216:217], v[130:131]
v_pk_fma_f32 v[242:243], v[84:85], v[84:85], v[242:243]
v_pk_add_f32 v[240:241], v[240:241], v[84:85]
v_pk_fma_f32 v[242:243], v[86:87], v[86:87], v[242:243]
v_pk_add_f32 v[240:241], v[240:241], v[86:87]
v_pk_fma_f32 v[218:219], v[132:133], v[132:133], v[218:219]
v_pk_add_f32 v[216:217], v[216:217], v[132:133]
v_pk_fma_f32 v[218:219], v[134:135], v[134:135], v[218:219]
v_pk_add_f32 v[216:217], v[216:217], v[134:135]
v_pk_fma_f32 v[242:243], v[88:89], v[88:89], v[242:243]
v_pk_add_f32 v[240:241], v[240:241], v[88:89]
v_pk_fma_f32 v[242:243], v[90:91], v[90:91], v[242:243]
v_pk_add_f32 v[240:241], v[240:241], v[90:91]
v_pk_fma_f32 v[218:219], v[136:137], v[136:137], v[218:219]
v_pk_add_f32 v[216:217], v[216:217], v[136:137]
v_pk_fma_f32 v[218:219], v[138:139], v[138:139], v[218:219]
v_pk_add_f32 v[216:217], v[216:217], v[138:139]
v_pk_fma_f32 v[242:243], v[92:93], v[92:93], v[242:243]
v_pk_add_f32 v[240:241], v[240:241], v[92:93]
v_pk_fma_f32 v[242:243], v[94:95], v[94:95], v[242:243]
v_pk_add_f32 v[240:241], v[240:241], v[94:95]
v_pk_fma_f32 v[218:219], v[140:141], v[140:141], v[218:219]
v_pk_add_f32 v[216:217], v[216:217], v[140:141]
v_pk_fma_f32 v[218:219], v[142:143], v[142:143], v[218:219]
v_pk_add_f32 v[216:217], v[216:217], v[142:143]
v_add_f32 v218, v218, v219
v_add_f32 v216, v216, v217
s_nop 1
v_permlane32_swap_b32 v216, v218
v_add_f32_e64 v216, v216, v218
v_mul_f32 v216, 1009429163, v216
v_mov_b32_e64 v218, v216
s_nop 1
v_permlane32_swap_b32 v216, v218
v_fma_f32 v218, -v216, v216, v218
v_max_f32_e64 v218, 0, v218
v_add_f32 v218, 925353388, v218
v_rsq_f32 v218, v218
v_add_f32 v240, v240, v241
v_mul_f32 v220, 3203396952, v218
v_mul_f32 v221, 3203396952, v218
v_mul_f32 v218, v216, v220
v_mul_f32 v219, v216, v220
v_add_f32 v242, v242, v243
s_nop 1
v_permlane32_swap_b32 v240, v242
v_add_f32 v240, v240, v242
v_mul_f32 v240, 1009429163, v240
v_mov_b32_e64 v242, v240
s_nop 1
v_permlane32_swap_b32 v240, v242
v_fma_f32 v242, -v240, v240, v242
v_max_f32_e64 v242, 0, v242
v_add_f32 v242, 925353388, v242
v_rsq_f32 v242, v242
s_nop 0
v_mul_f32 v244, 3203396952, v242
v_mul_f32 v245, 3203396952, v242
v_mul_f32 v242, v240, v244
v_mul_f32 v243, v240, v244
v_pk_fma_f32 v[48:49], v[48:49], v[244:245], v[242:243] neg_lo:[0,0,1] neg_hi:[0,0,1]
v_pk_fma_f32 v[50:51], v[50:51], v[244:245], v[242:243] neg_lo:[0,0,1] neg_hi:[0,0,1]
v_cvt_pk_bf16_f32 v48, v48, v49
v_cvt_pk_bf16_f32 v49, v50, v51
v_pk_fma_f32 v[52:53], v[52:53], v[244:245], v[242:243] neg_lo:[0,0,1] neg_hi:[0,0,1]
v_pk_fma_f32 v[54:55], v[54:55], v[244:245], v[242:243] neg_lo:[0,0,1] neg_hi:[0,0,1]
v_cvt_pk_bf16_f32 v50, v52, v53
v_cvt_pk_bf16_f32 v51, v54, v55
v_pk_fma_f32 v[56:57], v[56:57], v[244:245], v[242:243] neg_lo:[0,0,1] neg_hi:[0,0,1]
v_pk_fma_f32 v[58:59], v[58:59], v[244:245], v[242:243] neg_lo:[0,0,1] neg_hi:[0,0,1]
v_cvt_pk_bf16_f32 v52, v56, v57
v_cvt_pk_bf16_f32 v53, v58, v59
v_pk_fma_f32 v[60:61], v[60:61], v[244:245], v[242:243] neg_lo:[0,0,1] neg_hi:[0,0,1]
v_pk_fma_f32 v[62:63], v[62:63], v[244:245], v[242:243] neg_lo:[0,0,1] neg_hi:[0,0,1]
v_cvt_pk_bf16_f32 v54, v60, v61
v_cvt_pk_bf16_f32 v55, v62, v63
v_pk_fma_f32 v[64:65], v[64:65], v[244:245], v[242:243] neg_lo:[0,0,1] neg_hi:[0,0,1]
v_pk_fma_f32 v[66:67], v[66:67], v[244:245], v[242:243] neg_lo:[0,0,1] neg_hi:[0,0,1]
v_cvt_pk_bf16_f32 v56, v64, v65
v_cvt_pk_bf16_f32 v57, v66, v67
v_pk_fma_f32 v[68:69], v[68:69], v[244:245], v[242:243] neg_lo:[0,0,1] neg_hi:[0,0,1]
v_pk_fma_f32 v[70:71], v[70:71], v[244:245], v[242:243] neg_lo:[0,0,1] neg_hi:[0,0,1]
v_cvt_pk_bf16_f32 v58, v68, v69
v_cvt_pk_bf16_f32 v59, v70, v71
v_pk_fma_f32 v[72:73], v[72:73], v[244:245], v[242:243] neg_lo:[0,0,1] neg_hi:[0,0,1]
v_pk_fma_f32 v[74:75], v[74:75], v[244:245], v[242:243] neg_lo:[0,0,1] neg_hi:[0,0,1]
v_cvt_pk_bf16_f32 v60, v72, v73
v_cvt_pk_bf16_f32 v61, v74, v75
v_pk_fma_f32 v[76:77], v[76:77], v[244:245], v[242:243] neg_lo:[0,0,1] neg_hi:[0,0,1]
v_pk_fma_f32 v[78:79], v[78:79], v[244:245], v[242:243] neg_lo:[0,0,1] neg_hi:[0,0,1]
v_cvt_pk_bf16_f32 v62, v76, v77
v_cvt_pk_bf16_f32 v63, v78, v79
v_pk_fma_f32 v[80:81], v[80:81], v[244:245], v[242:243] neg_lo:[0,0,1] neg_hi:[0,0,1]
v_pk_fma_f32 v[82:83], v[82:83], v[244:245], v[242:243] neg_lo:[0,0,1] neg_hi:[0,0,1]
v_cvt_pk_bf16_f32 v64, v80, v81
v_cvt_pk_bf16_f32 v65, v82, v83
v_pk_fma_f32 v[84:85], v[84:85], v[244:245], v[242:243] neg_lo:[0,0,1] neg_hi:[0,0,1]
v_pk_fma_f32 v[86:87], v[86:87], v[244:245], v[242:243] neg_lo:[0,0,1] neg_hi:[0,0,1]
v_cvt_pk_bf16_f32 v66, v84, v85
v_cvt_pk_bf16_f32 v67, v86, v87
v_pk_fma_f32 v[88:89], v[88:89], v[244:245], v[242:243] neg_lo:[0,0,1] neg_hi:[0,0,1]
v_pk_fma_f32 v[90:91], v[90:91], v[244:245], v[242:243] neg_lo:[0,0,1] neg_hi:[0,0,1]
v_cvt_pk_bf16_f32 v68, v88, v89
v_cvt_pk_bf16_f32 v69, v90, v91
v_pk_fma_f32 v[92:93], v[92:93], v[244:245], v[242:243] neg_lo:[0,0,1] neg_hi:[0,0,1]
v_pk_fma_f32 v[94:95], v[94:95], v[244:245], v[242:243] neg_lo:[0,0,1] neg_hi:[0,0,1]
v_cvt_pk_bf16_f32 v70, v92, v93
v_cvt_pk_bf16_f32 v71, v94, v95
v_pk_fma_f32 v[96:97], v[96:97], v[220:221], v[218:219] neg_lo:[0,0,1] neg_hi:[0,0,1]
ds_read_b128 v[176:179], v250
v_cvt_pk_bf16_f32 v72, v96, v97
v_pk_fma_f32 v[98:99], v[98:99], v[220:221], v[218:219] neg_lo:[0,0,1] neg_hi:[0,0,1]
v_pk_fma_f32 v[100:101], v[100:101], v[220:221], v[218:219] neg_lo:[0,0,1] neg_hi:[0,0,1]
v_cvt_pk_bf16_f32 v73, v98, v99
v_cvt_pk_bf16_f32 v74, v100, v101
v_pk_fma_f32 v[102:103], v[102:103], v[220:221], v[218:219] neg_lo:[0,0,1] neg_hi:[0,0,1]
v_pk_fma_f32 v[104:105], v[104:105], v[220:221], v[218:219] neg_lo:[0,0,1] neg_hi:[0,0,1]
v_cvt_pk_bf16_f32 v75, v102, v103
v_cvt_pk_bf16_f32 v76, v104, v105
v_pk_fma_f32 v[106:107], v[106:107], v[220:221], v[218:219] neg_lo:[0,0,1] neg_hi:[0,0,1]
v_pk_fma_f32 v[108:109], v[108:109], v[220:221], v[218:219] neg_lo:[0,0,1] neg_hi:[0,0,1]
v_cvt_pk_bf16_f32 v77, v106, v107
v_cvt_pk_bf16_f32 v78, v108, v109
v_pk_fma_f32 v[110:111], v[110:111], v[220:221], v[218:219] neg_lo:[0,0,1] neg_hi:[0,0,1]
v_pk_fma_f32 v[112:113], v[112:113], v[220:221], v[218:219] neg_lo:[0,0,1] neg_hi:[0,0,1]
v_cvt_pk_bf16_f32 v79, v110, v111
v_cvt_pk_bf16_f32 v80, v112, v113
v_pk_fma_f32 v[114:115], v[114:115], v[220:221], v[218:219] neg_lo:[0,0,1] neg_hi:[0,0,1]
v_pk_fma_f32 v[116:117], v[116:117], v[220:221], v[218:219] neg_lo:[0,0,1] neg_hi:[0,0,1]
v_cvt_pk_bf16_f32 v81, v114, v115
v_cvt_pk_bf16_f32 v82, v116, v117
v_pk_fma_f32 v[118:119], v[118:119], v[220:221], v[218:219] neg_lo:[0,0,1] neg_hi:[0,0,1]
v_pk_fma_f32 v[120:121], v[120:121], v[220:221], v[218:219] neg_lo:[0,0,1] neg_hi:[0,0,1]
ds_read_b128 v[180:183], v250 offset:1024
v_cvt_pk_bf16_f32 v83, v118, v119
v_cvt_pk_bf16_f32 v84, v120, v121
v_pk_fma_f32 v[122:123], v[122:123], v[220:221], v[218:219] neg_lo:[0,0,1] neg_hi:[0,0,1]
v_pk_fma_f32 v[124:125], v[124:125], v[220:221], v[218:219] neg_lo:[0,0,1] neg_hi:[0,0,1]
v_cvt_pk_bf16_f32 v85, v122, v123
v_cvt_pk_bf16_f32 v86, v124, v125
v_pk_fma_f32 v[126:127], v[126:127], v[220:221], v[218:219] neg_lo:[0,0,1] neg_hi:[0,0,1]
v_pk_fma_f32 v[128:129], v[128:129], v[220:221], v[218:219] neg_lo:[0,0,1] neg_hi:[0,0,1]
v_cvt_pk_bf16_f32 v87, v126, v127
v_cvt_pk_bf16_f32 v88, v128, v129
v_pk_fma_f32 v[130:131], v[130:131], v[220:221], v[218:219] neg_lo:[0,0,1] neg_hi:[0,0,1]
v_pk_fma_f32 v[132:133], v[132:133], v[220:221], v[218:219] neg_lo:[0,0,1] neg_hi:[0,0,1]
v_cvt_pk_bf16_f32 v89, v130, v131
v_cvt_pk_bf16_f32 v90, v132, v133
v_pk_fma_f32 v[134:135], v[134:135], v[220:221], v[218:219] neg_lo:[0,0,1] neg_hi:[0,0,1]
v_pk_fma_f32 v[136:137], v[136:137], v[220:221], v[218:219] neg_lo:[0,0,1] neg_hi:[0,0,1]
v_cvt_pk_bf16_f32 v91, v134, v135
v_cvt_pk_bf16_f32 v92, v136, v137
v_pk_fma_f32 v[138:139], v[138:139], v[220:221], v[218:219] neg_lo:[0,0,1] neg_hi:[0,0,1]
v_pk_fma_f32 v[140:141], v[140:141], v[220:221], v[218:219] neg_lo:[0,0,1] neg_hi:[0,0,1]
v_cvt_pk_bf16_f32 v93, v138, v139
v_cvt_pk_bf16_f32 v94, v140, v141
v_pk_fma_f32 v[142:143], v[142:143], v[220:221], v[218:219] neg_lo:[0,0,1] neg_hi:[0,0,1]
ds_read_b128 v[184:187], v250 offset:2048
v_cvt_pk_bf16_f32 v95, v142, v143
v_cndmask_b32 v216, 0, v255, s[50:51]
v_and_b32 v216, 1006648320, v216
v_cndmask_b32 v217, 0, v255, s[52:53]
v_and_b32 v217, 1006648320, v217
v_cndmask_b32 v218, 0, v255, s[54:55]
v_and_b32 v218, 1006648320, v218
v_cndmask_b32 v219, 0, v255, s[56:57]
v_and_b32 v219, 1006648320, v219
v_cndmask_b32 v220, 0, v255, s[58:59]
v_and_b32 v220, 1006648320, v220
v_cndmask_b32 v221, 0, v255, s[60:61]
v_and_b32 v221, 1006648320, v221
v_cndmask_b32 v222, 0, v255, s[62:63]
v_and_b32 v222, 1006648320, v222
v_cndmask_b32 v223, 0, v255, s[64:65]
v_and_b32 v223, 1006648320, v223
s_waitcnt lgkmcnt(1)
v_mfma_f32_32x32x16_bf16 v[144:159], v[48:51], v[176:179], 0
s_cmp_lt_u32 s40, 4
s_cbranch_scc0 Lbk
s_setprio 2
Lbk:
ds_read_b128 v[188:191], v250 offset:3072
v_mfma_f32_32x32x16_bf16 v[160:175], v[72:75], v[176:179], 0
ds_read_b128 v[176:179], v250 offset:4096
v_mfma_f32_32x32x16_bf16 v[144:159], v[52:55], v[180:183], v[144:159]
v_mfma_f32_32x32x16_bf16 v[160:175], v[76:79], v[180:183], v[160:175]
ds_read_b128 v[180:183], v250 offset:5120
s_waitcnt lgkmcnt(3)
v_mfma_f32_32x32x16_bf16 v[144:159], v[56:59], v[184:187], v[144:159]
v_mfma_f32_32x32x16_bf16 v[160:175], v[80:83], v[184:187], v[160:175]
ds_read_b128 v[184:187], v250 offset:6144
s_waitcnt lgkmcnt(2)
v_mfma_f32_32x32x16_bf16 v[144:159], v[60:63], v[188:191], v[144:159]
v_mfma_f32_32x32x16_bf16 v[160:175], v[84:87], v[188:191], v[160:175]
ds_read_b128 v[188:191], v250 offset:7168
v_mfma_f32_32x32x16_bf16 v[144:159], v[64:67], v[176:179], v[144:159]
v_mfma_f32_32x32x16_bf16 v[160:175], v[88:91], v[176:179], v[160:175]
ds_read_b128 v[176:179], v250 offset:8192
s_waitcnt lgkmcnt(2)
v_mfma_f32_32x32x16_bf16 v[144:159], v[68:71], v[180:183], v[144:159]
v_mfma_f32_32x32x16_bf16 v[160:175], v[92:95], v[180:183], v[160:175]
ds_read_b128 v[180:183], v250 offset:9216
s_nop 9
v_cvt_pkrtz_f16_f32 v144, v144, v145
v_mfma_f32_32x32x16_bf16 v[112:127], v[48:51], v[184:187], 0
v_cvt_pkrtz_f16_f32 v145, v146, v147
v_lshrrev_b64 v[144:145], 2, v[144:145]
v_and_b32_sdwa v146, s47, v144 dst_sel:DWORD dst_unused:UNUSED_PAD src0_sel:DWORD src1_sel:WORD_1
v_and_b32_e64 v144, s47, v144
v_cvt_pk_f16_f32 v156, v156, v157
v_cvt_pk_f16_f32 v158, v158, v159
v_mfma_f32_32x32x16_bf16 v[128:143], v[72:75], v[184:187], 0
ds_read_u16 v146, v146
ds_read_u16 v144, v144
v_pk_fma_f16 v157, v156, v156, s48
v_and_b32_sdwa v147, s47, v145 dst_sel:DWORD dst_unused:UNUSED_PAD src0_sel:DWORD src1_sel:WORD_1
v_and_b32_e64 v145, s47, v145
v_pk_fma_f16 v159, v158, v158, s48
v_pk_mul_f16 v157, v156, v157
v_pk_mul_f16 v159, v158, v159
v_cvt_pkrtz_f16_f32 v148, v148, v149
v_cvt_pkrtz_f16_f32 v149, v150, v151
v_lshrrev_b64 v[148:149], 2, v[148:149]
ds_read_u16 v147, v147
ds_read_u16 v145, v145
v_and_b32_sdwa v150, s47, v148 dst_sel:DWORD dst_unused:UNUSED_PAD src0_sel:DWORD src1_sel:WORD_1
v_and_b32 v148, s47, v148
v_exp_f16_sdwa v157, v157 dst_sel:WORD_0 dst_unused:UNUSED_PRESERVE src0_sel:WORD_0
s_waitcnt lgkmcnt(4)
v_mfma_f32_32x32x16_bf16 v[112:127], v[52:55], v[188:191], v[112:127]
ds_read_u16 v150, v150
ds_read_u16 v148, v148
v_exp_f16_sdwa v159, v159 dst_sel:WORD_0 dst_unused:UNUSED_PRESERVE src0_sel:WORD_0
v_and_b32_sdwa v151, s47, v149 dst_sel:DWORD dst_unused:UNUSED_PAD src0_sel:DWORD src1_sel:WORD_1
v_and_b32_e64 v149, s47, v149
v_exp_f16_sdwa v157, v157 dst_sel:WORD_1 dst_unused:UNUSED_PRESERVE src0_sel:WORD_1
v_cvt_pkrtz_f16_f32 v152, v152, v153
v_cvt_pkrtz_f16_f32 v153, v154, v155
v_lshrrev_b64 v[152:153], 2, v[152:153]
v_and_b32_sdwa v154, s47, v152 dst_sel:DWORD dst_unused:UNUSED_PAD src0_sel:DWORD src1_sel:WORD_1
v_and_b32_e64 v152, s47, v152
ds_read_u16 v151, v151
ds_read_u16 v149, v149
ds_read_u16 v154, v154
ds_read_u16 v152, v152
v_mfma_f32_32x32x16_bf16 v[128:143], v[76:79], v[188:191], v[128:143]
v_exp_f16_sdwa v159, v159 dst_sel:WORD_1 dst_unused:UNUSED_PRESERVE src0_sel:WORD_1
v_and_b32_sdwa v155, s47, v153 dst_sel:DWORD dst_unused:UNUSED_PAD src0_sel:DWORD src1_sel:WORD_1
v_and_b32_e64 v153, s47, v153
v_pk_add_f16 v157, v157, 1.0 op_sel_hi:[1,0]
v_pk_add_f16 v159, v159, 1.0 op_sel_hi:[1,0]
v_rcp_f16_sdwa v157, v157 dst_sel:WORD_0 dst_unused:UNUSED_PRESERVE src0_sel:WORD_0
v_mfma_f32_32x32x16_bf16 v[112:127], v[56:59], v[176:179], v[112:127]
ds_read_b128 v[184:187], v250 offset:10240
ds_read_u16 v155, v155
ds_read_u16 v153, v153
v_rcp_f16_sdwa v159, v159 dst_sel:WORD_0 dst_unused:UNUSED_PRESERVE src0_sel:WORD_0
v_rcp_f16_sdwa v157, v157 dst_sel:WORD_1 dst_unused:UNUSED_PRESERVE src0_sel:WORD_1
v_mfma_f32_32x32x16_bf16 v[128:143], v[80:83], v[176:179], v[128:143]
v_rcp_f16_sdwa v159, v159 dst_sel:WORD_1 dst_unused:UNUSED_PRESERVE src0_sel:WORD_1
v_pk_mul_f16 v156, v156, v157
v_pk_mul_f16 v158, v158, v159
v_fma_mix_f32 v224, v156, v156, v224 op_sel_hi:[1,1,0]
v_mfma_f32_32x32x16_bf16 v[112:127], v[60:63], v[180:183], v[112:127]
ds_read_b128 v[188:191], v250 offset:11264
v_fma_mix_f32 v224, v158, v158, v224 op_sel_hi:[1,1,0]
v_cvt_pkrtz_f16_f32 v160, v160, v161
v_fma_mix_f32 v224, v156, v156, v224 op_sel:[1,1,0] op_sel_hi:[1,1,0]
v_cvt_pkrtz_f16_f32 v161, v162, v163
v_fma_mix_f32 v224, v158, v158, v224 op_sel:[1,1,0] op_sel_hi:[1,1,0]
v_lshrrev_b64 v[160:161], 2, v[160:161]
s_waitcnt lgkmcnt(7)
v_fma_mix_f32 v224, v144, v144, v224 op_sel_hi:[1,1,0]
v_and_b32_sdwa v162, s47, v160 dst_sel:DWORD dst_unused:UNUSED_PAD src0_sel:DWORD src1_sel:WORD_1
v_fma_mix_f32 v224, v145, v145, v224 op_sel_hi:[1,1,0]
v_and_b32 v160, s47, v160
v_fma_mix_f32 v224, v146, v146, v224 op_sel_hi:[1,1,0]
v_cvt_pk_f16_f32 v172, v172, v173
v_fma_mix_f32 v224, v147, v147, v224 op_sel_hi:[1,1,0]
v_cvt_pk_f16_f32 v174, v174, v175
v_mfma_f32_32x32x16_bf16 v[128:143], v[84:87], v[180:183], v[128:143]
ds_read_u16 v162, v162
ds_read_u16 v160, v160
v_pk_fma_f16 v173, v172, v172, s48
v_fma_mix_f32 v224, v148, v148, v224 op_sel_hi:[1,1,0]
v_and_b32_sdwa v163, s47, v161 dst_sel:DWORD dst_unused:UNUSED_PAD src0_sel:DWORD src1_sel:WORD_1
s_waitcnt lgkmcnt(6)
v_fma_mix_f32 v224, v149, v149, v224 op_sel_hi:[1,1,0]
v_and_b32 v161, s47, v161
v_pk_fma_f16 v175, v174, v174, s48
v_pk_mul_f16 v173, v172, v173
v_pk_mul_f16 v175, v174, v175
v_fma_mix_f32 v224, v150, v150, v224 op_sel_hi:[1,1,0]
v_cvt_pkrtz_f16_f32 v164, v164, v165
v_fma_mix_f32 v224, v151, v151, v224 op_sel_hi:[1,1,0]
ds_read_u16 v163, v163
ds_read_u16 v161, v161
ds_read_b128 v[176:179], v250 offset:12288
v_cvt_pkrtz_f16_f32 v165, v166, v167
v_lshrrev_b64 v[164:165], 2, v[164:165]
v_and_b32_sdwa v166, s47, v164 dst_sel:DWORD dst_unused:UNUSED_PAD src0_sel:DWORD src1_sel:WORD_1
v_and_b32 v164, s47, v164
v_exp_f16_sdwa v173, v173 dst_sel:WORD_0 dst_unused:UNUSED_PRESERVE src0_sel:WORD_0
s_waitcnt lgkmcnt(6)
v_mfma_f32_32x32x16_bf16 v[112:127], v[64:67], v[184:187], v[112:127]
ds_read_u16 v166, v166
ds_read_u16 v164, v164
v_fma_mix_f32 v224, v152, v152, v224 op_sel_hi:[1,1,0]
v_exp_f16_sdwa v175, v175 dst_sel:WORD_0 dst_unused:UNUSED_PRESERVE src0_sel:WORD_0
v_fma_mix_f32 v224, v153, v153, v224 op_sel_hi:[1,1,0]
v_and_b32_sdwa v167, s47, v165 dst_sel:DWORD dst_unused:UNUSED_PAD src0_sel:DWORD src1_sel:WORD_1
v_and_b32_e64 v165, s47, v165
v_exp_f16_sdwa v173, v173 dst_sel:WORD_1 dst_unused:UNUSED_PRESERVE src0_sel:WORD_1
v_fma_mix_f32 v224, v154, v154, v224 op_sel_hi:[1,1,0]
v_cvt_pkrtz_f16_f32 v168, v168, v169
v_fma_mix_f32 v224, v155, v155, v224 op_sel_hi:[1,1,0]
v_cvt_pkrtz_f16_f32 v169, v170, v171
v_lshrrev_b64 v[168:169], 2, v[168:169]
ds_read_u16 v167, v167
ds_read_u16 v165, v165
v_and_b32_sdwa v170, s47, v168 dst_sel:DWORD dst_unused:UNUSED_PAD src0_sel:DWORD src1_sel:WORD_1
v_and_b32_e64 v168, s47, v168
v_mfma_f32_32x32x16_bf16 v[128:143], v[88:91], v[184:187], v[128:143]
ds_read_u16 v170, v170
ds_read_u16 v168, v168
v_exp_f16_sdwa v175, v175 dst_sel:WORD_1 dst_unused:UNUSED_PRESERVE src0_sel:WORD_1
v_and_b32_sdwa v171, s47, v169 dst_sel:DWORD dst_unused:UNUSED_PAD src0_sel:DWORD src1_sel:WORD_1
v_and_b32 v169, s47, v169
v_pk_add_f16 v173, v173, 1.0 op_sel_hi:[1,0]
v_pk_add_f16 v175, v175, 1.0 op_sel_hi:[1,0]
v_rcp_f16_sdwa v173, v173 dst_sel:WORD_0 dst_unused:UNUSED_PRESERVE src0_sel:WORD_0
s_waitcnt lgkmcnt(6)
v_mfma_f32_32x32x16_bf16 v[112:127], v[68:71], v[188:191], v[112:127]
ds_read_b128 v[180:183], v250 offset:13312
ds_read_u16 v171, v171
ds_read_u16 v169, v169
v_rcp_f16_sdwa v175, v175 dst_sel:WORD_0 dst_unused:UNUSED_PRESERVE src0_sel:WORD_0
v_rcp_f16_sdwa v173, v173 dst_sel:WORD_1 dst_unused:UNUSED_PRESERVE src0_sel:WORD_1
v_mfma_f32_32x32x16_bf16 v[128:143], v[92:95], v[188:191], v[128:143]
v_rcp_f16_sdwa v175, v175 dst_sel:WORD_1 dst_unused:UNUSED_PRESERVE src0_sel:WORD_1
v_pk_mul_f16 v172, v172, v173
v_pk_mul_f16 v174, v174, v175
v_fma_mix_f32 v224, v172, v172, v224 op_sel_hi:[1,1,0]
v_mfma_f32_32x32x16_bf16 v[96:111], v[48:51], v[176:179], 0
ds_read_b128 v[184:187], v250 offset:14336
v_fma_mix_f32 v224, v174, v174, v224 op_sel_hi:[1,1,0]
v_cvt_pkrtz_f16_f32 v112, v112, v113
v_fma_mix_f32 v224, v172, v172, v224 op_sel:[1,1,0] op_sel_hi:[1,1,0]
v_cvt_pkrtz_f16_f32 v113, v114, v115
v_fma_mix_f32 v224, v174, v174, v224 op_sel:[1,1,0] op_sel_hi:[1,1,0]
v_lshrrev_b64 v[112:113], 2, v[112:113]
v_fma_mix_f32 v224, v160, v160, v224 op_sel_hi:[1,1,0]
v_and_b32_sdwa v114, s47, v112 dst_sel:DWORD dst_unused:UNUSED_PAD src0_sel:DWORD src1_sel:WORD_1
v_fma_mix_f32 v224, v161, v161, v224 op_sel_hi:[1,1,0]
v_and_b32_e64 v112, s47, v112
v_fma_mix_f32 v224, v162, v162, v224 op_sel_hi:[1,1,0]
v_cvt_pk_f16_f32 v124, v124, v125
v_fma_mix_f32 v224, v163, v163, v224 op_sel_hi:[1,1,0]
v_cvt_pk_f16_f32 v126, v126, v127
v_mfma_f32_32x32x16_bf16 v[144:159], v[176:179], v[72:75], 0
ds_read_u16 v114, v114
ds_read_u16 v112, v112
v_pk_fma_f16 v125, v124, v124, s48
s_waitcnt lgkmcnt(5)
v_fma_mix_f32 v224, v164, v164, v224 op_sel_hi:[1,1,0]
v_and_b32_sdwa v115, s47, v113 dst_sel:DWORD dst_unused:UNUSED_PAD src0_sel:DWORD src1_sel:WORD_1
v_fma_mix_f32 v224, v165, v165, v224 op_sel_hi:[1,1,0]
v_and_b32 v113, s47, v113
v_pk_fma_f16 v127, v126, v126, s48
v_pk_mul_f16 v125, v124, v125
v_pk_mul_f16 v127, v126, v127
v_fma_mix_f32 v224, v166, v166, v224 op_sel_hi:[1,1,0]
v_cvt_pkrtz_f16_f32 v116, v116, v117
v_fma_mix_f32 v224, v167, v167, v224 op_sel_hi:[1,1,0]
ds_read_u16 v115, v115
ds_read_u16 v113, v113
ds_read_b128 v[188:191], v250 offset:15360
v_cvt_pkrtz_f16_f32 v117, v118, v119
v_lshrrev_b64 v[116:117], 2, v[116:117]
v_and_b32_sdwa v118, s47, v116 dst_sel:DWORD dst_unused:UNUSED_PAD src0_sel:DWORD src1_sel:WORD_1
v_and_b32_e64 v116, s47, v116
v_exp_f16_sdwa v125, v125 dst_sel:WORD_0 dst_unused:UNUSED_PRESERVE src0_sel:WORD_0
v_mfma_f32_32x32x16_bf16 v[96:111], v[52:55], v[180:183], v[96:111]
ds_read_u16 v118, v118
ds_read_u16 v116, v116
v_fma_mix_f32 v224, v168, v168, v224 op_sel_hi:[1,1,0]
v_exp_f16_sdwa v127, v127 dst_sel:WORD_0 dst_unused:UNUSED_PRESERVE src0_sel:WORD_0
s_waitcnt lgkmcnt(7)
v_fma_mix_f32 v224, v169, v169, v224 op_sel_hi:[1,1,0]
v_and_b32_sdwa v119, s47, v117 dst_sel:DWORD dst_unused:UNUSED_PAD src0_sel:DWORD src1_sel:WORD_1
v_and_b32 v117, s47, v117
v_exp_f16_sdwa v125, v125 dst_sel:WORD_1 dst_unused:UNUSED_PRESERVE src0_sel:WORD_1
v_fma_mix_f32 v224, v170, v170, v224 op_sel_hi:[1,1,0]
v_cvt_pkrtz_f16_f32 v120, v120, v121
v_fma_mix_f32 v224, v171, v171, v224 op_sel_hi:[1,1,0]
v_cvt_pkrtz_f16_f32 v121, v122, v123
v_lshrrev_b64 v[120:121], 2, v[120:121]
ds_read_u16 v119, v119
ds_read_u16 v117, v117
v_and_b32_sdwa v122, s47, v120 dst_sel:DWORD dst_unused:UNUSED_PAD src0_sel:DWORD src1_sel:WORD_1
v_and_b32_e64 v120, s47, v120
v_mfma_f32_32x32x16_bf16 v[144:159], v[180:183], v[76:79], v[144:159]
ds_read_u16 v122, v122
ds_read_u16 v120, v120
v_exp_f16_sdwa v127, v127 dst_sel:WORD_1 dst_unused:UNUSED_PRESERVE src0_sel:WORD_1
v_and_b32_sdwa v123, s47, v121 dst_sel:DWORD dst_unused:UNUSED_PAD src0_sel:DWORD src1_sel:WORD_1
v_and_b32_e64 v121, s47, v121
v_pk_add_f16 v125, v125, 1.0 op_sel_hi:[1,0]
v_pk_add_f16 v127, v127, 1.0 op_sel_hi:[1,0]
v_rcp_f16_sdwa v125, v125 dst_sel:WORD_0 dst_unused:UNUSED_PRESERVE src0_sel:WORD_0
v_mfma_f32_32x32x16_bf16 v[96:111], v[56:59], v[184:187], v[96:111]
ds_read_b128 v[176:179], v250 offset:16384
ds_read_u16 v123, v123
ds_read_u16 v121, v121
v_rcp_f16_sdwa v127, v127 dst_sel:WORD_0 dst_unused:UNUSED_PRESERVE src0_sel:WORD_0
v_rcp_f16_sdwa v125, v125 dst_sel:WORD_1 dst_unused:UNUSED_PRESERVE src0_sel:WORD_1
v_mfma_f32_32x32x16_bf16 v[144:159], v[184:187], v[80:83], v[144:159]
v_rcp_f16_sdwa v127, v127 dst_sel:WORD_1 dst_unused:UNUSED_PRESERVE src0_sel:WORD_1
v_pk_mul_f16 v124, v124, v125
v_pk_mul_f16 v126, v126, v127
v_fma_mix_f32 v225, v124, v124, v225 op_sel_hi:[1,1,0]
s_waitcnt lgkmcnt(7)
v_mfma_f32_32x32x16_bf16 v[96:111], v[60:63], v[188:191], v[96:111]
ds_read_b128 v[180:183], v250 offset:17408
v_fma_mix_f32 v225, v126, v126, v225 op_sel_hi:[1,1,0]
v_cvt_pkrtz_f16_f32 v128, v128, v129
v_fma_mix_f32 v225, v124, v124, v225 op_sel:[1,1,0] op_sel_hi:[1,1,0]
v_cvt_pkrtz_f16_f32 v129, v130, v131
v_fma_mix_f32 v225, v126, v126, v225 op_sel:[1,1,0] op_sel_hi:[1,1,0]
v_lshrrev_b64 v[128:129], 2, v[128:129]
v_fma_mix_f32 v225, v112, v112, v225 op_sel_hi:[1,1,0]
v_and_b32_sdwa v130, s47, v128 dst_sel:DWORD dst_unused:UNUSED_PAD src0_sel:DWORD src1_sel:WORD_1
v_fma_mix_f32 v225, v113, v113, v225 op_sel_hi:[1,1,0]
v_and_b32 v128, s47, v128
v_fma_mix_f32 v225, v114, v114, v225 op_sel_hi:[1,1,0]
v_cvt_pk_f16_f32 v140, v140, v141
v_fma_mix_f32 v225, v115, v115, v225 op_sel_hi:[1,1,0]
v_cvt_pk_f16_f32 v142, v142, v143
v_mfma_f32_32x32x16_bf16 v[144:159], v[188:191], v[84:87], v[144:159]
ds_read_u16 v130, v130
ds_read_u16 v128, v128
v_pk_fma_f16 v141, v140, v140, s48
v_fma_mix_f32 v225, v116, v116, v225 op_sel_hi:[1,1,0]
v_and_b32_sdwa v131, s47, v129 dst_sel:DWORD dst_unused:UNUSED_PAD src0_sel:DWORD src1_sel:WORD_1
s_waitcnt lgkmcnt(5)
v_fma_mix_f32 v225, v117, v117, v225 op_sel_hi:[1,1,0]
v_and_b32 v129, s47, v129
v_pk_fma_f16 v143, v142, v142, s48
v_pk_mul_f16 v141, v140, v141
v_pk_mul_f16 v143, v142, v143
v_fma_mix_f32 v225, v118, v118, v225 op_sel_hi:[1,1,0]
v_cvt_pkrtz_f16_f32 v132, v132, v133
v_fma_mix_f32 v225, v119, v119, v225 op_sel_hi:[1,1,0]
ds_read_u16 v131, v131
ds_read_u16 v129, v129
ds_read_b128 v[184:187], v250 offset:18432
v_cvt_pkrtz_f16_f32 v133, v134, v135
v_lshrrev_b64 v[132:133], 2, v[132:133]
v_and_b32_sdwa v134, s47, v132 dst_sel:DWORD dst_unused:UNUSED_PAD src0_sel:DWORD src1_sel:WORD_1
v_and_b32_e64 v132, s47, v132
v_exp_f16_sdwa v141, v141 dst_sel:WORD_0 dst_unused:UNUSED_PRESERVE src0_sel:WORD_0
v_mfma_f32_32x32x16_bf16 v[96:111], v[64:67], v[176:179], v[96:111]
ds_read_u16 v134, v134
ds_read_u16 v132, v132
v_fma_mix_f32 v225, v120, v120, v225 op_sel_hi:[1,1,0]
v_exp_f16_sdwa v143, v143 dst_sel:WORD_0 dst_unused:UNUSED_PRESERVE src0_sel:WORD_0
s_waitcnt lgkmcnt(7)
v_fma_mix_f32 v225, v121, v121, v225 op_sel_hi:[1,1,0]
v_and_b32_sdwa v135, s47, v133 dst_sel:DWORD dst_unused:UNUSED_PAD src0_sel:DWORD src1_sel:WORD_1
v_and_b32 v133, s47, v133
v_exp_f16_sdwa v141, v141 dst_sel:WORD_1 dst_unused:UNUSED_PRESERVE src0_sel:WORD_1
v_fma_mix_f32 v225, v122, v122, v225 op_sel_hi:[1,1,0]
v_cvt_pkrtz_f16_f32 v136, v136, v137
v_fma_mix_f32 v225, v123, v123, v225 op_sel_hi:[1,1,0]
v_cvt_pkrtz_f16_f32 v137, v138, v139
v_lshrrev_b64 v[136:137], 2, v[136:137]
ds_read_u16 v135, v135
ds_read_u16 v133, v133
v_and_b32_sdwa v138, s47, v136 dst_sel:DWORD dst_unused:UNUSED_PAD src0_sel:DWORD src1_sel:WORD_1
v_and_b32_e64 v136, s47, v136
v_mfma_f32_32x32x16_bf16 v[144:159], v[176:179], v[88:91], v[144:159]
ds_read_u16 v138, v138
ds_read_u16 v136, v136
v_exp_f16_sdwa v143, v143 dst_sel:WORD_1 dst_unused:UNUSED_PRESERVE src0_sel:WORD_1
v_and_b32_sdwa v139, s47, v137 dst_sel:DWORD dst_unused:UNUSED_PAD src0_sel:DWORD src1_sel:WORD_1
v_and_b32_e64 v137, s47, v137
v_pk_add_f16 v141, v141, 1.0 op_sel_hi:[1,0]
v_pk_add_f16 v143, v143, 1.0 op_sel_hi:[1,0]
v_rcp_f16_sdwa v141, v141 dst_sel:WORD_0 dst_unused:UNUSED_PRESERVE src0_sel:WORD_0
v_mfma_f32_32x32x16_bf16 v[96:111], v[68:71], v[180:183], v[96:111]
ds_read_b128 v[188:191], v250 offset:19456
ds_read_u16 v139, v139
ds_read_u16 v137, v137
v_rcp_f16_sdwa v143, v143 dst_sel:WORD_0 dst_unused:UNUSED_PRESERVE src0_sel:WORD_0
v_rcp_f16_sdwa v141, v141 dst_sel:WORD_1 dst_unused:UNUSED_PRESERVE src0_sel:WORD_1
v_mfma_f32_32x32x16_bf16 v[144:159], v[180:183], v[92:95], v[144:159]
v_rcp_f16_sdwa v143, v143 dst_sel:WORD_1 dst_unused:UNUSED_PRESERVE src0_sel:WORD_1
v_pk_mul_f16 v140, v140, v141
v_pk_mul_f16 v142, v142, v143
v_fma_mix_f32 v225, v140, v140, v225 op_sel_hi:[1,1,0]
s_waitcnt lgkmcnt(7)
v_mfma_f32_32x32x16_bf16 v[160:175], v[48:51], v[184:187], 0
ds_read_b128 v[176:179], v250 offset:20480
v_fma_mix_f32 v225, v142, v142, v225 op_sel_hi:[1,1,0]
v_cvt_pkrtz_f16_f32 v96, v96, v97
v_fma_mix_f32 v225, v140, v140, v225 op_sel:[1,1,0] op_sel_hi:[1,1,0]
v_cvt_pkrtz_f16_f32 v97, v98, v99
v_fma_mix_f32 v225, v142, v142, v225 op_sel:[1,1,0] op_sel_hi:[1,1,0]
v_lshrrev_b64 v[96:97], 2, v[96:97]
v_fma_mix_f32 v225, v128, v128, v225 op_sel_hi:[1,1,0]
v_and_b32_sdwa v98, s47, v96 dst_sel:DWORD dst_unused:UNUSED_PAD src0_sel:DWORD src1_sel:WORD_1
v_fma_mix_f32 v225, v129, v129, v225 op_sel_hi:[1,1,0]
v_and_b32 v96, s47, v96
v_fma_mix_f32 v225, v130, v130, v225 op_sel_hi:[1,1,0]
v_cvt_pk_f16_f32 v108, v108, v109
v_fma_mix_f32 v225, v131, v131, v225 op_sel_hi:[1,1,0]
v_cvt_pk_f16_f32 v110, v110, v111
v_mfma_f32_32x32x16_bf16 v[112:127], v[184:187], v[72:75], 0
ds_read_u16 v98, v98
ds_read_u16 v96, v96
v_pk_fma_f16 v109, v108, v108, s48
v_fma_mix_f32 v225, v132, v132, v225 op_sel_hi:[1,1,0]
v_and_b32_sdwa v99, s47, v97 dst_sel:DWORD dst_unused:UNUSED_PAD src0_sel:DWORD src1_sel:WORD_1
s_waitcnt lgkmcnt(5)
v_fma_mix_f32 v225, v133, v133, v225 op_sel_hi:[1,1,0]
v_and_b32 v97, s47, v97
v_pk_fma_f16 v111, v110, v110, s48
v_pk_mul_f16 v109, v108, v109
v_pk_mul_f16 v111, v110, v111
v_fma_mix_f32 v225, v134, v134, v225 op_sel_hi:[1,1,0]
v_cvt_pkrtz_f16_f32 v100, v100, v101
v_fma_mix_f32 v225, v135, v135, v225 op_sel_hi:[1,1,0]
ds_read_u16 v99, v99
ds_read_u16 v97, v97
ds_read_b128 v[180:183], v250 offset:21504
v_cvt_pkrtz_f16_f32 v101, v102, v103
v_lshrrev_b64 v[100:101], 2, v[100:101]
v_and_b32_sdwa v102, s47, v100 dst_sel:DWORD dst_unused:UNUSED_PAD src0_sel:DWORD src1_sel:WORD_1
v_and_b32_e64 v100, s47, v100
v_exp_f16_sdwa v109, v109 dst_sel:WORD_0 dst_unused:UNUSED_PRESERVE src0_sel:WORD_0
v_mfma_f32_32x32x16_bf16 v[160:175], v[52:55], v[188:191], v[160:175]
ds_read_u16 v102, v102
ds_read_u16 v100, v100
v_fma_mix_f32 v225, v136, v136, v225 op_sel_hi:[1,1,0]
v_exp_f16_sdwa v111, v111 dst_sel:WORD_0 dst_unused:UNUSED_PRESERVE src0_sel:WORD_0
s_waitcnt lgkmcnt(7)
v_fma_mix_f32 v225, v137, v137, v225 op_sel_hi:[1,1,0]
v_and_b32_sdwa v103, s47, v101 dst_sel:DWORD dst_unused:UNUSED_PAD src0_sel:DWORD src1_sel:WORD_1
v_and_b32 v101, s47, v101
v_exp_f16_sdwa v109, v109 dst_sel:WORD_1 dst_unused:UNUSED_PRESERVE src0_sel:WORD_1
v_fma_mix_f32 v225, v138, v138, v225 op_sel_hi:[1,1,0]
v_cvt_pkrtz_f16_f32 v104, v104, v105
v_fma_mix_f32 v225, v139, v139, v225 op_sel_hi:[1,1,0]
v_cvt_pkrtz_f16_f32 v105, v106, v107
v_lshrrev_b64 v[104:105], 2, v[104:105]
ds_read_u16 v103, v103
ds_read_u16 v101, v101
v_and_b32_sdwa v106, s47, v104 dst_sel:DWORD dst_unused:UNUSED_PAD src0_sel:DWORD src1_sel:WORD_1
v_and_b32_e64 v104, s47, v104
v_mfma_f32_32x32x16_bf16 v[112:127], v[188:191], v[76:79], v[112:127]
ds_read_u16 v106, v106
ds_read_u16 v104, v104
v_exp_f16_sdwa v111, v111 dst_sel:WORD_1 dst_unused:UNUSED_PRESERVE src0_sel:WORD_1
v_and_b32_sdwa v107, s47, v105 dst_sel:DWORD dst_unused:UNUSED_PAD src0_sel:DWORD src1_sel:WORD_1
v_and_b32_e64 v105, s47, v105
v_pk_add_f16 v109, v109, 1.0 op_sel_hi:[1,0]
v_pk_add_f16 v111, v111, 1.0 op_sel_hi:[1,0]
v_rcp_f16_sdwa v109, v109 dst_sel:WORD_0 dst_unused:UNUSED_PRESERVE src0_sel:WORD_0
v_mfma_f32_32x32x16_bf16 v[160:175], v[56:59], v[176:179], v[160:175]
ds_read_b128 v[184:187], v250 offset:22528
ds_read_u16 v107, v107
ds_read_u16 v105, v105
v_rcp_f16_sdwa v111, v111 dst_sel:WORD_0 dst_unused:UNUSED_PRESERVE src0_sel:WORD_0
v_rcp_f16_sdwa v109, v109 dst_sel:WORD_1 dst_unused:UNUSED_PRESERVE src0_sel:WORD_1
v_mfma_f32_32x32x16_bf16 v[112:127], v[176:179], v[80:83], v[112:127]
v_rcp_f16_sdwa v111, v111 dst_sel:WORD_1 dst_unused:UNUSED_PRESERVE src0_sel:WORD_1
v_pk_mul_f16 v108, v108, v109
v_pk_mul_f16 v110, v110, v111
v_fma_mix_f32 v226, v108, v108, v226 op_sel_hi:[1,1,0]
s_waitcnt lgkmcnt(7)
v_mfma_f32_32x32x16_bf16 v[160:175], v[60:63], v[180:183], v[160:175]
ds_read_b128 v[188:191], v250 offset:23552
v_fma_mix_f32 v226, v110, v110, v226 op_sel_hi:[1,1,0]
v_cvt_pkrtz_f16_f32 v144, v144, v145
v_fma_mix_f32 v226, v108, v108, v226 op_sel:[1,1,0] op_sel_hi:[1,1,0]
v_cvt_pkrtz_f16_f32 v145, v146, v147
v_fma_mix_f32 v226, v110, v110, v226 op_sel:[1,1,0] op_sel_hi:[1,1,0]
v_lshrrev_b64 v[144:145], 2, v[144:145]
v_fma_mix_f32 v226, v96, v96, v226 op_sel_hi:[1,1,0]
v_and_b32_sdwa v146, s47, v144 dst_sel:DWORD dst_unused:UNUSED_PAD src0_sel:DWORD src1_sel:WORD_1
v_fma_mix_f32 v226, v97, v97, v226 op_sel_hi:[1,1,0]
v_and_b32 v144, s47, v144
v_fma_mix_f32 v226, v98, v98, v226 op_sel_hi:[1,1,0]
v_cvt_pk_f16_f32 v156, v156, v157
v_fma_mix_f32 v226, v99, v99, v226 op_sel_hi:[1,1,0]
v_cvt_pk_f16_f32 v158, v158, v159
v_mfma_f32_32x32x16_bf16 v[112:127], v[180:183], v[84:87], v[112:127]
ds_read_u16_d16_hi v146, v146
ds_read_u16 v144, v144
v_pk_fma_f16 v157, v156, v156, s48
v_fma_mix_f32 v226, v100, v100, v226 op_sel_hi:[1,1,0]
v_and_b32_sdwa v147, s47, v145 dst_sel:DWORD dst_unused:UNUSED_PAD src0_sel:DWORD src1_sel:WORD_1
s_waitcnt lgkmcnt(5)
v_fma_mix_f32 v226, v101, v101, v226 op_sel_hi:[1,1,0]
v_and_b32 v145, s47, v145
v_pk_fma_f16 v159, v158, v158, s48
v_pk_mul_f16 v157, v156, v157
v_fma_mix_f32 v226, v102, v102, v226 op_sel_hi:[1,1,0]
v_cvt_pkrtz_f16_f32 v148, v148, v149
v_fma_mix_f32 v226, v103, v103, v226 op_sel_hi:[1,1,0]
v_cvt_pkrtz_f16_f32 v149, v150, v151
ds_read_u16_d16_hi v147, v147
ds_read_u16 v145, v145
ds_read_b128 v[176:179], v250 offset:24576
v_lshrrev_b64 v[148:149], 2, v[148:149]
v_and_b32_sdwa v150, s47, v148 dst_sel:DWORD dst_unused:UNUSED_PAD src0_sel:DWORD src1_sel:WORD_1
v_and_b32_e64 v148, s47, v148
v_pk_mul_f16 v159, v158, v159
v_exp_f16_sdwa v157, v157 dst_sel:WORD_0 dst_unused:UNUSED_PRESERVE src0_sel:WORD_0
v_mfma_f32_32x32x16_bf16 v[160:175], v[64:67], v[184:187], v[160:175]
ds_read_u16_d16_hi v150, v150
ds_read_u16 v148, v148
v_fma_mix_f32 v226, v104, v104, v226 op_sel_hi:[1,1,0]
v_and_b32_sdwa v151, s47, v149 dst_sel:DWORD dst_unused:UNUSED_PAD src0_sel:DWORD src1_sel:WORD_1
s_waitcnt lgkmcnt(7)
v_fma_mix_f32 v226, v105, v105, v226 op_sel_hi:[1,1,0]
v_and_b32 v149, s47, v149
v_exp_f16_sdwa v159, v159 dst_sel:WORD_0 dst_unused:UNUSED_PRESERVE src0_sel:WORD_0
v_fma_mix_f32 v226, v106, v106, v226 op_sel_hi:[1,1,0]
v_cvt_pkrtz_f16_f32 v152, v152, v153
v_fma_mix_f32 v226, v107, v107, v226 op_sel_hi:[1,1,0]
v_cvt_pkrtz_f16_f32 v153, v154, v155
v_lshrrev_b64 v[152:153], 2, v[152:153]
ds_read_u16_d16_hi v151, v151
ds_read_u16 v149, v149
v_and_b32_sdwa v154, s47, v152 dst_sel:DWORD dst_unused:UNUSED_PAD src0_sel:DWORD src1_sel:WORD_1
v_and_b32_e64 v152, s47, v152
v_exp_f16_sdwa v157, v157 dst_sel:WORD_1 dst_unused:UNUSED_PRESERVE src0_sel:WORD_1
v_mfma_f32_32x32x16_bf16 v[112:127], v[184:187], v[88:91], v[112:127]
ds_read_u16_d16_hi v154, v154
ds_read_u16 v152, v152
ds_read_b128 v[180:183], v250 offset:25600
v_and_b32_sdwa v155, s47, v153 dst_sel:DWORD dst_unused:UNUSED_PAD src0_sel:DWORD src1_sel:WORD_1
v_and_b32_e64 v153, s47, v153
v_exp_f16_sdwa v159, v159 dst_sel:WORD_1 dst_unused:UNUSED_PRESERVE src0_sel:WORD_1
v_pk_add_f16 v157, v157, 1.0 op_sel_hi:[1,0]
v_mfma_f32_32x32x16_bf16 v[160:175], v[68:71], v[188:191], v[160:175]
ds_read_u16_d16_hi v155, v155
ds_read_u16 v153, v153
v_pk_add_f16 v159, v159, 1.0 op_sel_hi:[1,0]
v_rcp_f16_sdwa v157, v157 dst_sel:WORD_0 dst_unused:UNUSED_PRESERVE src0_sel:WORD_0
v_rcp_f16_sdwa v159, v159 dst_sel:WORD_0 dst_unused:UNUSED_PRESERVE src0_sel:WORD_0
v_mfma_f32_32x32x16_bf16 v[112:127], v[188:191], v[92:95], v[112:127]
ds_read_b128 v[184:187], v250 offset:26624
v_rcp_f16_sdwa v157, v157 dst_sel:WORD_1 dst_unused:UNUSED_PRESERVE src0_sel:WORD_1
v_rcp_f16_sdwa v159, v159 dst_sel:WORD_1 dst_unused:UNUSED_PRESERVE src0_sel:WORD_1
v_pk_mul_f16 v6, v156, v157
s_waitcnt lgkmcnt(8)
v_mfma_f32_32x32x16_bf16 v[128:143], v[48:51], v[176:179], 0
v_pk_mul_f16 v7, v158, v159
v_lshl_add_u64 v[0:1], v[144:145], 0, v[146:147]
v_cvt_pkrtz_f16_f32 v160, v160, v161
v_cvt_pkrtz_f16_f32 v161, v162, v163
v_lshrrev_b64 v[160:161], 2, v[160:161]
v_and_b32_sdwa v162, s47, v160 dst_sel:DWORD dst_unused:UNUSED_PAD src0_sel:DWORD src1_sel:WORD_1
v_and_b32 v160, s47, v160
v_cvt_pk_f16_f32 v172, v172, v173
v_cvt_pk_f16_f32 v174, v174, v175
v_mfma_f32_32x32x16_bf16 v[96:111], v[176:179], v[72:75], 0
ds_read_u16 v162, v162
ds_read_u16 v160, v160
v_pk_fma_f16 v173, v172, v172, s48
v_and_b32_sdwa v163, s47, v161 dst_sel:DWORD dst_unused:UNUSED_PAD src0_sel:DWORD src1_sel:WORD_1
v_and_b32 v161, s47, v161
v_pk_fma_f16 v175, v174, v174, s48
v_pk_mul_f16 v173, v172, v173
v_pk_mul_f16 v175, v174, v175
s_waitcnt lgkmcnt(6)
v_lshl_add_u64 v[4:5], v[148:149], 0, v[150:151]
v_cvt_pkrtz_f16_f32 v164, v164, v165
v_cvt_pkrtz_f16_f32 v165, v166, v167
ds_read_u16 v163, v163
ds_read_u16 v161, v161
ds_read_b128 v[188:191], v250 offset:27648
v_lshrrev_b64 v[164:165], 2, v[164:165]
v_and_b32_sdwa v166, s47, v164 dst_sel:DWORD dst_unused:UNUSED_PAD src0_sel:DWORD src1_sel:WORD_1
v_and_b32 v164, s47, v164
v_exp_f16_sdwa v173, v173 dst_sel:WORD_0 dst_unused:UNUSED_PRESERVE src0_sel:WORD_0
s_waitcnt lgkmcnt(7)
v_mfma_f32_32x32x16_bf16 v[128:143], v[52:55], v[180:183], v[128:143]
ds_read_u16 v166, v166
ds_read_u16 v164, v164
v_exp_f16_sdwa v175, v175 dst_sel:WORD_0 dst_unused:UNUSED_PRESERVE src0_sel:WORD_0
v_and_b32_sdwa v167, s47, v165 dst_sel:DWORD dst_unused:UNUSED_PAD src0_sel:DWORD src1_sel:WORD_1
v_and_b32 v165, s47, v165
v_exp_f16_sdwa v173, v173 dst_sel:WORD_1 dst_unused:UNUSED_PRESERVE src0_sel:WORD_1
s_waitcnt lgkmcnt(7)
v_lshl_add_u64 v[2:3], v[152:153], 0, v[154:155]
v_cvt_pkrtz_f16_f32 v168, v168, v169
v_cvt_pkrtz_f16_f32 v169, v170, v171
v_lshrrev_b64 v[168:169], 2, v[168:169]
v_and_b32_sdwa v170, s47, v168 dst_sel:DWORD dst_unused:UNUSED_PAD src0_sel:DWORD src1_sel:WORD_1
ds_read_u16 v167, v167
ds_read_u16 v165, v165
v_and_b32_e64 v168, s47, v168
v_mfma_f32_32x32x16_bf16 v[96:111], v[180:183], v[76:79], v[96:111]
ds_read_u16 v170, v170
ds_read_u16 v168, v168
v_exp_f16_sdwa v175, v175 dst_sel:WORD_1 dst_unused:UNUSED_PRESERVE src0_sel:WORD_1
v_and_b32_sdwa v171, s47, v169 dst_sel:DWORD dst_unused:UNUSED_PAD src0_sel:DWORD src1_sel:WORD_1
v_and_b32_e64 v169, s47, v169
v_mfma_f32_32x32x16_f16 v[144:159], v[0:3], v[216:219], 0
ds_read_b128 v[176:179], v250 offset:28672
ds_read_u16 v171, v171
ds_read_u16 v169, v169
v_pk_add_f16 v173, v173, 1.0 op_sel_hi:[1,0]
v_pk_add_f16 v175, v175, 1.0 op_sel_hi:[1,0]
v_rcp_f16_sdwa v173, v173 dst_sel:WORD_0 dst_unused:UNUSED_PRESERVE src0_sel:WORD_0
v_mfma_f32_32x32x16_f16 v[144:159], v[4:7], v[220:223], v[144:159]
v_permlane16_swap_b32 v0, v4
v_permlane16_swap_b32 v1, v5
v_permlane16_swap_b32 v2, v6
v_permlane16_swap_b32 v3, v7
v_rcp_f16_sdwa v175, v175 dst_sel:WORD_0 dst_unused:UNUSED_PRESERVE src0_sel:WORD_0
v_mfma_f32_32x32x16_bf16 v[128:143], v[56:59], v[184:187], v[128:143]
v_rcp_f16_sdwa v173, v173 dst_sel:WORD_1 dst_unused:UNUSED_PRESERVE src0_sel:WORD_1
v_rcp_f16_sdwa v175, v175 dst_sel:WORD_1 dst_unused:UNUSED_PRESERVE src0_sel:WORD_1
s_nop 3
v_fmac_f32 v226, v144, v144
v_mfma_f32_32x32x16_bf16 v[96:111], v[184:187], v[80:83], v[96:111]
ds_read_b128 v[180:183], v250 offset:29696
v_pk_mul_f16 v172, v172, v173
v_fmac_f32_e64 v226, v145, v145
v_pk_mul_f16 v174, v174, v175
v_fmac_f32 v226, v146, v146
v_fmac_f32 v226, v147, v147
v_fma_mix_f32 v227, v172, v172, v227 op_sel_hi:[1,1,0]
v_fmac_f32 v226, v148, v148
v_fmac_f32 v226, v149, v149
v_fma_mix_f32 v227, v174, v174, v227 op_sel_hi:[1,1,0]
s_waitcnt lgkmcnt(6)
v_mfma_f32_32x32x16_bf16 v[128:143], v[60:63], v[188:191], v[128:143]
v_fmac_f32 v226, v150, v150
v_fma_mix_f32 v227, v172, v172, v227 op_sel:[1,1,0] op_sel_hi:[1,1,0]
v_fmac_f32 v226, v151, v151
v_fmac_f32 v226, v152, v152
v_fma_mix_f32 v227, v174, v174, v227 op_sel:[1,1,0] op_sel_hi:[1,1,0]
v_fmac_f32_e64 v226, v153, v153
v_fma_mix_f32 v227, v160, v160, v227 op_sel_hi:[1,1,0]
v_fmac_f32_e64 v226, v154, v154
v_fma_mix_f32 v227, v161, v161, v227 op_sel_hi:[1,1,0]
v_cvt_pkrtz_f16_f32 v112, v112, v113
v_fma_mix_f32 v227, v162, v162, v227 op_sel_hi:[1,1,0]
v_cvt_pkrtz_f16_f32 v113, v114, v115
v_fma_mix_f32 v227, v163, v163, v227 op_sel_hi:[1,1,0]
v_lshrrev_b64 v[112:113], 2, v[112:113]
v_and_b32_sdwa v114, s47, v112 dst_sel:DWORD dst_unused:UNUSED_PAD src0_sel:DWORD src1_sel:WORD_1
v_and_b32_e64 v112, s47, v112
v_cvt_pk_f16_f32 v124, v124, v125
v_fmac_f32_e64 v226, v155, v155
v_cvt_pk_f16_f32 v126, v126, v127
v_fmac_f32 v226, v156, v156
v_fmac_f32 v226, v157, v157
v_mfma_f32_32x32x16_bf16 v[96:111], v[188:191], v[84:87], v[96:111]
ds_read_u16_d16_hi v114, v114
ds_read_u16 v112, v112
v_pk_fma_f16 v125, v124, v124, s48
v_fmac_f32_e64 v226, v158, v158
v_fma_mix_f32 v227, v164, v164, v227 op_sel_hi:[1,1,0]
v_and_b32_sdwa v115, s47, v113 dst_sel:DWORD dst_unused:UNUSED_PAD src0_sel:DWORD src1_sel:WORD_1
v_fma_mix_f32 v227, v165, v165, v227 op_sel_hi:[1,1,0]
v_and_b32 v113, s47, v113
v_fmac_f32 v226, v159, v159
v_pk_fma_f16 v127, v126, v126, s48
v_pk_mul_f16 v125, v124, v125
v_fma_mix_f32 v227, v166, v166, v227 op_sel_hi:[1,1,0]
v_cvt_pkrtz_f16_f32 v116, v116, v117
v_fma_mix_f32 v227, v167, v167, v227 op_sel_hi:[1,1,0]
ds_read_u16_d16_hi v115, v115
ds_read_u16 v113, v113
ds_read_b128 v[184:187], v250 offset:30720
v_cvt_pkrtz_f16_f32 v117, v118, v119
v_lshrrev_b64 v[116:117], 2, v[116:117]
v_and_b32_sdwa v118, s47, v116 dst_sel:DWORD dst_unused:UNUSED_PAD src0_sel:DWORD src1_sel:WORD_1
v_and_b32 v116, s47, v116
v_pk_mul_f16 v127, v126, v127
v_exp_f16_sdwa v125, v125 dst_sel:WORD_0 dst_unused:UNUSED_PRESERVE src0_sel:WORD_0
s_waitcnt lgkmcnt(5)
v_mfma_f32_32x32x16_bf16 v[128:143], v[64:67], v[176:179], v[128:143]
ds_read_u16_d16_hi v118, v118
ds_read_u16 v116, v116
v_fma_mix_f32 v227, v168, v168, v227 op_sel_hi:[1,1,0]
v_and_b32_sdwa v119, s47, v117 dst_sel:DWORD dst_unused:UNUSED_PAD src0_sel:DWORD src1_sel:WORD_1
v_fma_mix_f32 v227, v169, v169, v227 op_sel_hi:[1,1,0]
v_and_b32_e64 v117, s47, v117
v_exp_f16_sdwa v127, v127 dst_sel:WORD_0 dst_unused:UNUSED_PRESERVE src0_sel:WORD_0
v_fma_mix_f32 v227, v170, v170, v227 op_sel_hi:[1,1,0]
v_cvt_pkrtz_f16_f32 v120, v120, v121
v_fma_mix_f32 v227, v171, v171, v227 op_sel_hi:[1,1,0]
v_cvt_pkrtz_f16_f32 v121, v122, v123
v_lshrrev_b64 v[120:121], 2, v[120:121]
ds_read_u16_d16_hi v119, v119
ds_read_u16 v117, v117
v_and_b32_sdwa v122, s47, v120 dst_sel:DWORD dst_unused:UNUSED_PAD src0_sel:DWORD src1_sel:WORD_1
v_and_b32_e64 v120, s47, v120
v_exp_f16_sdwa v125, v125 dst_sel:WORD_1 dst_unused:UNUSED_PRESERVE src0_sel:WORD_1
v_mfma_f32_32x32x16_bf16 v[96:111], v[176:179], v[88:91], v[96:111]
ds_read_u16_d16_hi v122, v122
ds_read_u16 v120, v120
ds_read_b128 v[188:191], v250 offset:31744
v_and_b32_sdwa v123, s47, v121 dst_sel:DWORD dst_unused:UNUSED_PAD src0_sel:DWORD src1_sel:WORD_1
v_and_b32_e64 v121, s47, v121
v_exp_f16_sdwa v127, v127 dst_sel:WORD_1 dst_unused:UNUSED_PRESERVE src0_sel:WORD_1
v_pk_add_f16 v125, v125, 1.0 op_sel_hi:[1,0]
v_mfma_f32_32x32x16_bf16 v[128:143], v[68:71], v[180:183], v[128:143]
ds_read_u16_d16_hi v123, v123
ds_read_u16 v121, v121
v_pk_add_f16 v127, v127, 1.0 op_sel_hi:[1,0]
v_rcp_f16_sdwa v125, v125 dst_sel:WORD_0 dst_unused:UNUSED_PRESERVE src0_sel:WORD_0
v_rcp_f16_sdwa v127, v127 dst_sel:WORD_0 dst_unused:UNUSED_PRESERVE src0_sel:WORD_0
v_mfma_f32_32x32x16_bf16 v[96:111], v[180:183], v[92:95], v[96:111]
ds_read_b128 v[176:179], v250 offset:32768
v_rcp_f16_sdwa v125, v125 dst_sel:WORD_1 dst_unused:UNUSED_PRESERVE src0_sel:WORD_1
v_rcp_f16_sdwa v127, v127 dst_sel:WORD_1 dst_unused:UNUSED_PRESERVE src0_sel:WORD_1
s_cmp_lg_u32 s40, 0
s_cbranch_scc1 Lpix
v_and_b32 v244, 0x3ff, v250
buffer_load_dword v245, v244, s[28:31], 0 offen
buffer_load_dword v245, v244, s[24:27], 0 offen
v_mov_b32 v244, 0
Lpi:
buffer_load_dword v245, v244, s[36:39], 0 offen sc1
s_waitcnt vmcnt(0)
v_readfirstlane_b32 s43, v245
s_cmp_eq_u32 s76, 0
s_cbranch_scc1 Lpix
s_sub_u32 s76, s76, 1
s_cmp_lt_u32 s43, 256
s_cbranch_scc1 Lpi
Lpix:
s_waitcnt lgkmcnt(8)
v_mfma_f32_32x32x16_bf16 v[144:159], v[48:51], v[184:187], 0
v_pk_mul_f16 v14, v124, v125
v_pk_mul_f16 v15, v126, v127
v_lshl_add_u64 v[8:9], v[112:113], 0, v[114:115]
v_cvt_pkrtz_f16_f32 v128, v128, v129
v_cvt_pkrtz_f16_f32 v129, v130, v131
v_lshrrev_b64 v[128:129], 2, v[128:129]
v_and_b32_sdwa v130, s47, v128 dst_sel:DWORD dst_unused:UNUSED_PAD src0_sel:DWORD src1_sel:WORD_1
v_and_b32_e64 v128, s47, v128
v_cvt_pk_f16_f32 v140, v140, v141
v_cvt_pk_f16_f32 v142, v142, v143
v_mfma_f32_32x32x16_bf16 v[160:175], v[184:187], v[72:75], 0
ds_read_u16 v130, v130
ds_read_u16 v128, v128
v_pk_fma_f16 v141, v140, v140, s48
v_and_b32_sdwa v131, s47, v129 dst_sel:DWORD dst_unused:UNUSED_PAD src0_sel:DWORD src1_sel:WORD_1
v_and_b32 v129, s47, v129
v_pk_fma_f16 v143, v142, v142, s48
v_pk_mul_f16 v141, v140, v141
v_pk_mul_f16 v143, v142, v143
s_waitcnt lgkmcnt(6)
v_lshl_add_u64 v[12:13], v[116:117], 0, v[118:119]
v_cvt_pkrtz_f16_f32 v132, v132, v133
v_cvt_pkrtz_f16_f32 v133, v134, v135
ds_read_u16 v131, v131
ds_read_u16 v129, v129
ds_read_b128 v[180:183], v250 offset:33792
v_lshrrev_b64 v[132:133], 2, v[132:133]
v_and_b32_sdwa v134, s47, v132 dst_sel:DWORD dst_unused:UNUSED_PAD src0_sel:DWORD src1_sel:WORD_1
v_and_b32 v132, s47, v132
v_exp_f16_sdwa v141, v141 dst_sel:WORD_0 dst_unused:UNUSED_PRESERVE src0_sel:WORD_0
s_waitcnt lgkmcnt(7)
v_mfma_f32_32x32x16_bf16 v[144:159], v[52:55], v[188:191], v[144:159]
ds_read_u16 v134, v134
ds_read_u16 v132, v132
v_exp_f16_sdwa v143, v143 dst_sel:WORD_0 dst_unused:UNUSED_PRESERVE src0_sel:WORD_0
v_and_b32_sdwa v135, s47, v133 dst_sel:DWORD dst_unused:UNUSED_PAD src0_sel:DWORD src1_sel:WORD_1
v_and_b32 v133, s47, v133
v_exp_f16_sdwa v141, v141 dst_sel:WORD_1 dst_unused:UNUSED_PRESERVE src0_sel:WORD_1
s_waitcnt lgkmcnt(7)
v_lshl_add_u64 v[10:11], v[120:121], 0, v[122:123]
v_cvt_pkrtz_f16_f32 v136, v136, v137
v_cvt_pkrtz_f16_f32 v137, v138, v139
v_lshrrev_b64 v[136:137], 2, v[136:137]
v_and_b32_sdwa v138, s47, v136 dst_sel:DWORD dst_unused:UNUSED_PAD src0_sel:DWORD src1_sel:WORD_1
ds_read_u16 v135, v135
ds_read_u16 v133, v133
v_and_b32_e64 v136, s47, v136
v_mfma_f32_32x32x16_bf16 v[160:175], v[188:191], v[76:79], v[160:175]
ds_read_u16 v138, v138
ds_read_u16 v136, v136
v_exp_f16_sdwa v143, v143 dst_sel:WORD_1 dst_unused:UNUSED_PRESERVE src0_sel:WORD_1
v_and_b32_sdwa v139, s47, v137 dst_sel:DWORD dst_unused:UNUSED_PAD src0_sel:DWORD src1_sel:WORD_1
v_and_b32_e64 v137, s47, v137
v_mfma_f32_32x32x16_f16 v[112:127], v[8:11], v[216:219], 0
ds_read_b128 v[184:187], v250 offset:34816
ds_read_u16 v139, v139
ds_read_u16 v137, v137
v_pk_add_f16 v141, v141, 1.0 op_sel_hi:[1,0]
v_pk_add_f16 v143, v143, 1.0 op_sel_hi:[1,0]
v_rcp_f16_sdwa v141, v141 dst_sel:WORD_0 dst_unused:UNUSED_PRESERVE src0_sel:WORD_0
v_mfma_f32_32x32x16_f16 v[112:127], v[12:15], v[220:223], v[112:127]
v_permlane16_swap_b32 v8, v12
v_permlane16_swap_b32 v9, v13
v_permlane16_swap_b32 v10, v14
v_permlane16_swap_b32 v11, v15
v_rcp_f16_sdwa v143, v143 dst_sel:WORD_0 dst_unused:UNUSED_PRESERVE src0_sel:WORD_0
v_mfma_f32_32x32x16_bf16 v[144:159], v[56:59], v[176:179], v[144:159]
v_rcp_f16_sdwa v141, v141 dst_sel:WORD_1 dst_unused:UNUSED_PRESERVE src0_sel:WORD_1
v_rcp_f16_sdwa v143, v143 dst_sel:WORD_1 dst_unused:UNUSED_PRESERVE src0_sel:WORD_1
s_nop 3
v_fmac_f32 v227, v112, v112
v_mfma_f32_32x32x16_bf16 v[160:175], v[176:179], v[80:83], v[160:175]
ds_read_b128 v[188:191], v250 offset:35840
v_pk_mul_f16 v140, v140, v141
v_fmac_f32_e64 v227, v113, v113
v_pk_mul_f16 v142, v142, v143
v_fmac_f32 v227, v114, v114
v_fmac_f32 v227, v115, v115
v_fma_mix_f32 v228, v140, v140, v228 op_sel_hi:[1,1,0]
v_fmac_f32 v227, v116, v116
v_fmac_f32 v227, v117, v117
v_fma_mix_f32 v228, v142, v142, v228 op_sel_hi:[1,1,0]
s_waitcnt lgkmcnt(6)
v_mfma_f32_32x32x16_bf16 v[144:159], v[60:63], v[180:183], v[144:159]
v_fmac_f32 v227, v118, v118
v_fma_mix_f32 v228, v140, v140, v228 op_sel:[1,1,0] op_sel_hi:[1,1,0]
v_fmac_f32 v227, v119, v119
v_fmac_f32 v227, v120, v120
v_fma_mix_f32 v228, v142, v142, v228 op_sel:[1,1,0] op_sel_hi:[1,1,0]
v_fmac_f32_e64 v227, v121, v121
v_fma_mix_f32 v228, v128, v128, v228 op_sel_hi:[1,1,0]
v_fmac_f32_e64 v227, v122, v122
v_fma_mix_f32 v228, v129, v129, v228 op_sel_hi:[1,1,0]
v_cvt_pkrtz_f16_f32 v96, v96, v97
v_fma_mix_f32 v228, v130, v130, v228 op_sel_hi:[1,1,0]
v_cvt_pkrtz_f16_f32 v97, v98, v99
v_fma_mix_f32 v228, v131, v131, v228 op_sel_hi:[1,1,0]
v_lshrrev_b64 v[96:97], 2, v[96:97]
v_and_b32_sdwa v98, s47, v96 dst_sel:DWORD dst_unused:UNUSED_PAD src0_sel:DWORD src1_sel:WORD_1
v_and_b32_e64 v96, s47, v96
v_cvt_pk_f16_f32 v108, v108, v109
v_fmac_f32_e64 v227, v123, v123
v_cvt_pk_f16_f32 v110, v110, v111
v_fmac_f32 v227, v124, v124
v_fmac_f32 v227, v125, v125
v_mfma_f32_32x32x16_bf16 v[160:175], v[180:183], v[84:87], v[160:175]
ds_read_u16_d16_hi v98, v98
ds_read_u16 v96, v96
v_pk_fma_f16 v109, v108, v108, s48
v_fmac_f32_e64 v227, v126, v126
v_fma_mix_f32 v228, v132, v132, v228 op_sel_hi:[1,1,0]
v_and_b32_sdwa v99, s47, v97 dst_sel:DWORD dst_unused:UNUSED_PAD src0_sel:DWORD src1_sel:WORD_1
v_fma_mix_f32 v228, v133, v133, v228 op_sel_hi:[1,1,0]
v_and_b32 v97, s47, v97
v_fmac_f32 v227, v127, v127
v_pk_fma_f16 v111, v110, v110, s48
v_pk_mul_f16 v109, v108, v109
v_fma_mix_f32 v228, v134, v134, v228 op_sel_hi:[1,1,0]
v_cvt_pkrtz_f16_f32 v100, v100, v101
v_fma_mix_f32 v228, v135, v135, v228 op_sel_hi:[1,1,0]
ds_read_u16_d16_hi v99, v99
ds_read_u16 v97, v97
ds_read_b128 v[176:179], v250 offset:36864
v_cvt_pkrtz_f16_f32 v101, v102, v103
v_lshrrev_b64 v[100:101], 2, v[100:101]
v_and_b32_sdwa v102, s47, v100 dst_sel:DWORD dst_unused:UNUSED_PAD src0_sel:DWORD src1_sel:WORD_1
v_and_b32 v100, s47, v100
v_pk_mul_f16 v111, v110, v111
v_exp_f16_sdwa v109, v109 dst_sel:WORD_0 dst_unused:UNUSED_PRESERVE src0_sel:WORD_0
s_waitcnt lgkmcnt(5)
v_mfma_f32_32x32x16_bf16 v[144:159], v[64:67], v[184:187], v[144:159]
ds_read_u16_d16_hi v102, v102
ds_read_u16 v100, v100
v_fma_mix_f32 v228, v136, v136, v228 op_sel_hi:[1,1,0]
v_and_b32_sdwa v103, s47, v101 dst_sel:DWORD dst_unused:UNUSED_PAD src0_sel:DWORD src1_sel:WORD_1
v_fma_mix_f32 v228, v137, v137, v228 op_sel_hi:[1,1,0]
v_and_b32_e64 v101, s47, v101
v_exp_f16_sdwa v111, v111 dst_sel:WORD_0 dst_unused:UNUSED_PRESERVE src0_sel:WORD_0
v_fma_mix_f32 v228, v138, v138, v228 op_sel_hi:[1,1,0]
v_cvt_pkrtz_f16_f32 v104, v104, v105
v_fma_mix_f32 v228, v139, v139, v228 op_sel_hi:[1,1,0]
v_cvt_pkrtz_f16_f32 v105, v106, v107
v_lshrrev_b64 v[104:105], 2, v[104:105]
ds_read_u16_d16_hi v103, v103
ds_read_u16 v101, v101
v_and_b32_sdwa v106, s47, v104 dst_sel:DWORD dst_unused:UNUSED_PAD src0_sel:DWORD src1_sel:WORD_1
v_and_b32_e64 v104, s47, v104
v_exp_f16_sdwa v109, v109 dst_sel:WORD_1 dst_unused:UNUSED_PRESERVE src0_sel:WORD_1
v_mfma_f32_32x32x16_bf16 v[160:175], v[184:187], v[88:91], v[160:175]
ds_read_u16_d16_hi v106, v106
ds_read_u16 v104, v104
ds_read_b128 v[180:183], v250 offset:37888
v_and_b32_sdwa v107, s47, v105 dst_sel:DWORD dst_unused:UNUSED_PAD src0_sel:DWORD src1_sel:WORD_1
v_and_b32_e64 v105, s47, v105
v_exp_f16_sdwa v111, v111 dst_sel:WORD_1 dst_unused:UNUSED_PRESERVE src0_sel:WORD_1
v_pk_add_f16 v109, v109, 1.0 op_sel_hi:[1,0]
v_mfma_f32_32x32x16_bf16 v[144:159], v[68:71], v[188:191], v[144:159]
ds_read_u16_d16_hi v107, v107
ds_read_u16 v105, v105
v_pk_add_f16 v111, v111, 1.0 op_sel_hi:[1,0]
v_rcp_f16_sdwa v109, v109 dst_sel:WORD_0 dst_unused:UNUSED_PRESERVE src0_sel:WORD_0
v_rcp_f16_sdwa v111, v111 dst_sel:WORD_0 dst_unused:UNUSED_PRESERVE src0_sel:WORD_0
v_mfma_f32_32x32x16_bf16 v[160:175], v[188:191], v[92:95], v[160:175]
ds_read_b128 v[184:187], v250 offset:38912
v_rcp_f16_sdwa v109, v109 dst_sel:WORD_1 dst_unused:UNUSED_PRESERVE src0_sel:WORD_1
v_rcp_f16_sdwa v111, v111 dst_sel:WORD_1 dst_unused:UNUSED_PRESERVE src0_sel:WORD_1
v_pk_mul_f16 v22, v108, v109
s_waitcnt lgkmcnt(8)
v_mfma_f32_32x32x16_bf16 v[112:127], v[48:51], v[176:179], 0
v_pk_mul_f16 v23, v110, v111
v_lshl_add_u64 v[16:17], v[96:97], 0, v[98:99]
v_cvt_pkrtz_f16_f32 v144, v144, v145
v_cvt_pkrtz_f16_f32 v145, v146, v147
v_lshrrev_b64 v[144:145], 2, v[144:145]
v_and_b32_sdwa v146, s47, v144 dst_sel:DWORD dst_unused:UNUSED_PAD src0_sel:DWORD src1_sel:WORD_1
v_and_b32 v144, s47, v144
v_cvt_pk_f16_f32 v156, v156, v157
v_cvt_pk_f16_f32 v158, v158, v159
v_mfma_f32_32x32x16_bf16 v[128:143], v[176:179], v[72:75], 0
ds_read_u16 v146, v146
ds_read_u16 v144, v144
v_pk_fma_f16 v157, v156, v156, s48
v_and_b32_sdwa v147, s47, v145 dst_sel:DWORD dst_unused:UNUSED_PAD src0_sel:DWORD src1_sel:WORD_1
v_and_b32 v145, s47, v145
v_pk_fma_f16 v159, v158, v158, s48
v_pk_mul_f16 v157, v156, v157
v_pk_mul_f16 v159, v158, v159
s_waitcnt lgkmcnt(6)
v_lshl_add_u64 v[20:21], v[100:101], 0, v[102:103]
v_cvt_pkrtz_f16_f32 v148, v148, v149
v_cvt_pkrtz_f16_f32 v149, v150, v151
ds_read_u16 v147, v147
ds_read_u16 v145, v145
ds_read_b128 v[188:191], v250 offset:39936
v_lshrrev_b64 v[148:149], 2, v[148:149]
v_and_b32_sdwa v150, s47, v148 dst_sel:DWORD dst_unused:UNUSED_PAD src0_sel:DWORD src1_sel:WORD_1
v_and_b32 v148, s47, v148
v_exp_f16_sdwa v157, v157 dst_sel:WORD_0 dst_unused:UNUSED_PRESERVE src0_sel:WORD_0
s_waitcnt lgkmcnt(7)
v_mfma_f32_32x32x16_bf16 v[112:127], v[52:55], v[180:183], v[112:127]
ds_read_u16 v150, v150
ds_read_u16 v148, v148
v_exp_f16_sdwa v159, v159 dst_sel:WORD_0 dst_unused:UNUSED_PRESERVE src0_sel:WORD_0
v_and_b32_sdwa v151, s47, v149 dst_sel:DWORD dst_unused:UNUSED_PAD src0_sel:DWORD src1_sel:WORD_1
v_and_b32 v149, s47, v149
v_exp_f16_sdwa v157, v157 dst_sel:WORD_1 dst_unused:UNUSED_PRESERVE src0_sel:WORD_1
s_waitcnt lgkmcnt(7)
v_lshl_add_u64 v[18:19], v[104:105], 0, v[106:107]
v_cvt_pkrtz_f16_f32 v152, v152, v153
v_cvt_pkrtz_f16_f32 v153, v154, v155
v_lshrrev_b64 v[152:153], 2, v[152:153]
v_and_b32_sdwa v154, s47, v152 dst_sel:DWORD dst_unused:UNUSED_PAD src0_sel:DWORD src1_sel:WORD_1
ds_read_u16 v151, v151
ds_read_u16 v149, v149
v_and_b32_e64 v152, s47, v152
v_mfma_f32_32x32x16_bf16 v[128:143], v[180:183], v[76:79], v[128:143]
ds_read_u16 v154, v154
ds_read_u16 v152, v152
v_exp_f16_sdwa v159, v159 dst_sel:WORD_1 dst_unused:UNUSED_PRESERVE src0_sel:WORD_1
v_and_b32_sdwa v155, s47, v153 dst_sel:DWORD dst_unused:UNUSED_PAD src0_sel:DWORD src1_sel:WORD_1
v_and_b32_e64 v153, s47, v153
v_mfma_f32_32x32x16_f16 v[96:111], v[16:19], v[216:219], 0
ds_read_b128 v[176:179], v250 offset:40960
ds_read_u16 v155, v155
ds_read_u16 v153, v153
v_pk_add_f16 v157, v157, 1.0 op_sel_hi:[1,0]
v_pk_add_f16 v159, v159, 1.0 op_sel_hi:[1,0]
v_rcp_f16_sdwa v157, v157 dst_sel:WORD_0 dst_unused:UNUSED_PRESERVE src0_sel:WORD_0
v_mfma_f32_32x32x16_f16 v[96:111], v[20:23], v[220:223], v[96:111]
v_permlane16_swap_b32 v16, v20
v_permlane16_swap_b32 v17, v21
v_permlane16_swap_b32 v18, v22
v_permlane16_swap_b32 v19, v23
v_rcp_f16_sdwa v159, v159 dst_sel:WORD_0 dst_unused:UNUSED_PRESERVE src0_sel:WORD_0
v_mfma_f32_32x32x16_bf16 v[112:127], v[56:59], v[184:187], v[112:127]
v_rcp_f16_sdwa v157, v157 dst_sel:WORD_1 dst_unused:UNUSED_PRESERVE src0_sel:WORD_1
v_rcp_f16_sdwa v159, v159 dst_sel:WORD_1 dst_unused:UNUSED_PRESERVE src0_sel:WORD_1
s_nop 3
v_fmac_f32 v228, v96, v96
v_mfma_f32_32x32x16_bf16 v[128:143], v[184:187], v[80:83], v[128:143]
ds_read_b128 v[180:183], v250 offset:41984
v_pk_mul_f16 v156, v156, v157
v_fmac_f32_e64 v228, v97, v97
v_pk_mul_f16 v158, v158, v159
v_fmac_f32 v228, v98, v98
v_fmac_f32 v228, v99, v99
v_fma_mix_f32 v229, v156, v156, v229 op_sel_hi:[1,1,0]
v_fmac_f32 v228, v100, v100
v_fmac_f32 v228, v101, v101
v_fma_mix_f32 v229, v158, v158, v229 op_sel_hi:[1,1,0]
s_waitcnt lgkmcnt(6)
v_mfma_f32_32x32x16_bf16 v[112:127], v[60:63], v[188:191], v[112:127]
v_fmac_f32 v228, v102, v102
v_fma_mix_f32 v229, v156, v156, v229 op_sel:[1,1,0] op_sel_hi:[1,1,0]
v_fmac_f32 v228, v103, v103
v_fmac_f32 v228, v104, v104
v_fma_mix_f32 v229, v158, v158, v229 op_sel:[1,1,0] op_sel_hi:[1,1,0]
v_fmac_f32_e64 v228, v105, v105
v_fma_mix_f32 v229, v144, v144, v229 op_sel_hi:[1,1,0]
v_fmac_f32_e64 v228, v106, v106
v_fma_mix_f32 v229, v145, v145, v229 op_sel_hi:[1,1,0]
v_cvt_pkrtz_f16_f32 v160, v160, v161
v_fma_mix_f32 v229, v146, v146, v229 op_sel_hi:[1,1,0]
v_cvt_pkrtz_f16_f32 v161, v162, v163
v_fma_mix_f32 v229, v147, v147, v229 op_sel_hi:[1,1,0]
v_lshrrev_b64 v[160:161], 2, v[160:161]
v_and_b32_sdwa v162, s47, v160 dst_sel:DWORD dst_unused:UNUSED_PAD src0_sel:DWORD src1_sel:WORD_1
v_and_b32_e64 v160, s47, v160
v_cvt_pk_f16_f32 v172, v172, v173
v_fmac_f32_e64 v228, v107, v107
v_cvt_pk_f16_f32 v174, v174, v175
v_fmac_f32 v228, v108, v108
v_fmac_f32 v228, v109, v109
v_mfma_f32_32x32x16_bf16 v[128:143], v[188:191], v[84:87], v[128:143]
ds_read_u16_d16_hi v162, v162
ds_read_u16 v160, v160
v_pk_fma_f16 v173, v172, v172, s48
v_fmac_f32_e64 v228, v110, v110
v_fma_mix_f32 v229, v148, v148, v229 op_sel_hi:[1,1,0]
v_and_b32_sdwa v163, s47, v161 dst_sel:DWORD dst_unused:UNUSED_PAD src0_sel:DWORD src1_sel:WORD_1
v_fma_mix_f32 v229, v149, v149, v229 op_sel_hi:[1,1,0]
v_and_b32 v161, s47, v161
v_fmac_f32 v228, v111, v111
v_pk_fma_f16 v175, v174, v174, s48
v_pk_mul_f16 v173, v172, v173
v_fma_mix_f32 v229, v150, v150, v229 op_sel_hi:[1,1,0]
v_cvt_pkrtz_f16_f32 v164, v164, v165
v_fma_mix_f32 v229, v151, v151, v229 op_sel_hi:[1,1,0]
ds_read_u16_d16_hi v163, v163
ds_read_u16 v161, v161
ds_read_b128 v[184:187], v250 offset:43008
v_cvt_pkrtz_f16_f32 v165, v166, v167
v_lshrrev_b64 v[164:165], 2, v[164:165]
v_and_b32_sdwa v166, s47, v164 dst_sel:DWORD dst_unused:UNUSED_PAD src0_sel:DWORD src1_sel:WORD_1
v_and_b32 v164, s47, v164
v_pk_mul_f16 v175, v174, v175
v_exp_f16_sdwa v173, v173 dst_sel:WORD_0 dst_unused:UNUSED_PRESERVE src0_sel:WORD_0
s_waitcnt lgkmcnt(5)
v_mfma_f32_32x32x16_bf16 v[112:127], v[64:67], v[176:179], v[112:127]
ds_read_u16_d16_hi v166, v166
ds_read_u16 v164, v164
v_fma_mix_f32 v229, v152, v152, v229 op_sel_hi:[1,1,0]
v_and_b32_sdwa v167, s47, v165 dst_sel:DWORD dst_unused:UNUSED_PAD src0_sel:DWORD src1_sel:WORD_1
v_fma_mix_f32 v229, v153, v153, v229 op_sel_hi:[1,1,0]
v_and_b32_e64 v165, s47, v165
v_exp_f16_sdwa v175, v175 dst_sel:WORD_0 dst_unused:UNUSED_PRESERVE src0_sel:WORD_0
v_fma_mix_f32 v229, v154, v154, v229 op_sel_hi:[1,1,0]
v_cvt_pkrtz_f16_f32 v168, v168, v169
v_fma_mix_f32 v229, v155, v155, v229 op_sel_hi:[1,1,0]
v_cvt_pkrtz_f16_f32 v169, v170, v171
v_lshrrev_b64 v[168:169], 2, v[168:169]
ds_read_u16_d16_hi v167, v167
ds_read_u16 v165, v165
v_and_b32_sdwa v170, s47, v168 dst_sel:DWORD dst_unused:UNUSED_PAD src0_sel:DWORD src1_sel:WORD_1
v_and_b32_e64 v168, s47, v168
v_exp_f16_sdwa v173, v173 dst_sel:WORD_1 dst_unused:UNUSED_PRESERVE src0_sel:WORD_1
v_mfma_f32_32x32x16_bf16 v[128:143], v[176:179], v[88:91], v[128:143]
ds_read_u16_d16_hi v170, v170
ds_read_u16 v168, v168
ds_read_b128 v[188:191], v250 offset:44032
v_and_b32_sdwa v171, s47, v169 dst_sel:DWORD dst_unused:UNUSED_PAD src0_sel:DWORD src1_sel:WORD_1
v_and_b32_e64 v169, s47, v169
v_exp_f16_sdwa v175, v175 dst_sel:WORD_1 dst_unused:UNUSED_PRESERVE src0_sel:WORD_1
v_pk_add_f16 v173, v173, 1.0 op_sel_hi:[1,0]
v_mfma_f32_32x32x16_bf16 v[112:127], v[68:71], v[180:183], v[112:127]
ds_read_u16_d16_hi v171, v171
ds_read_u16 v169, v169
v_pk_add_f16 v175, v175, 1.0 op_sel_hi:[1,0]
v_rcp_f16_sdwa v173, v173 dst_sel:WORD_0 dst_unused:UNUSED_PRESERVE src0_sel:WORD_0
v_rcp_f16_sdwa v175, v175 dst_sel:WORD_0 dst_unused:UNUSED_PRESERVE src0_sel:WORD_0
v_mfma_f32_32x32x16_bf16 v[128:143], v[180:183], v[92:95], v[128:143]
ds_read_b128 v[176:179], v250 offset:45056
v_rcp_f16_sdwa v173, v173 dst_sel:WORD_1 dst_unused:UNUSED_PRESERVE src0_sel:WORD_1
v_rcp_f16_sdwa v175, v175 dst_sel:WORD_1 dst_unused:UNUSED_PRESERVE src0_sel:WORD_1
v_pk_mul_f16 v198, v172, v173
s_waitcnt lgkmcnt(8)
v_mfma_f32_32x32x16_bf16 v[96:111], v[48:51], v[184:187], 0
v_pk_mul_f16 v199, v174, v175
v_lshl_add_u64 v[192:193], v[160:161], 0, v[162:163]
v_cvt_pkrtz_f16_f32 v112, v112, v113
v_cvt_pkrtz_f16_f32 v113, v114, v115
v_lshrrev_b64 v[112:113], 2, v[112:113]
v_and_b32_sdwa v114, s47, v112 dst_sel:DWORD dst_unused:UNUSED_PAD src0_sel:DWORD src1_sel:WORD_1
v_and_b32 v112, s47, v112
v_cvt_pk_f16_f32 v124, v124, v125
v_cvt_pk_f16_f32 v126, v126, v127
v_mfma_f32_32x32x16_bf16 v[144:159], v[184:187], v[72:75], 0
ds_read_u16 v114, v114
ds_read_u16 v112, v112
v_pk_fma_f16 v125, v124, v124, s48
v_and_b32_sdwa v115, s47, v113 dst_sel:DWORD dst_unused:UNUSED_PAD src0_sel:DWORD src1_sel:WORD_1
v_and_b32 v113, s47, v113
v_pk_fma_f16 v127, v126, v126, s48
v_pk_mul_f16 v125, v124, v125
v_pk_mul_f16 v127, v126, v127
s_waitcnt lgkmcnt(6)
v_lshl_add_u64 v[196:197], v[164:165], 0, v[166:167]
v_cvt_pkrtz_f16_f32 v116, v116, v117
v_cvt_pkrtz_f16_f32 v117, v118, v119
ds_read_u16 v115, v115
ds_read_u16 v113, v113
ds_read_b128 v[180:183], v250 offset:46080
v_lshrrev_b64 v[116:117], 2, v[116:117]
v_and_b32_sdwa v118, s47, v116 dst_sel:DWORD dst_unused:UNUSED_PAD src0_sel:DWORD src1_sel:WORD_1
v_and_b32 v116, s47, v116
v_exp_f16_sdwa v125, v125 dst_sel:WORD_0 dst_unused:UNUSED_PRESERVE src0_sel:WORD_0
s_waitcnt lgkmcnt(7)
v_mfma_f32_32x32x16_bf16 v[96:111], v[52:55], v[188:191], v[96:111]
ds_read_u16 v118, v118
ds_read_u16 v116, v116
v_exp_f16_sdwa v127, v127 dst_sel:WORD_0 dst_unused:UNUSED_PRESERVE src0_sel:WORD_0
v_and_b32_sdwa v119, s47, v117 dst_sel:DWORD dst_unused:UNUSED_PAD src0_sel:DWORD src1_sel:WORD_1
v_and_b32 v117, s47, v117
v_exp_f16_sdwa v125, v125 dst_sel:WORD_1 dst_unused:UNUSED_PRESERVE src0_sel:WORD_1
s_waitcnt lgkmcnt(7)
v_lshl_add_u64 v[194:195], v[168:169], 0, v[170:171]
v_cvt_pkrtz_f16_f32 v120, v120, v121
v_cvt_pkrtz_f16_f32 v121, v122, v123
v_lshrrev_b64 v[120:121], 2, v[120:121]
v_and_b32_sdwa v122, s47, v120 dst_sel:DWORD dst_unused:UNUSED_PAD src0_sel:DWORD src1_sel:WORD_1
ds_read_u16 v119, v119
ds_read_u16 v117, v117
v_and_b32_e64 v120, s47, v120
v_mfma_f32_32x32x16_bf16 v[144:159], v[188:191], v[76:79], v[144:159]
ds_read_u16 v122, v122
ds_read_u16 v120, v120
v_exp_f16_sdwa v127, v127 dst_sel:WORD_1 dst_unused:UNUSED_PRESERVE src0_sel:WORD_1
v_and_b32_sdwa v123, s47, v121 dst_sel:DWORD dst_unused:UNUSED_PAD src0_sel:DWORD src1_sel:WORD_1
v_and_b32_e64 v121, s47, v121
v_mfma_f32_32x32x16_f16 v[160:175], v[192:195], v[216:219], 0
ds_read_b128 v[184:187], v250 offset:47104
ds_read_u16 v123, v123
ds_read_u16 v121, v121
v_pk_add_f16 v125, v125, 1.0 op_sel_hi:[1,0]
v_pk_add_f16 v127, v127, 1.0 op_sel_hi:[1,0]
v_rcp_f16_sdwa v125, v125 dst_sel:WORD_0 dst_unused:UNUSED_PRESERVE src0_sel:WORD_0
v_mfma_f32_32x32x16_f16 v[160:175], v[196:199], v[220:223], v[160:175]
v_permlane16_swap_b32 v192, v196
v_permlane16_swap_b32 v193, v197
v_permlane16_swap_b32 v194, v198
v_permlane16_swap_b32 v195, v199
v_rcp_f16_sdwa v127, v127 dst_sel:WORD_0 dst_unused:UNUSED_PRESERVE src0_sel:WORD_0
v_mfma_f32_32x32x16_bf16 v[96:111], v[56:59], v[176:179], v[96:111]
v_rcp_f16_sdwa v125, v125 dst_sel:WORD_1 dst_unused:UNUSED_PRESERVE src0_sel:WORD_1
v_rcp_f16_sdwa v127, v127 dst_sel:WORD_1 dst_unused:UNUSED_PRESERVE src0_sel:WORD_1
s_nop 3
v_fmac_f32 v229, v160, v160
v_mfma_f32_32x32x16_bf16 v[144:159], v[176:179], v[80:83], v[144:159]
ds_read_b128 v[188:191], v250 offset:48128
v_pk_mul_f16 v124, v124, v125
v_fmac_f32_e64 v229, v161, v161
v_pk_mul_f16 v126, v126, v127
v_fmac_f32 v229, v162, v162
v_fmac_f32 v229, v163, v163
v_fma_mix_f32 v230, v124, v124, v230 op_sel_hi:[1,1,0]
v_fmac_f32 v229, v164, v164
v_fmac_f32 v229, v165, v165
v_fma_mix_f32 v230, v126, v126, v230 op_sel_hi:[1,1,0]
s_waitcnt lgkmcnt(6)
v_mfma_f32_32x32x16_bf16 v[96:111], v[60:63], v[180:183], v[96:111]
v_fmac_f32 v229, v166, v166
v_fma_mix_f32 v230, v124, v124, v230 op_sel:[1,1,0] op_sel_hi:[1,1,0]
v_fmac_f32 v229, v167, v167
v_fmac_f32 v229, v168, v168
v_fma_mix_f32 v230, v126, v126, v230 op_sel:[1,1,0] op_sel_hi:[1,1,0]
v_fmac_f32_e64 v229, v169, v169
v_fma_mix_f32 v230, v112, v112, v230 op_sel_hi:[1,1,0]
v_fmac_f32_e64 v229, v170, v170
v_fma_mix_f32 v230, v113, v113, v230 op_sel_hi:[1,1,0]
v_cvt_pkrtz_f16_f32 v128, v128, v129
v_fma_mix_f32 v230, v114, v114, v230 op_sel_hi:[1,1,0]
v_cvt_pkrtz_f16_f32 v129, v130, v131
v_fma_mix_f32 v230, v115, v115, v230 op_sel_hi:[1,1,0]
v_lshrrev_b64 v[128:129], 2, v[128:129]
v_and_b32_sdwa v130, s47, v128 dst_sel:DWORD dst_unused:UNUSED_PAD src0_sel:DWORD src1_sel:WORD_1
v_and_b32_e64 v128, s47, v128
v_cvt_pk_f16_f32 v140, v140, v141
v_fmac_f32_e64 v229, v171, v171
v_cvt_pk_f16_f32 v142, v142, v143
v_fmac_f32 v229, v172, v172
v_fmac_f32 v229, v173, v173
v_mfma_f32_32x32x16_bf16 v[144:159], v[180:183], v[84:87], v[144:159]
ds_read_u16_d16_hi v130, v130
ds_read_u16 v128, v128
v_pk_fma_f16 v141, v140, v140, s48
v_fmac_f32_e64 v229, v174, v174
v_fma_mix_f32 v230, v116, v116, v230 op_sel_hi:[1,1,0]
v_and_b32_sdwa v131, s47, v129 dst_sel:DWORD dst_unused:UNUSED_PAD src0_sel:DWORD src1_sel:WORD_1
v_fma_mix_f32 v230, v117, v117, v230 op_sel_hi:[1,1,0]
v_and_b32 v129, s47, v129
v_fmac_f32 v229, v175, v175
v_pk_fma_f16 v143, v142, v142, s48
v_pk_mul_f16 v141, v140, v141
v_fma_mix_f32 v230, v118, v118, v230 op_sel_hi:[1,1,0]
v_cvt_pkrtz_f16_f32 v132, v132, v133
v_fma_mix_f32 v230, v119, v119, v230 op_sel_hi:[1,1,0]
ds_read_u16_d16_hi v131, v131
ds_read_u16 v129, v129
ds_read_b128 v[176:179], v250 offset:49152
v_cvt_pkrtz_f16_f32 v133, v134, v135
v_lshrrev_b64 v[132:133], 2, v[132:133]
v_and_b32_sdwa v134, s47, v132 dst_sel:DWORD dst_unused:UNUSED_PAD src0_sel:DWORD src1_sel:WORD_1
v_and_b32 v132, s47, v132
v_pk_mul_f16 v143, v142, v143
v_exp_f16_sdwa v141, v141 dst_sel:WORD_0 dst_unused:UNUSED_PRESERVE src0_sel:WORD_0
s_waitcnt lgkmcnt(5)
v_mfma_f32_32x32x16_bf16 v[96:111], v[64:67], v[184:187], v[96:111]
ds_read_u16_d16_hi v134, v134
ds_read_u16 v132, v132
v_fma_mix_f32 v230, v120, v120, v230 op_sel_hi:[1,1,0]
v_and_b32_sdwa v135, s47, v133 dst_sel:DWORD dst_unused:UNUSED_PAD src0_sel:DWORD src1_sel:WORD_1
v_fma_mix_f32 v230, v121, v121, v230 op_sel_hi:[1,1,0]
v_and_b32_e64 v133, s47, v133
v_exp_f16_sdwa v143, v143 dst_sel:WORD_0 dst_unused:UNUSED_PRESERVE src0_sel:WORD_0
v_fma_mix_f32 v230, v122, v122, v230 op_sel_hi:[1,1,0]
v_cvt_pkrtz_f16_f32 v136, v136, v137
v_fma_mix_f32 v230, v123, v123, v230 op_sel_hi:[1,1,0]
v_cvt_pkrtz_f16_f32 v137, v138, v139
v_lshrrev_b64 v[136:137], 2, v[136:137]
ds_read_u16_d16_hi v135, v135
ds_read_u16 v133, v133
v_and_b32_sdwa v138, s47, v136 dst_sel:DWORD dst_unused:UNUSED_PAD src0_sel:DWORD src1_sel:WORD_1
v_and_b32_e64 v136, s47, v136
v_exp_f16_sdwa v141, v141 dst_sel:WORD_1 dst_unused:UNUSED_PRESERVE src0_sel:WORD_1
v_mfma_f32_32x32x16_bf16 v[144:159], v[184:187], v[88:91], v[144:159]
ds_read_u16_d16_hi v138, v138
ds_read_u16 v136, v136
ds_read_b128 v[180:183], v250 offset:50176
v_and_b32_sdwa v139, s47, v137 dst_sel:DWORD dst_unused:UNUSED_PAD src0_sel:DWORD src1_sel:WORD_1
v_and_b32_e64 v137, s47, v137
v_exp_f16_sdwa v143, v143 dst_sel:WORD_1 dst_unused:UNUSED_PRESERVE src0_sel:WORD_1
v_pk_add_f16 v141, v141, 1.0 op_sel_hi:[1,0]
v_mfma_f32_32x32x16_bf16 v[96:111], v[68:71], v[188:191], v[96:111]
ds_read_u16_d16_hi v139, v139
ds_read_u16 v137, v137
v_pk_add_f16 v143, v143, 1.0 op_sel_hi:[1,0]
v_rcp_f16_sdwa v141, v141 dst_sel:WORD_0 dst_unused:UNUSED_PRESERVE src0_sel:WORD_0
v_rcp_f16_sdwa v143, v143 dst_sel:WORD_0 dst_unused:UNUSED_PRESERVE src0_sel:WORD_0
v_mfma_f32_32x32x16_bf16 v[144:159], v[188:191], v[92:95], v[144:159]
ds_read_b128 v[184:187], v250 offset:51200
v_rcp_f16_sdwa v141, v141 dst_sel:WORD_1 dst_unused:UNUSED_PRESERVE src0_sel:WORD_1
v_rcp_f16_sdwa v143, v143 dst_sel:WORD_1 dst_unused:UNUSED_PRESERVE src0_sel:WORD_1
v_mov_b32 v239, 0
s_branch Law5
Lax5:
s_sleep 2
Law5:
ds_read_b32 v239, v247 offset:28
s_sub_u32 s76, s76, 1
s_cselect_b32 s44, 4, 0
s_cselect_b32 s76, 0, s76
s_waitcnt lgkmcnt(0)
v_readfirstlane_b32 s43, v239
s_nop 1
s_max_u32 s43, s43, s44
s_cmp_lt_u32 s43, 4
s_cbranch_scc1 Lax5
v_bfe_u32 v237, v250, 4, 6
v_lshrrev_b32_e64 v246, 2, v237
v_mul_u32_u24 v246, 192, v246
v_and_b32_e64 v237, 3, v237
v_lshl_add_u32 v246, v237, 4, v246
v_mfma_f32_32x32x16_bf16 v[160:175], v[48:51], v[176:179], 0
v_permlane32_swap_b32 v224, v225
v_add_f32 v224, v224, v225
v_permlane32_swap_b32 v226, v227
v_add_f32 v226, v226, v227
v_permlane32_swap_b32 v228, v229
v_add_f32 v228, v228, v229
v_pk_mul_f16 v206, v140, v141
v_pk_mul_f16 v207, v142, v143
ds_write_b32 v248, v224 offset:5120
ds_write_b32 v248, v226 offset:5376
ds_write_b32 v248, v228 offset:5632
v_lshl_add_u64 v[200:201], v[128:129], 0, v[130:131]
v_cvt_pkrtz_f16_f32 v96, v96, v97
v_cvt_pkrtz_f16_f32 v97, v98, v99
v_lshrrev_b64 v[96:97], 2, v[96:97]
v_and_b32_sdwa v98, s47, v96 dst_sel:DWORD dst_unused:UNUSED_PAD src0_sel:DWORD src1_sel:WORD_1
v_and_b32_e64 v96, s47, v96
v_cvt_pk_f16_f32 v108, v108, v109
v_cvt_pk_f16_f32 v110, v110, v111
v_mfma_f32_32x32x16_bf16 v[112:127], v[176:179], v[72:75], 0
ds_read_u16 v98, v98
ds_read_u16 v96, v96
v_pk_fma_f16 v109, v108, v108, s48
v_and_b32_sdwa v99, s47, v97 dst_sel:DWORD dst_unused:UNUSED_PAD src0_sel:DWORD src1_sel:WORD_1
v_and_b32_e64 v97, s47, v97
v_pk_fma_f16 v111, v110, v110, s48
v_pk_mul_f16 v109, v108, v109
v_pk_mul_f16 v111, v110, v111
v_lshl_add_u64 v[204:205], v[132:133], 0, v[134:135]
v_cvt_pkrtz_f16_f32 v100, v100, v101
v_cvt_pkrtz_f16_f32 v101, v102, v103
ds_read_u16 v99, v99
ds_read_u16 v97, v97
ds_read_b128 v[188:191], v250 offset:52224
v_lshrrev_b64 v[100:101], 2, v[100:101]
v_and_b32_sdwa v102, s47, v100 dst_sel:DWORD dst_unused:UNUSED_PAD src0_sel:DWORD src1_sel:WORD_1
v_and_b32_e64 v100, s47, v100
v_exp_f16_sdwa v109, v109 dst_sel:WORD_0 dst_unused:UNUSED_PRESERVE src0_sel:WORD_0
v_mfma_f32_32x32x16_bf16 v[160:175], v[52:55], v[180:183], v[160:175]
ds_read_u16 v102, v102
ds_read_u16 v100, v100
s_add_u32 m0, s72, 0
s_add_u32 s43, s82, 0
buffer_load_dwordx4 v246, s[16:19], s43 offen lds
v_exp_f16_sdwa v111, v111 dst_sel:WORD_0 dst_unused:UNUSED_PRESERVE src0_sel:WORD_0
v_and_b32_sdwa v103, s47, v101 dst_sel:DWORD dst_unused:UNUSED_PAD src0_sel:DWORD src1_sel:WORD_1
v_and_b32_e64 v101, s47, v101
v_exp_f16_sdwa v109, v109 dst_sel:WORD_1 dst_unused:UNUSED_PRESERVE src0_sel:WORD_1
v_lshl_add_u64 v[202:203], v[136:137], 0, v[138:139]
v_cvt_pkrtz_f16_f32 v104, v104, v105
v_cvt_pkrtz_f16_f32 v105, v106, v107
v_lshrrev_b64 v[104:105], 2, v[104:105]
v_and_b32_sdwa v106, s47, v104 dst_sel:DWORD dst_unused:UNUSED_PAD src0_sel:DWORD src1_sel:WORD_1
ds_read_u16 v103, v103
ds_read_u16 v101, v101
v_and_b32_e64 v104, s47, v104
v_mfma_f32_32x32x16_bf16 v[112:127], v[180:183], v[76:79], v[112:127]
ds_read_u16 v106, v106
ds_read_u16 v104, v104
v_exp_f16_sdwa v111, v111 dst_sel:WORD_1 dst_unused:UNUSED_PRESERVE src0_sel:WORD_1
v_and_b32_sdwa v107, s47, v105 dst_sel:DWORD dst_unused:UNUSED_PAD src0_sel:DWORD src1_sel:WORD_1
v_and_b32 v105, s47, v105
v_mfma_f32_32x32x16_f16 v[128:143], v[200:203], v[216:219], 0
ds_read_b128 v[176:179], v250 offset:53248
s_waitcnt lgkmcnt(9)
ds_read_u16 v107, v107
ds_read_u16 v105, v105
v_pk_add_f16 v109, v109, 1.0 op_sel_hi:[1,0]
v_pk_add_f16 v111, v111, 1.0 op_sel_hi:[1,0]
v_rcp_f16_sdwa v109, v109 dst_sel:WORD_0 dst_unused:UNUSED_PRESERVE src0_sel:WORD_0
v_mfma_f32_32x32x16_f16 v[128:143], v[204:207], v[220:223], v[128:143]
v_permlane16_swap_b32 v200, v204
v_permlane16_swap_b32 v201, v205
v_permlane16_swap_b32 v202, v206
v_permlane16_swap_b32 v203, v207
v_rcp_f16_sdwa v111, v111 dst_sel:WORD_0 dst_unused:UNUSED_PRESERVE src0_sel:WORD_0
v_mfma_f32_32x32x16_bf16 v[160:175], v[56:59], v[184:187], v[160:175]
v_rcp_f16_sdwa v109, v109 dst_sel:WORD_1 dst_unused:UNUSED_PRESERVE src0_sel:WORD_1
s_add_u32 m0, s72, 1024
s_add_u32 s43, s82, 64
buffer_load_dwordx4 v246, s[16:19], s43 offen lds
v_rcp_f16_sdwa v111, v111 dst_sel:WORD_1 dst_unused:UNUSED_PRESERVE src0_sel:WORD_1
s_nop 0
v_fmac_f32_e64 v230, v128, v128
v_mfma_f32_32x32x16_bf16 v[112:127], v[184:187], v[80:83], v[112:127]
ds_read_b128 v[180:183], v250 offset:54272
v_pk_mul_f16 v108, v108, v109
v_fmac_f32_e64 v230, v129, v129
v_pk_mul_f16 v110, v110, v111
v_fmac_f32 v230, v130, v130
v_fmac_f32 v230, v131, v131
v_fma_mix_f32 v231, v108, v108, v231 op_sel_hi:[1,1,0]
v_fmac_f32 v230, v132, v132
v_fmac_f32 v230, v133, v133
v_fma_mix_f32 v231, v110, v110, v231 op_sel_hi:[1,1,0]
s_waitcnt lgkmcnt(6)
v_mfma_f32_32x32x16_bf16 v[160:175], v[60:63], v[188:191], v[160:175]
v_fmac_f32 v230, v134, v134
v_fma_mix_f32 v231, v108, v108, v231 op_sel:[1,1,0] op_sel_hi:[1,1,0]
v_fmac_f32 v230, v135, v135
v_fmac_f32 v230, v136, v136
v_fma_mix_f32 v231, v110, v110, v231 op_sel:[1,1,0] op_sel_hi:[1,1,0]
v_fmac_f32_e64 v230, v137, v137
v_fma_mix_f32 v231, v96, v96, v231 op_sel_hi:[1,1,0]
v_fmac_f32_e64 v230, v138, v138
v_fma_mix_f32 v231, v97, v97, v231 op_sel_hi:[1,1,0]
v_cvt_pkrtz_f16_f32 v144, v144, v145
v_fma_mix_f32 v231, v98, v98, v231 op_sel_hi:[1,1,0]
v_cvt_pkrtz_f16_f32 v145, v146, v147
v_fma_mix_f32 v231, v99, v99, v231 op_sel_hi:[1,1,0]
v_lshrrev_b64 v[144:145], 2, v[144:145]
v_and_b32_sdwa v146, s47, v144 dst_sel:DWORD dst_unused:UNUSED_PAD src0_sel:DWORD src1_sel:WORD_1
v_and_b32_e64 v144, s47, v144
v_cvt_pk_f16_f32 v156, v156, v157
v_fmac_f32_e64 v230, v139, v139
v_cvt_pk_f16_f32 v158, v158, v159
v_fmac_f32 v230, v140, v140
v_fmac_f32 v230, v141, v141
v_mfma_f32_32x32x16_bf16 v[112:127], v[188:191], v[84:87], v[112:127]
ds_read_u16_d16_hi v146, v146
ds_read_u16 v144, v144
v_pk_fma_f16 v157, v156, v156, s48
v_fmac_f32_e64 v230, v142, v142
v_fma_mix_f32 v231, v100, v100, v231 op_sel_hi:[1,1,0]
v_and_b32_sdwa v147, s47, v145 dst_sel:DWORD dst_unused:UNUSED_PAD src0_sel:DWORD src1_sel:WORD_1
v_fma_mix_f32 v231, v101, v101, v231 op_sel_hi:[1,1,0]
v_and_b32 v145, s47, v145
v_fmac_f32 v230, v143, v143
v_pk_fma_f16 v159, v158, v158, s48
v_pk_mul_f16 v157, v156, v157
v_fma_mix_f32 v231, v102, v102, v231 op_sel_hi:[1,1,0]
v_cvt_pkrtz_f16_f32 v148, v148, v149
v_fma_mix_f32 v231, v103, v103, v231 op_sel_hi:[1,1,0]
ds_read_u16_d16_hi v147, v147
ds_read_u16 v145, v145
ds_read_b128 v[184:187], v250 offset:55296
v_cvt_pkrtz_f16_f32 v149, v150, v151
v_lshrrev_b64 v[148:149], 2, v[148:149]
v_and_b32_sdwa v150, s47, v148 dst_sel:DWORD dst_unused:UNUSED_PAD src0_sel:DWORD src1_sel:WORD_1
v_and_b32 v148, s47, v148
v_pk_mul_f16 v159, v158, v159
v_exp_f16_sdwa v157, v157 dst_sel:WORD_0 dst_unused:UNUSED_PRESERVE src0_sel:WORD_0
s_waitcnt lgkmcnt(5)
v_mfma_f32_32x32x16_bf16 v[160:175], v[64:67], v[176:179], v[160:175]
ds_read_u16_d16_hi v150, v150
ds_read_u16 v148, v148
s_add_u32 m0, s72, 2048
s_add_u32 s43, s82, 128
buffer_load_dwordx4 v246, s[16:19], s43 offen lds
v_fma_mix_f32 v231, v104, v104, v231 op_sel_hi:[1,1,0]
v_and_b32_sdwa v151, s47, v149 dst_sel:DWORD dst_unused:UNUSED_PAD src0_sel:DWORD src1_sel:WORD_1
v_fma_mix_f32 v231, v105, v105, v231 op_sel_hi:[1,1,0]
v_and_b32_e64 v149, s47, v149
v_exp_f16_sdwa v159, v159 dst_sel:WORD_0 dst_unused:UNUSED_PRESERVE src0_sel:WORD_0
v_fma_mix_f32 v231, v106, v106, v231 op_sel_hi:[1,1,0]
v_cvt_pkrtz_f16_f32 v152, v152, v153
v_fma_mix_f32 v231, v107, v107, v231 op_sel_hi:[1,1,0]
v_cvt_pkrtz_f16_f32 v153, v154, v155
v_lshrrev_b64 v[152:153], 2, v[152:153]
ds_read_u16_d16_hi v151, v151
ds_read_u16 v149, v149
v_and_b32_sdwa v154, s47, v152 dst_sel:DWORD dst_unused:UNUSED_PAD src0_sel:DWORD src1_sel:WORD_1
v_and_b32_e64 v152, s47, v152
v_exp_f16_sdwa v157, v157 dst_sel:WORD_1 dst_unused:UNUSED_PRESERVE src0_sel:WORD_1
v_mfma_f32_32x32x16_bf16 v[112:127], v[176:179], v[88:91], v[112:127]
ds_read_u16_d16_hi v154, v154
ds_read_u16 v152, v152
ds_read_b128 v[188:191], v250 offset:56320
v_and_b32_sdwa v155, s47, v153 dst_sel:DWORD dst_unused:UNUSED_PAD src0_sel:DWORD src1_sel:WORD_1
v_and_b32_e64 v153, s47, v153
v_exp_f16_sdwa v159, v159 dst_sel:WORD_1 dst_unused:UNUSED_PRESERVE src0_sel:WORD_1
v_pk_add_f16 v157, v157, 1.0 op_sel_hi:[1,0]
v_mfma_f32_32x32x16_bf16 v[160:175], v[68:71], v[180:183], v[160:175]
ds_read_u16_d16_hi v155, v155
ds_read_u16 v153, v153
v_pk_add_f16 v159, v159, 1.0 op_sel_hi:[1,0]
v_rcp_f16_sdwa v157, v157 dst_sel:WORD_0 dst_unused:UNUSED_PRESERVE src0_sel:WORD_0
v_rcp_f16_sdwa v159, v159 dst_sel:WORD_0 dst_unused:UNUSED_PRESERVE src0_sel:WORD_0
s_add_u32 m0, s72, 3072
s_add_u32 s43, s82, 3072
buffer_load_dwordx4 v246, s[16:19], s43 offen lds
v_mfma_f32_32x32x16_bf16 v[112:127], v[180:183], v[92:95], v[112:127]
ds_read_b128 v[176:179], v250 offset:57344
v_rcp_f16_sdwa v157, v157 dst_sel:WORD_1 dst_unused:UNUSED_PRESERVE src0_sel:WORD_1
v_rcp_f16_sdwa v159, v159 dst_sel:WORD_1 dst_unused:UNUSED_PRESERVE src0_sel:WORD_1
v_pk_mul_f16 v214, v156, v157
s_waitcnt lgkmcnt(7)
v_mfma_f32_32x32x16_bf16 v[128:143], v[48:51], v[184:187], 0
v_pk_mul_f16 v215, v158, v159
v_lshl_add_u64 v[208:209], v[144:145], 0, v[146:147]
v_cvt_pkrtz_f16_f32 v160, v160, v161
v_cvt_pkrtz_f16_f32 v161, v162, v163
v_lshrrev_b64 v[160:161], 2, v[160:161]
v_and_b32_sdwa v162, s47, v160 dst_sel:DWORD dst_unused:UNUSED_PAD src0_sel:DWORD src1_sel:WORD_1
v_and_b32 v160, s47, v160
v_cvt_pk_f16_f32 v172, v172, v173
v_cvt_pk_f16_f32 v174, v174, v175
v_mfma_f32_32x32x16_bf16 v[96:111], v[72:75], v[184:187], 0
ds_read_u16 v162, v162
ds_read_u16 v160, v160
v_pk_fma_f16 v173, v172, v172, s48
v_and_b32_sdwa v163, s47, v161 dst_sel:DWORD dst_unused:UNUSED_PAD src0_sel:DWORD src1_sel:WORD_1
v_and_b32 v161, s47, v161
v_pk_fma_f16 v175, v174, v174, s48
v_pk_mul_f16 v173, v172, v173
v_pk_mul_f16 v175, v174, v175
s_waitcnt lgkmcnt(5)
v_lshl_add_u64 v[212:213], v[148:149], 0, v[150:151]
v_cvt_pkrtz_f16_f32 v164, v164, v165
v_cvt_pkrtz_f16_f32 v165, v166, v167
ds_read_u16 v163, v163
ds_read_u16 v161, v161
ds_read_b128 v[180:183], v250 offset:58368
v_lshrrev_b64 v[164:165], 2, v[164:165]
v_and_b32_sdwa v166, s47, v164 dst_sel:DWORD dst_unused:UNUSED_PAD src0_sel:DWORD src1_sel:WORD_1
v_and_b32_e64 v164, s47, v164
v_exp_f16_sdwa v173, v173 dst_sel:WORD_0 dst_unused:UNUSED_PRESERVE src0_sel:WORD_0
v_mfma_f32_32x32x16_bf16 v[128:143], v[52:55], v[188:191], v[128:143]
ds_read_u16 v166, v166
ds_read_u16 v164, v164
s_add_u32 m0, s72, 4096
s_add_u32 s43, s82, 3136
buffer_load_dwordx4 v246, s[16:19], s43 offen lds
v_exp_f16_sdwa v175, v175 dst_sel:WORD_0 dst_unused:UNUSED_PRESERVE src0_sel:WORD_0
v_and_b32_sdwa v167, s47, v165 dst_sel:DWORD dst_unused:UNUSED_PAD src0_sel:DWORD src1_sel:WORD_1
v_and_b32 v165, s47, v165
v_exp_f16_sdwa v173, v173 dst_sel:WORD_1 dst_unused:UNUSED_PRESERVE src0_sel:WORD_1
s_waitcnt lgkmcnt(7)
v_lshl_add_u64 v[210:211], v[152:153], 0, v[154:155]
v_cvt_pkrtz_f16_f32 v168, v168, v169
v_cvt_pkrtz_f16_f32 v169, v170, v171
v_lshrrev_b64 v[168:169], 2, v[168:169]
v_and_b32_sdwa v170, s47, v168 dst_sel:DWORD dst_unused:UNUSED_PAD src0_sel:DWORD src1_sel:WORD_1
ds_read_u16 v167, v167
ds_read_u16 v165, v165
v_and_b32_e64 v168, s47, v168
v_mfma_f32_32x32x16_bf16 v[96:111], v[76:79], v[188:191], v[96:111]
ds_read_u16 v170, v170
ds_read_u16 v168, v168
v_exp_f16_sdwa v175, v175 dst_sel:WORD_1 dst_unused:UNUSED_PRESERVE src0_sel:WORD_1
v_and_b32_sdwa v171, s47, v169 dst_sel:DWORD dst_unused:UNUSED_PAD src0_sel:DWORD src1_sel:WORD_1
v_and_b32_e64 v169, s47, v169
v_mfma_f32_32x32x16_f16 v[144:159], v[208:211], v[216:219], 0
ds_read_b128 v[184:187], v250 offset:59392
ds_read_u16 v171, v171
ds_read_u16 v169, v169
v_pk_add_f16 v173, v173, 1.0 op_sel_hi:[1,0]
v_pk_add_f16 v175, v175, 1.0 op_sel_hi:[1,0]
v_rcp_f16_sdwa v173, v173 dst_sel:WORD_0 dst_unused:UNUSED_PRESERVE src0_sel:WORD_0
v_mfma_f32_32x32x16_f16 v[144:159], v[212:215], v[220:223], v[144:159]
v_permlane16_swap_b32 v208, v212
v_permlane16_swap_b32 v209, v213
v_permlane16_swap_b32 v210, v214
v_permlane16_swap_b32 v211, v215
v_rcp_f16_sdwa v175, v175 dst_sel:WORD_0 dst_unused:UNUSED_PRESERVE src0_sel:WORD_0
v_mfma_f32_32x32x16_bf16 v[128:143], v[56:59], v[176:179], v[128:143]
v_rcp_f16_sdwa v173, v173 dst_sel:WORD_1 dst_unused:UNUSED_PRESERVE src0_sel:WORD_1
s_add_u32 m0, s72, 6144
s_add_u32 s43, s82, 6144
buffer_load_dwordx4 v246, s[16:19], s43 offen lds
v_rcp_f16_sdwa v175, v175 dst_sel:WORD_1 dst_unused:UNUSED_PRESERVE src0_sel:WORD_1
s_nop 0
v_fmac_f32 v231, v144, v144
v_mfma_f32_32x32x16_bf16 v[96:111], v[80:83], v[176:179], v[96:111]
ds_read_b128 v[188:191], v250 offset:60416
v_pk_mul_f16 v172, v172, v173
v_fmac_f32_e64 v231, v145, v145
v_pk_mul_f16 v174, v174, v175
v_fmac_f32 v231, v146, v146
v_fmac_f32 v231, v147, v147
v_fma_mix_f32 v232, v172, v172, v232 op_sel_hi:[1,1,0]
v_fmac_f32 v231, v148, v148
v_fmac_f32 v231, v149, v149
v_fma_mix_f32 v232, v174, v174, v232 op_sel_hi:[1,1,0]
s_waitcnt lgkmcnt(6)
v_mfma_f32_32x32x16_bf16 v[128:143], v[60:63], v[180:183], v[128:143]
v_fmac_f32 v231, v150, v150
v_fma_mix_f32 v232, v172, v172, v232 op_sel:[1,1,0] op_sel_hi:[1,1,0]
v_fmac_f32 v231, v151, v151
v_fmac_f32 v231, v152, v152
v_fma_mix_f32 v232, v174, v174, v232 op_sel:[1,1,0] op_sel_hi:[1,1,0]
v_fmac_f32_e64 v231, v153, v153
v_fma_mix_f32 v232, v160, v160, v232 op_sel_hi:[1,1,0]
v_fmac_f32_e64 v231, v154, v154
v_fma_mix_f32 v232, v161, v161, v232 op_sel_hi:[1,1,0]
v_cvt_pkrtz_f16_f32 v112, v112, v113
v_fma_mix_f32 v232, v162, v162, v232 op_sel_hi:[1,1,0]
v_cvt_pkrtz_f16_f32 v113, v114, v115
v_fma_mix_f32 v232, v163, v163, v232 op_sel_hi:[1,1,0]
v_lshrrev_b64 v[112:113], 2, v[112:113]
v_and_b32_sdwa v114, s47, v112 dst_sel:DWORD dst_unused:UNUSED_PAD src0_sel:DWORD src1_sel:WORD_1
v_and_b32_e64 v112, s47, v112
v_cvt_pk_f16_f32 v124, v124, v125
v_fmac_f32_e64 v231, v155, v155
v_cvt_pk_f16_f32 v126, v126, v127
v_fmac_f32 v231, v156, v156
v_fmac_f32 v231, v157, v157
v_mfma_f32_32x32x16_bf16 v[96:111], v[84:87], v[180:183], v[96:111]
ds_read_u16_d16_hi v114, v114
ds_read_u16 v112, v112
v_pk_fma_f16 v125, v124, v124, s48
v_fmac_f32_e64 v231, v158, v158
v_fma_mix_f32 v232, v164, v164, v232 op_sel_hi:[1,1,0]
v_and_b32_sdwa v115, s47, v113 dst_sel:DWORD dst_unused:UNUSED_PAD src0_sel:DWORD src1_sel:WORD_1
v_fma_mix_f32 v232, v165, v165, v232 op_sel_hi:[1,1,0]
v_and_b32 v113, s47, v113
v_fmac_f32 v231, v159, v159
s_nop 1
v_permlane32_swap_b32 v230, v231
v_add_f32_e64 v230, v230, v231
v_pk_fma_f16 v127, v126, v126, s48
v_pk_mul_f16 v125, v124, v125
v_fma_mix_f32 v232, v166, v166, v232 op_sel_hi:[1,1,0]
ds_read_u16_d16_hi v115, v115
ds_read_u16 v113, v113
ds_write_b32 v248, v230 offset:8192
ds_read_b128 v[176:179], v250 offset:61440
v_fma_mix_f32 v232, v167, v167, v232 op_sel_hi:[1,1,0]
v_cvt_pkrtz_f16_f32 v116, v116, v117
v_cvt_pkrtz_f16_f32 v117, v118, v119
v_lshrrev_b64 v[116:117], 2, v[116:117]
v_and_b32_sdwa v118, s47, v116 dst_sel:DWORD dst_unused:UNUSED_PAD src0_sel:DWORD src1_sel:WORD_1
v_and_b32 v116, s47, v116
v_pk_mul_f16 v127, v126, v127
v_exp_f16_sdwa v125, v125 dst_sel:WORD_0 dst_unused:UNUSED_PRESERVE src0_sel:WORD_0
s_waitcnt lgkmcnt(6)
v_mfma_f32_32x32x16_bf16 v[128:143], v[64:67], v[184:187], v[128:143]
ds_read_u16_d16_hi v118, v118
ds_read_u16 v116, v116
s_add_u32 m0, s72, 7168
s_add_u32 s43, s82, 6208
buffer_load_dwordx4 v246, s[16:19], s43 offen lds
v_fma_mix_f32 v232, v168, v168, v232 op_sel_hi:[1,1,0]
v_and_b32_sdwa v119, s47, v117 dst_sel:DWORD dst_unused:UNUSED_PAD src0_sel:DWORD src1_sel:WORD_1
v_fma_mix_f32 v232, v169, v169, v232 op_sel_hi:[1,1,0]
v_and_b32_e64 v117, s47, v117
v_exp_f16_sdwa v127, v127 dst_sel:WORD_0 dst_unused:UNUSED_PRESERVE src0_sel:WORD_0
v_fma_mix_f32 v232, v170, v170, v232 op_sel_hi:[1,1,0]
v_cvt_pkrtz_f16_f32 v120, v120, v121
v_fma_mix_f32 v232, v171, v171, v232 op_sel_hi:[1,1,0]
v_cvt_pkrtz_f16_f32 v121, v122, v123
v_lshrrev_b64 v[120:121], 2, v[120:121]
ds_read_u16_d16_hi v119, v119
ds_read_u16 v117, v117
v_and_b32_sdwa v122, s47, v120 dst_sel:DWORD dst_unused:UNUSED_PAD src0_sel:DWORD src1_sel:WORD_1
v_and_b32_e64 v120, s47, v120
v_exp_f16_sdwa v125, v125 dst_sel:WORD_1 dst_unused:UNUSED_PRESERVE src0_sel:WORD_1
v_mfma_f32_32x32x16_bf16 v[96:111], v[88:91], v[184:187], v[96:111]
ds_read_u16_d16_hi v122, v122
ds_read_u16 v120, v120
ds_read_b128 v[180:183], v250 offset:62464
v_and_b32_sdwa v123, s47, v121 dst_sel:DWORD dst_unused:UNUSED_PAD src0_sel:DWORD src1_sel:WORD_1
v_and_b32 v121, s47, v121
v_exp_f16_sdwa v127, v127 dst_sel:WORD_1 dst_unused:UNUSED_PRESERVE src0_sel:WORD_1
v_pk_add_f16 v125, v125, 1.0 op_sel_hi:[1,0]
v_mfma_f32_32x32x16_bf16 v[128:143], v[68:71], v[188:191], v[128:143]
ds_read_u16_d16_hi v123, v123
ds_read_u16 v121, v121
v_pk_add_f16 v127, v127, 1.0 op_sel_hi:[1,0]
v_rcp_f16_sdwa v125, v125 dst_sel:WORD_0 dst_unused:UNUSED_PRESERVE src0_sel:WORD_0
v_rcp_f16_sdwa v127, v127 dst_sel:WORD_0 dst_unused:UNUSED_PRESERVE src0_sel:WORD_0
v_mfma_f32_32x32x16_bf16 v[96:111], v[92:95], v[188:191], v[96:111]
s_waitcnt lgkmcnt(8)
ds_read_b128 v[184:187], v250 offset:63488
v_rcp_f16_sdwa v125, v125 dst_sel:WORD_1 dst_unused:UNUSED_PRESERVE src0_sel:WORD_1
v_rcp_f16_sdwa v127, v127 dst_sel:WORD_1 dst_unused:UNUSED_PRESERVE src0_sel:WORD_1
v_pk_mul_f16 v230, v124, v125
v_mfma_f32_32x32x16_bf16 v[144:159], v[48:51], v[176:179], 0
v_pk_mul_f16 v231, v126, v127
v_lshl_add_u64 v[224:225], v[112:113], 0, v[114:115]
v_cvt_pkrtz_f16_f32 v128, v128, v129
v_cvt_pkrtz_f16_f32 v129, v130, v131
v_lshrrev_b64 v[128:129], 2, v[128:129]
v_and_b32_sdwa v130, s47, v128 dst_sel:DWORD dst_unused:UNUSED_PAD src0_sel:DWORD src1_sel:WORD_1
v_and_b32_e64 v128, s47, v128
v_cvt_pk_f16_f32 v140, v140, v141
v_cvt_pk_f16_f32 v142, v142, v143
v_mfma_f32_32x32x16_bf16 v[160:175], v[176:179], v[72:75], 0
ds_read_u16 v130, v130
ds_read_u16 v128, v128
v_pk_fma_f16 v141, v140, v140, s48
v_and_b32_sdwa v131, s47, v129 dst_sel:DWORD dst_unused:UNUSED_PAD src0_sel:DWORD src1_sel:WORD_1
v_and_b32 v129, s47, v129
v_pk_fma_f16 v143, v142, v142, s48
v_pk_mul_f16 v141, v140, v141
v_pk_mul_f16 v143, v142, v143
s_waitcnt lgkmcnt(6)
v_lshl_add_u64 v[228:229], v[116:117], 0, v[118:119]
v_cvt_pkrtz_f16_f32 v132, v132, v133
v_cvt_pkrtz_f16_f32 v133, v134, v135
ds_read_u16 v131, v131
ds_read_u16 v129, v129
ds_read_b128 v[188:191], v250 offset:64512
v_lshrrev_b64 v[132:133], 2, v[132:133]
v_and_b32_sdwa v134, s47, v132 dst_sel:DWORD dst_unused:UNUSED_PAD src0_sel:DWORD src1_sel:WORD_1
v_and_b32 v132, s47, v132
v_exp_f16_sdwa v141, v141 dst_sel:WORD_0 dst_unused:UNUSED_PRESERVE src0_sel:WORD_0
s_waitcnt lgkmcnt(7)
v_mfma_f32_32x32x16_bf16 v[144:159], v[52:55], v[180:183], v[144:159]
ds_read_u16 v134, v134
ds_read_u16 v132, v132
v_exp_f16_sdwa v143, v143 dst_sel:WORD_0 dst_unused:UNUSED_PRESERVE src0_sel:WORD_0
v_and_b32_sdwa v135, s47, v133 dst_sel:DWORD dst_unused:UNUSED_PAD src0_sel:DWORD src1_sel:WORD_1
v_and_b32 v133, s47, v133
v_exp_f16_sdwa v141, v141 dst_sel:WORD_1 dst_unused:UNUSED_PRESERVE src0_sel:WORD_1
s_waitcnt lgkmcnt(7)
v_lshl_add_u64 v[226:227], v[120:121], 0, v[122:123]
v_cvt_pkrtz_f16_f32 v136, v136, v137
v_cvt_pkrtz_f16_f32 v137, v138, v139
v_lshrrev_b64 v[136:137], 2, v[136:137]
v_and_b32_sdwa v138, s47, v136 dst_sel:DWORD dst_unused:UNUSED_PAD src0_sel:DWORD src1_sel:WORD_1
ds_read_u16 v135, v135
ds_read_u16 v133, v133
v_and_b32_e64 v136, s47, v136
v_mfma_f32_32x32x16_bf16 v[160:175], v[180:183], v[76:79], v[160:175]
ds_read_u16 v138, v138
ds_read_u16 v136, v136
v_exp_f16_sdwa v143, v143 dst_sel:WORD_1 dst_unused:UNUSED_PRESERVE src0_sel:WORD_1
v_and_b32_sdwa v139, s47, v137 dst_sel:DWORD dst_unused:UNUSED_PAD src0_sel:DWORD src1_sel:WORD_1
v_and_b32_e64 v137, s47, v137
v_mfma_f32_32x32x16_f16 v[112:127], v[224:227], v[216:219], 0
ds_read_b128 v[176:179], v251
ds_read_u16 v139, v139
ds_read_u16 v137, v137
v_pk_add_f16 v141, v141, 1.0 op_sel_hi:[1,0]
v_pk_add_f16 v143, v143, 1.0 op_sel_hi:[1,0]
v_rcp_f16_sdwa v141, v141 dst_sel:WORD_0 dst_unused:UNUSED_PRESERVE src0_sel:WORD_0
v_mfma_f32_32x32x16_f16 v[112:127], v[228:231], v[220:223], v[112:127]
v_permlane16_swap_b32 v224, v228
v_permlane16_swap_b32 v225, v229
v_permlane16_swap_b32 v226, v230
v_permlane16_swap_b32 v227, v231
v_rcp_f16_sdwa v143, v143 dst_sel:WORD_0 dst_unused:UNUSED_PRESERVE src0_sel:WORD_0
v_mfma_f32_32x32x16_bf16 v[144:159], v[56:59], v[184:187], v[144:159]
v_rcp_f16_sdwa v141, v141 dst_sel:WORD_1 dst_unused:UNUSED_PRESERVE src0_sel:WORD_1
v_rcp_f16_sdwa v143, v143 dst_sel:WORD_1 dst_unused:UNUSED_PRESERVE src0_sel:WORD_1
s_nop 3
v_fmac_f32 v232, v112, v112
v_mfma_f32_32x32x16_bf16 v[160:175], v[184:187], v[80:83], v[160:175]
ds_read_b128 v[180:183], v251 offset:1024
v_pk_mul_f16 v140, v140, v141
v_fmac_f32_e64 v232, v113, v113
v_pk_mul_f16 v142, v142, v143
v_fmac_f32 v232, v114, v114
v_fmac_f32 v232, v115, v115
v_fma_mix_f32 v233, v140, v140, v233 op_sel_hi:[1,1,0]
v_fmac_f32 v232, v116, v116
v_fmac_f32 v232, v117, v117
v_fma_mix_f32 v233, v142, v142, v233 op_sel_hi:[1,1,0]
s_waitcnt lgkmcnt(6)
v_mfma_f32_32x32x16_bf16 v[144:159], v[60:63], v[188:191], v[144:159]
v_fmac_f32 v232, v118, v118
v_fma_mix_f32 v233, v140, v140, v233 op_sel:[1,1,0] op_sel_hi:[1,1,0]
v_fmac_f32 v232, v119, v119
v_fmac_f32 v232, v120, v120
v_fma_mix_f32 v233, v142, v142, v233 op_sel:[1,1,0] op_sel_hi:[1,1,0]
v_fmac_f32_e64 v232, v121, v121
v_fma_mix_f32 v233, v128, v128, v233 op_sel_hi:[1,1,0]
v_fmac_f32_e64 v232, v122, v122
v_fma_mix_f32 v233, v129, v129, v233 op_sel_hi:[1,1,0]
v_cvt_pkrtz_f16_f32 v96, v96, v97
v_fma_mix_f32 v233, v130, v130, v233 op_sel_hi:[1,1,0]
v_cvt_pkrtz_f16_f32 v97, v98, v99
v_fma_mix_f32 v233, v131, v131, v233 op_sel_hi:[1,1,0]
v_lshrrev_b64 v[96:97], 2, v[96:97]
v_and_b32_sdwa v98, s47, v96 dst_sel:DWORD dst_unused:UNUSED_PAD src0_sel:DWORD src1_sel:WORD_1
v_and_b32_e64 v96, s47, v96
v_cvt_pk_f16_f32 v108, v108, v109
v_fmac_f32_e64 v232, v123, v123
v_cvt_pk_f16_f32 v110, v110, v111
v_fmac_f32 v232, v124, v124
v_fmac_f32 v232, v125, v125
v_mfma_f32_32x32x16_bf16 v[160:175], v[188:191], v[84:87], v[160:175]
ds_read_u16 v98, v98
ds_read_u16 v96, v96
v_pk_fma_f16 v109, v108, v108, s48
v_fmac_f32_e64 v232, v126, v126
v_fma_mix_f32 v233, v132, v132, v233 op_sel_hi:[1,1,0]
v_and_b32_sdwa v99, s47, v97 dst_sel:DWORD dst_unused:UNUSED_PAD src0_sel:DWORD src1_sel:WORD_1
v_fma_mix_f32 v233, v133, v133, v233 op_sel_hi:[1,1,0]
v_and_b32 v97, s47, v97
v_fmac_f32 v232, v127, v127
v_pk_fma_f16 v111, v110, v110, s48
v_pk_mul_f16 v109, v108, v109
v_pk_mul_f16 v111, v110, v111
v_fma_mix_f32 v233, v134, v134, v233 op_sel_hi:[1,1,0]
v_cvt_pkrtz_f16_f32 v100, v100, v101
ds_read_u16 v99, v99
ds_read_u16 v97, v97
ds_read_b128 v[184:187], v251 offset:2048
v_fma_mix_f32 v233, v135, v135, v233 op_sel_hi:[1,1,0]
v_cvt_pkrtz_f16_f32 v101, v102, v103
v_lshrrev_b64 v[100:101], 2, v[100:101]
v_and_b32_sdwa v102, s47, v100 dst_sel:DWORD dst_unused:UNUSED_PAD src0_sel:DWORD src1_sel:WORD_1
v_and_b32 v100, s47, v100
v_exp_f16_sdwa v109, v109 dst_sel:WORD_0 dst_unused:UNUSED_PRESERVE src0_sel:WORD_0
s_waitcnt lgkmcnt(5)
v_mfma_f32_32x32x16_bf16 v[144:159], v[64:67], v[176:179], v[144:159]
ds_read_u16 v102, v102
ds_read_u16 v100, v100
v_fma_mix_f32 v233, v136, v136, v233 op_sel_hi:[1,1,0]
v_exp_f16_sdwa v111, v111 dst_sel:WORD_0 dst_unused:UNUSED_PRESERVE src0_sel:WORD_0
v_fma_mix_f32 v233, v137, v137, v233 op_sel_hi:[1,1,0]
v_and_b32_sdwa v103, s47, v101 dst_sel:DWORD dst_unused:UNUSED_PAD src0_sel:DWORD src1_sel:WORD_1
v_and_b32_e64 v101, s47, v101
v_exp_f16_sdwa v109, v109 dst_sel:WORD_1 dst_unused:UNUSED_PRESERVE src0_sel:WORD_1
v_fma_mix_f32 v233, v138, v138, v233 op_sel_hi:[1,1,0]
v_cvt_pkrtz_f16_f32 v104, v104, v105
v_fma_mix_f32 v233, v139, v139, v233 op_sel_hi:[1,1,0]
v_cvt_pkrtz_f16_f32 v105, v106, v107
v_lshrrev_b64 v[104:105], 2, v[104:105]
ds_read_u16 v103, v103
ds_read_u16 v101, v101
v_and_b32_sdwa v106, s47, v104 dst_sel:DWORD dst_unused:UNUSED_PAD src0_sel:DWORD src1_sel:WORD_1
v_and_b32_e64 v104, s47, v104
v_mfma_f32_32x32x16_bf16 v[160:175], v[176:179], v[88:91], v[160:175]
ds_read_u16 v106, v106
ds_read_u16 v104, v104
v_exp_f16_sdwa v111, v111 dst_sel:WORD_1 dst_unused:UNUSED_PRESERVE src0_sel:WORD_1
v_and_b32_sdwa v107, s47, v105 dst_sel:DWORD dst_unused:UNUSED_PAD src0_sel:DWORD src1_sel:WORD_1
v_and_b32_e64 v105, s47, v105
v_pk_add_f16 v109, v109, 1.0 op_sel_hi:[1,0]
v_pk_add_f16 v111, v111, 1.0 op_sel_hi:[1,0]
v_rcp_f16_sdwa v109, v109 dst_sel:WORD_0 dst_unused:UNUSED_PRESERVE src0_sel:WORD_0
v_mfma_f32_32x32x16_bf16 v[144:159], v[68:71], v[180:183], v[144:159]
ds_read_b128 v[188:191], v251 offset:3072
ds_read_u16 v107, v107
ds_read_u16 v105, v105
v_rcp_f16_sdwa v111, v111 dst_sel:WORD_0 dst_unused:UNUSED_PRESERVE src0_sel:WORD_0
v_rcp_f16_sdwa v109, v109 dst_sel:WORD_1 dst_unused:UNUSED_PRESERVE src0_sel:WORD_1
v_mfma_f32_32x32x16_bf16 v[160:175], v[180:183], v[92:95], v[160:175]
v_rcp_f16_sdwa v111, v111 dst_sel:WORD_1 dst_unused:UNUSED_PRESERVE src0_sel:WORD_1
v_pk_mul_f16 v108, v108, v109
v_pk_mul_f16 v110, v110, v111
v_fma_mix_f32 v233, v108, v108, v233 op_sel_hi:[1,1,0]
s_waitcnt lgkmcnt(6)
v_mfma_f32_32x32x16_bf16 v[112:127], v[48:51], v[184:187], 0
ds_read_b128 v[176:179], v251 offset:4096
v_fma_mix_f32 v233, v110, v110, v233 op_sel_hi:[1,1,0]
v_bfe_u32 v237, v250, 4, 6
v_min_u32 v237, 47, v237
v_lshlrev_b32_e64 v244, 5, v237
v_add_u32 v244, 95232, v244
v_add_u32 v245, 2304, v244
v_cmp_gt_u32 vcc, 24, v237
s_nop 1
v_cndmask_b32 v244, v245, v244, vcc
v_lshlrev_b32 v237, 13, v237
v_add_u32 v245, 4096, v237
v_fma_mix_f32 v233, v108, v108, v233 op_sel:[1,1,0] op_sel_hi:[1,1,0]
v_cvt_pkrtz_f16_f32 v144, v144, v145
v_fma_mix_f32 v233, v110, v110, v233 op_sel:[1,1,0] op_sel_hi:[1,1,0]
v_cvt_pkrtz_f16_f32 v145, v146, v147
v_fma_mix_f32 v233, v96, v96, v233 op_sel_hi:[1,1,0]
v_lshrrev_b64 v[144:145], 2, v[144:145]
v_fma_mix_f32 v233, v97, v97, v233 op_sel_hi:[1,1,0]
v_and_b32_sdwa v146, s47, v144 dst_sel:DWORD dst_unused:UNUSED_PAD src0_sel:DWORD src1_sel:WORD_1
v_fma_mix_f32 v233, v98, v98, v233 op_sel_hi:[1,1,0]
v_and_b32_e64 v144, s47, v144
v_fma_mix_f32 v233, v99, v99, v233 op_sel_hi:[1,1,0]
v_cvt_pk_f16_f32 v156, v156, v157
v_cvt_pk_f16_f32 v158, v158, v159
v_mfma_f32_32x32x16_bf16 v[128:143], v[184:187], v[72:75], 0
ds_read_u16 v146, v146
ds_read_u16 v144, v144
v_pk_fma_f16 v157, v156, v156, s48
v_fma_mix_f32 v233, v100, v100, v233 op_sel_hi:[1,1,0]
v_and_b32_sdwa v147, s47, v145 dst_sel:DWORD dst_unused:UNUSED_PAD src0_sel:DWORD src1_sel:WORD_1
s_waitcnt lgkmcnt(3)
v_fma_mix_f32 v233, v101, v101, v233 op_sel_hi:[1,1,0]
v_and_b32 v145, s47, v145
v_pk_fma_f16 v159, v158, v158, s48
v_pk_mul_f16 v157, v156, v157
v_pk_mul_f16 v159, v158, v159
v_fma_mix_f32 v233, v102, v102, v233 op_sel_hi:[1,1,0]
v_cvt_pkrtz_f16_f32 v148, v148, v149
v_fma_mix_f32 v233, v103, v103, v233 op_sel_hi:[1,1,0]
ds_read_u16 v147, v147
ds_read_u16 v145, v145
ds_read_b128 v[180:183], v251 offset:5120
v_cvt_pkrtz_f16_f32 v149, v150, v151
v_lshrrev_b64 v[148:149], 2, v[148:149]
v_and_b32_sdwa v150, s47, v148 dst_sel:DWORD dst_unused:UNUSED_PAD src0_sel:DWORD src1_sel:WORD_1
v_and_b32_e64 v148, s47, v148
v_exp_f16_sdwa v157, v157 dst_sel:WORD_0 dst_unused:UNUSED_PRESERVE src0_sel:WORD_0
v_mfma_f32_32x32x16_bf16 v[112:127], v[52:55], v[188:191], v[112:127]
ds_read_u16 v150, v150
ds_read_u16 v148, v148
v_fma_mix_f32 v233, v104, v104, v233 op_sel_hi:[1,1,0]
v_exp_f16_sdwa v159, v159 dst_sel:WORD_0 dst_unused:UNUSED_PRESERVE src0_sel:WORD_0
v_fma_mix_f32 v233, v105, v105, v233 op_sel_hi:[1,1,0]
v_and_b32_sdwa v151, s47, v149 dst_sel:DWORD dst_unused:UNUSED_PAD src0_sel:DWORD src1_sel:WORD_1
v_and_b32_e64 v149, s47, v149
v_exp_f16_sdwa v157, v157 dst_sel:WORD_1 dst_unused:UNUSED_PRESERVE src0_sel:WORD_1
v_fma_mix_f32 v233, v106, v106, v233 op_sel_hi:[1,1,0]
v_cvt_pkrtz_f16_f32 v152, v152, v153
v_fma_mix_f32 v233, v107, v107, v233 op_sel_hi:[1,1,0]
v_cvt_pkrtz_f16_f32 v153, v154, v155
v_lshrrev_b64 v[152:153], 2, v[152:153]
ds_read_u16 v151, v151
ds_read_u16 v149, v149
v_and_b32_sdwa v154, s47, v152 dst_sel:DWORD dst_unused:UNUSED_PAD src0_sel:DWORD src1_sel:WORD_1
v_and_b32_e64 v152, s47, v152
v_mfma_f32_32x32x16_bf16 v[128:143], v[188:191], v[76:79], v[128:143]
ds_read_u16 v154, v154
ds_read_u16 v152, v152
v_exp_f16_sdwa v159, v159 dst_sel:WORD_1 dst_unused:UNUSED_PRESERVE src0_sel:WORD_1
v_and_b32_sdwa v155, s47, v153 dst_sel:DWORD dst_unused:UNUSED_PAD src0_sel:DWORD src1_sel:WORD_1
v_and_b32 v153, s47, v153
v_pk_add_f16 v157, v157, 1.0 op_sel_hi:[1,0]
v_pk_add_f16 v159, v159, 1.0 op_sel_hi:[1,0]
v_rcp_f16_sdwa v157, v157 dst_sel:WORD_0 dst_unused:UNUSED_PRESERVE src0_sel:WORD_0
s_waitcnt lgkmcnt(6)
v_mfma_f32_32x32x16_bf16 v[112:127], v[56:59], v[176:179], v[112:127]
ds_read_b128 v[184:187], v251 offset:6144
ds_read_u16 v155, v155
ds_read_u16 v153, v153
v_rcp_f16_sdwa v159, v159 dst_sel:WORD_0 dst_unused:UNUSED_PRESERVE src0_sel:WORD_0
v_rcp_f16_sdwa v157, v157 dst_sel:WORD_1 dst_unused:UNUSED_PRESERVE src0_sel:WORD_1
v_mfma_f32_32x32x16_bf16 v[128:143], v[176:179], v[80:83], v[128:143]
v_rcp_f16_sdwa v159, v159 dst_sel:WORD_1 dst_unused:UNUSED_PRESERVE src0_sel:WORD_1
v_pk_mul_f16 v156, v156, v157
v_pk_mul_f16 v158, v158, v159
v_fma_mix_f32 v234, v156, v156, v234 op_sel_hi:[1,1,0]
v_mfma_f32_32x32x16_bf16 v[112:127], v[60:63], v[180:183], v[112:127]
ds_read_b128 v[188:191], v251 offset:7168
v_fma_mix_f32 v234, v158, v158, v234 op_sel_hi:[1,1,0]
v_permlane32_swap_b32 v232, v233
v_add_f32_e64 v232, v232, v233
s_setprio 1
ds_write_b32 v248, v232 offset:8448
v_fma_mix_f32 v234, v156, v156, v234 op_sel:[1,1,0] op_sel_hi:[1,1,0]
v_cvt_pkrtz_f16_f32 v160, v160, v161
v_fma_mix_f32 v234, v158, v158, v234 op_sel:[1,1,0] op_sel_hi:[1,1,0]
v_cvt_pkrtz_f16_f32 v161, v162, v163
v_fma_mix_f32 v234, v144, v144, v234 op_sel_hi:[1,1,0]
v_lshrrev_b64 v[160:161], 2, v[160:161]
v_fma_mix_f32 v234, v145, v145, v234 op_sel_hi:[1,1,0]
v_and_b32_sdwa v162, s47, v160 dst_sel:DWORD dst_unused:UNUSED_PAD src0_sel:DWORD src1_sel:WORD_1
v_fma_mix_f32 v234, v146, v146, v234 op_sel_hi:[1,1,0]
v_and_b32_e64 v160, s47, v160
v_fma_mix_f32 v234, v147, v147, v234 op_sel_hi:[1,1,0]
v_cvt_pk_f16_f32 v172, v172, v173
v_cvt_pk_f16_f32 v174, v174, v175
v_mfma_f32_32x32x16_bf16 v[128:143], v[180:183], v[84:87], v[128:143]
ds_read_u16_d16_hi v162, v162
ds_read_u16 v160, v160
v_pk_fma_f16 v173, v172, v172, s48
s_waitcnt lgkmcnt(6)
v_fma_mix_f32 v234, v148, v148, v234 op_sel_hi:[1,1,0]
v_and_b32_sdwa v163, s47, v161 dst_sel:DWORD dst_unused:UNUSED_PAD src0_sel:DWORD src1_sel:WORD_1
v_fma_mix_f32 v234, v149, v149, v234 op_sel_hi:[1,1,0]
v_and_b32 v161, s47, v161
v_pk_fma_f16 v175, v174, v174, s48
v_pk_mul_f16 v173, v172, v173
v_fma_mix_f32 v234, v150, v150, v234 op_sel_hi:[1,1,0]
v_cvt_pkrtz_f16_f32 v164, v164, v165
v_fma_mix_f32 v234, v151, v151, v234 op_sel_hi:[1,1,0]
v_cvt_pkrtz_f16_f32 v165, v166, v167
ds_read_u16_d16_hi v163, v163
ds_read_u16 v161, v161
v_lshrrev_b64 v[164:165], 2, v[164:165]
v_and_b32_sdwa v166, s47, v164 dst_sel:DWORD dst_unused:UNUSED_PAD src0_sel:DWORD src1_sel:WORD_1
v_and_b32_e64 v164, s47, v164
v_pk_mul_f16 v175, v174, v175
v_exp_f16_sdwa v173, v173 dst_sel:WORD_0 dst_unused:UNUSED_PRESERVE src0_sel:WORD_0
v_mfma_f32_32x32x16_bf16 v[112:127], v[64:67], v[184:187], v[112:127]
ds_read_u16_d16_hi v166, v166
ds_read_u16 v164, v164
v_fma_mix_f32 v234, v152, v152, v234 op_sel_hi:[1,1,0]
v_and_b32_sdwa v167, s47, v165 dst_sel:DWORD dst_unused:UNUSED_PAD src0_sel:DWORD src1_sel:WORD_1
s_waitcnt lgkmcnt(6)
v_fma_mix_f32 v234, v153, v153, v234 op_sel_hi:[1,1,0]
v_and_b32 v165, s47, v165
v_exp_f16_sdwa v175, v175 dst_sel:WORD_0 dst_unused:UNUSED_PRESERVE src0_sel:WORD_0
v_fma_mix_f32 v234, v154, v154, v234 op_sel_hi:[1,1,0]
v_cvt_pkrtz_f16_f32 v168, v168, v169
v_fma_mix_f32 v234, v155, v155, v234 op_sel_hi:[1,1,0]
v_cvt_pkrtz_f16_f32 v169, v170, v171
v_lshrrev_b64 v[168:169], 2, v[168:169]
ds_read_u16_d16_hi v167, v167
ds_read_u16 v165, v165
v_and_b32_sdwa v170, s47, v168 dst_sel:DWORD dst_unused:UNUSED_PAD src0_sel:DWORD src1_sel:WORD_1
v_and_b32_e64 v168, s47, v168
v_exp_f16_sdwa v173, v173 dst_sel:WORD_1 dst_unused:UNUSED_PRESERVE src0_sel:WORD_1
v_mfma_f32_32x32x16_bf16 v[128:143], v[184:187], v[88:91], v[128:143]
ds_read_u16_d16_hi v170, v170
ds_read_u16 v168, v168
v_and_b32_sdwa v171, s47, v169 dst_sel:DWORD dst_unused:UNUSED_PAD src0_sel:DWORD src1_sel:WORD_1
v_and_b32_e64 v169, s47, v169
v_exp_f16_sdwa v175, v175 dst_sel:WORD_1 dst_unused:UNUSED_PRESERVE src0_sel:WORD_1
v_pk_add_f16 v173, v173, 1.0 op_sel_hi:[1,0]
v_mfma_f32_32x32x16_bf16 v[112:127], v[68:71], v[188:191], v[112:127]
ds_read_u16_d16_hi v171, v171
ds_read_u16 v169, v169
v_pk_add_f16 v175, v175, 1.0 op_sel_hi:[1,0]
v_rcp_f16_sdwa v173, v173 dst_sel:WORD_0 dst_unused:UNUSED_PRESERVE src0_sel:WORD_0
v_rcp_f16_sdwa v175, v175 dst_sel:WORD_0 dst_unused:UNUSED_PRESERVE src0_sel:WORD_0
v_mfma_f32_32x32x16_bf16 v[128:143], v[188:191], v[92:95], v[128:143]
v_rcp_f16_sdwa v173, v173 dst_sel:WORD_1 dst_unused:UNUSED_PRESERVE src0_sel:WORD_1
v_rcp_f16_sdwa v175, v175 dst_sel:WORD_1 dst_unused:UNUSED_PRESERVE src0_sel:WORD_1
v_pk_mul_f16 v102, v172, v173
v_pk_mul_f16 v103, v174, v175
s_waitcnt lgkmcnt(5)
v_lshl_add_u64 v[96:97], v[160:161], 0, v[162:163]
s_waitcnt lgkmcnt(4)
v_lshl_add_u64 v[100:101], v[164:165], 0, v[166:167]
ds_read_b128 v[176:179], v250
ds_read_b128 v[180:183], v250 offset:1024
ds_read_b128 v[184:187], v250 offset:2048
s_nop 0
v_cvt_pkrtz_f16_f32 v128, v128, v129
v_cvt_pkrtz_f16_f32 v129, v130, v131
v_lshrrev_b64 v[128:129], 2, v[128:129]
v_and_b32_sdwa v130, s47, v128 dst_sel:DWORD dst_unused:UNUSED_PAD src0_sel:DWORD src1_sel:WORD_1
v_and_b32 v128, s47, v128
v_cvt_pk_f16_f32 v140, v140, v141
v_cvt_pk_f16_f32 v142, v142, v143
v_pk_fma_f16 v141, v140, v140, s48
v_and_b32_sdwa v131, s47, v129 dst_sel:DWORD dst_unused:UNUSED_PAD src0_sel:DWORD src1_sel:WORD_1
v_and_b32_e64 v129, s47, v129
v_pk_fma_f16 v143, v142, v142, s48
ds_read_u16_d16_hi v130, v130
ds_read_u16 v128, v128
ds_read_u16_d16_hi v131, v131
ds_read_u16 v129, v129
v_pk_mul_f16 v141, v140, v141
v_cvt_pkrtz_f16_f32 v132, v132, v133
v_cvt_pkrtz_f16_f32 v133, v134, v135
v_lshrrev_b64 v[132:133], 2, v[132:133]
v_and_b32_sdwa v134, s47, v132 dst_sel:DWORD dst_unused:UNUSED_PAD src0_sel:DWORD src1_sel:WORD_1
v_and_b32_e64 v132, s47, v132
v_pk_mul_f16 v143, v142, v143
v_exp_f16_sdwa v141, v141 dst_sel:WORD_0 dst_unused:UNUSED_PRESERVE src0_sel:WORD_0
v_and_b32_sdwa v135, s47, v133 dst_sel:DWORD dst_unused:UNUSED_PAD src0_sel:DWORD src1_sel:WORD_1
v_and_b32 v133, s47, v133
v_exp_f16_sdwa v143, v143 dst_sel:WORD_0 dst_unused:UNUSED_PRESERVE src0_sel:WORD_0
s_waitcnt lgkmcnt(6)
v_lshl_add_u64 v[98:99], v[168:169], 0, v[170:171]
ds_read_u16_d16_hi v134, v134
ds_read_u16 v132, v132
ds_read_u16_d16_hi v135, v135
ds_read_u16 v133, v133
v_cvt_pkrtz_f16_f32 v136, v136, v137
v_cvt_pkrtz_f16_f32 v137, v138, v139
v_lshrrev_b64 v[136:137], 2, v[136:137]
v_and_b32_sdwa v138, s47, v136 dst_sel:DWORD dst_unused:UNUSED_PAD src0_sel:DWORD src1_sel:WORD_1
v_and_b32_e64 v136, s47, v136
v_exp_f16_sdwa v141, v141 dst_sel:WORD_1 dst_unused:UNUSED_PRESERVE src0_sel:WORD_1
v_mfma_f32_32x32x16_f16 v[160:175], v[96:99], v[216:219], 0
ds_read_u16_d16_hi v138, v138
ds_read_u16 v136, v136
v_and_b32_sdwa v139, s47, v137 dst_sel:DWORD dst_unused:UNUSED_PAD src0_sel:DWORD src1_sel:WORD_1
v_and_b32_e64 v137, s47, v137
v_exp_f16_sdwa v143, v143 dst_sel:WORD_1 dst_unused:UNUSED_PRESERVE src0_sel:WORD_1
v_pk_add_f16 v141, v141, 1.0 op_sel_hi:[1,0]
v_mfma_f32_32x32x16_f16 v[160:175], v[100:103], v[220:223], v[160:175]
ds_read_u16_d16_hi v139, v139
ds_read_u16 v137, v137
v_pk_add_f16 v143, v143, 1.0 op_sel_hi:[1,0]
v_permlane16_swap_b32 v96, v100
v_permlane16_swap_b32 v97, v101
v_permlane16_swap_b32 v98, v102
v_permlane16_swap_b32 v99, v103
v_rcp_f16_sdwa v141, v141 dst_sel:WORD_0 dst_unused:UNUSED_PRESERVE src0_sel:WORD_0
v_rcp_f16_sdwa v143, v143 dst_sel:WORD_0 dst_unused:UNUSED_PRESERVE src0_sel:WORD_0
v_rcp_f16_sdwa v141, v141 dst_sel:WORD_1 dst_unused:UNUSED_PRESERVE src0_sel:WORD_1
s_nop 1
v_fmac_f32 v234, v160, v160
v_fmac_f32 v234, v161, v161
v_fmac_f32 v234, v162, v162
ds_read_b128 v[188:191], v250 offset:3072
v_rcp_f16_sdwa v143, v143 dst_sel:WORD_1 dst_unused:UNUSED_PRESERVE src0_sel:WORD_1
v_fmac_f32 v234, v163, v163
v_fmac_f32 v234, v164, v164
v_fmac_f32 v234, v165, v165
v_mfma_f32_32x32x16_bf16 v[144:159], v[176:179], v[72:75], 0
s_waitcnt lgkmcnt(7)
ds_read_b128 v[176:179], v250 offset:4096
v_fmac_f32_e64 v234, v166, v166
v_pk_mul_f16 v110, v140, v141
v_fmac_f32 v234, v167, v167
v_fmac_f32 v234, v168, v168
v_pk_mul_f16 v111, v142, v143
v_fmac_f32_e64 v234, v169, v169
v_lshl_add_u64 v[104:105], v[128:129], 0, v[130:131]
v_fmac_f32_e64 v234, v170, v170
v_cvt_pkrtz_f16_f32 v112, v112, v113
v_cvt_pkrtz_f16_f32 v113, v114, v115
v_lshrrev_b64 v[112:113], 2, v[112:113]
v_and_b32_sdwa v114, s47, v112 dst_sel:DWORD dst_unused:UNUSED_PAD src0_sel:DWORD src1_sel:WORD_1
v_and_b32_e64 v112, s47, v112
v_cvt_pk_f16_f32 v124, v124, v125
v_fmac_f32_e64 v234, v171, v171
v_cvt_pk_f16_f32 v126, v126, v127
v_fmac_f32 v234, v172, v172
v_fmac_f32 v234, v173, v173
v_mfma_f32_32x32x16_bf16 v[144:159], v[180:183], v[76:79], v[144:159]
ds_read_u16 v114, v114
ds_read_u16 v112, v112
ds_read_b128 v[180:183], v250 offset:5120
v_pk_fma_f16 v125, v124, v124, s48
v_fmac_f32_e64 v234, v174, v174
v_and_b32_sdwa v115, s47, v113 dst_sel:DWORD dst_unused:UNUSED_PAD src0_sel:DWORD src1_sel:WORD_1
v_and_b32_e64 v113, s47, v113
v_fmac_f32 v234, v175, v175
v_pk_fma_f16 v127, v126, v126, s48
v_pk_mul_f16 v125, v124, v125
v_pk_mul_f16 v127, v126, v127
s_waitcnt lgkmcnt(6)
v_lshl_add_u64 v[108:109], v[132:133], 0, v[134:135]
v_cvt_pkrtz_f16_f32 v116, v116, v117
ds_read_u16 v115, v115
ds_read_u16 v113, v113
v_cvt_pkrtz_f16_f32 v117, v118, v119
v_lshrrev_b64 v[116:117], 2, v[116:117]
v_and_b32_sdwa v118, s47, v116 dst_sel:DWORD dst_unused:UNUSED_PAD src0_sel:DWORD src1_sel:WORD_1
v_and_b32_e64 v116, s47, v116
v_exp_f16_sdwa v125, v125 dst_sel:WORD_0 dst_unused:UNUSED_PRESERVE src0_sel:WORD_0
v_mfma_f32_32x32x16_bf16 v[144:159], v[184:187], v[80:83], v[144:159]
ds_read_u16 v118, v118
ds_read_u16 v116, v116
ds_read_b128 v[184:187], v250 offset:6144
v_exp_f16_sdwa v127, v127 dst_sel:WORD_0 dst_unused:UNUSED_PRESERVE src0_sel:WORD_0
v_and_b32_sdwa v119, s47, v117 dst_sel:DWORD dst_unused:UNUSED_PAD src0_sel:DWORD src1_sel:WORD_1
v_and_b32 v117, s47, v117
v_exp_f16_sdwa v125, v125 dst_sel:WORD_1 dst_unused:UNUSED_PRESERVE src0_sel:WORD_1
s_waitcnt lgkmcnt(7)
v_lshl_add_u64 v[106:107], v[136:137], 0, v[138:139]
v_cvt_pkrtz_f16_f32 v120, v120, v121
v_cvt_pkrtz_f16_f32 v121, v122, v123
v_lshrrev_b64 v[120:121], 2, v[120:121]
v_and_b32_sdwa v122, s47, v120 dst_sel:DWORD dst_unused:UNUSED_PAD src0_sel:DWORD src1_sel:WORD_1
ds_read_u16 v119, v119
ds_read_u16 v117, v117
v_and_b32_e64 v120, s47, v120
v_mfma_f32_32x32x16_bf16 v[144:159], v[188:191], v[84:87], v[144:159]
ds_read_u16 v122, v122
ds_read_u16 v120, v120
ds_read_b128 v[188:191], v250 offset:7168
s_waitcnt vmcnt(0)
v_exp_f16_sdwa v127, v127 dst_sel:WORD_1 dst_unused:UNUSED_PRESERVE src0_sel:WORD_1
v_and_b32_sdwa v123, s47, v121 dst_sel:DWORD dst_unused:UNUSED_PAD src0_sel:DWORD src1_sel:WORD_1
v_mfma_f32_32x32x16_f16 v[128:143], v[104:107], v[216:219], 0
v_and_b32 v121, s47, v121
v_pk_add_f16 v125, v125, 1.0 op_sel_hi:[1,0]
v_pk_add_f16 v127, v127, 1.0 op_sel_hi:[1,0]
v_rcp_f16_sdwa v125, v125 dst_sel:WORD_0 dst_unused:UNUSED_PRESERVE src0_sel:WORD_0
v_mfma_f32_32x32x16_f16 v[128:143], v[108:111], v[220:223], v[128:143]
ds_read_u16 v123, v123
ds_read_u16 v121, v121
v_permlane16_swap_b32 v104, v108
v_permlane16_swap_b32 v105, v109
v_permlane16_swap_b32 v106, v110
v_permlane16_swap_b32 v107, v111
v_mfma_f32_32x32x16_bf16 v[144:159], v[176:179], v[88:91], v[144:159]
ds_read_b128 v[176:179], v250 offset:8192
v_rcp_f16_sdwa v127, v127 dst_sel:WORD_0 dst_unused:UNUSED_PRESERVE src0_sel:WORD_0
v_rcp_f16_sdwa v125, v125 dst_sel:WORD_1 dst_unused:UNUSED_PRESERVE src0_sel:WORD_1
v_rcp_f16_sdwa v127, v127 dst_sel:WORD_1 dst_unused:UNUSED_PRESERVE src0_sel:WORD_1
s_waitcnt lgkmcnt(8)
v_mfma_f32_32x32x16_bf16 v[144:159], v[180:183], v[92:95], v[144:159]
ds_read_b128 v[180:183], v250 offset:9216
v_fmac_f32 v235, v128, v128
v_pk_mul_f16 v124, v124, v125
v_fmac_f32_e64 v235, v129, v129
v_pk_mul_f16 v126, v126, v127
v_fmac_f32 v235, v130, v130
v_fmac_f32 v235, v131, v131
v_fmac_f32 v235, v132, v132
v_fmac_f32 v235, v133, v133
v_mfma_f32_32x32x16_bf16 v[160:175], v[184:187], v[72:75], 0
ds_read_b128 v[184:187], v250 offset:10240
v_permlane16_swap_b32 v48, v52
v_permlane16_swap_b32 v49, v53
v_permlane16_swap_b32 v50, v54
v_permlane16_swap_b32 v51, v55
v_permlane16_swap_b32 v56, v60
v_permlane16_swap_b32 v57, v61
v_permlane16_swap_b32 v58, v62
v_permlane16_swap_b32 v59, v63
v_permlane16_swap_b32 v64, v68
v_permlane16_swap_b32 v65, v69
v_permlane16_swap_b32 v66, v70
v_permlane16_swap_b32 v67, v71
v_permlane16_swap_b32 v24, v28
v_permlane16_swap_b32 v25, v29
v_permlane16_swap_b32 v26, v30
v_permlane16_swap_b32 v27, v31
v_permlane16_swap_b32 v32, v36
v_permlane16_swap_b32 v33, v37
v_permlane16_swap_b32 v34, v38
v_permlane16_swap_b32 v35, v39
v_permlane16_swap_b32 v40, v44
v_permlane16_swap_b32 v41, v45
v_permlane16_swap_b32 v42, v46
v_permlane16_swap_b32 v43, v47
v_fmac_f32 v235, v134, v134
v_fmac_f32 v235, v135, v135
v_fmac_f32 v235, v136, v136
v_fmac_f32 v235, v137, v137
v_fmac_f32_e64 v235, v138, v138
v_cvt_pkrtz_f16_f32 v144, v144, v145
v_cvt_pkrtz_f16_f32 v145, v146, v147
v_lshrrev_b64 v[144:145], 2, v[144:145]
v_and_b32_sdwa v146, s47, v144 dst_sel:DWORD dst_unused:UNUSED_PAD src0_sel:DWORD src1_sel:WORD_1
v_and_b32_e64 v144, s47, v144
v_cvt_pk_f16_f32 v156, v156, v157
v_fmac_f32_e64 v235, v139, v139
v_cvt_pk_f16_f32 v158, v158, v159
v_fmac_f32_e64 v235, v140, v140
v_fmac_f32 v235, v141, v141
s_waitcnt lgkmcnt(0)
v_mfma_f32_32x32x16_bf16 v[160:175], v[188:191], v[76:79], v[160:175]
ds_read_u16_d16_hi v146, v146
ds_read_u16 v144, v144
ds_read_b128 v[188:191], v250 offset:11264
v_pk_fma_f16 v157, v156, v156, s48
v_fmac_f32_e64 v235, v142, v142
v_and_b32_sdwa v147, s47, v145 dst_sel:DWORD dst_unused:UNUSED_PAD src0_sel:DWORD src1_sel:WORD_1
v_and_b32 v145, s47, v145
v_fmac_f32 v235, v143, v143
v_fma_mix_f32 v235, v124, v124, v235 op_sel_hi:[1,1,0]
v_pk_fma_f16 v159, v158, v158, s48
v_fma_mix_f32 v235, v126, v126, v235 op_sel_hi:[1,1,0]
v_pk_mul_f16 v157, v156, v157
v_fma_mix_f32 v235, v124, v124, v235 op_sel:[1,1,0] op_sel_hi:[1,1,0]
ds_read_u16_d16_hi v147, v147
ds_read_u16 v145, v145
v_fma_mix_f32 v235, v126, v126, v235 op_sel:[1,1,0] op_sel_hi:[1,1,0]
v_cvt_pkrtz_f16_f32 v148, v148, v149
v_fma_mix_f32 v235, v112, v112, v235 op_sel_hi:[1,1,0]
v_cvt_pkrtz_f16_f32 v149, v150, v151
v_fma_mix_f32 v235, v113, v113, v235 op_sel_hi:[1,1,0]
v_lshrrev_b64 v[148:149], 2, v[148:149]
v_fma_mix_f32 v235, v114, v114, v235 op_sel_hi:[1,1,0]
v_and_b32_sdwa v150, s47, v148 dst_sel:DWORD dst_unused:UNUSED_PAD src0_sel:DWORD src1_sel:WORD_1
v_fma_mix_f32 v235, v115, v115, v235 op_sel_hi:[1,1,0]
v_and_b32_e64 v148, s47, v148
v_fma_mix_f32 v235, v116, v116, v235 op_sel_hi:[1,1,0]
v_pk_mul_f16 v159, v158, v159
v_fma_mix_f32 v235, v117, v117, v235 op_sel_hi:[1,1,0]
v_exp_f16_sdwa v157, v157 dst_sel:WORD_0 dst_unused:UNUSED_PRESERVE src0_sel:WORD_0
v_fma_mix_f32 v235, v118, v118, v235 op_sel_hi:[1,1,0]
v_mfma_f32_32x32x16_bf16 v[160:175], v[176:179], v[80:83], v[160:175]
v_fma_mix_f32 v235, v119, v119, v235 op_sel_hi:[1,1,0]
v_and_b32_sdwa v151, s47, v149 dst_sel:DWORD dst_unused:UNUSED_PAD src0_sel:DWORD src1_sel:WORD_1
v_fma_mix_f32 v235, v120, v120, v235 op_sel_hi:[1,1,0]
v_and_b32_e64 v149, s47, v149
v_fma_mix_f32 v235, v121, v121, v235 op_sel_hi:[1,1,0]
v_exp_f16_sdwa v159, v159 dst_sel:WORD_0 dst_unused:UNUSED_PRESERVE src0_sel:WORD_0
v_fma_mix_f32 v235, v122, v122, v235 op_sel_hi:[1,1,0]
ds_read_u16_d16_hi v150, v150
ds_read_u16 v148, v148
ds_read_u16_d16_hi v151, v151
ds_read_u16 v149, v149
v_fma_mix_f32 v235, v123, v123, v235 op_sel_hi:[1,1,0]
v_cvt_pkrtz_f16_f32 v152, v152, v153
s_nop 0
v_permlane32_swap_b32 v234, v235
v_add_f32_e64 v234, v234, v235
v_cvt_pkrtz_f16_f32 v153, v154, v155
v_lshrrev_b64 v[152:153], 2, v[152:153]
v_and_b32_sdwa v154, s47, v152 dst_sel:DWORD dst_unused:UNUSED_PAD src0_sel:DWORD src1_sel:WORD_1
v_and_b32_e64 v152, s47, v152
v_exp_f16_sdwa v157, v157 dst_sel:WORD_1 dst_unused:UNUSED_PRESERVE src0_sel:WORD_1
v_mfma_f32_32x32x16_bf16 v[160:175], v[180:183], v[84:87], v[160:175]
ds_write_b32 v248, v234 offset:8704
s_setprio 3
v_mov_b32_e64 v238, 1
s_waitcnt lgkmcnt(0)
s_nop 9
s_mov_b64 exec, 1
ds_add_rtn_u32 v239, v247, v238 offset:0
s_mov_b64 exec, -1
s_waitcnt lgkmcnt(0)
v_readfirstlane_b32 s43, v239
s_nop 1
s_cmp_lg_u32 s43, 7
s_cbranch_scc1 Lnopub
ds_read_b128 v[128:131], v244
ds_read_b128 v[132:135], v244 offset:16
ds_read_b128 v[136:139], v244 offset:9216
ds_read_b128 v[140:143], v244 offset:9232
ds_read_b128 v[112:115], v244 offset:18432
ds_read_b128 v[116:119], v244 offset:18448
ds_read_b128 v[120:123], v244 offset:27648
ds_read_b128 v[124:127], v244 offset:27664
ds_read_b128 v[216:219], v244 offset:36864
ds_read_b128 v[220:223], v244 offset:36880
s_waitcnt lgkmcnt(7)
v_add_f32 v128, v128, v136
v_add_f32 v129, v129, v137
v_add_f32 v130, v130, v138
v_add_f32 v131, v131, v139
s_waitcnt lgkmcnt(6)
v_add_f32 v132, v132, v140
v_add_f32 v133, v133, v141
v_add_f32 v134, v134, v142
v_add_f32 v135, v135, v143
ds_read_b128 v[136:139], v244 offset:46080
ds_read_b128 v[140:143], v244 offset:46096
s_waitcnt lgkmcnt(7)
v_add_f32 v128, v128, v112
v_add_f32 v129, v129, v113
v_add_f32 v130, v130, v114
v_add_f32 v131, v131, v115
s_waitcnt lgkmcnt(6)
v_add_f32 v132, v132, v116
v_add_f32 v133, v133, v117
v_add_f32 v134, v134, v118
v_add_f32 v135, v135, v119
ds_read_b128 v[112:115], v244 offset:55296
ds_read_b128 v[116:119], v244 offset:55312
s_waitcnt lgkmcnt(7)
v_add_f32 v128, v128, v120
v_add_f32 v129, v129, v121
v_add_f32 v130, v130, v122
v_add_f32 v131, v131, v123
s_waitcnt lgkmcnt(6)
v_add_f32 v132, v132, v124
v_add_f32 v133, v133, v125
v_add_f32 v134, v134, v126
v_add_f32 v135, v135, v127
ds_read_b128 v[120:123], v244 offset:64512
ds_read_b128 v[124:127], v244 offset:64528
s_waitcnt lgkmcnt(7)
v_add_f32 v128, v128, v216
v_add_f32 v129, v129, v217
v_add_f32 v130, v130, v218
v_add_f32 v131, v131, v219
s_waitcnt lgkmcnt(6)
v_add_f32 v132, v132, v220
v_add_f32 v133, v133, v221
v_add_f32 v134, v134, v222
v_add_f32 v135, v135, v223
s_waitcnt lgkmcnt(5)
v_add_f32 v128, v128, v136
v_add_f32 v129, v129, v137
v_add_f32 v130, v130, v138
v_add_f32 v131, v131, v139
s_waitcnt lgkmcnt(4)
v_add_f32 v132, v132, v140
v_add_f32 v133, v133, v141
v_add_f32 v134, v134, v142
v_add_f32 v135, v135, v143
s_waitcnt lgkmcnt(3)
v_add_f32 v128, v128, v112
v_add_f32 v129, v129, v113
v_add_f32 v130, v130, v114
v_add_f32 v131, v131, v115
s_waitcnt lgkmcnt(2)
v_add_f32 v132, v132, v116
v_add_f32 v133, v133, v117
v_add_f32 v134, v134, v118
v_add_f32 v135, v135, v119
s_waitcnt lgkmcnt(1)
v_add_f32 v128, v128, v120
v_add_f32 v129, v129, v121
v_add_f32 v130, v130, v122
v_add_f32 v131, v131, v123
s_waitcnt lgkmcnt(0)
v_add_f32 v132, v132, v124
v_add_f32 v133, v133, v125
v_add_f32 v134, v134, v126
v_add_f32 v135, v135, v127
v_min_u32 v216, -2, v128
v_min_u32 v217, -2, v129
v_min_u32 v218, -2, v130
v_min_u32 v219, -2, v131
v_min_u32 v220, -2, v132
v_min_u32 v221, -2, v133
v_min_u32_e64 v222, -2, v134
v_min_u32 v223, -2, v135
s_lshl_b32 s43, s2, 4
buffer_store_dwordx4 v[216:219], v237, s[32:35], s43 offen sc1
buffer_store_dwordx4 v[220:223], v245, s[32:35], s43 offen sc1
ds_write_b32 v247, v238 offset:4
s_waitcnt lgkmcnt(0)
s_nop 1
Lnopub:
s_mov_b32 s77, 0
v_bfe_u32 v244, v250, 8, 2
v_lshlrev_b32 v244, 3, v244
s_cmp_lg_u32 s40, 0
s_cbranch_scc1 Lnorole
v_subrev_u32 v245, 16384, v250
v_lshrrev_b32_e64 v240, 1, v245
v_add_u32 v240, v240, v245
s_cmp_lt_u32 s2, 96
s_cselect_b32 s77, 1, 2
s_cbranch_scc1 Lred
s_and_b32 s44, s2, 7
s_lshl_b32 s44, s44, 11
s_add_u32 s44, s44, 393216
s_waitcnt lgkmcnt(0)
buffer_load_dwordx2 v[128:129], v240, s[32:35], s44 offen sc1
buffer_load_dwordx2 v[130:131], v240, s[32:35], s44 offen offset:8 sc1
buffer_load_dwordx2 v[132:133], v240, s[32:35], s44 offen offset:16 sc1
v_lshrrev_b32_e64 v241, 1, v240
buffer_load_dword v135, v241, s[24:27], 0 offen
buffer_load_dword v137, v241, s[24:27], 0 offen offset:4
buffer_load_dword v139, v241, s[24:27], 0 offen offset:8
s_branch Lnorole
Lred:
s_lshl_b32 s44, s2, 12
s_waitcnt vmcnt(4)
buffer_load_dwordx4 v[128:131], v245, s[32:35], s44 offen sc1
s_waitcnt vmcnt(3)
buffer_load_dwordx4 v[132:135], v245, s[32:35], s44 offen offset:1024 sc1
s_waitcnt vmcnt(2)
buffer_load_dwordx4 v[136:139], v245, s[32:35], s44 offen offset:2048 sc1
buffer_load_dwordx4 v[140:143], v245, s[32:35], s44 offen offset:3072 sc1
Lnorole:
s_setprio 0
ds_read_u16_d16_hi v154, v154
ds_read_u16 v152, v152
v_and_b32_sdwa v155, s47, v153 dst_sel:DWORD dst_unused:UNUSED_PAD src0_sel:DWORD src1_sel:WORD_1
v_and_b32_e64 v153, s47, v153
v_exp_f16_sdwa v159, v159 dst_sel:WORD_1 dst_unused:UNUSED_PRESERVE src0_sel:WORD_1
v_pk_add_f16 v157, v157, 1.0 op_sel_hi:[1,0]
v_mfma_f32_32x32x16_bf16 v[160:175], v[184:187], v[88:91], v[160:175]
ds_read_u16_d16_hi v155, v155
ds_read_u16 v153, v153
v_pk_add_f16 v159, v159, 1.0 op_sel_hi:[1,0]
v_rcp_f16_sdwa v157, v157 dst_sel:WORD_0 dst_unused:UNUSED_PRESERVE src0_sel:WORD_0
v_rcp_f16_sdwa v159, v159 dst_sel:WORD_0 dst_unused:UNUSED_PRESERVE src0_sel:WORD_0
v_mfma_f32_32x32x16_bf16 v[160:175], v[188:191], v[92:95], v[160:175]
ds_read_b128 v[176:179], v250 offset:55296
ds_read_b128 v[180:183], v250 offset:56320
ds_read_b128 v[184:187], v250 offset:57344
v_rcp_f16_sdwa v157, v157 dst_sel:WORD_1 dst_unused:UNUSED_PRESERVE src0_sel:WORD_1
v_rcp_f16_sdwa v159, v159 dst_sel:WORD_1 dst_unused:UNUSED_PRESERVE src0_sel:WORD_1
s_waitcnt lgkmcnt(7)
v_pk_mul_f16 v118, v156, v157
v_pk_mul_f16 v119, v158, v159
v_lshl_add_u64 v[112:113], v[144:145], 0, v[146:147]
v_lshl_add_u64 v[116:117], v[148:149], 0, v[150:151]
ds_read_b128 v[188:191], v250 offset:58368
s_nop 0
v_permlane16_swap_b32 v112, v116
v_cvt_pkrtz_f16_f32 v160, v160, v161
v_cvt_pkrtz_f16_f32 v161, v162, v163
v_lshrrev_b64 v[160:161], 2, v[160:161]
v_and_b32_sdwa v162, s47, v160 dst_sel:DWORD dst_unused:UNUSED_PAD src0_sel:DWORD src1_sel:WORD_1
v_and_b32 v160, s47, v160
v_cvt_pk_f16_f32 v172, v172, v173
v_cvt_pk_f16_f32 v174, v174, v175
v_pk_fma_f16 v173, v172, v172, s48
v_and_b32_sdwa v163, s47, v161 dst_sel:DWORD dst_unused:UNUSED_PAD src0_sel:DWORD src1_sel:WORD_1
v_and_b32_e64 v161, s47, v161
v_pk_fma_f16 v175, v174, v174, s48
ds_read_u16_d16_hi v162, v162
ds_read_u16 v160, v160
ds_read_u16_d16_hi v163, v163
ds_read_u16 v161, v161
v_pk_mul_f16 v173, v172, v173
s_cmp_eq_u32 s77, 0
s_cbranch_scc1 Lpp1
s_call_b64 s[78:79], Lpolln
Lpp1:
v_cvt_pkrtz_f16_f32 v164, v164, v165
v_cvt_pkrtz_f16_f32 v165, v166, v167
v_lshrrev_b64 v[164:165], 2, v[164:165]
v_and_b32_sdwa v166, s47, v164 dst_sel:DWORD dst_unused:UNUSED_PAD src0_sel:DWORD src1_sel:WORD_1
v_and_b32 v164, s47, v164
v_pk_mul_f16 v175, v174, v175
v_exp_f16_sdwa v173, v173 dst_sel:WORD_0 dst_unused:UNUSED_PRESERVE src0_sel:WORD_0
v_and_b32_sdwa v167, s47, v165 dst_sel:DWORD dst_unused:UNUSED_PAD src0_sel:DWORD src1_sel:WORD_1
v_and_b32 v165, s47, v165
v_exp_f16_sdwa v175, v175 dst_sel:WORD_0 dst_unused:UNUSED_PRESERVE src0_sel:WORD_0
s_waitcnt lgkmcnt(6)
v_lshl_add_u64 v[114:115], v[152:153], 0, v[154:155]
ds_read_u16_d16_hi v166, v166
ds_read_u16 v164, v164
ds_read_u16_d16_hi v167, v167
ds_read_u16 v165, v165
v_cvt_pkrtz_f16_f32 v168, v168, v169
v_cvt_pkrtz_f16_f32 v169, v170, v171
v_lshrrev_b64 v[168:169], 2, v[168:169]
v_and_b32_sdwa v170, s47, v168 dst_sel:DWORD dst_unused:UNUSED_PAD src0_sel:DWORD src1_sel:WORD_1
v_and_b32_e64 v168, s47, v168
v_exp_f16_sdwa v173, v173 dst_sel:WORD_1 dst_unused:UNUSED_PRESERVE src0_sel:WORD_1
v_mfma_f32_32x32x16_bf16 v[144:159], v[176:179], v[72:75], 0
ds_read_u16_d16_hi v170, v170
ds_read_u16 v168, v168
ds_read_b128 v[176:179], v250 offset:59392
v_permlane16_swap_b32 v113, v117
v_permlane16_swap_b32 v114, v118
v_permlane16_swap_b32 v115, v119
s_cmp_eq_u32 s77, 0
s_cbranch_scc1 Lpp2
s_nop 5
s_call_b64 s[78:79], Lpolln
Lpp2:
v_and_b32_sdwa v171, s47, v169 dst_sel:DWORD dst_unused:UNUSED_PAD src0_sel:DWORD src1_sel:WORD_1
v_and_b32_e64 v169, s47, v169
v_exp_f16_sdwa v175, v175 dst_sel:WORD_1 dst_unused:UNUSED_PRESERVE src0_sel:WORD_1
v_mfma_f32_32x32x16_bf16 v[144:159], v[180:183], v[76:79], v[144:159]
ds_read_u16_d16_hi v171, v171
ds_read_u16 v169, v169
s_waitcnt lgkmcnt(10)
ds_read_b128 v[180:183], v250 offset:60416
v_pk_add_f16 v173, v173, 1.0 op_sel_hi:[1,0]
v_pk_add_f16 v175, v175, 1.0 op_sel_hi:[1,0]
v_rcp_f16_sdwa v173, v173 dst_sel:WORD_0 dst_unused:UNUSED_PRESERVE src0_sel:WORD_0
v_mfma_f32_32x32x16_bf16 v[144:159], v[184:187], v[80:83], v[144:159]
v_rcp_f16_sdwa v175, v175 dst_sel:WORD_0 dst_unused:UNUSED_PRESERVE src0_sel:WORD_0
v_rcp_f16_sdwa v173, v173 dst_sel:WORD_1 dst_unused:UNUSED_PRESERVE src0_sel:WORD_1
v_rcp_f16_sdwa v175, v175 dst_sel:WORD_1 dst_unused:UNUSED_PRESERVE src0_sel:WORD_1
v_mfma_f32_32x32x16_bf16 v[144:159], v[188:191], v[84:87], v[144:159]
v_pk_mul_f16 v222, v172, v173
v_pk_mul_f16 v223, v174, v175
s_waitcnt lgkmcnt(8)
v_lshl_add_u64 v[216:217], v[160:161], 0, v[162:163]
s_waitcnt lgkmcnt(6)
v_lshl_add_u64 v[220:221], v[164:165], 0, v[166:167]
s_waitcnt lgkmcnt(3)
v_mfma_f32_32x32x16_bf16 v[144:159], v[176:179], v[88:91], v[144:159]
s_cmp_eq_u32 s77, 0
s_cbranch_scc1 Lpp3
s_nop 11
s_call_b64 s[78:79], Lpolln
Lpp3:
s_waitcnt lgkmcnt(0)
v_mfma_f32_32x32x16_bf16 v[144:159], v[180:183], v[92:95], v[144:159]
s_mul_i32 s43, s40, 96
buffer_load_dwordx2 v[176:177], v244, s[28:31], s43 offen
buffer_load_dwordx2 v[178:179], v244, s[28:31], s43 offen offset:32
buffer_load_dwordx2 v[180:181], v244, s[28:31], s43 offen offset:64
v_mov_b32 v249, 0
s_branch Law6
Lax6:
s_sleep 2
Law6:
ds_read_b32 v249, v247 offset:4
s_sub_u32 s76, s76, 1
s_cselect_b32 s44, 1, 0
s_cselect_b32 s76, 0, s76
s_waitcnt lgkmcnt(0)
v_readfirstlane_b32 s43, v249
s_nop 1
s_max_u32 s43, s43, s44
s_cmp_lt_u32 s43, 1
s_cbranch_scc1 Lax6
s_add_u32 m0, s72, 5120
s_add_u32 s43, s82, 3200
buffer_load_dwordx4 v246, s[16:19], s43 offen lds
s_add_u32 m0, s72, 8192
s_add_u32 s43, s82, 6272
buffer_load_dwordx4 v246, s[16:19], s43 offen lds
v_lshl_add_u64 v[218:219], v[168:169], 0, v[170:171]
v_cvt_pkrtz_f16_f32 v144, v144, v145
v_cvt_pkrtz_f16_f32 v145, v146, v147
v_lshrrev_b64 v[144:145], 2, v[144:145]
v_and_b32_sdwa v146, s47, v144 dst_sel:DWORD dst_unused:UNUSED_PAD src0_sel:DWORD src1_sel:WORD_1
v_and_b32_e64 v144, s47, v144
v_cvt_pk_f16_f32 v156, v156, v157
v_cvt_pk_f16_f32 v158, v158, v159
v_pk_fma_f16 v157, v156, v156, s48
v_and_b32_sdwa v147, s47, v145 dst_sel:DWORD dst_unused:UNUSED_PAD src0_sel:DWORD src1_sel:WORD_1
v_and_b32 v145, s47, v145
v_pk_fma_f16 v159, v158, v158, s48
ds_read_u16_d16_hi v146, v146
ds_read_u16 v144, v144
s_cmp_eq_u32 s77, 0
s_cbranch_scc1 Lpp4
s_call_b64 s[78:79], Lpolln
Lpp4:
ds_read_u16_d16_hi v147, v147
ds_read_u16 v145, v145
v_pk_mul_f16 v157, v156, v157
v_cvt_pkrtz_f16_f32 v148, v148, v149
v_cvt_pkrtz_f16_f32 v149, v150, v151
v_lshrrev_b64 v[148:149], 2, v[148:149]
v_and_b32_sdwa v150, s47, v148 dst_sel:DWORD dst_unused:UNUSED_PAD src0_sel:DWORD src1_sel:WORD_1
v_and_b32_e64 v148, s47, v148
v_pk_mul_f16 v159, v158, v159
v_exp_f16_sdwa v157, v157 dst_sel:WORD_0 dst_unused:UNUSED_PRESERVE src0_sel:WORD_0
v_and_b32_sdwa v151, s47, v149 dst_sel:DWORD dst_unused:UNUSED_PAD src0_sel:DWORD src1_sel:WORD_1
v_and_b32_e64 v149, s47, v149
v_exp_f16_sdwa v159, v159 dst_sel:WORD_0 dst_unused:UNUSED_PRESERVE src0_sel:WORD_0
v_cvt_pkrtz_f16_f32 v152, v152, v153
ds_read_u16_d16_hi v150, v150
ds_read_u16 v148, v148
ds_read_u16_d16_hi v151, v151
ds_read_u16 v149, v149
s_cmp_eq_u32 s77, 0
s_cbranch_scc1 Lpp5
s_call_b64 s[78:79], Lpolln
Lpp5:
s_setprio 3
v_cvt_pkrtz_f16_f32 v153, v154, v155
v_lshrrev_b64 v[152:153], 2, v[152:153]
v_and_b32_sdwa v154, s47, v152 dst_sel:DWORD dst_unused:UNUSED_PAD src0_sel:DWORD src1_sel:WORD_1
v_and_b32_e64 v152, s47, v152
v_exp_f16_sdwa v157, v157 dst_sel:WORD_1 dst_unused:UNUSED_PRESERVE src0_sel:WORD_1
v_permlane16_swap_b32 v216, v220
v_permlane16_swap_b32 v217, v221
v_permlane16_swap_b32 v218, v222
v_permlane16_swap_b32 v219, v223
v_and_b32_sdwa v155, s47, v153 dst_sel:DWORD dst_unused:UNUSED_PAD src0_sel:DWORD src1_sel:WORD_1
ds_read_u16_d16_hi v154, v154
ds_read_u16 v152, v152
v_and_b32_e64 v153, s47, v153
v_exp_f16_sdwa v159, v159 dst_sel:WORD_1 dst_unused:UNUSED_PRESERVE src0_sel:WORD_1
v_pk_add_f16 v157, v157, 1.0 op_sel_hi:[1,0]
v_pk_add_f16 v159, v159, 1.0 op_sel_hi:[1,0]
v_rcp_f16_sdwa v157, v157 dst_sel:WORD_0 dst_unused:UNUSED_PRESERVE src0_sel:WORD_0
v_rcp_f16_sdwa v159, v159 dst_sel:WORD_0 dst_unused:UNUSED_PRESERVE src0_sel:WORD_0
v_rcp_f16_sdwa v157, v157 dst_sel:WORD_1 dst_unused:UNUSED_PRESERVE src0_sel:WORD_1
ds_read_u16_d16_hi v155, v155
ds_read_u16 v153, v153
v_bfe_u32 v190, v250, 4, 6
v_lshl_add_u32 v186, v190, 4, s72
s_mul_i32 s43, s40, 3
s_add_u32 s43, s43, 0
s_and_b32 s44, s43, 1
s_mul_i32 s44, s44, 3064
s_mul_i32 s43, s43, 3072
s_sub_u32 s43, s43, s44
s_add_u32 s43, s43, 90112
v_lshl_add_u32 v173, v190, 4, s43
s_mul_i32 s43, s40, 3
s_add_u32 s43, s43, 1
s_and_b32 s44, s43, 1
s_mul_i32 s44, s44, 3064
s_mul_i32 s43, s43, 3072
s_sub_u32 s43, s43, s44
s_add_u32 s43, s43, 90112
v_lshl_add_u32 v174, v190, 4, s43
s_mul_i32 s43, s40, 3
s_add_u32 s43, s43, 2
s_and_b32 s44, s43, 1
s_mul_i32 s44, s44, 3064
s_mul_i32 s43, s43, 3072
s_sub_u32 s43, s43, s44
s_add_u32 s43, s43, 90112
v_lshl_add_u32 v175, v190, 4, s43
v_lshl_add_u32 v187, v244, 2, s72
v_and_b32_e64 v189, 3, v190
v_bfe_u32 v191, v190, 2, 1
v_lshl_add_u32 v189, v191, 3, v189
v_bfe_u32 v191, v190, 3, 1
v_lshl_add_u32 v189, v191, 2, v189
v_bfe_u32 v191, v190, 4, 1
v_lshl_add_u32 v189, v191, 6, v189
v_bfe_u32 v191, v190, 5, 1
v_lshl_add_u32 v189, v191, 5, v189
v_lshlrev_b32_e64 v189, 4, v189
v_add_u32 v248, 16384, v189
v_add_u32 v249, 53248, v189
v_min_u32 v189, 11, v190
s_mul_i32 s43, s40, 12
v_add_u32 v189, s43, v189
v_cmp_gt_u32 vcc, 64, v189
v_lshlrev_b32_e64 v189, 2, v189
v_add_u32 v172, 93312, v189
v_add_u32 v191, 16128, v189
v_add_u32 v189, 7680, v189
v_cndmask_b32 v189, v189, v191, vcc
v_add_u32 v188, s72, v244
v_lshrrev_b32_e64 v191, 3, v190
v_mul_u32_u24 v191, 9120, v191
v_mul_u32_u24 v190, 12, v190
v_add_u32 v191, v191, v190
v_add_u32 v191, 93184, v191
ds_read_b64_tr_b16 v[72:73], v186
ds_read_b64_tr_b16 v[74:75], v186 offset:8
ds_read_b64_tr_b16 v[84:85], v186 offset:3072
s_waitcnt lgkmcnt(6)
ds_read_b64_tr_b16 v[86:87], v186 offset:3080
ds_read_b64_tr_b16 v[160:161], v186 offset:6144
ds_read_b64_tr_b16 v[162:163], v186 offset:6152
s_cmp_eq_u32 s77, 0
s_cbranch_scc1 Lpp6
s_call_b64 s[78:79], Lpolln
Lpp6:
ds_read_b64_tr_b16 v[76:77], v186 offset:1024
ds_read_b64_tr_b16 v[78:79], v186 offset:1032
ds_read_b64_tr_b16 v[88:89], v186 offset:4096
ds_read_b64_tr_b16 v[90:91], v186 offset:4104
ds_read_b64_tr_b16 v[164:165], v186 offset:7168
ds_read_b64_tr_b16 v[166:167], v186 offset:7176
v_rcp_f16_sdwa v159, v159 dst_sel:WORD_1 dst_unused:UNUSED_PRESERVE src0_sel:WORD_1
v_pk_mul_f16 v238, v156, v157
v_pk_mul_f16 v239, v158, v159
v_lshl_add_u64 v[232:233], v[144:145], 0, v[146:147]
v_lshl_add_u64 v[236:237], v[148:149], 0, v[150:151]
s_waitcnt lgkmcnt(12)
ds_read_b64_tr_b16 v[80:81], v186 offset:2048
ds_read_b64_tr_b16 v[82:83], v186 offset:2056
s_waitcnt vmcnt(4) lgkmcnt(13)
v_mfma_f32_16x16x16_bf16 v[120:123], v[72:73], v[176:177], 0
v_lshlrev_b32 v182, 16, v72
v_and_b32 v183, 4294901760, v72
s_waitcnt lgkmcnt(12)
v_mfma_f32_16x16x16_bf16 v[124:127], v[74:75], v[176:177], 0
v_cvt_pk_f16_f32 v72, v182, v183
v_lshlrev_b32 v184, 16, v73
s_waitcnt vmcnt(3) lgkmcnt(11)
v_mfma_f32_16x16x16_bf16 v[120:123], v[84:85], v[178:179], v[120:123]
v_and_b32 v185, 4294901760, v73
v_cvt_pk_f16_f32 v73, v184, v185
s_waitcnt lgkmcnt(10)
v_mfma_f32_16x16x16_bf16 v[124:127], v[86:87], v[178:179], v[124:127]
v_lshlrev_b32_e64 v182, 16, v74
v_and_b32 v183, 4294901760, v74
s_waitcnt vmcnt(2) lgkmcnt(8)
v_mfma_f32_16x16x16_bf16 v[120:123], v[160:161], v[180:181], v[120:123]
v_cvt_pk_f16_f32 v74, v182, v183
v_lshlrev_b32 v184, 16, v75
v_mfma_f32_16x16x16_bf16 v[124:127], v[162:163], v[180:181], v[124:127]
s_setprio 2
s_cmp_eq_u32 s77, 0
s_cbranch_scc1 Lpp7
s_nop 6
s_call_b64 s[78:79], Lpolln
Lpp7:
v_and_b32 v185, 4294901760, v75
v_cvt_pk_f16_f32 v75, v184, v185
v_lshlrev_b32_e64 v182, 16, v84
v_and_b32 v183, 4294901760, v84
v_lshlrev_b32 v184, 16, v85
v_and_b32 v185, 4294901760, v85
v_lshl_add_u64 v[234:235], v[152:153], 0, v[154:155]
v_permlane16_swap_b32 v232, v236
s_mov_b32 exec_lo, 65537
s_mov_b32 exec_hi, 65537
ds_write_b128 v187, v[120:123] offset:3200
ds_write_b128 v187, v[124:127] offset:3216
s_mov_b64 exec, -1
v_cvt_pk_f16_f32 v84, v182, v183
v_cvt_pk_f16_f32 v85, v184, v185
v_lshlrev_b32 v182, 16, v86
v_and_b32 v183, 4294901760, v86
v_cvt_pk_f16_f32 v86, v182, v183
v_lshlrev_b32_e64 v184, 16, v87
v_and_b32 v185, 4294901760, v87
v_cvt_pk_f16_f32 v87, v184, v185
v_lshlrev_b32_e64 v182, 16, v160
v_and_b32 v183, 4294901760, v160
v_cvt_pk_f16_f32 v160, v182, v183
v_lshlrev_b32_e64 v184, 16, v161
v_and_b32 v185, 4294901760, v161
v_cvt_pk_f16_f32 v161, v184, v185
v_lshlrev_b32_e64 v182, 16, v162
v_and_b32 v183, 4294901760, v162
v_cvt_pk_f16_f32 v162, v182, v183
s_cmp_eq_u32 s77, 0
s_cbranch_scc1 Lpp8
s_call_b64 s[78:79], Lpolln
Lpp8:
v_lshlrev_b32 v184, 16, v163
v_and_b32 v185, 4294901760, v163
v_cvt_pk_f16_f32 v163, v184, v185
s_waitcnt lgkmcnt(9)
v_mfma_f32_16x16x16_bf16 v[120:123], v[76:77], v[176:177], 0
v_lshlrev_b32_e64 v182, 16, v76
v_and_b32 v183, 4294901760, v76
s_waitcnt lgkmcnt(8)
v_mfma_f32_16x16x16_bf16 v[124:127], v[78:79], v[176:177], 0
v_cvt_pk_f16_f32 v76, v182, v183
v_lshlrev_b32 v184, 16, v77
s_waitcnt lgkmcnt(7)
v_mfma_f32_16x16x16_bf16 v[120:123], v[88:89], v[178:179], v[120:123]
v_and_b32 v185, 4294901760, v77
v_cvt_pk_f16_f32 v77, v184, v185
s_waitcnt lgkmcnt(6)
v_mfma_f32_16x16x16_bf16 v[124:127], v[90:91], v[178:179], v[124:127]
v_lshlrev_b32_e64 v182, 16, v78
v_and_b32 v183, 4294901760, v78
s_waitcnt lgkmcnt(5)
v_mfma_f32_16x16x16_bf16 v[120:123], v[164:165], v[180:181], v[120:123]
v_cvt_pk_f16_f32 v78, v182, v183
v_permlane16_swap_b32 v233, v237
s_waitcnt lgkmcnt(4)
v_mfma_f32_16x16x16_bf16 v[124:127], v[166:167], v[180:181], v[124:127]
s_setprio 1
v_permlane16_swap_b32 v234, v238
v_permlane16_swap_b32 v235, v239
v_lshlrev_b32 v184, 16, v79
v_and_b32 v185, 4294901760, v79
v_cvt_pk_f16_f32 v79, v184, v185
v_lshlrev_b32 v182, 16, v88
v_and_b32 v183, 4294901760, v88
v_cvt_pk_f16_f32 v88, v182, v183
s_nop 0
s_mov_b32 exec_lo, 65537
s_mov_b32 exec_hi, 65537
ds_write_b128 v187, v[120:123] offset:3328
ds_write_b128 v187, v[124:127] offset:3344
s_mov_b64 exec, -1
v_lshlrev_b32 v184, 16, v89
v_and_b32 v185, 4294901760, v89
v_cvt_pk_f16_f32 v89, v184, v185
s_cmp_eq_u32 s77, 0
s_cbranch_scc1 Lpp9
s_call_b64 s[78:79], Lpolln
Lpp9:
v_lshlrev_b32_e64 v182, 16, v90
v_and_b32 v183, 4294901760, v90
v_cvt_pk_f16_f32 v90, v182, v183
s_waitcnt vmcnt(0)
ds_read_b64_tr_b16 v[92:93], v186 offset:5120
ds_read_b64_tr_b16 v[94:95], v186 offset:5128
ds_read_b64_tr_b16 v[168:169], v186 offset:8192
ds_read_b64_tr_b16 v[170:171], v186 offset:8200
v_lshlrev_b32_e64 v184, 16, v91
v_and_b32 v185, 4294901760, v91
v_cvt_pk_f16_f32 v91, v184, v185
v_lshlrev_b32_e64 v182, 16, v164
v_and_b32 v183, 4294901760, v164
v_cvt_pk_f16_f32 v164, v182, v183
v_lshlrev_b32_e64 v184, 16, v165
v_and_b32 v185, 4294901760, v165
v_cvt_pk_f16_f32 v165, v184, v185
v_lshlrev_b32_e64 v182, 16, v166
v_and_b32 v183, 4294901760, v166
v_cvt_pk_f16_f32 v166, v182, v183
v_lshlrev_b32 v184, 16, v167
v_and_b32 v185, 4294901760, v167
v_cvt_pk_f16_f32 v167, v184, v185
s_waitcnt lgkmcnt(9)
v_mfma_f32_16x16x16_bf16 v[120:123], v[80:81], v[176:177], 0
v_lshlrev_b32 v182, 16, v80
v_and_b32 v183, 4294901760, v80
s_waitcnt lgkmcnt(8)
v_mfma_f32_16x16x16_bf16 v[124:127], v[82:83], v[176:177], 0
v_cvt_pk_f16_f32 v80, v182, v183
v_lshlrev_b32 v184, 16, v81
s_waitcnt lgkmcnt(3)
v_mfma_f32_16x16x16_bf16 v[120:123], v[92:93], v[178:179], v[120:123]
v_and_b32 v185, 4294901760, v81
v_cvt_pk_f16_f32 v81, v184, v185
s_waitcnt lgkmcnt(1)
v_mfma_f32_16x16x16_bf16 v[124:127], v[94:95], v[178:179], v[124:127]
v_lshlrev_b32 v182, 16, v82
v_and_b32 v183, 4294901760, v82
v_mfma_f32_16x16x16_bf16 v[120:123], v[168:169], v[180:181], v[120:123]
v_cvt_pk_f16_f32 v82, v182, v183
v_lshlrev_b32_e64 v184, 16, v83
s_waitcnt lgkmcnt(0)
v_mfma_f32_16x16x16_bf16 v[124:127], v[170:171], v[180:181], v[124:127]
s_cmp_eq_u32 s77, 0
s_cbranch_scc1 Lpp10
s_nop 7
s_call_b64 s[78:79], Lpolln
Lpp10:
s_setprio 0
v_and_b32 v185, 4294901760, v83
v_cvt_pk_f16_f32 v83, v184, v185
v_lshlrev_b32_e64 v182, 16, v92
v_and_b32 v183, 4294901760, v92
v_cvt_pk_f16_f32 v92, v182, v183
v_lshlrev_b32_e64 v184, 16, v93
v_and_b32 v185, 4294901760, v93
v_cvt_pk_f16_f32 v93, v184, v185
s_mov_b32 exec_lo, 65537
s_mov_b32 exec_hi, 65537
ds_write_b128 v187, v[120:123] offset:3456
ds_write_b128 v187, v[124:127] offset:3472
s_mov_b64 exec, -1
ds_read_b128 v[120:123], v248
ds_read_b128 v[124:127], v248 offset:2048
v_lshlrev_b32 v182, 16, v94
v_and_b32 v183, 4294901760, v94
v_cvt_pk_f16_f32 v94, v182, v183
v_lshlrev_b32_e64 v184, 16, v95
v_and_b32 v185, 4294901760, v95
v_cvt_pk_f16_f32 v95, v184, v185
s_cmp_eq_u32 s77, 0
s_cbranch_scc1 Lpp11
s_call_b64 s[78:79], Lpolln
Lpp11:
v_lshlrev_b32 v182, 16, v168
v_and_b32 v183, 4294901760, v168
v_cvt_pk_f16_f32 v168, v182, v183
v_lshlrev_b32_e64 v184, 16, v169
v_and_b32 v185, 4294901760, v169
v_cvt_pk_f16_f32 v169, v184, v185
v_lshlrev_b32_e64 v182, 16, v170
v_and_b32 v183, 4294901760, v170
v_cvt_pk_f16_f32 v170, v182, v183
v_lshlrev_b32_e64 v184, 16, v171
v_and_b32 v185, 4294901760, v171
v_cvt_pk_f16_f32 v171, v184, v185
s_cmp_eq_u32 s77, 0
s_cbranch_scc1 Lpp12
s_call_b64 s[78:79], Lpolln
Lpp12:
s_waitcnt lgkmcnt(0)
s_barrier
s_setprio 2
ds_read_b32 v176, v172
ds_read_b32 v177, v172 offset:9216
ds_read_b32 v178, v172 offset:18432
ds_read_b32 v179, v172 offset:27648
ds_read_b32 v180, v172 offset:36864
ds_read_b32 v181, v172 offset:46080
ds_read_b32 v182, v172 offset:55296
ds_read_b32 v183, v172 offset:64512
v_mfma_f32_16x16x32_bf16 v[144:147], v[120:123], v[48:51], 0
s_cmp_eq_u32 s77, 0
s_cbranch_scc1 Lpp13
s_nop 7
s_call_b64 s[78:79], Lpolln
Lpp13:
v_mfma_f32_16x16x32_bf16 v[148:151], v[120:123], v[52:55], 0
v_mfma_f32_16x16x32_bf16 v[152:155], v[120:123], v[24:27], 0
ds_read_b128 v[120:123], v248 offset:4096
v_mfma_f32_16x16x32_bf16 v[144:147], v[124:127], v[56:59], v[144:147]
s_waitcnt lgkmcnt(7)
v_add_f32 v176, v176, v177
v_mfma_f32_16x16x32_bf16 v[148:151], v[124:127], v[60:63], v[148:151]
s_waitcnt lgkmcnt(6)
v_add_f32 v176, v176, v178
s_waitcnt lgkmcnt(5)
v_add_f32 v176, v176, v179
s_cmp_eq_u32 s77, 0
s_cbranch_scc1 Lpp14
s_nop 3
s_call_b64 s[78:79], Lpolln
Lpp14:
s_waitcnt lgkmcnt(4)
v_add_f32 v176, v176, v180
s_waitcnt lgkmcnt(3)
v_add_f32 v176, v176, v181
s_waitcnt lgkmcnt(2)
v_add_f32 v176, v176, v182
s_waitcnt lgkmcnt(1)
v_add_f32 v176, v176, v183
ds_write_b32 v189, v176
v_mfma_f32_16x16x32_bf16 v[152:155], v[124:127], v[32:35], v[152:155]
ds_read_b128 v[124:127], v248 offset:256
s_waitcnt lgkmcnt(2)
v_mfma_f32_16x16x32_bf16 v[144:147], v[120:123], v[64:67], v[144:147]
v_mfma_f32_16x16x32_bf16 v[148:151], v[120:123], v[68:71], v[148:151]
s_cmp_eq_u32 s77, 0
s_cbranch_scc1 Lpp15
s_nop 7
s_call_b64 s[78:79], Lpolln
Lpp15:
v_mfma_f32_16x16x32_bf16 v[152:155], v[120:123], v[40:43], v[152:155]
ds_read_b128 v[120:123], v248 offset:2304
s_nop 2
v_cvt_pk_f16_f32 v144, v144, v145
v_cvt_pk_f16_f32 v146, v146, v147
v_pk_fma_f16 v145, v144, v144, s48
v_pk_fma_f16 v147, v146, v146, s48
v_cvt_pkrtz_f16_f32 v148, v148, v149
v_cvt_pkrtz_f16_f32 v149, v150, v151
v_lshrrev_b64 v[148:149], 2, v[148:149]
v_and_b32_sdwa v150, s47, v148 dst_sel:DWORD dst_unused:UNUSED_PAD src0_sel:DWORD src1_sel:WORD_1
v_and_b32 v148, s47, v148
s_waitcnt lgkmcnt(1)
v_mfma_f32_16x16x32_bf16 v[156:159], v[124:127], v[48:51], 0
ds_read_u16_d16_hi v150, v150
ds_read_u16 v148, v148
v_mfma_f32_16x16x32_bf16 v[176:179], v[124:127], v[52:55], 0
s_cmp_eq_u32 s77, 0
s_cbranch_scc1 Lpp16
s_nop 7
s_call_b64 s[78:79], Lpolln
Lpp16:
v_and_b32_sdwa v151, s47, v149 dst_sel:DWORD dst_unused:UNUSED_PAD src0_sel:DWORD src1_sel:WORD_1
v_and_b32 v149, s47, v149
v_mfma_f32_16x16x32_bf16 v[180:183], v[124:127], v[24:27], 0
ds_read_b128 v[124:127], v248 offset:4352
ds_read_u16_d16_hi v151, v151
s_waitcnt lgkmcnt(4)
v_mfma_f32_16x16x32_bf16 v[156:159], v[120:123], v[56:59], v[156:159]
ds_read_u16 v149, v149
v_pk_mul_f16 v145, v144, v145
v_mfma_f32_16x16x32_bf16 v[176:179], v[120:123], v[60:63], v[176:179]
v_pk_mul_f16 v147, v146, v147
v_cvt_pkrtz_f16_f32 v152, v152, v153
v_cvt_pkrtz_f16_f32 v153, v154, v155
v_lshrrev_b64 v[152:153], 2, v[152:153]
v_and_b32_sdwa v154, s47, v152 dst_sel:DWORD dst_unused:UNUSED_PAD src0_sel:DWORD src1_sel:WORD_1
v_and_b32_e64 v152, s47, v152
v_exp_f16_sdwa v145, v145 dst_sel:WORD_0 dst_unused:UNUSED_PRESERVE src0_sel:WORD_0
v_mfma_f32_16x16x32_bf16 v[180:183], v[120:123], v[32:35], v[180:183]
ds_read_u16_d16_hi v154, v154
ds_read_u16 v152, v152
s_cmp_eq_u32 s77, 0
s_cbranch_scc1 Lpp17
s_nop 5
s_call_b64 s[78:79], Lpolln
Lpp17:
v_exp_f16_sdwa v147, v147 dst_sel:WORD_0 dst_unused:UNUSED_PRESERVE src0_sel:WORD_0
v_and_b32_sdwa v155, s47, v153 dst_sel:DWORD dst_unused:UNUSED_PAD src0_sel:DWORD src1_sel:WORD_1
v_and_b32 v153, s47, v153
v_exp_f16_sdwa v145, v145 dst_sel:WORD_1 dst_unused:UNUSED_PRESERVE src0_sel:WORD_1
s_waitcnt lgkmcnt(4)
v_mfma_f32_16x16x32_bf16 v[156:159], v[124:127], v[64:67], v[156:159]
ds_read_u16_d16_hi v155, v155
ds_read_u16 v153, v153
v_mfma_f32_16x16x32_bf16 v[176:179], v[124:127], v[68:71], v[176:179]
v_exp_f16_sdwa v147, v147 dst_sel:WORD_1 dst_unused:UNUSED_PRESERVE src0_sel:WORD_1
v_mfma_f32_16x16x32_bf16 v[180:183], v[124:127], v[40:43], v[180:183]
v_pk_add_f16 v145, v145, 1.0 op_sel_hi:[1,0]
v_pk_add_f16 v147, v147, 1.0 op_sel_hi:[1,0]
s_cmp_eq_u32 s77, 0
s_cbranch_scc1 Lpp18
s_nop 5
s_call_b64 s[78:79], Lpolln
Lpp18:
v_rcp_f16_sdwa v145, v145 dst_sel:WORD_0 dst_unused:UNUSED_PRESERVE src0_sel:WORD_0
v_rcp_f16_sdwa v147, v147 dst_sel:WORD_0 dst_unused:UNUSED_PRESERVE src0_sel:WORD_0
v_cvt_pkrtz_f16_f32 v156, v156, v157
v_cvt_pkrtz_f16_f32 v157, v158, v159
v_lshrrev_b64 v[156:157], 2, v[156:157]
v_and_b32_sdwa v158, s47, v156 dst_sel:DWORD dst_unused:UNUSED_PAD src0_sel:DWORD src1_sel:WORD_1
v_and_b32_e64 v156, s47, v156
v_rcp_f16_sdwa v145, v145 dst_sel:WORD_1 dst_unused:UNUSED_PRESERVE src0_sel:WORD_1
v_and_b32_sdwa v159, s47, v157 dst_sel:DWORD dst_unused:UNUSED_PAD src0_sel:DWORD src1_sel:WORD_1
v_and_b32_e64 v157, s47, v157
v_rcp_f16_sdwa v147, v147 dst_sel:WORD_1 dst_unused:UNUSED_PRESERVE src0_sel:WORD_1
v_cvt_pkrtz_f16_f32 v176, v176, v177
v_cvt_pkrtz_f16_f32 v177, v178, v179
ds_read_u16_d16_hi v158, v158
ds_read_u16 v156, v156
ds_read_u16_d16_hi v159, v159
ds_read_u16 v157, v157
v_lshrrev_b64 v[176:177], 2, v[176:177]
v_and_b32_sdwa v178, s47, v176 dst_sel:DWORD dst_unused:UNUSED_PAD src0_sel:DWORD src1_sel:WORD_1
v_and_b32_e64 v176, s47, v176
v_pk_mul_f16 v144, v144, v145
v_and_b32_sdwa v179, s47, v177 dst_sel:DWORD dst_unused:UNUSED_PAD src0_sel:DWORD src1_sel:WORD_1
v_and_b32_e64 v177, s47, v177
v_pk_mul_f16 v145, v146, v147
s_waitcnt lgkmcnt(5)
v_lshl_add_u64 v[148:149], v[148:149], 0, v[150:151]
v_cvt_pkrtz_f16_f32 v180, v180, v181
ds_read_u16_d16_hi v178, v178
ds_read_u16 v176, v176
s_cmp_eq_u32 s77, 0
s_cbranch_scc1 Lpp19
s_call_b64 s[78:79], Lpolln
Lpp19:
ds_read_u16_d16_hi v179, v179
ds_read_u16 v177, v177
v_cvt_pkrtz_f16_f32 v181, v182, v183
v_lshrrev_b64 v[180:181], 2, v[180:181]
v_and_b32_sdwa v182, s47, v180 dst_sel:DWORD dst_unused:UNUSED_PAD src0_sel:DWORD src1_sel:WORD_1
v_and_b32_e64 v180, s47, v180
v_and_b32_sdwa v183, s47, v181 dst_sel:DWORD dst_unused:UNUSED_PAD src0_sel:DWORD src1_sel:WORD_1
v_and_b32 v181, s47, v181
s_waitcnt lgkmcnt(8)
v_lshl_add_u64 v[152:153], v[152:153], 0, v[154:155]
ds_read_u16_d16_hi v182, v182
ds_read_u16 v180, v180
ds_read_u16_d16_hi v183, v183
ds_read_u16 v181, v181
s_cmp_eq_u32 s77, 0
s_cbranch_scc1 Lpp20
s_call_b64 s[78:79], Lpolln
Lpp20:
s_cmp_eq_u32 s77, 0
s_cbranch_scc1 Lpp21
s_call_b64 s[78:79], Lpolln
Lpp21:
ds_read_b128 v[120:123], v248 offset:6144
s_waitcnt lgkmcnt(9)
v_lshl_add_u64 v[146:147], v[156:157], 0, v[158:159]
s_waitcnt lgkmcnt(5)
v_lshl_add_u64 v[150:151], v[176:177], 0, v[178:179]
s_waitcnt lgkmcnt(1)
v_lshl_add_u64 v[154:155], v[180:181], 0, v[182:183]
s_cmp_lg_u32 s40, 0
s_cbranch_scc1 Lspinx
s_setprio 3
Lspin:
s_cmp_eq_u32 s77, 0
s_cbranch_scc1 Lspiny
s_cmp_eq_u32 s76, 0
s_cbranch_scc1 Lspiny
s_sub_u32 s76, s76, 1
s_call_b64 s[78:79], Lpoll
s_branch Lspin
Lspiny:
ds_write_b32 v191, v128
ds_write_b32 v191, v129 offset:4
ds_write_b32 v191, v130 offset:8
s_waitcnt lgkmcnt(0)
Lspinx:
s_waitcnt lgkmcnt(0)
s_barrier
ds_read_b64 v[240:241], v188 offset:3072
ds_read_b64 v[242:243], v188 offset:3104
ds_read_b64 v[244:245], v188 offset:3136
ds_read_b128 v[128:131], v254 offset:8192
ds_read_b128 v[132:135], v254 offset:8208
ds_read_b128 v[136:139], v254 offset:8320
ds_read_b128 v[140:143], v254 offset:8336
s_waitcnt lgkmcnt(6)
v_pk_mul_f16 v72, v72, v240
v_pk_mul_f16 v73, v73, v241
v_and_b32 v72, s49, v72
v_and_b32 v73, s49, v73
s_waitcnt lgkmcnt(4)
v_pk_mul_f16 v74, v74, v240
v_pk_mul_f16 v75, v75, v241
v_and_b32 v74, s49, v74
v_and_b32 v75, s49, v75
v_pk_mul_f16 v76, v76, v240
v_pk_mul_f16 v77, v77, v241
v_and_b32 v76, s49, v76
v_and_b32 v77, s49, v77
v_pk_mul_f16 v78, v78, v240
v_pk_mul_f16 v79, v79, v241
ds_write_b64 v173, v[72:73]
ds_write_b64 v173, v[74:75] offset:3072
v_and_b32 v78, s49, v78
v_and_b32 v79, s49, v79
v_pk_mul_f16 v80, v80, v240
v_pk_mul_f16 v81, v81, v241
v_and_b32 v80, s49, v80
v_and_b32 v81, s49, v81
v_pk_mul_f16 v82, v82, v240
v_pk_mul_f16 v83, v83, v241
ds_write_b64 v173, v[76:77] offset:1024
ds_write_b64 v173, v[78:79] offset:4096
v_and_b32 v82, s49, v82
v_and_b32 v83, s49, v83
v_pk_mul_f16 v84, v84, v242
v_pk_mul_f16 v85, v85, v243
v_and_b32 v84, s49, v84
v_and_b32 v85, s49, v85
v_pk_mul_f16 v86, v86, v242
v_pk_mul_f16 v87, v87, v243
ds_write_b64 v173, v[80:81] offset:2048
ds_write_b64 v173, v[82:83] offset:5120
v_and_b32 v86, s49, v86
v_and_b32 v87, s49, v87
v_pk_mul_f16 v88, v88, v242
v_pk_mul_f16 v89, v89, v243
v_and_b32 v88, s49, v88
v_and_b32 v89, s49, v89
v_pk_mul_f16 v90, v90, v242
v_pk_mul_f16 v91, v91, v243
ds_write_b64 v174, v[84:85]
ds_write_b64 v174, v[86:87] offset:3072
v_and_b32 v90, s49, v90
v_and_b32 v91, s49, v91
v_pk_mul_f16 v92, v92, v242
v_pk_mul_f16 v93, v93, v243
v_and_b32 v92, s49, v92
v_and_b32 v93, s49, v93
v_pk_mul_f16 v94, v94, v242
v_pk_mul_f16 v95, v95, v243
ds_write_b64 v174, v[88:89] offset:1024
ds_write_b64 v174, v[90:91] offset:4096
v_and_b32 v94, s49, v94
v_and_b32 v95, s49, v95
v_pk_mul_f16 v160, v160, v244
v_pk_mul_f16 v161, v161, v245
v_and_b32 v160, s49, v160
v_and_b32 v161, s49, v161
v_pk_mul_f16 v162, v162, v244
v_pk_mul_f16 v163, v163, v245
ds_write_b64 v174, v[92:93] offset:2048
s_waitcnt lgkmcnt(6)
ds_write_b64 v174, v[94:95] offset:5120
v_and_b32 v162, s49, v162
v_and_b32_e64 v163, s49, v163
v_pk_mul_f16 v164, v164, v244
v_pk_mul_f16 v165, v165, v245
v_and_b32 v164, s49, v164
v_and_b32 v165, s49, v165
v_pk_mul_f16 v166, v166, v244
v_pk_mul_f16 v167, v167, v245
ds_write_b64 v175, v[160:161]
ds_write_b64 v175, v[162:163] offset:3072
v_and_b32 v166, s49, v166
v_and_b32 v167, s49, v167
v_pk_mul_f16 v168, v168, v244
v_pk_mul_f16 v169, v169, v245
v_and_b32 v168, s49, v168
v_and_b32 v169, s49, v169
v_pk_mul_f16 v170, v170, v244
v_pk_mul_f16 v171, v171, v245
ds_write_b64 v175, v[164:165] offset:1024
ds_write_b64 v175, v[166:167] offset:4096
v_and_b32_e64 v170, s49, v170
v_and_b32 v171, s49, v171
ds_write_b64 v175, v[168:169] offset:2048
ds_write_b64 v175, v[170:171] offset:5120
ds_read_b128 v[240:243], v254
ds_read_b128 v[244:247], v254 offset:16
s_waitcnt lgkmcnt(0)
s_barrier
ds_read_b128 v[124:127], v251 offset:20480
ds_read_b128 v[184:187], v251 offset:23552
ds_read_b128 v[188:191], v251 offset:21504
ds_read_b128 v[160:163], v251 offset:24576
buffer_load_dwordx4 v[164:167], v253, s[4:7], s71 offen
buffer_load_dwordx4 v[168:171], v253, s[4:7], s71 offen offset:64
v_mfma_f32_16x16x32_bf16 v[172:175], v[120:123], v[48:51], 0
s_setprio 3
v_mfma_f32_16x16x32_bf16 v[156:159], v[120:123], v[52:55], 0
v_mfma_f32_16x16x32_bf16 v[176:179], v[120:123], v[24:27], 0
ds_read_b128 v[120:123], v251 offset:22528
s_waitcnt lgkmcnt(4)
v_mfma_f32_16x16x32_f16 v[72:75], v[124:127], v[4:7], v[128:131]
v_mfma_f32_16x16x32_f16 v[128:131], v[124:127], v[0:3], v[128:131]
ds_read_b128 v[124:127], v248 offset:8192
s_waitcnt lgkmcnt(4)
v_mfma_f32_16x16x32_f16 v[76:79], v[184:187], v[4:7], v[132:135]
v_mfma_f32_16x16x32_f16 v[132:135], v[184:187], v[0:3], v[132:135]
ds_read_b128 v[184:187], v251 offset:25600
s_waitcnt lgkmcnt(4)
v_mfma_f32_16x16x32_f16 v[80:83], v[188:191], v[4:7], v[136:139]
v_mfma_f32_16x16x32_f16 v[136:139], v[188:191], v[0:3], v[136:139]
ds_read_b128 v[188:191], v251 offset:26624
s_waitcnt lgkmcnt(4)
v_mfma_f32_16x16x32_f16 v[84:87], v[160:163], v[4:7], v[140:143]
v_mfma_f32_16x16x32_f16 v[140:143], v[160:163], v[0:3], v[140:143]
ds_read_b128 v[160:163], v251 offset:29696
s_waitcnt lgkmcnt(4)
v_mfma_f32_16x16x32_f16 v[88:91], v[120:123], v[4:7], v[240:243]
s_waitcnt lgkmcnt(3)
v_mfma_f32_16x16x32_bf16 v[172:175], v[124:127], v[56:59], v[172:175]
v_mfma_f32_16x16x32_f16 v[240:243], v[120:123], v[0:3], v[240:243]
ds_read_b128 v[120:123], v251 offset:27648
s_waitcnt lgkmcnt(3)
v_mfma_f32_16x16x32_f16 v[92:95], v[184:187], v[4:7], v[244:247]
v_mfma_f32_16x16x32_f16 v[244:247], v[184:187], v[0:3], v[244:247]
ds_read_b128 v[184:187], v251 offset:30720
v_mfma_f32_16x16x32_bf16 v[156:159], v[124:127], v[60:63], v[156:159]
s_waitcnt lgkmcnt(3)
v_mfma_f32_16x16x32_f16 v[72:75], v[188:191], v[12:15], v[72:75]
v_mfma_f32_16x16x32_f16 v[128:131], v[188:191], v[8:11], v[128:131]
ds_read_b128 v[188:191], v251 offset:28672
s_waitcnt lgkmcnt(3)
v_mfma_f32_16x16x32_f16 v[76:79], v[160:163], v[12:15], v[76:79]
v_mfma_f32_16x16x32_bf16 v[176:179], v[124:127], v[32:35], v[176:179]
ds_read_b128 v[124:127], v248 offset:10240
v_mfma_f32_16x16x32_f16 v[132:135], v[160:163], v[8:11], v[132:135]
ds_read_b128 v[160:163], v251 offset:31744
s_waitcnt lgkmcnt(4)
v_mfma_f32_16x16x32_f16 v[80:83], v[120:123], v[12:15], v[80:83]
v_mfma_f32_16x16x32_f16 v[136:139], v[120:123], v[8:11], v[136:139]
ds_read_b128 v[120:123], v251 offset:32768
s_setprio 2
s_waitcnt lgkmcnt(4)
v_mfma_f32_16x16x32_f16 v[84:87], v[184:187], v[12:15], v[84:87]
v_mfma_f32_16x16x32_f16 v[140:143], v[184:187], v[8:11], v[140:143]
ds_read_b128 v[184:187], v248 offset:6400
s_waitcnt lgkmcnt(4)
v_mfma_f32_16x16x32_f16 v[88:91], v[188:191], v[12:15], v[88:91]
s_waitcnt lgkmcnt(3)
v_mfma_f32_16x16x32_bf16 v[172:175], v[124:127], v[64:67], v[172:175]
v_mfma_f32_16x16x32_bf16 v[156:159], v[124:127], v[68:71], v[156:159]
v_mfma_f32_16x16x32_f16 v[240:243], v[188:191], v[8:11], v[240:243]
ds_read_b128 v[188:191], v251 offset:33792
s_nop 4
v_cvt_pk_f16_f32 v172, v172, v173
s_waitcnt lgkmcnt(3)
v_mfma_f32_16x16x32_f16 v[92:95], v[160:163], v[12:15], v[92:95]
v_cvt_pk_f16_f32 v174, v174, v175
v_cvt_pkrtz_f16_f32 v156, v156, v157
v_mfma_f32_16x16x32_f16 v[244:247], v[160:163], v[8:11], v[244:247]
ds_read_b128 v[160:163], v251 offset:36864
v_cvt_pkrtz_f16_f32 v157, v158, v159
v_mfma_f32_16x16x32_bf16 v[176:179], v[124:127], v[40:43], v[176:179]
ds_read_b128 v[124:127], v251 offset:35840
v_lshrrev_b64 v[156:157], 2, v[156:157]
s_waitcnt lgkmcnt(3)
v_mfma_f32_16x16x32_f16 v[72:75], v[120:123], v[20:23], v[72:75]
v_and_b32_sdwa v158, s47, v156 dst_sel:DWORD dst_unused:UNUSED_PAD src0_sel:DWORD src1_sel:WORD_1
v_and_b32 v156, s47, v156
v_mfma_f32_16x16x32_f16 v[128:131], v[120:123], v[16:19], v[128:131]
ds_read_b128 v[120:123], v251 offset:34816
ds_read_u16_d16_hi v158, v158
v_mfma_f32_16x16x32_bf16 v[180:183], v[184:187], v[48:51], 0
ds_read_u16 v156, v156
v_pk_fma_f16 v173, v172, v172, s48
s_waitcnt lgkmcnt(5)
v_mfma_f32_16x16x32_f16 v[80:83], v[188:191], v[20:23], v[80:83]
v_and_b32_sdwa v159, s47, v157 dst_sel:DWORD dst_unused:UNUSED_PAD src0_sel:DWORD src1_sel:WORD_1
v_and_b32_e64 v157, s47, v157
v_mfma_f32_16x16x32_f16 v[136:139], v[188:191], v[16:19], v[136:139]
ds_read_b128 v[188:191], v252 offset:4096
ds_read_u16_d16_hi v159, v159
s_waitcnt lgkmcnt(5)
v_mfma_f32_16x16x32_f16 v[76:79], v[124:127], v[20:23], v[76:79]
ds_read_u16 v157, v157
v_pk_fma_f16 v175, v174, v174, s48
v_mfma_f32_16x16x32_f16 v[132:135], v[124:127], v[16:19], v[132:135]
ds_read_b128 v[124:127], v251 offset:37888
v_pk_mul_f16 v173, v172, v173
v_mfma_f32_16x16x32_bf16 v[0:3], v[184:187], v[52:55], 0
v_pk_mul_f16 v175, v174, v175
v_cvt_pkrtz_f16_f32 v176, v176, v177
v_mfma_f32_16x16x32_f16 v[84:87], v[160:163], v[20:23], v[84:87]
v_cvt_pkrtz_f16_f32 v177, v178, v179
v_lshrrev_b64 v[176:177], 2, v[176:177]
v_mfma_f32_16x16x32_f16 v[140:143], v[160:163], v[16:19], v[140:143]
ds_read_b128 v[160:163], v252 offset:7168
v_and_b32_sdwa v178, s47, v176 dst_sel:DWORD dst_unused:UNUSED_PAD src0_sel:DWORD src1_sel:WORD_1
s_waitcnt lgkmcnt(7)
v_mfma_f32_16x16x32_f16 v[88:91], v[120:123], v[20:23], v[88:91]
v_and_b32 v176, s47, v176
v_exp_f16_sdwa v173, v173 dst_sel:WORD_0 dst_unused:UNUSED_PRESERVE src0_sel:WORD_0
v_mfma_f32_16x16x32_bf16 v[4:7], v[184:187], v[24:27], 0
ds_read_b128 v[184:187], v248 offset:8448
ds_read_u16_d16_hi v178, v178
v_mfma_f32_16x16x32_f16 v[240:243], v[120:123], v[16:19], v[240:243]
ds_read_b128 v[120:123], v252 offset:5120
ds_read_u16 v176, v176
s_waitcnt lgkmcnt(8)
v_mfma_f32_16x16x32_f16 v[72:75], v[188:191], v[100:103], v[72:75]
s_setprio 1
v_exp_f16_sdwa v175, v175 dst_sel:WORD_0 dst_unused:UNUSED_PRESERVE src0_sel:WORD_0
v_mfma_f32_16x16x32_f16 v[128:131], v[188:191], v[96:99], v[128:131]
ds_read_b128 v[188:191], v252 offset:6144
v_and_b32_sdwa v179, s47, v177 dst_sel:DWORD dst_unused:UNUSED_PAD src0_sel:DWORD src1_sel:WORD_1
s_waitcnt lgkmcnt(6)
v_mfma_f32_16x16x32_f16 v[92:95], v[124:127], v[20:23], v[92:95]
v_mov_b32 v20, 0
v_mov_b32_e64 v21, 0
v_mfma_f32_16x16x32_f16 v[244:247], v[124:127], v[16:19], v[244:247]
ds_read_b128 v[124:127], v252 offset:8192
v_mov_b32 v16, 0
s_waitcnt lgkmcnt(5)
v_mfma_f32_16x16x32_bf16 v[180:183], v[184:187], v[56:59], v[180:183]
v_mov_b32_e64 v17, 0
v_cndmask_b32 v18, 0, v255, s[88:89]
v_cndmask_b32 v19, 0, v255, s[90:91]
v_mfma_f32_16x16x32_bf16 v[0:3], v[184:187], v[60:63], v[0:3]
v_and_b32 v177, s47, v177
v_exp_f16_sdwa v173, v173 dst_sel:WORD_1 dst_unused:UNUSED_PRESERVE src0_sel:WORD_1
v_mfma_f32_16x16x32_f16 v[76:79], v[160:163], v[100:103], v[76:79]
ds_read_u16_d16_hi v179, v179
ds_read_u16 v177, v177
v_mfma_f32_16x16x32_f16 v[132:135], v[160:163], v[96:99], v[132:135]
ds_read_b128 v[160:163], v252 offset:9216
v_exp_f16_sdwa v175, v175 dst_sel:WORD_1 dst_unused:UNUSED_PRESERVE src0_sel:WORD_1
s_waitcnt lgkmcnt(6)
v_mfma_f32_16x16x32_f16 v[80:83], v[120:123], v[100:103], v[80:83]
v_pk_add_f16 v173, v173, 1.0 op_sel_hi:[1,0]
v_pk_add_f16 v175, v175, 1.0 op_sel_hi:[1,0]
v_mfma_f32_16x16x32_bf16 v[4:7], v[184:187], v[32:35], v[4:7]
ds_read_b128 v[184:187], v248 offset:10496
v_rcp_f16_sdwa v173, v173 dst_sel:WORD_0 dst_unused:UNUSED_PRESERVE src0_sel:WORD_0
v_mfma_f32_16x16x32_f16 v[136:139], v[120:123], v[96:99], v[136:139]
ds_read_b128 v[120:123], v252 offset:10240
v_rcp_f16_sdwa v175, v175 dst_sel:WORD_0 dst_unused:UNUSED_PRESERVE src0_sel:WORD_0
s_waitcnt lgkmcnt(5)
v_mfma_f32_16x16x32_f16 v[84:87], v[124:127], v[100:103], v[84:87]
v_rcp_f16_sdwa v173, v173 dst_sel:WORD_1 dst_unused:UNUSED_PRESERVE src0_sel:WORD_1
v_mfma_f32_16x16x32_f16 v[140:143], v[124:127], v[96:99], v[140:143]
ds_read_b128 v[124:127], v252 offset:13312
v_rcp_f16_sdwa v175, v175 dst_sel:WORD_1 dst_unused:UNUSED_PRESERVE src0_sel:WORD_1
v_mfma_f32_16x16x32_f16 v[88:91], v[188:191], v[100:103], v[88:91]
v_mfma_f32_16x16x32_f16 v[240:243], v[188:191], v[96:99], v[240:243]
ds_read_b128 v[188:191], v248 offset:12288
s_waitcnt lgkmcnt(3)
v_mfma_f32_16x16x32_bf16 v[180:183], v[184:187], v[64:67], v[180:183]
v_mfma_f32_16x16x32_f16 v[92:95], v[160:163], v[100:103], v[92:95]
v_pk_mul_f16 v172, v172, v173
v_mfma_f32_16x16x32_bf16 v[0:3], v[184:187], v[68:71], v[0:3]
s_nop 4
v_cvt_pk_f16_f32 v180, v180, v181
v_mfma_f32_16x16x32_f16 v[244:247], v[160:163], v[96:99], v[244:247]
ds_read_b128 v[160:163], v252 offset:14336
v_cvt_pk_f16_f32 v182, v182, v183
s_waitcnt lgkmcnt(3)
v_mfma_f32_16x16x32_f16 v[72:75], v[120:123], v[108:111], v[72:75]
v_pk_fma_f16 v181, v180, v180, s48
v_cvt_pkrtz_f16_f32 v0, v0, v1
v_mfma_f32_16x16x32_f16 v[128:131], v[120:123], v[104:107], v[128:131]
ds_read_b128 v[120:123], v252 offset:12288
v_cvt_pkrtz_f16_f32 v1, v2, v3
v_mfma_f32_16x16x32_bf16 v[4:7], v[184:187], v[40:43], v[4:7]
ds_read_b128 v[184:187], v252 offset:11264
v_lshrrev_b64 v[0:1], 2, v[0:1]
s_waitcnt lgkmcnt(3)
v_mfma_f32_16x16x32_f16 v[76:79], v[124:127], v[108:111], v[76:79]
v_and_b32_sdwa v2, s47, v0 dst_sel:DWORD dst_unused:UNUSED_PAD src0_sel:DWORD src1_sel:WORD_1
v_and_b32 v0, s47, v0
v_mfma_f32_16x16x32_f16 v[132:135], v[124:127], v[104:107], v[132:135]
ds_read_b128 v[124:127], v252 offset:15360
s_setprio 0
ds_read_u16_d16_hi v2, v2
v_mfma_f32_16x16x32_bf16 v[8:11], v[188:191], v[48:51], 0
ds_read_u16 v0, v0
v_and_b32_sdwa v3, s47, v1 dst_sel:DWORD dst_unused:UNUSED_PAD src0_sel:DWORD src1_sel:WORD_1
s_waitcnt lgkmcnt(5)
v_mfma_f32_16x16x32_f16 v[84:87], v[160:163], v[108:111], v[84:87]
v_and_b32 v1, s47, v1
v_pk_fma_f16 v183, v182, v182, s48
v_mfma_f32_16x16x32_f16 v[140:143], v[160:163], v[104:107], v[140:143]
ds_read_b128 v[160:163], v251 offset:41984
ds_read_u16_d16_hi v3, v3
s_waitcnt lgkmcnt(5)
v_mfma_f32_16x16x32_f16 v[80:83], v[184:187], v[108:111], v[80:83]
ds_read_u16 v1, v1
v_pk_mul_f16 v181, v180, v181
v_mfma_f32_16x16x32_f16 v[136:139], v[184:187], v[104:107], v[136:139]
ds_read_b128 v[184:187], v251 offset:38912
v_pk_mul_f16 v183, v182, v183
v_mfma_f32_16x16x32_bf16 v[12:15], v[188:191], v[52:55], 0
v_cvt_pkrtz_f16_f32 v4, v4, v5
v_cvt_pkrtz_f16_f32 v5, v6, v7
v_mfma_f32_16x16x32_f16 v[88:91], v[120:123], v[108:111], v[88:91]
v_lshrrev_b64 v[4:5], 2, v[4:5]
v_and_b32_sdwa v6, s47, v4 dst_sel:DWORD dst_unused:UNUSED_PAD src0_sel:DWORD src1_sel:WORD_1
v_mfma_f32_16x16x32_f16 v[240:243], v[120:123], v[104:107], v[240:243]
ds_read_b128 v[120:123], v251 offset:39936
v_and_b32 v4, s47, v4
s_waitcnt lgkmcnt(7)
v_mfma_f32_16x16x32_f16 v[92:95], v[124:127], v[108:111], v[92:95]
ds_read_u16_d16_hi v6, v6
ds_read_u16 v4, v4
v_mfma_f32_16x16x32_bf16 v[96:99], v[188:191], v[24:27], 0
ds_read_b128 v[188:191], v248 offset:14336
v_pk_mul_f16 v173, v174, v175
v_mfma_f32_16x16x32_f16 v[244:247], v[124:127], v[104:107], v[244:247]
ds_read_b128 v[124:127], v251 offset:43008
buffer_load_dwordx4 v[100:103], v253, s[4:7], s71 offen offset:128
buffer_load_dwordx4 v[104:107], v253, s[4:7], s71 offen offset:192
s_waitcnt lgkmcnt(8)
v_mfma_f32_16x16x32_f16 v[76:79], v[160:163], v[196:199], v[76:79]
v_exp_f16_sdwa v181, v181 dst_sel:WORD_0 dst_unused:UNUSED_PRESERVE src0_sel:WORD_0
v_mfma_f32_16x16x32_f16 v[132:135], v[160:163], v[192:195], v[132:135]
ds_read_b128 v[160:163], v251 offset:44032
v_lshl_add_u64 v[156:157], v[156:157], 0, v[158:159]
s_waitcnt lgkmcnt(6)
v_mfma_f32_16x16x32_f16 v[72:75], v[184:187], v[196:199], v[72:75]
v_exp_f16_sdwa v183, v183 dst_sel:WORD_0 dst_unused:UNUSED_PRESERVE src0_sel:WORD_0
v_mfma_f32_16x16x32_f16 v[128:131], v[184:187], v[192:195], v[128:131]
ds_read_b128 v[184:187], v251 offset:40960
v_and_b32_sdwa v7, s47, v5 dst_sel:DWORD dst_unused:UNUSED_PAD src0_sel:DWORD src1_sel:WORD_1
s_waitcnt lgkmcnt(6)
v_mfma_f32_16x16x32_f16 v[80:83], v[120:123], v[196:199], v[80:83]
v_and_b32 v5, s47, v5
v_exp_f16_sdwa v181, v181 dst_sel:WORD_1 dst_unused:UNUSED_PRESERVE src0_sel:WORD_1
v_mfma_f32_16x16x32_f16 v[136:139], v[120:123], v[192:195], v[136:139]
ds_read_b128 v[120:123], v251 offset:45056
ds_read_u16_d16_hi v7, v7
ds_read_u16 v5, v5
s_waitcnt lgkmcnt(6)
v_mfma_f32_16x16x32_bf16 v[8:11], v[188:191], v[56:59], v[8:11]
v_lshl_add_u64 v[176:177], v[176:177], 0, v[178:179]
v_exp_f16_sdwa v183, v183 dst_sel:WORD_1 dst_unused:UNUSED_PRESERVE src0_sel:WORD_1
v_mfma_f32_16x16x32_bf16 v[12:15], v[188:191], v[60:63], v[12:15]
v_pk_add_f16 v181, v181, 1.0 op_sel_hi:[1,0]
v_pk_add_f16 v183, v183, 1.0 op_sel_hi:[1,0]
s_waitcnt lgkmcnt(5)
v_mfma_f32_16x16x32_f16 v[84:87], v[124:127], v[196:199], v[84:87]
v_rcp_f16_sdwa v181, v181 dst_sel:WORD_0 dst_unused:UNUSED_PRESERVE src0_sel:WORD_0
v_mfma_f32_16x16x32_f16 v[140:143], v[124:127], v[192:195], v[140:143]
ds_read_b128 v[124:127], v251 offset:48128
v_rcp_f16_sdwa v183, v183 dst_sel:WORD_0 dst_unused:UNUSED_PRESERVE src0_sel:WORD_0
v_mfma_f32_16x16x32_bf16 v[96:99], v[188:191], v[32:35], v[96:99]
ds_read_b128 v[188:191], v248 offset:16384
v_rcp_f16_sdwa v181, v181 dst_sel:WORD_1 dst_unused:UNUSED_PRESERVE src0_sel:WORD_1
s_waitcnt lgkmcnt(5)
v_mfma_f32_16x16x32_f16 v[88:91], v[184:187], v[196:199], v[88:91]
s_setprio 3
v_mfma_f32_16x16x32_f16 v[240:243], v[184:187], v[192:195], v[240:243]
ds_read_b128 v[184:187], v251 offset:46080
v_rcp_f16_sdwa v183, v183 dst_sel:WORD_1 dst_unused:UNUSED_PRESERVE src0_sel:WORD_1
v_mfma_f32_16x16x32_f16 v[92:95], v[160:163], v[196:199], v[92:95]
v_mfma_f32_16x16x32_f16 v[244:247], v[160:163], v[192:195], v[244:247]
ds_read_b128 v[160:163], v248 offset:12544
s_waitcnt lgkmcnt(4)
v_mfma_f32_16x16x32_f16 v[72:75], v[120:123], v[204:207], v[72:75]
s_waitcnt lgkmcnt(2)
v_mfma_f32_16x16x32_bf16 v[8:11], v[188:191], v[64:67], v[8:11]
v_pk_mul_f16 v174, v180, v181
v_mfma_f32_16x16x32_bf16 v[12:15], v[188:191], v[68:71], v[12:15]
v_mfma_f32_16x16x32_f16 v[128:131], v[120:123], v[200:203], v[128:131]
ds_read_b128 v[120:123], v251 offset:47104
v_pk_mul_f16 v175, v182, v183
v_mfma_f32_16x16x32_f16 v[76:79], v[124:127], v[204:207], v[76:79]
s_nop 1
v_cvt_pkrtz_f16_f32 v8, v8, v9
v_cvt_pkrtz_f16_f32 v9, v10, v11
v_mfma_f32_16x16x32_f16 v[132:135], v[124:127], v[200:203], v[132:135]
ds_read_b128 v[124:127], v251 offset:50176
v_lshrrev_b64 v[8:9], 2, v[8:9]
v_mfma_f32_16x16x32_bf16 v[96:99], v[188:191], v[40:43], v[96:99]
ds_read_b128 v[188:191], v251 offset:49152
v_and_b32_sdwa v10, s47, v8 dst_sel:DWORD dst_unused:UNUSED_PAD src0_sel:DWORD src1_sel:WORD_1
s_waitcnt lgkmcnt(3)
v_mfma_f32_16x16x32_f16 v[80:83], v[184:187], v[204:207], v[80:83]
v_and_b32_e64 v8, s47, v8
v_and_b32_sdwa v11, s47, v9 dst_sel:DWORD dst_unused:UNUSED_PAD src0_sel:DWORD src1_sel:WORD_1
v_mfma_f32_16x16x32_f16 v[136:139], v[184:187], v[200:203], v[136:139]
ds_read_b128 v[184:187], v251 offset:51200
ds_read_u16_d16_hi v10, v10
v_mfma_f32_16x16x32_bf16 v[108:111], v[160:163], v[48:51], 0
ds_read_u16 v8, v8
v_and_b32_e64 v9, s47, v9
s_waitcnt lgkmcnt(5)
v_mfma_f32_16x16x32_f16 v[88:91], v[120:123], v[204:207], v[88:91]
ds_read_u16_d16_hi v11, v11
ds_read_u16 v9, v9
v_mfma_f32_16x16x32_f16 v[240:243], v[120:123], v[200:203], v[240:243]
ds_read_b128 v[120:123], v251 offset:52224
v_cvt_pkrtz_f16_f32 v12, v12, v13
s_waitcnt lgkmcnt(6)
v_mfma_f32_16x16x32_f16 v[84:87], v[188:191], v[204:207], v[84:87]
v_cvt_pkrtz_f16_f32 v13, v14, v15
v_lshrrev_b64 v[12:13], 2, v[12:13]
v_mfma_f32_16x16x32_f16 v[140:143], v[188:191], v[200:203], v[140:143]
ds_read_b128 v[188:191], v251 offset:54272
v_and_b32_sdwa v14, s47, v12 dst_sel:DWORD dst_unused:UNUSED_PAD src0_sel:DWORD src1_sel:WORD_1
v_mfma_f32_16x16x32_bf16 v[192:195], v[160:163], v[52:55], 0
v_and_b32_e64 v12, s47, v12
v_and_b32_sdwa v15, s47, v13 dst_sel:DWORD dst_unused:UNUSED_PAD src0_sel:DWORD src1_sel:WORD_1
v_mfma_f32_16x16x32_f16 v[92:95], v[124:127], v[204:207], v[92:95]
ds_read_u16_d16_hi v14, v14
ds_read_u16 v12, v12
v_mfma_f32_16x16x32_f16 v[244:247], v[124:127], v[200:203], v[244:247]
ds_read_b128 v[124:127], v251 offset:55296
buffer_load_dwordx4 v[200:203], v253, s[4:7], s71 offen offset:256
buffer_load_dwordx4 v[204:207], v253, s[4:7], s71 offen offset:320
s_waitcnt lgkmcnt(9)
v_mfma_f32_16x16x32_f16 v[72:75], v[184:187], v[212:215], v[72:75]
v_and_b32 v13, s47, v13
v_lshl_add_u64 v[158:159], v[0:1], 0, v[2:3]
v_mfma_f32_16x16x32_bf16 v[196:199], v[160:163], v[24:27], 0
ds_read_b128 v[160:163], v248 offset:14592
ds_read_u16_d16_hi v15, v15
v_mfma_f32_16x16x32_f16 v[128:131], v[184:187], v[208:211], v[128:131]
ds_read_b128 v[184:187], v248 offset:16640
s_setprio 2
ds_read_u16 v13, v13
v_cvt_pkrtz_f16_f32 v96, v96, v97
v_cvt_pkrtz_f16_f32 v97, v98, v99
v_lshrrev_b64 v[96:97], 2, v[96:97]
s_waitcnt lgkmcnt(8)
v_mfma_f32_16x16x32_f16 v[80:83], v[120:123], v[212:215], v[80:83]
v_and_b32_sdwa v98, s47, v96 dst_sel:DWORD dst_unused:UNUSED_PAD src0_sel:DWORD src1_sel:WORD_1
v_and_b32 v96, s47, v96
s_waitcnt lgkmcnt(7)
v_mfma_f32_16x16x32_f16 v[76:79], v[188:191], v[212:215], v[76:79]
ds_read_u16_d16_hi v98, v98
ds_read_u16 v96, v96
v_mfma_f32_16x16x32_f16 v[132:135], v[188:191], v[208:211], v[132:135]
ds_read_b128 v[188:191], v251 offset:53248
v_and_b32_sdwa v99, s47, v97 dst_sel:DWORD dst_unused:UNUSED_PAD src0_sel:DWORD src1_sel:WORD_1
v_mfma_f32_16x16x32_f16 v[136:139], v[120:123], v[208:211], v[136:139]
ds_read_b128 v[120:123], v251 offset:57344
v_and_b32_e64 v97, s47, v97
v_lshl_add_u64 v[178:179], v[4:5], 0, v[6:7]
ds_read_u16_d16_hi v99, v99
ds_read_u16 v97, v97
s_waitcnt lgkmcnt(10)
v_mfma_f32_16x16x32_f16 v[84:87], v[124:127], v[212:215], v[84:87]
s_waitcnt lgkmcnt(9)
v_mfma_f32_16x16x32_bf16 v[108:111], v[160:163], v[56:59], v[108:111]
v_mfma_f32_16x16x32_bf16 v[192:195], v[160:163], v[60:63], v[192:195]
v_mfma_f32_16x16x32_bf16 v[196:199], v[160:163], v[32:35], v[196:199]
ds_read_b128 v[160:163], v251 offset:56320
v_mfma_f32_16x16x32_f16 v[140:143], v[124:127], v[208:211], v[140:143]
ds_read_b128 v[124:127], v248 offset:18432
s_waitcnt lgkmcnt(9)
v_mfma_f32_16x16x32_bf16 v[108:111], v[184:187], v[64:67], v[108:111]
v_mfma_f32_16x16x32_bf16 v[192:195], v[184:187], v[68:71], v[192:195]
v_mfma_f32_16x16x32_bf16 v[196:199], v[184:187], v[40:43], v[196:199]
ds_read_b128 v[184:187], v251 offset:60416
s_nop 4
v_cvt_pk_f16_f32 v108, v108, v109
v_cvt_pk_f16_f32 v110, v110, v111
v_pk_fma_f16 v109, v108, v108, s48
v_pk_fma_f16 v111, v110, v110, s48
v_cvt_pkrtz_f16_f32 v192, v192, v193
v_cvt_pkrtz_f16_f32 v193, v194, v195
s_waitcnt lgkmcnt(6)
v_mfma_f32_16x16x32_f16 v[88:91], v[188:191], v[212:215], v[88:91]
v_lshrrev_b64 v[192:193], 2, v[192:193]
v_and_b32_sdwa v194, s47, v192 dst_sel:DWORD dst_unused:UNUSED_PAD src0_sel:DWORD src1_sel:WORD_1
v_mfma_f32_16x16x32_f16 v[240:243], v[188:191], v[208:211], v[240:243]
ds_read_b128 v[188:191], v251 offset:58368
v_and_b32 v192, s47, v192
s_waitcnt lgkmcnt(6)
v_mfma_f32_16x16x32_f16 v[72:75], v[120:123], v[228:231], v[72:75]
s_setprio 1
ds_read_u16_d16_hi v194, v194
ds_read_u16 v192, v192
v_mfma_f32_16x16x32_f16 v[128:131], v[120:123], v[224:227], v[128:131]
ds_read_b128 v[120:123], v248 offset:20480
v_and_b32_sdwa v195, s47, v193 dst_sel:DWORD dst_unused:UNUSED_PAD src0_sel:DWORD src1_sel:WORD_1
v_and_b32 v193, s47, v193
v_pk_mul_f16 v109, v108, v109
v_pk_mul_f16 v111, v110, v111
s_waitcnt lgkmcnt(6)
v_mfma_f32_16x16x32_f16 v[92:95], v[160:163], v[212:215], v[92:95]
ds_read_u16_d16_hi v195, v195
ds_read_u16 v193, v193
v_mfma_f32_16x16x32_f16 v[244:247], v[160:163], v[208:211], v[244:247]
ds_read_b128 v[160:163], v251 offset:61440
v_cvt_pkrtz_f16_f32 v196, v196, v197
s_waitcnt lgkmcnt(8)
v_mfma_f32_16x16x32_bf16 v[208:211], v[124:127], v[48:51], 0
v_cvt_pkrtz_f16_f32 v197, v198, v199
v_lshrrev_b64 v[196:197], 2, v[196:197]
s_waitcnt lgkmcnt(7)
v_mfma_f32_16x16x32_f16 v[76:79], v[184:187], v[228:231], v[76:79]
v_and_b32_sdwa v198, s47, v196 dst_sel:DWORD dst_unused:UNUSED_PAD src0_sel:DWORD src1_sel:WORD_1
v_and_b32 v196, s47, v196
v_mfma_f32_16x16x32_bf16 v[212:215], v[124:127], v[52:55], 0
ds_read_u16_d16_hi v198, v198
ds_read_u16 v196, v196
v_mfma_f32_16x16x32_f16 v[132:135], v[184:187], v[224:227], v[132:135]
ds_read_b128 v[184:187], v251 offset:62464
v_lshl_add_u64 v[8:9], v[8:9], 0, v[10:11]
s_waitcnt lgkmcnt(9)
v_mfma_f32_16x16x32_f16 v[80:83], v[188:191], v[228:231], v[80:83]
v_exp_f16_sdwa v109, v109 dst_sel:WORD_0 dst_unused:UNUSED_PRESERVE src0_sel:WORD_0
v_mfma_f32_16x16x32_bf16 v[180:183], v[124:127], v[24:27], 0
ds_read_b128 v[124:127], v251 offset:59392
v_exp_f16_sdwa v111, v111 dst_sel:WORD_0 dst_unused:UNUSED_PRESERVE src0_sel:WORD_0
v_mfma_f32_16x16x32_f16 v[136:139], v[188:191], v[224:227], v[136:139]
ds_read_b128 v[188:191], v248 offset:22528
v_and_b32_sdwa v199, s47, v197 dst_sel:DWORD dst_unused:UNUSED_PAD src0_sel:DWORD src1_sel:WORD_1
s_waitcnt lgkmcnt(8)
v_mfma_f32_16x16x32_bf16 v[208:211], v[120:123], v[56:59], v[208:211]
v_and_b32 v197, s47, v197
v_lshl_add_u64 v[12:13], v[12:13], 0, v[14:15]
v_mfma_f32_16x16x32_bf16 v[212:215], v[120:123], v[60:63], v[212:215]
ds_read_u16_d16_hi v199, v199
ds_read_u16 v197, v197
s_waitcnt lgkmcnt(7)
v_mfma_f32_16x16x32_f16 v[84:87], v[160:163], v[228:231], v[84:87]
v_exp_f16_sdwa v109, v109 dst_sel:WORD_1 dst_unused:UNUSED_PRESERVE src0_sel:WORD_1
v_mfma_f32_16x16x32_f16 v[140:143], v[160:163], v[224:227], v[140:143]
ds_read_b128 v[160:163], v251 offset:8192
v_exp_f16_sdwa v111, v111 dst_sel:WORD_1 dst_unused:UNUSED_PRESERVE src0_sel:WORD_1
v_mfma_f32_16x16x32_bf16 v[180:183], v[120:123], v[32:35], v[180:183]
ds_read_b128 v[120:123], v251 offset:11264
v_lshl_add_u64 v[96:97], v[96:97], 0, v[98:99]
s_waitcnt lgkmcnt(6)
v_mfma_f32_16x16x32_f16 v[92:95], v[184:187], v[228:231], v[92:95]
s_setprio 0
v_pk_add_f16 v109, v109, 1.0 op_sel_hi:[1,0]
v_pk_add_f16 v111, v111, 1.0 op_sel_hi:[1,0]
s_waitcnt lgkmcnt(5)
v_mfma_f32_16x16x32_f16 v[88:91], v[124:127], v[228:231], v[88:91]
v_rcp_f16_sdwa v109, v109 dst_sel:WORD_0 dst_unused:UNUSED_PRESERVE src0_sel:WORD_0
v_mfma_f32_16x16x32_f16 v[240:243], v[124:127], v[224:227], v[240:243]
ds_read_b128 v[124:127], v251 offset:9216
v_rcp_f16_sdwa v111, v111 dst_sel:WORD_0 dst_unused:UNUSED_PRESERVE src0_sel:WORD_0
v_mfma_f32_16x16x32_f16 v[244:247], v[184:187], v[224:227], v[244:247]
ds_read_b128 v[184:187], v248 offset:18688
v_rcp_f16_sdwa v109, v109 dst_sel:WORD_1 dst_unused:UNUSED_PRESERVE src0_sel:WORD_1
s_waitcnt lgkmcnt(6)
v_mfma_f32_16x16x32_bf16 v[208:211], v[188:191], v[64:67], v[208:211]
v_rcp_f16_sdwa v111, v111 dst_sel:WORD_1 dst_unused:UNUSED_PRESERVE src0_sel:WORD_1
s_waitcnt lgkmcnt(3)
v_mfma_f32_16x16x32_f16 v[72:75], v[160:163], v[116:119], v[72:75]
v_mfma_f32_16x16x32_f16 v[128:131], v[160:163], v[112:115], v[128:131]
ds_read_b128 v[160:163], v251 offset:10240
s_nop 2
v_cvt_pk_f16_f32 v208, v208, v209
v_mfma_f32_16x16x32_bf16 v[212:215], v[188:191], v[68:71], v[212:215]
v_cvt_pk_f16_f32 v210, v210, v211
v_pk_fma_f16 v209, v208, v208, s48
s_waitcnt lgkmcnt(3)
v_mfma_f32_16x16x32_f16 v[76:79], v[120:123], v[116:119], v[76:79]
v_pk_fma_f16 v211, v210, v210, s48
v_pk_mul_f16 v209, v208, v209
v_mfma_f32_16x16x32_f16 v[132:135], v[120:123], v[112:115], v[132:135]
ds_read_b128 v[120:123], v251 offset:13312
v_cvt_pkrtz_f16_f32 v212, v212, v213
v_mfma_f32_16x16x32_bf16 v[180:183], v[188:191], v[40:43], v[180:183]
ds_read_b128 v[188:191], v251 offset:12288
v_cvt_pkrtz_f16_f32 v213, v214, v215
s_waitcnt lgkmcnt(3)
v_mfma_f32_16x16x32_f16 v[80:83], v[124:127], v[116:119], v[80:83]
v_lshrrev_b64 v[212:213], 2, v[212:213]
v_and_b32_sdwa v214, s47, v212 dst_sel:DWORD dst_unused:UNUSED_PAD src0_sel:DWORD src1_sel:WORD_1
v_mfma_f32_16x16x32_bf16 v[0:3], v[184:187], v[48:51], 0
v_and_b32 v212, s47, v212
v_and_b32_sdwa v215, s47, v213 dst_sel:DWORD dst_unused:UNUSED_PAD src0_sel:DWORD src1_sel:WORD_1
v_mfma_f32_16x16x32_f16 v[136:139], v[124:127], v[112:115], v[136:139]
ds_read_b128 v[124:127], v248 offset:20736
ds_read_u16_d16_hi v214, v214
v_mfma_f32_16x16x32_bf16 v[4:7], v[184:187], v[52:55], 0
ds_read_u16 v212, v212
v_and_b32 v213, s47, v213
s_waitcnt lgkmcnt(5)
v_mfma_f32_16x16x32_f16 v[88:91], v[160:163], v[116:119], v[88:91]
ds_read_u16_d16_hi v215, v215
ds_read_u16 v213, v213
s_waitcnt lgkmcnt(5)
v_mfma_f32_16x16x32_f16 v[84:87], v[188:191], v[116:119], v[84:87]
v_pk_mul_f16 v10, v108, v109
v_pk_mul_f16 v211, v210, v211
v_mfma_f32_16x16x32_f16 v[140:143], v[188:191], v[112:115], v[140:143]
ds_read_b128 v[188:191], v251 offset:17408
s_setprio 3
v_cvt_pkrtz_f16_f32 v180, v180, v181
v_mfma_f32_16x16x32_bf16 v[224:227], v[184:187], v[24:27], 0
ds_read_b128 v[184:187], v251 offset:14336
v_cvt_pkrtz_f16_f32 v181, v182, v183
v_mfma_f32_16x16x32_f16 v[240:243], v[160:163], v[112:115], v[240:243]
ds_read_b128 v[160:163], v248 offset:22784
v_lshrrev_b64 v[180:181], 2, v[180:181]
v_mfma_f32_16x16x32_f16 v[92:95], v[120:123], v[116:119], v[92:95]
v_and_b32_sdwa v182, s47, v180 dst_sel:DWORD dst_unused:UNUSED_PAD src0_sel:DWORD src1_sel:WORD_1
v_and_b32 v180, s47, v180
s_waitcnt lgkmcnt(7)
v_mfma_f32_16x16x32_bf16 v[0:3], v[124:127], v[56:59], v[0:3]
ds_read_u16_d16_hi v182, v182
ds_read_u16 v180, v180
v_mfma_f32_16x16x32_f16 v[244:247], v[120:123], v[112:115], v[244:247]
ds_read_b128 v[120:123], v251 offset:15360
v_pk_mul_f16 v11, v110, v111
s_waitcnt vmcnt(5)
v_mfma_f32_16x16x32_bf16 v[128:131], v[18:21], v[164:167], v[128:131]
v_exp_f16_sdwa v209, v209 dst_sel:WORD_0 dst_unused:UNUSED_PRESERVE src0_sel:WORD_0
v_mfma_f32_16x16x32_bf16 v[132:135], v[16:19], v[164:167], v[132:135]
v_lshl_add_u64 v[14:15], v[192:193], 0, v[194:195]
v_exp_f16_sdwa v211, v211 dst_sel:WORD_0 dst_unused:UNUSED_PRESERVE src0_sel:WORD_0
s_waitcnt vmcnt(4)
v_mfma_f32_16x16x32_bf16 v[136:139], v[18:21], v[168:171], v[136:139]
v_and_b32_sdwa v183, s47, v181 dst_sel:DWORD dst_unused:UNUSED_PAD src0_sel:DWORD src1_sel:WORD_1
v_and_b32 v181, s47, v181
v_mfma_f32_16x16x32_bf16 v[140:143], v[16:19], v[168:171], v[140:143]
ds_read_u16_d16_hi v183, v183
ds_read_u16 v181, v181
s_waitcnt lgkmcnt(6)
v_mfma_f32_16x16x32_f16 v[72:75], v[184:187], v[220:223], v[72:75]
v_exp_f16_sdwa v209, v209 dst_sel:WORD_1 dst_unused:UNUSED_PRESERVE src0_sel:WORD_1
v_mfma_f32_16x16x32_bf16 v[4:7], v[124:127], v[60:63], v[4:7]
v_lshl_add_u64 v[98:99], v[196:197], 0, v[198:199]
v_exp_f16_sdwa v211, v211 dst_sel:WORD_1 dst_unused:UNUSED_PRESERVE src0_sel:WORD_1
v_mfma_f32_16x16x32_f16 v[128:131], v[184:187], v[216:219], v[128:131]
ds_read_b128 v[184:187], v251 offset:16384
v_pk_add_f16 v209, v209, 1.0 op_sel_hi:[1,0]
v_mfma_f32_16x16x32_bf16 v[224:227], v[124:127], v[32:35], v[224:227]
ds_read_b128 v[124:127], v251 offset:18432
v_pk_add_f16 v211, v211, 1.0 op_sel_hi:[1,0]
v_mfma_f32_16x16x32_f16 v[76:79], v[188:191], v[220:223], v[76:79]
v_rcp_f16_sdwa v209, v209 dst_sel:WORD_0 dst_unused:UNUSED_PRESERVE src0_sel:WORD_0
v_mfma_f32_16x16x32_f16 v[132:135], v[188:191], v[216:219], v[132:135]
ds_read_b128 v[188:191], v248 offset:24576
v_rcp_f16_sdwa v211, v211 dst_sel:WORD_0 dst_unused:UNUSED_PRESERVE src0_sel:WORD_0
s_waitcnt lgkmcnt(5)
v_mfma_f32_16x16x32_bf16 v[0:3], v[160:163], v[64:67], v[0:3]
v_rcp_f16_sdwa v209, v209 dst_sel:WORD_1 dst_unused:UNUSED_PRESERVE src0_sel:WORD_1
v_mfma_f32_16x16x32_f16 v[80:83], v[120:123], v[220:223], v[80:83]
v_rcp_f16_sdwa v211, v211 dst_sel:WORD_1 dst_unused:UNUSED_PRESERVE src0_sel:WORD_1
v_mfma_f32_16x16x32_f16 v[136:139], v[120:123], v[216:219], v[136:139]
ds_read_b128 v[120:123], v251 offset:63488
s_nop 2
v_cvt_pkrtz_f16_f32 v0, v0, v1
v_mfma_f32_16x16x32_bf16 v[4:7], v[160:163], v[68:71], v[4:7]
v_cvt_pkrtz_f16_f32 v1, v2, v3
v_lshrrev_b64 v[0:1], 2, v[0:1]
s_waitcnt lgkmcnt(2)
v_mfma_f32_16x16x32_f16 v[84:87], v[124:127], v[220:223], v[84:87]
s_setprio 2
v_and_b32_sdwa v2, s47, v0 dst_sel:DWORD dst_unused:UNUSED_PAD src0_sel:DWORD src1_sel:WORD_1
v_and_b32_e64 v0, s47, v0
v_mfma_f32_16x16x32_f16 v[140:143], v[124:127], v[216:219], v[140:143]
ds_read_b128 v[124:127], v252 offset:1024
ds_read_u16_d16_hi v2, v2
v_mfma_f32_16x16x32_bf16 v[224:227], v[160:163], v[40:43], v[224:227]
ds_read_b128 v[160:163], v251 offset:19456
ds_read_u16 v0, v0
v_mfma_f32_16x16x32_f16 v[88:91], v[184:187], v[220:223], v[88:91]
v_and_b32_sdwa v3, s47, v1 dst_sel:DWORD dst_unused:UNUSED_PAD src0_sel:DWORD src1_sel:WORD_1
v_and_b32_e64 v1, s47, v1
v_mfma_f32_16x16x32_f16 v[240:243], v[184:187], v[216:219], v[240:243]
ds_read_b128 v[184:187], v248 offset:26624
ds_read_u16_d16_hi v3, v3
s_waitcnt lgkmcnt(7)
v_mfma_f32_16x16x32_bf16 v[228:231], v[188:191], v[48:51], 0
ds_read_u16 v1, v1
v_cvt_pkrtz_f16_f32 v4, v4, v5
v_mfma_f32_16x16x32_bf16 v[112:115], v[188:191], v[52:55], 0
v_cvt_pkrtz_f16_f32 v5, v6, v7
v_lshrrev_b64 v[4:5], 2, v[4:5]
s_waitcnt vmcnt(3)
v_mfma_f32_16x16x32_bf16 v[240:243], v[18:21], v[100:103], v[240:243]
v_and_b32_sdwa v6, s47, v4 dst_sel:DWORD dst_unused:UNUSED_PAD src0_sel:DWORD src1_sel:WORD_1
v_and_b32 v4, s47, v4
s_waitcnt vmcnt(2)
v_mfma_f32_16x16x32_bf16 v[72:75], v[18:21], v[104:107], v[72:75]
ds_read_u16_d16_hi v6, v6
ds_read_u16 v4, v4
v_mfma_f32_16x16x32_bf16 v[76:79], v[16:19], v[104:107], v[76:79]
v_pk_mul_f16 v208, v208, v209
v_and_b32_sdwa v7, s47, v5 dst_sel:DWORD dst_unused:UNUSED_PAD src0_sel:DWORD src1_sel:WORD_1
s_waitcnt lgkmcnt(6)
v_mfma_f32_16x16x32_f16 v[92:95], v[160:163], v[220:223], v[92:95]
v_and_b32 v5, s47, v5
v_pk_mul_f16 v209, v210, v211
v_mfma_f32_16x16x32_f16 v[244:247], v[160:163], v[216:219], v[244:247]
ds_read_b128 v[160:163], v252 offset:2048
ds_read_u16_d16_hi v7, v7
v_mfma_f32_16x16x32_bf16 v[244:247], v[16:19], v[100:103], v[244:247]
ds_read_u16 v5, v5
v_lshl_add_u64 v[212:213], v[212:213], 0, v[214:215]
v_mfma_f32_16x16x32_f16 v[72:75], v[120:123], v[236:239], v[72:75]
v_cvt_pkrtz_f16_f32 v224, v224, v225
v_cvt_pkrtz_f16_f32 v225, v226, v227
v_mfma_f32_16x16x32_bf16 v[116:119], v[188:191], v[24:27], 0
ds_read_b128 v[188:191], v251 offset:64512
v_lshrrev_b64 v[224:225], 2, v[224:225]
v_mfma_f32_16x16x32_f16 v[128:131], v[120:123], v[232:235], v[128:131]
ds_read_b128 v[120:123], v248 offset:28672
s_nop 0
v_cvt_pk_bf16_f32 v72, v72, v73
v_mfma_f32_16x16x32_f16 v[76:79], v[124:127], v[236:239], v[76:79]
v_cvt_pk_bf16_f32 v73, v74, v75
v_and_b32_sdwa v226, s47, v224 dst_sel:DWORD dst_unused:UNUSED_PAD src0_sel:DWORD src1_sel:WORD_1
s_waitcnt lgkmcnt(7)
v_mfma_f32_16x16x32_bf16 v[228:231], v[184:187], v[56:59], v[228:231]
v_and_b32_e64 v224, s47, v224
v_cvt_pk_bf16_f32 v128, v128, v129
v_mfma_f32_16x16x32_f16 v[132:135], v[124:127], v[232:235], v[132:135]
ds_read_b128 v[124:127], v252
v_cvt_pk_bf16_f32 v129, v130, v131
v_mfma_f32_16x16x32_bf16 v[112:115], v[184:187], v[60:63], v[112:115]
v_cvt_pk_bf16_f32 v74, v76, v77
v_cvt_pk_bf16_f32 v75, v78, v79
v_mfma_f32_16x16x32_bf16 v[116:119], v[184:187], v[32:35], v[116:119]
ds_read_b128 v[76:79], v254 offset:8208
s_nop 0
v_cvt_pk_bf16_f32 v130, v132, v133
v_cvt_pk_bf16_f32 v131, v134, v135
s_setprio 1
ds_read_b128 v[132:135], v254 offset:8192
ds_read_b128 v[184:187], v252 offset:3072
s_waitcnt lgkmcnt(8)
v_mfma_f32_16x16x32_f16 v[84:87], v[160:163], v[236:239], v[84:87]
ds_read_u16_d16_hi v226, v226
ds_read_u16 v224, v224
s_waitcnt lgkmcnt(7)
v_mfma_f32_16x16x32_f16 v[80:83], v[188:191], v[236:239], v[80:83]
v_and_b32_sdwa v227, s47, v225 dst_sel:DWORD dst_unused:UNUSED_PAD src0_sel:DWORD src1_sel:WORD_1
v_and_b32_e64 v225, s47, v225
v_mfma_f32_16x16x32_f16 v[136:139], v[188:191], v[232:235], v[136:139]
ds_read_b128 v[188:191], v251 offset:8192
ds_read_u16_d16_hi v227, v227
v_mfma_f32_16x16x32_f16 v[140:143], v[160:163], v[232:235], v[140:143]
ds_read_b128 v[160:163], v248 offset:24832
ds_read_u16 v225, v225
s_waitcnt lgkmcnt(10)
v_mfma_f32_16x16x32_bf16 v[228:231], v[120:123], v[64:67], v[228:231]
v_lshl_add_u64 v[180:181], v[180:181], 0, v[182:183]
v_cvt_pk_bf16_f32 v136, v136, v137
v_cvt_pk_bf16_f32 v137, v138, v139
s_waitcnt lgkmcnt(9)
v_mfma_f32_16x16x32_f16 v[88:91], v[124:127], v[236:239], v[88:91]
v_cvt_pk_bf16_f32 v138, v140, v141
v_cvt_pk_bf16_f32 v139, v142, v143
v_mfma_f32_16x16x32_f16 v[240:243], v[124:127], v[232:235], v[240:243]
ds_read_b128 v[140:143], v254 offset:8320
ds_read_b128 v[124:127], v248 offset:26880
v_mfma_f32_16x16x32_bf16 v[112:115], v[120:123], v[68:71], v[112:115]
v_cvt_pk_f16_f32 v228, v228, v229
v_cvt_pk_f16_f32 v230, v230, v231
s_waitcnt lgkmcnt(8)
v_mfma_f32_16x16x32_f16 v[92:95], v[184:187], v[236:239], v[92:95]
v_pk_fma_f16 v229, v228, v228, s48
v_cvt_pk_bf16_f32 v240, v240, v241
v_cvt_pk_bf16_f32 v241, v242, v243
v_mfma_f32_16x16x32_f16 v[244:247], v[184:187], v[232:235], v[244:247]
ds_read_b128 v[184:187], v251 offset:9216
v_cvt_pkrtz_f16_f32 v112, v112, v113
v_mfma_f32_16x16x32_bf16 v[116:119], v[120:123], v[40:43], v[116:119]
ds_read_b128 v[120:123], v251 offset:11264
v_cvt_pkrtz_f16_f32 v113, v114, v115
s_waitcnt vmcnt(1)
v_mfma_f32_16x16x32_bf16 v[80:83], v[18:21], v[200:203], v[80:83]
v_lshrrev_b64 v[112:113], 2, v[112:113]
v_cvt_pk_bf16_f32 v242, v244, v245
v_cvt_pk_bf16_f32 v243, v246, v247
v_mfma_f32_16x16x32_bf16 v[84:87], v[16:19], v[200:203], v[84:87]
ds_read_b128 v[244:247], v254
v_and_b32_sdwa v114, s47, v112 dst_sel:DWORD dst_unused:UNUSED_PAD src0_sel:DWORD src1_sel:WORD_1
s_waitcnt vmcnt(0)
v_mfma_f32_16x16x32_bf16 v[88:91], v[18:21], v[204:207], v[88:91]
v_cvt_pk_bf16_f32 v80, v80, v81
v_cvt_pk_bf16_f32 v81, v82, v83
v_mfma_f32_16x16x32_bf16 v[92:95], v[16:19], v[204:207], v[92:95]
v_and_b32_e64 v112, s47, v112
v_cvt_pk_bf16_f32 v82, v84, v85
v_cvt_pk_bf16_f32 v83, v86, v87
s_waitcnt lgkmcnt(5)
v_mfma_f32_16x16x32_f16 v[164:167], v[188:191], v[152:155], v[132:135]
ds_read_b128 v[84:87], v254 offset:8336
v_cvt_pk_bf16_f32 v88, v88, v89
v_cvt_pk_bf16_f32 v89, v90, v91
v_mfma_f32_16x16x32_bf16 v[108:111], v[160:163], v[48:51], 0
v_cvt_pk_bf16_f32 v90, v92, v93
v_cvt_pk_bf16_f32 v91, v94, v95
v_mfma_f32_16x16x32_f16 v[168:171], v[188:191], v[148:151], v[132:135]
ds_read_b128 v[92:95], v254 offset:16
buffer_store_dwordx4 v[128:131], v253, s[8:11], s71 offen sc1
buffer_store_dwordx4 v[136:139], v253, s[8:11], s71 offen offset:64 sc1
v_mfma_f32_16x16x32_f16 v[132:135], v[188:191], v[144:147], v[132:135]
ds_read_b128 v[188:191], v251 offset:12288
ds_read_u16_d16_hi v114, v114
v_mfma_f32_16x16x32_bf16 v[192:195], v[160:163], v[52:55], 0
ds_read_u16 v112, v112
v_and_b32_sdwa v115, s47, v113 dst_sel:DWORD dst_unused:UNUSED_PAD src0_sel:DWORD src1_sel:WORD_1
s_waitcnt lgkmcnt(5)
v_mfma_f32_16x16x32_f16 v[216:219], v[120:123], v[152:155], v[76:79]
s_setprio 0
v_and_b32_e64 v113, s47, v113
v_pk_fma_f16 v231, v230, v230, s48
v_mfma_f32_16x16x32_bf16 v[196:199], v[160:163], v[24:27], 0
ds_read_b128 v[160:163], v248 offset:28928
ds_read_u16_d16_hi v115, v115
v_mfma_f32_16x16x32_f16 v[220:223], v[120:123], v[148:151], v[76:79]
ds_read_u16 v113, v113
v_pk_mul_f16 v229, v228, v229
v_mfma_f32_16x16x32_f16 v[76:79], v[120:123], v[144:147], v[76:79]
ds_read_b128 v[120:123], v251 offset:10240
v_pk_mul_f16 v231, v230, v231
v_mfma_f32_16x16x32_bf16 v[108:111], v[124:127], v[56:59], v[108:111]
v_cvt_pkrtz_f16_f32 v116, v116, v117
v_cvt_pkrtz_f16_f32 v117, v118, v119
v_mfma_f32_16x16x32_f16 v[100:103], v[184:187], v[152:155], v[140:143]
v_lshrrev_b64 v[116:117], 2, v[116:117]
v_and_b32_sdwa v118, s47, v116 dst_sel:DWORD dst_unused:UNUSED_PAD src0_sel:DWORD src1_sel:WORD_1
v_mfma_f32_16x16x32_bf16 v[192:195], v[124:127], v[60:63], v[192:195]
v_and_b32_e64 v116, s47, v116
v_lshl_add_u64 v[210:211], v[0:1], 0, v[2:3]
v_mfma_f32_16x16x32_f16 v[104:107], v[184:187], v[148:151], v[140:143]
ds_read_u16_d16_hi v118, v118
ds_read_u16 v116, v116
v_exp_f16_sdwa v229, v229 dst_sel:WORD_0 dst_unused:UNUSED_PRESERVE src0_sel:WORD_0
v_mfma_f32_16x16x32_f16 v[140:143], v[184:187], v[144:147], v[140:143]
ds_read_b128 v[184:187], v251 offset:13312
v_exp_f16_sdwa v231, v231 dst_sel:WORD_0 dst_unused:UNUSED_PRESERVE src0_sel:WORD_0
v_mfma_f32_16x16x32_bf16 v[196:199], v[124:127], v[32:35], v[196:199]
ds_read_b128 v[124:127], v248 offset:30720
v_and_b32_sdwa v119, s47, v117 dst_sel:DWORD dst_unused:UNUSED_PAD src0_sel:DWORD src1_sel:WORD_1
s_waitcnt lgkmcnt(7)
v_mfma_f32_16x16x32_f16 v[232:235], v[188:191], v[152:155], v[84:87]
v_and_b32 v117, s47, v117
v_lshl_add_u64 v[214:215], v[4:5], 0, v[6:7]
v_mfma_f32_16x16x32_f16 v[236:239], v[188:191], v[148:151], v[84:87]
ds_read_u16_d16_hi v119, v119
ds_read_u16 v117, v117
v_mfma_f32_16x16x32_bf16 v[108:111], v[160:163], v[64:67], v[108:111]
v_exp_f16_sdwa v229, v229 dst_sel:WORD_1 dst_unused:UNUSED_PRESERVE src0_sel:WORD_1
v_mfma_f32_16x16x32_f16 v[84:87], v[188:191], v[144:147], v[84:87]
ds_read_b128 v[188:191], v251 offset:14336
v_exp_f16_sdwa v231, v231 dst_sel:WORD_1 dst_unused:UNUSED_PRESERVE src0_sel:WORD_1
v_mfma_f32_16x16x32_bf16 v[192:195], v[160:163], v[68:71], v[192:195]
v_lshl_add_u64 v[182:183], v[224:225], 0, v[226:227]
v_pk_add_f16 v229, v229, 1.0 op_sel_hi:[1,0]
s_waitcnt lgkmcnt(6)
v_mfma_f32_16x16x32_f16 v[200:203], v[120:123], v[152:155], v[244:247]
s_setprio 3
v_pk_add_f16 v231, v231, 1.0 op_sel_hi:[1,0]
v_rcp_f16_sdwa v229, v229 dst_sel:WORD_0 dst_unused:UNUSED_PRESERVE src0_sel:WORD_0
v_mfma_f32_16x16x32_f16 v[204:207], v[120:123], v[148:151], v[244:247]
v_rcp_f16_sdwa v231, v231 dst_sel:WORD_0 dst_unused:UNUSED_PRESERVE src0_sel:WORD_0
v_mfma_f32_16x16x32_bf16 v[196:199], v[160:163], v[40:43], v[196:199]
ds_read_b128 v[160:163], v248 offset:32768
v_cvt_pkrtz_f16_f32 v192, v192, v193
v_mfma_f32_16x16x32_f16 v[244:247], v[120:123], v[144:147], v[244:247]
ds_read_b128 v[120:123], v251 offset:17408
v_cvt_pkrtz_f16_f32 v193, v194, v195
s_waitcnt lgkmcnt(4)
v_mfma_f32_16x16x32_bf16 v[128:131], v[124:127], v[48:51], 0
v_lshrrev_b64 v[192:193], 2, v[192:193]
v_and_b32_sdwa v194, s47, v192 dst_sel:DWORD dst_unused:UNUSED_PAD src0_sel:DWORD src1_sel:WORD_1
v_mfma_f32_16x16x32_f16 v[4:7], v[184:187], v[152:155], v[92:95]
v_and_b32 v192, s47, v192
v_cvt_pk_f16_f32 v108, v108, v109
v_mfma_f32_16x16x32_f16 v[224:227], v[184:187], v[148:151], v[92:95]
ds_read_u16_d16_hi v194, v194
ds_read_u16 v192, v192
v_mfma_f32_16x16x32_bf16 v[136:139], v[124:127], v[52:55], 0
v_rcp_f16_sdwa v229, v229 dst_sel:WORD_1 dst_unused:UNUSED_PRESERVE src0_sel:WORD_1
v_mfma_f32_16x16x32_f16 v[92:95], v[184:187], v[144:147], v[92:95]
ds_read_b128 v[184:187], v251 offset:15360
v_cvt_pk_f16_f32 v110, v110, v111
v_mfma_f32_16x16x32_bf16 v[0:3], v[124:127], v[24:27], 0
ds_read_b128 v[124:127], v248 offset:34816
v_pk_fma_f16 v109, v108, v108, s48
s_waitcnt lgkmcnt(5)
v_mfma_f32_16x16x32_f16 v[164:167], v[188:191], v[176:179], v[164:167]
v_rcp_f16_sdwa v231, v231 dst_sel:WORD_1 dst_unused:UNUSED_PRESERVE src0_sel:WORD_1
v_mfma_f32_16x16x32_f16 v[168:171], v[188:191], v[156:159], v[168:171]
v_and_b32_sdwa v195, s47, v193 dst_sel:DWORD dst_unused:UNUSED_PAD src0_sel:DWORD src1_sel:WORD_1
v_and_b32 v193, s47, v193
v_mfma_f32_16x16x32_bf16 v[128:131], v[160:163], v[56:59], v[128:131]
ds_read_u16_d16_hi v195, v195
ds_read_u16 v193, v193
v_pk_fma_f16 v111, v110, v110, s48
v_mfma_f32_16x16x32_f16 v[132:135], v[188:191], v[172:175], v[132:135]
ds_read_b128 v[188:191], v251 offset:18432
v_pk_mul_f16 v109, v108, v109
v_pk_mul_f16 v228, v228, v229
v_mfma_f32_16x16x32_bf16 v[136:139], v[160:163], v[60:63], v[136:139]
v_pk_mul_f16 v111, v110, v111
v_cvt_pkrtz_f16_f32 v196, v196, v197
s_waitcnt lgkmcnt(6)
v_mfma_f32_16x16x32_f16 v[216:219], v[120:123], v[176:179], v[216:219]
v_cvt_pkrtz_f16_f32 v197, v198, v199
v_lshrrev_b64 v[196:197], 2, v[196:197]
v_and_b32_sdwa v198, s47, v196 dst_sel:DWORD dst_unused:UNUSED_PAD src0_sel:DWORD src1_sel:WORD_1
v_and_b32 v196, s47, v196
v_pk_mul_f16 v229, v230, v231
v_exp_f16_sdwa v109, v109 dst_sel:WORD_0 dst_unused:UNUSED_PRESERVE src0_sel:WORD_0
v_lshl_add_u64 v[112:113], v[112:113], 0, v[114:115]
v_mfma_f32_16x16x32_f16 v[220:223], v[120:123], v[156:159], v[220:223]
ds_read_u16_d16_hi v198, v198
ds_read_u16 v196, v196
s_setprio 2
v_mfma_f32_16x16x32_bf16 v[0:3], v[160:163], v[32:35], v[0:3]
ds_read_b128 v[160:163], v248 offset:30976
v_exp_f16_sdwa v111, v111 dst_sel:WORD_0 dst_unused:UNUSED_PRESERVE src0_sel:WORD_0
v_and_b32_sdwa v199, s47, v197 dst_sel:DWORD dst_unused:UNUSED_PAD src0_sel:DWORD src1_sel:WORD_1
v_and_b32_e64 v197, s47, v197
v_mfma_f32_16x16x32_f16 v[76:79], v[120:123], v[172:175], v[76:79]
ds_read_u16_d16_hi v199, v199
ds_read_u16 v197, v197
ds_read_b128 v[120:123], v251 offset:16384
s_waitcnt lgkmcnt(7)
v_mfma_f32_16x16x32_bf16 v[128:131], v[124:127], v[64:67], v[128:131]
v_exp_f16_sdwa v109, v109 dst_sel:WORD_1 dst_unused:UNUSED_PRESERVE src0_sel:WORD_1
v_mfma_f32_16x16x32_f16 v[100:103], v[184:187], v[176:179], v[100:103]
v_lshl_add_u64 v[116:117], v[116:117], 0, v[118:119]
v_exp_f16_sdwa v111, v111 dst_sel:WORD_1 dst_unused:UNUSED_PRESERVE src0_sel:WORD_1
v_mfma_f32_16x16x32_f16 v[104:107], v[184:187], v[156:159], v[104:107]
v_pk_add_f16 v109, v109, 1.0 op_sel_hi:[1,0]
v_pk_add_f16 v111, v111, 1.0 op_sel_hi:[1,0]
v_mfma_f32_16x16x32_bf16 v[136:139], v[124:127], v[68:71], v[136:139]
v_rcp_f16_sdwa v109, v109 dst_sel:WORD_0 dst_unused:UNUSED_PRESERVE src0_sel:WORD_0
v_mfma_f32_16x16x32_f16 v[140:143], v[184:187], v[172:175], v[140:143]
ds_read_b128 v[184:187], v251 offset:19456
v_rcp_f16_sdwa v111, v111 dst_sel:WORD_0 dst_unused:UNUSED_PRESERVE src0_sel:WORD_0
v_mfma_f32_16x16x32_bf16 v[0:3], v[124:127], v[40:43], v[0:3]
ds_read_b128 v[124:127], v248 offset:33024
v_cvt_pkrtz_f16_f32 v128, v128, v129
s_waitcnt lgkmcnt(6)
v_mfma_f32_16x16x32_f16 v[232:235], v[188:191], v[176:179], v[232:235]
v_cvt_pkrtz_f16_f32 v129, v130, v131
v_lshrrev_b64 v[128:129], 2, v[128:129]
v_mfma_f32_16x16x32_f16 v[236:239], v[188:191], v[156:159], v[236:239]
v_and_b32_sdwa v130, s47, v128 dst_sel:DWORD dst_unused:UNUSED_PAD src0_sel:DWORD src1_sel:WORD_1
v_and_b32_e64 v128, s47, v128
s_waitcnt lgkmcnt(4)
v_mfma_f32_16x16x32_bf16 v[144:147], v[160:163], v[48:51], 0
ds_read_u16_d16_hi v130, v130
ds_read_u16 v128, v128
v_mfma_f32_16x16x32_f16 v[84:87], v[188:191], v[172:175], v[84:87]
ds_read_b128 v[188:191], v248 offset:35072
v_rcp_f16_sdwa v109, v109 dst_sel:WORD_1 dst_unused:UNUSED_PRESERVE src0_sel:WORD_1
v_mfma_f32_16x16x32_bf16 v[148:151], v[160:163], v[52:55], 0
v_and_b32_sdwa v131, s47, v129 dst_sel:DWORD dst_unused:UNUSED_PAD src0_sel:DWORD src1_sel:WORD_1
v_and_b32_e64 v129, s47, v129
s_waitcnt lgkmcnt(5)
v_mfma_f32_16x16x32_f16 v[200:203], v[120:123], v[176:179], v[200:203]
s_setprio 1
buffer_store_dwordx4 v[240:243], v253, s[8:11], s71 offen offset:128 sc1
buffer_store_dwordx4 v[72:75], v253, s[8:11], s71 offen offset:192 sc1
ds_read_u16_d16_hi v131, v131
v_mfma_f32_16x16x32_f16 v[204:207], v[120:123], v[156:159], v[204:207]
ds_read_u16 v129, v129
v_rcp_f16_sdwa v111, v111 dst_sel:WORD_1 dst_unused:UNUSED_PRESERVE src0_sel:WORD_1
v_mfma_f32_16x16x32_bf16 v[152:155], v[160:163], v[24:27], 0
ds_read_b128 v[160:163], v251 offset:23552
v_cvt_pkrtz_f16_f32 v136, v136, v137
v_mfma_f32_16x16x32_f16 v[244:247], v[120:123], v[172:175], v[244:247]
ds_read_b128 v[120:123], v249
buffer_load_dwordx4 v[240:243], v253, s[4:7], s70 offen
buffer_load_dwordx4 v[72:75], v253, s[4:7], s70 offen offset:64
s_waitcnt lgkmcnt(7)
v_mfma_f32_16x16x32_bf16 v[144:147], v[124:127], v[56:59], v[144:147]
v_cvt_pkrtz_f16_f32 v137, v138, v139
v_lshrrev_b64 v[136:137], 2, v[136:137]
v_mfma_f32_16x16x32_f16 v[4:7], v[184:187], v[176:179], v[4:7]
ds_read_b128 v[176:179], v251 offset:20480
v_and_b32_sdwa v138, s47, v136 dst_sel:DWORD dst_unused:UNUSED_PAD src0_sel:DWORD src1_sel:WORD_1
v_and_b32 v136, s47, v136
v_mfma_f32_16x16x32_f16 v[224:227], v[184:187], v[156:159], v[224:227]
ds_read_u16_d16_hi v138, v138
ds_read_u16 v136, v136
v_pk_mul_f16 v230, v108, v109
v_mfma_f32_16x16x32_bf16 v[148:151], v[124:127], v[60:63], v[148:151]
v_and_b32_sdwa v139, s47, v137 dst_sel:DWORD dst_unused:UNUSED_PAD src0_sel:DWORD src1_sel:WORD_1
v_and_b32_e64 v137, s47, v137
v_pk_mul_f16 v231, v110, v111
v_mfma_f32_16x16x32_f16 v[92:95], v[184:187], v[172:175], v[92:95]
ds_read_u16_d16_hi v139, v139
ds_read_u16 v137, v137
ds_read_b128 v[184:187], v251 offset:24576
v_lshl_add_u64 v[114:115], v[192:193], 0, v[194:195]
v_mfma_f32_16x16x32_bf16 v[152:155], v[124:127], v[32:35], v[152:155]
ds_read_b128 v[124:127], v251 offset:21504
buffer_load_dwordx4 v[172:175], v253, s[4:7], s70 offen offset:128
buffer_load_dwordx4 v[156:159], v253, s[4:7], s70 offen offset:192
s_waitcnt lgkmcnt(6)
v_mfma_f32_16x16x32_f16 v[164:167], v[176:179], v[96:99], v[164:167]
v_cvt_pkrtz_f16_f32 v0, v0, v1
v_cvt_pkrtz_f16_f32 v1, v2, v3
v_lshrrev_b64 v[0:1], 2, v[0:1]
v_and_b32_sdwa v2, s47, v0 dst_sel:DWORD dst_unused:UNUSED_PAD src0_sel:DWORD src1_sel:WORD_1
v_and_b32 v0, s47, v0
v_mfma_f32_16x16x32_f16 v[168:171], v[176:179], v[12:15], v[168:171]
ds_read_u16_d16_hi v2, v2
ds_read_u16 v0, v0
v_and_b32_sdwa v3, s47, v1 dst_sel:DWORD dst_unused:UNUSED_PAD src0_sel:DWORD src1_sel:WORD_1
v_and_b32_e64 v1, s47, v1
v_mfma_f32_16x16x32_bf16 v[144:147], v[188:191], v[64:67], v[144:147]
ds_read_u16_d16_hi v3, v3
ds_read_u16 v1, v1
v_mfma_f32_16x16x32_f16 v[132:135], v[176:179], v[8:11], v[132:135]
ds_read_b128 v[176:179], v249 offset:2048
v_lshl_add_u64 v[118:119], v[196:197], 0, v[198:199]
v_mfma_f32_16x16x32_bf16 v[148:151], v[188:191], v[68:71], v[148:151]
s_nop 1
v_cvt_pk_f16_f32 v144, v144, v145
v_mfma_f32_16x16x32_f16 v[216:219], v[160:163], v[96:99], v[216:219]
s_setprio 0
v_cvt_pk_f16_f32 v146, v146, v147
v_pk_fma_f16 v145, v144, v144, s48
v_mfma_f32_16x16x32_f16 v[220:223], v[160:163], v[12:15], v[220:223]
v_cvt_pkrtz_f16_f32 v148, v148, v149
v_cvt_pkrtz_f16_f32 v149, v150, v151
v_mfma_f32_16x16x32_bf16 v[152:155], v[188:191], v[40:43], v[152:155]
ds_read_b128 v[188:191], v251 offset:22528
v_lshrrev_b64 v[148:149], 2, v[148:149]
v_mfma_f32_16x16x32_f16 v[76:79], v[160:163], v[8:11], v[76:79]
ds_read_b128 v[160:163], v251 offset:25600
v_and_b32_sdwa v150, s47, v148 dst_sel:DWORD dst_unused:UNUSED_PAD src0_sel:DWORD src1_sel:WORD_1
v_mfma_f32_16x16x32_bf16 v[108:111], v[120:123], v[48:51], 0
v_and_b32 v148, s47, v148
v_and_b32_sdwa v151, s47, v149 dst_sel:DWORD dst_unused:UNUSED_PAD src0_sel:DWORD src1_sel:WORD_1
s_waitcnt lgkmcnt(6)
v_mfma_f32_16x16x32_f16 v[100:103], v[124:127], v[96:99], v[100:103]
ds_read_u16_d16_hi v150, v150
ds_read_u16 v148, v148
v_mfma_f32_16x16x32_f16 v[104:107], v[124:127], v[12:15], v[104:107]
v_and_b32_e64 v149, s47, v149
v_pk_fma_f16 v147, v146, v146, s48
v_mfma_f32_16x16x32_bf16 v[192:195], v[120:123], v[52:55], 0
ds_read_u16_d16_hi v151, v151
ds_read_u16 v149, v149
v_mfma_f32_16x16x32_f16 v[140:143], v[124:127], v[8:11], v[140:143]
ds_read_b128 v[124:127], v251 offset:26624
v_pk_mul_f16 v145, v144, v145
v_mfma_f32_16x16x32_f16 v[232:235], v[184:187], v[96:99], v[232:235]
v_pk_mul_f16 v147, v146, v147
v_cvt_pkrtz_f16_f32 v152, v152, v153
v_mfma_f32_16x16x32_bf16 v[196:199], v[120:123], v[24:27], 0
ds_read_b128 v[120:123], v249 offset:4096
v_cvt_pkrtz_f16_f32 v153, v154, v155
v_mfma_f32_16x16x32_f16 v[236:239], v[184:187], v[12:15], v[236:239]
v_lshrrev_b64 v[152:153], 2, v[152:153]
v_and_b32_sdwa v154, s47, v152 dst_sel:DWORD dst_unused:UNUSED_PAD src0_sel:DWORD src1_sel:WORD_1
s_waitcnt lgkmcnt(7)
v_mfma_f32_16x16x32_bf16 v[108:111], v[176:179], v[56:59], v[108:111]
v_and_b32 v152, s47, v152
v_lshl_add_u64 v[128:129], v[128:129], 0, v[130:131]
v_mfma_f32_16x16x32_f16 v[84:87], v[184:187], v[8:11], v[84:87]
ds_read_b128 v[184:187], v249 offset:256
ds_read_u16_d16_hi v154, v154
v_mfma_f32_16x16x32_f16 v[200:203], v[188:191], v[96:99], v[200:203]
s_setprio 3
ds_read_u16 v152, v152
v_exp_f16_sdwa v145, v145 dst_sel:WORD_0 dst_unused:UNUSED_PRESERVE src0_sel:WORD_0
v_mfma_f32_16x16x32_bf16 v[192:195], v[176:179], v[60:63], v[192:195]
v_exp_f16_sdwa v147, v147 dst_sel:WORD_0 dst_unused:UNUSED_PRESERVE src0_sel:WORD_0
v_mfma_f32_16x16x32_f16 v[204:207], v[188:191], v[12:15], v[204:207]
v_and_b32_sdwa v155, s47, v153 dst_sel:DWORD dst_unused:UNUSED_PAD src0_sel:DWORD src1_sel:WORD_1
v_and_b32 v153, s47, v153
v_mfma_f32_16x16x32_bf16 v[196:199], v[176:179], v[32:35], v[196:199]
ds_read_b128 v[176:179], v251 offset:29696
ds_read_u16_d16_hi v155, v155
v_mfma_f32_16x16x32_f16 v[244:247], v[188:191], v[8:11], v[244:247]
ds_read_b128 v[188:191], v251 offset:27648
ds_read_u16 v153, v153
s_waitcnt lgkmcnt(8)
v_mfma_f32_16x16x32_f16 v[4:7], v[160:163], v[96:99], v[4:7]
v_lshl_add_u64 v[136:137], v[136:137], 0, v[138:139]
v_exp_f16_sdwa v145, v145 dst_sel:WORD_1 dst_unused:UNUSED_PRESERVE src0_sel:WORD_1
s_waitcnt lgkmcnt(7)
v_mfma_f32_16x16x32_bf16 v[108:111], v[120:123], v[64:67], v[108:111]
v_exp_f16_sdwa v147, v147 dst_sel:WORD_1 dst_unused:UNUSED_PRESERVE src0_sel:WORD_1
v_mfma_f32_16x16x32_f16 v[224:227], v[160:163], v[12:15], v[224:227]
v_lshl_add_u64 v[0:1], v[0:1], 0, v[2:3]
v_pk_add_f16 v145, v145, 1.0 op_sel_hi:[1,0]
v_mfma_f32_16x16x32_bf16 v[192:195], v[120:123], v[68:71], v[192:195]
v_pk_add_f16 v147, v147, 1.0 op_sel_hi:[1,0]
v_rcp_f16_sdwa v145, v145 dst_sel:WORD_0 dst_unused:UNUSED_PRESERVE src0_sel:WORD_0
v_mfma_f32_16x16x32_f16 v[92:95], v[160:163], v[8:11], v[92:95]
ds_read_b128 v[160:163], v249 offset:2304
v_rcp_f16_sdwa v147, v147 dst_sel:WORD_0 dst_unused:UNUSED_PRESERVE src0_sel:WORD_0
v_mfma_f32_16x16x32_f16 v[164:167], v[124:127], v[180:183], v[164:167]
s_nop 1
v_cvt_pkrtz_f16_f32 v192, v192, v193
v_cvt_pkrtz_f16_f32 v193, v194, v195
v_mfma_f32_16x16x32_bf16 v[196:199], v[120:123], v[40:43], v[196:199]
ds_read_b128 v[120:123], v251 offset:30720
v_lshrrev_b64 v[192:193], 2, v[192:193]
v_mfma_f32_16x16x32_f16 v[168:171], v[124:127], v[212:215], v[168:171]
v_and_b32_sdwa v194, s47, v192 dst_sel:DWORD dst_unused:UNUSED_PAD src0_sel:DWORD src1_sel:WORD_1
v_and_b32 v192, s47, v192
s_waitcnt lgkmcnt(3)
v_mfma_f32_16x16x32_bf16 v[8:11], v[184:187], v[48:51], 0
ds_read_u16_d16_hi v194, v194
ds_read_u16 v192, v192
v_mfma_f32_16x16x32_f16 v[132:135], v[124:127], v[208:211], v[132:135]
ds_read_b128 v[124:127], v249 offset:4352
s_setprio 2
v_cvt_pk_f16_f32 v108, v108, v109
v_mfma_f32_16x16x32_f16 v[216:219], v[176:179], v[180:183], v[216:219]
v_rcp_f16_sdwa v145, v145 dst_sel:WORD_1 dst_unused:UNUSED_PRESERVE src0_sel:WORD_1
v_mfma_f32_16x16x32_bf16 v[12:15], v[184:187], v[52:55], 0
v_cvt_pk_f16_f32 v110, v110, v111
v_pk_fma_f16 v109, v108, v108, s48
v_mfma_f32_16x16x32_f16 v[220:223], v[176:179], v[212:215], v[220:223]
v_rcp_f16_sdwa v147, v147 dst_sel:WORD_1 dst_unused:UNUSED_PRESERVE src0_sel:WORD_1
v_mfma_f32_16x16x32_bf16 v[96:99], v[184:187], v[24:27], 0
ds_read_b128 v[184:187], v251 offset:28672
v_and_b32_sdwa v195, s47, v193 dst_sel:DWORD dst_unused:UNUSED_PAD src0_sel:DWORD src1_sel:WORD_1
v_mfma_f32_16x16x32_f16 v[76:79], v[176:179], v[208:211], v[76:79]
ds_read_b128 v[176:179], v251 offset:31744
v_and_b32 v193, s47, v193
v_mfma_f32_16x16x32_f16 v[100:103], v[188:191], v[180:183], v[100:103]
buffer_store_dwordx4 v[80:83], v253, s[8:11], s71 offen offset:256 sc1
buffer_store_dwordx4 v[88:91], v253, s[8:11], s71 offen offset:320 sc1
buffer_load_dwordx4 v[80:83], v253, s[4:7], s70 offen offset:256
buffer_load_dwordx4 v[88:91], v253, s[4:7], s70 offen offset:320
s_waitcnt lgkmcnt(5)
v_mfma_f32_16x16x32_bf16 v[8:11], v[160:163], v[56:59], v[8:11]
ds_read_u16_d16_hi v195, v195
ds_read_u16 v193, v193
v_pk_fma_f16 v111, v110, v110, s48
v_mfma_f32_16x16x32_f16 v[104:107], v[188:191], v[212:215], v[104:107]
v_pk_mul_f16 v109, v108, v109
v_pk_mul_f16 v130, v144, v145
v_mfma_f32_16x16x32_bf16 v[12:15], v[160:163], v[60:63], v[12:15]
v_pk_mul_f16 v111, v110, v111
v_cvt_pkrtz_f16_f32 v196, v196, v197
v_mfma_f32_16x16x32_f16 v[140:143], v[188:191], v[208:211], v[140:143]
ds_read_b128 v[188:191], v249 offset:6144
v_cvt_pkrtz_f16_f32 v197, v198, v199
v_lshrrev_b64 v[196:197], 2, v[196:197]
v_and_b32_sdwa v198, s47, v196 dst_sel:DWORD dst_unused:UNUSED_PAD src0_sel:DWORD src1_sel:WORD_1
v_and_b32_e64 v196, s47, v196
v_pk_mul_f16 v131, v146, v147
v_exp_f16_sdwa v109, v109 dst_sel:WORD_0 dst_unused:UNUSED_PRESERVE src0_sel:WORD_0
v_mfma_f32_16x16x32_f16 v[232:235], v[120:123], v[180:183], v[232:235]
ds_read_u16_d16_hi v198, v198
ds_read_u16 v196, v196
v_lshl_add_u64 v[138:139], v[148:149], 0, v[150:151]
v_mfma_f32_16x16x32_bf16 v[96:99], v[160:163], v[32:35], v[96:99]
ds_read_b128 v[160:163], v251 offset:32768
v_exp_f16_sdwa v111, v111 dst_sel:WORD_0 dst_unused:UNUSED_PRESERVE src0_sel:WORD_0
v_mfma_f32_16x16x32_f16 v[236:239], v[120:123], v[212:215], v[236:239]
v_and_b32_sdwa v199, s47, v197 dst_sel:DWORD dst_unused:UNUSED_PAD src0_sel:DWORD src1_sel:WORD_1
v_and_b32_e64 v197, s47, v197
s_waitcnt lgkmcnt(5)
v_mfma_f32_16x16x32_bf16 v[8:11], v[124:127], v[64:67], v[8:11]
ds_read_u16_d16_hi v199, v199
ds_read_u16 v197, v197
v_mfma_f32_16x16x32_f16 v[84:87], v[120:123], v[208:211], v[84:87]
ds_read_b128 v[120:123], v249 offset:8192
v_exp_f16_sdwa v109, v109 dst_sel:WORD_1 dst_unused:UNUSED_PRESERVE src0_sel:WORD_1
s_setprio 1
v_mfma_f32_16x16x32_f16 v[200:203], v[184:187], v[180:183], v[200:203]
v_lshl_add_u64 v[2:3], v[152:153], 0, v[154:155]
v_exp_f16_sdwa v111, v111 dst_sel:WORD_1 dst_unused:UNUSED_PRESERVE src0_sel:WORD_1
v_mfma_f32_16x16x32_bf16 v[12:15], v[124:127], v[68:71], v[12:15]
v_pk_add_f16 v109, v109, 1.0 op_sel_hi:[1,0]
v_pk_add_f16 v111, v111, 1.0 op_sel_hi:[1,0]
v_mfma_f32_16x16x32_f16 v[204:207], v[184:187], v[212:215], v[204:207]
v_rcp_f16_sdwa v109, v109 dst_sel:WORD_0 dst_unused:UNUSED_PRESERVE src0_sel:WORD_0
v_mfma_f32_16x16x32_bf16 v[96:99], v[124:127], v[40:43], v[96:99]
ds_read_b128 v[124:127], v251 offset:35840
v_rcp_f16_sdwa v111, v111 dst_sel:WORD_0 dst_unused:UNUSED_PRESERVE src0_sel:WORD_0
v_mfma_f32_16x16x32_f16 v[244:247], v[184:187], v[208:211], v[244:247]
ds_read_b128 v[184:187], v251 offset:33792
v_cvt_pkrtz_f16_f32 v8, v8, v9
v_mfma_f32_16x16x32_f16 v[4:7], v[176:179], v[180:183], v[4:7]
v_cvt_pkrtz_f16_f32 v9, v10, v11
v_lshrrev_b64 v[8:9], 2, v[8:9]
s_waitcnt lgkmcnt(4)
v_mfma_f32_16x16x32_bf16 v[144:147], v[188:191], v[48:51], 0
v_and_b32_sdwa v10, s47, v8 dst_sel:DWORD dst_unused:UNUSED_PAD src0_sel:DWORD src1_sel:WORD_1
v_and_b32 v8, s47, v8
v_mfma_f32_16x16x32_f16 v[224:227], v[176:179], v[212:215], v[224:227]
ds_read_u16_d16_hi v10, v10
ds_read_u16 v8, v8
v_mfma_f32_16x16x32_bf16 v[148:151], v[188:191], v[52:55], 0
v_rcp_f16_sdwa v109, v109 dst_sel:WORD_1 dst_unused:UNUSED_PRESERVE src0_sel:WORD_1
v_mfma_f32_16x16x32_f16 v[92:95], v[176:179], v[208:211], v[92:95]
ds_read_b128 v[176:179], v249 offset:10240
v_and_b32_sdwa v11, s47, v9 dst_sel:DWORD dst_unused:UNUSED_PAD src0_sel:DWORD src1_sel:WORD_1
v_mfma_f32_16x16x32_f16 v[164:167], v[160:163], v[116:119], v[164:167]
v_and_b32_e64 v9, s47, v9
v_rcp_f16_sdwa v111, v111 dst_sel:WORD_1 dst_unused:UNUSED_PRESERVE src0_sel:WORD_1
v_mfma_f32_16x16x32_bf16 v[152:155], v[188:191], v[24:27], 0
ds_read_b128 v[188:191], v251 offset:36864
ds_read_u16_d16_hi v11, v11
v_mfma_f32_16x16x32_f16 v[168:171], v[160:163], v[112:115], v[168:171]
ds_read_u16 v9, v9
v_cvt_pkrtz_f16_f32 v12, v12, v13
s_waitcnt lgkmcnt(6)
v_mfma_f32_16x16x32_bf16 v[144:147], v[120:123], v[56:59], v[144:147]
v_cvt_pkrtz_f16_f32 v13, v14, v15
v_lshrrev_b64 v[12:13], 2, v[12:13]
v_mfma_f32_16x16x32_f16 v[132:135], v[160:163], v[228:231], v[132:135]
ds_read_b128 v[160:163], v249 offset:6400
v_and_b32_sdwa v14, s47, v12 dst_sel:DWORD dst_unused:UNUSED_PAD src0_sel:DWORD src1_sel:WORD_1
v_and_b32 v12, s47, v12
v_mfma_f32_16x16x32_f16 v[216:219], v[124:127], v[116:119], v[216:219]
ds_read_u16_d16_hi v14, v14
ds_read_u16 v12, v12
s_setprio 0
v_pk_mul_f16 v108, v108, v109
v_mfma_f32_16x16x32_bf16 v[148:151], v[120:123], v[60:63], v[148:151]
v_and_b32_sdwa v15, s47, v13 dst_sel:DWORD dst_unused:UNUSED_PAD src0_sel:DWORD src1_sel:WORD_1
v_and_b32 v13, s47, v13
v_pk_mul_f16 v109, v110, v111
v_mfma_f32_16x16x32_f16 v[220:223], v[124:127], v[112:115], v[220:223]
ds_read_u16_d16_hi v15, v15
ds_read_u16 v13, v13
v_lshl_add_u64 v[192:193], v[192:193], 0, v[194:195]
v_mfma_f32_16x16x32_bf16 v[152:155], v[120:123], v[32:35], v[152:155]
ds_read_b128 v[120:123], v251 offset:34816
v_cvt_pkrtz_f16_f32 v96, v96, v97
v_mfma_f32_16x16x32_f16 v[76:79], v[124:127], v[228:231], v[76:79]
ds_read_b128 v[124:127], v251 offset:37888
v_cvt_pkrtz_f16_f32 v97, v98, v99
v_lshrrev_b64 v[96:97], 2, v[96:97]
v_and_b32_sdwa v98, s47, v96 dst_sel:DWORD dst_unused:UNUSED_PAD src0_sel:DWORD src1_sel:WORD_1
v_and_b32_e64 v96, s47, v96
v_mfma_f32_16x16x32_f16 v[100:103], v[184:187], v[116:119], v[100:103]
ds_read_u16_d16_hi v98, v98
ds_read_u16 v96, v96
v_and_b32_sdwa v99, s47, v97 dst_sel:DWORD dst_unused:UNUSED_PAD src0_sel:DWORD src1_sel:WORD_1
v_and_b32 v97, s47, v97
s_waitcnt lgkmcnt(8)
v_mfma_f32_16x16x32_bf16 v[144:147], v[176:179], v[64:67], v[144:147]
ds_read_u16_d16_hi v99, v99
ds_read_u16 v97, v97
v_mfma_f32_16x16x32_f16 v[104:107], v[184:187], v[112:115], v[104:107]
v_lshl_add_u64 v[196:197], v[196:197], 0, v[198:199]
v_mfma_f32_16x16x32_f16 v[140:143], v[184:187], v[228:231], v[140:143]
ds_read_b128 v[184:187], v249 offset:8448
s_nop 1
v_cvt_pk_f16_f32 v144, v144, v145
v_mfma_f32_16x16x32_bf16 v[148:151], v[176:179], v[68:71], v[148:151]
v_cvt_pk_f16_f32 v146, v146, v147
v_pk_fma_f16 v145, v144, v144, s48
v_mfma_f32_16x16x32_f16 v[232:235], v[188:191], v[116:119], v[232:235]
v_pk_fma_f16 v147, v146, v146, s48
v_pk_mul_f16 v145, v144, v145
v_mfma_f32_16x16x32_bf16 v[152:155], v[176:179], v[40:43], v[152:155]
ds_read_b128 v[176:179], v251 offset:38912
s_nop 0
v_cvt_pkrtz_f16_f32 v148, v148, v149
v_mfma_f32_16x16x32_f16 v[236:239], v[188:191], v[112:115], v[236:239]
v_cvt_pkrtz_f16_f32 v149, v150, v151
v_lshrrev_b64 v[148:149], 2, v[148:149]
v_mfma_f32_16x16x32_f16 v[84:87], v[188:191], v[228:231], v[84:87]
ds_read_b128 v[188:191], v249 offset:10496
v_and_b32_sdwa v150, s47, v148 dst_sel:DWORD dst_unused:UNUSED_PAD src0_sel:DWORD src1_sel:WORD_1
v_mfma_f32_16x16x32_bf16 v[208:211], v[160:163], v[48:51], 0
s_setprio 3
v_and_b32_e64 v148, s47, v148
v_and_b32_sdwa v151, s47, v149 dst_sel:DWORD dst_unused:UNUSED_PAD src0_sel:DWORD src1_sel:WORD_1
s_waitcnt lgkmcnt(6)
v_mfma_f32_16x16x32_f16 v[200:203], v[120:123], v[116:119], v[200:203]
ds_read_u16_d16_hi v150, v150
ds_read_u16 v148, v148
v_mfma_f32_16x16x32_bf16 v[212:215], v[160:163], v[52:55], 0
v_and_b32_e64 v149, s47, v149
v_pk_mul_f16 v147, v146, v147
v_mfma_f32_16x16x32_f16 v[204:207], v[120:123], v[112:115], v[204:207]
ds_read_u16_d16_hi v151, v151
ds_read_u16 v149, v149
v_mfma_f32_16x16x32_f16 v[244:247], v[120:123], v[228:231], v[244:247]
ds_read_b128 v[120:123], v251 offset:39936
v_cvt_pkrtz_f16_f32 v152, v152, v153
v_mfma_f32_16x16x32_bf16 v[180:183], v[160:163], v[24:27], 0
ds_read_b128 v[160:163], v251 offset:41984
v_cvt_pkrtz_f16_f32 v153, v154, v155
v_mfma_f32_16x16x32_f16 v[4:7], v[124:127], v[116:119], v[4:7]
v_lshrrev_b64 v[152:153], 2, v[152:153]
v_and_b32_sdwa v154, s47, v152 dst_sel:DWORD dst_unused:UNUSED_PAD src0_sel:DWORD src1_sel:WORD_1
s_waitcnt lgkmcnt(7)
v_mfma_f32_16x16x32_bf16 v[208:211], v[184:187], v[56:59], v[208:211]
v_and_b32 v152, s47, v152
v_lshl_add_u64 v[110:111], v[8:9], 0, v[10:11]
v_mfma_f32_16x16x32_f16 v[224:227], v[124:127], v[112:115], v[224:227]
ds_read_u16_d16_hi v154, v154
ds_read_u16 v152, v152
v_mfma_f32_16x16x32_f16 v[92:95], v[124:127], v[228:231], v[92:95]
ds_read_b128 v[124:127], v249 offset:12288
v_exp_f16_sdwa v145, v145 dst_sel:WORD_0 dst_unused:UNUSED_PRESERVE src0_sel:WORD_0
v_mfma_f32_16x16x32_bf16 v[212:215], v[184:187], v[60:63], v[212:215]
v_exp_f16_sdwa v147, v147 dst_sel:WORD_0 dst_unused:UNUSED_PRESERVE src0_sel:WORD_0
s_waitcnt vmcnt(7)
v_mfma_f32_16x16x32_bf16 v[132:135], v[18:21], v[240:243], v[132:135]
v_and_b32_sdwa v155, s47, v153 dst_sel:DWORD dst_unused:UNUSED_PAD src0_sel:DWORD src1_sel:WORD_1
v_and_b32_e64 v153, s47, v153
v_mfma_f32_16x16x32_bf16 v[76:79], v[16:19], v[240:243], v[76:79]
ds_read_u16_d16_hi v155, v155
ds_read_u16 v153, v153
s_waitcnt vmcnt(6)
v_mfma_f32_16x16x32_bf16 v[140:143], v[18:21], v[72:75], v[140:143]
v_lshl_add_u64 v[194:195], v[12:13], 0, v[14:15]
v_exp_f16_sdwa v145, v145 dst_sel:WORD_1 dst_unused:UNUSED_PRESERVE src0_sel:WORD_1
v_mfma_f32_16x16x32_bf16 v[84:87], v[16:19], v[72:75], v[84:87]
buffer_load_dwordx4 v[228:231], v253, s[4:7], s69 offen
buffer_load_dwordx4 v[112:115], v253, s[4:7], s69 offen offset:64
v_exp_f16_sdwa v147, v147 dst_sel:WORD_1 dst_unused:UNUSED_PRESERVE src0_sel:WORD_1
v_mfma_f32_16x16x32_f16 v[164:167], v[176:179], v[0:3], v[164:167]
v_lshl_add_u64 v[198:199], v[96:97], 0, v[98:99]
v_pk_add_f16 v145, v145, 1.0 op_sel_hi:[1,0]
v_mfma_f32_16x16x32_bf16 v[180:183], v[184:187], v[32:35], v[180:183]
ds_read_b128 v[184:187], v251 offset:43008
v_pk_add_f16 v147, v147, 1.0 op_sel_hi:[1,0]
v_mfma_f32_16x16x32_f16 v[168:171], v[176:179], v[136:139], v[168:171]
v_rcp_f16_sdwa v145, v145 dst_sel:WORD_0 dst_unused:UNUSED_PRESERVE src0_sel:WORD_0
v_mfma_f32_16x16x32_f16 v[132:135], v[176:179], v[128:131], v[132:135]
ds_read_b128 v[176:179], v249 offset:14336
v_rcp_f16_sdwa v147, v147 dst_sel:WORD_0 dst_unused:UNUSED_PRESERVE src0_sel:WORD_0
s_waitcnt lgkmcnt(4)
v_mfma_f32_16x16x32_bf16 v[208:211], v[188:191], v[64:67], v[208:211]
s_setprio 2
v_rcp_f16_sdwa v145, v145 dst_sel:WORD_1 dst_unused:UNUSED_PRESERVE src0_sel:WORD_1
v_mfma_f32_16x16x32_f16 v[216:219], v[160:163], v[0:3], v[216:219]
v_rcp_f16_sdwa v147, v147 dst_sel:WORD_1 dst_unused:UNUSED_PRESERVE src0_sel:WORD_1
v_mfma_f32_16x16x32_bf16 v[212:215], v[188:191], v[68:71], v[212:215]
s_nop 2
v_cvt_pk_f16_f32 v208, v208, v209
v_cvt_pk_f16_f32 v210, v210, v211
v_mfma_f32_16x16x32_f16 v[220:223], v[160:163], v[136:139], v[220:223]
v_pk_fma_f16 v209, v208, v208, s48
v_pk_fma_f16 v211, v210, v210, s48
v_mfma_f32_16x16x32_f16 v[76:79], v[160:163], v[128:131], v[76:79]
ds_read_b128 v[160:163], v251 offset:44032
v_cvt_pkrtz_f16_f32 v212, v212, v213
v_mfma_f32_16x16x32_bf16 v[180:183], v[188:191], v[40:43], v[180:183]
ds_read_b128 v[188:191], v251 offset:40960
v_cvt_pkrtz_f16_f32 v213, v214, v215
v_mfma_f32_16x16x32_f16 v[100:103], v[120:123], v[0:3], v[100:103]
v_lshrrev_b64 v[212:213], 2, v[212:213]
v_and_b32_sdwa v214, s47, v212 dst_sel:DWORD dst_unused:UNUSED_PAD src0_sel:DWORD src1_sel:WORD_1
v_mfma_f32_16x16x32_bf16 v[116:119], v[124:127], v[48:51], 0
v_and_b32 v212, s47, v212
v_and_b32_sdwa v215, s47, v213 dst_sel:DWORD dst_unused:UNUSED_PAD src0_sel:DWORD src1_sel:WORD_1
v_mfma_f32_16x16x32_f16 v[104:107], v[120:123], v[136:139], v[104:107]
ds_read_u16_d16_hi v214, v214
ds_read_u16 v212, v212
v_mfma_f32_16x16x32_f16 v[140:143], v[120:123], v[128:131], v[140:143]
ds_read_b128 v[120:123], v249 offset:16384
v_and_b32 v213, s47, v213
v_mfma_f32_16x16x32_bf16 v[240:243], v[124:127], v[52:55], 0
ds_read_u16_d16_hi v215, v215
ds_read_u16 v213, v213
s_waitcnt lgkmcnt(7)
v_mfma_f32_16x16x32_f16 v[232:235], v[184:187], v[0:3], v[232:235]
v_pk_mul_f16 v209, v208, v209
v_pk_mul_f16 v144, v144, v145
v_mfma_f32_16x16x32_bf16 v[72:75], v[124:127], v[24:27], 0
ds_read_b128 v[124:127], v251 offset:45056
v_pk_mul_f16 v211, v210, v211
v_mfma_f32_16x16x32_f16 v[236:239], v[184:187], v[136:139], v[236:239]
v_cvt_pkrtz_f16_f32 v180, v180, v181
v_cvt_pkrtz_f16_f32 v181, v182, v183
v_mfma_f32_16x16x32_f16 v[84:87], v[184:187], v[128:131], v[84:87]
ds_read_b128 v[184:187], v249 offset:12544
v_lshrrev_b64 v[180:181], 2, v[180:181]
v_mfma_f32_16x16x32_bf16 v[116:119], v[176:179], v[56:59], v[116:119]
s_setprio 1
v_and_b32_sdwa v182, s47, v180 dst_sel:DWORD dst_unused:UNUSED_PAD src0_sel:DWORD src1_sel:WORD_1
v_and_b32_e64 v180, s47, v180
s_waitcnt lgkmcnt(7)
v_mfma_f32_16x16x32_f16 v[200:203], v[188:191], v[0:3], v[200:203]
ds_read_u16_d16_hi v182, v182
ds_read_u16 v180, v180
v_mfma_f32_16x16x32_bf16 v[240:243], v[176:179], v[60:63], v[240:243]
v_pk_mul_f16 v145, v146, v147
v_exp_f16_sdwa v209, v209 dst_sel:WORD_0 dst_unused:UNUSED_PRESERVE src0_sel:WORD_0
v_mfma_f32_16x16x32_f16 v[204:207], v[188:191], v[136:139], v[204:207]
v_lshl_add_u64 v[148:149], v[148:149], 0, v[150:151]
v_exp_f16_sdwa v211, v211 dst_sel:WORD_0 dst_unused:UNUSED_PRESERVE src0_sel:WORD_0
v_mfma_f32_16x16x32_f16 v[244:247], v[188:191], v[128:131], v[244:247]
ds_read_b128 v[188:191], v251 offset:46080
v_and_b32_sdwa v183, s47, v181 dst_sel:DWORD dst_unused:UNUSED_PAD src0_sel:DWORD src1_sel:WORD_1
v_mfma_f32_16x16x32_bf16 v[72:75], v[176:179], v[32:35], v[72:75]
ds_read_b128 v[176:179], v251 offset:48128
v_and_b32 v181, s47, v181
v_mfma_f32_16x16x32_f16 v[4:7], v[160:163], v[0:3], v[4:7]
ds_read_u16_d16_hi v183, v183
ds_read_u16 v181, v181
s_waitcnt lgkmcnt(8)
v_mfma_f32_16x16x32_bf16 v[116:119], v[120:123], v[64:67], v[116:119]
v_exp_f16_sdwa v209, v209 dst_sel:WORD_1 dst_unused:UNUSED_PRESERVE src0_sel:WORD_1
v_mfma_f32_16x16x32_f16 v[224:227], v[160:163], v[136:139], v[224:227]
v_lshl_add_u64 v[152:153], v[152:153], 0, v[154:155]
v_exp_f16_sdwa v211, v211 dst_sel:WORD_1 dst_unused:UNUSED_PRESERVE src0_sel:WORD_1
v_mfma_f32_16x16x32_f16 v[92:95], v[160:163], v[128:131], v[92:95]
ds_read_b128 v[160:163], v249 offset:14592
v_pk_add_f16 v209, v209, 1.0 op_sel_hi:[1,0]
v_mfma_f32_16x16x32_bf16 v[240:243], v[120:123], v[68:71], v[240:243]
v_pk_add_f16 v211, v211, 1.0 op_sel_hi:[1,0]
v_rcp_f16_sdwa v209, v209 dst_sel:WORD_0 dst_unused:UNUSED_PRESERVE src0_sel:WORD_0
s_waitcnt vmcnt(7)
v_mfma_f32_16x16x32_bf16 v[244:247], v[18:21], v[172:175], v[244:247]
v_rcp_f16_sdwa v211, v211 dst_sel:WORD_0 dst_unused:UNUSED_PRESERVE src0_sel:WORD_0
v_mfma_f32_16x16x32_bf16 v[92:95], v[16:19], v[172:175], v[92:95]
v_cvt_pkrtz_f16_f32 v116, v116, v117
v_cvt_pkrtz_f16_f32 v117, v118, v119
s_waitcnt vmcnt(6)
v_mfma_f32_16x16x32_bf16 v[168:171], v[18:21], v[156:159], v[168:171]
v_lshrrev_b64 v[116:117], 2, v[116:117]
v_and_b32_sdwa v118, s47, v116 dst_sel:DWORD dst_unused:UNUSED_PAD src0_sel:DWORD src1_sel:WORD_1
v_mfma_f32_16x16x32_bf16 v[220:223], v[16:19], v[156:159], v[220:223]
v_and_b32 v116, s47, v116
v_rcp_f16_sdwa v209, v209 dst_sel:WORD_1 dst_unused:UNUSED_PRESERVE src0_sel:WORD_1
s_waitcnt lgkmcnt(1)
v_mfma_f32_16x16x32_f16 v[164:167], v[124:127], v[196:199], v[164:167]
ds_read_u16_d16_hi v118, v118
ds_read_u16 v116, v116
v_mfma_f32_16x16x32_bf16 v[72:75], v[120:123], v[40:43], v[72:75]
ds_read_b128 v[120:123], v251 offset:49152
v_and_b32_sdwa v119, s47, v117 dst_sel:DWORD dst_unused:UNUSED_PAD src0_sel:DWORD src1_sel:WORD_1
v_mfma_f32_16x16x32_f16 v[168:171], v[124:127], v[192:195], v[168:171]
v_and_b32 v117, s47, v117
v_rcp_f16_sdwa v211, v211 dst_sel:WORD_1 dst_unused:UNUSED_PRESERVE src0_sel:WORD_1
v_mfma_f32_16x16x32_f16 v[132:135], v[124:127], v[108:111], v[132:135]
ds_read_b128 v[124:127], v249 offset:16640
ds_read_u16_d16_hi v119, v119
v_mfma_f32_16x16x32_bf16 v[8:11], v[184:187], v[48:51], 0
s_setprio 0
ds_read_u16 v117, v117
v_cvt_pkrtz_f16_f32 v240, v240, v241
v_mfma_f32_16x16x32_f16 v[216:219], v[176:179], v[196:199], v[216:219]
v_cvt_pkrtz_f16_f32 v241, v242, v243
v_lshrrev_b64 v[240:241], 2, v[240:241]
v_mfma_f32_16x16x32_bf16 v[12:15], v[184:187], v[52:55], 0
v_and_b32_sdwa v242, s47, v240 dst_sel:DWORD dst_unused:UNUSED_PAD src0_sel:DWORD src1_sel:WORD_1
v_and_b32_e64 v240, s47, v240
v_mfma_f32_16x16x32_f16 v[220:223], v[176:179], v[192:195], v[220:223]
ds_read_u16_d16_hi v242, v242
ds_read_u16 v240, v240
v_mfma_f32_16x16x32_f16 v[76:79], v[176:179], v[108:111], v[76:79]
ds_read_b128 v[176:179], v251 offset:50176
v_pk_mul_f16 v146, v208, v209
v_mfma_f32_16x16x32_bf16 v[96:99], v[184:187], v[24:27], 0
ds_read_b128 v[184:187], v251 offset:47104
v_and_b32_sdwa v243, s47, v241 dst_sel:DWORD dst_unused:UNUSED_PAD src0_sel:DWORD src1_sel:WORD_1
v_mfma_f32_16x16x32_f16 v[100:103], v[188:191], v[196:199], v[100:103]
v_and_b32 v241, s47, v241
v_pk_mul_f16 v147, v210, v211
v_mfma_f32_16x16x32_f16 v[104:107], v[188:191], v[192:195], v[104:107]
ds_read_u16_d16_hi v243, v243
ds_read_u16 v241, v241
s_waitcnt lgkmcnt(8)
v_mfma_f32_16x16x32_bf16 v[8:11], v[160:163], v[56:59], v[8:11]
v_lshl_add_u64 v[150:151], v[212:213], 0, v[214:215]
v_cvt_pkrtz_f16_f32 v72, v72, v73
v_mfma_f32_16x16x32_f16 v[140:143], v[188:191], v[108:111], v[140:143]
ds_read_b128 v[188:191], v249 offset:18432
v_cvt_pkrtz_f16_f32 v73, v74, v75
v_mfma_f32_16x16x32_bf16 v[12:15], v[160:163], v[60:63], v[12:15]
v_lshrrev_b64 v[72:73], 2, v[72:73]
v_and_b32_sdwa v74, s47, v72 dst_sel:DWORD dst_unused:UNUSED_PAD src0_sel:DWORD src1_sel:WORD_1
v_mfma_f32_16x16x32_f16 v[232:235], v[120:123], v[196:199], v[232:235]
v_and_b32_e64 v72, s47, v72
v_and_b32_sdwa v75, s47, v73 dst_sel:DWORD dst_unused:UNUSED_PAD src0_sel:DWORD src1_sel:WORD_1
v_mfma_f32_16x16x32_f16 v[236:239], v[120:123], v[192:195], v[236:239]
ds_read_u16_d16_hi v74, v74
ds_read_u16 v72, v72
v_mfma_f32_16x16x32_bf16 v[96:99], v[160:163], v[32:35], v[96:99]
ds_read_b128 v[160:163], v251 offset:51200
v_and_b32_e64 v73, s47, v73
v_mfma_f32_16x16x32_f16 v[84:87], v[120:123], v[108:111], v[84:87]
ds_read_b128 v[120:123], v249 offset:20480
ds_read_u16_d16_hi v75, v75
ds_read_u16 v73, v73
s_setprio 3
v_mfma_f32_16x16x32_bf16 v[8:11], v[124:127], v[64:67], v[8:11]
v_lshl_add_u64 v[154:155], v[180:181], 0, v[182:183]
s_waitcnt lgkmcnt(9)
v_mfma_f32_16x16x32_f16 v[200:203], v[184:187], v[196:199], v[200:203]
v_mfma_f32_16x16x32_f16 v[204:207], v[184:187], v[192:195], v[204:207]
s_nop 3
v_cvt_pk_f16_f32 v8, v8, v9
v_mfma_f32_16x16x32_bf16 v[12:15], v[124:127], v[68:71], v[12:15]
v_cvt_pk_f16_f32 v10, v10, v11
v_pk_fma_f16 v9, v8, v8, s48
v_mfma_f32_16x16x32_f16 v[244:247], v[184:187], v[108:111], v[244:247]
ds_read_b128 v[184:187], v249 offset:22528
v_pk_fma_f16 v11, v10, v10, s48
v_mfma_f32_16x16x32_bf16 v[96:99], v[124:127], v[40:43], v[96:99]
ds_read_b128 v[124:127], v251 offset:54272
s_nop 0
v_cvt_pkrtz_f16_f32 v12, v12, v13
v_mfma_f32_16x16x32_f16 v[4:7], v[176:179], v[196:199], v[4:7]
v_cvt_pkrtz_f16_f32 v13, v14, v15
v_lshrrev_b64 v[12:13], 2, v[12:13]
v_mfma_f32_16x16x32_f16 v[224:227], v[176:179], v[192:195], v[224:227]
buffer_load_dwordx4 v[128:131], v250, s[32:35], s80 offen
s_add_u32 s46, s80, 2097152
buffer_load_dwordx4 v[136:139], v250, s[32:35], s46 offen
v_and_b32_sdwa v14, s47, v12 dst_sel:DWORD dst_unused:UNUSED_PAD src0_sel:DWORD src1_sel:WORD_1
s_waitcnt lgkmcnt(5)
v_mfma_f32_16x16x32_bf16 v[0:3], v[188:191], v[48:51], 0
v_and_b32 v12, s47, v12
v_and_b32_sdwa v15, s47, v13 dst_sel:DWORD dst_unused:UNUSED_PAD src0_sel:DWORD src1_sel:WORD_1
v_mfma_f32_16x16x32_f16 v[92:95], v[176:179], v[108:111], v[92:95]
ds_read_b128 v[176:179], v251 offset:52224
ds_read_u16_d16_hi v14, v14
v_mfma_f32_16x16x32_bf16 v[172:175], v[188:191], v[52:55], 0
ds_read_u16 v12, v12
v_and_b32_e64 v13, s47, v13
v_mfma_f32_16x16x32_f16 v[164:167], v[160:163], v[152:155], v[164:167]
ds_read_u16_d16_hi v15, v15
ds_read_u16 v13, v13
v_mfma_f32_16x16x32_bf16 v[156:159], v[188:191], v[24:27], 0
ds_read_b128 v[188:191], v249 offset:18688
v_pk_mul_f16 v9, v8, v9
v_mfma_f32_16x16x32_f16 v[168:171], v[160:163], v[148:151], v[168:171]
s_setprio 2
v_pk_mul_f16 v11, v10, v11
v_cvt_pkrtz_f16_f32 v96, v96, v97
s_waitcnt lgkmcnt(6)
v_mfma_f32_16x16x32_bf16 v[0:3], v[120:123], v[56:59], v[0:3]
v_cvt_pkrtz_f16_f32 v97, v98, v99
v_lshrrev_b64 v[96:97], 2, v[96:97]
v_mfma_f32_16x16x32_f16 v[132:135], v[160:163], v[144:147], v[132:135]
ds_read_b128 v[160:163], v251 offset:55296
v_and_b32_sdwa v98, s47, v96 dst_sel:DWORD dst_unused:UNUSED_PAD src0_sel:DWORD src1_sel:WORD_1
v_mfma_f32_16x16x32_bf16 v[172:175], v[120:123], v[60:63], v[172:175]
v_and_b32_e64 v96, s47, v96
v_lshl_add_u64 v[116:117], v[116:117], 0, v[118:119]
v_mfma_f32_16x16x32_f16 v[216:219], v[124:127], v[152:155], v[216:219]
ds_read_u16_d16_hi v98, v98
ds_read_u16 v96, v96
v_exp_f16_sdwa v9, v9 dst_sel:WORD_0 dst_unused:UNUSED_PRESERVE src0_sel:WORD_0
v_mfma_f32_16x16x32_bf16 v[156:159], v[120:123], v[32:35], v[156:159]
ds_read_b128 v[120:123], v249 offset:20736
v_exp_f16_sdwa v11, v11 dst_sel:WORD_0 dst_unused:UNUSED_PRESERVE src0_sel:WORD_0
v_mfma_f32_16x16x32_f16 v[220:223], v[124:127], v[148:151], v[220:223]
v_and_b32_sdwa v99, s47, v97 dst_sel:DWORD dst_unused:UNUSED_PAD src0_sel:DWORD src1_sel:WORD_1
v_and_b32_e64 v97, s47, v97
v_mfma_f32_16x16x32_bf16 v[0:3], v[184:187], v[64:67], v[0:3]
ds_read_u16_d16_hi v99, v99
ds_read_u16 v97, v97
v_lshl_add_u64 v[240:241], v[240:241], 0, v[242:243]
v_mfma_f32_16x16x32_f16 v[76:79], v[124:127], v[144:147], v[76:79]
ds_read_b128 v[124:127], v251 offset:53248
v_exp_f16_sdwa v9, v9 dst_sel:WORD_1 dst_unused:UNUSED_PRESERVE src0_sel:WORD_1
v_mfma_f32_16x16x32_bf16 v[172:175], v[184:187], v[68:71], v[172:175]
v_exp_f16_sdwa v11, v11 dst_sel:WORD_1 dst_unused:UNUSED_PRESERVE src0_sel:WORD_1
s_waitcnt lgkmcnt(7)
v_mfma_f32_16x16x32_f16 v[100:103], v[176:179], v[152:155], v[100:103]
v_lshl_add_u64 v[72:73], v[72:73], 0, v[74:75]
v_pk_add_f16 v9, v9, 1.0 op_sel_hi:[1,0]
v_mfma_f32_16x16x32_bf16 v[156:159], v[184:187], v[40:43], v[156:159]
ds_read_b128 v[184:187], v249 offset:22784
v_pk_add_f16 v11, v11, 1.0 op_sel_hi:[1,0]
v_mfma_f32_16x16x32_f16 v[104:107], v[176:179], v[148:151], v[104:107]
s_setprio 1
v_rcp_f16_sdwa v9, v9 dst_sel:WORD_0 dst_unused:UNUSED_PRESERVE src0_sel:WORD_0
v_mfma_f32_16x16x32_bf16 v[208:211], v[188:191], v[48:51], 0
v_rcp_f16_sdwa v11, v11 dst_sel:WORD_0 dst_unused:UNUSED_PRESERVE src0_sel:WORD_0
v_mfma_f32_16x16x32_f16 v[140:143], v[176:179], v[144:147], v[140:143]
ds_read_b128 v[176:179], v251 offset:56320
v_cvt_pkrtz_f16_f32 v172, v172, v173
v_mfma_f32_16x16x32_bf16 v[212:215], v[188:191], v[52:55], 0
v_cvt_pkrtz_f16_f32 v173, v174, v175
v_lshrrev_b64 v[172:173], 2, v[172:173]
s_waitcnt lgkmcnt(4)
v_mfma_f32_16x16x32_f16 v[232:235], v[160:163], v[152:155], v[232:235]
v_and_b32_sdwa v174, s47, v172 dst_sel:DWORD dst_unused:UNUSED_PAD src0_sel:DWORD src1_sel:WORD_1
v_and_b32 v172, s47, v172
v_cvt_pk_f16_f32 v0, v0, v1
v_mfma_f32_16x16x32_bf16 v[180:183], v[188:191], v[24:27], 0
ds_read_u16_d16_hi v174, v174
ds_read_u16 v172, v172
ds_read_b128 v[188:191], v249 offset:24576
v_rcp_f16_sdwa v9, v9 dst_sel:WORD_1 dst_unused:UNUSED_PRESERVE src0_sel:WORD_1
v_mfma_f32_16x16x32_f16 v[236:239], v[160:163], v[148:151], v[236:239]
v_cvt_pk_f16_f32 v2, v2, v3
v_pk_fma_f16 v1, v0, v0, s48
v_rcp_f16_sdwa v11, v11 dst_sel:WORD_1 dst_unused:UNUSED_PRESERVE src0_sel:WORD_1
s_add_u32 s46, s80, 4194304
buffer_load_dwordx4 v[108:111], v250, s[32:35], s46 offen
s_add_u32 s46, s80, 6291456
buffer_load_dwordx4 v[192:195], v250, s[32:35], s46 offen
v_mfma_f32_16x16x32_bf16 v[208:211], v[120:123], v[56:59], v[208:211]
v_and_b32_sdwa v175, s47, v173 dst_sel:DWORD dst_unused:UNUSED_PAD src0_sel:DWORD src1_sel:WORD_1
v_and_b32_e64 v173, s47, v173
v_pk_fma_f16 v3, v2, v2, s48
v_mfma_f32_16x16x32_f16 v[84:87], v[160:163], v[144:147], v[84:87]
ds_read_u16_d16_hi v175, v175
ds_read_u16 v173, v173
ds_read_b128 v[160:163], v251 offset:57344
v_pk_mul_f16 v1, v0, v1
v_pk_mul_f16 v118, v8, v9
v_mfma_f32_16x16x32_bf16 v[212:215], v[120:123], v[60:63], v[212:215]
v_pk_mul_f16 v3, v2, v3
buffer_load_dwordx4 v[196:199], v253, s[4:7], s69 offen offset:128
s_waitcnt lgkmcnt(6)
v_mfma_f32_16x16x32_f16 v[200:203], v[124:127], v[152:155], v[200:203]
v_cvt_pkrtz_f16_f32 v156, v156, v157
v_cvt_pkrtz_f16_f32 v157, v158, v159
v_lshrrev_b64 v[156:157], 2, v[156:157]
v_and_b32_sdwa v158, s47, v156 dst_sel:DWORD dst_unused:UNUSED_PAD src0_sel:DWORD src1_sel:WORD_1
v_and_b32 v156, s47, v156
v_pk_mul_f16 v119, v10, v11
v_exp_f16_sdwa v1, v1 dst_sel:WORD_0 dst_unused:UNUSED_PRESERVE src0_sel:WORD_0
v_lshl_add_u64 v[242:243], v[12:13], 0, v[14:15]
v_mfma_f32_16x16x32_bf16 v[180:183], v[120:123], v[32:35], v[180:183]
ds_read_u16_d16_hi v158, v158
ds_read_u16 v156, v156
ds_read_b128 v[120:123], v249 offset:26624
v_mfma_f32_16x16x32_f16 v[204:207], v[124:127], v[148:151], v[204:207]
v_exp_f16_sdwa v3, v3 dst_sel:WORD_0 dst_unused:UNUSED_PRESERVE src0_sel:WORD_0
v_and_b32_sdwa v159, s47, v157 dst_sel:DWORD dst_unused:UNUSED_PAD src0_sel:DWORD src1_sel:WORD_1
v_and_b32 v157, s47, v157
v_mfma_f32_16x16x32_bf16 v[208:211], v[184:187], v[64:67], v[208:211]
ds_read_u16_d16_hi v159, v159
ds_read_u16 v157, v157
s_setprio 0
v_mfma_f32_16x16x32_f16 v[244:247], v[124:127], v[144:147], v[244:247]
ds_read_b128 v[124:127], v251 offset:60416
v_exp_f16_sdwa v1, v1 dst_sel:WORD_1 dst_unused:UNUSED_PRESERVE src0_sel:WORD_1
v_mfma_f32_16x16x32_bf16 v[212:215], v[184:187], v[68:71], v[212:215]
v_lshl_add_u64 v[74:75], v[96:97], 0, v[98:99]
v_exp_f16_sdwa v3, v3 dst_sel:WORD_1 dst_unused:UNUSED_PRESERVE src0_sel:WORD_1
v_mfma_f32_16x16x32_f16 v[4:7], v[176:179], v[152:155], v[4:7]
v_pk_add_f16 v1, v1, 1.0 op_sel_hi:[1,0]
v_pk_add_f16 v3, v3, 1.0 op_sel_hi:[1,0]
v_mfma_f32_16x16x32_bf16 v[180:183], v[184:187], v[40:43], v[180:183]
ds_read_b128 v[184:187], v249 offset:28672
v_rcp_f16_sdwa v1, v1 dst_sel:WORD_0 dst_unused:UNUSED_PRESERVE src0_sel:WORD_0
v_mfma_f32_16x16x32_f16 v[224:227], v[176:179], v[148:151], v[224:227]
v_rcp_f16_sdwa v3, v3 dst_sel:WORD_0 dst_unused:UNUSED_PRESERVE src0_sel:WORD_0
s_waitcnt lgkmcnt(6)
v_mfma_f32_16x16x32_bf16 v[8:11], v[188:191], v[48:51], 0
v_cvt_pkrtz_f16_f32 v208, v208, v209
v_cvt_pkrtz_f16_f32 v209, v210, v211
v_mfma_f32_16x16x32_f16 v[92:95], v[176:179], v[144:147], v[92:95]
ds_read_b128 v[176:179], v251 offset:58368
v_lshrrev_b64 v[208:209], 2, v[208:209]
s_waitcnt vmcnt(8)
v_mfma_f32_16x16x32_bf16 v[104:107], v[18:21], v[80:83], v[104:107]
v_and_b32_sdwa v210, s47, v208 dst_sel:DWORD dst_unused:UNUSED_PAD src0_sel:DWORD src1_sel:WORD_1
v_and_b32 v208, s47, v208
v_mfma_f32_16x16x32_bf16 v[236:239], v[16:19], v[80:83], v[236:239]
ds_read_u16_d16_hi v210, v210
ds_read_u16 v208, v208
s_waitcnt vmcnt(7)
v_mfma_f32_16x16x32_bf16 v[204:207], v[18:21], v[88:91], v[204:207]
v_rcp_f16_sdwa v1, v1 dst_sel:WORD_1 dst_unused:UNUSED_PRESERVE src0_sel:WORD_1
v_mfma_f32_16x16x32_bf16 v[224:227], v[16:19], v[88:91], v[224:227]
v_and_b32_sdwa v211, s47, v209 dst_sel:DWORD dst_unused:UNUSED_PAD src0_sel:DWORD src1_sel:WORD_1
v_and_b32_e64 v209, s47, v209
v_mfma_f32_16x16x32_bf16 v[12:15], v[188:191], v[52:55], 0
ds_read_u16_d16_hi v211, v211
ds_read_u16 v209, v209
v_mfma_f32_16x16x32_f16 v[164:167], v[160:163], v[72:75], v[164:167]
v_rcp_f16_sdwa v3, v3 dst_sel:WORD_1 dst_unused:UNUSED_PRESERVE src0_sel:WORD_1
v_mfma_f32_16x16x32_bf16 v[96:99], v[188:191], v[24:27], 0
ds_read_b128 v[188:191], v249 offset:24832
v_cvt_pkrtz_f16_f32 v212, v212, v213
v_mfma_f32_16x16x32_f16 v[168:171], v[160:163], v[240:243], v[168:171]
s_setprio 3
v_cvt_pkrtz_f16_f32 v213, v214, v215
v_lshrrev_b64 v[212:213], 2, v[212:213]
s_waitcnt lgkmcnt(5)
v_mfma_f32_16x16x32_bf16 v[8:11], v[120:123], v[56:59], v[8:11]
v_and_b32_sdwa v214, s47, v212 dst_sel:DWORD dst_unused:UNUSED_PAD src0_sel:DWORD src1_sel:WORD_1
v_and_b32_e64 v212, s47, v212
v_mfma_f32_16x16x32_f16 v[132:135], v[160:163], v[116:119], v[132:135]
ds_read_b128 v[160:163], v251 offset:61440
ds_read_u16_d16_hi v214, v214
ds_read_u16 v212, v212
v_pk_mul_f16 v0, v0, v1
v_mfma_f32_16x16x32_bf16 v[12:15], v[120:123], v[60:63], v[12:15]
v_and_b32_sdwa v215, s47, v213 dst_sel:DWORD dst_unused:UNUSED_PAD src0_sel:DWORD src1_sel:WORD_1
v_and_b32_e64 v213, s47, v213
v_mfma_f32_16x16x32_f16 v[216:219], v[124:127], v[72:75], v[216:219]
ds_read_u16_d16_hi v215, v215
ds_read_u16 v213, v213
v_pk_mul_f16 v1, v2, v3
v_lshl_add_u64 v[172:173], v[172:173], 0, v[174:175]
v_mfma_f32_16x16x32_bf16 v[96:99], v[120:123], v[32:35], v[96:99]
ds_read_b128 v[120:123], v249 offset:26880
v_cvt_pkrtz_f16_f32 v180, v180, v181
v_cvt_pkrtz_f16_f32 v181, v182, v183
v_lshrrev_b64 v[180:181], 2, v[180:181]
v_and_b32_sdwa v182, s47, v180 dst_sel:DWORD dst_unused:UNUSED_PAD src0_sel:DWORD src1_sel:WORD_1
v_and_b32_e64 v180, s47, v180
v_mfma_f32_16x16x32_f16 v[220:223], v[124:127], v[240:243], v[220:223]
ds_read_u16_d16_hi v182, v182
ds_read_u16 v180, v180
v_and_b32_sdwa v183, s47, v181 dst_sel:DWORD dst_unused:UNUSED_PAD src0_sel:DWORD src1_sel:WORD_1
v_and_b32 v181, s47, v181
v_mfma_f32_16x16x32_bf16 v[8:11], v[184:187], v[64:67], v[8:11]
ds_read_u16_d16_hi v183, v183
ds_read_u16 v181, v181
s_add_u32 s46, s80, 8388608
buffer_load_dwordx4 v[144:147], v250, s[32:35], s46 offen
s_add_u32 s46, s80, 10485760
buffer_load_dwordx4 v[148:151], v250, s[32:35], s46 offen
v_mfma_f32_16x16x32_f16 v[76:79], v[124:127], v[116:119], v[76:79]
s_waitcnt lgkmcnt(9)
ds_read_b128 v[124:127], v251 offset:59392
v_lshl_add_u64 v[156:157], v[156:157], 0, v[158:159]
v_mfma_f32_16x16x32_bf16 v[12:15], v[184:187], v[68:71], v[12:15]
v_cvt_pk_f16_f32 v8, v8, v9
v_cvt_pk_f16_f32 v10, v10, v11
v_mfma_f32_16x16x32_f16 v[100:103], v[176:179], v[72:75], v[100:103]
v_pk_fma_f16 v9, v8, v8, s48
v_pk_fma_f16 v11, v10, v10, s48
v_mfma_f32_16x16x32_bf16 v[96:99], v[184:187], v[40:43], v[96:99]
ds_read_b128 v[184:187], v249 offset:28928
s_nop 0
v_cvt_pkrtz_f16_f32 v12, v12, v13
v_mfma_f32_16x16x32_f16 v[104:107], v[176:179], v[240:243], v[104:107]
s_setprio 2
v_cvt_pkrtz_f16_f32 v13, v14, v15
v_lshrrev_b64 v[12:13], 2, v[12:13]
v_mfma_f32_16x16x32_bf16 v[152:155], v[188:191], v[48:51], 0
v_and_b32_sdwa v14, s47, v12 dst_sel:DWORD dst_unused:UNUSED_PAD src0_sel:DWORD src1_sel:WORD_1
v_and_b32_e64 v12, s47, v12
v_mfma_f32_16x16x32_f16 v[140:143], v[176:179], v[116:119], v[140:143]
ds_read_b128 v[176:179], v251 offset:62464
ds_read_u16_d16_hi v14, v14
v_mfma_f32_16x16x32_bf16 v[80:83], v[188:191], v[52:55], 0
ds_read_u16 v12, v12
v_and_b32_sdwa v15, s47, v13 dst_sel:DWORD dst_unused:UNUSED_PAD src0_sel:DWORD src1_sel:WORD_1
v_mfma_f32_16x16x32_f16 v[232:235], v[160:163], v[72:75], v[232:235]
v_and_b32 v13, s47, v13
v_pk_mul_f16 v9, v8, v9
v_mfma_f32_16x16x32_bf16 v[88:91], v[188:191], v[24:27], 0
ds_read_b128 v[188:191], v249 offset:30720
s_waitcnt lgkmcnt(8)
ds_read_u16_d16_hi v15, v15
v_mfma_f32_16x16x32_f16 v[236:239], v[160:163], v[240:243], v[236:239]
ds_read_u16 v13, v13
v_pk_mul_f16 v11, v10, v11
v_mfma_f32_16x16x32_bf16 v[152:155], v[120:123], v[56:59], v[152:155]
v_cvt_pkrtz_f16_f32 v96, v96, v97
v_cvt_pkrtz_f16_f32 v97, v98, v99
v_mfma_f32_16x16x32_f16 v[84:87], v[160:163], v[116:119], v[84:87]
ds_read_b128 v[160:163], v251 offset:63488
v_lshrrev_b64 v[96:97], 2, v[96:97]
v_mfma_f32_16x16x32_bf16 v[80:83], v[120:123], v[60:63], v[80:83]
v_and_b32_sdwa v98, s47, v96 dst_sel:DWORD dst_unused:UNUSED_PAD src0_sel:DWORD src1_sel:WORD_1
v_and_b32 v96, s47, v96
s_waitcnt lgkmcnt(7)
v_mfma_f32_16x16x32_f16 v[200:203], v[124:127], v[72:75], v[200:203]
ds_read_u16_d16_hi v98, v98
ds_read_u16 v96, v96
v_lshl_add_u64 v[2:3], v[208:209], 0, v[210:211]
v_exp_f16_sdwa v9, v9 dst_sel:WORD_0 dst_unused:UNUSED_PRESERVE src0_sel:WORD_0
v_mfma_f32_16x16x32_bf16 v[88:91], v[120:123], v[32:35], v[88:91]
ds_read_b128 v[120:123], v249 offset:32768
v_exp_f16_sdwa v11, v11 dst_sel:WORD_0 dst_unused:UNUSED_PRESERVE src0_sel:WORD_0
v_mfma_f32_16x16x32_f16 v[204:207], v[124:127], v[240:243], v[204:207]
s_setprio 1
v_and_b32_sdwa v99, s47, v97 dst_sel:DWORD dst_unused:UNUSED_PAD src0_sel:DWORD src1_sel:WORD_1
v_and_b32_e64 v97, s47, v97
v_mfma_f32_16x16x32_bf16 v[152:155], v[184:187], v[64:67], v[152:155]
ds_read_u16_d16_hi v99, v99
ds_read_u16 v97, v97
v_lshl_add_u64 v[174:175], v[212:213], 0, v[214:215]
v_mfma_f32_16x16x32_f16 v[244:247], v[124:127], v[116:119], v[244:247]
ds_read_b128 v[124:127], v252 offset:1024
v_exp_f16_sdwa v9, v9 dst_sel:WORD_1 dst_unused:UNUSED_PRESERVE src0_sel:WORD_1
v_mfma_f32_16x16x32_bf16 v[80:83], v[184:187], v[68:71], v[80:83]
v_exp_f16_sdwa v11, v11 dst_sel:WORD_1 dst_unused:UNUSED_PRESERVE src0_sel:WORD_1
s_waitcnt lgkmcnt(7)
v_mfma_f32_16x16x32_f16 v[4:7], v[176:179], v[72:75], v[4:7]
v_lshl_add_u64 v[158:159], v[180:181], 0, v[182:183]
v_pk_add_f16 v9, v9, 1.0 op_sel_hi:[1,0]
v_mfma_f32_16x16x32_bf16 v[88:91], v[184:187], v[40:43], v[88:91]
ds_read_b128 v[184:187], v249 offset:34816
v_pk_add_f16 v11, v11, 1.0 op_sel_hi:[1,0]
v_mfma_f32_16x16x32_f16 v[224:227], v[176:179], v[240:243], v[224:227]
v_rcp_f16_sdwa v9, v9 dst_sel:WORD_0 dst_unused:UNUSED_PRESERVE src0_sel:WORD_0
v_mfma_f32_16x16x32_bf16 v[208:211], v[188:191], v[48:51], 0
v_rcp_f16_sdwa v11, v11 dst_sel:WORD_0 dst_unused:UNUSED_PRESERVE src0_sel:WORD_0
v_mfma_f32_16x16x32_f16 v[92:95], v[176:179], v[116:119], v[92:95]
ds_read_b128 v[176:179], v251 offset:64512
v_cvt_pkrtz_f16_f32 v80, v80, v81
v_mfma_f32_16x16x32_bf16 v[212:215], v[188:191], v[52:55], 0
v_cvt_pkrtz_f16_f32 v81, v82, v83
v_lshrrev_b64 v[80:81], 2, v[80:81]
s_waitcnt lgkmcnt(5)
v_mfma_f32_16x16x32_f16 v[164:167], v[160:163], v[156:159], v[164:167]
v_and_b32_sdwa v82, s47, v80 dst_sel:DWORD dst_unused:UNUSED_PAD src0_sel:DWORD src1_sel:WORD_1
v_and_b32 v80, s47, v80
v_cvt_pk_f16_f32 v152, v152, v153
v_mfma_f32_16x16x32_bf16 v[180:183], v[188:191], v[24:27], 0
ds_read_u16_d16_hi v82, v82
ds_read_u16 v80, v80
ds_read_b128 v[188:191], v249 offset:30976
v_rcp_f16_sdwa v9, v9 dst_sel:WORD_1 dst_unused:UNUSED_PRESERVE src0_sel:WORD_1
s_setprio 0
v_mfma_f32_16x16x32_f16 v[168:171], v[160:163], v[172:175], v[168:171]
v_cvt_pk_f16_f32 v154, v154, v155
v_pk_fma_f16 v153, v152, v152, s48
v_rcp_f16_sdwa v11, v11 dst_sel:WORD_1 dst_unused:UNUSED_PRESERVE src0_sel:WORD_1
v_mfma_f32_16x16x32_bf16 v[208:211], v[120:123], v[56:59], v[208:211]
v_and_b32_sdwa v83, s47, v81 dst_sel:DWORD dst_unused:UNUSED_PAD src0_sel:DWORD src1_sel:WORD_1
v_and_b32 v81, s47, v81
v_pk_fma_f16 v155, v154, v154, s48
v_mfma_f32_16x16x32_f16 v[132:135], v[160:163], v[0:3], v[132:135]
ds_read_u16_d16_hi v83, v83
ds_read_u16 v81, v81
ds_read_b128 v[160:163], v252 offset:2048
v_pk_mul_f16 v153, v152, v153
v_pk_mul_f16 v8, v8, v9
v_mfma_f32_16x16x32_bf16 v[212:215], v[120:123], v[60:63], v[212:215]
v_pk_mul_f16 v155, v154, v155
v_cvt_pkrtz_f16_f32 v88, v88, v89
s_waitcnt lgkmcnt(6)
v_mfma_f32_16x16x32_f16 v[216:219], v[124:127], v[156:159], v[216:219]
v_cvt_pkrtz_f16_f32 v89, v90, v91
v_lshrrev_b64 v[88:89], 2, v[88:89]
v_and_b32_sdwa v90, s47, v88 dst_sel:DWORD dst_unused:UNUSED_PAD src0_sel:DWORD src1_sel:WORD_1
v_and_b32 v88, s47, v88
v_pk_mul_f16 v9, v10, v11
v_exp_f16_sdwa v153, v153 dst_sel:WORD_0 dst_unused:UNUSED_PRESERVE src0_sel:WORD_0
v_lshl_add_u64 v[12:13], v[12:13], 0, v[14:15]
v_mfma_f32_16x16x32_bf16 v[180:183], v[120:123], v[32:35], v[180:183]
ds_read_u16_d16_hi v90, v90
ds_read_u16 v88, v88
v_mfma_f32_16x16x32_f16 v[220:223], v[124:127], v[172:175], v[220:223]
ds_read_b128 v[120:123], v249 offset:35072
v_exp_f16_sdwa v155, v155 dst_sel:WORD_0 dst_unused:UNUSED_PRESERVE src0_sel:WORD_0
v_and_b32_sdwa v91, s47, v89 dst_sel:DWORD dst_unused:UNUSED_PAD src0_sel:DWORD src1_sel:WORD_1
v_and_b32_e64 v89, s47, v89
v_mfma_f32_16x16x32_bf16 v[208:211], v[184:187], v[64:67], v[208:211]
ds_read_u16_d16_hi v91, v91
ds_read_u16 v89, v89
s_waitcnt vmcnt(5)
v_permlane16_swap_b32 v128, v136
v_permlane16_swap_b32 v129, v137
v_permlane16_swap_b32 v130, v138
v_permlane16_swap_b32 v131, v139
s_waitcnt vmcnt(3)
v_permlane16_swap_b32 v108, v192
v_permlane16_swap_b32 v109, v193
v_permlane16_swap_b32 v110, v194
v_permlane16_swap_b32 v111, v195
v_mfma_f32_16x16x32_f16 v[76:79], v[124:127], v[0:3], v[76:79]
v_exp_f16_sdwa v153, v153 dst_sel:WORD_1 dst_unused:UNUSED_PRESERVE src0_sel:WORD_1
v_mfma_f32_16x16x32_bf16 v[212:215], v[184:187], v[68:71], v[212:215]
ds_read_b128 v[124:127], v252 offset:3072
v_lshl_add_u64 v[96:97], v[96:97], 0, v[98:99]
v_mfma_f32_16x16x32_f16 v[100:103], v[176:179], v[156:159], v[100:103]
v_exp_f16_sdwa v155, v155 dst_sel:WORD_1 dst_unused:UNUSED_PRESERVE src0_sel:WORD_1
v_mfma_f32_16x16x32_bf16 v[180:183], v[184:187], v[40:43], v[180:183]
s_setprio 3
v_pk_add_f16 v153, v153, 1.0 op_sel_hi:[1,0]
v_pk_add_f16 v155, v155, 1.0 op_sel_hi:[1,0]
v_mfma_f32_16x16x32_f16 v[104:107], v[176:179], v[172:175], v[104:107]
ds_read_b128 v[184:187], v248
v_rcp_f16_sdwa v153, v153 dst_sel:WORD_0 dst_unused:UNUSED_PRESERVE src0_sel:WORD_0
s_waitcnt lgkmcnt(4)
v_mfma_f32_16x16x32_bf16 v[116:119], v[188:191], v[48:51], 0
ds_read_b128 v[48:51], v252
v_rcp_f16_sdwa v155, v155 dst_sel:WORD_0 dst_unused:UNUSED_PRESERVE src0_sel:WORD_0
v_mfma_f32_16x16x32_f16 v[140:143], v[176:179], v[0:3], v[140:143]
ds_read_b128 v[176:179], v252 offset:4096
v_cvt_pkrtz_f16_f32 v208, v208, v209
v_mfma_f32_16x16x32_bf16 v[240:243], v[188:191], v[52:55], 0
ds_read_b128 v[52:55], v249 offset:33024
v_cvt_pkrtz_f16_f32 v209, v210, v211
v_mfma_f32_16x16x32_f16 v[232:235], v[160:163], v[156:159], v[232:235]
v_lshrrev_b64 v[208:209], 2, v[208:209]
v_and_b32_sdwa v210, s47, v208 dst_sel:DWORD dst_unused:UNUSED_PAD src0_sel:DWORD src1_sel:WORD_1
v_and_b32_e64 v208, s47, v208
v_mfma_f32_16x16x32_bf16 v[72:75], v[188:191], v[24:27], 0
ds_read_u16_d16_hi v210, v210
ds_read_u16 v208, v208
v_rcp_f16_sdwa v153, v153 dst_sel:WORD_1 dst_unused:UNUSED_PRESERVE src0_sel:WORD_1
v_mfma_f32_16x16x32_f16 v[236:239], v[160:163], v[172:175], v[236:239]
ds_read_b128 v[188:191], v248 offset:2048
v_and_b32_sdwa v211, s47, v209 dst_sel:DWORD dst_unused:UNUSED_PAD src0_sel:DWORD src1_sel:WORD_1
v_and_b32_e64 v209, s47, v209
v_rcp_f16_sdwa v155, v155 dst_sel:WORD_1 dst_unused:UNUSED_PRESERVE src0_sel:WORD_1
ds_read_u16_d16_hi v211, v211
ds_read_u16 v209, v209
s_waitcnt lgkmcnt(5)
v_mfma_f32_16x16x32_bf16 v[116:119], v[52:55], v[56:59], v[116:119]
s_waitcnt vmcnt(0)
v_permlane16_swap_b32 v144, v148
v_permlane16_swap_b32 v145, v149
v_permlane16_swap_b32 v146, v150
v_permlane16_swap_b32 v147, v151
v_mfma_f32_16x16x32_f16 v[84:87], v[160:163], v[0:3], v[84:87]
v_cvt_pkrtz_f16_f32 v212, v212, v213
v_cvt_pkrtz_f16_f32 v213, v214, v215
v_lshrrev_b64 v[212:213], 2, v[212:213]
v_and_b32_sdwa v214, s47, v212 dst_sel:DWORD dst_unused:UNUSED_PAD src0_sel:DWORD src1_sel:WORD_1
v_and_b32_e64 v212, s47, v212
v_pk_mul_f16 v10, v152, v153
v_mfma_f32_16x16x32_bf16 v[240:243], v[52:55], v[60:63], v[240:243]
ds_read_u16_d16_hi v214, v214
ds_read_u16 v212, v212
ds_read_b128 v[160:163], v252 offset:7168
v_mfma_f32_16x16x32_f16 v[200:203], v[48:51], v[156:159], v[200:203]
v_and_b32_sdwa v215, s47, v213 dst_sel:DWORD dst_unused:UNUSED_PAD src0_sel:DWORD src1_sel:WORD_1
v_and_b32_e64 v213, s47, v213
v_pk_mul_f16 v11, v154, v155
v_lshl_add_u64 v[14:15], v[80:81], 0, v[82:83]
v_mfma_f32_16x16x32_bf16 v[72:75], v[52:55], v[32:35], v[72:75]
ds_read_u16_d16_hi v215, v215
ds_read_u16 v213, v213
s_setprio 2
v_cvt_pkrtz_f16_f32 v180, v180, v181
v_cvt_pkrtz_f16_f32 v181, v182, v183
v_lshrrev_b64 v[180:181], 2, v[180:181]
v_and_b32_sdwa v182, s47, v180 dst_sel:DWORD dst_unused:UNUSED_PAD src0_sel:DWORD src1_sel:WORD_1
v_and_b32 v180, s47, v180
v_mfma_f32_16x16x32_f16 v[204:207], v[48:51], v[172:175], v[204:207]
ds_read_u16_d16_hi v182, v182
ds_read_u16 v180, v180
ds_read_b128 v[52:55], v248 offset:4096
v_and_b32_sdwa v183, s47, v181 dst_sel:DWORD dst_unused:UNUSED_PAD src0_sel:DWORD src1_sel:WORD_1
v_and_b32_e64 v181, s47, v181
v_mfma_f32_16x16x32_bf16 v[116:119], v[120:123], v[64:67], v[116:119]
ds_read_u16_d16_hi v183, v183
ds_read_u16 v181, v181
v_mfma_f32_16x16x32_f16 v[244:247], v[48:51], v[0:3], v[244:247]
s_waitcnt lgkmcnt(10)
ds_read_b128 v[48:51], v252 offset:5120
v_lshl_add_u64 v[98:99], v[88:89], 0, v[90:91]
v_mfma_f32_16x16x32_bf16 v[240:243], v[120:123], v[68:71], v[240:243]
s_nop 0
v_cvt_pk_f16_f32 v116, v116, v117
v_mfma_f32_16x16x32_f16 v[4:7], v[124:127], v[156:159], v[4:7]
v_cvt_pk_f16_f32 v118, v118, v119
v_pk_fma_f16 v117, v116, v116, s48
v_mfma_f32_16x16x32_bf16 v[72:75], v[120:123], v[40:43], v[72:75]
ds_read_b128 v[120:123], v248 offset:256
s_nop 0
v_cvt_pkrtz_f16_f32 v240, v240, v241
v_mfma_f32_16x16x32_f16 v[224:227], v[124:127], v[172:175], v[224:227]
v_cvt_pkrtz_f16_f32 v241, v242, v243
v_lshrrev_b64 v[240:241], 2, v[240:241]
v_mfma_f32_16x16x32_bf16 v[24:27], v[184:187], v[28:31], 0
v_and_b32_sdwa v242, s47, v240 dst_sel:DWORD dst_unused:UNUSED_PAD src0_sel:DWORD src1_sel:WORD_1
v_and_b32 v240, s47, v240
v_mfma_f32_16x16x32_f16 v[92:95], v[124:127], v[0:3], v[92:95]
ds_read_b128 v[124:127], v252 offset:8192
ds_read_u16_d16_hi v242, v242
v_mfma_f32_16x16x32_bf16 v[164:167], v[18:21], v[228:231], v[164:167]
ds_read_u16 v240, v240
v_and_b32_sdwa v243, s47, v241 dst_sel:DWORD dst_unused:UNUSED_PAD src0_sel:DWORD src1_sel:WORD_1
v_mfma_f32_16x16x32_bf16 v[216:219], v[16:19], v[228:231], v[216:219]
v_and_b32 v241, s47, v241
v_pk_fma_f16 v119, v118, v118, s48
v_mfma_f32_16x16x32_bf16 v[100:103], v[18:21], v[112:115], v[100:103]
s_waitcnt lgkmcnt(8)
ds_read_u16_d16_hi v243, v243
ds_read_u16 v241, v241
v_mfma_f32_16x16x32_bf16 v[232:235], v[16:19], v[112:115], v[232:235]
v_pk_mul_f16 v117, v116, v117
v_pk_mul_f16 v119, v118, v119
v_mfma_f32_16x16x32_bf16 v[56:59], v[184:187], v[128:131], 0
v_cvt_pkrtz_f16_f32 v72, v72, v73
v_cvt_pkrtz_f16_f32 v73, v74, v75
v_mfma_f32_16x16x32_f16 v[164:167], v[176:179], v[96:99], v[164:167]
s_setprio 1
v_lshrrev_b64 v[72:73], 2, v[72:73]
v_and_b32_sdwa v74, s47, v72 dst_sel:DWORD dst_unused:UNUSED_PAD src0_sel:DWORD src1_sel:WORD_1
v_mfma_f32_16x16x32_bf16 v[60:63], v[184:187], v[136:139], 0
ds_read_b128 v[184:187], v248 offset:2304
v_and_b32 v72, s47, v72
v_mfma_f32_16x16x32_f16 v[168:171], v[176:179], v[12:15], v[168:171]
ds_read_u16_d16_hi v74, v74
ds_read_u16 v72, v72
v_mfma_f32_16x16x32_bf16 v[24:27], v[188:191], v[36:39], v[24:27]
v_lshl_add_u64 v[208:209], v[208:209], 0, v[210:211]
v_exp_f16_sdwa v117, v117 dst_sel:WORD_0 dst_unused:UNUSED_PRESERVE src0_sel:WORD_0
v_mfma_f32_16x16x32_f16 v[132:135], v[176:179], v[8:11], v[132:135]
ds_read_b128 v[176:179], v252 offset:6144
v_exp_f16_sdwa v119, v119 dst_sel:WORD_0 dst_unused:UNUSED_PRESERVE src0_sel:WORD_0
v_mfma_f32_16x16x32_bf16 v[56:59], v[188:191], v[108:111], v[56:59]
v_and_b32_sdwa v75, s47, v73 dst_sel:DWORD dst_unused:UNUSED_PAD src0_sel:DWORD src1_sel:WORD_1
v_and_b32 v73, s47, v73
v_mfma_f32_16x16x32_f16 v[216:219], v[160:163], v[96:99], v[216:219]
ds_read_u16_d16_hi v75, v75
s_waitcnt lgkmcnt(7)
ds_read_u16 v73, v73
v_mfma_f32_16x16x32_bf16 v[60:63], v[188:191], v[192:195], v[60:63]
ds_read_b128 v[188:191], v248 offset:4352
v_lshl_add_u64 v[212:213], v[212:213], 0, v[214:215]
v_mfma_f32_16x16x32_f16 v[220:223], v[160:163], v[12:15], v[220:223]
v_exp_f16_sdwa v117, v117 dst_sel:WORD_1 dst_unused:UNUSED_PRESERVE src0_sel:WORD_1
v_mfma_f32_16x16x32_bf16 v[24:27], v[52:55], v[44:47], v[24:27]
v_exp_f16_sdwa v119, v119 dst_sel:WORD_1 dst_unused:UNUSED_PRESERVE src0_sel:WORD_1
v_mfma_f32_16x16x32_f16 v[76:79], v[160:163], v[8:11], v[76:79]
ds_read_b128 v[160:163], v252 offset:9216
v_lshl_add_u64 v[180:181], v[180:181], 0, v[182:183]
v_mfma_f32_16x16x32_bf16 v[56:59], v[52:55], v[144:147], v[56:59]
v_pk_add_f16 v117, v117, 1.0 op_sel_hi:[1,0]
v_pk_add_f16 v119, v119, 1.0 op_sel_hi:[1,0]
v_mfma_f32_16x16x32_f16 v[100:103], v[48:51], v[96:99], v[100:103]
s_setprio 0
v_rcp_f16_sdwa v117, v117 dst_sel:WORD_0 dst_unused:UNUSED_PRESERVE src0_sel:WORD_0
v_mfma_f32_16x16x32_bf16 v[60:63], v[52:55], v[148:151], v[60:63]
ds_read_b128 v[52:55], v248 offset:6144
v_rcp_f16_sdwa v119, v119 dst_sel:WORD_0 dst_unused:UNUSED_PRESERVE src0_sel:WORD_0
v_mfma_f32_16x16x32_f16 v[104:107], v[48:51], v[12:15], v[104:107]
v_cvt_pkrtz_f16_f32 v24, v24, v25
v_cvt_pkrtz_f16_f32 v25, v26, v27
v_mfma_f32_16x16x32_bf16 v[32:35], v[120:123], v[28:31], 0
v_lshrrev_b64 v[24:25], 2, v[24:25]
v_and_b32_sdwa v26, s47, v24 dst_sel:DWORD dst_unused:UNUSED_PAD src0_sel:DWORD src1_sel:WORD_1
v_mfma_f32_16x16x32_f16 v[140:143], v[48:51], v[8:11], v[140:143]
ds_read_b128 v[48:51], v252 offset:10240
v_and_b32 v24, s47, v24
v_mfma_f32_16x16x32_bf16 v[152:155], v[120:123], v[128:131], 0
ds_read_u16_d16_hi v26, v26
ds_read_u16 v24, v24
v_mfma_f32_16x16x32_f16 v[232:235], v[124:127], v[96:99], v[232:235]
v_rcp_f16_sdwa v117, v117 dst_sel:WORD_1 dst_unused:UNUSED_PRESERVE src0_sel:WORD_1
v_mfma_f32_16x16x32_bf16 v[80:83], v[120:123], v[136:139], 0
ds_read_b128 v[120:123], v248 offset:8192
v_and_b32_sdwa v27, s47, v25 dst_sel:DWORD dst_unused:UNUSED_PAD src0_sel:DWORD src1_sel:WORD_1
v_mfma_f32_16x16x32_f16 v[236:239], v[124:127], v[12:15], v[236:239]
v_and_b32 v25, s47, v25
v_rcp_f16_sdwa v119, v119 dst_sel:WORD_1 dst_unused:UNUSED_PRESERVE src0_sel:WORD_1
s_waitcnt lgkmcnt(4)
v_mfma_f32_16x16x32_bf16 v[32:35], v[184:187], v[36:39], v[32:35]
ds_read_u16_d16_hi v27, v27
ds_read_u16 v25, v25
v_mfma_f32_16x16x32_f16 v[84:87], v[124:127], v[8:11], v[84:87]
v_cvt_pkrtz_f16_f32 v56, v56, v57
v_cvt_pkrtz_f16_f32 v57, v58, v59
v_lshrrev_b64 v[56:57], 2, v[56:57]
v_and_b32_sdwa v58, s47, v56 dst_sel:DWORD dst_unused:UNUSED_PAD src0_sel:DWORD src1_sel:WORD_1
v_and_b32_e64 v56, s47, v56
v_pk_mul_f16 v210, v116, v117
v_mfma_f32_16x16x32_bf16 v[152:155], v[184:187], v[108:111], v[152:155]
ds_read_u16_d16_hi v58, v58
ds_read_u16 v56, v56
ds_read_b128 v[124:127], v252 offset:13312
v_mfma_f32_16x16x32_f16 v[200:203], v[176:179], v[96:99], v[200:203]
v_and_b32_sdwa v59, s47, v57 dst_sel:DWORD dst_unused:UNUSED_PAD src0_sel:DWORD src1_sel:WORD_1
v_and_b32_e64 v57, s47, v57
v_pk_mul_f16 v211, v118, v119
v_lshl_add_u64 v[214:215], v[240:241], 0, v[242:243]
v_mfma_f32_16x16x32_bf16 v[80:83], v[184:187], v[192:195], v[80:83]
ds_read_u16_d16_hi v59, v59
ds_read_u16 v57, v57
s_setprio 3
v_cvt_pkrtz_f16_f32 v60, v60, v61
v_cvt_pkrtz_f16_f32 v61, v62, v63
v_lshrrev_b64 v[60:61], 2, v[60:61]
v_and_b32_sdwa v62, s47, v60 dst_sel:DWORD dst_unused:UNUSED_PAD src0_sel:DWORD src1_sel:WORD_1
v_and_b32 v60, s47, v60
v_mfma_f32_16x16x32_f16 v[204:207], v[176:179], v[12:15], v[204:207]
ds_read_u16_d16_hi v62, v62
ds_read_u16 v60, v60
ds_read_b128 v[184:187], v248 offset:10240
v_and_b32_sdwa v63, s47, v61 dst_sel:DWORD dst_unused:UNUSED_PAD src0_sel:DWORD src1_sel:WORD_1
v_and_b32 v61, s47, v61
v_mfma_f32_16x16x32_bf16 v[32:35], v[188:191], v[44:47], v[32:35]
ds_read_u16_d16_hi v63, v63
s_waitcnt lgkmcnt(9)
ds_read_u16 v61, v61
v_mfma_f32_16x16x32_f16 v[244:247], v[176:179], v[8:11], v[244:247]
ds_read_b128 v[176:179], v252 offset:11264
v_lshl_add_u64 v[182:183], v[72:73], 0, v[74:75]
v_mfma_f32_16x16x32_bf16 v[152:155], v[188:191], v[144:147], v[152:155]
s_nop 0
v_cvt_pk_f16_f32 v32, v32, v33
v_mfma_f32_16x16x32_f16 v[4:7], v[160:163], v[96:99], v[4:7]
v_cvt_pk_f16_f32 v34, v34, v35
v_pk_fma_f16 v33, v32, v32, s48
v_mfma_f32_16x16x32_bf16 v[80:83], v[188:191], v[148:151], v[80:83]
ds_read_b128 v[188:191], v248 offset:6400
s_nop 0
v_cvt_pkrtz_f16_f32 v152, v152, v153
v_mfma_f32_16x16x32_f16 v[224:227], v[160:163], v[12:15], v[224:227]
v_cvt_pkrtz_f16_f32 v153, v154, v155
v_lshrrev_b64 v[152:153], 2, v[152:153]
v_mfma_f32_16x16x32_bf16 v[88:91], v[52:55], v[28:31], 0
v_and_b32_sdwa v154, s47, v152 dst_sel:DWORD dst_unused:UNUSED_PAD src0_sel:DWORD src1_sel:WORD_1
v_and_b32_e64 v152, s47, v152
v_mfma_f32_16x16x32_f16 v[92:95], v[160:163], v[8:11], v[92:95]
ds_read_b128 v[160:163], v252 offset:14336
ds_read_u16_d16_hi v154, v154
v_mfma_f32_16x16x32_bf16 v[64:67], v[52:55], v[128:131], 0
ds_read_u16 v152, v152
v_and_b32_sdwa v155, s47, v153 dst_sel:DWORD dst_unused:UNUSED_PAD src0_sel:DWORD src1_sel:WORD_1
v_mfma_f32_16x16x32_f16 v[164:167], v[48:51], v[180:183], v[164:167]
s_setprio 2
v_and_b32_e64 v153, s47, v153
v_pk_fma_f16 v35, v34, v34, s48
v_mfma_f32_16x16x32_bf16 v[68:71], v[52:55], v[136:139], 0
s_waitcnt lgkmcnt(8)
ds_read_b128 v[52:55], v248 offset:8448
ds_read_u16_d16_hi v155, v155
v_mfma_f32_16x16x32_f16 v[168:171], v[48:51], v[212:215], v[168:171]
ds_read_u16 v153, v153
v_pk_mul_f16 v33, v32, v33
v_mfma_f32_16x16x32_bf16 v[88:91], v[120:123], v[36:39], v[88:91]
v_pk_mul_f16 v35, v34, v35
v_cvt_pkrtz_f16_f32 v80, v80, v81
v_mfma_f32_16x16x32_f16 v[132:135], v[48:51], v[208:211], v[132:135]
ds_read_b128 v[48:51], v252 offset:12288
v_cvt_pkrtz_f16_f32 v81, v82, v83
v_mfma_f32_16x16x32_bf16 v[64:67], v[120:123], v[108:111], v[64:67]
v_lshrrev_b64 v[80:81], 2, v[80:81]
v_and_b32_sdwa v82, s47, v80 dst_sel:DWORD dst_unused:UNUSED_PAD src0_sel:DWORD src1_sel:WORD_1
v_mfma_f32_16x16x32_f16 v[216:219], v[124:127], v[180:183], v[216:219]
v_and_b32_e64 v80, s47, v80
v_lshl_add_u64 v[24:25], v[24:25], 0, v[26:27]
v_exp_f16_sdwa v33, v33 dst_sel:WORD_0 dst_unused:UNUSED_PRESERVE src0_sel:WORD_0
v_mfma_f32_16x16x32_bf16 v[68:71], v[120:123], v[192:195], v[68:71]
ds_read_u16_d16_hi v82, v82
ds_read_u16 v80, v80
v_mfma_f32_16x16x32_f16 v[220:223], v[124:127], v[212:215], v[220:223]
ds_read_b128 v[120:123], v248 offset:10496
v_exp_f16_sdwa v35, v35 dst_sel:WORD_0 dst_unused:UNUSED_PRESERVE src0_sel:WORD_0
v_and_b32_sdwa v83, s47, v81 dst_sel:DWORD dst_unused:UNUSED_PAD src0_sel:DWORD src1_sel:WORD_1
v_and_b32_e64 v81, s47, v81
s_waitcnt lgkmcnt(8)
v_mfma_f32_16x16x32_bf16 v[88:91], v[184:187], v[44:47], v[88:91]
ds_read_u16_d16_hi v83, v83
ds_read_u16 v81, v81
v_lshl_add_u64 v[56:57], v[56:57], 0, v[58:59]
v_mfma_f32_16x16x32_f16 v[76:79], v[124:127], v[208:211], v[76:79]
v_exp_f16_sdwa v33, v33 dst_sel:WORD_1 dst_unused:UNUSED_PRESERVE src0_sel:WORD_1
v_mfma_f32_16x16x32_bf16 v[64:67], v[184:187], v[144:147], v[64:67]
ds_read_b128 v[124:127], v252 offset:15360
s_setprio 1
v_exp_f16_sdwa v35, v35 dst_sel:WORD_1 dst_unused:UNUSED_PRESERVE src0_sel:WORD_1
v_mfma_f32_16x16x32_f16 v[100:103], v[176:179], v[180:183], v[100:103]
v_lshl_add_u64 v[60:61], v[60:61], 0, v[62:63]
v_pk_add_f16 v33, v33, 1.0 op_sel_hi:[1,0]
v_mfma_f32_16x16x32_bf16 v[68:71], v[184:187], v[148:151], v[68:71]
ds_read_b128 v[184:187], v248 offset:12288
v_pk_add_f16 v35, v35, 1.0 op_sel_hi:[1,0]
v_mfma_f32_16x16x32_f16 v[104:107], v[176:179], v[212:215], v[104:107]
v_rcp_f16_sdwa v33, v33 dst_sel:WORD_0 dst_unused:UNUSED_PRESERVE src0_sel:WORD_0
v_mfma_f32_16x16x32_bf16 v[40:43], v[188:191], v[28:31], 0
v_rcp_f16_sdwa v35, v35 dst_sel:WORD_0 dst_unused:UNUSED_PRESERVE src0_sel:WORD_0
v_mfma_f32_16x16x32_f16 v[140:143], v[176:179], v[208:211], v[140:143]
ds_read_b128 v[176:179], v251 offset:8192
v_cvt_pkrtz_f16_f32 v64, v64, v65
v_mfma_f32_16x16x32_bf16 v[0:3], v[188:191], v[128:131], 0
v_cvt_pkrtz_f16_f32 v65, v66, v67
v_lshrrev_b64 v[64:65], 2, v[64:65]
v_mfma_f32_16x16x32_f16 v[232:235], v[160:163], v[180:183], v[232:235]
v_and_b32_sdwa v66, s47, v64 dst_sel:DWORD dst_unused:UNUSED_PAD src0_sel:DWORD src1_sel:WORD_1
v_and_b32_e64 v64, s47, v64
v_cvt_pk_f16_f32 v88, v88, v89
v_mfma_f32_16x16x32_bf16 v[172:175], v[188:191], v[136:139], 0
ds_read_u16_d16_hi v66, v66
ds_read_u16 v64, v64
v_rcp_f16_sdwa v33, v33 dst_sel:WORD_1 dst_unused:UNUSED_PRESERVE src0_sel:WORD_1
v_mfma_f32_16x16x32_f16 v[236:239], v[160:163], v[212:215], v[236:239]
v_cvt_pk_f16_f32 v90, v90, v91
v_pk_fma_f16 v89, v88, v88, s48
v_rcp_f16_sdwa v35, v35 dst_sel:WORD_1 dst_unused:UNUSED_PRESERVE src0_sel:WORD_1
s_waitcnt lgkmcnt(3)
v_mfma_f32_16x16x32_bf16 v[40:43], v[52:55], v[36:39], v[40:43]
ds_read_b128 v[188:191], v248 offset:14336
v_and_b32_sdwa v67, s47, v65 dst_sel:DWORD dst_unused:UNUSED_PAD src0_sel:DWORD src1_sel:WORD_1
v_and_b32 v65, s47, v65
v_pk_fma_f16 v91, v90, v90, s48
v_mfma_f32_16x16x32_f16 v[84:87], v[160:163], v[208:211], v[84:87]
ds_read_u16_d16_hi v67, v67
ds_read_u16 v65, v65
ds_read_b128 v[160:163], v251 offset:11264
v_pk_mul_f16 v89, v88, v89
v_pk_mul_f16 v26, v32, v33
v_mfma_f32_16x16x32_bf16 v[0:3], v[52:55], v[108:111], v[0:3]
s_setprio 0
v_pk_mul_f16 v91, v90, v91
v_cvt_pkrtz_f16_f32 v68, v68, v69
v_mfma_f32_16x16x32_f16 v[200:203], v[48:51], v[180:183], v[200:203]
v_cvt_pkrtz_f16_f32 v69, v70, v71
v_lshrrev_b64 v[68:69], 2, v[68:69]
v_and_b32_sdwa v70, s47, v68 dst_sel:DWORD dst_unused:UNUSED_PAD src0_sel:DWORD src1_sel:WORD_1
v_and_b32 v68, s47, v68
v_pk_mul_f16 v27, v34, v35
v_exp_f16_sdwa v89, v89 dst_sel:WORD_0 dst_unused:UNUSED_PRESERVE src0_sel:WORD_0
v_lshl_add_u64 v[58:59], v[152:153], 0, v[154:155]
v_mfma_f32_16x16x32_bf16 v[172:175], v[52:55], v[192:195], v[172:175]
ds_read_u16_d16_hi v70, v70
ds_read_u16 v68, v68
v_mfma_f32_16x16x32_f16 v[204:207], v[48:51], v[212:215], v[204:207]
ds_read_b128 v[52:55], v248 offset:16384
v_exp_f16_sdwa v91, v91 dst_sel:WORD_0 dst_unused:UNUSED_PRESERVE src0_sel:WORD_0
v_and_b32_sdwa v71, s47, v69 dst_sel:DWORD dst_unused:UNUSED_PAD src0_sel:DWORD src1_sel:WORD_1
v_and_b32_e64 v69, s47, v69
v_mfma_f32_16x16x32_bf16 v[40:43], v[120:123], v[44:47], v[40:43]
ds_read_u16_d16_hi v71, v71
ds_read_u16 v69, v69
v_mfma_f32_16x16x32_f16 v[244:247], v[48:51], v[208:211], v[244:247]
v_cvt_pk_bf16_f32 v132, v132, v133
v_cvt_pk_bf16_f32 v133, v134, v135
v_cvt_pk_bf16_f32 v134, v76, v77
v_cvt_pk_bf16_f32 v135, v78, v79
v_cvt_pk_bf16_f32 v168, v168, v169
v_cvt_pk_bf16_f32 v169, v170, v171
v_cvt_pk_bf16_f32 v170, v220, v221
v_cvt_pk_bf16_f32 v171, v222, v223
v_cvt_pk_bf16_f32 v164, v164, v165
v_cvt_pk_bf16_f32 v165, v166, v167
v_cvt_pk_bf16_f32 v166, v216, v217
v_cvt_pk_bf16_f32 v167, v218, v219
v_exp_f16_sdwa v89, v89 dst_sel:WORD_1 dst_unused:UNUSED_PRESERVE src0_sel:WORD_1
v_cvt_pk_bf16_f32 v140, v140, v141
v_cvt_pk_bf16_f32 v141, v142, v143
v_cvt_pk_bf16_f32 v142, v84, v85
v_cvt_pk_bf16_f32 v143, v86, v87
v_cvt_pk_bf16_f32 v104, v104, v105
ds_read_b128 v[76:79], v254 offset:8192
ds_read_b128 v[220:223], v254 offset:8208
ds_read_b128 v[48:51], v251 offset:9216
v_cvt_pk_bf16_f32 v105, v106, v107
v_cvt_pk_bf16_f32 v106, v236, v237
v_cvt_pk_bf16_f32 v107, v238, v239
v_cvt_pk_bf16_f32 v100, v100, v101
v_cvt_pk_bf16_f32 v101, v102, v103
v_cvt_pk_bf16_f32 v102, v232, v233
v_cvt_pk_bf16_f32 v103, v234, v235
v_mfma_f32_16x16x32_bf16 v[0:3], v[120:123], v[144:147], v[0:3]
s_waitcnt lgkmcnt(5)
ds_read_b128 v[84:87], v254 offset:8320
ds_read_b128 v[236:239], v254 offset:8336
v_mfma_f32_16x16x32_f16 v[4:7], v[124:127], v[180:183], v[4:7]
v_lshl_add_u64 v[62:63], v[80:81], 0, v[82:83]
v_exp_f16_sdwa v91, v91 dst_sel:WORD_1 dst_unused:UNUSED_PRESERVE src0_sel:WORD_1
v_cvt_pk_bf16_f32 v244, v244, v245
v_cvt_pk_bf16_f32 v245, v246, v247
v_cvt_pk_bf16_f32 v204, v204, v205
v_cvt_pk_bf16_f32 v205, v206, v207
v_mfma_f32_16x16x32_bf16 v[172:175], v[120:123], v[148:151], v[172:175]
v_pk_add_f16 v89, v89, 1.0 op_sel_hi:[1,0]
v_pk_add_f16 v91, v91, 1.0 op_sel_hi:[1,0]
v_mfma_f32_16x16x32_f16 v[224:227], v[124:127], v[212:215], v[224:227]
ds_read_b128 v[120:123], v248 offset:12544
v_rcp_f16_sdwa v89, v89 dst_sel:WORD_0 dst_unused:UNUSED_PRESERVE src0_sel:WORD_0
v_mfma_f32_16x16x32_bf16 v[156:159], v[184:187], v[28:31], 0
v_rcp_f16_sdwa v91, v91 dst_sel:WORD_0 dst_unused:UNUSED_PRESERVE src0_sel:WORD_0
v_mfma_f32_16x16x32_f16 v[92:95], v[124:127], v[208:211], v[92:95]
s_nop 2
v_cvt_pk_bf16_f32 v206, v224, v225
v_cvt_pk_bf16_f32 v207, v226, v227
v_mfma_f32_16x16x32_bf16 v[200:203], v[18:21], v[196:199], v[200:203]
ds_read_b128 v[224:227], v254 offset:16
ds_read_b128 v[124:127], v251 offset:12288
v_mfma_f32_16x16x32_bf16 v[4:7], v[16:19], v[196:199], v[4:7]
v_cvt_pkrtz_f16_f32 v40, v40, v41
v_cvt_pk_bf16_f32 v246, v92, v93
v_cvt_pk_bf16_f32 v247, v94, v95
v_mfma_f32_16x16x32_bf16 v[228:231], v[184:187], v[128:131], 0
ds_read_b128 v[92:95], v254
v_cvt_pk_bf16_f32 v200, v200, v201
v_cvt_pk_bf16_f32 v201, v202, v203
s_setprio 3
v_cvt_pk_bf16_f32 v202, v4, v5
v_cvt_pk_bf16_f32 v203, v6, v7
s_waitcnt lgkmcnt(4)
v_mfma_f32_16x16x32_f16 v[116:119], v[176:179], v[60:63], v[76:79]
v_cvt_pkrtz_f16_f32 v41, v42, v43
v_lshrrev_b64 v[40:41], 2, v[40:41]
v_and_b32_sdwa v42, s47, v40 dst_sel:DWORD dst_unused:UNUSED_PAD src0_sel:DWORD src1_sel:WORD_1
v_and_b32_e64 v40, s47, v40
v_mfma_f32_16x16x32_bf16 v[112:115], v[184:187], v[136:139], 0
ds_read_u16_d16_hi v42, v42
ds_read_u16 v40, v40
v_rcp_f16_sdwa v89, v89 dst_sel:WORD_1 dst_unused:UNUSED_PRESERVE src0_sel:WORD_1
buffer_store_dwordx4 v[132:135], v253, s[8:11], s70 offen sc1
buffer_store_dwordx4 v[140:143], v253, s[8:11], s70 offen offset:64 sc1
v_mfma_f32_16x16x32_f16 v[240:243], v[176:179], v[56:59], v[76:79]
ds_read_b128 v[184:187], v248 offset:14592
v_and_b32_sdwa v43, s47, v41 dst_sel:DWORD dst_unused:UNUSED_PAD src0_sel:DWORD src1_sel:WORD_1
v_and_b32_e64 v41, s47, v41
v_rcp_f16_sdwa v91, v91 dst_sel:WORD_1 dst_unused:UNUSED_PRESERVE src0_sel:WORD_1
v_mfma_f32_16x16x32_bf16 v[156:159], v[188:191], v[36:39], v[156:159]
ds_read_u16_d16_hi v43, v43
ds_read_u16 v41, v41
v_mfma_f32_16x16x32_f16 v[76:79], v[176:179], v[24:27], v[76:79]
v_cvt_pkrtz_f16_f32 v0, v0, v1
v_cvt_pkrtz_f16_f32 v1, v2, v3
v_lshrrev_b64 v[0:1], 2, v[0:1]
v_and_b32_sdwa v2, s47, v0 dst_sel:DWORD dst_unused:UNUSED_PAD src0_sel:DWORD src1_sel:WORD_1
v_and_b32_e64 v0, s47, v0
v_pk_mul_f16 v88, v88, v89
v_mfma_f32_16x16x32_bf16 v[228:231], v[188:191], v[108:111], v[228:231]
ds_read_u16_d16_hi v2, v2
ds_read_u16 v0, v0
ds_read_b128 v[176:179], v251 offset:10240
v_mfma_f32_16x16x32_f16 v[72:75], v[160:163], v[60:63], v[220:223]
v_and_b32_sdwa v3, s47, v1 dst_sel:DWORD dst_unused:UNUSED_PAD src0_sel:DWORD src1_sel:WORD_1
v_and_b32_e64 v1, s47, v1
v_pk_mul_f16 v89, v90, v91
v_lshl_add_u64 v[64:65], v[64:65], 0, v[66:67]
v_mfma_f32_16x16x32_bf16 v[112:115], v[188:191], v[192:195], v[112:115]
ds_read_u16_d16_hi v3, v3
ds_read_u16 v1, v1
v_cvt_pkrtz_f16_f32 v172, v172, v173
v_cvt_pkrtz_f16_f32 v173, v174, v175
v_lshrrev_b64 v[172:173], 2, v[172:173]
v_and_b32_sdwa v174, s47, v172 dst_sel:DWORD dst_unused:UNUSED_PAD src0_sel:DWORD src1_sel:WORD_1
v_and_b32 v172, s47, v172
v_mfma_f32_16x16x32_f16 v[8:11], v[160:163], v[56:59], v[220:223]
ds_read_u16_d16_hi v174, v174
s_waitcnt lgkmcnt(7)
ds_read_u16 v172, v172
ds_read_b128 v[188:191], v248 offset:16640
v_and_b32_sdwa v175, s47, v173 dst_sel:DWORD dst_unused:UNUSED_PAD src0_sel:DWORD src1_sel:WORD_1
v_and_b32_e64 v173, s47, v173
v_mfma_f32_16x16x32_bf16 v[156:159], v[52:55], v[44:47], v[156:159]
ds_read_u16_d16_hi v175, v175
ds_read_u16 v173, v173
v_mfma_f32_16x16x32_f16 v[220:223], v[160:163], v[24:27], v[220:223]
ds_read_b128 v[160:163], v251 offset:13312
s_setprio 2
v_lshl_add_u64 v[68:69], v[68:69], 0, v[70:71]
v_mfma_f32_16x16x32_bf16 v[228:231], v[52:55], v[144:147], v[228:231]
s_nop 0
v_cvt_pk_f16_f32 v156, v156, v157
v_mfma_f32_16x16x32_f16 v[12:15], v[48:51], v[60:63], v[84:87]
v_cvt_pk_f16_f32 v158, v158, v159
v_pk_fma_f16 v157, v156, v156, s48
v_mfma_f32_16x16x32_bf16 v[112:115], v[52:55], v[148:151], v[112:115]
ds_read_b128 v[52:55], v248 offset:18432
s_nop 0
v_cvt_pkrtz_f16_f32 v228, v228, v229
v_mfma_f32_16x16x32_f16 v[96:99], v[48:51], v[56:59], v[84:87]
v_cvt_pkrtz_f16_f32 v229, v230, v231
v_lshrrev_b64 v[228:229], 2, v[228:229]
v_mfma_f32_16x16x32_bf16 v[32:35], v[120:123], v[28:31], 0
v_and_b32_sdwa v230, s47, v228 dst_sel:DWORD dst_unused:UNUSED_PAD src0_sel:DWORD src1_sel:WORD_1
v_and_b32 v228, s47, v228
v_mfma_f32_16x16x32_f16 v[84:87], v[48:51], v[24:27], v[84:87]
ds_read_b128 v[48:51], v251 offset:14336
ds_read_u16_d16_hi v230, v230
v_mfma_f32_16x16x32_bf16 v[152:155], v[120:123], v[128:131], 0
s_waitcnt lgkmcnt(9)
ds_read_u16 v228, v228
v_and_b32_sdwa v231, s47, v229 dst_sel:DWORD dst_unused:UNUSED_PAD src0_sel:DWORD src1_sel:WORD_1
v_mfma_f32_16x16x32_f16 v[208:211], v[124:127], v[60:63], v[236:239]
v_and_b32 v229, s47, v229
v_pk_fma_f16 v159, v158, v158, s48
v_mfma_f32_16x16x32_bf16 v[80:83], v[120:123], v[136:139], 0
ds_read_b128 v[120:123], v248 offset:20480
ds_read_u16_d16_hi v231, v231
v_mfma_f32_16x16x32_f16 v[212:215], v[124:127], v[56:59], v[236:239]
ds_read_u16 v229, v229
v_pk_mul_f16 v157, v156, v157
v_mfma_f32_16x16x32_bf16 v[32:35], v[184:187], v[36:39], v[32:35]
v_pk_mul_f16 v159, v158, v159
v_cvt_pkrtz_f16_f32 v112, v112, v113
v_mfma_f32_16x16x32_f16 v[236:239], v[124:127], v[24:27], v[236:239]
ds_read_b128 v[124:127], v251 offset:17408
s_setprio 1
v_cvt_pkrtz_f16_f32 v113, v114, v115
v_mfma_f32_16x16x32_bf16 v[152:155], v[184:187], v[108:111], v[152:155]
v_lshrrev_b64 v[112:113], 2, v[112:113]
v_and_b32_sdwa v114, s47, v112 dst_sel:DWORD dst_unused:UNUSED_PAD src0_sel:DWORD src1_sel:WORD_1
v_mfma_f32_16x16x32_f16 v[180:183], v[176:179], v[60:63], v[92:95]
v_and_b32 v112, s47, v112
v_lshl_add_u64 v[90:91], v[40:41], 0, v[42:43]
v_exp_f16_sdwa v157, v157 dst_sel:WORD_0 dst_unused:UNUSED_PRESERVE src0_sel:WORD_0
v_mfma_f32_16x16x32_bf16 v[80:83], v[184:187], v[192:195], v[80:83]
ds_read_u16_d16_hi v114, v114
s_waitcnt lgkmcnt(7)
ds_read_u16 v112, v112
v_mfma_f32_16x16x32_f16 v[196:199], v[176:179], v[56:59], v[92:95]
ds_read_b128 v[184:187], v248 offset:22528
v_exp_f16_sdwa v159, v159 dst_sel:WORD_0 dst_unused:UNUSED_PRESERVE src0_sel:WORD_0
v_and_b32_sdwa v115, s47, v113 dst_sel:DWORD dst_unused:UNUSED_PAD src0_sel:DWORD src1_sel:WORD_1
v_and_b32 v113, s47, v113
v_mfma_f32_16x16x32_bf16 v[32:35], v[188:191], v[44:47], v[32:35]
ds_read_u16_d16_hi v115, v115
ds_read_u16 v113, v113
v_lshl_add_u64 v[66:67], v[0:1], 0, v[2:3]
v_mfma_f32_16x16x32_f16 v[92:95], v[176:179], v[24:27], v[92:95]
v_exp_f16_sdwa v157, v157 dst_sel:WORD_1 dst_unused:UNUSED_PRESERVE src0_sel:WORD_1
v_mfma_f32_16x16x32_bf16 v[152:155], v[188:191], v[144:147], v[152:155]
ds_read_b128 v[176:179], v251 offset:15360
v_exp_f16_sdwa v159, v159 dst_sel:WORD_1 dst_unused:UNUSED_PRESERVE src0_sel:WORD_1
v_mfma_f32_16x16x32_f16 v[216:219], v[160:163], v[60:63], v[224:227]
v_lshl_add_u64 v[70:71], v[172:173], 0, v[174:175]
v_pk_add_f16 v157, v157, 1.0 op_sel_hi:[1,0]
v_mfma_f32_16x16x32_bf16 v[80:83], v[188:191], v[148:151], v[80:83]
ds_read_b128 v[188:191], v248 offset:18688
v_pk_add_f16 v159, v159, 1.0 op_sel_hi:[1,0]
v_mfma_f32_16x16x32_f16 v[232:235], v[160:163], v[56:59], v[224:227]
v_rcp_f16_sdwa v157, v157 dst_sel:WORD_0 dst_unused:UNUSED_PRESERVE src0_sel:WORD_0
v_mfma_f32_16x16x32_bf16 v[4:7], v[52:55], v[28:31], 0
v_rcp_f16_sdwa v159, v159 dst_sel:WORD_0 dst_unused:UNUSED_PRESERVE src0_sel:WORD_0
v_mfma_f32_16x16x32_f16 v[224:227], v[160:163], v[24:27], v[224:227]
s_setprio 0
ds_read_b128 v[160:163], v251 offset:18432
v_cvt_pkrtz_f16_f32 v152, v152, v153
v_mfma_f32_16x16x32_bf16 v[132:135], v[52:55], v[128:131], 0
v_cvt_pkrtz_f16_f32 v153, v154, v155
v_lshrrev_b64 v[152:153], 2, v[152:153]
v_mfma_f32_16x16x32_f16 v[116:119], v[48:51], v[68:71], v[116:119]
v_and_b32_sdwa v154, s47, v152 dst_sel:DWORD dst_unused:UNUSED_PAD src0_sel:DWORD src1_sel:WORD_1
v_and_b32_e64 v152, s47, v152
v_cvt_pk_f16_f32 v32, v32, v33
v_mfma_f32_16x16x32_bf16 v[140:143], v[52:55], v[136:139], 0
ds_read_u16_d16_hi v154, v154
s_waitcnt lgkmcnt(5)
ds_read_u16 v152, v152
v_rcp_f16_sdwa v157, v157 dst_sel:WORD_1 dst_unused:UNUSED_PRESERVE src0_sel:WORD_1
v_mfma_f32_16x16x32_f16 v[240:243], v[48:51], v[64:67], v[240:243]
v_cvt_pk_f16_f32 v34, v34, v35
v_pk_fma_f16 v33, v32, v32, s48
v_rcp_f16_sdwa v159, v159 dst_sel:WORD_1 dst_unused:UNUSED_PRESERVE src0_sel:WORD_1
v_mfma_f32_16x16x32_bf16 v[4:7], v[120:123], v[36:39], v[4:7]
ds_read_b128 v[52:55], v248 offset:20736
v_and_b32_sdwa v155, s47, v153 dst_sel:DWORD dst_unused:UNUSED_PAD src0_sel:DWORD src1_sel:WORD_1
v_and_b32_e64 v153, s47, v153
v_pk_fma_f16 v35, v34, v34, s48
v_mfma_f32_16x16x32_f16 v[76:79], v[48:51], v[88:91], v[76:79]
ds_read_u16_d16_hi v155, v155
ds_read_u16 v153, v153
buffer_store_dwordx4 v[244:247], v253, s[8:11], s70 offen offset:128 sc1
buffer_store_dwordx4 v[168:171], v253, s[8:11], s70 offen offset:192 sc1
ds_read_b128 v[48:51], v251 offset:16384
v_pk_mul_f16 v33, v32, v33
v_pk_mul_f16 v156, v156, v157
v_mfma_f32_16x16x32_bf16 v[132:135], v[120:123], v[108:111], v[132:135]
v_pk_mul_f16 v35, v34, v35
v_cvt_pkrtz_f16_f32 v80, v80, v81
v_mfma_f32_16x16x32_f16 v[72:75], v[124:127], v[68:71], v[72:75]
v_cvt_pkrtz_f16_f32 v81, v82, v83
v_lshrrev_b64 v[80:81], 2, v[80:81]
v_and_b32_sdwa v82, s47, v80 dst_sel:DWORD dst_unused:UNUSED_PAD src0_sel:DWORD src1_sel:WORD_1
v_and_b32_e64 v80, s47, v80
v_pk_mul_f16 v157, v158, v159
v_exp_f16_sdwa v33, v33 dst_sel:WORD_0 dst_unused:UNUSED_PRESERVE src0_sel:WORD_0
v_lshl_add_u64 v[228:229], v[228:229], 0, v[230:231]
v_mfma_f32_16x16x32_bf16 v[140:143], v[120:123], v[192:195], v[140:143]
ds_read_u16_d16_hi v82, v82
ds_read_u16 v80, v80
v_mfma_f32_16x16x32_f16 v[8:11], v[124:127], v[64:67], v[8:11]
ds_read_b128 v[120:123], v248 offset:22784
v_exp_f16_sdwa v35, v35 dst_sel:WORD_0 dst_unused:UNUSED_PRESERVE src0_sel:WORD_0
v_and_b32_sdwa v83, s47, v81 dst_sel:DWORD dst_unused:UNUSED_PAD src0_sel:DWORD src1_sel:WORD_1
v_and_b32_e64 v81, s47, v81
v_mfma_f32_16x16x32_bf16 v[4:7], v[184:187], v[44:47], v[4:7]
ds_read_u16_d16_hi v83, v83
ds_read_u16 v81, v81
v_mfma_f32_16x16x32_f16 v[220:223], v[124:127], v[88:91], v[220:223]
v_exp_f16_sdwa v33, v33 dst_sel:WORD_1 dst_unused:UNUSED_PRESERVE src0_sel:WORD_1
s_setprio 3
s_waitcnt lgkmcnt(6)
ds_read_b128 v[124:127], v251 offset:19456
v_mfma_f32_16x16x32_bf16 v[132:135], v[184:187], v[144:147], v[132:135]
v_lshl_add_u64 v[112:113], v[112:113], 0, v[114:115]
v_exp_f16_sdwa v35, v35 dst_sel:WORD_1 dst_unused:UNUSED_PRESERVE src0_sel:WORD_1
v_mfma_f32_16x16x32_f16 v[12:15], v[176:179], v[68:71], v[12:15]
v_pk_add_f16 v33, v33, 1.0 op_sel_hi:[1,0]
v_pk_add_f16 v35, v35, 1.0 op_sel_hi:[1,0]
v_mfma_f32_16x16x32_bf16 v[140:143], v[184:187], v[148:151], v[140:143]
ds_read_b128 v[184:187], v248 offset:24576
v_rcp_f16_sdwa v33, v33 dst_sel:WORD_0 dst_unused:UNUSED_PRESERVE src0_sel:WORD_0
v_mfma_f32_16x16x32_f16 v[96:99], v[176:179], v[64:67], v[96:99]
v_rcp_f16_sdwa v35, v35 dst_sel:WORD_0 dst_unused:UNUSED_PRESERVE src0_sel:WORD_0
v_mfma_f32_16x16x32_bf16 v[40:43], v[188:191], v[28:31], 0
v_cvt_pkrtz_f16_f32 v4, v4, v5
v_cvt_pkrtz_f16_f32 v5, v6, v7
v_mfma_f32_16x16x32_f16 v[84:87], v[176:179], v[88:91], v[84:87]
ds_read_b128 v[176:179], v251 offset:20480
v_lshrrev_b64 v[4:5], 2, v[4:5]
v_mfma_f32_16x16x32_bf16 v[0:3], v[188:191], v[128:131], 0
v_and_b32_sdwa v6, s47, v4 dst_sel:DWORD dst_unused:UNUSED_PAD src0_sel:DWORD src1_sel:WORD_1
v_and_b32_e64 v4, s47, v4
v_mfma_f32_16x16x32_f16 v[208:211], v[160:163], v[68:71], v[208:211]
ds_read_u16_d16_hi v6, v6
ds_read_u16 v4, v4
v_mfma_f32_16x16x32_bf16 v[172:175], v[188:191], v[136:139], 0
v_rcp_f16_sdwa v33, v33 dst_sel:WORD_1 dst_unused:UNUSED_PRESERVE src0_sel:WORD_1
v_mfma_f32_16x16x32_f16 v[212:215], v[160:163], v[64:67], v[212:215]
ds_read_b128 v[188:191], v248 offset:26624
v_and_b32_sdwa v7, s47, v5 dst_sel:DWORD dst_unused:UNUSED_PAD src0_sel:DWORD src1_sel:WORD_1
v_and_b32 v5, s47, v5
v_rcp_f16_sdwa v35, v35 dst_sel:WORD_1 dst_unused:UNUSED_PRESERVE src0_sel:WORD_1
v_mfma_f32_16x16x32_bf16 v[40:43], v[52:55], v[36:39], v[40:43]
ds_read_u16_d16_hi v7, v7
ds_read_u16 v5, v5
v_mfma_f32_16x16x32_f16 v[236:239], v[160:163], v[88:91], v[236:239]
s_setprio 2
v_cvt_pkrtz_f16_f32 v132, v132, v133
v_cvt_pkrtz_f16_f32 v133, v134, v135
v_lshrrev_b64 v[132:133], 2, v[132:133]
v_and_b32_sdwa v134, s47, v132 dst_sel:DWORD dst_unused:UNUSED_PAD src0_sel:DWORD src1_sel:WORD_1
v_and_b32 v132, s47, v132
v_pk_mul_f16 v158, v32, v33
v_mfma_f32_16x16x32_bf16 v[0:3], v[52:55], v[108:111], v[0:3]
ds_read_u16_d16_hi v134, v134
s_waitcnt lgkmcnt(6)
ds_read_u16 v132, v132
ds_read_b128 v[160:163], v251 offset:23552
v_mfma_f32_16x16x32_f16 v[180:183], v[48:51], v[68:71], v[180:183]
v_and_b32_sdwa v135, s47, v133 dst_sel:DWORD dst_unused:UNUSED_PAD src0_sel:DWORD src1_sel:WORD_1
v_and_b32_e64 v133, s47, v133
v_pk_mul_f16 v159, v34, v35
v_lshl_add_u64 v[230:231], v[152:153], 0, v[154:155]
v_mfma_f32_16x16x32_bf16 v[172:175], v[52:55], v[192:195], v[172:175]
ds_read_u16_d16_hi v135, v135
ds_read_u16 v133, v133
v_cvt_pkrtz_f16_f32 v140, v140, v141
v_cvt_pkrtz_f16_f32 v141, v142, v143
v_lshrrev_b64 v[140:141], 2, v[140:141]
v_and_b32_sdwa v142, s47, v140 dst_sel:DWORD dst_unused:UNUSED_PAD src0_sel:DWORD src1_sel:WORD_1
v_and_b32_e64 v140, s47, v140
v_mfma_f32_16x16x32_f16 v[196:199], v[48:51], v[64:67], v[196:199]
ds_read_u16_d16_hi v142, v142
ds_read_u16 v140, v140
ds_read_b128 v[52:55], v248 offset:28672
v_and_b32_sdwa v143, s47, v141 dst_sel:DWORD dst_unused:UNUSED_PAD src0_sel:DWORD src1_sel:WORD_1
v_and_b32_e64 v141, s47, v141
v_mfma_f32_16x16x32_bf16 v[40:43], v[120:123], v[44:47], v[40:43]
ds_read_u16_d16_hi v143, v143
ds_read_u16 v141, v141
v_mfma_f32_16x16x32_f16 v[92:95], v[48:51], v[88:91], v[92:95]
s_waitcnt lgkmcnt(10)
ds_read_b128 v[48:51], v251 offset:21504
v_lshl_add_u64 v[114:115], v[80:81], 0, v[82:83]
v_mfma_f32_16x16x32_bf16 v[0:3], v[120:123], v[144:147], v[0:3]
s_nop 0
v_cvt_pk_f16_f32 v40, v40, v41
v_mfma_f32_16x16x32_f16 v[216:219], v[124:127], v[68:71], v[216:219]
v_cvt_pk_f16_f32 v42, v42, v43
v_pk_fma_f16 v41, v40, v40, s48
v_mfma_f32_16x16x32_bf16 v[172:175], v[120:123], v[148:151], v[172:175]
ds_read_b128 v[120:123], v248 offset:24832
s_nop 0
v_cvt_pkrtz_f16_f32 v0, v0, v1
v_mfma_f32_16x16x32_f16 v[232:235], v[124:127], v[64:67], v[232:235]
v_cvt_pkrtz_f16_f32 v1, v2, v3
v_lshrrev_b64 v[0:1], 2, v[0:1]
v_mfma_f32_16x16x32_bf16 v[24:27], v[184:187], v[28:31], 0
s_setprio 1
v_and_b32_sdwa v2, s47, v0 dst_sel:DWORD dst_unused:UNUSED_PAD src0_sel:DWORD src1_sel:WORD_1
v_and_b32_e64 v0, s47, v0
v_mfma_f32_16x16x32_f16 v[224:227], v[124:127], v[88:91], v[224:227]
ds_read_b128 v[124:127], v251 offset:24576
ds_read_u16_d16_hi v2, v2
v_mfma_f32_16x16x32_bf16 v[56:59], v[184:187], v[128:131], 0
ds_read_u16 v0, v0
v_and_b32_sdwa v3, s47, v1 dst_sel:DWORD dst_unused:UNUSED_PAD src0_sel:DWORD src1_sel:WORD_1
v_mfma_f32_16x16x32_f16 v[116:119], v[176:179], v[112:115], v[116:119]
v_and_b32 v1, s47, v1
v_pk_fma_f16 v43, v42, v42, s48
v_mfma_f32_16x16x32_bf16 v[60:63], v[184:187], v[136:139], 0
s_waitcnt lgkmcnt(8)
ds_read_b128 v[184:187], v248 offset:26880
ds_read_u16_d16_hi v3, v3
v_mfma_f32_16x16x32_f16 v[240:243], v[176:179], v[228:231], v[240:243]
ds_read_u16 v1, v1
v_pk_mul_f16 v41, v40, v41
v_mfma_f32_16x16x32_bf16 v[24:27], v[188:191], v[36:39], v[24:27]
v_pk_mul_f16 v43, v42, v43
v_cvt_pkrtz_f16_f32 v172, v172, v173
v_mfma_f32_16x16x32_f16 v[76:79], v[176:179], v[156:159], v[76:79]
ds_read_b128 v[176:179], v251 offset:22528
v_cvt_pkrtz_f16_f32 v173, v174, v175
v_mfma_f32_16x16x32_bf16 v[56:59], v[188:191], v[108:111], v[56:59]
v_lshrrev_b64 v[172:173], 2, v[172:173]
v_and_b32_sdwa v174, s47, v172 dst_sel:DWORD dst_unused:UNUSED_PAD src0_sel:DWORD src1_sel:WORD_1
v_mfma_f32_16x16x32_f16 v[72:75], v[160:163], v[112:115], v[72:75]
v_and_b32_e64 v172, s47, v172
v_lshl_add_u64 v[4:5], v[4:5], 0, v[6:7]
v_exp_f16_sdwa v41, v41 dst_sel:WORD_0 dst_unused:UNUSED_PRESERVE src0_sel:WORD_0
v_mfma_f32_16x16x32_bf16 v[60:63], v[188:191], v[192:195], v[60:63]
ds_read_u16_d16_hi v174, v174
ds_read_u16 v172, v172
buffer_store_dwordx4 v[104:107], v253, s[8:11], s70 offen offset:256 sc1
buffer_store_dwordx4 v[204:207], v253, s[8:11], s70 offen offset:320 sc1
v_mfma_f32_16x16x32_f16 v[8:11], v[160:163], v[228:231], v[8:11]
ds_read_b128 v[188:191], v248 offset:28928
v_exp_f16_sdwa v43, v43 dst_sel:WORD_0 dst_unused:UNUSED_PRESERVE src0_sel:WORD_0
v_and_b32_sdwa v175, s47, v173 dst_sel:DWORD dst_unused:UNUSED_PAD src0_sel:DWORD src1_sel:WORD_1
v_and_b32_e64 v173, s47, v173
s_waitcnt lgkmcnt(8)
v_mfma_f32_16x16x32_bf16 v[24:27], v[52:55], v[44:47], v[24:27]
ds_read_u16_d16_hi v175, v175
ds_read_u16 v173, v173
s_setprio 0
v_lshl_add_u64 v[132:133], v[132:133], 0, v[134:135]
v_mfma_f32_16x16x32_f16 v[220:223], v[160:163], v[156:159], v[220:223]
v_exp_f16_sdwa v41, v41 dst_sel:WORD_1 dst_unused:UNUSED_PRESERVE src0_sel:WORD_1
v_mfma_f32_16x16x32_bf16 v[56:59], v[52:55], v[144:147], v[56:59]
ds_read_b128 v[160:163], v251 offset:25600
v_exp_f16_sdwa v43, v43 dst_sel:WORD_1 dst_unused:UNUSED_PRESERVE src0_sel:WORD_1
v_mfma_f32_16x16x32_f16 v[12:15], v[48:51], v[112:115], v[12:15]
v_lshl_add_u64 v[140:141], v[140:141], 0, v[142:143]
v_pk_add_f16 v41, v41, 1.0 op_sel_hi:[1,0]
v_mfma_f32_16x16x32_bf16 v[60:63], v[52:55], v[148:151], v[60:63]
ds_read_b128 v[52:55], v248 offset:30720
v_pk_add_f16 v43, v43, 1.0 op_sel_hi:[1,0]
v_mfma_f32_16x16x32_f16 v[96:99], v[48:51], v[228:231], v[96:99]
v_rcp_f16_sdwa v41, v41 dst_sel:WORD_0 dst_unused:UNUSED_PRESERVE src0_sel:WORD_0
v_mfma_f32_16x16x32_bf16 v[244:247], v[120:123], v[28:31], 0
v_rcp_f16_sdwa v43, v43 dst_sel:WORD_0 dst_unused:UNUSED_PRESERVE src0_sel:WORD_0
v_mfma_f32_16x16x32_f16 v[84:87], v[48:51], v[156:159], v[84:87]
ds_read_b128 v[48:51], v251 offset:26624
v_cvt_pkrtz_f16_f32 v56, v56, v57
v_mfma_f32_16x16x32_bf16 v[168:171], v[120:123], v[128:131], 0
v_cvt_pkrtz_f16_f32 v57, v58, v59
v_lshrrev_b64 v[56:57], 2, v[56:57]
v_mfma_f32_16x16x32_f16 v[208:211], v[124:127], v[112:115], v[208:211]
v_and_b32_sdwa v58, s47, v56 dst_sel:DWORD dst_unused:UNUSED_PAD src0_sel:DWORD src1_sel:WORD_1
v_and_b32_e64 v56, s47, v56
v_cvt_pk_f16_f32 v24, v24, v25
v_mfma_f32_16x16x32_bf16 v[32:35], v[120:123], v[136:139], 0
ds_read_u16_d16_hi v58, v58
ds_read_u16 v56, v56
v_rcp_f16_sdwa v41, v41 dst_sel:WORD_1 dst_unused:UNUSED_PRESERVE src0_sel:WORD_1
v_mfma_f32_16x16x32_f16 v[212:215], v[124:127], v[228:231], v[212:215]
v_cvt_pk_f16_f32 v26, v26, v27
v_pk_fma_f16 v25, v24, v24, s48
v_rcp_f16_sdwa v43, v43 dst_sel:WORD_1 dst_unused:UNUSED_PRESERVE src0_sel:WORD_1
s_waitcnt lgkmcnt(3)
v_mfma_f32_16x16x32_bf16 v[244:247], v[184:187], v[36:39], v[244:247]
ds_read_b128 v[120:123], v248 offset:32768
s_setprio 3
v_and_b32_sdwa v59, s47, v57 dst_sel:DWORD dst_unused:UNUSED_PAD src0_sel:DWORD src1_sel:WORD_1
v_and_b32_e64 v57, s47, v57
v_pk_fma_f16 v27, v26, v26, s48
v_mfma_f32_16x16x32_f16 v[236:239], v[124:127], v[156:159], v[236:239]
ds_read_u16_d16_hi v59, v59
ds_read_u16 v57, v57
ds_read_b128 v[124:127], v251 offset:29696
v_pk_mul_f16 v25, v24, v25
v_pk_mul_f16 v6, v40, v41
v_mfma_f32_16x16x32_bf16 v[168:171], v[184:187], v[108:111], v[168:171]
v_pk_mul_f16 v27, v26, v27
buffer_load_dwordx4 v[152:155], v253, s[4:7], s69 offen offset:192
v_mfma_f32_16x16x32_f16 v[180:183], v[176:179], v[112:115], v[180:183]
v_cvt_pkrtz_f16_f32 v60, v60, v61
v_cvt_pkrtz_f16_f32 v61, v62, v63
v_lshrrev_b64 v[60:61], 2, v[60:61]
v_and_b32_sdwa v62, s47, v60 dst_sel:DWORD dst_unused:UNUSED_PAD src0_sel:DWORD src1_sel:WORD_1
v_and_b32_e64 v60, s47, v60
v_pk_mul_f16 v7, v42, v43
v_exp_f16_sdwa v25, v25 dst_sel:WORD_0 dst_unused:UNUSED_PRESERVE src0_sel:WORD_0
v_lshl_add_u64 v[134:135], v[0:1], 0, v[2:3]
v_mfma_f32_16x16x32_bf16 v[32:35], v[184:187], v[192:195], v[32:35]
ds_read_u16_d16_hi v62, v62
ds_read_u16 v60, v60
v_mfma_f32_16x16x32_f16 v[196:199], v[176:179], v[228:231], v[196:199]
ds_read_b128 v[184:187], v248 offset:34816
v_exp_f16_sdwa v27, v27 dst_sel:WORD_0 dst_unused:UNUSED_PRESERVE src0_sel:WORD_0
v_and_b32_sdwa v63, s47, v61 dst_sel:DWORD dst_unused:UNUSED_PAD src0_sel:DWORD src1_sel:WORD_1
v_and_b32_e64 v61, s47, v61
v_mfma_f32_16x16x32_bf16 v[244:247], v[188:191], v[44:47], v[244:247]
ds_read_u16_d16_hi v63, v63
ds_read_u16 v61, v61
v_mfma_f32_16x16x32_f16 v[92:95], v[176:179], v[156:159], v[92:95]
v_exp_f16_sdwa v25, v25 dst_sel:WORD_1 dst_unused:UNUSED_PRESERVE src0_sel:WORD_1
v_mfma_f32_16x16x32_bf16 v[168:171], v[188:191], v[144:147], v[168:171]
ds_read_b128 v[176:179], v251 offset:27648
v_lshl_add_u64 v[142:143], v[172:173], 0, v[174:175]
v_mfma_f32_16x16x32_f16 v[216:219], v[160:163], v[112:115], v[216:219]
v_exp_f16_sdwa v27, v27 dst_sel:WORD_1 dst_unused:UNUSED_PRESERVE src0_sel:WORD_1
v_mfma_f32_16x16x32_bf16 v[32:35], v[188:191], v[148:151], v[32:35]
v_pk_add_f16 v25, v25, 1.0 op_sel_hi:[1,0]
v_pk_add_f16 v27, v27, 1.0 op_sel_hi:[1,0]
v_mfma_f32_16x16x32_f16 v[232:235], v[160:163], v[228:231], v[232:235]
ds_read_b128 v[188:191], v248 offset:30976
s_setprio 2
v_rcp_f16_sdwa v25, v25 dst_sel:WORD_0 dst_unused:UNUSED_PRESERVE src0_sel:WORD_0
v_mfma_f32_16x16x32_bf16 v[80:83], v[52:55], v[28:31], 0
v_rcp_f16_sdwa v27, v27 dst_sel:WORD_0 dst_unused:UNUSED_PRESERVE src0_sel:WORD_0
v_mfma_f32_16x16x32_f16 v[224:227], v[160:163], v[156:159], v[224:227]
ds_read_b128 v[160:163], v251 offset:30720
v_cvt_pkrtz_f16_f32 v244, v244, v245
v_mfma_f32_16x16x32_bf16 v[88:91], v[52:55], v[128:131], 0
v_cvt_pkrtz_f16_f32 v245, v246, v247
v_lshrrev_b64 v[244:245], 2, v[244:245]
s_waitcnt lgkmcnt(4)
v_mfma_f32_16x16x32_f16 v[116:119], v[48:51], v[140:143], v[116:119]
v_and_b32_sdwa v246, s47, v244 dst_sel:DWORD dst_unused:UNUSED_PAD src0_sel:DWORD src1_sel:WORD_1
v_and_b32_e64 v244, s47, v244
v_mfma_f32_16x16x32_bf16 v[64:67], v[52:55], v[136:139], 0
ds_read_u16_d16_hi v246, v246
ds_read_u16 v244, v244
v_rcp_f16_sdwa v25, v25 dst_sel:WORD_1 dst_unused:UNUSED_PRESERVE src0_sel:WORD_1
v_mfma_f32_16x16x32_f16 v[240:243], v[48:51], v[132:135], v[240:243]
ds_read_b128 v[52:55], v248 offset:33024
v_and_b32_sdwa v247, s47, v245 dst_sel:DWORD dst_unused:UNUSED_PAD src0_sel:DWORD src1_sel:WORD_1
v_and_b32_e64 v245, s47, v245
v_rcp_f16_sdwa v27, v27 dst_sel:WORD_1 dst_unused:UNUSED_PRESERVE src0_sel:WORD_1
v_mfma_f32_16x16x32_bf16 v[80:83], v[120:123], v[36:39], v[80:83]
ds_read_u16_d16_hi v247, v247
ds_read_u16 v245, v245
v_mfma_f32_16x16x32_f16 v[76:79], v[48:51], v[4:7], v[76:79]
v_cvt_pkrtz_f16_f32 v168, v168, v169
v_cvt_pkrtz_f16_f32 v169, v170, v171
v_lshrrev_b64 v[168:169], 2, v[168:169]
v_and_b32_sdwa v170, s47, v168 dst_sel:DWORD dst_unused:UNUSED_PAD src0_sel:DWORD src1_sel:WORD_1
v_and_b32_e64 v168, s47, v168
v_pk_mul_f16 v24, v24, v25
v_mfma_f32_16x16x32_bf16 v[88:91], v[120:123], v[108:111], v[88:91]
ds_read_u16_d16_hi v170, v170
ds_read_u16 v168, v168
ds_read_b128 v[48:51], v251 offset:28672
v_mfma_f32_16x16x32_f16 v[72:75], v[124:127], v[140:143], v[72:75]
v_and_b32_sdwa v171, s47, v169 dst_sel:DWORD dst_unused:UNUSED_PAD src0_sel:DWORD src1_sel:WORD_1
v_and_b32_e64 v169, s47, v169
v_pk_mul_f16 v25, v26, v27
v_lshl_add_u64 v[56:57], v[56:57], 0, v[58:59]
v_mfma_f32_16x16x32_bf16 v[64:67], v[120:123], v[192:195], v[64:67]
ds_read_u16_d16_hi v171, v171
ds_read_u16 v169, v169
v_cvt_pkrtz_f16_f32 v32, v32, v33
v_cvt_pkrtz_f16_f32 v33, v34, v35
v_lshrrev_b64 v[32:33], 2, v[32:33]
v_and_b32_sdwa v34, s47, v32 dst_sel:DWORD dst_unused:UNUSED_PAD src0_sel:DWORD src1_sel:WORD_1
v_and_b32_e64 v32, s47, v32
v_mfma_f32_16x16x32_f16 v[8:11], v[124:127], v[132:135], v[8:11]
ds_read_u16_d16_hi v34, v34
s_waitcnt lgkmcnt(8)
ds_read_u16 v32, v32
ds_read_b128 v[120:123], v248 offset:35072
s_setprio 1
buffer_store_dwordx4 v[164:167], v253, s[8:11], s69 offen sc1
buffer_store_dwordx4 v[100:103], v253, s[8:11], s69 offen offset:64 sc1
v_and_b32_sdwa v35, s47, v33 dst_sel:DWORD dst_unused:UNUSED_PAD src0_sel:DWORD src1_sel:WORD_1
v_and_b32 v33, s47, v33
v_mfma_f32_16x16x32_bf16 v[80:83], v[184:187], v[44:47], v[80:83]
ds_read_u16_d16_hi v35, v35
ds_read_u16 v33, v33
v_mfma_f32_16x16x32_f16 v[220:223], v[124:127], v[4:7], v[220:223]
ds_read_b128 v[124:127], v251 offset:31744
v_lshl_add_u64 v[60:61], v[60:61], 0, v[62:63]
v_mfma_f32_16x16x32_bf16 v[88:91], v[184:187], v[144:147], v[88:91]
s_nop 1
v_cvt_pk_f16_f32 v80, v80, v81
v_mfma_f32_16x16x32_f16 v[12:15], v[176:179], v[140:143], v[12:15]
v_cvt_pk_f16_f32 v82, v82, v83
v_pk_fma_f16 v81, v80, v80, s48
v_mfma_f32_16x16x32_bf16 v[64:67], v[184:187], v[148:151], v[64:67]
ds_read_b128 v[184:187], v249
v_cvt_pkrtz_f16_f32 v88, v88, v89
v_mfma_f32_16x16x32_f16 v[96:99], v[176:179], v[132:135], v[96:99]
v_cvt_pkrtz_f16_f32 v89, v90, v91
v_lshrrev_b64 v[88:89], 2, v[88:89]
v_mfma_f32_16x16x32_bf16 v[68:71], v[188:191], v[28:31], 0
v_and_b32_sdwa v90, s47, v88 dst_sel:DWORD dst_unused:UNUSED_PAD src0_sel:DWORD src1_sel:WORD_1
v_and_b32 v88, s47, v88
v_mfma_f32_16x16x32_f16 v[84:87], v[176:179], v[4:7], v[84:87]
ds_read_b128 v[176:179], v251 offset:32768
s_waitcnt lgkmcnt(8)
ds_read_u16_d16_hi v90, v90
v_mfma_f32_16x16x32_bf16 v[104:107], v[188:191], v[128:131], 0
ds_read_u16 v88, v88
v_and_b32_sdwa v91, s47, v89 dst_sel:DWORD dst_unused:UNUSED_PAD src0_sel:DWORD src1_sel:WORD_1
v_mfma_f32_16x16x32_f16 v[208:211], v[160:163], v[140:143], v[208:211]
v_and_b32 v89, s47, v89
v_pk_fma_f16 v83, v82, v82, s48
v_mfma_f32_16x16x32_bf16 v[204:207], v[188:191], v[136:139], 0
ds_read_b128 v[188:191], v249 offset:2048
ds_read_u16_d16_hi v91, v91
v_mfma_f32_16x16x32_f16 v[212:215], v[160:163], v[132:135], v[212:215]
s_setprio 0
ds_read_u16 v89, v89
v_pk_mul_f16 v81, v80, v81
v_mfma_f32_16x16x32_bf16 v[68:71], v[52:55], v[36:39], v[68:71]
v_pk_mul_f16 v83, v82, v83
v_cvt_pkrtz_f16_f32 v64, v64, v65
v_mfma_f32_16x16x32_f16 v[236:239], v[160:163], v[4:7], v[236:239]
ds_read_b128 v[160:163], v251 offset:35840
v_cvt_pkrtz_f16_f32 v65, v66, v67
v_mfma_f32_16x16x32_bf16 v[104:107], v[52:55], v[108:111], v[104:107]
buffer_load_dwordx4 v[40:43], v253, s[4:7], s69 offen offset:256
buffer_load_dwordx4 v[0:3], v253, s[4:7], s69 offen offset:320
v_lshrrev_b64 v[64:65], 2, v[64:65]
v_mfma_f32_16x16x32_f16 v[180:183], v[48:51], v[140:143], v[180:183]
v_and_b32_sdwa v66, s47, v64 dst_sel:DWORD dst_unused:UNUSED_PAD src0_sel:DWORD src1_sel:WORD_1
v_and_b32 v64, s47, v64
v_lshl_add_u64 v[26:27], v[244:245], 0, v[246:247]
v_exp_f16_sdwa v81, v81 dst_sel:WORD_0 dst_unused:UNUSED_PRESERVE src0_sel:WORD_0
v_mfma_f32_16x16x32_bf16 v[204:207], v[52:55], v[192:195], v[204:207]
ds_read_u16_d16_hi v66, v66
s_waitcnt lgkmcnt(7)
ds_read_u16 v64, v64
v_mfma_f32_16x16x32_f16 v[196:199], v[48:51], v[132:135], v[196:199]
ds_read_b128 v[52:55], v249 offset:4096
v_exp_f16_sdwa v83, v83 dst_sel:WORD_0 dst_unused:UNUSED_PRESERVE src0_sel:WORD_0
v_and_b32_sdwa v67, s47, v65 dst_sel:DWORD dst_unused:UNUSED_PAD src0_sel:DWORD src1_sel:WORD_1
v_and_b32_e64 v65, s47, v65
v_mfma_f32_16x16x32_bf16 v[68:71], v[120:123], v[44:47], v[68:71]
ds_read_u16_d16_hi v67, v67
ds_read_u16 v65, v65
v_lshl_add_u64 v[58:59], v[168:169], 0, v[170:171]
v_mfma_f32_16x16x32_f16 v[92:95], v[48:51], v[4:7], v[92:95]
v_exp_f16_sdwa v81, v81 dst_sel:WORD_1 dst_unused:UNUSED_PRESERVE src0_sel:WORD_1
v_mfma_f32_16x16x32_bf16 v[104:107], v[120:123], v[144:147], v[104:107]
ds_read_b128 v[48:51], v251 offset:33792
v_exp_f16_sdwa v83, v83 dst_sel:WORD_1 dst_unused:UNUSED_PRESERVE src0_sel:WORD_1
v_mfma_f32_16x16x32_f16 v[216:219], v[124:127], v[140:143], v[216:219]
v_lshl_add_u64 v[62:63], v[32:33], 0, v[34:35]
v_pk_add_f16 v81, v81, 1.0 op_sel_hi:[1,0]
v_mfma_f32_16x16x32_bf16 v[204:207], v[120:123], v[148:151], v[204:207]
ds_read_b128 v[120:123], v249 offset:256
v_pk_add_f16 v83, v83, 1.0 op_sel_hi:[1,0]
v_mfma_f32_16x16x32_f16 v[232:235], v[124:127], v[132:135], v[232:235]
s_setprio 3
v_rcp_f16_sdwa v81, v81 dst_sel:WORD_0 dst_unused:UNUSED_PRESERVE src0_sel:WORD_0
v_mfma_f32_16x16x32_bf16 v[172:175], v[184:187], v[28:31], 0
v_rcp_f16_sdwa v83, v83 dst_sel:WORD_0 dst_unused:UNUSED_PRESERVE src0_sel:WORD_0
v_mfma_f32_16x16x32_f16 v[224:227], v[124:127], v[4:7], v[224:227]
ds_read_b128 v[124:127], v251 offset:36864
v_cvt_pkrtz_f16_f32 v104, v104, v105
v_mfma_f32_16x16x32_bf16 v[156:159], v[184:187], v[128:131], 0
v_cvt_pkrtz_f16_f32 v105, v106, v107
v_lshrrev_b64 v[104:105], 2, v[104:105]
v_mfma_f32_16x16x32_f16 v[116:119], v[176:179], v[60:63], v[116:119]
v_and_b32_sdwa v106, s47, v104 dst_sel:DWORD dst_unused:UNUSED_PAD src0_sel:DWORD src1_sel:WORD_1
v_and_b32_e64 v104, s47, v104
v_cvt_pk_f16_f32 v68, v68, v69
v_mfma_f32_16x16x32_bf16 v[228:231], v[184:187], v[136:139], 0
ds_read_u16_d16_hi v106, v106
s_waitcnt lgkmcnt(5)
ds_read_u16 v104, v104
v_rcp_f16_sdwa v81, v81 dst_sel:WORD_1 dst_unused:UNUSED_PRESERVE src0_sel:WORD_1
v_mfma_f32_16x16x32_f16 v[240:243], v[176:179], v[56:59], v[240:243]
v_cvt_pk_f16_f32 v70, v70, v71
v_pk_fma_f16 v69, v68, v68, s48
v_rcp_f16_sdwa v83, v83 dst_sel:WORD_1 dst_unused:UNUSED_PRESERVE src0_sel:WORD_1
v_mfma_f32_16x16x32_bf16 v[172:175], v[188:191], v[36:39], v[172:175]
ds_read_b128 v[184:187], v249 offset:2304
v_and_b32_sdwa v107, s47, v105 dst_sel:DWORD dst_unused:UNUSED_PAD src0_sel:DWORD src1_sel:WORD_1
v_and_b32_e64 v105, s47, v105
v_pk_fma_f16 v71, v70, v70, s48
v_mfma_f32_16x16x32_f16 v[76:79], v[176:179], v[24:27], v[76:79]
ds_read_u16_d16_hi v107, v107
ds_read_u16 v105, v105
ds_read_b128 v[176:179], v251 offset:34816
v_pk_mul_f16 v69, v68, v69
v_pk_mul_f16 v80, v80, v81
v_mfma_f32_16x16x32_bf16 v[156:159], v[188:191], v[108:111], v[156:159]
v_pk_mul_f16 v71, v70, v71
v_cvt_pkrtz_f16_f32 v204, v204, v205
v_mfma_f32_16x16x32_f16 v[72:75], v[160:163], v[60:63], v[72:75]
v_cvt_pkrtz_f16_f32 v205, v206, v207
v_lshrrev_b64 v[204:205], 2, v[204:205]
v_and_b32_sdwa v206, s47, v204 dst_sel:DWORD dst_unused:UNUSED_PAD src0_sel:DWORD src1_sel:WORD_1
v_and_b32_e64 v204, s47, v204
v_pk_mul_f16 v81, v82, v83
v_exp_f16_sdwa v69, v69 dst_sel:WORD_0 dst_unused:UNUSED_PRESERVE src0_sel:WORD_0
v_lshl_add_u64 v[88:89], v[88:89], 0, v[90:91]
v_mfma_f32_16x16x32_bf16 v[228:231], v[188:191], v[192:195], v[228:231]
ds_read_u16_d16_hi v206, v206
ds_read_u16 v204, v204
v_mfma_f32_16x16x32_f16 v[8:11], v[160:163], v[56:59], v[8:11]
s_setprio 2
ds_read_b128 v[188:191], v249 offset:4352
v_exp_f16_sdwa v71, v71 dst_sel:WORD_0 dst_unused:UNUSED_PRESERVE src0_sel:WORD_0
v_and_b32_sdwa v207, s47, v205 dst_sel:DWORD dst_unused:UNUSED_PAD src0_sel:DWORD src1_sel:WORD_1
v_and_b32_e64 v205, s47, v205
v_mfma_f32_16x16x32_bf16 v[172:175], v[52:55], v[44:47], v[172:175]
ds_read_u16_d16_hi v207, v207
ds_read_u16 v205, v205
v_mfma_f32_16x16x32_f16 v[220:223], v[160:163], v[24:27], v[220:223]
v_exp_f16_sdwa v69, v69 dst_sel:WORD_1 dst_unused:UNUSED_PRESERVE src0_sel:WORD_1
v_mfma_f32_16x16x32_bf16 v[156:159], v[52:55], v[144:147], v[156:159]
s_waitcnt lgkmcnt(6)
ds_read_b128 v[160:163], v251 offset:37888
buffer_store_dwordx4 v[200:203], v253, s[8:11], s69 offen offset:128 sc1
v_lshl_add_u64 v[64:65], v[64:65], 0, v[66:67]
v_mfma_f32_16x16x32_f16 v[12:15], v[48:51], v[60:63], v[12:15]
v_exp_f16_sdwa v71, v71 dst_sel:WORD_1 dst_unused:UNUSED_PRESERVE src0_sel:WORD_1
v_mfma_f32_16x16x32_bf16 v[228:231], v[52:55], v[148:151], v[228:231]
v_pk_add_f16 v69, v69, 1.0 op_sel_hi:[1,0]
v_pk_add_f16 v71, v71, 1.0 op_sel_hi:[1,0]
v_mfma_f32_16x16x32_f16 v[96:99], v[48:51], v[56:59], v[96:99]
ds_read_b128 v[52:55], v249 offset:6144
v_rcp_f16_sdwa v69, v69 dst_sel:WORD_0 dst_unused:UNUSED_PRESERVE src0_sel:WORD_0
v_mfma_f32_16x16x32_bf16 v[112:115], v[120:123], v[28:31], 0
v_rcp_f16_sdwa v71, v71 dst_sel:WORD_0 dst_unused:UNUSED_PRESERVE src0_sel:WORD_0
v_mfma_f32_16x16x32_f16 v[84:87], v[48:51], v[24:27], v[84:87]
ds_read_b128 v[48:51], v251 offset:38912
v_cvt_pkrtz_f16_f32 v172, v172, v173
v_mfma_f32_16x16x32_bf16 v[164:167], v[120:123], v[128:131], 0
v_cvt_pkrtz_f16_f32 v173, v174, v175
v_lshrrev_b64 v[172:173], 2, v[172:173]
v_mfma_f32_16x16x32_f16 v[208:211], v[124:127], v[60:63], v[208:211]
v_and_b32_sdwa v174, s47, v172 dst_sel:DWORD dst_unused:UNUSED_PAD src0_sel:DWORD src1_sel:WORD_1
v_and_b32_e64 v172, s47, v172
v_mfma_f32_16x16x32_bf16 v[100:103], v[120:123], v[136:139], 0
ds_read_u16_d16_hi v174, v174
ds_read_u16 v172, v172
v_rcp_f16_sdwa v69, v69 dst_sel:WORD_1 dst_unused:UNUSED_PRESERVE src0_sel:WORD_1
s_setprio 1
v_mfma_f32_16x16x32_f16 v[212:215], v[124:127], v[56:59], v[212:215]
ds_read_b128 v[120:123], v249 offset:8192
v_and_b32_sdwa v175, s47, v173 dst_sel:DWORD dst_unused:UNUSED_PAD src0_sel:DWORD src1_sel:WORD_1
v_and_b32 v173, s47, v173
v_rcp_f16_sdwa v71, v71 dst_sel:WORD_1 dst_unused:UNUSED_PRESERVE src0_sel:WORD_1
v_mfma_f32_16x16x32_bf16 v[112:115], v[184:187], v[36:39], v[112:115]
ds_read_u16_d16_hi v175, v175
ds_read_u16 v173, v173
v_mfma_f32_16x16x32_f16 v[236:239], v[124:127], v[24:27], v[236:239]
v_cvt_pkrtz_f16_f32 v156, v156, v157
v_cvt_pkrtz_f16_f32 v157, v158, v159
v_lshrrev_b64 v[156:157], 2, v[156:157]
v_and_b32_sdwa v158, s47, v156 dst_sel:DWORD dst_unused:UNUSED_PAD src0_sel:DWORD src1_sel:WORD_1
v_and_b32 v156, s47, v156
v_pk_mul_f16 v82, v68, v69
v_mfma_f32_16x16x32_bf16 v[164:167], v[184:187], v[108:111], v[164:167]
ds_read_u16_d16_hi v158, v158
s_waitcnt lgkmcnt(6)
ds_read_u16 v156, v156
ds_read_b128 v[124:127], v251 offset:41984
buffer_load_dwordx4 v[244:247], v253, s[4:7], s68 offen
buffer_load_dwordx4 v[168:171], v253, s[4:7], s68 offen offset:64
v_mfma_f32_16x16x32_f16 v[180:183], v[176:179], v[60:63], v[180:183]
v_and_b32_sdwa v159, s47, v157 dst_sel:DWORD dst_unused:UNUSED_PAD src0_sel:DWORD src1_sel:WORD_1
v_and_b32_e64 v157, s47, v157
v_pk_mul_f16 v83, v70, v71
v_lshl_add_u64 v[90:91], v[104:105], 0, v[106:107]
v_mfma_f32_16x16x32_bf16 v[100:103], v[184:187], v[192:195], v[100:103]
ds_read_u16_d16_hi v159, v159
ds_read_u16 v157, v157
v_cvt_pkrtz_f16_f32 v228, v228, v229
v_cvt_pkrtz_f16_f32 v229, v230, v231
v_lshrrev_b64 v[228:229], 2, v[228:229]
v_and_b32_sdwa v230, s47, v228 dst_sel:DWORD dst_unused:UNUSED_PAD src0_sel:DWORD src1_sel:WORD_1
v_and_b32_e64 v228, s47, v228
v_mfma_f32_16x16x32_f16 v[196:199], v[176:179], v[56:59], v[196:199]
ds_read_u16_d16_hi v230, v230
ds_read_u16 v228, v228
ds_read_b128 v[184:187], v249 offset:10240
v_and_b32_sdwa v231, s47, v229 dst_sel:DWORD dst_unused:UNUSED_PAD src0_sel:DWORD src1_sel:WORD_1
v_and_b32 v229, s47, v229
v_mfma_f32_16x16x32_bf16 v[112:115], v[188:191], v[44:47], v[112:115]
ds_read_u16_d16_hi v231, v231
ds_read_u16 v229, v229
v_mfma_f32_16x16x32_f16 v[92:95], v[176:179], v[24:27], v[92:95]
s_waitcnt lgkmcnt(10)
ds_read_b128 v[176:179], v251 offset:39936
v_lshl_add_u64 v[66:67], v[204:205], 0, v[206:207]
v_mfma_f32_16x16x32_bf16 v[164:167], v[188:191], v[144:147], v[164:167]
s_nop 0
v_cvt_pk_f16_f32 v112, v112, v113
v_mfma_f32_16x16x32_f16 v[216:219], v[160:163], v[60:63], v[216:219]
v_cvt_pk_f16_f32 v114, v114, v115
v_pk_fma_f16 v113, v112, v112, s48
v_mfma_f32_16x16x32_bf16 v[100:103], v[188:191], v[148:151], v[100:103]
s_setprio 0
ds_read_b128 v[188:191], v249 offset:6400
v_cvt_pkrtz_f16_f32 v164, v164, v165
v_mfma_f32_16x16x32_f16 v[232:235], v[160:163], v[56:59], v[232:235]
v_cvt_pkrtz_f16_f32 v165, v166, v167
v_lshrrev_b64 v[164:165], 2, v[164:165]
v_mfma_f32_16x16x32_bf16 v[32:35], v[52:55], v[28:31], 0
v_and_b32_sdwa v166, s47, v164 dst_sel:DWORD dst_unused:UNUSED_PAD src0_sel:DWORD src1_sel:WORD_1
v_and_b32_e64 v164, s47, v164
v_mfma_f32_16x16x32_f16 v[224:227], v[160:163], v[24:27], v[224:227]
ds_read_b128 v[160:163], v251 offset:43008
ds_read_u16_d16_hi v166, v166
v_mfma_f32_16x16x32_bf16 v[4:7], v[52:55], v[128:131], 0
ds_read_u16 v164, v164
v_and_b32_sdwa v167, s47, v165 dst_sel:DWORD dst_unused:UNUSED_PAD src0_sel:DWORD src1_sel:WORD_1
v_mfma_f32_16x16x32_f16 v[116:119], v[48:51], v[64:67], v[116:119]
v_and_b32 v165, s47, v165
v_pk_fma_f16 v115, v114, v114, s48
v_mfma_f32_16x16x32_bf16 v[132:135], v[52:55], v[136:139], 0
s_waitcnt lgkmcnt(8)
ds_read_b128 v[52:55], v249 offset:8448
ds_read_u16_d16_hi v167, v167
v_mfma_f32_16x16x32_f16 v[240:243], v[48:51], v[88:91], v[240:243]
ds_read_u16 v165, v165
v_pk_mul_f16 v113, v112, v113
v_mfma_f32_16x16x32_bf16 v[32:35], v[120:123], v[36:39], v[32:35]
v_pk_mul_f16 v115, v114, v115
v_cvt_pkrtz_f16_f32 v100, v100, v101
v_mfma_f32_16x16x32_f16 v[76:79], v[48:51], v[80:83], v[76:79]
ds_read_b128 v[48:51], v251 offset:40960
v_cvt_pkrtz_f16_f32 v101, v102, v103
v_mfma_f32_16x16x32_bf16 v[4:7], v[120:123], v[108:111], v[4:7]
v_lshrrev_b64 v[100:101], 2, v[100:101]
v_and_b32_sdwa v102, s47, v100 dst_sel:DWORD dst_unused:UNUSED_PAD src0_sel:DWORD src1_sel:WORD_1
v_mfma_f32_16x16x32_f16 v[72:75], v[124:127], v[64:67], v[72:75]
v_and_b32 v100, s47, v100
v_lshl_add_u64 v[172:173], v[172:173], 0, v[174:175]
v_exp_f16_sdwa v113, v113 dst_sel:WORD_0 dst_unused:UNUSED_PRESERVE src0_sel:WORD_0
v_mfma_f32_16x16x32_bf16 v[132:135], v[120:123], v[192:195], v[132:135]
ds_read_u16_d16_hi v102, v102
ds_read_u16 v100, v100
s_setprio 3
v_mfma_f32_16x16x32_f16 v[8:11], v[124:127], v[88:91], v[8:11]
ds_read_b128 v[120:123], v249 offset:10496
v_exp_f16_sdwa v115, v115 dst_sel:WORD_0 dst_unused:UNUSED_PRESERVE src0_sel:WORD_0
v_and_b32_sdwa v103, s47, v101 dst_sel:DWORD dst_unused:UNUSED_PAD src0_sel:DWORD src1_sel:WORD_1
v_and_b32 v101, s47, v101
s_waitcnt lgkmcnt(8)
v_mfma_f32_16x16x32_bf16 v[32:35], v[184:187], v[44:47], v[32:35]
ds_read_u16_d16_hi v103, v103
ds_read_u16 v101, v101
v_lshl_add_u64 v[156:157], v[156:157], 0, v[158:159]
v_mfma_f32_16x16x32_f16 v[220:223], v[124:127], v[80:83], v[220:223]
v_exp_f16_sdwa v113, v113 dst_sel:WORD_1 dst_unused:UNUSED_PRESERVE src0_sel:WORD_1
v_mfma_f32_16x16x32_bf16 v[4:7], v[184:187], v[144:147], v[4:7]
ds_read_b128 v[124:127], v251 offset:44032
v_exp_f16_sdwa v115, v115 dst_sel:WORD_1 dst_unused:UNUSED_PRESERVE src0_sel:WORD_1
v_mfma_f32_16x16x32_f16 v[12:15], v[176:179], v[64:67], v[12:15]
v_lshl_add_u64 v[228:229], v[228:229], 0, v[230:231]
v_pk_add_f16 v113, v113, 1.0 op_sel_hi:[1,0]
v_mfma_f32_16x16x32_bf16 v[132:135], v[184:187], v[148:151], v[132:135]
ds_read_b128 v[184:187], v249 offset:12288
v_pk_add_f16 v115, v115, 1.0 op_sel_hi:[1,0]
v_mfma_f32_16x16x32_f16 v[96:99], v[176:179], v[88:91], v[96:99]
v_rcp_f16_sdwa v113, v113 dst_sel:WORD_0 dst_unused:UNUSED_PRESERVE src0_sel:WORD_0
v_mfma_f32_16x16x32_bf16 v[140:143], v[188:191], v[28:31], 0
v_rcp_f16_sdwa v115, v115 dst_sel:WORD_0 dst_unused:UNUSED_PRESERVE src0_sel:WORD_0
v_mfma_f32_16x16x32_f16 v[84:87], v[176:179], v[80:83], v[84:87]
ds_read_b128 v[176:179], v251 offset:45056
v_cvt_pkrtz_f16_f32 v4, v4, v5
v_mfma_f32_16x16x32_bf16 v[200:203], v[188:191], v[128:131], 0
v_cvt_pkrtz_f16_f32 v5, v6, v7
v_lshrrev_b64 v[4:5], 2, v[4:5]
v_mfma_f32_16x16x32_f16 v[208:211], v[160:163], v[64:67], v[208:211]
v_and_b32_sdwa v6, s47, v4 dst_sel:DWORD dst_unused:UNUSED_PAD src0_sel:DWORD src1_sel:WORD_1
v_and_b32 v4, s47, v4
v_cvt_pk_f16_f32 v32, v32, v33
s_setprio 2
ds_read_u16_d16_hi v6, v6
ds_read_u16 v4, v4
v_mfma_f32_16x16x32_bf16 v[68:71], v[188:191], v[136:139], 0
v_rcp_f16_sdwa v113, v113 dst_sel:WORD_1 dst_unused:UNUSED_PRESERVE src0_sel:WORD_1
v_mfma_f32_16x16x32_f16 v[212:215], v[160:163], v[88:91], v[212:215]
v_cvt_pk_f16_f32 v34, v34, v35
v_pk_fma_f16 v33, v32, v32, s48
v_rcp_f16_sdwa v115, v115 dst_sel:WORD_1 dst_unused:UNUSED_PRESERVE src0_sel:WORD_1
s_waitcnt lgkmcnt(4)
v_mfma_f32_16x16x32_bf16 v[140:143], v[52:55], v[36:39], v[140:143]
ds_read_b128 v[188:191], v249 offset:14336
v_and_b32_sdwa v7, s47, v5 dst_sel:DWORD dst_unused:UNUSED_PAD src0_sel:DWORD src1_sel:WORD_1
v_and_b32 v5, s47, v5
v_pk_fma_f16 v35, v34, v34, s48
v_mfma_f32_16x16x32_f16 v[236:239], v[160:163], v[80:83], v[236:239]
ds_read_u16_d16_hi v7, v7
ds_read_u16 v5, v5
ds_read_b128 v[160:163], v251 offset:48128
v_pk_mul_f16 v33, v32, v33
v_pk_mul_f16 v174, v112, v113
v_mfma_f32_16x16x32_bf16 v[200:203], v[52:55], v[108:111], v[200:203]
v_pk_mul_f16 v35, v34, v35
buffer_load_dwordx4 v[104:107], v253, s[4:7], s68 offen offset:128
buffer_load_dwordx4 v[204:207], v253, s[4:7], s68 offen offset:192
v_mfma_f32_16x16x32_f16 v[180:183], v[48:51], v[64:67], v[180:183]
v_cvt_pkrtz_f16_f32 v132, v132, v133
v_cvt_pkrtz_f16_f32 v133, v134, v135
v_lshrrev_b64 v[132:133], 2, v[132:133]
v_and_b32_sdwa v134, s47, v132 dst_sel:DWORD dst_unused:UNUSED_PAD src0_sel:DWORD src1_sel:WORD_1
v_and_b32_e64 v132, s47, v132
v_pk_mul_f16 v175, v114, v115
v_exp_f16_sdwa v33, v33 dst_sel:WORD_0 dst_unused:UNUSED_PRESERVE src0_sel:WORD_0
v_lshl_add_u64 v[158:159], v[164:165], 0, v[166:167]
v_mfma_f32_16x16x32_bf16 v[68:71], v[52:55], v[192:195], v[68:71]
ds_read_u16_d16_hi v134, v134
ds_read_u16 v132, v132
v_mfma_f32_16x16x32_f16 v[196:199], v[48:51], v[88:91], v[196:199]
ds_read_b128 v[52:55], v249 offset:16384
v_exp_f16_sdwa v35, v35 dst_sel:WORD_0 dst_unused:UNUSED_PRESERVE src0_sel:WORD_0
v_and_b32_sdwa v135, s47, v133 dst_sel:DWORD dst_unused:UNUSED_PAD src0_sel:DWORD src1_sel:WORD_1
v_and_b32_e64 v133, s47, v133
v_mfma_f32_16x16x32_bf16 v[140:143], v[120:123], v[44:47], v[140:143]
ds_read_u16_d16_hi v135, v135
ds_read_u16 v133, v133
v_mfma_f32_16x16x32_f16 v[92:95], v[48:51], v[80:83], v[92:95]
v_exp_f16_sdwa v33, v33 dst_sel:WORD_1 dst_unused:UNUSED_PRESERVE src0_sel:WORD_1
v_mfma_f32_16x16x32_bf16 v[200:203], v[120:123], v[144:147], v[200:203]
ds_read_b128 v[48:51], v251 offset:46080
v_lshl_add_u64 v[230:231], v[100:101], 0, v[102:103]
v_mfma_f32_16x16x32_f16 v[216:219], v[124:127], v[64:67], v[216:219]
v_exp_f16_sdwa v35, v35 dst_sel:WORD_1 dst_unused:UNUSED_PRESERVE src0_sel:WORD_1
s_setprio 1
v_mfma_f32_16x16x32_bf16 v[68:71], v[120:123], v[148:151], v[68:71]
v_pk_add_f16 v33, v33, 1.0 op_sel_hi:[1,0]
v_pk_add_f16 v35, v35, 1.0 op_sel_hi:[1,0]
v_mfma_f32_16x16x32_f16 v[232:235], v[124:127], v[88:91], v[232:235]
ds_read_b128 v[120:123], v249 offset:12544
v_rcp_f16_sdwa v33, v33 dst_sel:WORD_0 dst_unused:UNUSED_PRESERVE src0_sel:WORD_0
s_waitcnt lgkmcnt(6)
v_mfma_f32_16x16x32_bf16 v[24:27], v[184:187], v[28:31], 0
v_rcp_f16_sdwa v35, v35 dst_sel:WORD_0 dst_unused:UNUSED_PRESERVE src0_sel:WORD_0
v_mfma_f32_16x16x32_f16 v[224:227], v[124:127], v[80:83], v[224:227]
ds_read_b128 v[124:127], v251 offset:49152
v_cvt_pkrtz_f16_f32 v140, v140, v141
v_mfma_f32_16x16x32_bf16 v[56:59], v[184:187], v[128:131], 0
v_cvt_pkrtz_f16_f32 v141, v142, v143
v_lshrrev_b64 v[140:141], 2, v[140:141]
v_mfma_f32_16x16x32_f16 v[116:119], v[176:179], v[228:231], v[116:119]
v_and_b32_sdwa v142, s47, v140 dst_sel:DWORD dst_unused:UNUSED_PAD src0_sel:DWORD src1_sel:WORD_1
v_and_b32_e64 v140, s47, v140
v_mfma_f32_16x16x32_bf16 v[60:63], v[184:187], v[136:139], 0
ds_read_u16_d16_hi v142, v142
ds_read_u16 v140, v140
v_rcp_f16_sdwa v33, v33 dst_sel:WORD_1 dst_unused:UNUSED_PRESERVE src0_sel:WORD_1
v_mfma_f32_16x16x32_f16 v[240:243], v[176:179], v[156:159], v[240:243]
ds_read_b128 v[184:187], v249 offset:14592
v_and_b32_sdwa v143, s47, v141 dst_sel:DWORD dst_unused:UNUSED_PAD src0_sel:DWORD src1_sel:WORD_1
v_and_b32_e64 v141, s47, v141
v_rcp_f16_sdwa v35, v35 dst_sel:WORD_1 dst_unused:UNUSED_PRESERVE src0_sel:WORD_1
v_mfma_f32_16x16x32_bf16 v[24:27], v[188:191], v[36:39], v[24:27]
ds_read_u16_d16_hi v143, v143
ds_read_u16 v141, v141
v_mfma_f32_16x16x32_f16 v[76:79], v[176:179], v[172:175], v[76:79]
v_cvt_pkrtz_f16_f32 v200, v200, v201
v_cvt_pkrtz_f16_f32 v201, v202, v203
v_lshrrev_b64 v[200:201], 2, v[200:201]
v_and_b32_sdwa v202, s47, v200 dst_sel:DWORD dst_unused:UNUSED_PAD src0_sel:DWORD src1_sel:WORD_1
v_and_b32_e64 v200, s47, v200
v_pk_mul_f16 v32, v32, v33
v_mfma_f32_16x16x32_bf16 v[56:59], v[188:191], v[108:111], v[56:59]
ds_read_u16_d16_hi v202, v202
ds_read_u16 v200, v200
ds_read_b128 v[176:179], v251 offset:47104
v_mfma_f32_16x16x32_f16 v[72:75], v[160:163], v[228:231], v[72:75]
v_and_b32_sdwa v203, s47, v201 dst_sel:DWORD dst_unused:UNUSED_PAD src0_sel:DWORD src1_sel:WORD_1
v_and_b32_e64 v201, s47, v201
v_pk_mul_f16 v33, v34, v35
v_lshl_add_u64 v[4:5], v[4:5], 0, v[6:7]
v_mfma_f32_16x16x32_bf16 v[60:63], v[188:191], v[192:195], v[60:63]
s_waitcnt lgkmcnt(7)
ds_read_u16_d16_hi v203, v203
ds_read_u16 v201, v201
s_setprio 0
v_cvt_pkrtz_f16_f32 v68, v68, v69
v_cvt_pkrtz_f16_f32 v69, v70, v71
v_lshrrev_b64 v[68:69], 2, v[68:69]
v_and_b32_sdwa v70, s47, v68 dst_sel:DWORD dst_unused:UNUSED_PAD src0_sel:DWORD src1_sel:WORD_1
v_and_b32_e64 v68, s47, v68
v_mfma_f32_16x16x32_f16 v[8:11], v[160:163], v[156:159], v[8:11]
ds_read_u16_d16_hi v70, v70
ds_read_u16 v68, v68
ds_read_b128 v[188:191], v249 offset:16640
v_and_b32_sdwa v71, s47, v69 dst_sel:DWORD dst_unused:UNUSED_PAD src0_sel:DWORD src1_sel:WORD_1
v_and_b32_e64 v69, s47, v69
v_mfma_f32_16x16x32_bf16 v[24:27], v[52:55], v[44:47], v[24:27]
ds_read_u16_d16_hi v71, v71
ds_read_u16 v69, v69
v_mfma_f32_16x16x32_f16 v[220:223], v[160:163], v[172:175], v[220:223]
ds_read_b128 v[160:163], v251 offset:50176
v_lshl_add_u64 v[132:133], v[132:133], 0, v[134:135]
v_mfma_f32_16x16x32_bf16 v[56:59], v[52:55], v[144:147], v[56:59]
s_nop 1
v_cvt_pk_f16_f32 v24, v24, v25
v_mfma_f32_16x16x32_f16 v[12:15], v[48:51], v[228:231], v[12:15]
v_cvt_pk_f16_f32 v26, v26, v27
v_pk_fma_f16 v25, v24, v24, s48
v_mfma_f32_16x16x32_bf16 v[60:63], v[52:55], v[148:151], v[60:63]
s_waitcnt lgkmcnt(9)
ds_read_b128 v[52:55], v249 offset:18432
v_cvt_pkrtz_f16_f32 v56, v56, v57
v_mfma_f32_16x16x32_f16 v[96:99], v[48:51], v[156:159], v[96:99]
v_cvt_pkrtz_f16_f32 v57, v58, v59
v_lshrrev_b64 v[56:57], 2, v[56:57]
v_mfma_f32_16x16x32_bf16 v[112:115], v[120:123], v[28:31], 0
v_and_b32_sdwa v58, s47, v56 dst_sel:DWORD dst_unused:UNUSED_PAD src0_sel:DWORD src1_sel:WORD_1
v_and_b32_e64 v56, s47, v56
v_mfma_f32_16x16x32_f16 v[84:87], v[48:51], v[172:175], v[84:87]
ds_read_b128 v[48:51], v251 offset:51200
ds_read_u16_d16_hi v58, v58
v_mfma_f32_16x16x32_bf16 v[164:167], v[120:123], v[128:131], 0
ds_read_u16 v56, v56
v_and_b32_sdwa v59, s47, v57 dst_sel:DWORD dst_unused:UNUSED_PAD src0_sel:DWORD src1_sel:WORD_1
v_mfma_f32_16x16x32_f16 v[208:211], v[124:127], v[228:231], v[208:211]
s_setprio 3
v_and_b32_e64 v57, s47, v57
v_pk_fma_f16 v27, v26, v26, s48
v_mfma_f32_16x16x32_bf16 v[100:103], v[120:123], v[136:139], 0
ds_read_b128 v[120:123], v249 offset:20480
ds_read_u16_d16_hi v59, v59
v_mfma_f32_16x16x32_f16 v[212:215], v[124:127], v[156:159], v[212:215]
s_waitcnt lgkmcnt(10)
ds_read_u16 v57, v57
v_pk_mul_f16 v25, v24, v25
v_mfma_f32_16x16x32_bf16 v[112:115], v[184:187], v[36:39], v[112:115]
v_pk_mul_f16 v27, v26, v27
v_cvt_pkrtz_f16_f32 v60, v60, v61
v_mfma_f32_16x16x32_f16 v[236:239], v[124:127], v[172:175], v[236:239]
ds_read_b128 v[124:127], v251 offset:54272
v_cvt_pkrtz_f16_f32 v61, v62, v63
v_mfma_f32_16x16x32_bf16 v[164:167], v[184:187], v[108:111], v[164:167]
buffer_load_dwordx4 v[80:83], v253, s[4:7], s68 offen offset:256
buffer_load_dwordx4 v[88:91], v253, s[4:7], s68 offen offset:320
v_lshrrev_b64 v[60:61], 2, v[60:61]
v_mfma_f32_16x16x32_f16 v[180:183], v[176:179], v[228:231], v[180:183]
v_and_b32_sdwa v62, s47, v60 dst_sel:DWORD dst_unused:UNUSED_PAD src0_sel:DWORD src1_sel:WORD_1
v_and_b32_e64 v60, s47, v60
v_lshl_add_u64 v[34:35], v[140:141], 0, v[142:143]
v_exp_f16_sdwa v25, v25 dst_sel:WORD_0 dst_unused:UNUSED_PRESERVE src0_sel:WORD_0
v_mfma_f32_16x16x32_bf16 v[100:103], v[184:187], v[192:195], v[100:103]
ds_read_u16_d16_hi v62, v62
ds_read_u16 v60, v60
v_mfma_f32_16x16x32_f16 v[196:199], v[176:179], v[156:159], v[196:199]
ds_read_b128 v[184:187], v249 offset:22528
v_exp_f16_sdwa v27, v27 dst_sel:WORD_0 dst_unused:UNUSED_PRESERVE src0_sel:WORD_0
v_and_b32_sdwa v63, s47, v61 dst_sel:DWORD dst_unused:UNUSED_PAD src0_sel:DWORD src1_sel:WORD_1
v_and_b32 v61, s47, v61
s_waitcnt lgkmcnt(8)
v_mfma_f32_16x16x32_bf16 v[112:115], v[188:191], v[44:47], v[112:115]
ds_read_u16_d16_hi v63, v63
ds_read_u16 v61, v61
v_lshl_add_u64 v[6:7], v[200:201], 0, v[202:203]
v_mfma_f32_16x16x32_f16 v[92:95], v[176:179], v[172:175], v[92:95]
v_exp_f16_sdwa v25, v25 dst_sel:WORD_1 dst_unused:UNUSED_PRESERVE src0_sel:WORD_1
v_mfma_f32_16x16x32_bf16 v[164:167], v[188:191], v[144:147], v[164:167]
ds_read_b128 v[176:179], v251 offset:52224
v_exp_f16_sdwa v27, v27 dst_sel:WORD_1 dst_unused:UNUSED_PRESERVE src0_sel:WORD_1
v_mfma_f32_16x16x32_f16 v[216:219], v[160:163], v[228:231], v[216:219]
s_setprio 2
v_lshl_add_u64 v[134:135], v[68:69], 0, v[70:71]
v_pk_add_f16 v25, v25, 1.0 op_sel_hi:[1,0]
v_mfma_f32_16x16x32_bf16 v[100:103], v[188:191], v[148:151], v[100:103]
ds_read_b128 v[188:191], v249 offset:18688
v_pk_add_f16 v27, v27, 1.0 op_sel_hi:[1,0]
v_mfma_f32_16x16x32_f16 v[232:235], v[160:163], v[156:159], v[232:235]
v_rcp_f16_sdwa v25, v25 dst_sel:WORD_0 dst_unused:UNUSED_PRESERVE src0_sel:WORD_0
v_mfma_f32_16x16x32_bf16 v[64:67], v[52:55], v[28:31], 0
v_rcp_f16_sdwa v27, v27 dst_sel:WORD_0 dst_unused:UNUSED_PRESERVE src0_sel:WORD_0
v_mfma_f32_16x16x32_f16 v[224:227], v[160:163], v[172:175], v[224:227]
ds_read_b128 v[160:163], v251 offset:55296
v_cvt_pkrtz_f16_f32 v164, v164, v165
s_waitcnt vmcnt(11)
v_mfma_f32_16x16x32_bf16 v[76:79], v[18:21], v[152:155], v[76:79]
v_cvt_pkrtz_f16_f32 v165, v166, v167
v_lshrrev_b64 v[164:165], 2, v[164:165]
v_mfma_f32_16x16x32_bf16 v[220:223], v[16:19], v[152:155], v[220:223]
v_and_b32_sdwa v166, s47, v164 dst_sel:DWORD dst_unused:UNUSED_PAD src0_sel:DWORD src1_sel:WORD_1
v_and_b32_e64 v164, s47, v164
v_mfma_f32_16x16x32_bf16 v[140:143], v[52:55], v[128:131], 0
ds_read_u16_d16_hi v166, v166
ds_read_u16 v164, v164
v_mfma_f32_16x16x32_f16 v[116:119], v[48:51], v[132:135], v[116:119]
v_cvt_pk_f16_f32 v112, v112, v113
v_rcp_f16_sdwa v25, v25 dst_sel:WORD_1 dst_unused:UNUSED_PRESERVE src0_sel:WORD_1
v_mfma_f32_16x16x32_bf16 v[200:203], v[52:55], v[136:139], 0
v_cvt_pk_f16_f32 v114, v114, v115
v_pk_fma_f16 v113, v112, v112, s48
v_mfma_f32_16x16x32_f16 v[240:243], v[48:51], v[4:7], v[240:243]
s_waitcnt lgkmcnt(3)
ds_read_b128 v[52:55], v249 offset:20736
v_rcp_f16_sdwa v27, v27 dst_sel:WORD_1 dst_unused:UNUSED_PRESERVE src0_sel:WORD_1
v_mfma_f32_16x16x32_bf16 v[64:67], v[120:123], v[36:39], v[64:67]
v_and_b32_sdwa v167, s47, v165 dst_sel:DWORD dst_unused:UNUSED_PAD src0_sel:DWORD src1_sel:WORD_1
v_and_b32 v165, s47, v165
v_pk_fma_f16 v115, v114, v114, s48
v_mfma_f32_16x16x32_f16 v[76:79], v[48:51], v[32:35], v[76:79]
ds_read_u16_d16_hi v167, v167
ds_read_u16 v165, v165
ds_read_b128 v[48:51], v251 offset:53248
v_pk_mul_f16 v113, v112, v113
v_pk_mul_f16 v24, v24, v25
v_mfma_f32_16x16x32_bf16 v[140:143], v[120:123], v[108:111], v[140:143]
v_pk_mul_f16 v115, v114, v115
s_setprio 1
v_cvt_pkrtz_f16_f32 v100, v100, v101
v_mfma_f32_16x16x32_f16 v[72:75], v[124:127], v[132:135], v[72:75]
v_cvt_pkrtz_f16_f32 v101, v102, v103
v_lshrrev_b64 v[100:101], 2, v[100:101]
v_and_b32_sdwa v102, s47, v100 dst_sel:DWORD dst_unused:UNUSED_PAD src0_sel:DWORD src1_sel:WORD_1
v_and_b32 v100, s47, v100
v_pk_mul_f16 v25, v26, v27
v_exp_f16_sdwa v113, v113 dst_sel:WORD_0 dst_unused:UNUSED_PRESERVE src0_sel:WORD_0
v_lshl_add_u64 v[56:57], v[56:57], 0, v[58:59]
v_mfma_f32_16x16x32_bf16 v[200:203], v[120:123], v[192:195], v[200:203]
ds_read_u16_d16_hi v102, v102
ds_read_u16 v100, v100
v_mfma_f32_16x16x32_f16 v[8:11], v[124:127], v[4:7], v[8:11]
ds_read_b128 v[120:123], v249 offset:22784
v_exp_f16_sdwa v115, v115 dst_sel:WORD_0 dst_unused:UNUSED_PRESERVE src0_sel:WORD_0
v_and_b32_sdwa v103, s47, v101 dst_sel:DWORD dst_unused:UNUSED_PAD src0_sel:DWORD src1_sel:WORD_1
v_and_b32_e64 v101, s47, v101
v_mfma_f32_16x16x32_bf16 v[64:67], v[184:187], v[44:47], v[64:67]
ds_read_u16_d16_hi v103, v103
ds_read_u16 v101, v101
v_mfma_f32_16x16x32_f16 v[220:223], v[124:127], v[32:35], v[220:223]
v_exp_f16_sdwa v113, v113 dst_sel:WORD_1 dst_unused:UNUSED_PRESERVE src0_sel:WORD_1
v_mfma_f32_16x16x32_bf16 v[140:143], v[184:187], v[144:147], v[140:143]
ds_read_b128 v[124:127], v251 offset:56320
v_lshl_add_u64 v[60:61], v[60:61], 0, v[62:63]
v_mfma_f32_16x16x32_f16 v[12:15], v[176:179], v[132:135], v[12:15]
v_exp_f16_sdwa v115, v115 dst_sel:WORD_1 dst_unused:UNUSED_PRESERVE src0_sel:WORD_1
v_mfma_f32_16x16x32_bf16 v[200:203], v[184:187], v[148:151], v[200:203]
v_pk_add_f16 v113, v113, 1.0 op_sel_hi:[1,0]
v_pk_add_f16 v115, v115, 1.0 op_sel_hi:[1,0]
v_mfma_f32_16x16x32_f16 v[96:99], v[176:179], v[4:7], v[96:99]
ds_read_b128 v[184:187], v249 offset:24576
v_rcp_f16_sdwa v113, v113 dst_sel:WORD_0 dst_unused:UNUSED_PRESERVE src0_sel:WORD_0
v_mfma_f32_16x16x32_bf16 v[68:71], v[188:191], v[28:31], 0
v_rcp_f16_sdwa v115, v115 dst_sel:WORD_0 dst_unused:UNUSED_PRESERVE src0_sel:WORD_0
v_mfma_f32_16x16x32_f16 v[84:87], v[176:179], v[32:35], v[84:87]
ds_read_b128 v[176:179], v251 offset:57344
v_cvt_pkrtz_f16_f32 v64, v64, v65
v_mfma_f32_16x16x32_bf16 v[172:175], v[188:191], v[128:131], 0
s_setprio 0
v_cvt_pkrtz_f16_f32 v65, v66, v67
v_lshrrev_b64 v[64:65], 2, v[64:65]
s_waitcnt lgkmcnt(4)
v_mfma_f32_16x16x32_f16 v[208:211], v[160:163], v[132:135], v[208:211]
v_and_b32_sdwa v66, s47, v64 dst_sel:DWORD dst_unused:UNUSED_PAD src0_sel:DWORD src1_sel:WORD_1
v_and_b32_e64 v64, s47, v64
v_mfma_f32_16x16x32_bf16 v[156:159], v[188:191], v[136:139], 0
ds_read_u16_d16_hi v66, v66
ds_read_u16 v64, v64
v_rcp_f16_sdwa v113, v113 dst_sel:WORD_1 dst_unused:UNUSED_PRESERVE src0_sel:WORD_1
v_mfma_f32_16x16x32_f16 v[212:215], v[160:163], v[4:7], v[212:215]
ds_read_b128 v[188:191], v249 offset:26624
v_and_b32_sdwa v67, s47, v65 dst_sel:DWORD dst_unused:UNUSED_PAD src0_sel:DWORD src1_sel:WORD_1
v_and_b32_e64 v65, s47, v65
v_rcp_f16_sdwa v115, v115 dst_sel:WORD_1 dst_unused:UNUSED_PRESERVE src0_sel:WORD_1
v_mfma_f32_16x16x32_bf16 v[68:71], v[52:55], v[36:39], v[68:71]
ds_read_u16_d16_hi v67, v67
ds_read_u16 v65, v65
v_mfma_f32_16x16x32_f16 v[236:239], v[160:163], v[32:35], v[236:239]
v_cvt_pkrtz_f16_f32 v140, v140, v141
v_cvt_pkrtz_f16_f32 v141, v142, v143
v_lshrrev_b64 v[140:141], 2, v[140:141]
v_and_b32_sdwa v142, s47, v140 dst_sel:DWORD dst_unused:UNUSED_PAD src0_sel:DWORD src1_sel:WORD_1
v_and_b32_e64 v140, s47, v140
v_pk_mul_f16 v26, v112, v113
v_mfma_f32_16x16x32_bf16 v[172:175], v[52:55], v[108:111], v[172:175]
ds_read_u16_d16_hi v142, v142
ds_read_u16 v140, v140
ds_read_b128 v[160:163], v251 offset:60416
v_mfma_f32_16x16x32_f16 v[180:183], v[48:51], v[132:135], v[180:183]
v_and_b32_sdwa v143, s47, v141 dst_sel:DWORD dst_unused:UNUSED_PAD src0_sel:DWORD src1_sel:WORD_1
v_and_b32_e64 v141, s47, v141
v_pk_mul_f16 v27, v114, v115
v_lshl_add_u64 v[58:59], v[164:165], 0, v[166:167]
v_mfma_f32_16x16x32_bf16 v[156:159], v[52:55], v[192:195], v[156:159]
ds_read_u16_d16_hi v143, v143
ds_read_u16 v141, v141
v_cvt_pkrtz_f16_f32 v200, v200, v201
v_cvt_pkrtz_f16_f32 v201, v202, v203
v_lshrrev_b64 v[200:201], 2, v[200:201]
v_and_b32_sdwa v202, s47, v200 dst_sel:DWORD dst_unused:UNUSED_PAD src0_sel:DWORD src1_sel:WORD_1
v_and_b32 v200, s47, v200
v_mfma_f32_16x16x32_f16 v[196:199], v[48:51], v[4:7], v[196:199]
ds_read_u16_d16_hi v202, v202
s_waitcnt lgkmcnt(8)
ds_read_u16 v200, v200
ds_read_b128 v[52:55], v249 offset:28672
v_and_b32_sdwa v203, s47, v201 dst_sel:DWORD dst_unused:UNUSED_PAD src0_sel:DWORD src1_sel:WORD_1
v_and_b32_e64 v201, s47, v201
v_mfma_f32_16x16x32_bf16 v[68:71], v[120:123], v[44:47], v[68:71]
ds_read_u16_d16_hi v203, v203
ds_read_u16 v201, v201
v_mfma_f32_16x16x32_f16 v[92:95], v[48:51], v[32:35], v[92:95]
ds_read_b128 v[48:51], v251 offset:58368
s_setprio 3
v_lshl_add_u64 v[62:63], v[100:101], 0, v[102:103]
v_mfma_f32_16x16x32_bf16 v[172:175], v[120:123], v[144:147], v[172:175]
s_nop 0
v_cvt_pk_f16_f32 v68, v68, v69
v_mfma_f32_16x16x32_f16 v[216:219], v[124:127], v[132:135], v[216:219]
v_cvt_pk_f16_f32 v70, v70, v71
v_pk_fma_f16 v69, v68, v68, s48
v_mfma_f32_16x16x32_bf16 v[156:159], v[120:123], v[148:151], v[156:159]
ds_read_b128 v[120:123], v249 offset:24832
s_nop 0
v_cvt_pkrtz_f16_f32 v172, v172, v173
v_mfma_f32_16x16x32_f16 v[232:235], v[124:127], v[4:7], v[232:235]
v_cvt_pkrtz_f16_f32 v173, v174, v175
v_lshrrev_b64 v[172:173], 2, v[172:173]
v_mfma_f32_16x16x32_bf16 v[228:231], v[184:187], v[28:31], 0
v_and_b32_sdwa v174, s47, v172 dst_sel:DWORD dst_unused:UNUSED_PAD src0_sel:DWORD src1_sel:WORD_1
v_and_b32 v172, s47, v172
v_mfma_f32_16x16x32_f16 v[224:227], v[124:127], v[32:35], v[224:227]
ds_read_b128 v[124:127], v251 offset:61440
s_waitcnt lgkmcnt(8)
ds_read_u16_d16_hi v174, v174
s_waitcnt vmcnt(8)
v_mfma_f32_16x16x32_bf16 v[84:87], v[18:21], v[40:43], v[84:87]
ds_read_u16 v172, v172
v_and_b32_sdwa v175, s47, v173 dst_sel:DWORD dst_unused:UNUSED_PAD src0_sel:DWORD src1_sel:WORD_1
v_mfma_f32_16x16x32_bf16 v[236:239], v[16:19], v[40:43], v[236:239]
v_and_b32 v173, s47, v173
v_pk_fma_f16 v71, v70, v70, s48
s_waitcnt vmcnt(7)
v_mfma_f32_16x16x32_bf16 v[92:95], v[18:21], v[0:3], v[92:95]
ds_read_u16_d16_hi v175, v175
ds_read_u16 v173, v173
v_mfma_f32_16x16x32_bf16 v[224:227], v[16:19], v[0:3], v[224:227]
v_pk_mul_f16 v69, v68, v69
v_pk_mul_f16 v71, v70, v71
v_mfma_f32_16x16x32_bf16 v[152:155], v[184:187], v[128:131], 0
v_cvt_pkrtz_f16_f32 v156, v156, v157
v_cvt_pkrtz_f16_f32 v157, v158, v159
v_mfma_f32_16x16x32_f16 v[116:119], v[176:179], v[60:63], v[116:119]
v_lshrrev_b64 v[156:157], 2, v[156:157]
v_and_b32_sdwa v158, s47, v156 dst_sel:DWORD dst_unused:UNUSED_PAD src0_sel:DWORD src1_sel:WORD_1
v_mfma_f32_16x16x32_bf16 v[112:115], v[184:187], v[136:139], 0
ds_read_b128 v[184:187], v249 offset:26880
v_and_b32_e64 v156, s47, v156
v_mfma_f32_16x16x32_f16 v[240:243], v[176:179], v[56:59], v[240:243]
ds_read_u16_d16_hi v158, v158
ds_read_u16 v156, v156
v_mfma_f32_16x16x32_bf16 v[228:231], v[188:191], v[36:39], v[228:231]
v_lshl_add_u64 v[64:65], v[64:65], 0, v[66:67]
v_exp_f16_sdwa v69, v69 dst_sel:WORD_0 dst_unused:UNUSED_PRESERVE src0_sel:WORD_0
v_mfma_f32_16x16x32_f16 v[76:79], v[176:179], v[24:27], v[76:79]
s_waitcnt lgkmcnt(7)
ds_read_b128 v[176:179], v251 offset:59392
s_setprio 2
v_exp_f16_sdwa v71, v71 dst_sel:WORD_0 dst_unused:UNUSED_PRESERVE src0_sel:WORD_0
v_mfma_f32_16x16x32_bf16 v[152:155], v[188:191], v[108:111], v[152:155]
v_and_b32_sdwa v159, s47, v157 dst_sel:DWORD dst_unused:UNUSED_PAD src0_sel:DWORD src1_sel:WORD_1
v_and_b32_e64 v157, s47, v157
v_mfma_f32_16x16x32_f16 v[72:75], v[160:163], v[60:63], v[72:75]
ds_read_u16_d16_hi v159, v159
ds_read_u16 v157, v157
v_mfma_f32_16x16x32_bf16 v[112:115], v[188:191], v[192:195], v[112:115]
ds_read_b128 v[188:191], v249 offset:28928
v_lshl_add_u64 v[140:141], v[140:141], 0, v[142:143]
v_mfma_f32_16x16x32_f16 v[8:11], v[160:163], v[56:59], v[8:11]
v_exp_f16_sdwa v69, v69 dst_sel:WORD_1 dst_unused:UNUSED_PRESERVE src0_sel:WORD_1
v_mfma_f32_16x16x32_bf16 v[228:231], v[52:55], v[44:47], v[228:231]
v_exp_f16_sdwa v71, v71 dst_sel:WORD_1 dst_unused:UNUSED_PRESERVE src0_sel:WORD_1
v_mfma_f32_16x16x32_f16 v[220:223], v[160:163], v[24:27], v[220:223]
ds_read_b128 v[160:163], v251 offset:62464
v_lshl_add_u64 v[200:201], v[200:201], 0, v[202:203]
v_mfma_f32_16x16x32_bf16 v[152:155], v[52:55], v[144:147], v[152:155]
v_pk_add_f16 v69, v69, 1.0 op_sel_hi:[1,0]
v_pk_add_f16 v71, v71, 1.0 op_sel_hi:[1,0]
v_mfma_f32_16x16x32_f16 v[12:15], v[48:51], v[60:63], v[12:15]
v_rcp_f16_sdwa v69, v69 dst_sel:WORD_0 dst_unused:UNUSED_PRESERVE src0_sel:WORD_0
v_mfma_f32_16x16x32_bf16 v[112:115], v[52:55], v[148:151], v[112:115]
ds_read_b128 v[52:55], v249 offset:30720
v_rcp_f16_sdwa v71, v71 dst_sel:WORD_0 dst_unused:UNUSED_PRESERVE src0_sel:WORD_0
v_mfma_f32_16x16x32_f16 v[96:99], v[48:51], v[56:59], v[96:99]
v_cvt_pkrtz_f16_f32 v152, v152, v153
v_cvt_pkrtz_f16_f32 v153, v154, v155
v_mfma_f32_16x16x32_bf16 v[164:167], v[120:123], v[28:31], 0
v_lshrrev_b64 v[152:153], 2, v[152:153]
v_and_b32_sdwa v154, s47, v152 dst_sel:DWORD dst_unused:UNUSED_PAD src0_sel:DWORD src1_sel:WORD_1
v_mfma_f32_16x16x32_f16 v[84:87], v[48:51], v[24:27], v[84:87]
ds_read_b128 v[48:51], v251 offset:63488
s_setprio 1
v_and_b32_e64 v152, s47, v152
v_mfma_f32_16x16x32_bf16 v[100:103], v[120:123], v[128:131], 0
ds_read_u16_d16_hi v154, v154
s_waitcnt lgkmcnt(5)
ds_read_u16 v152, v152
v_mfma_f32_16x16x32_f16 v[208:211], v[124:127], v[60:63], v[208:211]
v_cvt_pk_f16_f32 v228, v228, v229
v_rcp_f16_sdwa v69, v69 dst_sel:WORD_1 dst_unused:UNUSED_PRESERVE src0_sel:WORD_1
v_mfma_f32_16x16x32_bf16 v[32:35], v[120:123], v[136:139], 0
v_cvt_pk_f16_f32 v230, v230, v231
v_pk_fma_f16 v229, v228, v228, s48
v_mfma_f32_16x16x32_f16 v[212:215], v[124:127], v[56:59], v[212:215]
ds_read_b128 v[120:123], v249 offset:32768
v_rcp_f16_sdwa v71, v71 dst_sel:WORD_1 dst_unused:UNUSED_PRESERVE src0_sel:WORD_1
v_mfma_f32_16x16x32_bf16 v[164:167], v[184:187], v[36:39], v[164:167]
v_and_b32_sdwa v155, s47, v153 dst_sel:DWORD dst_unused:UNUSED_PAD src0_sel:DWORD src1_sel:WORD_1
v_and_b32_e64 v153, s47, v153
v_pk_fma_f16 v231, v230, v230, s48
v_mfma_f32_16x16x32_f16 v[236:239], v[124:127], v[24:27], v[236:239]
ds_read_u16_d16_hi v155, v155
ds_read_u16 v153, v153
ds_read_b128 v[124:127], v252 offset:1024
v_pk_mul_f16 v229, v228, v229
v_pk_mul_f16 v66, v68, v69
v_mfma_f32_16x16x32_bf16 v[100:103], v[184:187], v[108:111], v[100:103]
v_pk_mul_f16 v231, v230, v231
v_cvt_pkrtz_f16_f32 v112, v112, v113
v_mfma_f32_16x16x32_f16 v[180:183], v[176:179], v[60:63], v[180:183]
v_cvt_pkrtz_f16_f32 v113, v114, v115
v_lshrrev_b64 v[112:113], 2, v[112:113]
v_and_b32_sdwa v114, s47, v112 dst_sel:DWORD dst_unused:UNUSED_PAD src0_sel:DWORD src1_sel:WORD_1
v_and_b32_e64 v112, s47, v112
v_pk_mul_f16 v67, v70, v71
v_exp_f16_sdwa v229, v229 dst_sel:WORD_0 dst_unused:UNUSED_PRESERVE src0_sel:WORD_0
v_lshl_add_u64 v[142:143], v[172:173], 0, v[174:175]
v_mfma_f32_16x16x32_bf16 v[32:35], v[184:187], v[192:195], v[32:35]
ds_read_u16_d16_hi v114, v114
ds_read_u16 v112, v112
v_mfma_f32_16x16x32_f16 v[196:199], v[176:179], v[56:59], v[196:199]
ds_read_b128 v[184:187], v249 offset:34816
v_exp_f16_sdwa v231, v231 dst_sel:WORD_0 dst_unused:UNUSED_PRESERVE src0_sel:WORD_0
v_and_b32_sdwa v115, s47, v113 dst_sel:DWORD dst_unused:UNUSED_PAD src0_sel:DWORD src1_sel:WORD_1
v_and_b32_e64 v113, s47, v113
s_waitcnt lgkmcnt(6)
v_mfma_f32_16x16x32_bf16 v[164:167], v[188:191], v[44:47], v[164:167]
ds_read_u16_d16_hi v115, v115
ds_read_u16 v113, v113
v_mfma_f32_16x16x32_f16 v[92:95], v[176:179], v[24:27], v[92:95]
v_exp_f16_sdwa v229, v229 dst_sel:WORD_1 dst_unused:UNUSED_PRESERVE src0_sel:WORD_1
s_setprio 0
ds_read_b128 v[176:179], v251 offset:64512
v_mfma_f32_16x16x32_bf16 v[100:103], v[188:191], v[144:147], v[100:103]
v_lshl_add_u64 v[202:203], v[156:157], 0, v[158:159]
v_exp_f16_sdwa v231, v231 dst_sel:WORD_1 dst_unused:UNUSED_PRESERVE src0_sel:WORD_1
v_mfma_f32_16x16x32_f16 v[216:219], v[160:163], v[60:63], v[216:219]
v_pk_add_f16 v229, v229, 1.0 op_sel_hi:[1,0]
v_pk_add_f16 v231, v231, 1.0 op_sel_hi:[1,0]
v_mfma_f32_16x16x32_bf16 v[32:35], v[188:191], v[148:151], v[32:35]
ds_read_b128 v[188:191], v249 offset:30976
v_rcp_f16_sdwa v229, v229 dst_sel:WORD_0 dst_unused:UNUSED_PRESERVE src0_sel:WORD_0
v_mfma_f32_16x16x32_f16 v[232:235], v[160:163], v[56:59], v[232:235]
v_rcp_f16_sdwa v231, v231 dst_sel:WORD_0 dst_unused:UNUSED_PRESERVE src0_sel:WORD_0
v_mfma_f32_16x16x32_bf16 v[4:7], v[52:55], v[28:31], 0
v_cvt_pkrtz_f16_f32 v164, v164, v165
v_cvt_pkrtz_f16_f32 v165, v166, v167
v_mfma_f32_16x16x32_f16 v[224:227], v[160:163], v[24:27], v[224:227]
ds_read_b128 v[160:163], v252 offset:2048
v_lshrrev_b64 v[164:165], 2, v[164:165]
s_waitcnt vmcnt(5)
v_mfma_f32_16x16x32_bf16 v[240:243], v[18:21], v[244:247], v[240:243]
v_and_b32_sdwa v166, s47, v164 dst_sel:DWORD dst_unused:UNUSED_PAD src0_sel:DWORD src1_sel:WORD_1
v_and_b32_e64 v164, s47, v164
v_mfma_f32_16x16x32_bf16 v[8:11], v[16:19], v[244:247], v[8:11]
ds_read_u16_d16_hi v166, v166
ds_read_u16 v164, v164
s_waitcnt vmcnt(4)
v_mfma_f32_16x16x32_bf16 v[96:99], v[18:21], v[168:171], v[96:99]
v_rcp_f16_sdwa v229, v229 dst_sel:WORD_1 dst_unused:UNUSED_PRESERVE src0_sel:WORD_1
v_mfma_f32_16x16x32_bf16 v[212:215], v[16:19], v[168:171], v[212:215]
v_and_b32_sdwa v167, s47, v165 dst_sel:DWORD dst_unused:UNUSED_PAD src0_sel:DWORD src1_sel:WORD_1
v_and_b32 v165, s47, v165
v_mfma_f32_16x16x32_bf16 v[132:135], v[52:55], v[128:131], 0
ds_read_u16_d16_hi v167, v167
ds_read_u16 v165, v165
v_mfma_f32_16x16x32_f16 v[116:119], v[48:51], v[200:203], v[116:119]
v_rcp_f16_sdwa v231, v231 dst_sel:WORD_1 dst_unused:UNUSED_PRESERVE src0_sel:WORD_1
v_mfma_f32_16x16x32_bf16 v[40:43], v[52:55], v[136:139], 0
s_waitcnt lgkmcnt(5)
ds_read_b128 v[52:55], v249 offset:33024
v_cvt_pkrtz_f16_f32 v100, v100, v101
v_mfma_f32_16x16x32_f16 v[240:243], v[48:51], v[140:143], v[240:243]
v_cvt_pkrtz_f16_f32 v101, v102, v103
v_lshrrev_b64 v[100:101], 2, v[100:101]
v_mfma_f32_16x16x32_bf16 v[4:7], v[120:123], v[36:39], v[4:7]
v_and_b32_sdwa v102, s47, v100 dst_sel:DWORD dst_unused:UNUSED_PAD src0_sel:DWORD src1_sel:WORD_1
v_and_b32 v100, s47, v100
v_mfma_f32_16x16x32_f16 v[76:79], v[48:51], v[64:67], v[76:79]
s_setprio 3
ds_read_u16_d16_hi v102, v102
ds_read_u16 v100, v100
ds_read_b128 v[48:51], v252
v_pk_mul_f16 v228, v228, v229
v_mfma_f32_16x16x32_bf16 v[132:135], v[120:123], v[108:111], v[132:135]
v_and_b32_sdwa v103, s47, v101 dst_sel:DWORD dst_unused:UNUSED_PAD src0_sel:DWORD src1_sel:WORD_1
v_and_b32_e64 v101, s47, v101
v_mfma_f32_16x16x32_f16 v[72:75], v[124:127], v[200:203], v[72:75]
ds_read_u16_d16_hi v103, v103
ds_read_u16 v101, v101
v_pk_mul_f16 v229, v230, v231
v_lshl_add_u64 v[152:153], v[152:153], 0, v[154:155]
v_mfma_f32_16x16x32_bf16 v[40:43], v[120:123], v[192:195], v[40:43]
v_cvt_pkrtz_f16_f32 v32, v32, v33
v_cvt_pkrtz_f16_f32 v33, v34, v35
v_lshrrev_b64 v[32:33], 2, v[32:33]
v_and_b32_sdwa v34, s47, v32 dst_sel:DWORD dst_unused:UNUSED_PAD src0_sel:DWORD src1_sel:WORD_1
v_and_b32_e64 v32, s47, v32
v_mfma_f32_16x16x32_f16 v[8:11], v[124:127], v[140:143], v[8:11]
ds_read_u16_d16_hi v34, v34
ds_read_u16 v32, v32
ds_read_b128 v[120:123], v249 offset:35072
v_and_b32_sdwa v35, s47, v33 dst_sel:DWORD dst_unused:UNUSED_PAD src0_sel:DWORD src1_sel:WORD_1
v_and_b32 v33, s47, v33
v_mfma_f32_16x16x32_bf16 v[4:7], v[184:187], v[44:47], v[4:7]
ds_read_u16_d16_hi v35, v35
s_waitcnt lgkmcnt(9)
ds_read_u16 v33, v33
v_mfma_f32_16x16x32_f16 v[220:223], v[124:127], v[64:67], v[220:223]
ds_read_b128 v[124:127], v252 offset:3072
v_lshl_add_u64 v[112:113], v[112:113], 0, v[114:115]
v_mfma_f32_16x16x32_bf16 v[132:135], v[184:187], v[144:147], v[132:135]
s_nop 0
v_cvt_pk_f16_f32 v4, v4, v5
v_mfma_f32_16x16x32_f16 v[12:15], v[176:179], v[200:203], v[12:15]
v_cvt_pk_f16_f32 v6, v6, v7
v_pk_fma_f16 v5, v4, v4, s48
v_mfma_f32_16x16x32_bf16 v[40:43], v[184:187], v[148:151], v[40:43]
ds_read_b128 v[184:187], v252 offset:4096
s_nop 0
v_cvt_pkrtz_f16_f32 v132, v132, v133
v_mfma_f32_16x16x32_f16 v[96:99], v[176:179], v[140:143], v[96:99]
v_cvt_pkrtz_f16_f32 v133, v134, v135
v_lshrrev_b64 v[132:133], 2, v[132:133]
v_mfma_f32_16x16x32_bf16 v[0:3], v[188:191], v[28:31], 0
v_and_b32_sdwa v134, s47, v132 dst_sel:DWORD dst_unused:UNUSED_PAD src0_sel:DWORD src1_sel:WORD_1
v_and_b32 v132, s47, v132
v_mfma_f32_16x16x32_f16 v[84:87], v[176:179], v[64:67], v[84:87]
s_setprio 2
ds_read_u16_d16_hi v134, v134
ds_read_u16 v132, v132
v_mfma_f32_16x16x32_bf16 v[68:71], v[188:191], v[128:131], 0
v_and_b32_sdwa v135, s47, v133 dst_sel:DWORD dst_unused:UNUSED_PAD src0_sel:DWORD src1_sel:WORD_1
v_and_b32 v133, s47, v133
v_mfma_f32_16x16x32_f16 v[208:211], v[160:163], v[200:203], v[208:211]
ds_read_u16_d16_hi v135, v135
s_waitcnt lgkmcnt(8)
ds_read_u16 v133, v133
v_mfma_f32_16x16x32_bf16 v[172:175], v[188:191], v[136:139], 0
v_pk_fma_f16 v7, v6, v6, s48
v_pk_mul_f16 v5, v4, v5
v_mfma_f32_16x16x32_f16 v[212:215], v[160:163], v[140:143], v[212:215]
ds_read_b128 v[176:179], v252 offset:7168
v_pk_mul_f16 v7, v6, v7
v_mfma_f32_16x16x32_bf16 v[0:3], v[52:55], v[36:39], v[0:3]
v_cvt_pkrtz_f16_f32 v40, v40, v41
v_cvt_pkrtz_f16_f32 v41, v42, v43
v_mfma_f32_16x16x32_f16 v[236:239], v[160:163], v[64:67], v[236:239]
v_lshrrev_b64 v[40:41], 2, v[40:41]
v_and_b32_sdwa v42, s47, v40 dst_sel:DWORD dst_unused:UNUSED_PAD src0_sel:DWORD src1_sel:WORD_1
v_mfma_f32_16x16x32_bf16 v[68:71], v[52:55], v[108:111], v[68:71]
v_and_b32_e64 v40, s47, v40
v_lshl_add_u64 v[230:231], v[164:165], 0, v[166:167]
v_mfma_f32_16x16x32_f16 v[180:183], v[48:51], v[200:203], v[180:183]
ds_read_u16_d16_hi v42, v42
ds_read_u16 v40, v40
v_exp_f16_sdwa v5, v5 dst_sel:WORD_0 dst_unused:UNUSED_PRESERVE src0_sel:WORD_0
v_mfma_f32_16x16x32_bf16 v[172:175], v[52:55], v[192:195], v[172:175]
v_exp_f16_sdwa v7, v7 dst_sel:WORD_0 dst_unused:UNUSED_PRESERVE src0_sel:WORD_0
v_mfma_f32_16x16x32_f16 v[196:199], v[48:51], v[140:143], v[196:199]
v_and_b32_sdwa v43, s47, v41 dst_sel:DWORD dst_unused:UNUSED_PAD src0_sel:DWORD src1_sel:WORD_1
v_and_b32_e64 v41, s47, v41
s_waitcnt lgkmcnt(5)
v_mfma_f32_16x16x32_bf16 v[0:3], v[120:123], v[44:47], v[0:3]
ds_read_u16_d16_hi v43, v43
ds_read_u16 v41, v41
v_lshl_add_u64 v[154:155], v[100:101], 0, v[102:103]
s_setprio 1
v_mfma_f32_16x16x32_f16 v[92:95], v[48:51], v[64:67], v[92:95]
v_exp_f16_sdwa v5, v5 dst_sel:WORD_1 dst_unused:UNUSED_PRESERVE src0_sel:WORD_1
v_mfma_f32_16x16x32_bf16 v[68:71], v[120:123], v[144:147], v[68:71]
ds_read_b128 v[188:191], v252 offset:5120
v_exp_f16_sdwa v7, v7 dst_sel:WORD_1 dst_unused:UNUSED_PRESERVE src0_sel:WORD_1
v_mfma_f32_16x16x32_f16 v[216:219], v[124:127], v[200:203], v[216:219]
v_lshl_add_u64 v[114:115], v[32:33], 0, v[34:35]
v_pk_add_f16 v5, v5, 1.0 op_sel_hi:[1,0]
v_mfma_f32_16x16x32_bf16 v[172:175], v[120:123], v[148:151], v[172:175]
v_pk_add_f16 v7, v7, 1.0 op_sel_hi:[1,0]
v_rcp_f16_sdwa v5, v5 dst_sel:WORD_0 dst_unused:UNUSED_PRESERVE src0_sel:WORD_0
v_mfma_f32_16x16x32_f16 v[232:235], v[124:127], v[140:143], v[232:235]
ds_read_b128 v[160:163], v252 offset:8192
v_rcp_f16_sdwa v7, v7 dst_sel:WORD_0 dst_unused:UNUSED_PRESERVE src0_sel:WORD_0
v_mfma_f32_16x16x32_f16 v[224:227], v[124:127], v[64:67], v[224:227]
v_cvt_pkrtz_f16_f32 v68, v68, v69
v_cvt_pkrtz_f16_f32 v69, v70, v71
s_waitcnt vmcnt(3)
v_mfma_f32_16x16x32_bf16 v[196:199], v[18:21], v[104:107], v[196:199]
v_lshrrev_b64 v[68:69], 2, v[68:69]
v_and_b32_sdwa v70, s47, v68 dst_sel:DWORD dst_unused:UNUSED_PAD src0_sel:DWORD src1_sel:WORD_1
v_mfma_f32_16x16x32_bf16 v[232:235], v[16:19], v[104:107], v[232:235]
v_and_b32_e64 v68, s47, v68
v_cvt_pk_f16_f32 v0, v0, v1
s_waitcnt vmcnt(2)
v_mfma_f32_16x16x32_bf16 v[116:119], v[18:21], v[204:207], v[116:119]
ds_read_u16_d16_hi v70, v70
ds_read_u16 v68, v68
v_mfma_f32_16x16x32_bf16 v[72:75], v[16:19], v[204:207], v[72:75]
v_rcp_f16_sdwa v5, v5 dst_sel:WORD_1 dst_unused:UNUSED_PRESERVE src0_sel:WORD_1
v_mfma_f32_16x16x32_f16 v[116:119], v[184:187], v[112:115], v[116:119]
v_cvt_pk_f16_f32 v2, v2, v3
v_pk_fma_f16 v1, v0, v0, s48
v_mfma_f32_16x16x32_f16 v[240:243], v[184:187], v[152:155], v[240:243]
v_rcp_f16_sdwa v7, v7 dst_sel:WORD_1 dst_unused:UNUSED_PRESERVE src0_sel:WORD_1
s_setprio 0
v_and_b32_sdwa v71, s47, v69 dst_sel:DWORD dst_unused:UNUSED_PAD src0_sel:DWORD src1_sel:WORD_1
v_and_b32 v69, s47, v69
v_pk_fma_f16 v3, v2, v2, s48
v_mfma_f32_16x16x32_f16 v[76:79], v[184:187], v[228:231], v[76:79]
ds_read_u16_d16_hi v71, v71
ds_read_u16 v69, v69
ds_read_b128 v[52:55], v252 offset:6144
v_pk_mul_f16 v1, v0, v1
v_pk_mul_f16 v4, v4, v5
v_pk_mul_f16 v3, v2, v3
s_waitcnt lgkmcnt(5)
v_mfma_f32_16x16x32_f16 v[72:75], v[176:179], v[112:115], v[72:75]
v_cvt_pkrtz_f16_f32 v172, v172, v173
v_cvt_pkrtz_f16_f32 v173, v174, v175
v_lshrrev_b64 v[172:173], 2, v[172:173]
v_and_b32_sdwa v174, s47, v172 dst_sel:DWORD dst_unused:UNUSED_PAD src0_sel:DWORD src1_sel:WORD_1
v_and_b32 v172, s47, v172
v_pk_mul_f16 v5, v6, v7
v_exp_f16_sdwa v1, v1 dst_sel:WORD_0 dst_unused:UNUSED_PRESERVE src0_sel:WORD_0
v_lshl_add_u64 v[132:133], v[132:133], 0, v[134:135]
v_mfma_f32_16x16x32_f16 v[8:11], v[176:179], v[152:155], v[8:11]
ds_read_u16_d16_hi v174, v174
ds_read_u16 v172, v172
v_exp_f16_sdwa v3, v3 dst_sel:WORD_0 dst_unused:UNUSED_PRESERVE src0_sel:WORD_0
v_and_b32_sdwa v175, s47, v173 dst_sel:DWORD dst_unused:UNUSED_PAD src0_sel:DWORD src1_sel:WORD_1
v_and_b32 v173, s47, v173
v_mfma_f32_16x16x32_f16 v[220:223], v[176:179], v[228:231], v[220:223]
ds_read_u16_d16_hi v175, v175
ds_read_u16 v173, v173
v_exp_f16_sdwa v1, v1 dst_sel:WORD_1 dst_unused:UNUSED_PRESERVE src0_sel:WORD_1
v_mfma_f32_16x16x32_f16 v[12:15], v[188:191], v[112:115], v[12:15]
ds_read_b128 v[48:51], v252 offset:9216
v_lshl_add_u64 v[40:41], v[40:41], 0, v[42:43]
v_exp_f16_sdwa v3, v3 dst_sel:WORD_1 dst_unused:UNUSED_PRESERVE src0_sel:WORD_1
v_mfma_f32_16x16x32_f16 v[96:99], v[188:191], v[152:155], v[96:99]
v_pk_add_f16 v1, v1, 1.0 op_sel_hi:[1,0]
v_pk_add_f16 v3, v3, 1.0 op_sel_hi:[1,0]
s_setprio 3
v_rcp_f16_sdwa v1, v1 dst_sel:WORD_0 dst_unused:UNUSED_PRESERVE src0_sel:WORD_0
v_mfma_f32_16x16x32_f16 v[84:87], v[188:191], v[228:231], v[84:87]
ds_read_b128 v[120:123], v252 offset:10240
v_rcp_f16_sdwa v3, v3 dst_sel:WORD_0 dst_unused:UNUSED_PRESERVE src0_sel:WORD_0
v_mfma_f32_16x16x32_f16 v[208:211], v[160:163], v[112:115], v[208:211]
ds_read_b128 v[124:127], v252 offset:13312
v_rcp_f16_sdwa v1, v1 dst_sel:WORD_1 dst_unused:UNUSED_PRESERVE src0_sel:WORD_1
v_mfma_f32_16x16x32_f16 v[212:215], v[160:163], v[152:155], v[212:215]
v_rcp_f16_sdwa v3, v3 dst_sel:WORD_1 dst_unused:UNUSED_PRESERVE src0_sel:WORD_1
v_mfma_f32_16x16x32_f16 v[236:239], v[160:163], v[228:231], v[236:239]
ds_read_b128 v[184:187], v252 offset:11264
v_pk_mul_f16 v6, v0, v1
s_waitcnt lgkmcnt(6)
v_mfma_f32_16x16x32_f16 v[180:183], v[52:55], v[112:115], v[180:183]
v_pk_mul_f16 v7, v2, v3
v_lshl_add_u64 v[134:135], v[68:69], 0, v[70:71]
v_mfma_f32_16x16x32_f16 v[196:199], v[52:55], v[152:155], v[196:199]
ds_read_b128 v[176:179], v252 offset:14336
s_setprio 2
ds_read_b128 v[188:191], v252 offset:12288
v_mfma_f32_16x16x32_f16 v[92:95], v[52:55], v[228:231], v[92:95]
s_waitcnt lgkmcnt(5)
v_lshl_add_u64 v[42:43], v[172:173], 0, v[174:175]
ds_read_b128 v[160:163], v252 offset:15360
v_mfma_f32_16x16x32_f16 v[216:219], v[48:51], v[112:115], v[216:219]
v_mfma_f32_16x16x32_f16 v[232:235], v[48:51], v[152:155], v[232:235]
v_mfma_f32_16x16x32_f16 v[224:227], v[48:51], v[228:231], v[224:227]
s_waitcnt vmcnt(1)
v_mfma_f32_16x16x32_bf16 v[12:15], v[18:21], v[80:83], v[12:15]
v_mfma_f32_16x16x32_bf16 v[208:211], v[16:19], v[80:83], v[208:211]
s_waitcnt vmcnt(0)
v_mfma_f32_16x16x32_bf16 v[180:183], v[18:21], v[88:91], v[180:183]
v_mfma_f32_16x16x32_bf16 v[216:219], v[16:19], v[88:91], v[216:219]
s_waitcnt lgkmcnt(2)
v_mfma_f32_16x16x32_f16 v[116:119], v[120:123], v[40:43], v[116:119]
v_mfma_f32_16x16x32_f16 v[240:243], v[120:123], v[132:135], v[240:243]
v_mfma_f32_16x16x32_f16 v[76:79], v[120:123], v[4:7], v[76:79]
s_nop 5
v_cvt_pk_bf16_f32 v116, v116, v117
v_mfma_f32_16x16x32_f16 v[72:75], v[124:127], v[40:43], v[72:75]
s_setprio 1
v_cvt_pk_bf16_f32 v117, v118, v119
v_cvt_pk_bf16_f32 v240, v240, v241
v_mfma_f32_16x16x32_f16 v[8:11], v[124:127], v[132:135], v[8:11]
v_cvt_pk_bf16_f32 v76, v76, v77
v_cvt_pk_bf16_f32 v77, v78, v79
v_mfma_f32_16x16x32_f16 v[220:223], v[124:127], v[4:7], v[220:223]
v_cvt_pk_bf16_f32 v241, v242, v243
v_cvt_pk_bf16_f32 v118, v72, v73
v_mfma_f32_16x16x32_f16 v[12:15], v[184:187], v[40:43], v[12:15]
s_nop 1
v_cvt_pk_bf16_f32 v242, v8, v9
v_cvt_pk_bf16_f32 v243, v10, v11
v_mfma_f32_16x16x32_f16 v[96:99], v[184:187], v[132:135], v[96:99]
v_cvt_pk_bf16_f32 v78, v220, v221
v_cvt_pk_bf16_f32 v79, v222, v223
v_mfma_f32_16x16x32_f16 v[84:87], v[184:187], v[4:7], v[84:87]
v_cvt_pk_bf16_f32 v119, v74, v75
v_cvt_pk_bf16_f32 v12, v12, v13
v_mfma_f32_16x16x32_f16 v[208:211], v[176:179], v[40:43], v[208:211]
s_nop 1
v_cvt_pk_bf16_f32 v96, v96, v97
v_cvt_pk_bf16_f32 v97, v98, v99
v_mfma_f32_16x16x32_f16 v[212:215], v[176:179], v[132:135], v[212:215]
v_cvt_pk_bf16_f32 v84, v84, v85
v_cvt_pk_bf16_f32 v85, v86, v87
v_mfma_f32_16x16x32_f16 v[236:239], v[176:179], v[4:7], v[236:239]
v_cvt_pk_bf16_f32 v13, v14, v15
v_cvt_pk_bf16_f32 v14, v208, v209
v_cvt_pk_bf16_f32 v15, v210, v211
s_waitcnt lgkmcnt(0)
v_mfma_f32_16x16x32_f16 v[180:183], v[188:191], v[40:43], v[180:183]
v_cvt_pk_bf16_f32 v98, v212, v213
v_cvt_pk_bf16_f32 v99, v214, v215
v_mfma_f32_16x16x32_f16 v[196:199], v[188:191], v[132:135], v[196:199]
v_cvt_pk_bf16_f32 v86, v236, v237
v_cvt_pk_bf16_f32 v87, v238, v239
v_mfma_f32_16x16x32_f16 v[92:95], v[188:191], v[4:7], v[92:95]
s_nop 1
v_cvt_pk_bf16_f32 v180, v180, v181
v_cvt_pk_bf16_f32 v181, v182, v183
v_mfma_f32_16x16x32_f16 v[216:219], v[160:163], v[40:43], v[216:219]
v_cvt_pk_bf16_f32 v196, v196, v197
v_cvt_pk_bf16_f32 v197, v198, v199
v_mfma_f32_16x16x32_f16 v[232:235], v[160:163], v[132:135], v[232:235]
v_cvt_pk_bf16_f32 v92, v92, v93
v_cvt_pk_bf16_f32 v93, v94, v95
s_setprio 0
v_mfma_f32_16x16x32_f16 v[224:227], v[160:163], v[4:7], v[224:227]
s_nop 0
v_cvt_pk_bf16_f32 v182, v216, v217
v_cvt_pk_bf16_f32 v183, v218, v219
s_nop 0
v_cvt_pk_bf16_f32 v198, v232, v233
v_cvt_pk_bf16_f32 v199, v234, v235
s_nop 1
v_cvt_pk_bf16_f32 v94, v224, v225
v_cvt_pk_bf16_f32 v95, v226, v227
buffer_store_dwordx4 v[76:79], v253, s[8:11], s69 offen offset:192 sc1
buffer_store_dwordx4 v[84:87], v253, s[8:11], s69 offen offset:256 sc1
buffer_store_dwordx4 v[92:95], v253, s[8:11], s69 offen offset:320 sc1
buffer_store_dwordx4 v[240:243], v253, s[8:11], s68 offen sc1
buffer_store_dwordx4 v[96:99], v253, s[8:11], s68 offen offset:64 sc1
buffer_store_dwordx4 v[196:199], v253, s[8:11], s68 offen offset:128 sc1
buffer_store_dwordx4 v[116:119], v253, s[8:11], s68 offen offset:192 sc1
buffer_store_dwordx4 v[12:15], v253, s[8:11], s68 offen offset:256 sc1
buffer_store_dwordx4 v[180:183], v253, s[8:11], s68 offen offset:320 sc1
s_endpgm
Lpolln:
s_getreg_b32 s43, hwreg(HW_REG_IB_STS, 0, 4)
s_cmp_eq_u32 s43, 0
s_cbranch_scc1 Lpoll
s_setpc_b64 s[78:79]
Lpoll:
s_waitcnt vmcnt(0)
s_cmp_eq_u32 s77, 2
s_cbranch_scc1 LpollC
v_max_u32 v241, v128, v129
v_max3_u32 v241, v241, v130, v131
v_max3_u32 v241, v241, v132, v133
v_max3_u32 v241, v241, v134, v135
v_max3_u32 v241, v241, v136, v137
v_max3_u32 v241, v241, v138, v139
v_max3_u32 v241, v241, v140, v141
v_max3_u32 v241, v241, v142, v143
v_cmp_eq_u32 vcc, -1, v241
s_nop 4
s_cbranch_vccz LpollR
s_lshl_b32 s44, s2, 12
buffer_load_dwordx4 v[128:131], v245, s[32:35], s44 offen sc1
buffer_load_dwordx4 v[132:135], v245, s[32:35], s44 offen offset:1024 sc1
buffer_load_dwordx4 v[136:139], v245, s[32:35], s44 offen offset:2048 sc1
buffer_load_dwordx4 v[140:143], v245, s[32:35], s44 offen offset:3072 sc1
s_setpc_b64 s[78:79]
LpollR:
v_add_f32 v128, v128, v132
v_add_f32 v140, v136, v140
v_add_f32 v140, v128, v140
v_add_f32 v129, v129, v133
v_add_f32 v141, v137, v141
v_add_f32 v141, v129, v141
v_add_f32 v130, v130, v134
v_add_f32 v142, v138, v142
v_add_f32 v142, v130, v142
v_add_f32 v131, v131, v135
v_add_f32 v143, v139, v143
v_add_f32 v143, v131, v143
v_permlane32_swap_b32 v140, v141
s_nop 0
v_permlane32_swap_b32 v142, v143
v_add_f32 v140, v140, v141
v_add_f32_e64 v142, v142, v143
v_bfe_u32 v241, v245, 4, 4
v_lshlrev_b32 v241, 11, v241
v_permlane16_swap_b32 v140, v142
v_add_f32 v140, v140, v142
v_bfe_u32 v242, v245, 8, 1
v_lshl_add_u32 v241, v242, 3, v241
v_add_f32_dpp v140, v140, v140 row_ror:8 row_mask:0xf bank_mask:0xf
v_bfe_u32 v242, v245, 9, 1
v_lshl_add_u32 v241, v242, 2, v241
v_add_f32_dpp v140, v140, v140 row_ror:4 row_mask:0xf bank_mask:0xf
s_lshl_b32 s44, s2, 4
s_add_u32 s44, s44, 393216
v_add_f32_dpp v140, v140, v140 row_ror:2 row_mask:0xf bank_mask:0xf
s_mov_b32 s43, 1083289508
v_mov_b32 v242, 897988541
v_add_f32_dpp v140, v140, v140 row_ror:1 row_mask:0xf bank_mask:0xf
v_fma_f32 v140, v140, s43, v242
v_sqrt_f32_e64 v140, v140
s_mov_b32 exec_lo, 16711935
s_mov_b32 exec_hi, 16711935
v_min_u32_e64 v140, -2, v140
buffer_store_dword v140, v241, s[32:35], s44 offen sc1
s_mov_b64 exec, -1
s_mov_b32 s77, 2
s_and_b32 s44, s2, 7
s_lshl_b32 s44, s44, 11
s_add_u32 s44, s44, 393216
buffer_load_dwordx2 v[128:129], v240, s[32:35], s44 offen sc1
buffer_load_dwordx2 v[130:131], v240, s[32:35], s44 offen offset:8 sc1
buffer_load_dwordx2 v[132:133], v240, s[32:35], s44 offen offset:16 sc1
v_lshrrev_b32 v241, 1, v240
buffer_load_dword v135, v241, s[24:27], 0 offen
buffer_load_dword v137, v241, s[24:27], 0 offen offset:4
buffer_load_dword v139, v241, s[24:27], 0 offen offset:8
s_setpc_b64 s[78:79]
LpollC:
v_max3_u32 v241, v128, v129, v130
v_max3_u32 v241, v241, v131, v132
v_max_u32 v241, v241, v133
v_cmp_eq_u32 vcc, -1, v241
s_nop 4
s_cbranch_vccz LpollS
s_and_b32 s44, s2, 7
s_lshl_b32 s44, s44, 11
s_add_u32 s44, s44, 393216
buffer_load_dwordx2 v[128:129], v240, s[32:35], s44 offen sc1
buffer_load_dwordx2 v[130:131], v240, s[32:35], s44 offen offset:8 sc1
buffer_load_dwordx2 v[132:133], v240, s[32:35], s44 offen offset:16 sc1
s_setpc_b64 s[78:79]
LpollS:
v_add_f32 v243, v128, v129
v_add_f32 v243, v243, v130
v_add_f32 v243, v243, v131
v_add_f32 v243, v243, v132
v_add_f32 v243, v243, v133
v_lshlrev_b32_e64 v134, 16, v135
v_and_b32 v135, 4294901760, v135
v_add_f32_dpp v243, v243, v243 row_ror:8 row_mask:0xf bank_mask:0xf
v_lshlrev_b32_e64 v136, 16, v137
v_and_b32 v137, 4294901760, v137
v_add_f32_dpp v243, v243, v243 row_ror:4 row_mask:0xf bank_mask:0xf
v_lshlrev_b32_e64 v138, 16, v139
v_and_b32 v139, 4294901760, v139
v_add_f32_dpp v243, v243, v243 row_ror:2 row_mask:0xf bank_mask:0xf
v_mul_f32 v128, v128, v134
v_mul_f32 v129, v129, v135
v_add_f32_dpp v243, v243, v243 row_ror:1 row_mask:0xf bank_mask:0xf
v_mov_b32 v241, v243
v_mul_f32 v130, v130, v136
v_mul_f32 v131, v131, v137
v_permlane16_swap_b32 v243, v241
v_add_f32 v243, v243, v241
v_mov_b32 v241, v243
v_mul_f32 v132, v132, v138
v_mul_f32 v133, v133, v139
v_permlane32_swap_b32 v243, v241
v_add_f32 v243, v243, v241
v_mov_b32 v242, 3036348137
s_mov_b32 s43, 3131020332
v_fma_f32 v243, v243, s43, v242
v_rcp_f32_e64 v243, v243
s_mov_b32 s43, 3221808330
v_fma_f32 v128, v128, v243, s43
v_fma_f32 v129, v129, v243, s43
v_fma_f32 v130, v130, v243, s43
v_fma_f32 v131, v131, v243, s43
v_fma_f32 v132, v132, v243, s43
v_fma_f32 v133, v133, v243, s43
v_cvt_pk_f16_f32 v128, v128, v129
v_cvt_pk_f16_f32 v129, v130, v131
v_cvt_pk_f16_f32 v130, v132, v133
s_mov_b32 s77, 0
s_nop 1
s_setpc_b64 s[78:79]
Lend:
s_endpgm

.section .rodata,"a"
.p2align 6
.amdhsa_kernel standalone__modern_conv_block_convnext_v2__vision_kernel
  .amdhsa_next_free_vgpr 256
  .amdhsa_next_free_sgpr 102
  .amdhsa_accum_offset 256
  .amdhsa_group_segment_fixed_size 0
  .amdhsa_kernarg_size 72
  .amdhsa_user_sgpr_count 2
  .amdhsa_user_sgpr_kernarg_segment_ptr 1
  .amdhsa_system_sgpr_workgroup_id_x 1
.end_amdhsa_kernel
```

```asm
; @launch grid=(256,1,1) block=(512,1,1) lds=163840
.amdgcn_target "amdgcn-amd-amdhsa--gfx950"
.text
.globl standalone__modern_conv_block_convnext_v2__vision_kernel
.p2align 8
.type standalone__modern_conv_block_convnext_v2__vision_kernel,@function
standalone__modern_conv_block_convnext_v2__vision_kernel:
s_cmp_ge_u32 s2, 256
s_cbranch_scc1 Lend
s_load_dwordx16 s[80:95], s[0:1], 0
s_load_dwordx2 s[96:97], s[0:1], 64
v_mov_b32 v119, v0
v_and_b32 v118, 63, v0
v_lshrrev_b32 v120, 6, v0
s_nop 0
v_readfirstlane_b32 s40, v120
s_getpc_b64 s[74:75]
Lpc:
s_lshr_b32 s43, s2, 3
s_and_b32 s43, s43, 15
s_lshl_b32 s43, s43, 13
v_lshrrev_b32_e64 v122, 3, v0
v_lshl_add_u32 v122, v122, 7, s43
v_min_u32 v122, Lend-Lpc, v122
global_load_dword v112, v122, s[74:75]
s_and_b32 s43, s2, 7
s_lshr_b32 s44, s2, 3
s_and_b32 s41, s43, 3
s_lshl_b32 s41, s41, 2
s_and_b32 s45, s44, 3
s_add_u32 s41, s41, s45
s_lshr_b32 s42, s43, 2
s_lshl_b32 s42, s42, 3
s_lshr_b32 s45, s44, 2
s_add_u32 s42, s42, s45
s_lshl_b32 s41, s41, 5
s_lshl_b32 s42, s42, 5
s_and_b32 s43, s40, 3
s_mul_i32 s43, s43, 1536
s_add_u32 s67, s43, 90112
s_mul_i32 s44, s41, 192
s_add_u32 s43, s43, s44
s_sub_u32 s43, s43, 192
v_lshl_add_u32 v121, v118, 4, s43
v_add_u32 v123, 896, v121
v_mov_b32 v122, 2147483648
s_mov_b32 s44, 98304
v_cmp_gt_u32 vcc, s44, v121
s_nop 1
v_cndmask_b32 v236, v122, v121, vcc
v_cmp_gt_u32 vcc, s44, v123
s_nop 1
v_cndmask_b32 v237, v122, v123, vcc
s_mul_i32 s66, s42, 98304
v_min_u32 v128, 215, v119
v_lshlrev_b32_e64 v130, 3, v128
v_lshlrev_b32 v250, 4, v118
s_waitcnt lgkmcnt(0)
s_mov_b32 s4, s80
s_and_b32 s5, s81, 65535
s_mov_b32 s6, 50331648
s_mov_b32 s7, 131072
s_cmp_ge_u32 s40, 4
s_cbranch_scc1 Lrowb
s_mov_b32 s20, s82
s_and_b32 s21, s83, 65535
s_mov_b32 s22, 1728
s_mov_b32 s23, 131072
buffer_load_dwordx2 v[126:127], v130, s[20:23], 0 offen
s_add_u32 m0, s67, 0
s_sub_u32 s45, s66, 98304
s_cmp_eq_u32 s42, 0
s_cselect_b32 s45, 1073741824, s45
buffer_load_dwordx4 v236, s[4:7], s45 offen lds
s_add_u32 m0, s67, 6592
s_nop 0
buffer_load_dwordx4 v236, s[4:7], s66 offen lds
s_add_u32 m0, s67, 13200
s_add_u32 s66, s66, 98304
buffer_load_dwordx4 v236, s[4:7], s66 offen lds
s_add_u32 m0, s67, 19792
s_add_u32 s66, s66, 98304
buffer_load_dwordx4 v236, s[4:7], s66 offen lds
s_add_u32 m0, s67, 26400
s_add_u32 s66, s66, 98304
buffer_load_dwordx4 v236, s[4:7], s66 offen lds
s_add_u32 m0, s67, 32992
s_add_u32 s66, s66, 98304
buffer_load_dwordx4 v236, s[4:7], s66 offen lds
s_add_u32 m0, s67, 39600
s_add_u32 s66, s66, 98304
buffer_load_dwordx4 v236, s[4:7], s66 offen lds
s_add_u32 m0, s67, 46192
s_add_u32 s66, s66, 98304
buffer_load_dwordx4 v236, s[4:7], s66 offen lds
s_add_u32 m0, s67, 52736
s_add_u32 s66, s66, 98304
buffer_load_dwordx4 v236, s[4:7], s66 offen lds
s_add_u32 m0, s67, 59328
s_add_u32 s66, s66, 98304
buffer_load_dwordx4 v236, s[4:7], s66 offen lds
s_branch Lsetup
Lrowb:
s_add_u32 m0, s67, 896
s_sub_u32 s45, s66, 98304
s_cmp_eq_u32 s42, 0
s_cselect_b32 s45, 1073741824, s45
buffer_load_dwordx4 v237, s[4:7], s45 offen lds
s_add_u32 m0, s67, 7488
s_nop 0
buffer_load_dwordx4 v237, s[4:7], s66 offen lds
s_add_u32 m0, s67, 14096
s_add_u32 s66, s66, 98304
buffer_load_dwordx4 v237, s[4:7], s66 offen lds
s_add_u32 m0, s67, 20688
s_add_u32 s66, s66, 98304
buffer_load_dwordx4 v237, s[4:7], s66 offen lds
s_add_u32 m0, s67, 27296
s_add_u32 s66, s66, 98304
buffer_load_dwordx4 v237, s[4:7], s66 offen lds
s_add_u32 m0, s67, 33888
s_add_u32 s66, s66, 98304
buffer_load_dwordx4 v237, s[4:7], s66 offen lds
s_add_u32 m0, s67, 40496
s_add_u32 s66, s66, 98304
buffer_load_dwordx4 v237, s[4:7], s66 offen lds
s_add_u32 m0, s67, 47088
s_add_u32 s66, s66, 98304
buffer_load_dwordx4 v237, s[4:7], s66 offen lds
s_add_u32 m0, s67, 53632
s_add_u32 s66, s66, 98304
buffer_load_dwordx4 v237, s[4:7], s66 offen lds
s_add_u32 m0, s67, 60224
s_add_u32 s66, s66, 98304
buffer_load_dwordx4 v237, s[4:7], s66 offen lds
s_mov_b32 s12, s84
s_and_b32 s13, s85, 65535
s_mov_b32 s14, 73728
s_mov_b32 s15, 131072
v_lshrrev_b32 v115, 2, v118
v_mul_u32_u24 v115, 768, v115
v_and_b32_e64 v125, 3, v118
v_lshl_add_u32 v115, v125, 4, v115
s_and_b32 s43, s40, 3
s_add_u32 s43, s43, 0
s_mul_i32 s44, s43, 43
s_lshr_b32 s44, s44, 8
s_lshl_b32 s46, s43, 10
s_add_u32 m0, s46, 16384
s_mul_i32 s46, s44, 6
s_sub_u32 s43, s43, s46
s_mul_i32 s43, s43, 12288
s_lshl_b32 s44, s44, 6
s_add_u32 s43, s43, s44
buffer_load_dwordx4 v115, s[12:15], s43 offen lds
s_and_b32 s43, s40, 3
s_add_u32 s43, s43, 4
s_mul_i32 s44, s43, 43
s_lshr_b32 s44, s44, 8
s_lshl_b32 s46, s43, 10
s_add_u32 m0, s46, 16384
s_mul_i32 s46, s44, 6
s_sub_u32 s43, s43, s46
s_mul_i32 s43, s43, 12288
s_lshl_b32 s44, s44, 6
s_add_u32 s43, s43, s44
buffer_load_dwordx4 v115, s[12:15], s43 offen lds
s_and_b32 s43, s40, 3
s_add_u32 s43, s43, 8
s_mul_i32 s44, s43, 43
s_lshr_b32 s44, s44, 8
s_lshl_b32 s46, s43, 10
s_add_u32 m0, s46, 16384
s_mul_i32 s46, s44, 6
s_sub_u32 s43, s43, s46
s_mul_i32 s43, s43, 12288
s_lshl_b32 s44, s44, 6
s_add_u32 s43, s43, s44
buffer_load_dwordx4 v115, s[12:15], s43 offen lds
s_and_b32 s43, s40, 3
s_add_u32 s43, s43, 12
s_mul_i32 s44, s43, 43
s_lshr_b32 s44, s44, 8
s_lshl_b32 s46, s43, 10
s_add_u32 m0, s46, 16384
s_mul_i32 s46, s44, 6
s_sub_u32 s43, s43, s46
s_mul_i32 s43, s43, 12288
s_lshl_b32 s44, s44, 6
s_add_u32 s43, s43, s44
buffer_load_dwordx4 v115, s[12:15], s43 offen lds
s_and_b32 s43, s40, 3
s_add_u32 s43, s43, 16
s_mul_i32 s44, s43, 43
s_lshr_b32 s44, s44, 8
s_lshl_b32 s46, s43, 10
s_add_u32 m0, s46, 16384
s_mul_i32 s46, s44, 6
s_sub_u32 s43, s43, s46
s_mul_i32 s43, s43, 12288
s_lshl_b32 s44, s44, 6
s_add_u32 s43, s43, s44
buffer_load_dwordx4 v115, s[12:15], s43 offen lds
s_and_b32 s43, s40, 3
s_add_u32 s43, s43, 20
s_mul_i32 s44, s43, 43
s_lshr_b32 s44, s44, 8
s_lshl_b32 s46, s43, 10
s_add_u32 m0, s46, 16384
s_mul_i32 s46, s44, 6
s_sub_u32 s43, s43, s46
s_mul_i32 s43, s43, 12288
s_lshl_b32 s44, s44, 6
s_add_u32 s43, s43, s44
buffer_load_dwordx4 v115, s[12:15], s43 offen lds
v_bfe_u32 v141, v250, 4, 6
v_and_b32 v140, 15, v141
v_lshlrev_b32 v140, 7, v140
v_lshrrev_b32 v141, 4, v141
v_mul_u32_u24 v141, 98304, v141
s_sub_u32 s43, s67, -8000
s_mul_i32 s44, s41, 192
s_add_u32 s43, s43, s44
v_add3_u32 v140, v140, v141, s43
s_mov_b32 m0, 163840
s_add_u32 s44, s66, 393216
buffer_load_dword v140, s[4:7], s66 offen lds
buffer_load_dword v140, s[4:7], s44 offen lds
s_waitcnt vmcnt(8)
s_barrier
s_setprio 0
s_and_b32 s43, s40, 3
s_add_u32 s43, s43, 24
s_mul_i32 s44, s43, 43
s_lshr_b32 s44, s44, 8
s_lshl_b32 s46, s43, 10
s_add_u32 m0, s46, 16384
s_mul_i32 s46, s44, 6
s_sub_u32 s43, s43, s46
s_mul_i32 s43, s43, 12288
s_lshl_b32 s44, s44, 6
s_add_u32 s43, s43, s44
buffer_load_dwordx4 v115, s[12:15], s43 offen lds
s_and_b32 s43, s40, 3
s_add_u32 s43, s43, 28
s_mul_i32 s44, s43, 43
s_lshr_b32 s44, s44, 8
s_lshl_b32 s46, s43, 10
s_add_u32 m0, s46, 16384
s_mul_i32 s46, s44, 6
s_sub_u32 s43, s43, s46
s_mul_i32 s43, s43, 12288
s_lshl_b32 s44, s44, 6
s_add_u32 s43, s43, s44
buffer_load_dwordx4 v115, s[12:15], s43 offen lds
s_and_b32 s43, s40, 3
s_add_u32 s43, s43, 32
s_mul_i32 s44, s43, 43
s_lshr_b32 s44, s44, 8
s_lshl_b32 s46, s43, 10
s_add_u32 m0, s46, 16384
s_mul_i32 s46, s44, 6
s_sub_u32 s43, s43, s46
s_mul_i32 s43, s43, 12288
s_lshl_b32 s44, s44, 6
s_add_u32 s43, s43, s44
buffer_load_dwordx4 v115, s[12:15], s43 offen lds
s_and_b32 s43, s40, 3
s_add_u32 s43, s43, 36
s_mul_i32 s44, s43, 43
s_lshr_b32 s44, s44, 8
s_lshl_b32 s46, s43, 10
s_add_u32 m0, s46, 16384
s_mul_i32 s46, s44, 6
s_sub_u32 s43, s43, s46
s_mul_i32 s43, s43, 12288
s_lshl_b32 s44, s44, 6
s_add_u32 s43, s43, s44
buffer_load_dwordx4 v115, s[12:15], s43 offen lds
s_and_b32 s43, s40, 3
s_add_u32 s43, s43, 40
s_mul_i32 s44, s43, 43
s_lshr_b32 s44, s44, 8
s_lshl_b32 s46, s43, 10
s_add_u32 m0, s46, 16384
s_mul_i32 s46, s44, 6
s_sub_u32 s43, s43, s46
s_mul_i32 s43, s43, 12288
s_lshl_b32 s44, s44, 6
s_add_u32 s43, s43, s44
buffer_load_dwordx4 v115, s[12:15], s43 offen lds
s_and_b32 s43, s40, 3
s_add_u32 s43, s43, 44
s_mul_i32 s44, s43, 43
s_lshr_b32 s44, s44, 8
s_lshl_b32 s46, s43, 10
s_add_u32 m0, s46, 16384
s_mul_i32 s46, s44, 6
s_sub_u32 s43, s43, s46
s_mul_i32 s43, s43, 12288
s_lshl_b32 s44, s44, 6
s_add_u32 s43, s43, s44
buffer_load_dwordx4 v115, s[12:15], s43 offen lds
s_and_b32 s43, s40, 3
s_add_u32 s43, s43, 48
s_mul_i32 s44, s43, 43
s_lshr_b32 s44, s44, 8
s_lshl_b32 s46, s43, 10
s_add_u32 m0, s46, 16384
s_mul_i32 s46, s44, 6
s_sub_u32 s43, s43, s46
s_mul_i32 s43, s43, 12288
s_lshl_b32 s44, s44, 6
s_add_u32 s43, s43, s44
buffer_load_dwordx4 v115, s[12:15], s43 offen lds
s_and_b32 s43, s40, 3
s_add_u32 s43, s43, 52
s_mul_i32 s44, s43, 43
s_lshr_b32 s44, s44, 8
s_lshl_b32 s46, s43, 10
s_add_u32 m0, s46, 16384
s_mul_i32 s46, s44, 6
s_sub_u32 s43, s43, s46
s_mul_i32 s43, s43, 12288
s_lshl_b32 s44, s44, 6
s_add_u32 s43, s43, s44
buffer_load_dwordx4 v115, s[12:15], s43 offen lds
s_and_b32 s43, s40, 3
s_add_u32 s43, s43, 56
s_mul_i32 s44, s43, 43
s_lshr_b32 s44, s44, 8
s_lshl_b32 s46, s43, 10
s_add_u32 m0, s46, 16384
s_mul_i32 s46, s44, 6
s_sub_u32 s43, s43, s46
s_mul_i32 s43, s43, 12288
s_lshl_b32 s44, s44, 6
s_add_u32 s43, s43, s44
buffer_load_dwordx4 v115, s[12:15], s43 offen lds
s_and_b32 s43, s40, 3
s_add_u32 s43, s43, 60
s_mul_i32 s44, s43, 43
s_lshr_b32 s44, s44, 8
s_lshl_b32 s46, s43, 10
s_add_u32 m0, s46, 16384
s_mul_i32 s46, s44, 6
s_sub_u32 s43, s43, s46
s_mul_i32 s43, s43, 12288
s_lshl_b32 s44, s44, 6
s_add_u32 s43, s43, s44
buffer_load_dwordx4 v115, s[12:15], s43 offen lds
s_and_b32 s43, s40, 3
s_add_u32 s43, s43, 64
s_mul_i32 s44, s43, 43
s_lshr_b32 s44, s44, 8
s_lshl_b32 s46, s43, 10
s_add_u32 m0, s46, 16384
s_mul_i32 s46, s44, 6
s_sub_u32 s43, s43, s46
s_mul_i32 s43, s43, 12288
s_lshl_b32 s44, s44, 6
s_add_u32 s43, s43, s44
buffer_load_dwordx4 v115, s[12:15], s43 offen lds
s_and_b32 s43, s40, 3
s_add_u32 s43, s43, 68
s_mul_i32 s44, s43, 43
s_lshr_b32 s44, s44, 8
s_lshl_b32 s46, s43, 10
s_add_u32 m0, s46, 16384
s_mul_i32 s46, s44, 6
s_sub_u32 s43, s43, s46
s_mul_i32 s43, s43, 12288
s_lshl_b32 s44, s44, 6
s_add_u32 s43, s43, s44
buffer_load_dwordx4 v115, s[12:15], s43 offen lds
Lsetup:
s_mov_b32 s16, s86
s_and_b32 s17, s87, 65535
s_mov_b32 s18, 73728
s_mov_b32 s19, 131072
s_mov_b32 s24, s88
s_and_b32 s25, s89, 65535
s_mov_b32 s26, 768
s_mov_b32 s27, 131072
s_mov_b32 s28, s90
s_and_b32 s29, s91, 65535
s_mov_b32 s30, 768
s_mov_b32 s31, 131072
s_mov_b32 s8, s92
s_and_b32 s9, s93, 65535
s_mov_b32 s10, 50331648
s_mov_b32 s11, 131072
s_mov_b32 s36, s94
s_and_b32 s37, s95, 65535
s_mov_b32 s38, 256
s_mov_b32 s39, 131072
s_mov_b32 s32, s96
s_and_b32 s33, s97, 65535
s_mov_b32 s34, 83886080
s_mov_b32 s35, 131072
v_lshlrev_b32_e64 v250, 4, v118
v_add_u32 v250, 16384, v250
v_lshlrev_b32_e64 v251, 4, v118
v_add_u32 v251, 81920, v251
v_lshlrev_b32_e64 v252, 4, v118
v_add_u32 v252, 147456, v252
s_lshl_b32 s73, s2, 3
s_add_u32 s73, s73, s40
s_lshl_b32 s80, s73, 10
s_add_u32 s80, s80, 4177920
s_mul_i32 s73, s73, 16
s_add_u32 s73, s73, 1048576
s_mov_b32 s48, 1156203754
s_mov_b32 s49, 4294508536
s_mov_b32 s47, 16382
v_and_b32 v131, 15, v118
v_lshrrev_b32 v132, 4, v118
v_and_b32_e64 v133, 3, v131
v_mul_u32_u24 v134, 13200, v133
v_lshrrev_b32_e64 v133, 2, v131
v_lshl_add_u32 v133, v133, 1, v132
v_mul_u32_u24 v133, 192, v133
s_sub_u32 s43, s67, 90112
v_add3_u32 v246, v133, v134, s43
v_bfe_u32 v133, v131, 2, 1
v_sub_u32 v133, v132, v133
v_lshrrev_b32 v134, 3, v131
v_and_b32_e64 v135, 3, v131
v_lshl_add_u32 v135, v134, 2, v135
v_lshlrev_b32_e64 v136, 6, v133
v_lshl_add_u32 v136, v135, 3, v136
v_add_u32 v136, 156040, v136
v_mov_b32 v137, 156032
v_cmp_gt_u32 vcc, 3, v133
s_nop 1
v_cndmask_b32 v136, v137, v136, vcc
v_cmp_eq_u32 vcc, 0, v134
s_nop 1
v_cndmask_b32 v238, v137, v136, vcc
v_cndmask_b32 v239, v136, v137, vcc
v_lshrrev_b32 v133, 2, v131
v_bfe_u32 v135, v131, 1, 1
v_cmp_eq_u32 vcc, v133, v132
s_nop 1
v_cndmask_b32 v135, 8, v135, vcc
v_cmp_eq_u32 s[88:89], 0, v135
v_cmp_eq_u32 s[90:91], 1, v135
v_lshlrev_b32 v254, 5, v132
v_add_u32 v254, 7936, v254
v_lshlrev_b32 v253, 4, v132
v_and_b32 v131, 31, v118
v_lshrrev_b32_e64 v132, 5, v118
v_bfe_u32 v133, v131, 2, 1
v_bfe_u32 v134, v131, 3, 1
v_bfe_u32 v135, v131, 1, 1
v_lshrrev_b32 v136, 4, v131
v_lshl_add_u32 v135, v136, 1, v135
v_lshl_add_u32 v135, v134, 2, v135
v_cmp_eq_u32 vcc, v133, v132
s_nop 1
v_cndmask_b32 v135, 8, v135, vcc
v_cmp_eq_u32 s[50:51], 0, v135
v_cmp_eq_u32 s[52:53], 1, v135
v_cmp_eq_u32 s[54:55], 2, v135
v_cmp_eq_u32 s[56:57], 3, v135
v_cmp_eq_u32 s[58:59], 4, v135
v_cmp_eq_u32 s[60:61], 5, v135
v_cmp_eq_u32 s[62:63], 6, v135
v_cmp_eq_u32 s[64:65], 7, v135
v_and_b32 v136, 1, v131
v_lshlrev_b32 v136, 4, v136
v_mov_b32 v255, 16256
v_lshlrev_b32 v255, v136, v255
v_and_b32 v137, 19, v131
v_lshl_add_u32 v137, v133, 3, v137
v_lshl_add_u32 v137, v134, 2, v137
v_lshlrev_b32_e64 v137, 2, v137
v_lshl_add_u32 v137, v132, 7, v137
s_mul_i32 s82, s40, 9216
s_add_u32 s72, s82, 90112
v_add_u32 v248, s72, v137
v_and_b32 v133, 3, v118
v_mul_u32_u24 v134, 196608, v133
v_bfe_u32 v133, v118, 2, 2
v_mul_u32_u24 v133, 384, v133
v_add3_u32 v253, v253, v133, v134
s_mul_i32 s46, s41, 192
s_add_u32 s46, s46, s67
s_sub_u32 s46, s46, 90112
s_and_b32 s83, s40, 4
s_lshl_b32 s44, s83, 1
s_add_u32 s44, s44, s42
s_add_u32 s43, s44, 0
s_mul_i32 s43, s43, 98304
s_add_u32 s68, s43, s46
s_add_u32 s43, s44, 1
s_mul_i32 s43, s43, 98304
s_add_u32 s69, s43, s46
s_add_u32 s43, s44, 16
s_mul_i32 s43, s43, 98304
s_add_u32 s70, s43, s46
s_add_u32 s43, s44, 17
s_mul_i32 s43, s43, 98304
s_add_u32 s71, s43, s46
s_mov_b32 s92, 2863311530
s_mov_b32 s94, 3435973836
s_mov_b32 s93, 2863311530
s_mov_b32 s95, 3435973836
s_mov_b32 s81, 59328
s_mov_b32 s76, 200000
v_mov_b32 v247, 8128
v_lshrrev_b32 v148, 5, v118
v_lshlrev_b32 v116, 8, v148
v_bfe_u32 v148, v118, 2, 2
v_lshl_add_u32 v116, v148, 6, v116
v_bfe_u32 v148, v118, 4, 1
v_lshl_add_u32 v116, v148, 5, v116
v_and_b32_e64 v148, 1, v118
v_lshl_add_u32 v116, v148, 4, v116
v_bfe_u32 v148, v118, 1, 1
v_lshl_add_u32 v116, v148, 3, v116
s_and_b32 s43, s40, 3
s_lshl_b32 s43, s43, 10
v_add_u32_e64 v117, s43, v250
s_add_u32 s43, s43, 16384
v_add_u32 v116, s43, v116
v_mov_b32 v224, 0
v_mov_b32 v225, 0
v_mov_b32 v226, 0
v_mov_b32 v227, 0
v_mov_b32 v228, 0
v_mov_b32 v229, 0
v_mov_b32 v230, 0
v_mov_b32 v231, 0
v_mov_b32 v232, 0
v_mov_b32 v233, 0
v_mov_b32 v234, 0
v_mov_b32 v235, 0
s_cmp_ge_u32 s40, 4
s_cbranch_scc1 Lwa
v_mov_b32 v65, 0
v_mov_b32 v67, 0
v_mov_b32 v68, 0
v_mov_b32 v70, 0
v_mov_b32 v72, 0
v_mov_b32 v73, 0
v_min_u32 v140, 35, v119
v_mul_u32_u24 v140, 200, v140
v_add_u32 v140, 156032, v140
v_and_b32 v141, 31, v119
v_lshlrev_b32 v141, 3, v141
v_bfe_u32 v142, v119, 5, 1
v_lshl_add_u32 v141, v142, 13, v141
v_add_u32 v141, 7936, v141
v_cmp_gt_u32 vcc, 64, v119
s_nop 1
v_cndmask_b32 v140, v141, v140, vcc
ds_write_b64 v140, v[72:73]
v_lshrrev_b32 v140, 1, v128
v_mul_u32_u24 v141, 57, v140
v_lshrrev_b32 v141, 11, v141
v_mul_u32_u24 v142, 171, v140
v_lshrrev_b32_e64 v142, 11, v142
v_mul_u32_u24 v140, 200, v140
v_mul_u32_u24 v142, 2336, v142
v_mul_u32_u24 v141, 2208, v141
v_sub_u32 v140, v140, v142
v_add_u32 v140, v140, v141
v_and_b32_e64 v141, 1, v128
v_lshl_add_u32 v140, v141, 5, v140
v_add_u32 v140, 156040, v140
v_and_b32 v120, 255, v119
v_lshlrev_b32 v121, 8, v120
v_add_u32 v0, 4, v121
v_cvt_f32_f16 v0, v0
v_add_u32 v1, 12, v121
v_cvt_f32_f16 v1, v1
v_add_u32 v2, 20, v121
v_cvt_f32_f16 v2, v2
v_add_u32 v3, 28, v121
v_cvt_f32_f16 v3, v3
v_add_u32 v4, 36, v121
v_cvt_f32_f16 v4, v4
v_add_u32 v5, 44, v121
v_cvt_f32_f16 v5, v5
v_add_u32 v6, 52, v121
v_cvt_f32_f16 v6, v6
v_add_u32 v7, 60, v121
v_cvt_f32_f16_e64 v7, v7
v_add_u32 v8, 68, v121
v_cvt_f32_f16_e64 v8, v8
v_add_u32 v9, 76, v121
v_cvt_f32_f16_e64 v9, v9
v_add_u32 v10, 84, v121
v_cvt_f32_f16_e64 v10, v10
v_add_u32 v11, 92, v121
v_cvt_f32_f16_e64 v11, v11
v_add_u32 v12, 100, v121
v_cvt_f32_f16_e64 v12, v12
v_add_u32 v13, 108, v121
v_cvt_f32_f16_e64 v13, v13
v_add_u32 v14, 116, v121
v_cvt_f32_f16_e64 v14, v14
v_add_u32 v15, 124, v121
v_cvt_f32_f16_e64 v15, v15
v_add_u32 v16, 132, v121
v_cvt_f32_f16_e64 v16, v16
v_add_u32 v17, 140, v121
v_cvt_f32_f16_e64 v17, v17
v_add_u32 v18, 148, v121
v_cvt_f32_f16_e64 v18, v18
v_add_u32 v19, 156, v121
v_cvt_f32_f16_e64 v19, v19
v_add_u32 v20, 164, v121
v_cvt_f32_f16_e64 v20, v20
v_add_u32 v21, 172, v121
v_cvt_f32_f16_e64 v21, v21
v_add_u32 v22, 180, v121
v_cvt_f32_f16_e64 v22, v22
v_add_u32 v23, 188, v121
v_cvt_f32_f16_e64 v23, v23
v_add_u32 v24, 196, v121
v_cvt_f32_f16_e64 v24, v24
v_add_u32 v25, 204, v121
v_cvt_f32_f16_e64 v25, v25
v_add_u32 v26, 212, v121
v_cvt_f32_f16_e64 v26, v26
v_add_u32 v27, 220, v121
v_cvt_f32_f16_e64 v27, v27
v_add_u32 v28, 228, v121
v_cvt_f32_f16_e64 v28, v28
v_add_u32 v29, 236, v121
v_cvt_f32_f16_e64 v29, v29
v_add_u32 v30, 244, v121
v_cvt_f32_f16_e64 v30, v30
v_add_u32 v31, 252, v121
v_cvt_f32_f16_e64 v31, v31
v_fmaak_f32 v32, v0, v0, 0x409d30fc
v_mul_f32_e64 v32, v0, v32
v_fmaak_f32 v33, v1, v1, 0x409d30fc
v_mul_f32_e64 v33, v1, v33
v_fmaak_f32 v34, v2, v2, 0x409d30fc
v_mul_f32_e64 v34, v2, v34
v_fmaak_f32 v35, v3, v3, 0x409d30fc
v_mul_f32_e64 v35, v3, v35
v_fmaak_f32 v36, v4, v4, 0x409d30fc
v_mul_f32_e64 v36, v4, v36
v_fmaak_f32 v37, v5, v5, 0x409d30fc
v_mul_f32_e64 v37, v5, v37
v_fmaak_f32 v38, v6, v6, 0x409d30fc
v_mul_f32_e64 v38, v6, v38
v_fmaak_f32 v39, v7, v7, 0x409d30fc
v_mul_f32_e64 v39, v7, v39
v_fmaak_f32 v40, v8, v8, 0x409d30fc
v_mul_f32_e64 v40, v8, v40
v_fmaak_f32 v41, v9, v9, 0x409d30fc
v_mul_f32_e64 v41, v9, v41
v_fmaak_f32 v42, v10, v10, 0x409d30fc
v_mul_f32_e64 v42, v10, v42
v_fmaak_f32 v43, v11, v11, 0x409d30fc
v_mul_f32_e64 v43, v11, v43
v_fmaak_f32 v44, v12, v12, 0x409d30fc
v_mul_f32_e64 v44, v12, v44
v_fmaak_f32 v45, v13, v13, 0x409d30fc
v_mul_f32_e64 v45, v13, v45
v_fmaak_f32 v46, v14, v14, 0x409d30fc
v_mul_f32_e64 v46, v14, v46
v_fmaak_f32 v47, v15, v15, 0x409d30fc
v_mul_f32_e64 v47, v15, v47
v_fmaak_f32 v48, v16, v16, 0x409d30fc
v_mul_f32_e64 v48, v16, v48
v_fmaak_f32 v49, v17, v17, 0x409d30fc
v_mul_f32_e64 v49, v17, v49
v_fmaak_f32 v50, v18, v18, 0x409d30fc
v_mul_f32_e64 v50, v18, v50
v_fmaak_f32 v51, v19, v19, 0x409d30fc
v_mul_f32_e64 v51, v19, v51
v_fmaak_f32 v52, v20, v20, 0x409d30fc
v_mul_f32_e64 v52, v20, v52
v_fmaak_f32 v53, v21, v21, 0x409d30fc
v_mul_f32_e64 v53, v21, v53
v_fmaak_f32 v54, v22, v22, 0x409d30fc
v_mul_f32_e64 v54, v22, v54
v_fmaak_f32 v55, v23, v23, 0x409d30fc
v_mul_f32_e64 v55, v23, v55
v_fmaak_f32 v56, v24, v24, 0x409d30fc
v_mul_f32_e64 v56, v24, v56
v_fmaak_f32 v57, v25, v25, 0x409d30fc
v_mul_f32_e64 v57, v25, v57
v_fmaak_f32 v58, v26, v26, 0x409d30fc
v_mul_f32_e64 v58, v26, v58
v_fmaak_f32 v59, v27, v27, 0x409d30fc
v_mul_f32_e64 v59, v27, v59
v_fmaak_f32 v60, v28, v28, 0x409d30fc
v_mul_f32_e64 v60, v28, v60
v_fmaak_f32 v61, v29, v29, 0x409d30fc
v_mul_f32_e64 v61, v29, v61
v_fmaak_f32 v62, v30, v30, 0x409d30fc
v_mul_f32_e64 v62, v30, v62
v_fmaak_f32 v63, v31, v31, 0x409d30fc
v_mul_f32 v63, v31, v63
v_exp_f32 v32, v32
v_exp_f32 v33, v33
v_exp_f32 v34, v34
v_exp_f32 v35, v35
v_exp_f32 v36, v36
v_exp_f32 v37, v37
v_exp_f32 v38, v38
v_exp_f32 v39, v39
v_exp_f32 v40, v40
v_exp_f32 v41, v41
v_exp_f32 v42, v42
v_exp_f32 v43, v43
v_exp_f32 v44, v44
v_exp_f32 v45, v45
v_exp_f32 v46, v46
v_exp_f32 v47, v47
v_exp_f32 v48, v48
v_exp_f32 v49, v49
v_exp_f32 v50, v50
v_exp_f32 v51, v51
v_exp_f32 v52, v52
v_exp_f32 v53, v53
v_exp_f32 v54, v54
v_exp_f32 v55, v55
v_exp_f32 v56, v56
v_exp_f32 v57, v57
v_exp_f32 v58, v58
v_exp_f32 v59, v59
v_exp_f32 v60, v60
v_exp_f32 v61, v61
v_exp_f32 v62, v62
v_exp_f32 v63, v63
v_add_f32 v32, 1.0, v32
v_add_f32 v33, 1.0, v33
v_add_f32 v34, 1.0, v34
v_add_f32 v35, 1.0, v35
v_add_f32 v36, 1.0, v36
v_add_f32 v37, 1.0, v37
v_add_f32 v38, 1.0, v38
v_add_f32 v39, 1.0, v39
v_add_f32 v40, 1.0, v40
v_add_f32 v41, 1.0, v41
v_add_f32 v42, 1.0, v42
v_add_f32 v43, 1.0, v43
v_add_f32 v44, 1.0, v44
v_add_f32 v45, 1.0, v45
v_add_f32 v46, 1.0, v46
v_add_f32 v47, 1.0, v47
v_add_f32 v48, 1.0, v48
v_add_f32 v49, 1.0, v49
v_add_f32 v50, 1.0, v50
v_add_f32 v51, 1.0, v51
v_add_f32 v52, 1.0, v52
v_add_f32 v53, 1.0, v53
v_add_f32 v54, 1.0, v54
v_add_f32 v55, 1.0, v55
v_add_f32 v56, 1.0, v56
v_add_f32 v57, 1.0, v57
v_add_f32 v58, 1.0, v58
v_add_f32 v59, 1.0, v59
v_add_f32 v60, 1.0, v60
v_add_f32 v61, 1.0, v61
v_add_f32 v62, 1.0, v62
v_add_f32 v63, 1.0, v63
v_rcp_f32 v32, v32
v_rcp_f32 v33, v33
v_rcp_f32 v34, v34
v_rcp_f32 v35, v35
v_rcp_f32 v36, v36
v_rcp_f32 v37, v37
v_rcp_f32 v38, v38
v_rcp_f32 v39, v39
v_rcp_f32 v40, v40
v_rcp_f32 v41, v41
v_rcp_f32 v42, v42
v_rcp_f32 v43, v43
v_rcp_f32 v44, v44
v_rcp_f32 v45, v45
v_rcp_f32 v46, v46
v_rcp_f32 v47, v47
v_rcp_f32 v48, v48
v_rcp_f32 v49, v49
v_rcp_f32 v50, v50
v_rcp_f32 v51, v51
v_rcp_f32 v52, v52
v_rcp_f32 v53, v53
v_rcp_f32 v54, v54
v_rcp_f32 v55, v55
v_rcp_f32 v56, v56
v_rcp_f32 v57, v57
v_rcp_f32 v58, v58
v_rcp_f32 v59, v59
v_rcp_f32 v60, v60
v_rcp_f32 v61, v61
v_rcp_f32 v62, v62
v_rcp_f32 v63, v63
v_mul_f32 v0, v0, v32
v_mul_f32 v1, v1, v33
v_mul_f32 v2, v2, v34
v_mul_f32 v3, v3, v35
v_mul_f32 v4, v4, v36
v_mul_f32 v5, v5, v37
v_mul_f32 v6, v6, v38
v_mul_f32 v7, v7, v39
v_mul_f32 v8, v8, v40
v_mul_f32 v9, v9, v41
v_mul_f32 v10, v10, v42
v_mul_f32 v11, v11, v43
v_mul_f32 v12, v12, v44
v_mul_f32 v13, v13, v45
v_mul_f32 v14, v14, v46
v_mul_f32 v15, v15, v47
v_mul_f32 v16, v16, v48
v_mul_f32 v17, v17, v49
v_mul_f32 v18, v18, v50
v_mul_f32 v19, v19, v51
v_mul_f32 v20, v20, v52
v_mul_f32 v21, v21, v53
v_mul_f32 v22, v22, v54
v_mul_f32 v23, v23, v55
v_mul_f32 v24, v24, v56
v_mul_f32 v25, v25, v57
v_mul_f32 v26, v26, v58
v_mul_f32 v27, v27, v59
v_mul_f32 v28, v28, v60
v_mul_f32 v29, v29, v61
v_mul_f32 v30, v30, v62
v_mul_f32_e64 v31, v31, v63
v_cvt_pk_f16_f32 v32, v0, v1
v_cvt_pk_f16_f32 v33, v2, v3
v_cvt_pk_f16_f32 v34, v4, v5
v_cvt_pk_f16_f32 v35, v6, v7
v_cvt_pk_f16_f32 v36, v8, v9
v_cvt_pk_f16_f32 v37, v10, v11
v_cvt_pk_f16_f32 v38, v12, v13
v_cvt_pk_f16_f32 v39, v14, v15
v_cvt_pk_f16_f32 v40, v16, v17
v_cvt_pk_f16_f32 v41, v18, v19
v_cvt_pk_f16_f32 v42, v20, v21
v_cvt_pk_f16_f32 v43, v22, v23
v_cvt_pk_f16_f32 v44, v24, v25
v_cvt_pk_f16_f32 v45, v26, v27
v_cvt_pk_f16_f32 v46, v28, v29
v_cvt_pk_f16_f32 v47, v30, v31
v_add_u32 v32, 131074, v32
v_and_b32 v32, 4294770684, v32
v_add_u32 v33, 131074, v33
v_and_b32 v33, 4294770684, v33
v_add_u32 v34, 131074, v34
v_and_b32 v34, 4294770684, v34
v_add_u32 v35, 131074, v35
v_and_b32 v35, 4294770684, v35
v_add_u32 v36, 131074, v36
v_and_b32 v36, 4294770684, v36
v_add_u32 v37, 131074, v37
v_and_b32 v37, 4294770684, v37
v_add_u32 v38, 131074, v38
v_and_b32 v38, 4294770684, v38
v_add_u32 v39, 131074, v39
v_and_b32 v39, 4294770684, v39
v_add_u32 v40, 131074, v40
v_and_b32 v40, 4294770684, v40
v_add_u32 v41, 131074, v41
v_and_b32 v41, 4294770684, v41
v_add_u32 v42, 131074, v42
v_and_b32 v42, 4294770684, v42
v_add_u32 v43, 131074, v43
v_and_b32 v43, 4294770684, v43
v_add_u32 v44, 131074, v44
v_and_b32 v44, 4294770684, v44
v_add_u32 v45, 131074, v45
v_and_b32 v45, 4294770684, v45
v_add_u32 v46, 131074, v46
v_and_b32 v46, 4294770684, v46
v_add_u32 v47, 131074, v47
v_and_b32 v47, 4294770684, v47
v_lshlrev_b32 v121, 6, v120
v_bfe_u32 v120, v120, 2, 5
v_cmp_ne_u32 vcc, 31, v120
s_and_saveexec_b64 s[74:75], vcc
ds_write_b128 v121, v[32:35]
ds_write_b128 v121, v[36:39] offset:16
ds_write_b128 v121, v[40:43] offset:32
ds_write_b128 v121, v[44:47] offset:48
s_mov_b64 exec, s[74:75]
s_waitcnt vmcnt(10)
v_and_b32 v64, 65535, v126
ds_write_b64 v140, v[64:65]
v_and_b32 v66, 4294901760, v126
ds_write_b64 v140, v[66:67] offset:8
v_and_b32 v69, 65535, v127
ds_write_b64 v140, v[68:69] offset:16
v_and_b32 v71, 4294901760, v127
ds_write_b64 v140, v[70:71] offset:24
s_waitcnt vmcnt(0) lgkmcnt(0)
s_barrier
Lwa:
s_cmp_lt_u32 s40, 4
s_cbranch_scc1 Lsu1
s_waitcnt vmcnt(14)
v_add_u32 v113, 65536, v116
v_add_u32 v114, 65536, v117
ds_read_b64_tr_b16 v[0:1], v116
ds_read_b64_tr_b16 v[2:3], v116 offset:512
ds_read_b64_tr_b16 v[4:5], v116 offset:4096
ds_read_b64_tr_b16 v[6:7], v116 offset:4608
ds_read_b64_tr_b16 v[8:9], v116 offset:8192
ds_read_b64_tr_b16 v[10:11], v116 offset:8704
ds_read_b64_tr_b16 v[12:13], v116 offset:12288
ds_read_b64_tr_b16 v[14:15], v116 offset:12800
ds_read_b64_tr_b16 v[16:17], v116 offset:16384
ds_read_b64_tr_b16 v[18:19], v116 offset:16896
ds_read_b64_tr_b16 v[20:21], v116 offset:20480
ds_read_b64_tr_b16 v[22:23], v116 offset:20992
s_waitcnt lgkmcnt(10)
ds_write_b128 v117, v[0:3]
s_waitcnt lgkmcnt(9)
ds_write_b128 v117, v[4:7] offset:4096
s_waitcnt lgkmcnt(8)
ds_write_b128 v117, v[8:11] offset:8192
s_waitcnt lgkmcnt(7)
ds_write_b128 v117, v[12:15] offset:12288
s_waitcnt lgkmcnt(6)
ds_write_b128 v117, v[16:19] offset:16384
s_waitcnt lgkmcnt(5)
ds_write_b128 v117, v[20:23] offset:20480
v_mov_b32_e64 v223, 1
s_waitcnt lgkmcnt(0)
s_mov_b64 exec, 1
ds_add_u32 v247, v223 offset:8
s_mov_b64 exec, -1
s_nop 0
v_mov_b32_e64 v223, 0
s_branch Law1
Lax1:
s_sleep 2
Law1:
ds_read_b32 v223, v247 offset:16
s_sub_u32 s76, s76, 1
s_cselect_b32 s44, 4, 0
s_cselect_b32 s76, 0, s76
s_waitcnt lgkmcnt(0)
v_readfirstlane_b32 s43, v223
s_nop 1
s_max_u32 s43, s43, s44
s_cmp_lt_u32 s43, 4
s_cbranch_scc1 Lax1
s_add_u32 s81, s81, 6592
s_cmp_eq_u32 s81, 65920
s_cselect_b32 s81, 0, s81
s_add_u32 s43, s81, s67
s_add_u32 m0, s43, 16
s_add_u32 s66, s66, 98304
buffer_load_dwordx4 v236, s[4:7], s66 offen lds
s_add_u32 m0, s43, 912
s_nop 0
buffer_load_dwordx4 v237, s[4:7], s66 offen lds
s_add_u32 s81, s81, 6592
s_cmp_eq_u32 s81, 65920
s_cselect_b32 s81, 0, s81
s_add_u32 s43, s81, s67
s_add_u32 m0, s43, 16
s_add_u32 s66, s66, 98304
buffer_load_dwordx4 v236, s[4:7], s66 offen lds
s_add_u32 m0, s43, 912
s_nop 0
buffer_load_dwordx4 v237, s[4:7], s66 offen lds
s_add_u32 s81, s81, 6592
s_cmp_eq_u32 s81, 65920
s_cselect_b32 s81, 0, s81
s_add_u32 s43, s81, s67
s_add_u32 m0, s43, 32
s_add_u32 s66, s66, 98304
buffer_load_dwordx4 v236, s[4:7], s66 offen lds
s_add_u32 m0, s43, 928
s_nop 0
buffer_load_dwordx4 v237, s[4:7], s66 offen lds
s_add_u32 s81, s81, 6592
s_cmp_eq_u32 s81, 65920
s_cselect_b32 s81, 0, s81
s_add_u32 s43, s81, s67
s_add_u32 m0, s43, 32
s_add_u32 s66, s66, 98304
buffer_load_dwordx4 v236, s[4:7], s66 offen lds
s_add_u32 m0, s43, 928
s_nop 0
buffer_load_dwordx4 v237, s[4:7], s66 offen lds
s_add_u32 s81, s81, 6592
s_cmp_eq_u32 s81, 65920
s_cselect_b32 s81, 0, s81
s_add_u32 s43, s81, s67
s_add_u32 m0, s43, 48
s_add_u32 s66, s66, 98304
buffer_load_dwordx4 v236, s[4:7], s66 offen lds
s_add_u32 m0, s43, 944
s_nop 0
buffer_load_dwordx4 v237, s[4:7], s66 offen lds
s_add_u32 s81, s81, 6592
s_cmp_eq_u32 s81, 65920
s_cselect_b32 s81, 0, s81
s_add_u32 s43, s81, s67
s_add_u32 m0, s43, 48
s_add_u32 s66, s66, 98304
buffer_load_dwordx4 v236, s[4:7], s66 offen lds
s_add_u32 m0, s43, 944
s_nop 0
buffer_load_dwordx4 v237, s[4:7], s66 offen lds
s_add_u32 s81, s81, 6592
s_cmp_eq_u32 s81, 65920
s_cselect_b32 s81, 0, s81
s_add_u32 s43, s81, s67
s_add_u32 m0, s43, 0
s_add_u32 s66, s66, 98304
buffer_load_dwordx4 v236, s[4:7], s66 offen lds
s_add_u32 m0, s43, 896
s_nop 0
buffer_load_dwordx4 v237, s[4:7], s66 offen lds
s_add_u32 s81, s81, 6592
s_cmp_eq_u32 s81, 65920
s_cselect_b32 s81, 0, s81
s_add_u32 s43, s81, s67
s_add_u32 m0, s43, 0
s_add_u32 s66, s66, 98304
buffer_load_dwordx4 v236, s[4:7], s66 offen lds
s_add_u32 m0, s43, 896
s_nop 0
buffer_load_dwordx4 v237, s[4:7], s66 offen lds
s_waitcnt vmcnt(16)
v_add_u32 v113, 65536, v116
v_add_u32 v114, 65536, v117
ds_read_b64_tr_b16 v[0:1], v116 offset:24576
ds_read_b64_tr_b16 v[2:3], v116 offset:25088
ds_read_b64_tr_b16 v[4:5], v116 offset:28672
ds_read_b64_tr_b16 v[6:7], v116 offset:29184
ds_read_b64_tr_b16 v[8:9], v116 offset:32768
ds_read_b64_tr_b16 v[10:11], v116 offset:33280
ds_read_b64_tr_b16 v[12:13], v116 offset:36864
ds_read_b64_tr_b16 v[14:15], v116 offset:37376
ds_read_b64_tr_b16 v[16:17], v116 offset:40960
ds_read_b64_tr_b16 v[18:19], v116 offset:41472
ds_read_b64_tr_b16 v[20:21], v116 offset:45056
ds_read_b64_tr_b16 v[22:23], v116 offset:45568
ds_read_b64_tr_b16 v[24:25], v116 offset:49152
ds_read_b64_tr_b16 v[26:27], v116 offset:49664
ds_read_b64_tr_b16 v[28:29], v116 offset:53248
s_waitcnt lgkmcnt(14)
ds_read_b64_tr_b16 v[30:31], v116 offset:53760
s_waitcnt lgkmcnt(14)
ds_read_b64_tr_b16 v[32:33], v116 offset:57344
s_waitcnt lgkmcnt(14)
ds_read_b64_tr_b16 v[34:35], v116 offset:57856
s_waitcnt lgkmcnt(14)
ds_read_b64_tr_b16 v[36:37], v116 offset:61440
s_waitcnt lgkmcnt(14)
ds_read_b64_tr_b16 v[38:39], v116 offset:61952
s_waitcnt lgkmcnt(14)
ds_read_b64_tr_b16 v[40:41], v113
s_waitcnt lgkmcnt(14)
ds_read_b64_tr_b16 v[42:43], v113 offset:512
s_waitcnt lgkmcnt(14)
ds_read_b64_tr_b16 v[44:45], v113 offset:4096
s_waitcnt lgkmcnt(14)
ds_read_b64_tr_b16 v[46:47], v113 offset:4608
s_waitcnt lgkmcnt(14)
ds_write_b128 v117, v[0:3] offset:24576
s_waitcnt lgkmcnt(14)
ds_write_b128 v117, v[4:7] offset:28672
s_waitcnt lgkmcnt(14)
ds_write_b128 v117, v[8:11] offset:32768
s_waitcnt lgkmcnt(14)
ds_write_b128 v117, v[12:15] offset:36864
s_waitcnt lgkmcnt(14)
ds_write_b128 v117, v[16:19] offset:40960
s_waitcnt lgkmcnt(14)
ds_write_b128 v117, v[20:23] offset:45056
s_waitcnt lgkmcnt(14)
ds_write_b128 v117, v[24:27] offset:49152
s_waitcnt lgkmcnt(14)
ds_write_b128 v117, v[28:31] offset:53248
s_waitcnt lgkmcnt(14)
ds_write_b128 v117, v[32:35] offset:57344
s_waitcnt lgkmcnt(14)
s_waitcnt lgkmcnt(13)
ds_write_b128 v117, v[36:39] offset:61440
s_waitcnt lgkmcnt(12)
ds_write_b128 v114, v[40:43]
s_waitcnt lgkmcnt(11)
ds_write_b128 v114, v[44:47] offset:4096
v_mov_b32 v223, 1
s_waitcnt lgkmcnt(0)
s_mov_b64 exec, 1
ds_add_u32 v247, v223 offset:12
s_mov_b64 exec, -1
s_cmp_lg_u32 s40, 7
s_cbranch_scc1 Lnosent
v_bfe_u32 v104, v250, 4, 6
v_mov_b32 v108, -1
v_mov_b32 v109, -1
v_mov_b32 v110, -1
v_mov_b32 v111, -1
v_lshlrev_b32_e64 v100, 12, v104
v_add_u32 v101, 262144, v100
v_cmp_gt_u32 vcc, 32, v104
v_mov_b32 v105, 2147483648
s_nop 0
v_cndmask_b32 v101, v105, v101, vcc
s_lshl_b32 s43, s2, 4
buffer_store_dwordx4 v[108:111], v100, s[32:35], s43 offen sc1
buffer_store_dwordx4 v[108:111], v101, s[32:35], s43 offen sc1
s_add_u32 s43, s43, 393216
s_cmp_lt_u32 s2, 96
s_cselect_b32 s43, s43, 1073741824
v_lshlrev_b32 v103, 11, v104
s_mov_b64 exec, 0xff
buffer_store_dwordx4 v[108:111], v103, s[32:35], s43 offen sc1
s_mov_b64 exec, -1
s_nop 1
Lnosent:
s_setprio 3
s_waitcnt vmcnt(0)
s_cmp_lg_u32 s40, 7
s_cbranch_scc1 Lnoinit
s_waitcnt vmcnt(0)
v_mov_b32 v222, 1
v_mov_b32 v223, 0
s_mov_b64 exec, 1
buffer_atomic_add v222, v223, s[36:39], 0 offen
s_mov_b64 exec, -1
s_nop 1
Lnoinit:
Lsu1:
s_add_u32 s43, s81, 6592
v_add_u32_e64 v212, s43, v246
v_subrev_u32 v222, 65920, v212
v_min_u32_e64 v212, v212, v222
v_add_u32 v212, 90112, v212
v_add_u32_e64 v213, s43, v246
v_add_u32 v213, 6592, v213
v_subrev_u32 v222, 65920, v213
v_min_u32_e64 v213, v213, v222
v_add_u32 v213, 90112, v213
v_add_u32_e64 v214, s43, v246
v_add_u32 v214, 13184, v214
v_add_u32_e64 v222, 16, v214
v_bfi_b32 v214, 48, v222, v214
v_subrev_u32 v222, 65920, v214
v_min_u32_e64 v214, v214, v222
v_add_u32 v214, 90112, v214
v_add_u32_e64 v215, s43, v246
v_add_u32 v215, 19776, v215
v_add_u32_e64 v222, 16, v215
v_bfi_b32 v215, 48, v222, v215
v_subrev_u32 v222, 65920, v215
v_min_u32 v215, v215, v222
v_add_u32 v215, 90112, v215
ds_read_b128 v[144:147], v212
ds_read_b64 v[192:193], v238
ds_read_b64 v[194:195], v239
ds_read_b128 v[148:151], v213
ds_read_b128 v[152:155], v214
ds_read_b64 v[196:197], v238 offset:2400
ds_read_b64 v[198:199], v239 offset:2400
ds_read_b128 v[156:159], v215
ds_read_b64 v[200:201], v238 offset:4800
ds_read_b64 v[202:203], v239 offset:4800
ds_read_b128 v[160:163], v212 offset:16
ds_read_b64 v[204:205], v238 offset:200
ds_read_b64 v[206:207], v239 offset:200
ds_read_b128 v[164:167], v213 offset:16
ds_read_b128 v[168:171], v214 offset:16
s_waitcnt lgkmcnt(14)
ds_read_b64 v[208:209], v238 offset:2600
s_waitcnt lgkmcnt(13)
v_mfma_f32_16x16x32_bf16 v[0:3], v[192:195], v[144:147], 0
ds_read_b64 v[210:211], v239 offset:2600
ds_read_b128 v[172:175], v215 offset:16
s_waitcnt lgkmcnt(14)
v_mfma_f32_16x16x32_bf16 v[48:51], v[192:195], v[148:151], 0
ds_read_b64 v[192:193], v238 offset:5000
s_waitcnt lgkmcnt(14)
ds_read_b64 v[194:195], v239 offset:5000
s_waitcnt lgkmcnt(13)
v_mfma_f32_16x16x32_bf16 v[0:3], v[196:199], v[148:151], v[0:3]
ds_read_b128 v[144:147], v212 offset:32
ds_read_b128 v[148:151], v213 offset:32
v_mfma_f32_16x16x32_bf16 v[48:51], v[196:199], v[152:155], v[48:51]
s_waitcnt lgkmcnt(14)
ds_read_b64 v[196:197], v238 offset:400
s_waitcnt lgkmcnt(14)
ds_read_b64 v[198:199], v239 offset:400
s_waitcnt lgkmcnt(14)
v_mfma_f32_16x16x32_bf16 v[0:3], v[200:203], v[152:155], v[0:3]
ds_read_b128 v[152:155], v214 offset:32
v_mfma_f32_16x16x32_bf16 v[48:51], v[200:203], v[156:159], v[48:51]
s_waitcnt lgkmcnt(14)
ds_read_b64 v[200:201], v238 offset:2800
s_waitcnt lgkmcnt(14)
ds_read_b64 v[202:203], v239 offset:2800
s_waitcnt lgkmcnt(14)
v_mfma_f32_16x16x32_bf16 v[4:7], v[204:207], v[160:163], 0
ds_read_b128 v[156:159], v215 offset:32
s_waitcnt lgkmcnt(14)
v_mfma_f32_16x16x32_bf16 v[52:55], v[204:207], v[164:167], 0
ds_read_b64 v[204:205], v238 offset:5200
s_waitcnt lgkmcnt(14)
ds_read_b64 v[206:207], v239 offset:5200
s_waitcnt lgkmcnt(13)
v_mfma_f32_16x16x32_bf16 v[4:7], v[208:211], v[164:167], v[4:7]
ds_read_b128 v[160:163], v212 offset:48
ds_read_b128 v[164:167], v213 offset:48
v_mfma_f32_16x16x32_bf16 v[52:55], v[208:211], v[168:171], v[52:55]
s_waitcnt lgkmcnt(14)
ds_read_b64 v[208:209], v238 offset:600
s_waitcnt lgkmcnt(14)
ds_read_b64 v[210:211], v239 offset:600
s_waitcnt lgkmcnt(14)
v_mfma_f32_16x16x32_bf16 v[4:7], v[192:195], v[168:171], v[4:7]
ds_read_b128 v[168:171], v214 offset:48
v_mfma_f32_16x16x32_bf16 v[52:55], v[192:195], v[172:175], v[52:55]
s_waitcnt lgkmcnt(14)
ds_read_b64 v[192:193], v238 offset:3000
s_waitcnt lgkmcnt(14)
ds_read_b64 v[194:195], v239 offset:3000
s_waitcnt lgkmcnt(13)
v_mfma_f32_16x16x32_bf16 v[8:11], v[196:199], v[144:147], 0
ds_read_b128 v[172:175], v215 offset:48
ds_read_b128 v[144:147], v212 offset:64
v_mfma_f32_16x16x32_bf16 v[56:59], v[196:199], v[148:151], 0
s_waitcnt lgkmcnt(14)
ds_read_b64 v[196:197], v238 offset:5400
s_waitcnt lgkmcnt(14)
ds_read_b64 v[198:199], v239 offset:5400
s_waitcnt lgkmcnt(14)
v_mfma_f32_16x16x32_bf16 v[8:11], v[200:203], v[148:151], v[8:11]
ds_read_b128 v[148:151], v213 offset:64
v_mfma_f32_16x16x32_bf16 v[56:59], v[200:203], v[152:155], v[56:59]
s_waitcnt lgkmcnt(14)
ds_read_b64 v[200:201], v238 offset:800
s_waitcnt lgkmcnt(14)
ds_read_b64 v[202:203], v239 offset:800
s_waitcnt lgkmcnt(14)
v_mfma_f32_16x16x32_bf16 v[8:11], v[204:207], v[152:155], v[8:11]
ds_read_b128 v[152:155], v214 offset:64
v_mfma_f32_16x16x32_bf16 v[56:59], v[204:207], v[156:159], v[56:59]
s_waitcnt lgkmcnt(14)
ds_read_b64 v[204:205], v238 offset:3200
s_waitcnt lgkmcnt(14)
ds_read_b64 v[206:207], v239 offset:3200
s_waitcnt lgkmcnt(13)
v_mfma_f32_16x16x32_bf16 v[12:15], v[208:211], v[160:163], 0
ds_read_b128 v[156:159], v215 offset:64
ds_read_b128 v[160:163], v212 offset:80
v_mfma_f32_16x16x32_bf16 v[60:63], v[208:211], v[164:167], 0
s_waitcnt lgkmcnt(14)
ds_read_b64 v[208:209], v238 offset:5600
s_waitcnt lgkmcnt(14)
ds_read_b64 v[210:211], v239 offset:5600
s_waitcnt lgkmcnt(14)
v_mfma_f32_16x16x32_bf16 v[12:15], v[192:195], v[164:167], v[12:15]
ds_read_b128 v[164:167], v213 offset:80
v_mfma_f32_16x16x32_bf16 v[60:63], v[192:195], v[168:171], v[60:63]
s_waitcnt lgkmcnt(14)
ds_read_b64 v[192:193], v238 offset:1000
s_waitcnt lgkmcnt(14)
ds_read_b64 v[194:195], v239 offset:1000
s_waitcnt lgkmcnt(13)
v_mfma_f32_16x16x32_bf16 v[12:15], v[196:199], v[168:171], v[12:15]
ds_read_b128 v[168:171], v214 offset:80
v_mfma_f32_16x16x32_bf16 v[60:63], v[196:199], v[172:175], v[60:63]
ds_read_b64 v[196:197], v238 offset:3400
s_waitcnt lgkmcnt(14)
ds_read_b64 v[198:199], v239 offset:3400
s_waitcnt lgkmcnt(13)
v_mfma_f32_16x16x32_bf16 v[16:19], v[200:203], v[144:147], 0
ds_read_b128 v[172:175], v215 offset:80
ds_read_b128 v[144:147], v212 offset:96
v_mfma_f32_16x16x32_bf16 v[64:67], v[200:203], v[148:151], 0
s_waitcnt lgkmcnt(14)
ds_read_b64 v[200:201], v238 offset:5800
s_waitcnt lgkmcnt(14)
ds_read_b64 v[202:203], v239 offset:5800
s_waitcnt lgkmcnt(14)
v_mfma_f32_16x16x32_bf16 v[16:19], v[204:207], v[148:151], v[16:19]
ds_read_b128 v[148:151], v213 offset:96
v_mfma_f32_16x16x32_bf16 v[64:67], v[204:207], v[152:155], v[64:67]
s_waitcnt lgkmcnt(14)
ds_read_b64 v[204:205], v238 offset:1200
s_waitcnt lgkmcnt(14)
ds_read_b64 v[206:207], v239 offset:1200
s_waitcnt lgkmcnt(13)
v_mfma_f32_16x16x32_bf16 v[16:19], v[208:211], v[152:155], v[16:19]
ds_read_b128 v[152:155], v214 offset:96
v_mfma_f32_16x16x32_bf16 v[64:67], v[208:211], v[156:159], v[64:67]
ds_read_b64 v[208:209], v238 offset:3600
s_waitcnt lgkmcnt(14)
ds_read_b64 v[210:211], v239 offset:3600
s_waitcnt lgkmcnt(13)
v_mfma_f32_16x16x32_bf16 v[20:23], v[192:195], v[160:163], 0
ds_read_b128 v[156:159], v215 offset:96
ds_read_b128 v[160:163], v212 offset:112
v_mfma_f32_16x16x32_bf16 v[68:71], v[192:195], v[164:167], 0
s_waitcnt lgkmcnt(14)
ds_read_b64 v[192:193], v238 offset:6000
s_waitcnt lgkmcnt(14)
ds_read_b64 v[194:195], v239 offset:6000
s_waitcnt lgkmcnt(14)
v_mfma_f32_16x16x32_bf16 v[20:23], v[196:199], v[164:167], v[20:23]
ds_read_b128 v[164:167], v213 offset:112
v_mfma_f32_16x16x32_bf16 v[68:71], v[196:199], v[168:171], v[68:71]
s_waitcnt lgkmcnt(14)
ds_read_b64 v[196:197], v238 offset:1400
s_waitcnt lgkmcnt(14)
ds_read_b64 v[198:199], v239 offset:1400
s_waitcnt lgkmcnt(13)
v_mfma_f32_16x16x32_bf16 v[20:23], v[200:203], v[168:171], v[20:23]
ds_read_b128 v[168:171], v214 offset:112
v_mfma_f32_16x16x32_bf16 v[68:71], v[200:203], v[172:175], v[68:71]
ds_read_b64 v[200:201], v238 offset:3800
s_waitcnt lgkmcnt(14)
ds_read_b64 v[202:203], v239 offset:3800
s_waitcnt lgkmcnt(13)
v_mfma_f32_16x16x32_bf16 v[24:27], v[204:207], v[144:147], 0
ds_read_b128 v[172:175], v215 offset:112
ds_read_b128 v[144:147], v212 offset:128
v_mfma_f32_16x16x32_bf16 v[72:75], v[204:207], v[148:151], 0
s_waitcnt lgkmcnt(14)
ds_read_b64 v[204:205], v238 offset:6200
s_waitcnt lgkmcnt(14)
ds_read_b64 v[206:207], v239 offset:6200
s_waitcnt lgkmcnt(14)
v_mfma_f32_16x16x32_bf16 v[24:27], v[208:211], v[148:151], v[24:27]
ds_read_b128 v[148:151], v213 offset:128
v_mfma_f32_16x16x32_bf16 v[72:75], v[208:211], v[152:155], v[72:75]
s_waitcnt lgkmcnt(14)
ds_read_b64 v[208:209], v238 offset:1600
s_waitcnt lgkmcnt(14)
ds_read_b64 v[210:211], v239 offset:1600
s_waitcnt lgkmcnt(13)
v_mfma_f32_16x16x32_bf16 v[24:27], v[192:195], v[152:155], v[24:27]
ds_read_b128 v[152:155], v214 offset:128
v_mfma_f32_16x16x32_bf16 v[72:75], v[192:195], v[156:159], v[72:75]
ds_read_b64 v[192:193], v238 offset:4000
s_waitcnt lgkmcnt(14)
ds_read_b64 v[194:195], v239 offset:4000
s_waitcnt lgkmcnt(13)
v_mfma_f32_16x16x32_bf16 v[28:31], v[196:199], v[160:163], 0
ds_read_b128 v[156:159], v215 offset:128
ds_read_b128 v[160:163], v212 offset:144
v_mfma_f32_16x16x32_bf16 v[76:79], v[196:199], v[164:167], 0
s_waitcnt lgkmcnt(14)
ds_read_b64 v[196:197], v238 offset:6400
s_waitcnt lgkmcnt(14)
ds_read_b64 v[198:199], v239 offset:6400
s_waitcnt lgkmcnt(14)
v_mfma_f32_16x16x32_bf16 v[28:31], v[200:203], v[164:167], v[28:31]
ds_read_b128 v[164:167], v213 offset:144
v_mfma_f32_16x16x32_bf16 v[76:79], v[200:203], v[168:171], v[76:79]
s_waitcnt lgkmcnt(14)
ds_read_b64 v[200:201], v238 offset:1800
s_waitcnt lgkmcnt(14)
ds_read_b64 v[202:203], v239 offset:1800
s_waitcnt lgkmcnt(13)
v_mfma_f32_16x16x32_bf16 v[28:31], v[204:207], v[168:171], v[28:31]
ds_read_b128 v[168:171], v214 offset:144
v_mfma_f32_16x16x32_bf16 v[76:79], v[204:207], v[172:175], v[76:79]
ds_read_b64 v[204:205], v238 offset:4200
s_waitcnt lgkmcnt(14)
ds_read_b64 v[206:207], v239 offset:4200
s_waitcnt lgkmcnt(13)
v_mfma_f32_16x16x32_bf16 v[32:35], v[208:211], v[144:147], 0
ds_read_b128 v[172:175], v215 offset:144
ds_read_b128 v[144:147], v212 offset:160
v_mfma_f32_16x16x32_bf16 v[80:83], v[208:211], v[148:151], 0
s_waitcnt lgkmcnt(14)
ds_read_b64 v[208:209], v238 offset:6600
s_waitcnt lgkmcnt(14)
ds_read_b64 v[210:211], v239 offset:6600
s_waitcnt lgkmcnt(14)
v_mfma_f32_16x16x32_bf16 v[32:35], v[192:195], v[148:151], v[32:35]
ds_read_b128 v[148:151], v213 offset:160
v_mfma_f32_16x16x32_bf16 v[80:83], v[192:195], v[152:155], v[80:83]
s_waitcnt lgkmcnt(14)
ds_read_b64 v[192:193], v238 offset:2000
s_waitcnt lgkmcnt(14)
ds_read_b64 v[194:195], v239 offset:2000
s_waitcnt lgkmcnt(13)
v_mfma_f32_16x16x32_bf16 v[32:35], v[196:199], v[152:155], v[32:35]
ds_read_b128 v[152:155], v214 offset:160
v_mfma_f32_16x16x32_bf16 v[80:83], v[196:199], v[156:159], v[80:83]
ds_read_b64 v[196:197], v238 offset:4400
s_waitcnt lgkmcnt(14)
ds_read_b64 v[198:199], v239 offset:4400
s_waitcnt lgkmcnt(13)
v_mfma_f32_16x16x32_bf16 v[36:39], v[200:203], v[160:163], 0
ds_read_b128 v[156:159], v215 offset:160
ds_read_b128 v[160:163], v212 offset:176
v_mfma_f32_16x16x32_bf16 v[84:87], v[200:203], v[164:167], 0
s_waitcnt lgkmcnt(14)
ds_read_b64 v[200:201], v238 offset:6800
s_waitcnt lgkmcnt(14)
ds_read_b64 v[202:203], v239 offset:6800
s_waitcnt lgkmcnt(14)
v_mfma_f32_16x16x32_bf16 v[36:39], v[204:207], v[164:167], v[36:39]
ds_read_b128 v[164:167], v213 offset:176
v_mfma_f32_16x16x32_bf16 v[84:87], v[204:207], v[168:171], v[84:87]
s_waitcnt lgkmcnt(14)
ds_read_b64 v[204:205], v238 offset:2200
s_waitcnt lgkmcnt(14)
ds_read_b64 v[206:207], v239 offset:2200
s_waitcnt lgkmcnt(13)
v_mfma_f32_16x16x32_bf16 v[36:39], v[208:211], v[168:171], v[36:39]
ds_read_b128 v[168:171], v214 offset:176
v_mfma_f32_16x16x32_bf16 v[84:87], v[208:211], v[172:175], v[84:87]
ds_read_b64 v[208:209], v238 offset:4600
s_waitcnt lgkmcnt(14)
ds_read_b64 v[210:211], v239 offset:4600
s_waitcnt lgkmcnt(13)
v_mfma_f32_16x16x32_bf16 v[40:43], v[192:195], v[144:147], 0
ds_read_b128 v[172:175], v215 offset:176
v_mfma_f32_16x16x32_bf16 v[88:91], v[192:195], v[148:151], 0
ds_read_b64 v[192:193], v238 offset:7000
s_waitcnt lgkmcnt(14)
ds_read_b64 v[194:195], v239 offset:7000
s_waitcnt lgkmcnt(13)
v_mfma_f32_16x16x32_bf16 v[40:43], v[196:199], v[148:151], v[40:43]
v_mfma_f32_16x16x32_bf16 v[88:91], v[196:199], v[152:155], v[88:91]
s_waitcnt lgkmcnt(9)
v_mfma_f32_16x16x32_bf16 v[40:43], v[200:203], v[152:155], v[40:43]
v_mfma_f32_16x16x32_bf16 v[88:91], v[200:203], v[156:159], v[88:91]
s_waitcnt lgkmcnt(6)
v_mfma_f32_16x16x32_bf16 v[44:47], v[204:207], v[160:163], 0
v_mfma_f32_16x16x32_bf16 v[92:95], v[204:207], v[164:167], 0
s_waitcnt lgkmcnt(3)
v_mfma_f32_16x16x32_bf16 v[44:47], v[208:211], v[164:167], v[44:47]
v_mfma_f32_16x16x32_bf16 v[92:95], v[208:211], v[168:171], v[92:95]
s_waitcnt lgkmcnt(0)
v_mfma_f32_16x16x32_bf16 v[44:47], v[192:195], v[168:171], v[44:47]
v_mfma_f32_16x16x32_bf16 v[92:95], v[192:195], v[172:175], v[92:95]
v_mov_b32_e64 v223, 1
v_add_u32 v222, s83, v247
s_nop 7
s_mov_b64 exec, 1
ds_add_u32 v222, v223 offset:16
s_mov_b64 exec, -1
v_pk_mul_f32 v[242:243], v[0:1], v[0:1]
v_pk_add_f32 v[240:241], v[0:1], v[2:3]
v_pk_fma_f32 v[242:243], v[2:3], v[2:3], v[242:243]
v_pk_mul_f32 v[218:219], v[48:49], v[48:49]
v_pk_add_f32 v[216:217], v[48:49], v[50:51]
v_pk_fma_f32 v[218:219], v[50:51], v[50:51], v[218:219]
v_pk_fma_f32 v[242:243], v[4:5], v[4:5], v[242:243]
v_pk_add_f32 v[240:241], v[240:241], v[4:5]
v_pk_fma_f32 v[242:243], v[6:7], v[6:7], v[242:243]
v_pk_add_f32 v[240:241], v[240:241], v[6:7]
v_pk_fma_f32 v[218:219], v[52:53], v[52:53], v[218:219]
v_pk_add_f32 v[216:217], v[216:217], v[52:53]
v_pk_fma_f32 v[218:219], v[54:55], v[54:55], v[218:219]
v_pk_add_f32 v[216:217], v[216:217], v[54:55]
v_pk_fma_f32 v[242:243], v[8:9], v[8:9], v[242:243]
v_pk_add_f32 v[240:241], v[240:241], v[8:9]
v_pk_fma_f32 v[242:243], v[10:11], v[10:11], v[242:243]
v_pk_add_f32 v[240:241], v[240:241], v[10:11]
v_pk_fma_f32 v[218:219], v[56:57], v[56:57], v[218:219]
v_pk_add_f32 v[216:217], v[216:217], v[56:57]
v_pk_fma_f32 v[218:219], v[58:59], v[58:59], v[218:219]
v_pk_add_f32 v[216:217], v[216:217], v[58:59]
v_pk_fma_f32 v[242:243], v[12:13], v[12:13], v[242:243]
v_pk_add_f32 v[240:241], v[240:241], v[12:13]
v_pk_fma_f32 v[242:243], v[14:15], v[14:15], v[242:243]
v_pk_add_f32 v[240:241], v[240:241], v[14:15]
v_pk_fma_f32 v[218:219], v[60:61], v[60:61], v[218:219]
v_pk_add_f32 v[216:217], v[216:217], v[60:61]
v_pk_fma_f32 v[218:219], v[62:63], v[62:63], v[218:219]
v_pk_add_f32 v[216:217], v[216:217], v[62:63]
v_pk_fma_f32 v[242:243], v[16:17], v[16:17], v[242:243]
v_pk_add_f32 v[240:241], v[240:241], v[16:17]
v_pk_fma_f32 v[242:243], v[18:19], v[18:19], v[242:243]
v_pk_add_f32 v[240:241], v[240:241], v[18:19]
v_pk_fma_f32 v[218:219], v[64:65], v[64:65], v[218:219]
v_pk_add_f32 v[216:217], v[216:217], v[64:65]
v_pk_fma_f32 v[218:219], v[66:67], v[66:67], v[218:219]
v_pk_add_f32 v[216:217], v[216:217], v[66:67]
v_pk_fma_f32 v[242:243], v[20:21], v[20:21], v[242:243]
v_pk_add_f32 v[240:241], v[240:241], v[20:21]
v_pk_fma_f32 v[242:243], v[22:23], v[22:23], v[242:243]
v_pk_add_f32 v[240:241], v[240:241], v[22:23]
v_pk_fma_f32 v[218:219], v[68:69], v[68:69], v[218:219]
v_pk_add_f32 v[216:217], v[216:217], v[68:69]
v_pk_fma_f32 v[218:219], v[70:71], v[70:71], v[218:219]
v_pk_add_f32 v[216:217], v[216:217], v[70:71]
v_pk_fma_f32 v[242:243], v[24:25], v[24:25], v[242:243]
v_pk_add_f32 v[240:241], v[240:241], v[24:25]
v_pk_fma_f32 v[242:243], v[26:27], v[26:27], v[242:243]
v_pk_add_f32 v[240:241], v[240:241], v[26:27]
v_pk_fma_f32 v[218:219], v[72:73], v[72:73], v[218:219]
v_pk_add_f32 v[216:217], v[216:217], v[72:73]
v_pk_fma_f32 v[218:219], v[74:75], v[74:75], v[218:219]
v_pk_add_f32 v[216:217], v[216:217], v[74:75]
v_pk_fma_f32 v[242:243], v[28:29], v[28:29], v[242:243]
v_pk_add_f32 v[240:241], v[240:241], v[28:29]
v_pk_fma_f32 v[242:243], v[30:31], v[30:31], v[242:243]
v_pk_add_f32 v[240:241], v[240:241], v[30:31]
v_pk_fma_f32 v[218:219], v[76:77], v[76:77], v[218:219]
v_pk_add_f32 v[216:217], v[216:217], v[76:77]
v_pk_fma_f32 v[218:219], v[78:79], v[78:79], v[218:219]
v_pk_add_f32 v[216:217], v[216:217], v[78:79]
v_pk_fma_f32 v[242:243], v[32:33], v[32:33], v[242:243]
v_pk_add_f32 v[240:241], v[240:241], v[32:33]
v_pk_fma_f32 v[242:243], v[34:35], v[34:35], v[242:243]
v_pk_add_f32 v[240:241], v[240:241], v[34:35]
v_pk_fma_f32 v[218:219], v[80:81], v[80:81], v[218:219]
v_pk_add_f32 v[216:217], v[216:217], v[80:81]
v_pk_fma_f32 v[218:219], v[82:83], v[82:83], v[218:219]
v_pk_add_f32 v[216:217], v[216:217], v[82:83]
v_pk_fma_f32 v[242:243], v[36:37], v[36:37], v[242:243]
v_pk_add_f32 v[240:241], v[240:241], v[36:37]
v_pk_fma_f32 v[242:243], v[38:39], v[38:39], v[242:243]
v_pk_add_f32 v[240:241], v[240:241], v[38:39]
v_pk_fma_f32 v[218:219], v[84:85], v[84:85], v[218:219]
v_pk_add_f32 v[216:217], v[216:217], v[84:85]
v_pk_fma_f32 v[218:219], v[86:87], v[86:87], v[218:219]
v_pk_add_f32 v[216:217], v[216:217], v[86:87]
v_pk_fma_f32 v[242:243], v[40:41], v[40:41], v[242:243]
v_pk_add_f32 v[240:241], v[240:241], v[40:41]
v_pk_fma_f32 v[242:243], v[42:43], v[42:43], v[242:243]
v_pk_add_f32 v[240:241], v[240:241], v[42:43]
v_pk_fma_f32 v[218:219], v[88:89], v[88:89], v[218:219]
v_pk_add_f32 v[216:217], v[216:217], v[88:89]
v_pk_fma_f32 v[218:219], v[90:91], v[90:91], v[218:219]
v_pk_add_f32 v[216:217], v[216:217], v[90:91]
v_pk_fma_f32 v[242:243], v[44:45], v[44:45], v[242:243]
v_pk_add_f32 v[240:241], v[240:241], v[44:45]
v_pk_fma_f32 v[242:243], v[46:47], v[46:47], v[242:243]
v_pk_add_f32 v[240:241], v[240:241], v[46:47]
v_pk_fma_f32 v[218:219], v[92:93], v[92:93], v[218:219]
v_pk_add_f32 v[216:217], v[216:217], v[92:93]
v_pk_fma_f32 v[218:219], v[94:95], v[94:95], v[218:219]
v_pk_add_f32 v[216:217], v[216:217], v[94:95]
v_add_f32 v218, v218, v219
v_add_f32 v216, v216, v217
s_nop 1
v_permlane32_swap_b32 v216, v218
v_add_f32_e64 v216, v216, v218
v_mul_f32 v216, 1009429163, v216
v_mov_b32_e64 v218, v216
s_nop 1
v_permlane32_swap_b32 v216, v218
v_fma_f32 v218, -v216, v216, v218
v_max_f32_e64 v218, 0, v218
v_add_f32 v218, 925353388, v218
v_rsq_f32 v218, v218
v_add_f32 v240, v240, v241
v_mul_f32 v220, 3203396952, v218
v_mul_f32 v221, 3203396952, v218
v_mul_f32 v218, v216, v220
v_mul_f32 v219, v216, v220
v_add_f32 v242, v242, v243
s_nop 1
v_permlane32_swap_b32 v240, v242
v_add_f32 v240, v240, v242
v_mul_f32 v240, 1009429163, v240
v_mov_b32_e64 v242, v240
s_nop 1
v_permlane32_swap_b32 v240, v242
v_fma_f32 v242, -v240, v240, v242
v_max_f32_e64 v242, 0, v242
v_add_f32 v242, 925353388, v242
v_rsq_f32 v242, v242
s_nop 0
v_mul_f32 v244, 3203396952, v242
v_mul_f32 v245, 3203396952, v242
v_mul_f32 v242, v240, v244
v_mul_f32 v243, v240, v244
v_pk_fma_f32 v[0:1], v[0:1], v[244:245], v[242:243] neg_lo:[0,0,1] neg_hi:[0,0,1]
v_pk_fma_f32 v[2:3], v[2:3], v[244:245], v[242:243] neg_lo:[0,0,1] neg_hi:[0,0,1]
v_cvt_pk_bf16_f32 v0, v0, v1
v_cvt_pk_bf16_f32 v1, v2, v3
v_pk_fma_f32 v[4:5], v[4:5], v[244:245], v[242:243] neg_lo:[0,0,1] neg_hi:[0,0,1]
v_pk_fma_f32 v[6:7], v[6:7], v[244:245], v[242:243] neg_lo:[0,0,1] neg_hi:[0,0,1]
v_cvt_pk_bf16_f32 v2, v4, v5
v_cvt_pk_bf16_f32 v3, v6, v7
v_pk_fma_f32 v[8:9], v[8:9], v[244:245], v[242:243] neg_lo:[0,0,1] neg_hi:[0,0,1]
v_pk_fma_f32 v[10:11], v[10:11], v[244:245], v[242:243] neg_lo:[0,0,1] neg_hi:[0,0,1]
v_cvt_pk_bf16_f32 v4, v8, v9
v_cvt_pk_bf16_f32 v5, v10, v11
v_pk_fma_f32 v[12:13], v[12:13], v[244:245], v[242:243] neg_lo:[0,0,1] neg_hi:[0,0,1]
v_pk_fma_f32 v[14:15], v[14:15], v[244:245], v[242:243] neg_lo:[0,0,1] neg_hi:[0,0,1]
v_cvt_pk_bf16_f32 v6, v12, v13
v_cvt_pk_bf16_f32 v7, v14, v15
v_pk_fma_f32 v[16:17], v[16:17], v[244:245], v[242:243] neg_lo:[0,0,1] neg_hi:[0,0,1]
v_pk_fma_f32 v[18:19], v[18:19], v[244:245], v[242:243] neg_lo:[0,0,1] neg_hi:[0,0,1]
v_cvt_pk_bf16_f32 v8, v16, v17
v_cvt_pk_bf16_f32 v9, v18, v19
v_pk_fma_f32 v[20:21], v[20:21], v[244:245], v[242:243] neg_lo:[0,0,1] neg_hi:[0,0,1]
v_pk_fma_f32 v[22:23], v[22:23], v[244:245], v[242:243] neg_lo:[0,0,1] neg_hi:[0,0,1]
v_cvt_pk_bf16_f32 v10, v20, v21
v_cvt_pk_bf16_f32 v11, v22, v23
v_pk_fma_f32 v[24:25], v[24:25], v[244:245], v[242:243] neg_lo:[0,0,1] neg_hi:[0,0,1]
v_pk_fma_f32 v[26:27], v[26:27], v[244:245], v[242:243] neg_lo:[0,0,1] neg_hi:[0,0,1]
v_cvt_pk_bf16_f32 v12, v24, v25
v_cvt_pk_bf16_f32 v13, v26, v27
v_mov_b32 v223, 0
s_branch Law2
Lax2:
s_sleep 2
Law2:
ds_read_b32 v223, v247 offset:8
s_sub_u32 s76, s76, 1
s_cselect_b32 s44, 4, 0
s_cselect_b32 s76, 0, s76
s_waitcnt lgkmcnt(0)
v_readfirstlane_b32 s43, v223
s_nop 1
s_max_u32 s43, s43, s44
s_cmp_lt_u32 s43, 4
s_cbranch_scc1 Lax2
v_pk_fma_f32 v[28:29], v[28:29], v[244:245], v[242:243] neg_lo:[0,0,1] neg_hi:[0,0,1]
v_pk_fma_f32 v[30:31], v[30:31], v[244:245], v[242:243] neg_lo:[0,0,1] neg_hi:[0,0,1]
v_cvt_pk_bf16_f32 v14, v28, v29
v_cvt_pk_bf16_f32 v15, v30, v31
v_pk_fma_f32 v[32:33], v[32:33], v[244:245], v[242:243] neg_lo:[0,0,1] neg_hi:[0,0,1]
v_pk_fma_f32 v[34:35], v[34:35], v[244:245], v[242:243] neg_lo:[0,0,1] neg_hi:[0,0,1]
v_cvt_pk_bf16_f32 v16, v32, v33
v_cvt_pk_bf16_f32 v17, v34, v35
v_pk_fma_f32 v[36:37], v[36:37], v[244:245], v[242:243] neg_lo:[0,0,1] neg_hi:[0,0,1]
v_pk_fma_f32 v[38:39], v[38:39], v[244:245], v[242:243] neg_lo:[0,0,1] neg_hi:[0,0,1]
v_cvt_pk_bf16_f32 v18, v36, v37
v_cvt_pk_bf16_f32 v19, v38, v39
v_pk_fma_f32 v[40:41], v[40:41], v[244:245], v[242:243] neg_lo:[0,0,1] neg_hi:[0,0,1]
v_pk_fma_f32 v[42:43], v[42:43], v[244:245], v[242:243] neg_lo:[0,0,1] neg_hi:[0,0,1]
v_cvt_pk_bf16_f32 v20, v40, v41
v_cvt_pk_bf16_f32 v21, v42, v43
v_pk_fma_f32 v[44:45], v[44:45], v[244:245], v[242:243] neg_lo:[0,0,1] neg_hi:[0,0,1]
v_pk_fma_f32 v[46:47], v[46:47], v[244:245], v[242:243] neg_lo:[0,0,1] neg_hi:[0,0,1]
v_cvt_pk_bf16_f32 v22, v44, v45
v_cvt_pk_bf16_f32 v23, v46, v47
v_pk_fma_f32 v[48:49], v[48:49], v[220:221], v[218:219] neg_lo:[0,0,1] neg_hi:[0,0,1]
ds_read_b128 v[176:179], v250
v_cvt_pk_bf16_f32 v24, v48, v49
v_pk_fma_f32 v[50:51], v[50:51], v[220:221], v[218:219] neg_lo:[0,0,1] neg_hi:[0,0,1]
v_pk_fma_f32 v[52:53], v[52:53], v[220:221], v[218:219] neg_lo:[0,0,1] neg_hi:[0,0,1]
v_cvt_pk_bf16_f32 v25, v50, v51
v_cvt_pk_bf16_f32 v26, v52, v53
v_pk_fma_f32 v[54:55], v[54:55], v[220:221], v[218:219] neg_lo:[0,0,1] neg_hi:[0,0,1]
v_pk_fma_f32 v[56:57], v[56:57], v[220:221], v[218:219] neg_lo:[0,0,1] neg_hi:[0,0,1]
v_cvt_pk_bf16_f32 v27, v54, v55
v_cvt_pk_bf16_f32 v28, v56, v57
v_pk_fma_f32 v[58:59], v[58:59], v[220:221], v[218:219] neg_lo:[0,0,1] neg_hi:[0,0,1]
v_pk_fma_f32 v[60:61], v[60:61], v[220:221], v[218:219] neg_lo:[0,0,1] neg_hi:[0,0,1]
v_cvt_pk_bf16_f32 v29, v58, v59
v_cvt_pk_bf16_f32 v30, v60, v61
v_pk_fma_f32 v[62:63], v[62:63], v[220:221], v[218:219] neg_lo:[0,0,1] neg_hi:[0,0,1]
v_pk_fma_f32 v[64:65], v[64:65], v[220:221], v[218:219] neg_lo:[0,0,1] neg_hi:[0,0,1]
v_cvt_pk_bf16_f32 v31, v62, v63
v_cvt_pk_bf16_f32 v32, v64, v65
v_pk_fma_f32 v[66:67], v[66:67], v[220:221], v[218:219] neg_lo:[0,0,1] neg_hi:[0,0,1]
v_pk_fma_f32 v[68:69], v[68:69], v[220:221], v[218:219] neg_lo:[0,0,1] neg_hi:[0,0,1]
v_cvt_pk_bf16_f32 v33, v66, v67
v_cvt_pk_bf16_f32 v34, v68, v69
v_pk_fma_f32 v[70:71], v[70:71], v[220:221], v[218:219] neg_lo:[0,0,1] neg_hi:[0,0,1]
v_pk_fma_f32 v[72:73], v[72:73], v[220:221], v[218:219] neg_lo:[0,0,1] neg_hi:[0,0,1]
ds_read_b128 v[180:183], v250 offset:1024
v_cvt_pk_bf16_f32 v35, v70, v71
v_cvt_pk_bf16_f32 v36, v72, v73
v_pk_fma_f32 v[74:75], v[74:75], v[220:221], v[218:219] neg_lo:[0,0,1] neg_hi:[0,0,1]
v_pk_fma_f32 v[76:77], v[76:77], v[220:221], v[218:219] neg_lo:[0,0,1] neg_hi:[0,0,1]
v_cvt_pk_bf16_f32 v37, v74, v75
v_cvt_pk_bf16_f32 v38, v76, v77
v_pk_fma_f32 v[78:79], v[78:79], v[220:221], v[218:219] neg_lo:[0,0,1] neg_hi:[0,0,1]
v_pk_fma_f32 v[80:81], v[80:81], v[220:221], v[218:219] neg_lo:[0,0,1] neg_hi:[0,0,1]
v_cvt_pk_bf16_f32 v39, v78, v79
v_cvt_pk_bf16_f32 v40, v80, v81
v_pk_fma_f32 v[82:83], v[82:83], v[220:221], v[218:219] neg_lo:[0,0,1] neg_hi:[0,0,1]
v_pk_fma_f32 v[84:85], v[84:85], v[220:221], v[218:219] neg_lo:[0,0,1] neg_hi:[0,0,1]
v_cvt_pk_bf16_f32 v41, v82, v83
v_cvt_pk_bf16_f32 v42, v84, v85
v_pk_fma_f32 v[86:87], v[86:87], v[220:221], v[218:219] neg_lo:[0,0,1] neg_hi:[0,0,1]
v_pk_fma_f32 v[88:89], v[88:89], v[220:221], v[218:219] neg_lo:[0,0,1] neg_hi:[0,0,1]
v_cvt_pk_bf16_f32 v43, v86, v87
v_cvt_pk_bf16_f32 v44, v88, v89
v_pk_fma_f32 v[90:91], v[90:91], v[220:221], v[218:219] neg_lo:[0,0,1] neg_hi:[0,0,1]
v_pk_fma_f32 v[92:93], v[92:93], v[220:221], v[218:219] neg_lo:[0,0,1] neg_hi:[0,0,1]
v_cvt_pk_bf16_f32 v45, v90, v91
v_cvt_pk_bf16_f32 v46, v92, v93
v_pk_fma_f32 v[94:95], v[94:95], v[220:221], v[218:219] neg_lo:[0,0,1] neg_hi:[0,0,1]
ds_read_b128 v[184:187], v250 offset:2048
v_cvt_pk_bf16_f32 v47, v94, v95
s_waitcnt lgkmcnt(2)
v_mfma_f32_32x32x16_bf16 v[160:175], v[0:3], v[176:179], 0
ds_read_b128 v[188:191], v250 offset:3072
v_mfma_f32_32x32x16_bf16 v[96:111], v[24:27], v[176:179], 0
ds_read_b128 v[176:179], v250 offset:4096
s_waitcnt lgkmcnt(3)
v_mfma_f32_32x32x16_bf16 v[160:175], v[4:7], v[180:183], v[160:175]
v_mfma_f32_32x32x16_bf16 v[96:111], v[28:31], v[180:183], v[96:111]
ds_read_b128 v[180:183], v250 offset:5120
s_waitcnt lgkmcnt(3)
v_mfma_f32_32x32x16_bf16 v[160:175], v[8:11], v[184:187], v[160:175]
v_mfma_f32_32x32x16_bf16 v[96:111], v[32:35], v[184:187], v[96:111]
ds_read_b128 v[184:187], v250 offset:6144
s_waitcnt lgkmcnt(2)
v_mfma_f32_32x32x16_bf16 v[160:175], v[12:15], v[188:191], v[160:175]
v_mfma_f32_32x32x16_bf16 v[96:111], v[36:39], v[188:191], v[96:111]
ds_read_b128 v[188:191], v250 offset:7168
v_mfma_f32_32x32x16_bf16 v[160:175], v[16:19], v[176:179], v[160:175]
v_mfma_f32_32x32x16_bf16 v[96:111], v[40:43], v[176:179], v[96:111]
ds_read_b128 v[176:179], v250 offset:8192
s_waitcnt lgkmcnt(2)
v_mfma_f32_32x32x16_bf16 v[160:175], v[20:23], v[180:183], v[160:175]
v_mfma_f32_32x32x16_bf16 v[96:111], v[44:47], v[180:183], v[96:111]
ds_read_b128 v[180:183], v250 offset:9216
s_nop 9
v_cvt_pkrtz_f16_f32 v160, v160, v161
v_mfma_f32_32x32x16_bf16 v[112:127], v[0:3], v[184:187], 0
v_cvt_pkrtz_f16_f32 v161, v162, v163
v_lshrrev_b64 v[160:161], 2, v[160:161]
v_and_b32_sdwa v162, s47, v160 dst_sel:DWORD dst_unused:UNUSED_PAD src0_sel:DWORD src1_sel:WORD_1
v_and_b32_e64 v160, s47, v160
v_cvt_pk_f16_f32 v172, v172, v173
v_cvt_pk_f16_f32 v174, v174, v175
v_pk_fma_f16 v173, v172, v172, s48
v_mfma_f32_32x32x16_bf16 v[128:143], v[24:27], v[184:187], 0
ds_read_u16 v162, v162
ds_read_u16 v160, v160
v_and_b32_sdwa v163, s47, v161 dst_sel:DWORD dst_unused:UNUSED_PAD src0_sel:DWORD src1_sel:WORD_1
v_and_b32_e64 v161, s47, v161
v_pk_fma_f16 v175, v174, v174, s48
v_pk_mul_f16 v173, v172, v173
v_pk_mul_f16 v175, v174, v175
v_cvt_pkrtz_f16_f32 v164, v164, v165
v_cvt_pkrtz_f16_f32 v165, v166, v167
v_lshrrev_b64 v[164:165], 2, v[164:165]
ds_read_u16 v163, v163
ds_read_u16 v161, v161
v_and_b32_sdwa v166, s47, v164 dst_sel:DWORD dst_unused:UNUSED_PAD src0_sel:DWORD src1_sel:WORD_1
v_and_b32 v164, s47, v164
v_exp_f16_sdwa v173, v173 dst_sel:WORD_0 dst_unused:UNUSED_PRESERVE src0_sel:WORD_0
s_waitcnt lgkmcnt(4)
v_mfma_f32_32x32x16_bf16 v[112:127], v[4:7], v[188:191], v[112:127]
ds_read_u16 v166, v166
ds_read_u16 v164, v164
v_exp_f16_sdwa v175, v175 dst_sel:WORD_0 dst_unused:UNUSED_PRESERVE src0_sel:WORD_0
v_and_b32_sdwa v167, s47, v165 dst_sel:DWORD dst_unused:UNUSED_PAD src0_sel:DWORD src1_sel:WORD_1
v_and_b32_e64 v165, s47, v165
v_exp_f16_sdwa v173, v173 dst_sel:WORD_1 dst_unused:UNUSED_PRESERVE src0_sel:WORD_1
v_cvt_pkrtz_f16_f32 v168, v168, v169
v_cvt_pkrtz_f16_f32 v169, v170, v171
v_lshrrev_b64 v[168:169], 2, v[168:169]
v_and_b32_sdwa v170, s47, v168 dst_sel:DWORD dst_unused:UNUSED_PAD src0_sel:DWORD src1_sel:WORD_1
v_and_b32_e64 v168, s47, v168
ds_read_u16 v167, v167
ds_read_u16 v165, v165
ds_read_u16 v170, v170
ds_read_u16 v168, v168
v_exp_f16_sdwa v175, v175 dst_sel:WORD_1 dst_unused:UNUSED_PRESERVE src0_sel:WORD_1
v_mfma_f32_32x32x16_bf16 v[128:143], v[28:31], v[188:191], v[128:143]
ds_read_b128 v[184:187], v250 offset:10240
v_and_b32_sdwa v171, s47, v169 dst_sel:DWORD dst_unused:UNUSED_PAD src0_sel:DWORD src1_sel:WORD_1
v_and_b32_e64 v169, s47, v169
v_pk_add_f16 v173, v173, 1.0 op_sel_hi:[1,0]
v_pk_add_f16 v175, v175, 1.0 op_sel_hi:[1,0]
v_rcp_f16_sdwa v173, v173 dst_sel:WORD_0 dst_unused:UNUSED_PRESERVE src0_sel:WORD_0
v_mfma_f32_32x32x16_bf16 v[112:127], v[8:11], v[176:179], v[112:127]
ds_read_u16 v171, v171
ds_read_u16 v169, v169
v_rcp_f16_sdwa v175, v175 dst_sel:WORD_0 dst_unused:UNUSED_PRESERVE src0_sel:WORD_0
v_rcp_f16_sdwa v173, v173 dst_sel:WORD_1 dst_unused:UNUSED_PRESERVE src0_sel:WORD_1
v_rcp_f16_sdwa v175, v175 dst_sel:WORD_1 dst_unused:UNUSED_PRESERVE src0_sel:WORD_1
v_mfma_f32_32x32x16_bf16 v[128:143], v[32:35], v[176:179], v[128:143]
ds_read_b128 v[188:191], v250 offset:11264
v_pk_mul_f16 v172, v172, v173
v_pk_mul_f16 v174, v174, v175
v_fma_mix_f32 v224, v172, v172, v224 op_sel_hi:[1,1,0]
v_cvt_pkrtz_f16_f32 v96, v96, v97
v_fma_mix_f32 v224, v174, v174, v224 op_sel_hi:[1,1,0]
v_mfma_f32_32x32x16_bf16 v[112:127], v[12:15], v[180:183], v[112:127]
v_fma_mix_f32 v224, v172, v172, v224 op_sel:[1,1,0] op_sel_hi:[1,1,0]
v_cvt_pkrtz_f16_f32 v97, v98, v99
v_fma_mix_f32 v224, v174, v174, v224 op_sel:[1,1,0] op_sel_hi:[1,1,0]
v_lshrrev_b64 v[96:97], 2, v[96:97]
s_waitcnt lgkmcnt(7)
v_fma_mix_f32 v224, v160, v160, v224 op_sel_hi:[1,1,0]
v_and_b32_sdwa v98, s47, v96 dst_sel:DWORD dst_unused:UNUSED_PAD src0_sel:DWORD src1_sel:WORD_1
v_fma_mix_f32 v224, v161, v161, v224 op_sel_hi:[1,1,0]
v_and_b32 v96, s47, v96
v_fma_mix_f32 v224, v162, v162, v224 op_sel_hi:[1,1,0]
v_cvt_pk_f16_f32 v108, v108, v109
v_fma_mix_f32 v224, v163, v163, v224 op_sel_hi:[1,1,0]
v_cvt_pk_f16_f32 v110, v110, v111
v_pk_fma_f16 v109, v108, v108, s48
v_mfma_f32_32x32x16_bf16 v[128:143], v[36:39], v[180:183], v[128:143]
ds_read_u16 v98, v98
ds_read_u16 v96, v96
v_fma_mix_f32 v224, v164, v164, v224 op_sel_hi:[1,1,0]
v_and_b32_sdwa v99, s47, v97 dst_sel:DWORD dst_unused:UNUSED_PAD src0_sel:DWORD src1_sel:WORD_1
s_waitcnt lgkmcnt(6)
v_fma_mix_f32 v224, v165, v165, v224 op_sel_hi:[1,1,0]
v_and_b32 v97, s47, v97
v_pk_fma_f16 v111, v110, v110, s48
v_pk_mul_f16 v109, v108, v109
v_pk_mul_f16 v111, v110, v111
v_fma_mix_f32 v224, v166, v166, v224 op_sel_hi:[1,1,0]
v_cvt_pkrtz_f16_f32 v100, v100, v101
v_fma_mix_f32 v224, v167, v167, v224 op_sel_hi:[1,1,0]
ds_read_u16 v99, v99
ds_read_u16 v97, v97
ds_read_b128 v[176:179], v250 offset:12288
v_cvt_pkrtz_f16_f32 v101, v102, v103
v_lshrrev_b64 v[100:101], 2, v[100:101]
v_and_b32_sdwa v102, s47, v100 dst_sel:DWORD dst_unused:UNUSED_PAD src0_sel:DWORD src1_sel:WORD_1
v_and_b32 v100, s47, v100
v_exp_f16_sdwa v109, v109 dst_sel:WORD_0 dst_unused:UNUSED_PRESERVE src0_sel:WORD_0
s_waitcnt lgkmcnt(6)
v_mfma_f32_32x32x16_bf16 v[112:127], v[16:19], v[184:187], v[112:127]
ds_read_u16 v102, v102
ds_read_u16 v100, v100
v_exp_f16_sdwa v111, v111 dst_sel:WORD_0 dst_unused:UNUSED_PRESERVE src0_sel:WORD_0
v_fma_mix_f32 v224, v168, v168, v224 op_sel_hi:[1,1,0]
v_and_b32_sdwa v103, s47, v101 dst_sel:DWORD dst_unused:UNUSED_PAD src0_sel:DWORD src1_sel:WORD_1
v_fma_mix_f32 v224, v169, v169, v224 op_sel_hi:[1,1,0]
v_and_b32_e64 v101, s47, v101
v_exp_f16_sdwa v109, v109 dst_sel:WORD_1 dst_unused:UNUSED_PRESERVE src0_sel:WORD_1
v_fma_mix_f32 v224, v170, v170, v224 op_sel_hi:[1,1,0]
v_cvt_pkrtz_f16_f32 v104, v104, v105
v_fma_mix_f32 v224, v171, v171, v224 op_sel_hi:[1,1,0]
v_cvt_pkrtz_f16_f32 v105, v106, v107
v_lshrrev_b64 v[104:105], 2, v[104:105]
ds_read_u16 v103, v103
ds_read_u16 v101, v101
v_and_b32_sdwa v106, s47, v104 dst_sel:DWORD dst_unused:UNUSED_PAD src0_sel:DWORD src1_sel:WORD_1
v_and_b32_e64 v104, s47, v104
v_exp_f16_sdwa v111, v111 dst_sel:WORD_1 dst_unused:UNUSED_PRESERVE src0_sel:WORD_1
v_mfma_f32_32x32x16_bf16 v[128:143], v[40:43], v[184:187], v[128:143]
ds_read_u16 v106, v106
ds_read_u16 v104, v104
ds_read_b128 v[180:183], v250 offset:13312
v_and_b32_sdwa v107, s47, v105 dst_sel:DWORD dst_unused:UNUSED_PAD src0_sel:DWORD src1_sel:WORD_1
v_and_b32_e64 v105, s47, v105
v_pk_add_f16 v109, v109, 1.0 op_sel_hi:[1,0]
v_pk_add_f16 v111, v111, 1.0 op_sel_hi:[1,0]
v_rcp_f16_sdwa v109, v109 dst_sel:WORD_0 dst_unused:UNUSED_PRESERVE src0_sel:WORD_0
s_waitcnt lgkmcnt(7)
v_mfma_f32_32x32x16_bf16 v[112:127], v[20:23], v[188:191], v[112:127]
ds_read_u16 v107, v107
ds_read_u16 v105, v105
v_rcp_f16_sdwa v111, v111 dst_sel:WORD_0 dst_unused:UNUSED_PRESERVE src0_sel:WORD_0
v_rcp_f16_sdwa v109, v109 dst_sel:WORD_1 dst_unused:UNUSED_PRESERVE src0_sel:WORD_1
v_rcp_f16_sdwa v111, v111 dst_sel:WORD_1 dst_unused:UNUSED_PRESERVE src0_sel:WORD_1
v_mfma_f32_32x32x16_bf16 v[128:143], v[44:47], v[188:191], v[128:143]
ds_read_b128 v[184:187], v250 offset:14336
v_pk_mul_f16 v108, v108, v109
v_pk_mul_f16 v110, v110, v111
v_fma_mix_f32 v224, v108, v108, v224 op_sel_hi:[1,1,0]
s_nop 1
v_cvt_pkrtz_f16_f32 v112, v112, v113
v_fma_mix_f32 v224, v110, v110, v224 op_sel_hi:[1,1,0]
v_mfma_f32_32x32x16_bf16 v[144:159], v[0:3], v[176:179], 0
v_fma_mix_f32 v224, v108, v108, v224 op_sel:[1,1,0] op_sel_hi:[1,1,0]
v_cvt_pkrtz_f16_f32 v113, v114, v115
v_fma_mix_f32 v224, v110, v110, v224 op_sel:[1,1,0] op_sel_hi:[1,1,0]
v_lshrrev_b64 v[112:113], 2, v[112:113]
v_fma_mix_f32 v224, v96, v96, v224 op_sel_hi:[1,1,0]
v_and_b32_sdwa v114, s47, v112 dst_sel:DWORD dst_unused:UNUSED_PAD src0_sel:DWORD src1_sel:WORD_1
v_fma_mix_f32 v224, v97, v97, v224 op_sel_hi:[1,1,0]
v_and_b32_e64 v112, s47, v112
v_fma_mix_f32 v224, v98, v98, v224 op_sel_hi:[1,1,0]
v_cvt_pk_f16_f32 v124, v124, v125
v_fma_mix_f32 v224, v99, v99, v224 op_sel_hi:[1,1,0]
v_cvt_pk_f16_f32 v126, v126, v127
v_pk_fma_f16 v125, v124, v124, s48
v_mfma_f32_32x32x16_bf16 v[160:175], v[24:27], v[176:179], 0
ds_read_u16 v114, v114
ds_read_u16 v112, v112
s_waitcnt lgkmcnt(5)
v_fma_mix_f32 v224, v100, v100, v224 op_sel_hi:[1,1,0]
v_and_b32_sdwa v115, s47, v113 dst_sel:DWORD dst_unused:UNUSED_PAD src0_sel:DWORD src1_sel:WORD_1
v_fma_mix_f32 v224, v101, v101, v224 op_sel_hi:[1,1,0]
v_and_b32 v113, s47, v113
v_pk_fma_f16 v127, v126, v126, s48
v_pk_mul_f16 v125, v124, v125
v_pk_mul_f16 v127, v126, v127
v_fma_mix_f32 v224, v102, v102, v224 op_sel_hi:[1,1,0]
v_cvt_pkrtz_f16_f32 v116, v116, v117
v_fma_mix_f32 v224, v103, v103, v224 op_sel_hi:[1,1,0]
ds_read_u16 v115, v115
ds_read_u16 v113, v113
ds_read_b128 v[188:191], v250 offset:15360
v_cvt_pkrtz_f16_f32 v117, v118, v119
v_lshrrev_b64 v[116:117], 2, v[116:117]
v_and_b32_sdwa v118, s47, v116 dst_sel:DWORD dst_unused:UNUSED_PAD src0_sel:DWORD src1_sel:WORD_1
v_and_b32_e64 v116, s47, v116
v_exp_f16_sdwa v125, v125 dst_sel:WORD_0 dst_unused:UNUSED_PRESERVE src0_sel:WORD_0
v_mfma_f32_32x32x16_bf16 v[144:159], v[4:7], v[180:183], v[144:159]
ds_read_u16 v118, v118
ds_read_u16 v116, v116
v_exp_f16_sdwa v127, v127 dst_sel:WORD_0 dst_unused:UNUSED_PRESERVE src0_sel:WORD_0
v_fma_mix_f32 v224, v104, v104, v224 op_sel_hi:[1,1,0]
v_and_b32_sdwa v119, s47, v117 dst_sel:DWORD dst_unused:UNUSED_PAD src0_sel:DWORD src1_sel:WORD_1
s_waitcnt lgkmcnt(7)
v_fma_mix_f32 v224, v105, v105, v224 op_sel_hi:[1,1,0]
v_and_b32 v117, s47, v117
v_exp_f16_sdwa v125, v125 dst_sel:WORD_1 dst_unused:UNUSED_PRESERVE src0_sel:WORD_1
v_fma_mix_f32 v224, v106, v106, v224 op_sel_hi:[1,1,0]
v_cvt_pkrtz_f16_f32 v120, v120, v121
v_fma_mix_f32 v224, v107, v107, v224 op_sel_hi:[1,1,0]
v_cvt_pkrtz_f16_f32 v121, v122, v123
v_lshrrev_b64 v[120:121], 2, v[120:121]
ds_read_u16 v119, v119
ds_read_u16 v117, v117
v_and_b32_sdwa v122, s47, v120 dst_sel:DWORD dst_unused:UNUSED_PAD src0_sel:DWORD src1_sel:WORD_1
v_and_b32_e64 v120, s47, v120
v_exp_f16_sdwa v127, v127 dst_sel:WORD_1 dst_unused:UNUSED_PRESERVE src0_sel:WORD_1
v_mfma_f32_32x32x16_bf16 v[160:175], v[28:31], v[180:183], v[160:175]
ds_read_u16 v122, v122
ds_read_u16 v120, v120
ds_read_b128 v[176:179], v250 offset:16384
v_and_b32_sdwa v123, s47, v121 dst_sel:DWORD dst_unused:UNUSED_PAD src0_sel:DWORD src1_sel:WORD_1
v_and_b32_e64 v121, s47, v121
v_pk_add_f16 v125, v125, 1.0 op_sel_hi:[1,0]
v_pk_add_f16 v127, v127, 1.0 op_sel_hi:[1,0]
v_rcp_f16_sdwa v125, v125 dst_sel:WORD_0 dst_unused:UNUSED_PRESERVE src0_sel:WORD_0
v_mfma_f32_32x32x16_bf16 v[144:159], v[8:11], v[184:187], v[144:159]
ds_read_u16 v123, v123
ds_read_u16 v121, v121
v_rcp_f16_sdwa v127, v127 dst_sel:WORD_0 dst_unused:UNUSED_PRESERVE src0_sel:WORD_0
v_rcp_f16_sdwa v125, v125 dst_sel:WORD_1 dst_unused:UNUSED_PRESERVE src0_sel:WORD_1
v_rcp_f16_sdwa v127, v127 dst_sel:WORD_1 dst_unused:UNUSED_PRESERVE src0_sel:WORD_1
v_mfma_f32_32x32x16_bf16 v[160:175], v[32:35], v[184:187], v[160:175]
ds_read_b128 v[180:183], v250 offset:17408
v_pk_mul_f16 v124, v124, v125
v_pk_mul_f16 v126, v126, v127
v_fma_mix_f32 v225, v124, v124, v225 op_sel_hi:[1,1,0]
v_cvt_pkrtz_f16_f32 v128, v128, v129
v_fma_mix_f32 v225, v126, v126, v225 op_sel_hi:[1,1,0]
s_waitcnt lgkmcnt(7)
v_mfma_f32_32x32x16_bf16 v[144:159], v[12:15], v[188:191], v[144:159]
v_fma_mix_f32 v225, v124, v124, v225 op_sel:[1,1,0] op_sel_hi:[1,1,0]
v_cvt_pkrtz_f16_f32 v129, v130, v131
v_fma_mix_f32 v225, v126, v126, v225 op_sel:[1,1,0] op_sel_hi:[1,1,0]
v_lshrrev_b64 v[128:129], 2, v[128:129]
v_fma_mix_f32 v225, v112, v112, v225 op_sel_hi:[1,1,0]
v_and_b32_sdwa v130, s47, v128 dst_sel:DWORD dst_unused:UNUSED_PAD src0_sel:DWORD src1_sel:WORD_1
v_fma_mix_f32 v225, v113, v113, v225 op_sel_hi:[1,1,0]
v_and_b32 v128, s47, v128
v_fma_mix_f32 v225, v114, v114, v225 op_sel_hi:[1,1,0]
v_cvt_pk_f16_f32 v140, v140, v141
v_fma_mix_f32 v225, v115, v115, v225 op_sel_hi:[1,1,0]
v_cvt_pk_f16_f32 v142, v142, v143
v_pk_fma_f16 v141, v140, v140, s48
v_mfma_f32_32x32x16_bf16 v[160:175], v[36:39], v[188:191], v[160:175]
ds_read_u16 v130, v130
ds_read_u16 v128, v128
v_fma_mix_f32 v225, v116, v116, v225 op_sel_hi:[1,1,0]
v_and_b32_sdwa v131, s47, v129 dst_sel:DWORD dst_unused:UNUSED_PAD src0_sel:DWORD src1_sel:WORD_1
s_waitcnt lgkmcnt(5)
v_fma_mix_f32 v225, v117, v117, v225 op_sel_hi:[1,1,0]
v_and_b32 v129, s47, v129
v_pk_fma_f16 v143, v142, v142, s48
v_pk_mul_f16 v141, v140, v141
v_pk_mul_f16 v143, v142, v143
v_fma_mix_f32 v225, v118, v118, v225 op_sel_hi:[1,1,0]
v_cvt_pkrtz_f16_f32 v132, v132, v133
v_fma_mix_f32 v225, v119, v119, v225 op_sel_hi:[1,1,0]
ds_read_u16 v131, v131
ds_read_u16 v129, v129
ds_read_b128 v[184:187], v250 offset:18432
v_cvt_pkrtz_f16_f32 v133, v134, v135
v_lshrrev_b64 v[132:133], 2, v[132:133]
v_and_b32_sdwa v134, s47, v132 dst_sel:DWORD dst_unused:UNUSED_PAD src0_sel:DWORD src1_sel:WORD_1
v_and_b32_e64 v132, s47, v132
v_exp_f16_sdwa v141, v141 dst_sel:WORD_0 dst_unused:UNUSED_PRESERVE src0_sel:WORD_0
v_mfma_f32_32x32x16_bf16 v[144:159], v[16:19], v[176:179], v[144:159]
ds_read_u16 v134, v134
ds_read_u16 v132, v132
v_exp_f16_sdwa v143, v143 dst_sel:WORD_0 dst_unused:UNUSED_PRESERVE src0_sel:WORD_0
v_fma_mix_f32 v225, v120, v120, v225 op_sel_hi:[1,1,0]
v_and_b32_sdwa v135, s47, v133 dst_sel:DWORD dst_unused:UNUSED_PAD src0_sel:DWORD src1_sel:WORD_1
s_waitcnt lgkmcnt(7)
v_fma_mix_f32 v225, v121, v121, v225 op_sel_hi:[1,1,0]
v_and_b32 v133, s47, v133
v_exp_f16_sdwa v141, v141 dst_sel:WORD_1 dst_unused:UNUSED_PRESERVE src0_sel:WORD_1
v_fma_mix_f32 v225, v122, v122, v225 op_sel_hi:[1,1,0]
v_cvt_pkrtz_f16_f32 v136, v136, v137
v_fma_mix_f32 v225, v123, v123, v225 op_sel_hi:[1,1,0]
v_cvt_pkrtz_f16_f32 v137, v138, v139
v_lshrrev_b64 v[136:137], 2, v[136:137]
ds_read_u16 v135, v135
ds_read_u16 v133, v133
v_and_b32_sdwa v138, s47, v136 dst_sel:DWORD dst_unused:UNUSED_PAD src0_sel:DWORD src1_sel:WORD_1
v_and_b32_e64 v136, s47, v136
v_exp_f16_sdwa v143, v143 dst_sel:WORD_1 dst_unused:UNUSED_PRESERVE src0_sel:WORD_1
v_mfma_f32_32x32x16_bf16 v[160:175], v[40:43], v[176:179], v[160:175]
ds_read_u16 v138, v138
ds_read_u16 v136, v136
ds_read_b128 v[188:191], v250 offset:19456
v_and_b32_sdwa v139, s47, v137 dst_sel:DWORD dst_unused:UNUSED_PAD src0_sel:DWORD src1_sel:WORD_1
v_and_b32_e64 v137, s47, v137
v_pk_add_f16 v141, v141, 1.0 op_sel_hi:[1,0]
v_pk_add_f16 v143, v143, 1.0 op_sel_hi:[1,0]
v_rcp_f16_sdwa v141, v141 dst_sel:WORD_0 dst_unused:UNUSED_PRESERVE src0_sel:WORD_0
v_mfma_f32_32x32x16_bf16 v[144:159], v[20:23], v[180:183], v[144:159]
ds_read_u16 v139, v139
ds_read_u16 v137, v137
v_rcp_f16_sdwa v143, v143 dst_sel:WORD_0 dst_unused:UNUSED_PRESERVE src0_sel:WORD_0
v_rcp_f16_sdwa v141, v141 dst_sel:WORD_1 dst_unused:UNUSED_PRESERVE src0_sel:WORD_1
v_rcp_f16_sdwa v143, v143 dst_sel:WORD_1 dst_unused:UNUSED_PRESERVE src0_sel:WORD_1
v_mfma_f32_32x32x16_bf16 v[160:175], v[44:47], v[180:183], v[160:175]
ds_read_b128 v[176:179], v250 offset:20480
v_pk_mul_f16 v140, v140, v141
v_pk_mul_f16 v142, v142, v143
v_fma_mix_f32 v225, v140, v140, v225 op_sel_hi:[1,1,0]
s_nop 1
v_cvt_pkrtz_f16_f32 v144, v144, v145
v_fma_mix_f32 v225, v142, v142, v225 op_sel_hi:[1,1,0]
s_waitcnt lgkmcnt(7)
v_mfma_f32_32x32x16_bf16 v[96:111], v[0:3], v[184:187], 0
v_fma_mix_f32 v225, v140, v140, v225 op_sel:[1,1,0] op_sel_hi:[1,1,0]
v_cvt_pkrtz_f16_f32 v145, v146, v147
v_fma_mix_f32 v225, v142, v142, v225 op_sel:[1,1,0] op_sel_hi:[1,1,0]
v_lshrrev_b64 v[144:145], 2, v[144:145]
v_fma_mix_f32 v225, v128, v128, v225 op_sel_hi:[1,1,0]
v_and_b32_sdwa v146, s47, v144 dst_sel:DWORD dst_unused:UNUSED_PAD src0_sel:DWORD src1_sel:WORD_1
v_fma_mix_f32 v225, v129, v129, v225 op_sel_hi:[1,1,0]
v_and_b32_e64 v144, s47, v144
v_fma_mix_f32 v225, v130, v130, v225 op_sel_hi:[1,1,0]
v_cvt_pk_f16_f32 v156, v156, v157
v_fma_mix_f32 v225, v131, v131, v225 op_sel_hi:[1,1,0]
v_cvt_pk_f16_f32 v158, v158, v159
v_pk_fma_f16 v157, v156, v156, s48
v_mfma_f32_32x32x16_bf16 v[112:127], v[24:27], v[184:187], 0
ds_read_u16 v146, v146
ds_read_u16 v144, v144
v_fma_mix_f32 v225, v132, v132, v225 op_sel_hi:[1,1,0]
v_and_b32_sdwa v147, s47, v145 dst_sel:DWORD dst_unused:UNUSED_PAD src0_sel:DWORD src1_sel:WORD_1
s_waitcnt lgkmcnt(5)
v_fma_mix_f32 v225, v133, v133, v225 op_sel_hi:[1,1,0]
v_and_b32 v145, s47, v145
v_pk_fma_f16 v159, v158, v158, s48
v_pk_mul_f16 v157, v156, v157
v_pk_mul_f16 v159, v158, v159
v_fma_mix_f32 v225, v134, v134, v225 op_sel_hi:[1,1,0]
v_cvt_pkrtz_f16_f32 v148, v148, v149
v_fma_mix_f32 v225, v135, v135, v225 op_sel_hi:[1,1,0]
ds_read_u16 v147, v147
ds_read_u16 v145, v145
ds_read_b128 v[180:183], v250 offset:21504
v_cvt_pkrtz_f16_f32 v149, v150, v151
v_lshrrev_b64 v[148:149], 2, v[148:149]
v_and_b32_sdwa v150, s47, v148 dst_sel:DWORD dst_unused:UNUSED_PAD src0_sel:DWORD src1_sel:WORD_1
v_and_b32_e64 v148, s47, v148
v_exp_f16_sdwa v157, v157 dst_sel:WORD_0 dst_unused:UNUSED_PRESERVE src0_sel:WORD_0
v_mfma_f32_32x32x16_bf16 v[96:111], v[4:7], v[188:191], v[96:111]
ds_read_u16 v150, v150
ds_read_u16 v148, v148
v_exp_f16_sdwa v159, v159 dst_sel:WORD_0 dst_unused:UNUSED_PRESERVE src0_sel:WORD_0
v_fma_mix_f32 v225, v136, v136, v225 op_sel_hi:[1,1,0]
v_and_b32_sdwa v151, s47, v149 dst_sel:DWORD dst_unused:UNUSED_PAD src0_sel:DWORD src1_sel:WORD_1
s_waitcnt lgkmcnt(7)
v_fma_mix_f32 v225, v137, v137, v225 op_sel_hi:[1,1,0]
v_and_b32 v149, s47, v149
v_exp_f16_sdwa v157, v157 dst_sel:WORD_1 dst_unused:UNUSED_PRESERVE src0_sel:WORD_1
v_fma_mix_f32 v225, v138, v138, v225 op_sel_hi:[1,1,0]
v_cvt_pkrtz_f16_f32 v152, v152, v153
v_fma_mix_f32 v225, v139, v139, v225 op_sel_hi:[1,1,0]
v_cvt_pkrtz_f16_f32 v153, v154, v155
v_lshrrev_b64 v[152:153], 2, v[152:153]
ds_read_u16 v151, v151
ds_read_u16 v149, v149
v_and_b32_sdwa v154, s47, v152 dst_sel:DWORD dst_unused:UNUSED_PAD src0_sel:DWORD src1_sel:WORD_1
v_and_b32_e64 v152, s47, v152
v_exp_f16_sdwa v159, v159 dst_sel:WORD_1 dst_unused:UNUSED_PRESERVE src0_sel:WORD_1
v_mfma_f32_32x32x16_bf16 v[112:127], v[28:31], v[188:191], v[112:127]
ds_read_u16 v154, v154
ds_read_u16 v152, v152
ds_read_b128 v[184:187], v250 offset:22528
v_and_b32_sdwa v155, s47, v153 dst_sel:DWORD dst_unused:UNUSED_PAD src0_sel:DWORD src1_sel:WORD_1
v_and_b32_e64 v153, s47, v153
v_pk_add_f16 v157, v157, 1.0 op_sel_hi:[1,0]
v_pk_add_f16 v159, v159, 1.0 op_sel_hi:[1,0]
v_rcp_f16_sdwa v157, v157 dst_sel:WORD_0 dst_unused:UNUSED_PRESERVE src0_sel:WORD_0
v_mfma_f32_32x32x16_bf16 v[96:111], v[8:11], v[176:179], v[96:111]
ds_read_u16 v155, v155
ds_read_u16 v153, v153
v_rcp_f16_sdwa v159, v159 dst_sel:WORD_0 dst_unused:UNUSED_PRESERVE src0_sel:WORD_0
v_rcp_f16_sdwa v157, v157 dst_sel:WORD_1 dst_unused:UNUSED_PRESERVE src0_sel:WORD_1
v_rcp_f16_sdwa v159, v159 dst_sel:WORD_1 dst_unused:UNUSED_PRESERVE src0_sel:WORD_1
v_mfma_f32_32x32x16_bf16 v[112:127], v[32:35], v[176:179], v[112:127]
ds_read_b128 v[188:191], v250 offset:23552
v_mov_b32_e64 v223, 0
s_branch Law3
Lax3:
s_sleep 2
Law3:
ds_read_b32 v223, v247 offset:12
s_sub_u32 s76, s76, 1
s_cselect_b32 s44, 4, 0
s_cselect_b32 s76, 0, s76
s_waitcnt lgkmcnt(0)
v_readfirstlane_b32 s43, v223
s_nop 1
s_max_u32 s43, s43, s44
s_cmp_lt_u32 s43, 4
s_cbranch_scc1 Lax3
v_pk_mul_f16 v156, v156, v157
v_pk_mul_f16 v158, v158, v159
v_fma_mix_f32 v226, v156, v156, v226 op_sel_hi:[1,1,0]
v_mfma_f32_32x32x16_bf16 v[96:111], v[12:15], v[180:183], v[96:111]
v_fma_mix_f32 v226, v158, v158, v226 op_sel_hi:[1,1,0]
s_setprio 3
v_cvt_pkrtz_f16_f32 v160, v160, v161
v_fma_mix_f32 v226, v156, v156, v226 op_sel:[1,1,0] op_sel_hi:[1,1,0]
v_cvt_pkrtz_f16_f32 v161, v162, v163
v_fma_mix_f32 v226, v158, v158, v226 op_sel:[1,1,0] op_sel_hi:[1,1,0]
v_lshrrev_b64 v[160:161], 2, v[160:161]
v_fma_mix_f32 v226, v144, v144, v226 op_sel_hi:[1,1,0]
v_and_b32_sdwa v162, s47, v160 dst_sel:DWORD dst_unused:UNUSED_PAD src0_sel:DWORD src1_sel:WORD_1
v_fma_mix_f32 v226, v145, v145, v226 op_sel_hi:[1,1,0]
v_and_b32_e64 v160, s47, v160
v_fma_mix_f32 v226, v146, v146, v226 op_sel_hi:[1,1,0]
v_cvt_pk_f16_f32 v172, v172, v173
v_fma_mix_f32 v226, v147, v147, v226 op_sel_hi:[1,1,0]
v_cvt_pk_f16_f32 v174, v174, v175
v_pk_fma_f16 v173, v172, v172, s48
v_mfma_f32_32x32x16_bf16 v[112:127], v[36:39], v[180:183], v[112:127]
ds_read_u16 v162, v162
ds_read_u16 v160, v160
v_fma_mix_f32 v226, v148, v148, v226 op_sel_hi:[1,1,0]
v_and_b32_sdwa v163, s47, v161 dst_sel:DWORD dst_unused:UNUSED_PAD src0_sel:DWORD src1_sel:WORD_1
v_fma_mix_f32 v226, v149, v149, v226 op_sel_hi:[1,1,0]
v_and_b32_e64 v161, s47, v161
v_pk_fma_f16 v175, v174, v174, s48
v_pk_mul_f16 v173, v172, v173
v_pk_mul_f16 v175, v174, v175
v_fma_mix_f32 v226, v150, v150, v226 op_sel_hi:[1,1,0]
v_cvt_pkrtz_f16_f32 v164, v164, v165
v_fma_mix_f32 v226, v151, v151, v226 op_sel_hi:[1,1,0]
ds_read_u16 v163, v163
ds_read_u16 v161, v161
ds_read_b128 v[176:179], v250 offset:24576
v_cvt_pkrtz_f16_f32 v165, v166, v167
v_lshrrev_b64 v[164:165], 2, v[164:165]
v_and_b32_sdwa v166, s47, v164 dst_sel:DWORD dst_unused:UNUSED_PAD src0_sel:DWORD src1_sel:WORD_1
v_and_b32_e64 v164, s47, v164
v_exp_f16_sdwa v173, v173 dst_sel:WORD_0 dst_unused:UNUSED_PRESERVE src0_sel:WORD_0
v_mfma_f32_32x32x16_bf16 v[96:111], v[16:19], v[184:187], v[96:111]
ds_read_u16 v166, v166
ds_read_u16 v164, v164
v_exp_f16_sdwa v175, v175 dst_sel:WORD_0 dst_unused:UNUSED_PRESERVE src0_sel:WORD_0
v_fma_mix_f32 v226, v152, v152, v226 op_sel_hi:[1,1,0]
v_and_b32_sdwa v167, s47, v165 dst_sel:DWORD dst_unused:UNUSED_PAD src0_sel:DWORD src1_sel:WORD_1
v_fma_mix_f32 v226, v153, v153, v226 op_sel_hi:[1,1,0]
v_and_b32_e64 v165, s47, v165
v_exp_f16_sdwa v173, v173 dst_sel:WORD_1 dst_unused:UNUSED_PRESERVE src0_sel:WORD_1
v_fma_mix_f32 v226, v154, v154, v226 op_sel_hi:[1,1,0]
v_cvt_pkrtz_f16_f32 v168, v168, v169
v_fma_mix_f32 v226, v155, v155, v226 op_sel_hi:[1,1,0]
v_cvt_pkrtz_f16_f32 v169, v170, v171
v_lshrrev_b64 v[168:169], 2, v[168:169]
ds_read_u16 v167, v167
ds_read_u16 v165, v165
v_and_b32_sdwa v170, s47, v168 dst_sel:DWORD dst_unused:UNUSED_PAD src0_sel:DWORD src1_sel:WORD_1
v_and_b32_e64 v168, s47, v168
v_exp_f16_sdwa v175, v175 dst_sel:WORD_1 dst_unused:UNUSED_PRESERVE src0_sel:WORD_1
v_mfma_f32_32x32x16_bf16 v[112:127], v[40:43], v[184:187], v[112:127]
ds_read_u16 v170, v170
ds_read_u16 v168, v168
ds_read_b128 v[180:183], v250 offset:25600
v_and_b32_sdwa v171, s47, v169 dst_sel:DWORD dst_unused:UNUSED_PAD src0_sel:DWORD src1_sel:WORD_1
v_and_b32_e64 v169, s47, v169
v_pk_add_f16 v173, v173, 1.0 op_sel_hi:[1,0]
v_pk_add_f16 v175, v175, 1.0 op_sel_hi:[1,0]
v_rcp_f16_sdwa v173, v173 dst_sel:WORD_0 dst_unused:UNUSED_PRESERVE src0_sel:WORD_0
v_mfma_f32_32x32x16_bf16 v[96:111], v[20:23], v[188:191], v[96:111]
ds_read_u16 v171, v171
ds_read_u16 v169, v169
v_rcp_f16_sdwa v175, v175 dst_sel:WORD_0 dst_unused:UNUSED_PRESERVE src0_sel:WORD_0
v_rcp_f16_sdwa v173, v173 dst_sel:WORD_1 dst_unused:UNUSED_PRESERVE src0_sel:WORD_1
v_rcp_f16_sdwa v175, v175 dst_sel:WORD_1 dst_unused:UNUSED_PRESERVE src0_sel:WORD_1
v_mfma_f32_32x32x16_bf16 v[112:127], v[44:47], v[188:191], v[112:127]
ds_read_b128 v[184:187], v250 offset:26624
v_pk_mul_f16 v172, v172, v173
v_pk_mul_f16 v174, v174, v175
v_fma_mix_f32 v226, v172, v172, v226 op_sel_hi:[1,1,0]
s_nop 1
v_cvt_pkrtz_f16_f32 v96, v96, v97
v_fma_mix_f32 v226, v174, v174, v226 op_sel_hi:[1,1,0]
s_waitcnt lgkmcnt(7)
v_mfma_f32_32x32x16_bf16 v[128:143], v[0:3], v[176:179], 0
v_fma_mix_f32 v226, v172, v172, v226 op_sel:[1,1,0] op_sel_hi:[1,1,0]
v_cvt_pkrtz_f16_f32 v97, v98, v99
v_fma_mix_f32 v226, v174, v174, v226 op_sel:[1,1,0] op_sel_hi:[1,1,0]
v_lshrrev_b64 v[96:97], 2, v[96:97]
v_fma_mix_f32 v226, v160, v160, v226 op_sel_hi:[1,1,0]
v_and_b32_sdwa v98, s47, v96 dst_sel:DWORD dst_unused:UNUSED_PAD src0_sel:DWORD src1_sel:WORD_1
v_fma_mix_f32 v226, v161, v161, v226 op_sel_hi:[1,1,0]
v_and_b32_e64 v96, s47, v96
v_fma_mix_f32 v226, v162, v162, v226 op_sel_hi:[1,1,0]
v_cvt_pk_f16_f32 v108, v108, v109
v_fma_mix_f32 v226, v163, v163, v226 op_sel_hi:[1,1,0]
v_cvt_pk_f16_f32 v110, v110, v111
v_pk_fma_f16 v109, v108, v108, s48
v_mfma_f32_32x32x16_bf16 v[144:159], v[24:27], v[176:179], 0
ds_read_u16 v98, v98
ds_read_u16 v96, v96
v_fma_mix_f32 v226, v164, v164, v226 op_sel_hi:[1,1,0]
v_and_b32_sdwa v99, s47, v97 dst_sel:DWORD dst_unused:UNUSED_PAD src0_sel:DWORD src1_sel:WORD_1
s_waitcnt lgkmcnt(5)
v_fma_mix_f32 v226, v165, v165, v226 op_sel_hi:[1,1,0]
v_and_b32 v97, s47, v97
v_pk_fma_f16 v111, v110, v110, s48
v_pk_mul_f16 v109, v108, v109
v_pk_mul_f16 v111, v110, v111
v_fma_mix_f32 v226, v166, v166, v226 op_sel_hi:[1,1,0]
v_cvt_pkrtz_f16_f32 v100, v100, v101
v_fma_mix_f32 v226, v167, v167, v226 op_sel_hi:[1,1,0]
ds_read_u16 v99, v99
ds_read_u16 v97, v97
ds_read_b128 v[188:191], v250 offset:27648
v_cvt_pkrtz_f16_f32 v101, v102, v103
v_lshrrev_b64 v[100:101], 2, v[100:101]
v_and_b32_sdwa v102, s47, v100 dst_sel:DWORD dst_unused:UNUSED_PAD src0_sel:DWORD src1_sel:WORD_1
v_and_b32_e64 v100, s47, v100
v_exp_f16_sdwa v109, v109 dst_sel:WORD_0 dst_unused:UNUSED_PRESERVE src0_sel:WORD_0
v_mfma_f32_32x32x16_bf16 v[128:143], v[4:7], v[180:183], v[128:143]
ds_read_u16 v102, v102
ds_read_u16 v100, v100
v_exp_f16_sdwa v111, v111 dst_sel:WORD_0 dst_unused:UNUSED_PRESERVE src0_sel:WORD_0
v_fma_mix_f32 v226, v168, v168, v226 op_sel_hi:[1,1,0]
v_and_b32_sdwa v103, s47, v101 dst_sel:DWORD dst_unused:UNUSED_PAD src0_sel:DWORD src1_sel:WORD_1
s_waitcnt lgkmcnt(7)
v_fma_mix_f32 v226, v169, v169, v226 op_sel_hi:[1,1,0]
v_and_b32 v101, s47, v101
v_exp_f16_sdwa v109, v109 dst_sel:WORD_1 dst_unused:UNUSED_PRESERVE src0_sel:WORD_1
v_fma_mix_f32 v226, v170, v170, v226 op_sel_hi:[1,1,0]
v_cvt_pkrtz_f16_f32 v104, v104, v105
v_fma_mix_f32 v226, v171, v171, v226 op_sel_hi:[1,1,0]
v_cvt_pkrtz_f16_f32 v105, v106, v107
v_lshrrev_b64 v[104:105], 2, v[104:105]
ds_read_u16 v103, v103
ds_read_u16 v101, v101
v_and_b32_sdwa v106, s47, v104 dst_sel:DWORD dst_unused:UNUSED_PAD src0_sel:DWORD src1_sel:WORD_1
v_and_b32_e64 v104, s47, v104
v_exp_f16_sdwa v111, v111 dst_sel:WORD_1 dst_unused:UNUSED_PRESERVE src0_sel:WORD_1
v_mfma_f32_32x32x16_bf16 v[144:159], v[28:31], v[180:183], v[144:159]
ds_read_u16 v106, v106
ds_read_u16 v104, v104
ds_read_b128 v[176:179], v250 offset:28672
v_and_b32_sdwa v107, s47, v105 dst_sel:DWORD dst_unused:UNUSED_PAD src0_sel:DWORD src1_sel:WORD_1
v_and_b32_e64 v105, s47, v105
v_pk_add_f16 v109, v109, 1.0 op_sel_hi:[1,0]
v_pk_add_f16 v111, v111, 1.0 op_sel_hi:[1,0]
v_rcp_f16_sdwa v109, v109 dst_sel:WORD_0 dst_unused:UNUSED_PRESERVE src0_sel:WORD_0
v_mfma_f32_32x32x16_bf16 v[128:143], v[8:11], v[184:187], v[128:143]
ds_read_u16 v107, v107
ds_read_u16 v105, v105
v_rcp_f16_sdwa v111, v111 dst_sel:WORD_0 dst_unused:UNUSED_PRESERVE src0_sel:WORD_0
v_rcp_f16_sdwa v109, v109 dst_sel:WORD_1 dst_unused:UNUSED_PRESERVE src0_sel:WORD_1
v_rcp_f16_sdwa v111, v111 dst_sel:WORD_1 dst_unused:UNUSED_PRESERVE src0_sel:WORD_1
v_mfma_f32_32x32x16_bf16 v[144:159], v[32:35], v[184:187], v[144:159]
ds_read_b128 v[180:183], v250 offset:29696
v_pk_mul_f16 v108, v108, v109
v_pk_mul_f16 v110, v110, v111
v_fma_mix_f32 v227, v108, v108, v227 op_sel_hi:[1,1,0]
v_cvt_pkrtz_f16_f32 v112, v112, v113
v_fma_mix_f32 v227, v110, v110, v227 op_sel_hi:[1,1,0]
s_waitcnt lgkmcnt(7)
v_mfma_f32_32x32x16_bf16 v[128:143], v[12:15], v[188:191], v[128:143]
v_fma_mix_f32 v227, v108, v108, v227 op_sel:[1,1,0] op_sel_hi:[1,1,0]
v_cvt_pkrtz_f16_f32 v113, v114, v115
v_fma_mix_f32 v227, v110, v110, v227 op_sel:[1,1,0] op_sel_hi:[1,1,0]
v_lshrrev_b64 v[112:113], 2, v[112:113]
v_fma_mix_f32 v227, v96, v96, v227 op_sel_hi:[1,1,0]
v_and_b32_sdwa v114, s47, v112 dst_sel:DWORD dst_unused:UNUSED_PAD src0_sel:DWORD src1_sel:WORD_1
v_fma_mix_f32 v227, v97, v97, v227 op_sel_hi:[1,1,0]
v_and_b32 v112, s47, v112
v_fma_mix_f32 v227, v98, v98, v227 op_sel_hi:[1,1,0]
v_cvt_pk_f16_f32 v124, v124, v125
v_fma_mix_f32 v227, v99, v99, v227 op_sel_hi:[1,1,0]
v_cvt_pk_f16_f32 v126, v126, v127
v_pk_fma_f16 v125, v124, v124, s48
v_mfma_f32_32x32x16_bf16 v[144:159], v[36:39], v[188:191], v[144:159]
ds_read_u16 v114, v114
ds_read_u16 v112, v112
v_fma_mix_f32 v227, v100, v100, v227 op_sel_hi:[1,1,0]
v_and_b32_sdwa v115, s47, v113 dst_sel:DWORD dst_unused:UNUSED_PAD src0_sel:DWORD src1_sel:WORD_1
s_waitcnt lgkmcnt(5)
v_fma_mix_f32 v227, v101, v101, v227 op_sel_hi:[1,1,0]
v_and_b32 v113, s47, v113
v_pk_fma_f16 v127, v126, v126, s48
v_pk_mul_f16 v125, v124, v125
v_pk_mul_f16 v127, v126, v127
v_fma_mix_f32 v227, v102, v102, v227 op_sel_hi:[1,1,0]
v_cvt_pkrtz_f16_f32 v116, v116, v117
v_fma_mix_f32 v227, v103, v103, v227 op_sel_hi:[1,1,0]
ds_read_u16 v115, v115
ds_read_u16 v113, v113
ds_read_b128 v[184:187], v250 offset:30720
v_cvt_pkrtz_f16_f32 v117, v118, v119
v_lshrrev_b64 v[116:117], 2, v[116:117]
v_and_b32_sdwa v118, s47, v116 dst_sel:DWORD dst_unused:UNUSED_PAD src0_sel:DWORD src1_sel:WORD_1
v_and_b32_e64 v116, s47, v116
v_exp_f16_sdwa v125, v125 dst_sel:WORD_0 dst_unused:UNUSED_PRESERVE src0_sel:WORD_0
v_mfma_f32_32x32x16_bf16 v[128:143], v[16:19], v[176:179], v[128:143]
ds_read_u16 v118, v118
ds_read_u16 v116, v116
v_exp_f16_sdwa v127, v127 dst_sel:WORD_0 dst_unused:UNUSED_PRESERVE src0_sel:WORD_0
v_fma_mix_f32 v227, v104, v104, v227 op_sel_hi:[1,1,0]
v_and_b32_sdwa v119, s47, v117 dst_sel:DWORD dst_unused:UNUSED_PAD src0_sel:DWORD src1_sel:WORD_1
s_waitcnt lgkmcnt(7)
v_fma_mix_f32 v227, v105, v105, v227 op_sel_hi:[1,1,0]
v_and_b32 v117, s47, v117
v_exp_f16_sdwa v125, v125 dst_sel:WORD_1 dst_unused:UNUSED_PRESERVE src0_sel:WORD_1
v_fma_mix_f32 v227, v106, v106, v227 op_sel_hi:[1,1,0]
v_cvt_pkrtz_f16_f32 v120, v120, v121
v_fma_mix_f32 v227, v107, v107, v227 op_sel_hi:[1,1,0]
v_cvt_pkrtz_f16_f32 v121, v122, v123
v_lshrrev_b64 v[120:121], 2, v[120:121]
ds_read_u16 v119, v119
ds_read_u16 v117, v117
v_and_b32_sdwa v122, s47, v120 dst_sel:DWORD dst_unused:UNUSED_PAD src0_sel:DWORD src1_sel:WORD_1
v_and_b32_e64 v120, s47, v120
v_exp_f16_sdwa v127, v127 dst_sel:WORD_1 dst_unused:UNUSED_PRESERVE src0_sel:WORD_1
v_mfma_f32_32x32x16_bf16 v[144:159], v[40:43], v[176:179], v[144:159]
ds_read_u16 v122, v122
ds_read_u16 v120, v120
ds_read_b128 v[188:191], v250 offset:31744
v_and_b32_sdwa v123, s47, v121 dst_sel:DWORD dst_unused:UNUSED_PAD src0_sel:DWORD src1_sel:WORD_1
v_and_b32_e64 v121, s47, v121
v_pk_add_f16 v125, v125, 1.0 op_sel_hi:[1,0]
v_pk_add_f16 v127, v127, 1.0 op_sel_hi:[1,0]
v_rcp_f16_sdwa v125, v125 dst_sel:WORD_0 dst_unused:UNUSED_PRESERVE src0_sel:WORD_0
v_mfma_f32_32x32x16_bf16 v[128:143], v[20:23], v[180:183], v[128:143]
ds_read_u16 v123, v123
ds_read_u16 v121, v121
v_rcp_f16_sdwa v127, v127 dst_sel:WORD_0 dst_unused:UNUSED_PRESERVE src0_sel:WORD_0
v_rcp_f16_sdwa v125, v125 dst_sel:WORD_1 dst_unused:UNUSED_PRESERVE src0_sel:WORD_1
v_rcp_f16_sdwa v127, v127 dst_sel:WORD_1 dst_unused:UNUSED_PRESERVE src0_sel:WORD_1
v_mfma_f32_32x32x16_bf16 v[144:159], v[44:47], v[180:183], v[144:159]
ds_read_b128 v[176:179], v250 offset:32768
v_pk_mul_f16 v124, v124, v125
v_pk_mul_f16 v126, v126, v127
v_fma_mix_f32 v227, v124, v124, v227 op_sel_hi:[1,1,0]
s_nop 1
v_cvt_pkrtz_f16_f32 v128, v128, v129
v_fma_mix_f32 v227, v126, v126, v227 op_sel_hi:[1,1,0]
s_waitcnt lgkmcnt(7)
v_mfma_f32_32x32x16_bf16 v[160:175], v[0:3], v[184:187], 0
v_fma_mix_f32 v227, v124, v124, v227 op_sel:[1,1,0] op_sel_hi:[1,1,0]
v_cvt_pkrtz_f16_f32 v129, v130, v131
v_fma_mix_f32 v227, v126, v126, v227 op_sel:[1,1,0] op_sel_hi:[1,1,0]
v_lshrrev_b64 v[128:129], 2, v[128:129]
v_fma_mix_f32 v227, v112, v112, v227 op_sel_hi:[1,1,0]
v_and_b32_sdwa v130, s47, v128 dst_sel:DWORD dst_unused:UNUSED_PAD src0_sel:DWORD src1_sel:WORD_1
v_fma_mix_f32 v227, v113, v113, v227 op_sel_hi:[1,1,0]
v_and_b32_e64 v128, s47, v128
v_fma_mix_f32 v227, v114, v114, v227 op_sel_hi:[1,1,0]
v_cvt_pk_f16_f32 v140, v140, v141
v_fma_mix_f32 v227, v115, v115, v227 op_sel_hi:[1,1,0]
v_cvt_pk_f16_f32 v142, v142, v143
v_pk_fma_f16 v141, v140, v140, s48
v_mfma_f32_32x32x16_bf16 v[96:111], v[24:27], v[184:187], 0
ds_read_u16 v130, v130
ds_read_u16 v128, v128
v_fma_mix_f32 v227, v116, v116, v227 op_sel_hi:[1,1,0]
v_and_b32_sdwa v131, s47, v129 dst_sel:DWORD dst_unused:UNUSED_PAD src0_sel:DWORD src1_sel:WORD_1
s_waitcnt lgkmcnt(5)
v_fma_mix_f32 v227, v117, v117, v227 op_sel_hi:[1,1,0]
v_and_b32 v129, s47, v129
v_pk_fma_f16 v143, v142, v142, s48
v_pk_mul_f16 v141, v140, v141
v_pk_mul_f16 v143, v142, v143
v_fma_mix_f32 v227, v118, v118, v227 op_sel_hi:[1,1,0]
v_cvt_pkrtz_f16_f32 v132, v132, v133
v_fma_mix_f32 v227, v119, v119, v227 op_sel_hi:[1,1,0]
ds_read_u16 v131, v131
ds_read_u16 v129, v129
ds_read_b128 v[180:183], v250 offset:33792
v_cvt_pkrtz_f16_f32 v133, v134, v135
v_lshrrev_b64 v[132:133], 2, v[132:133]
v_and_b32_sdwa v134, s47, v132 dst_sel:DWORD dst_unused:UNUSED_PAD src0_sel:DWORD src1_sel:WORD_1
v_and_b32_e64 v132, s47, v132
v_exp_f16_sdwa v141, v141 dst_sel:WORD_0 dst_unused:UNUSED_PRESERVE src0_sel:WORD_0
v_mfma_f32_32x32x16_bf16 v[160:175], v[4:7], v[188:191], v[160:175]
ds_read_u16 v134, v134
ds_read_u16 v132, v132
v_exp_f16_sdwa v143, v143 dst_sel:WORD_0 dst_unused:UNUSED_PRESERVE src0_sel:WORD_0
v_fma_mix_f32 v227, v120, v120, v227 op_sel_hi:[1,1,0]
v_and_b32_sdwa v135, s47, v133 dst_sel:DWORD dst_unused:UNUSED_PAD src0_sel:DWORD src1_sel:WORD_1
s_waitcnt lgkmcnt(7)
v_fma_mix_f32 v227, v121, v121, v227 op_sel_hi:[1,1,0]
v_and_b32 v133, s47, v133
v_exp_f16_sdwa v141, v141 dst_sel:WORD_1 dst_unused:UNUSED_PRESERVE src0_sel:WORD_1
v_fma_mix_f32 v227, v122, v122, v227 op_sel_hi:[1,1,0]
v_cvt_pkrtz_f16_f32 v136, v136, v137
v_fma_mix_f32 v227, v123, v123, v227 op_sel_hi:[1,1,0]
v_cvt_pkrtz_f16_f32 v137, v138, v139
v_lshrrev_b64 v[136:137], 2, v[136:137]
ds_read_u16 v135, v135
ds_read_u16 v133, v133
v_and_b32_sdwa v138, s47, v136 dst_sel:DWORD dst_unused:UNUSED_PAD src0_sel:DWORD src1_sel:WORD_1
v_and_b32_e64 v136, s47, v136
v_exp_f16_sdwa v143, v143 dst_sel:WORD_1 dst_unused:UNUSED_PRESERVE src0_sel:WORD_1
v_mfma_f32_32x32x16_bf16 v[96:111], v[28:31], v[188:191], v[96:111]
ds_read_u16 v138, v138
ds_read_u16 v136, v136
ds_read_b128 v[184:187], v250 offset:34816
v_and_b32_sdwa v139, s47, v137 dst_sel:DWORD dst_unused:UNUSED_PAD src0_sel:DWORD src1_sel:WORD_1
v_and_b32_e64 v137, s47, v137
v_pk_add_f16 v141, v141, 1.0 op_sel_hi:[1,0]
v_pk_add_f16 v143, v143, 1.0 op_sel_hi:[1,0]
v_rcp_f16_sdwa v141, v141 dst_sel:WORD_0 dst_unused:UNUSED_PRESERVE src0_sel:WORD_0
v_mfma_f32_32x32x16_bf16 v[160:175], v[8:11], v[176:179], v[160:175]
ds_read_u16 v139, v139
ds_read_u16 v137, v137
v_rcp_f16_sdwa v143, v143 dst_sel:WORD_0 dst_unused:UNUSED_PRESERVE src0_sel:WORD_0
v_rcp_f16_sdwa v141, v141 dst_sel:WORD_1 dst_unused:UNUSED_PRESERVE src0_sel:WORD_1
v_rcp_f16_sdwa v143, v143 dst_sel:WORD_1 dst_unused:UNUSED_PRESERVE src0_sel:WORD_1
v_mfma_f32_32x32x16_bf16 v[96:111], v[32:35], v[176:179], v[96:111]
ds_read_b128 v[188:191], v250 offset:35840
v_pk_mul_f16 v140, v140, v141
v_pk_mul_f16 v142, v142, v143
v_fma_mix_f32 v228, v140, v140, v228 op_sel_hi:[1,1,0]
s_add_u32 s66, s66, 786432
s_sub_u32 s81, s81, 13184
v_bfe_u32 v223, v250, 4, 6
v_and_b32 v222, 15, v223
v_lshlrev_b32 v222, 7, v222
v_lshrrev_b32_e64 v223, 4, v223
v_mul_u32_u24 v223, 98304, v223
s_sub_u32 s43, s67, -8000
s_mul_i32 s44, s41, 192
s_add_u32 s43, s43, s44
v_add3_u32 v222, v222, v223, s43
s_mov_b32 m0, 163840
s_add_u32 s44, s66, 393216
buffer_load_dword v222, s[4:7], s66 offen lds
buffer_load_dword v222, s[4:7], s44 offen lds
v_fma_mix_f32 v228, v142, v142, v228 op_sel_hi:[1,1,0]
s_waitcnt lgkmcnt(6)
v_mfma_f32_32x32x16_bf16 v[160:175], v[12:15], v[180:183], v[160:175]
v_fma_mix_f32 v228, v140, v140, v228 op_sel:[1,1,0] op_sel_hi:[1,1,0]
v_cvt_pkrtz_f16_f32 v144, v144, v145
v_fma_mix_f32 v228, v142, v142, v228 op_sel:[1,1,0] op_sel_hi:[1,1,0]
v_cvt_pkrtz_f16_f32 v145, v146, v147
v_fma_mix_f32 v228, v128, v128, v228 op_sel_hi:[1,1,0]
v_lshrrev_b64 v[144:145], 2, v[144:145]
v_fma_mix_f32 v228, v129, v129, v228 op_sel_hi:[1,1,0]
v_and_b32_sdwa v146, s47, v144 dst_sel:DWORD dst_unused:UNUSED_PAD src0_sel:DWORD src1_sel:WORD_1
v_fma_mix_f32 v228, v130, v130, v228 op_sel_hi:[1,1,0]
v_and_b32_e64 v144, s47, v144
v_fma_mix_f32 v228, v131, v131, v228 op_sel_hi:[1,1,0]
v_cvt_pk_f16_f32 v156, v156, v157
v_cvt_pk_f16_f32 v158, v158, v159
v_pk_fma_f16 v157, v156, v156, s48
v_mfma_f32_32x32x16_bf16 v[96:111], v[36:39], v[180:183], v[96:111]
ds_read_u16 v146, v146
ds_read_u16 v144, v144
v_fma_mix_f32 v228, v132, v132, v228 op_sel_hi:[1,1,0]
v_and_b32_sdwa v147, s47, v145 dst_sel:DWORD dst_unused:UNUSED_PAD src0_sel:DWORD src1_sel:WORD_1
v_fma_mix_f32 v228, v133, v133, v228 op_sel_hi:[1,1,0]
v_and_b32_e64 v145, s47, v145
v_pk_fma_f16 v159, v158, v158, s48
v_pk_mul_f16 v157, v156, v157
v_pk_mul_f16 v159, v158, v159
v_fma_mix_f32 v228, v134, v134, v228 op_sel_hi:[1,1,0]
v_cvt_pkrtz_f16_f32 v148, v148, v149
v_fma_mix_f32 v228, v135, v135, v228 op_sel_hi:[1,1,0]
ds_read_u16 v147, v147
ds_read_u16 v145, v145
ds_read_b128 v[176:179], v250 offset:36864
v_cvt_pkrtz_f16_f32 v149, v150, v151
v_lshrrev_b64 v[148:149], 2, v[148:149]
v_and_b32_sdwa v150, s47, v148 dst_sel:DWORD dst_unused:UNUSED_PAD src0_sel:DWORD src1_sel:WORD_1
v_and_b32 v148, s47, v148
v_exp_f16_sdwa v157, v157 dst_sel:WORD_0 dst_unused:UNUSED_PRESERVE src0_sel:WORD_0
s_waitcnt lgkmcnt(5)
v_mfma_f32_32x32x16_bf16 v[160:175], v[16:19], v[184:187], v[160:175]
ds_read_u16 v150, v150
ds_read_u16 v148, v148
v_exp_f16_sdwa v159, v159 dst_sel:WORD_0 dst_unused:UNUSED_PRESERVE src0_sel:WORD_0
v_fma_mix_f32 v228, v136, v136, v228 op_sel_hi:[1,1,0]
v_and_b32_sdwa v151, s47, v149 dst_sel:DWORD dst_unused:UNUSED_PAD src0_sel:DWORD src1_sel:WORD_1
v_fma_mix_f32 v228, v137, v137, v228 op_sel_hi:[1,1,0]
v_and_b32_e64 v149, s47, v149
v_exp_f16_sdwa v157, v157 dst_sel:WORD_1 dst_unused:UNUSED_PRESERVE src0_sel:WORD_1
v_fma_mix_f32 v228, v138, v138, v228 op_sel_hi:[1,1,0]
v_cvt_pkrtz_f16_f32 v152, v152, v153
v_fma_mix_f32 v228, v139, v139, v228 op_sel_hi:[1,1,0]
v_cvt_pkrtz_f16_f32 v153, v154, v155
v_lshrrev_b64 v[152:153], 2, v[152:153]
ds_read_u16 v151, v151
ds_read_u16 v149, v149
v_and_b32_sdwa v154, s47, v152 dst_sel:DWORD dst_unused:UNUSED_PAD src0_sel:DWORD src1_sel:WORD_1
v_and_b32_e64 v152, s47, v152
v_exp_f16_sdwa v159, v159 dst_sel:WORD_1 dst_unused:UNUSED_PRESERVE src0_sel:WORD_1
v_mfma_f32_32x32x16_bf16 v[96:111], v[40:43], v[184:187], v[96:111]
ds_read_u16 v154, v154
ds_read_u16 v152, v152
ds_read_b128 v[180:183], v250 offset:37888
v_and_b32_sdwa v155, s47, v153 dst_sel:DWORD dst_unused:UNUSED_PAD src0_sel:DWORD src1_sel:WORD_1
v_and_b32_e64 v153, s47, v153
v_pk_add_f16 v157, v157, 1.0 op_sel_hi:[1,0]
v_pk_add_f16 v159, v159, 1.0 op_sel_hi:[1,0]
v_rcp_f16_sdwa v157, v157 dst_sel:WORD_0 dst_unused:UNUSED_PRESERVE src0_sel:WORD_0
v_mfma_f32_32x32x16_bf16 v[160:175], v[20:23], v[188:191], v[160:175]
ds_read_u16 v155, v155
ds_read_u16 v153, v153
v_rcp_f16_sdwa v159, v159 dst_sel:WORD_0 dst_unused:UNUSED_PRESERVE src0_sel:WORD_0
v_rcp_f16_sdwa v157, v157 dst_sel:WORD_1 dst_unused:UNUSED_PRESERVE src0_sel:WORD_1
v_rcp_f16_sdwa v159, v159 dst_sel:WORD_1 dst_unused:UNUSED_PRESERVE src0_sel:WORD_1
v_mfma_f32_32x32x16_bf16 v[96:111], v[44:47], v[188:191], v[96:111]
ds_read_b128 v[184:187], v250 offset:38912
v_pk_mul_f16 v156, v156, v157
v_pk_mul_f16 v158, v158, v159
v_fma_mix_f32 v228, v156, v156, v228 op_sel_hi:[1,1,0]
buffer_store_dwordx4 v[0:3], v250, s[32:35], s80 offen sc1
v_fma_mix_f32 v228, v158, v158, v228 op_sel_hi:[1,1,0]
s_waitcnt lgkmcnt(7)
v_mfma_f32_32x32x16_bf16 v[112:127], v[0:3], v[176:179], 0
v_fma_mix_f32 v228, v156, v156, v228 op_sel:[1,1,0] op_sel_hi:[1,1,0]
v_cvt_pkrtz_f16_f32 v160, v160, v161
v_fma_mix_f32 v228, v158, v158, v228 op_sel:[1,1,0] op_sel_hi:[1,1,0]
v_cvt_pkrtz_f16_f32 v161, v162, v163
v_fma_mix_f32 v228, v144, v144, v228 op_sel_hi:[1,1,0]
v_lshrrev_b64 v[160:161], 2, v[160:161]
v_fma_mix_f32 v228, v145, v145, v228 op_sel_hi:[1,1,0]
v_and_b32_sdwa v162, s47, v160 dst_sel:DWORD dst_unused:UNUSED_PAD src0_sel:DWORD src1_sel:WORD_1
v_fma_mix_f32 v228, v146, v146, v228 op_sel_hi:[1,1,0]
v_and_b32 v160, s47, v160
v_fma_mix_f32 v228, v147, v147, v228 op_sel_hi:[1,1,0]
v_cvt_pk_f16_f32 v172, v172, v173
v_cvt_pk_f16_f32 v174, v174, v175
v_pk_fma_f16 v173, v172, v172, s48
v_mfma_f32_32x32x16_bf16 v[128:143], v[24:27], v[176:179], 0
ds_read_u16 v162, v162
ds_read_u16 v160, v160
v_fma_mix_f32 v228, v148, v148, v228 op_sel_hi:[1,1,0]
v_and_b32_sdwa v163, s47, v161 dst_sel:DWORD dst_unused:UNUSED_PAD src0_sel:DWORD src1_sel:WORD_1
s_waitcnt lgkmcnt(5)
v_fma_mix_f32 v228, v149, v149, v228 op_sel_hi:[1,1,0]
v_and_b32 v161, s47, v161
v_pk_fma_f16 v175, v174, v174, s48
v_pk_mul_f16 v173, v172, v173
v_pk_mul_f16 v175, v174, v175
v_fma_mix_f32 v228, v150, v150, v228 op_sel_hi:[1,1,0]
v_cvt_pkrtz_f16_f32 v164, v164, v165
v_fma_mix_f32 v228, v151, v151, v228 op_sel_hi:[1,1,0]
ds_read_u16 v163, v163
ds_read_u16 v161, v161
ds_read_b128 v[188:191], v250 offset:39936
v_cvt_pkrtz_f16_f32 v165, v166, v167
v_lshrrev_b64 v[164:165], 2, v[164:165]
v_and_b32_sdwa v166, s47, v164 dst_sel:DWORD dst_unused:UNUSED_PAD src0_sel:DWORD src1_sel:WORD_1
v_and_b32_e64 v164, s47, v164
v_exp_f16_sdwa v173, v173 dst_sel:WORD_0 dst_unused:UNUSED_PRESERVE src0_sel:WORD_0
v_mfma_f32_32x32x16_bf16 v[112:127], v[4:7], v[180:183], v[112:127]
ds_read_u16 v166, v166
ds_read_u16 v164, v164
v_fma_mix_f32 v228, v152, v152, v228 op_sel_hi:[1,1,0]
v_exp_f16_sdwa v175, v175 dst_sel:WORD_0 dst_unused:UNUSED_PRESERVE src0_sel:WORD_0
s_waitcnt lgkmcnt(7)
v_fma_mix_f32 v228, v153, v153, v228 op_sel_hi:[1,1,0]
v_and_b32_sdwa v167, s47, v165 dst_sel:DWORD dst_unused:UNUSED_PAD src0_sel:DWORD src1_sel:WORD_1
v_and_b32 v165, s47, v165
v_exp_f16_sdwa v173, v173 dst_sel:WORD_1 dst_unused:UNUSED_PRESERVE src0_sel:WORD_1
v_fma_mix_f32 v228, v154, v154, v228 op_sel_hi:[1,1,0]
v_cvt_pkrtz_f16_f32 v168, v168, v169
v_fma_mix_f32 v228, v155, v155, v228 op_sel_hi:[1,1,0]
v_cvt_pkrtz_f16_f32 v169, v170, v171
v_lshrrev_b64 v[168:169], 2, v[168:169]
ds_read_u16 v167, v167
ds_read_u16 v165, v165
v_and_b32_sdwa v170, s47, v168 dst_sel:DWORD dst_unused:UNUSED_PAD src0_sel:DWORD src1_sel:WORD_1
v_and_b32_e64 v168, s47, v168
v_exp_f16_sdwa v175, v175 dst_sel:WORD_1 dst_unused:UNUSED_PRESERVE src0_sel:WORD_1
v_mfma_f32_32x32x16_bf16 v[128:143], v[28:31], v[180:183], v[128:143]
ds_read_u16 v170, v170
ds_read_u16 v168, v168
ds_read_b128 v[176:179], v250 offset:40960
v_and_b32_sdwa v171, s47, v169 dst_sel:DWORD dst_unused:UNUSED_PAD src0_sel:DWORD src1_sel:WORD_1
v_and_b32_e64 v169, s47, v169
v_pk_add_f16 v173, v173, 1.0 op_sel_hi:[1,0]
v_pk_add_f16 v175, v175, 1.0 op_sel_hi:[1,0]
v_rcp_f16_sdwa v173, v173 dst_sel:WORD_0 dst_unused:UNUSED_PRESERVE src0_sel:WORD_0
v_mfma_f32_32x32x16_bf16 v[112:127], v[8:11], v[184:187], v[112:127]
ds_read_u16 v171, v171
ds_read_u16 v169, v169
v_rcp_f16_sdwa v175, v175 dst_sel:WORD_0 dst_unused:UNUSED_PRESERVE src0_sel:WORD_0
v_rcp_f16_sdwa v173, v173 dst_sel:WORD_1 dst_unused:UNUSED_PRESERVE src0_sel:WORD_1
v_rcp_f16_sdwa v175, v175 dst_sel:WORD_1 dst_unused:UNUSED_PRESERVE src0_sel:WORD_1
v_mfma_f32_32x32x16_bf16 v[128:143], v[32:35], v[184:187], v[128:143]
ds_read_b128 v[180:183], v250 offset:41984
v_pk_mul_f16 v172, v172, v173
v_pk_mul_f16 v174, v174, v175
v_fma_mix_f32 v229, v172, v172, v229 op_sel_hi:[1,1,0]
v_cvt_pkrtz_f16_f32 v96, v96, v97
v_fma_mix_f32 v229, v174, v174, v229 op_sel_hi:[1,1,0]
s_waitcnt lgkmcnt(7)
v_mfma_f32_32x32x16_bf16 v[112:127], v[12:15], v[188:191], v[112:127]
v_fma_mix_f32 v229, v172, v172, v229 op_sel:[1,1,0] op_sel_hi:[1,1,0]
v_cvt_pkrtz_f16_f32 v97, v98, v99
v_fma_mix_f32 v229, v174, v174, v229 op_sel:[1,1,0] op_sel_hi:[1,1,0]
v_lshrrev_b64 v[96:97], 2, v[96:97]
v_fma_mix_f32 v229, v160, v160, v229 op_sel_hi:[1,1,0]
v_and_b32_sdwa v98, s47, v96 dst_sel:DWORD dst_unused:UNUSED_PAD src0_sel:DWORD src1_sel:WORD_1
v_fma_mix_f32 v229, v161, v161, v229 op_sel_hi:[1,1,0]
v_and_b32 v96, s47, v96
v_fma_mix_f32 v229, v162, v162, v229 op_sel_hi:[1,1,0]
v_cvt_pk_f16_f32 v108, v108, v109
v_fma_mix_f32 v229, v163, v163, v229 op_sel_hi:[1,1,0]
v_cvt_pk_f16_f32 v110, v110, v111
v_pk_fma_f16 v109, v108, v108, s48
v_mfma_f32_32x32x16_bf16 v[128:143], v[36:39], v[188:191], v[128:143]
ds_read_u16 v98, v98
ds_read_u16 v96, v96
v_fma_mix_f32 v229, v164, v164, v229 op_sel_hi:[1,1,0]
v_and_b32_sdwa v99, s47, v97 dst_sel:DWORD dst_unused:UNUSED_PAD src0_sel:DWORD src1_sel:WORD_1
s_waitcnt lgkmcnt(5)
v_fma_mix_f32 v229, v165, v165, v229 op_sel_hi:[1,1,0]
v_and_b32 v97, s47, v97
v_pk_fma_f16 v111, v110, v110, s48
v_pk_mul_f16 v109, v108, v109
v_pk_mul_f16 v111, v110, v111
v_fma_mix_f32 v229, v166, v166, v229 op_sel_hi:[1,1,0]
v_cvt_pkrtz_f16_f32 v100, v100, v101
v_fma_mix_f32 v229, v167, v167, v229 op_sel_hi:[1,1,0]
ds_read_u16 v99, v99
ds_read_u16 v97, v97
s_add_u32 s46, s80, 2097152
buffer_store_dwordx4 v[4:7], v250, s[32:35], s46 offen sc1
ds_read_b128 v[184:187], v250 offset:43008
v_cvt_pkrtz_f16_f32 v101, v102, v103
v_lshrrev_b64 v[100:101], 2, v[100:101]
v_and_b32_sdwa v102, s47, v100 dst_sel:DWORD dst_unused:UNUSED_PAD src0_sel:DWORD src1_sel:WORD_1
v_and_b32_e64 v100, s47, v100
v_exp_f16_sdwa v109, v109 dst_sel:WORD_0 dst_unused:UNUSED_PRESERVE src0_sel:WORD_0
v_mfma_f32_32x32x16_bf16 v[112:127], v[16:19], v[176:179], v[112:127]
ds_read_u16 v102, v102
ds_read_u16 v100, v100
v_fma_mix_f32 v229, v168, v168, v229 op_sel_hi:[1,1,0]
v_exp_f16_sdwa v111, v111 dst_sel:WORD_0 dst_unused:UNUSED_PRESERVE src0_sel:WORD_0
s_waitcnt lgkmcnt(7)
v_fma_mix_f32 v229, v169, v169, v229 op_sel_hi:[1,1,0]
v_and_b32_sdwa v103, s47, v101 dst_sel:DWORD dst_unused:UNUSED_PAD src0_sel:DWORD src1_sel:WORD_1
v_and_b32 v101, s47, v101
v_exp_f16_sdwa v109, v109 dst_sel:WORD_1 dst_unused:UNUSED_PRESERVE src0_sel:WORD_1
v_fma_mix_f32 v229, v170, v170, v229 op_sel_hi:[1,1,0]
v_cvt_pkrtz_f16_f32 v104, v104, v105
v_fma_mix_f32 v229, v171, v171, v229 op_sel_hi:[1,1,0]
v_cvt_pkrtz_f16_f32 v105, v106, v107
v_lshrrev_b64 v[104:105], 2, v[104:105]
ds_read_u16 v103, v103
ds_read_u16 v101, v101
v_and_b32_sdwa v106, s47, v104 dst_sel:DWORD dst_unused:UNUSED_PAD src0_sel:DWORD src1_sel:WORD_1
v_and_b32_e64 v104, s47, v104
v_exp_f16_sdwa v111, v111 dst_sel:WORD_1 dst_unused:UNUSED_PRESERVE src0_sel:WORD_1
v_mfma_f32_32x32x16_bf16 v[128:143], v[40:43], v[176:179], v[128:143]
ds_read_u16 v106, v106
ds_read_u16 v104, v104
ds_read_b128 v[188:191], v250 offset:44032
v_and_b32_sdwa v107, s47, v105 dst_sel:DWORD dst_unused:UNUSED_PAD src0_sel:DWORD src1_sel:WORD_1
v_and_b32_e64 v105, s47, v105
v_pk_add_f16 v109, v109, 1.0 op_sel_hi:[1,0]
v_pk_add_f16 v111, v111, 1.0 op_sel_hi:[1,0]
v_rcp_f16_sdwa v109, v109 dst_sel:WORD_0 dst_unused:UNUSED_PRESERVE src0_sel:WORD_0
v_mfma_f32_32x32x16_bf16 v[112:127], v[20:23], v[180:183], v[112:127]
ds_read_u16 v107, v107
ds_read_u16 v105, v105
v_rcp_f16_sdwa v111, v111 dst_sel:WORD_0 dst_unused:UNUSED_PRESERVE src0_sel:WORD_0
v_rcp_f16_sdwa v109, v109 dst_sel:WORD_1 dst_unused:UNUSED_PRESERVE src0_sel:WORD_1
v_rcp_f16_sdwa v111, v111 dst_sel:WORD_1 dst_unused:UNUSED_PRESERVE src0_sel:WORD_1
v_mfma_f32_32x32x16_bf16 v[128:143], v[44:47], v[180:183], v[128:143]
ds_read_b128 v[176:179], v250 offset:45056
v_pk_mul_f16 v108, v108, v109
v_pk_mul_f16 v110, v110, v111
v_fma_mix_f32 v229, v108, v108, v229 op_sel_hi:[1,1,0]
s_nop 1
v_cvt_pkrtz_f16_f32 v112, v112, v113
v_fma_mix_f32 v229, v110, v110, v229 op_sel_hi:[1,1,0]
s_waitcnt lgkmcnt(7)
v_mfma_f32_32x32x16_bf16 v[144:159], v[0:3], v[184:187], 0
v_fma_mix_f32 v229, v108, v108, v229 op_sel:[1,1,0] op_sel_hi:[1,1,0]
v_cvt_pkrtz_f16_f32 v113, v114, v115
v_fma_mix_f32 v229, v110, v110, v229 op_sel:[1,1,0] op_sel_hi:[1,1,0]
v_lshrrev_b64 v[112:113], 2, v[112:113]
v_fma_mix_f32 v229, v96, v96, v229 op_sel_hi:[1,1,0]
v_and_b32_sdwa v114, s47, v112 dst_sel:DWORD dst_unused:UNUSED_PAD src0_sel:DWORD src1_sel:WORD_1
v_fma_mix_f32 v229, v97, v97, v229 op_sel_hi:[1,1,0]
v_and_b32_e64 v112, s47, v112
v_fma_mix_f32 v229, v98, v98, v229 op_sel_hi:[1,1,0]
v_cvt_pk_f16_f32 v124, v124, v125
v_fma_mix_f32 v229, v99, v99, v229 op_sel_hi:[1,1,0]
v_cvt_pk_f16_f32 v126, v126, v127
v_pk_fma_f16 v125, v124, v124, s48
v_mfma_f32_32x32x16_bf16 v[160:175], v[24:27], v[184:187], 0
ds_read_u16 v114, v114
ds_read_u16 v112, v112
v_fma_mix_f32 v229, v100, v100, v229 op_sel_hi:[1,1,0]
v_and_b32_sdwa v115, s47, v113 dst_sel:DWORD dst_unused:UNUSED_PAD src0_sel:DWORD src1_sel:WORD_1
s_waitcnt lgkmcnt(5)
v_fma_mix_f32 v229, v101, v101, v229 op_sel_hi:[1,1,0]
v_and_b32 v113, s47, v113
v_pk_fma_f16 v127, v126, v126, s48
v_pk_mul_f16 v125, v124, v125
v_pk_mul_f16 v127, v126, v127
v_fma_mix_f32 v229, v102, v102, v229 op_sel_hi:[1,1,0]
v_cvt_pkrtz_f16_f32 v116, v116, v117
v_fma_mix_f32 v229, v103, v103, v229 op_sel_hi:[1,1,0]
ds_read_u16 v115, v115
ds_read_u16 v113, v113
ds_read_b128 v[180:183], v250 offset:46080
v_cvt_pkrtz_f16_f32 v117, v118, v119
v_lshrrev_b64 v[116:117], 2, v[116:117]
v_and_b32_sdwa v118, s47, v116 dst_sel:DWORD dst_unused:UNUSED_PAD src0_sel:DWORD src1_sel:WORD_1
v_and_b32_e64 v116, s47, v116
v_exp_f16_sdwa v125, v125 dst_sel:WORD_0 dst_unused:UNUSED_PRESERVE src0_sel:WORD_0
v_mfma_f32_32x32x16_bf16 v[144:159], v[4:7], v[188:191], v[144:159]
ds_read_u16 v118, v118
ds_read_u16 v116, v116
v_fma_mix_f32 v229, v104, v104, v229 op_sel_hi:[1,1,0]
v_exp_f16_sdwa v127, v127 dst_sel:WORD_0 dst_unused:UNUSED_PRESERVE src0_sel:WORD_0
s_waitcnt lgkmcnt(7)
v_fma_mix_f32 v229, v105, v105, v229 op_sel_hi:[1,1,0]
v_and_b32_sdwa v119, s47, v117 dst_sel:DWORD dst_unused:UNUSED_PAD src0_sel:DWORD src1_sel:WORD_1
v_and_b32 v117, s47, v117
v_exp_f16_sdwa v125, v125 dst_sel:WORD_1 dst_unused:UNUSED_PRESERVE src0_sel:WORD_1
v_fma_mix_f32 v229, v106, v106, v229 op_sel_hi:[1,1,0]
v_cvt_pkrtz_f16_f32 v120, v120, v121
v_fma_mix_f32 v229, v107, v107, v229 op_sel_hi:[1,1,0]
v_cvt_pkrtz_f16_f32 v121, v122, v123
v_lshrrev_b64 v[120:121], 2, v[120:121]
ds_read_u16 v119, v119
ds_read_u16 v117, v117
s_add_u32 s46, s80, 4194304
buffer_store_dwordx4 v[8:11], v250, s[32:35], s46 offen sc1
v_and_b32_sdwa v122, s47, v120 dst_sel:DWORD dst_unused:UNUSED_PAD src0_sel:DWORD src1_sel:WORD_1
v_and_b32_e64 v120, s47, v120
v_exp_f16_sdwa v127, v127 dst_sel:WORD_1 dst_unused:UNUSED_PRESERVE src0_sel:WORD_1
v_mfma_f32_32x32x16_bf16 v[160:175], v[28:31], v[188:191], v[160:175]
ds_read_u16 v122, v122
ds_read_u16 v120, v120
ds_read_b128 v[184:187], v250 offset:47104
v_and_b32_sdwa v123, s47, v121 dst_sel:DWORD dst_unused:UNUSED_PAD src0_sel:DWORD src1_sel:WORD_1
v_and_b32_e64 v121, s47, v121
v_pk_add_f16 v125, v125, 1.0 op_sel_hi:[1,0]
v_pk_add_f16 v127, v127, 1.0 op_sel_hi:[1,0]
v_rcp_f16_sdwa v125, v125 dst_sel:WORD_0 dst_unused:UNUSED_PRESERVE src0_sel:WORD_0
v_mfma_f32_32x32x16_bf16 v[144:159], v[8:11], v[176:179], v[144:159]
ds_read_u16 v123, v123
ds_read_u16 v121, v121
v_rcp_f16_sdwa v127, v127 dst_sel:WORD_0 dst_unused:UNUSED_PRESERVE src0_sel:WORD_0
v_rcp_f16_sdwa v125, v125 dst_sel:WORD_1 dst_unused:UNUSED_PRESERVE src0_sel:WORD_1
v_rcp_f16_sdwa v127, v127 dst_sel:WORD_1 dst_unused:UNUSED_PRESERVE src0_sel:WORD_1
v_mfma_f32_32x32x16_bf16 v[160:175], v[32:35], v[176:179], v[160:175]
ds_read_b128 v[188:191], v250 offset:48128
v_pk_mul_f16 v124, v124, v125
v_pk_mul_f16 v126, v126, v127
v_fma_mix_f32 v230, v124, v124, v230 op_sel_hi:[1,1,0]
v_cvt_pkrtz_f16_f32 v128, v128, v129
v_fma_mix_f32 v230, v126, v126, v230 op_sel_hi:[1,1,0]
s_waitcnt lgkmcnt(7)
v_mfma_f32_32x32x16_bf16 v[144:159], v[12:15], v[180:183], v[144:159]
v_fma_mix_f32 v230, v124, v124, v230 op_sel:[1,1,0] op_sel_hi:[1,1,0]
v_cvt_pkrtz_f16_f32 v129, v130, v131
v_fma_mix_f32 v230, v126, v126, v230 op_sel:[1,1,0] op_sel_hi:[1,1,0]
v_lshrrev_b64 v[128:129], 2, v[128:129]
v_fma_mix_f32 v230, v112, v112, v230 op_sel_hi:[1,1,0]
v_and_b32_sdwa v130, s47, v128 dst_sel:DWORD dst_unused:UNUSED_PAD src0_sel:DWORD src1_sel:WORD_1
v_fma_mix_f32 v230, v113, v113, v230 op_sel_hi:[1,1,0]
v_and_b32 v128, s47, v128
v_fma_mix_f32 v230, v114, v114, v230 op_sel_hi:[1,1,0]
v_cvt_pk_f16_f32 v140, v140, v141
v_fma_mix_f32 v230, v115, v115, v230 op_sel_hi:[1,1,0]
v_cvt_pk_f16_f32 v142, v142, v143
v_pk_fma_f16 v141, v140, v140, s48
v_mfma_f32_32x32x16_bf16 v[160:175], v[36:39], v[180:183], v[160:175]
ds_read_u16 v130, v130
ds_read_u16 v128, v128
v_fma_mix_f32 v230, v116, v116, v230 op_sel_hi:[1,1,0]
v_and_b32_sdwa v131, s47, v129 dst_sel:DWORD dst_unused:UNUSED_PAD src0_sel:DWORD src1_sel:WORD_1
s_waitcnt lgkmcnt(5)
v_fma_mix_f32 v230, v117, v117, v230 op_sel_hi:[1,1,0]
v_and_b32 v129, s47, v129
v_pk_fma_f16 v143, v142, v142, s48
v_pk_mul_f16 v141, v140, v141
v_pk_mul_f16 v143, v142, v143
v_fma_mix_f32 v230, v118, v118, v230 op_sel_hi:[1,1,0]
v_cvt_pkrtz_f16_f32 v132, v132, v133
v_fma_mix_f32 v230, v119, v119, v230 op_sel_hi:[1,1,0]
ds_read_u16 v131, v131
ds_read_u16 v129, v129
ds_read_b128 v[176:179], v250 offset:49152
v_cvt_pkrtz_f16_f32 v133, v134, v135
v_lshrrev_b64 v[132:133], 2, v[132:133]
v_and_b32_sdwa v134, s47, v132 dst_sel:DWORD dst_unused:UNUSED_PAD src0_sel:DWORD src1_sel:WORD_1
v_and_b32_e64 v132, s47, v132
v_exp_f16_sdwa v141, v141 dst_sel:WORD_0 dst_unused:UNUSED_PRESERVE src0_sel:WORD_0
v_mfma_f32_32x32x16_bf16 v[144:159], v[16:19], v[184:187], v[144:159]
ds_read_u16 v134, v134
ds_read_u16 v132, v132
v_fma_mix_f32 v230, v120, v120, v230 op_sel_hi:[1,1,0]
v_exp_f16_sdwa v143, v143 dst_sel:WORD_0 dst_unused:UNUSED_PRESERVE src0_sel:WORD_0
s_waitcnt lgkmcnt(7)
v_fma_mix_f32 v230, v121, v121, v230 op_sel_hi:[1,1,0]
v_and_b32_sdwa v135, s47, v133 dst_sel:DWORD dst_unused:UNUSED_PAD src0_sel:DWORD src1_sel:WORD_1
v_and_b32 v133, s47, v133
v_exp_f16_sdwa v141, v141 dst_sel:WORD_1 dst_unused:UNUSED_PRESERVE src0_sel:WORD_1
v_fma_mix_f32 v230, v122, v122, v230 op_sel_hi:[1,1,0]
v_cvt_pkrtz_f16_f32 v136, v136, v137
v_fma_mix_f32 v230, v123, v123, v230 op_sel_hi:[1,1,0]
v_cvt_pkrtz_f16_f32 v137, v138, v139
v_lshrrev_b64 v[136:137], 2, v[136:137]
ds_read_u16 v135, v135
ds_read_u16 v133, v133
v_and_b32_sdwa v138, s47, v136 dst_sel:DWORD dst_unused:UNUSED_PAD src0_sel:DWORD src1_sel:WORD_1
v_and_b32_e64 v136, s47, v136
v_exp_f16_sdwa v143, v143 dst_sel:WORD_1 dst_unused:UNUSED_PRESERVE src0_sel:WORD_1
v_mfma_f32_32x32x16_bf16 v[160:175], v[40:43], v[184:187], v[160:175]
ds_read_u16 v138, v138
ds_read_u16 v136, v136
ds_read_b128 v[180:183], v250 offset:50176
v_and_b32_sdwa v139, s47, v137 dst_sel:DWORD dst_unused:UNUSED_PAD src0_sel:DWORD src1_sel:WORD_1
v_and_b32_e64 v137, s47, v137
v_pk_add_f16 v141, v141, 1.0 op_sel_hi:[1,0]
v_pk_add_f16 v143, v143, 1.0 op_sel_hi:[1,0]
v_rcp_f16_sdwa v141, v141 dst_sel:WORD_0 dst_unused:UNUSED_PRESERVE src0_sel:WORD_0
v_mfma_f32_32x32x16_bf16 v[144:159], v[20:23], v[188:191], v[144:159]
ds_read_u16 v139, v139
ds_read_u16 v137, v137
s_add_u32 s46, s80, 6291456
buffer_store_dwordx4 v[12:15], v250, s[32:35], s46 offen sc1
v_rcp_f16_sdwa v143, v143 dst_sel:WORD_0 dst_unused:UNUSED_PRESERVE src0_sel:WORD_0
v_rcp_f16_sdwa v141, v141 dst_sel:WORD_1 dst_unused:UNUSED_PRESERVE src0_sel:WORD_1
v_rcp_f16_sdwa v143, v143 dst_sel:WORD_1 dst_unused:UNUSED_PRESERVE src0_sel:WORD_1
v_mfma_f32_32x32x16_bf16 v[160:175], v[44:47], v[188:191], v[160:175]
ds_read_b128 v[184:187], v250 offset:51200
v_pk_mul_f16 v140, v140, v141
v_pk_mul_f16 v142, v142, v143
v_fma_mix_f32 v230, v140, v140, v230 op_sel_hi:[1,1,0]
v_cvt_pkrtz_f16_f32 v144, v144, v145
v_fma_mix_f32 v230, v142, v142, v230 op_sel_hi:[1,1,0]
s_waitcnt lgkmcnt(7)
v_mfma_f32_32x32x16_bf16 v[96:111], v[0:3], v[176:179], 0
v_fma_mix_f32 v230, v140, v140, v230 op_sel:[1,1,0] op_sel_hi:[1,1,0]
v_cvt_pkrtz_f16_f32 v145, v146, v147
v_fma_mix_f32 v230, v142, v142, v230 op_sel:[1,1,0] op_sel_hi:[1,1,0]
v_lshrrev_b64 v[144:145], 2, v[144:145]
v_fma_mix_f32 v230, v128, v128, v230 op_sel_hi:[1,1,0]
v_and_b32_sdwa v146, s47, v144 dst_sel:DWORD dst_unused:UNUSED_PAD src0_sel:DWORD src1_sel:WORD_1
v_fma_mix_f32 v230, v129, v129, v230 op_sel_hi:[1,1,0]
v_and_b32 v144, s47, v144
v_fma_mix_f32 v230, v130, v130, v230 op_sel_hi:[1,1,0]
v_cvt_pk_f16_f32 v156, v156, v157
v_fma_mix_f32 v230, v131, v131, v230 op_sel_hi:[1,1,0]
v_cvt_pk_f16_f32 v158, v158, v159
v_pk_fma_f16 v157, v156, v156, s48
v_mfma_f32_32x32x16_bf16 v[112:127], v[24:27], v[176:179], 0
ds_read_u16 v146, v146
ds_read_u16 v144, v144
v_fma_mix_f32 v230, v132, v132, v230 op_sel_hi:[1,1,0]
v_and_b32_sdwa v147, s47, v145 dst_sel:DWORD dst_unused:UNUSED_PAD src0_sel:DWORD src1_sel:WORD_1
s_waitcnt lgkmcnt(5)
v_fma_mix_f32 v230, v133, v133, v230 op_sel_hi:[1,1,0]
v_and_b32 v145, s47, v145
v_pk_fma_f16 v159, v158, v158, s48
v_pk_mul_f16 v157, v156, v157
v_pk_mul_f16 v159, v158, v159
v_fma_mix_f32 v230, v134, v134, v230 op_sel_hi:[1,1,0]
v_cvt_pkrtz_f16_f32 v148, v148, v149
v_fma_mix_f32 v230, v135, v135, v230 op_sel_hi:[1,1,0]
ds_read_u16 v147, v147
ds_read_u16 v145, v145
ds_read_b128 v[188:191], v250 offset:52224
v_cvt_pkrtz_f16_f32 v149, v150, v151
v_lshrrev_b64 v[148:149], 2, v[148:149]
v_and_b32_sdwa v150, s47, v148 dst_sel:DWORD dst_unused:UNUSED_PAD src0_sel:DWORD src1_sel:WORD_1
v_and_b32_e64 v148, s47, v148
v_exp_f16_sdwa v157, v157 dst_sel:WORD_0 dst_unused:UNUSED_PRESERVE src0_sel:WORD_0
v_mfma_f32_32x32x16_bf16 v[96:111], v[4:7], v[180:183], v[96:111]
ds_read_u16 v150, v150
ds_read_u16 v148, v148
v_fma_mix_f32 v230, v136, v136, v230 op_sel_hi:[1,1,0]
v_exp_f16_sdwa v159, v159 dst_sel:WORD_0 dst_unused:UNUSED_PRESERVE src0_sel:WORD_0
s_waitcnt lgkmcnt(7)
v_fma_mix_f32 v230, v137, v137, v230 op_sel_hi:[1,1,0]
v_and_b32_sdwa v151, s47, v149 dst_sel:DWORD dst_unused:UNUSED_PAD src0_sel:DWORD src1_sel:WORD_1
v_and_b32 v149, s47, v149
v_exp_f16_sdwa v157, v157 dst_sel:WORD_1 dst_unused:UNUSED_PRESERVE src0_sel:WORD_1
v_fma_mix_f32 v230, v138, v138, v230 op_sel_hi:[1,1,0]
v_cvt_pkrtz_f16_f32 v152, v152, v153
v_fma_mix_f32 v230, v139, v139, v230 op_sel_hi:[1,1,0]
v_cvt_pkrtz_f16_f32 v153, v154, v155
v_lshrrev_b64 v[152:153], 2, v[152:153]
ds_read_u16 v151, v151
ds_read_u16 v149, v149
v_and_b32_sdwa v154, s47, v152 dst_sel:DWORD dst_unused:UNUSED_PAD src0_sel:DWORD src1_sel:WORD_1
v_and_b32_e64 v152, s47, v152
v_exp_f16_sdwa v159, v159 dst_sel:WORD_1 dst_unused:UNUSED_PRESERVE src0_sel:WORD_1
v_mfma_f32_32x32x16_bf16 v[112:127], v[28:31], v[180:183], v[112:127]
ds_read_u16 v154, v154
ds_read_u16 v152, v152
ds_read_b128 v[176:179], v250 offset:53248
v_and_b32_sdwa v155, s47, v153 dst_sel:DWORD dst_unused:UNUSED_PAD src0_sel:DWORD src1_sel:WORD_1
v_and_b32_e64 v153, s47, v153
v_pk_add_f16 v157, v157, 1.0 op_sel_hi:[1,0]
v_pk_add_f16 v159, v159, 1.0 op_sel_hi:[1,0]
v_rcp_f16_sdwa v157, v157 dst_sel:WORD_0 dst_unused:UNUSED_PRESERVE src0_sel:WORD_0
v_mfma_f32_32x32x16_bf16 v[96:111], v[8:11], v[184:187], v[96:111]
ds_read_u16 v155, v155
ds_read_u16 v153, v153
v_rcp_f16_sdwa v159, v159 dst_sel:WORD_0 dst_unused:UNUSED_PRESERVE src0_sel:WORD_0
v_rcp_f16_sdwa v157, v157 dst_sel:WORD_1 dst_unused:UNUSED_PRESERVE src0_sel:WORD_1
s_add_u32 s46, s80, 8388608
buffer_store_dwordx4 v[16:19], v250, s[32:35], s46 offen sc1
v_rcp_f16_sdwa v159, v159 dst_sel:WORD_1 dst_unused:UNUSED_PRESERVE src0_sel:WORD_1
v_mfma_f32_32x32x16_bf16 v[112:127], v[32:35], v[184:187], v[112:127]
ds_read_b128 v[180:183], v250 offset:54272
v_pk_mul_f16 v156, v156, v157
v_pk_mul_f16 v158, v158, v159
v_fma_mix_f32 v231, v156, v156, v231 op_sel_hi:[1,1,0]
v_cvt_pkrtz_f16_f32 v160, v160, v161
v_fma_mix_f32 v231, v158, v158, v231 op_sel_hi:[1,1,0]
s_waitcnt lgkmcnt(7)
v_mfma_f32_32x32x16_bf16 v[96:111], v[12:15], v[188:191], v[96:111]
v_fma_mix_f32 v231, v156, v156, v231 op_sel:[1,1,0] op_sel_hi:[1,1,0]
v_cvt_pkrtz_f16_f32 v161, v162, v163
v_fma_mix_f32 v231, v158, v158, v231 op_sel:[1,1,0] op_sel_hi:[1,1,0]
v_lshrrev_b64 v[160:161], 2, v[160:161]
v_fma_mix_f32 v231, v144, v144, v231 op_sel_hi:[1,1,0]
v_and_b32_sdwa v162, s47, v160 dst_sel:DWORD dst_unused:UNUSED_PAD src0_sel:DWORD src1_sel:WORD_1
v_fma_mix_f32 v231, v145, v145, v231 op_sel_hi:[1,1,0]
v_and_b32 v160, s47, v160
v_fma_mix_f32 v231, v146, v146, v231 op_sel_hi:[1,1,0]
v_cvt_pk_f16_f32 v172, v172, v173
v_fma_mix_f32 v231, v147, v147, v231 op_sel_hi:[1,1,0]
v_cvt_pk_f16_f32 v174, v174, v175
v_pk_fma_f16 v173, v172, v172, s48
v_mfma_f32_32x32x16_bf16 v[112:127], v[36:39], v[188:191], v[112:127]
ds_read_u16 v162, v162
ds_read_u16 v160, v160
v_fma_mix_f32 v231, v148, v148, v231 op_sel_hi:[1,1,0]
v_and_b32_sdwa v163, s47, v161 dst_sel:DWORD dst_unused:UNUSED_PAD src0_sel:DWORD src1_sel:WORD_1
s_waitcnt lgkmcnt(5)
v_fma_mix_f32 v231, v149, v149, v231 op_sel_hi:[1,1,0]
v_and_b32 v161, s47, v161
v_pk_fma_f16 v175, v174, v174, s48
v_pk_mul_f16 v173, v172, v173
v_pk_mul_f16 v175, v174, v175
v_fma_mix_f32 v231, v150, v150, v231 op_sel_hi:[1,1,0]
v_cvt_pkrtz_f16_f32 v164, v164, v165
v_fma_mix_f32 v231, v151, v151, v231 op_sel_hi:[1,1,0]
ds_read_u16 v163, v163
ds_read_u16 v161, v161
ds_read_b128 v[184:187], v250 offset:55296
v_cvt_pkrtz_f16_f32 v165, v166, v167
v_lshrrev_b64 v[164:165], 2, v[164:165]
v_and_b32_sdwa v166, s47, v164 dst_sel:DWORD dst_unused:UNUSED_PAD src0_sel:DWORD src1_sel:WORD_1
v_and_b32_e64 v164, s47, v164
v_exp_f16_sdwa v173, v173 dst_sel:WORD_0 dst_unused:UNUSED_PRESERVE src0_sel:WORD_0
v_mfma_f32_32x32x16_bf16 v[96:111], v[16:19], v[176:179], v[96:111]
ds_read_u16 v166, v166
ds_read_u16 v164, v164
v_fma_mix_f32 v231, v152, v152, v231 op_sel_hi:[1,1,0]
v_exp_f16_sdwa v175, v175 dst_sel:WORD_0 dst_unused:UNUSED_PRESERVE src0_sel:WORD_0
s_waitcnt lgkmcnt(7)
v_fma_mix_f32 v231, v153, v153, v231 op_sel_hi:[1,1,0]
v_and_b32_sdwa v167, s47, v165 dst_sel:DWORD dst_unused:UNUSED_PAD src0_sel:DWORD src1_sel:WORD_1
v_and_b32 v165, s47, v165
v_exp_f16_sdwa v173, v173 dst_sel:WORD_1 dst_unused:UNUSED_PRESERVE src0_sel:WORD_1
v_fma_mix_f32 v231, v154, v154, v231 op_sel_hi:[1,1,0]
v_cvt_pkrtz_f16_f32 v168, v168, v169
v_fma_mix_f32 v231, v155, v155, v231 op_sel_hi:[1,1,0]
v_cvt_pkrtz_f16_f32 v169, v170, v171
v_lshrrev_b64 v[168:169], 2, v[168:169]
ds_read_u16 v167, v167
ds_read_u16 v165, v165
v_and_b32_sdwa v170, s47, v168 dst_sel:DWORD dst_unused:UNUSED_PAD src0_sel:DWORD src1_sel:WORD_1
v_and_b32_e64 v168, s47, v168
v_exp_f16_sdwa v175, v175 dst_sel:WORD_1 dst_unused:UNUSED_PRESERVE src0_sel:WORD_1
v_mfma_f32_32x32x16_bf16 v[112:127], v[40:43], v[176:179], v[112:127]
ds_read_u16 v170, v170
ds_read_u16 v168, v168
ds_read_b128 v[188:191], v250 offset:56320
v_and_b32_sdwa v171, s47, v169 dst_sel:DWORD dst_unused:UNUSED_PAD src0_sel:DWORD src1_sel:WORD_1
v_and_b32_e64 v169, s47, v169
v_pk_add_f16 v173, v173, 1.0 op_sel_hi:[1,0]
v_pk_add_f16 v175, v175, 1.0 op_sel_hi:[1,0]
v_rcp_f16_sdwa v173, v173 dst_sel:WORD_0 dst_unused:UNUSED_PRESERVE src0_sel:WORD_0
v_mfma_f32_32x32x16_bf16 v[96:111], v[20:23], v[180:183], v[96:111]
ds_read_u16 v171, v171
ds_read_u16 v169, v169
v_rcp_f16_sdwa v175, v175 dst_sel:WORD_0 dst_unused:UNUSED_PRESERVE src0_sel:WORD_0
v_rcp_f16_sdwa v173, v173 dst_sel:WORD_1 dst_unused:UNUSED_PRESERVE src0_sel:WORD_1
v_rcp_f16_sdwa v175, v175 dst_sel:WORD_1 dst_unused:UNUSED_PRESERVE src0_sel:WORD_1
v_mfma_f32_32x32x16_bf16 v[112:127], v[44:47], v[180:183], v[112:127]
ds_read_b128 v[176:179], v250 offset:57344
v_pk_mul_f16 v172, v172, v173
v_pk_mul_f16 v174, v174, v175
v_fma_mix_f32 v231, v172, v172, v231 op_sel_hi:[1,1,0]
s_add_u32 s46, s80, 10485760
buffer_store_dwordx4 v[20:23], v250, s[32:35], s46 offen sc1
v_fma_mix_f32 v231, v174, v174, v231 op_sel_hi:[1,1,0]
s_waitcnt lgkmcnt(7)
v_mfma_f32_32x32x16_bf16 v[128:143], v[0:3], v[184:187], 0
v_fma_mix_f32 v231, v172, v172, v231 op_sel:[1,1,0] op_sel_hi:[1,1,0]
v_cvt_pkrtz_f16_f32 v96, v96, v97
v_fma_mix_f32 v231, v174, v174, v231 op_sel:[1,1,0] op_sel_hi:[1,1,0]
v_cvt_pkrtz_f16_f32 v97, v98, v99
v_fma_mix_f32 v231, v160, v160, v231 op_sel_hi:[1,1,0]
v_lshrrev_b64 v[96:97], 2, v[96:97]
v_fma_mix_f32 v231, v161, v161, v231 op_sel_hi:[1,1,0]
v_and_b32_sdwa v98, s47, v96 dst_sel:DWORD dst_unused:UNUSED_PAD src0_sel:DWORD src1_sel:WORD_1
v_fma_mix_f32 v231, v162, v162, v231 op_sel_hi:[1,1,0]
v_and_b32 v96, s47, v96
v_fma_mix_f32 v231, v163, v163, v231 op_sel_hi:[1,1,0]
v_cvt_pk_f16_f32 v108, v108, v109
v_cvt_pk_f16_f32 v110, v110, v111
v_pk_fma_f16 v109, v108, v108, s48
v_mfma_f32_32x32x16_bf16 v[144:159], v[24:27], v[184:187], 0
ds_read_u16 v98, v98
ds_read_u16 v96, v96
v_fma_mix_f32 v231, v164, v164, v231 op_sel_hi:[1,1,0]
v_and_b32_sdwa v99, s47, v97 dst_sel:DWORD dst_unused:UNUSED_PAD src0_sel:DWORD src1_sel:WORD_1
s_waitcnt lgkmcnt(5)
v_fma_mix_f32 v231, v165, v165, v231 op_sel_hi:[1,1,0]
v_and_b32 v97, s47, v97
v_pk_fma_f16 v111, v110, v110, s48
v_pk_mul_f16 v109, v108, v109
v_pk_mul_f16 v111, v110, v111
v_fma_mix_f32 v231, v166, v166, v231 op_sel_hi:[1,1,0]
v_cvt_pkrtz_f16_f32 v100, v100, v101
v_fma_mix_f32 v231, v167, v167, v231 op_sel_hi:[1,1,0]
ds_read_u16 v99, v99
ds_read_u16 v97, v97
ds_read_b128 v[180:183], v250 offset:58368
v_cvt_pkrtz_f16_f32 v101, v102, v103
v_lshrrev_b64 v[100:101], 2, v[100:101]
v_and_b32_sdwa v102, s47, v100 dst_sel:DWORD dst_unused:UNUSED_PAD src0_sel:DWORD src1_sel:WORD_1
v_and_b32_e64 v100, s47, v100
v_exp_f16_sdwa v109, v109 dst_sel:WORD_0 dst_unused:UNUSED_PRESERVE src0_sel:WORD_0
v_mfma_f32_32x32x16_bf16 v[128:143], v[4:7], v[188:191], v[128:143]
ds_read_u16 v102, v102
ds_read_u16 v100, v100
v_fma_mix_f32 v231, v168, v168, v231 op_sel_hi:[1,1,0]
v_exp_f16_sdwa v111, v111 dst_sel:WORD_0 dst_unused:UNUSED_PRESERVE src0_sel:WORD_0
s_waitcnt lgkmcnt(7)
v_fma_mix_f32 v231, v169, v169, v231 op_sel_hi:[1,1,0]
v_and_b32_sdwa v103, s47, v101 dst_sel:DWORD dst_unused:UNUSED_PAD src0_sel:DWORD src1_sel:WORD_1
v_and_b32 v101, s47, v101
v_exp_f16_sdwa v109, v109 dst_sel:WORD_1 dst_unused:UNUSED_PRESERVE src0_sel:WORD_1
v_fma_mix_f32 v231, v170, v170, v231 op_sel_hi:[1,1,0]
v_cvt_pkrtz_f16_f32 v104, v104, v105
v_fma_mix_f32 v231, v171, v171, v231 op_sel_hi:[1,1,0]
v_cvt_pkrtz_f16_f32 v105, v106, v107
v_lshrrev_b64 v[104:105], 2, v[104:105]
ds_read_u16 v103, v103
ds_read_u16 v101, v101
v_and_b32_sdwa v106, s47, v104 dst_sel:DWORD dst_unused:UNUSED_PAD src0_sel:DWORD src1_sel:WORD_1
v_and_b32_e64 v104, s47, v104
v_exp_f16_sdwa v111, v111 dst_sel:WORD_1 dst_unused:UNUSED_PRESERVE src0_sel:WORD_1
v_mfma_f32_32x32x16_bf16 v[144:159], v[28:31], v[188:191], v[144:159]
ds_read_u16 v106, v106
ds_read_u16 v104, v104
ds_read_b128 v[184:187], v250 offset:59392
v_and_b32_sdwa v107, s47, v105 dst_sel:DWORD dst_unused:UNUSED_PAD src0_sel:DWORD src1_sel:WORD_1
v_and_b32_e64 v105, s47, v105
v_pk_add_f16 v109, v109, 1.0 op_sel_hi:[1,0]
v_pk_add_f16 v111, v111, 1.0 op_sel_hi:[1,0]
v_rcp_f16_sdwa v109, v109 dst_sel:WORD_0 dst_unused:UNUSED_PRESERVE src0_sel:WORD_0
v_mfma_f32_32x32x16_bf16 v[128:143], v[8:11], v[176:179], v[128:143]
ds_read_u16 v107, v107
ds_read_u16 v105, v105
v_rcp_f16_sdwa v111, v111 dst_sel:WORD_0 dst_unused:UNUSED_PRESERVE src0_sel:WORD_0
v_rcp_f16_sdwa v109, v109 dst_sel:WORD_1 dst_unused:UNUSED_PRESERVE src0_sel:WORD_1
v_rcp_f16_sdwa v111, v111 dst_sel:WORD_1 dst_unused:UNUSED_PRESERVE src0_sel:WORD_1
v_mfma_f32_32x32x16_bf16 v[144:159], v[32:35], v[176:179], v[144:159]
ds_read_b128 v[188:191], v250 offset:60416
v_pk_mul_f16 v108, v108, v109
v_pk_mul_f16 v110, v110, v111
v_fma_mix_f32 v232, v108, v108, v232 op_sel_hi:[1,1,0]
v_add_u32_e64 v222, s83, v247
v_mov_b32 v223, 0
s_branch Law4
Lax4:
s_sleep 2
Law4:
ds_read_b32 v223, v222 offset:20
s_sub_u32 s76, s76, 1
s_cselect_b32 s44, 4, 0
s_cselect_b32 s76, 0, s76
s_waitcnt lgkmcnt(0)
v_readfirstlane_b32 s43, v223
s_nop 1
s_max_u32 s43, s43, s44
s_cmp_lt_u32 s43, 4
s_cbranch_scc1 Lax4
v_mfma_f32_32x32x16_bf16 v[128:143], v[12:15], v[180:183], v[128:143]
s_add_u32 s81, s81, 6592
s_cmp_eq_u32 s81, 65920
s_cselect_b32 s81, 0, s81
s_add_u32 s43, s81, s67
s_add_u32 m0, s43, 16
s_add_u32 s66, s66, 98304
buffer_load_dwordx4 v236, s[4:7], s66 offen lds
s_add_u32 m0, s43, 912
s_nop 0
buffer_load_dwordx4 v237, s[4:7], s66 offen lds
v_fma_mix_f32 v232, v110, v110, v232 op_sel_hi:[1,1,0]
v_cvt_pkrtz_f16_f32 v112, v112, v113
v_fma_mix_f32 v232, v108, v108, v232 op_sel:[1,1,0] op_sel_hi:[1,1,0]
v_cvt_pkrtz_f16_f32 v113, v114, v115
v_fma_mix_f32 v232, v110, v110, v232 op_sel:[1,1,0] op_sel_hi:[1,1,0]
v_lshrrev_b64 v[112:113], 2, v[112:113]
v_fma_mix_f32 v232, v96, v96, v232 op_sel_hi:[1,1,0]
v_and_b32_sdwa v114, s47, v112 dst_sel:DWORD dst_unused:UNUSED_PAD src0_sel:DWORD src1_sel:WORD_1
v_fma_mix_f32 v232, v97, v97, v232 op_sel_hi:[1,1,0]
v_and_b32_e64 v112, s47, v112
v_fma_mix_f32 v232, v98, v98, v232 op_sel_hi:[1,1,0]
v_cvt_pk_f16_f32 v124, v124, v125
v_fma_mix_f32 v232, v99, v99, v232 op_sel_hi:[1,1,0]
v_cvt_pk_f16_f32 v126, v126, v127
v_pk_fma_f16 v125, v124, v124, s48
v_mfma_f32_32x32x16_bf16 v[144:159], v[36:39], v[180:183], v[144:159]
ds_read_u16 v114, v114
ds_read_u16 v112, v112
v_fma_mix_f32 v232, v100, v100, v232 op_sel_hi:[1,1,0]
v_and_b32_sdwa v115, s47, v113 dst_sel:DWORD dst_unused:UNUSED_PAD src0_sel:DWORD src1_sel:WORD_1
v_fma_mix_f32 v232, v101, v101, v232 op_sel_hi:[1,1,0]
v_and_b32_e64 v113, s47, v113
v_pk_fma_f16 v127, v126, v126, s48
v_pk_mul_f16 v125, v124, v125
v_pk_mul_f16 v127, v126, v127
v_fma_mix_f32 v232, v102, v102, v232 op_sel_hi:[1,1,0]
v_cvt_pkrtz_f16_f32 v116, v116, v117
v_fma_mix_f32 v232, v103, v103, v232 op_sel_hi:[1,1,0]
ds_read_u16 v115, v115
ds_read_u16 v113, v113
ds_read_b128 v[176:179], v250 offset:61440
v_cvt_pkrtz_f16_f32 v117, v118, v119
v_lshrrev_b64 v[116:117], 2, v[116:117]
v_and_b32_sdwa v118, s47, v116 dst_sel:DWORD dst_unused:UNUSED_PAD src0_sel:DWORD src1_sel:WORD_1
v_and_b32_e64 v116, s47, v116
v_exp_f16_sdwa v125, v125 dst_sel:WORD_0 dst_unused:UNUSED_PRESERVE src0_sel:WORD_0
v_mfma_f32_32x32x16_bf16 v[128:143], v[16:19], v[184:187], v[128:143]
ds_read_u16 v118, v118
ds_read_u16 v116, v116
s_add_u32 s81, s81, 6592
s_cmp_eq_u32 s81, 65920
s_cselect_b32 s81, 0, s81
s_add_u32 s43, s81, s67
s_add_u32 m0, s43, 16
s_add_u32 s66, s66, 98304
buffer_load_dwordx4 v236, s[4:7], s66 offen lds
s_add_u32 m0, s43, 912
s_nop 0
buffer_load_dwordx4 v237, s[4:7], s66 offen lds
v_fma_mix_f32 v232, v104, v104, v232 op_sel_hi:[1,1,0]
v_exp_f16_sdwa v127, v127 dst_sel:WORD_0 dst_unused:UNUSED_PRESERVE src0_sel:WORD_0
v_fma_mix_f32 v232, v105, v105, v232 op_sel_hi:[1,1,0]
v_and_b32_sdwa v119, s47, v117 dst_sel:DWORD dst_unused:UNUSED_PAD src0_sel:DWORD src1_sel:WORD_1
v_and_b32_e64 v117, s47, v117
v_exp_f16_sdwa v125, v125 dst_sel:WORD_1 dst_unused:UNUSED_PRESERVE src0_sel:WORD_1
v_fma_mix_f32 v232, v106, v106, v232 op_sel_hi:[1,1,0]
v_cvt_pkrtz_f16_f32 v120, v120, v121
v_fma_mix_f32 v232, v107, v107, v232 op_sel_hi:[1,1,0]
v_cvt_pkrtz_f16_f32 v121, v122, v123
v_lshrrev_b64 v[120:121], 2, v[120:121]
ds_read_u16 v119, v119
ds_read_u16 v117, v117
v_and_b32_sdwa v122, s47, v120 dst_sel:DWORD dst_unused:UNUSED_PAD src0_sel:DWORD src1_sel:WORD_1
v_and_b32_e64 v120, s47, v120
v_exp_f16_sdwa v127, v127 dst_sel:WORD_1 dst_unused:UNUSED_PRESERVE src0_sel:WORD_1
v_mfma_f32_32x32x16_bf16 v[144:159], v[40:43], v[184:187], v[144:159]
ds_read_u16 v122, v122
ds_read_u16 v120, v120
ds_read_b128 v[180:183], v250 offset:62464
v_and_b32_sdwa v123, s47, v121 dst_sel:DWORD dst_unused:UNUSED_PAD src0_sel:DWORD src1_sel:WORD_1
v_and_b32_e64 v121, s47, v121
v_pk_add_f16 v125, v125, 1.0 op_sel_hi:[1,0]
v_pk_add_f16 v127, v127, 1.0 op_sel_hi:[1,0]
v_rcp_f16_sdwa v125, v125 dst_sel:WORD_0 dst_unused:UNUSED_PRESERVE src0_sel:WORD_0
v_mfma_f32_32x32x16_bf16 v[128:143], v[20:23], v[188:191], v[128:143]
ds_read_u16 v123, v123
ds_read_u16 v121, v121
s_add_u32 s81, s81, 6592
s_cmp_eq_u32 s81, 65920
s_cselect_b32 s81, 0, s81
s_add_u32 s43, s81, s67
s_add_u32 m0, s43, 32
s_add_u32 s66, s66, 98304
buffer_load_dwordx4 v236, s[4:7], s66 offen lds
s_add_u32 m0, s43, 928
s_nop 0
buffer_load_dwordx4 v237, s[4:7], s66 offen lds
v_rcp_f16_sdwa v127, v127 dst_sel:WORD_0 dst_unused:UNUSED_PRESERVE src0_sel:WORD_0
v_rcp_f16_sdwa v125, v125 dst_sel:WORD_1 dst_unused:UNUSED_PRESERVE src0_sel:WORD_1
v_rcp_f16_sdwa v127, v127 dst_sel:WORD_1 dst_unused:UNUSED_PRESERVE src0_sel:WORD_1
v_mfma_f32_32x32x16_bf16 v[144:159], v[44:47], v[188:191], v[144:159]
ds_read_b128 v[184:187], v250 offset:63488
v_pk_mul_f16 v124, v124, v125
v_pk_mul_f16 v126, v126, v127
s_add_u32 s81, s81, 6592
s_cmp_eq_u32 s81, 65920
s_cselect_b32 s81, 0, s81
s_add_u32 s43, s81, s67
s_add_u32 m0, s43, 32
s_add_u32 s66, s66, 98304
buffer_load_dwordx4 v236, s[4:7], s66 offen lds
s_add_u32 m0, s43, 928
s_nop 0
buffer_load_dwordx4 v237, s[4:7], s66 offen lds
v_fma_mix_f32 v232, v124, v124, v232 op_sel_hi:[1,1,0]
v_cvt_pkrtz_f16_f32 v128, v128, v129
s_waitcnt lgkmcnt(7)
v_mfma_f32_32x32x16_bf16 v[160:175], v[0:3], v[176:179], 0
v_fma_mix_f32 v232, v126, v126, v232 op_sel_hi:[1,1,0]
v_cvt_pkrtz_f16_f32 v129, v130, v131
v_fma_mix_f32 v232, v124, v124, v232 op_sel:[1,1,0] op_sel_hi:[1,1,0]
v_lshrrev_b64 v[128:129], 2, v[128:129]
v_fma_mix_f32 v232, v126, v126, v232 op_sel:[1,1,0] op_sel_hi:[1,1,0]
v_and_b32_sdwa v130, s47, v128 dst_sel:DWORD dst_unused:UNUSED_PAD src0_sel:DWORD src1_sel:WORD_1
v_fma_mix_f32 v232, v112, v112, v232 op_sel_hi:[1,1,0]
v_and_b32 v128, s47, v128
v_fma_mix_f32 v232, v113, v113, v232 op_sel_hi:[1,1,0]
v_cvt_pk_f16_f32 v140, v140, v141
v_fma_mix_f32 v232, v114, v114, v232 op_sel_hi:[1,1,0]
v_cvt_pk_f16_f32 v142, v142, v143
v_fma_mix_f32 v232, v115, v115, v232 op_sel_hi:[1,1,0]
v_pk_fma_f16 v141, v140, v140, s48
v_mfma_f32_32x32x16_bf16 v[96:111], v[24:27], v[176:179], 0
ds_read_u16 v130, v130
ds_read_u16 v128, v128
v_fma_mix_f32 v232, v116, v116, v232 op_sel_hi:[1,1,0]
v_and_b32_sdwa v131, s47, v129 dst_sel:DWORD dst_unused:UNUSED_PAD src0_sel:DWORD src1_sel:WORD_1
s_waitcnt lgkmcnt(5)
v_fma_mix_f32 v232, v117, v117, v232 op_sel_hi:[1,1,0]
v_and_b32 v129, s47, v129
v_pk_fma_f16 v143, v142, v142, s48
v_pk_mul_f16 v141, v140, v141
v_pk_mul_f16 v143, v142, v143
v_fma_mix_f32 v232, v118, v118, v232 op_sel_hi:[1,1,0]
v_cvt_pkrtz_f16_f32 v132, v132, v133
v_fma_mix_f32 v232, v119, v119, v232 op_sel_hi:[1,1,0]
ds_read_u16 v131, v131
ds_read_u16 v129, v129
ds_read_b128 v[188:191], v250 offset:64512
s_add_u32 s81, s81, 6592
s_cmp_eq_u32 s81, 65920
s_cselect_b32 s81, 0, s81
s_add_u32 s43, s81, s67
s_add_u32 m0, s43, 48
s_add_u32 s66, s66, 98304
buffer_load_dwordx4 v236, s[4:7], s66 offen lds
s_add_u32 m0, s43, 944
s_nop 0
buffer_load_dwordx4 v237, s[4:7], s66 offen lds
v_cvt_pkrtz_f16_f32 v133, v134, v135
v_lshrrev_b64 v[132:133], 2, v[132:133]
v_and_b32_sdwa v134, s47, v132 dst_sel:DWORD dst_unused:UNUSED_PAD src0_sel:DWORD src1_sel:WORD_1
v_and_b32_e64 v132, s47, v132
v_exp_f16_sdwa v141, v141 dst_sel:WORD_0 dst_unused:UNUSED_PRESERVE src0_sel:WORD_0
v_mfma_f32_32x32x16_bf16 v[160:175], v[4:7], v[180:183], v[160:175]
ds_read_u16 v134, v134
ds_read_u16 v132, v132
v_fma_mix_f32 v232, v120, v120, v232 op_sel_hi:[1,1,0]
v_exp_f16_sdwa v143, v143 dst_sel:WORD_0 dst_unused:UNUSED_PRESERVE src0_sel:WORD_0
s_waitcnt lgkmcnt(7)
v_fma_mix_f32 v232, v121, v121, v232 op_sel_hi:[1,1,0]
v_and_b32_sdwa v135, s47, v133 dst_sel:DWORD dst_unused:UNUSED_PAD src0_sel:DWORD src1_sel:WORD_1
v_and_b32 v133, s47, v133
v_exp_f16_sdwa v141, v141 dst_sel:WORD_1 dst_unused:UNUSED_PRESERVE src0_sel:WORD_1
v_fma_mix_f32 v232, v122, v122, v232 op_sel_hi:[1,1,0]
v_cvt_pkrtz_f16_f32 v136, v136, v137
v_fma_mix_f32 v232, v123, v123, v232 op_sel_hi:[1,1,0]
v_cvt_pkrtz_f16_f32 v137, v138, v139
v_lshrrev_b64 v[136:137], 2, v[136:137]
ds_read_u16 v135, v135
ds_read_u16 v133, v133
v_and_b32_sdwa v138, s47, v136 dst_sel:DWORD dst_unused:UNUSED_PAD src0_sel:DWORD src1_sel:WORD_1
v_and_b32_e64 v136, s47, v136
v_exp_f16_sdwa v143, v143 dst_sel:WORD_1 dst_unused:UNUSED_PRESERVE src0_sel:WORD_1
v_mfma_f32_32x32x16_bf16 v[96:111], v[28:31], v[180:183], v[96:111]
ds_read_u16 v138, v138
ds_read_u16 v136, v136
ds_read_b128 v[176:179], v251
v_and_b32_sdwa v139, s47, v137 dst_sel:DWORD dst_unused:UNUSED_PAD src0_sel:DWORD src1_sel:WORD_1
v_and_b32_e64 v137, s47, v137
v_pk_add_f16 v141, v141, 1.0 op_sel_hi:[1,0]
v_pk_add_f16 v143, v143, 1.0 op_sel_hi:[1,0]
v_rcp_f16_sdwa v141, v141 dst_sel:WORD_0 dst_unused:UNUSED_PRESERVE src0_sel:WORD_0
v_mfma_f32_32x32x16_bf16 v[160:175], v[8:11], v[184:187], v[160:175]
ds_read_u16 v139, v139
ds_read_u16 v137, v137
s_add_u32 s81, s81, 6592
s_cmp_eq_u32 s81, 65920
s_cselect_b32 s81, 0, s81
s_add_u32 s43, s81, s67
s_add_u32 m0, s43, 48
s_add_u32 s66, s66, 98304
buffer_load_dwordx4 v236, s[4:7], s66 offen lds
s_add_u32 m0, s43, 944
s_nop 0
buffer_load_dwordx4 v237, s[4:7], s66 offen lds
v_rcp_f16_sdwa v143, v143 dst_sel:WORD_0 dst_unused:UNUSED_PRESERVE src0_sel:WORD_0
v_rcp_f16_sdwa v141, v141 dst_sel:WORD_1 dst_unused:UNUSED_PRESERVE src0_sel:WORD_1
v_rcp_f16_sdwa v143, v143 dst_sel:WORD_1 dst_unused:UNUSED_PRESERVE src0_sel:WORD_1
v_mfma_f32_32x32x16_bf16 v[96:111], v[32:35], v[184:187], v[96:111]
ds_read_b128 v[180:183], v251 offset:1024
s_add_u32 s81, s81, 6592
s_cmp_eq_u32 s81, 65920
s_cselect_b32 s81, 0, s81
s_add_u32 s43, s81, s67
s_add_u32 m0, s43, 0
s_add_u32 s66, s66, 98304
buffer_load_dwordx4 v236, s[4:7], s66 offen lds
s_add_u32 m0, s43, 896
s_nop 0
buffer_load_dwordx4 v237, s[4:7], s66 offen lds
v_pk_mul_f16 v140, v140, v141
v_pk_mul_f16 v142, v142, v143
v_fma_mix_f32 v233, v140, v140, v233 op_sel_hi:[1,1,0]
v_cvt_pkrtz_f16_f32 v144, v144, v145
s_waitcnt lgkmcnt(7)
v_mfma_f32_32x32x16_bf16 v[160:175], v[12:15], v[188:191], v[160:175]
v_fma_mix_f32 v233, v142, v142, v233 op_sel_hi:[1,1,0]
v_cvt_pkrtz_f16_f32 v145, v146, v147
v_fma_mix_f32 v233, v140, v140, v233 op_sel:[1,1,0] op_sel_hi:[1,1,0]
v_lshrrev_b64 v[144:145], 2, v[144:145]
v_fma_mix_f32 v233, v142, v142, v233 op_sel:[1,1,0] op_sel_hi:[1,1,0]
v_and_b32_sdwa v146, s47, v144 dst_sel:DWORD dst_unused:UNUSED_PAD src0_sel:DWORD src1_sel:WORD_1
v_fma_mix_f32 v233, v128, v128, v233 op_sel_hi:[1,1,0]
v_and_b32 v144, s47, v144
v_fma_mix_f32 v233, v129, v129, v233 op_sel_hi:[1,1,0]
v_cvt_pk_f16_f32 v156, v156, v157
v_fma_mix_f32 v233, v130, v130, v233 op_sel_hi:[1,1,0]
v_cvt_pk_f16_f32 v158, v158, v159
v_fma_mix_f32 v233, v131, v131, v233 op_sel_hi:[1,1,0]
v_pk_fma_f16 v157, v156, v156, s48
v_mfma_f32_32x32x16_bf16 v[96:111], v[36:39], v[188:191], v[96:111]
ds_read_u16 v146, v146
ds_read_u16 v144, v144
v_fma_mix_f32 v233, v132, v132, v233 op_sel_hi:[1,1,0]
v_and_b32_sdwa v147, s47, v145 dst_sel:DWORD dst_unused:UNUSED_PAD src0_sel:DWORD src1_sel:WORD_1
s_waitcnt lgkmcnt(5)
v_fma_mix_f32 v233, v133, v133, v233 op_sel_hi:[1,1,0]
s_add_u32 s81, s81, 6592
s_cmp_eq_u32 s81, 65920
s_cselect_b32 s81, 0, s81
s_add_u32 s43, s81, s67
s_add_u32 m0, s43, 0
s_add_u32 s66, s66, 98304
buffer_load_dwordx4 v236, s[4:7], s66 offen lds
s_add_u32 m0, s43, 896
s_nop 0
buffer_load_dwordx4 v237, s[4:7], s66 offen lds
v_and_b32 v145, s47, v145
v_pk_fma_f16 v159, v158, v158, s48
v_pk_mul_f16 v157, v156, v157
v_pk_mul_f16 v159, v158, v159
v_fma_mix_f32 v233, v134, v134, v233 op_sel_hi:[1,1,0]
v_cvt_pkrtz_f16_f32 v148, v148, v149
v_fma_mix_f32 v233, v135, v135, v233 op_sel_hi:[1,1,0]
ds_read_u16 v147, v147
ds_read_u16 v145, v145
ds_read_b128 v[184:187], v251 offset:2048
v_cvt_pkrtz_f16_f32 v149, v150, v151
v_lshrrev_b64 v[148:149], 2, v[148:149]
v_and_b32_sdwa v150, s47, v148 dst_sel:DWORD dst_unused:UNUSED_PAD src0_sel:DWORD src1_sel:WORD_1
v_and_b32_e64 v148, s47, v148
v_exp_f16_sdwa v157, v157 dst_sel:WORD_0 dst_unused:UNUSED_PRESERVE src0_sel:WORD_0
v_mfma_f32_32x32x16_bf16 v[160:175], v[16:19], v[176:179], v[160:175]
ds_read_u16 v150, v150
ds_read_u16 v148, v148
v_fma_mix_f32 v233, v136, v136, v233 op_sel_hi:[1,1,0]
v_exp_f16_sdwa v159, v159 dst_sel:WORD_0 dst_unused:UNUSED_PRESERVE src0_sel:WORD_0
s_waitcnt lgkmcnt(7)
v_fma_mix_f32 v233, v137, v137, v233 op_sel_hi:[1,1,0]
v_and_b32_sdwa v151, s47, v149 dst_sel:DWORD dst_unused:UNUSED_PAD src0_sel:DWORD src1_sel:WORD_1
v_and_b32 v149, s47, v149
v_exp_f16_sdwa v157, v157 dst_sel:WORD_1 dst_unused:UNUSED_PRESERVE src0_sel:WORD_1
v_fma_mix_f32 v233, v138, v138, v233 op_sel_hi:[1,1,0]
v_cvt_pkrtz_f16_f32 v152, v152, v153
v_fma_mix_f32 v233, v139, v139, v233 op_sel_hi:[1,1,0]
v_cvt_pkrtz_f16_f32 v153, v154, v155
v_lshrrev_b64 v[152:153], 2, v[152:153]
ds_read_u16 v151, v151
ds_read_u16 v149, v149
v_and_b32_sdwa v154, s47, v152 dst_sel:DWORD dst_unused:UNUSED_PAD src0_sel:DWORD src1_sel:WORD_1
v_and_b32_e64 v152, s47, v152
v_exp_f16_sdwa v159, v159 dst_sel:WORD_1 dst_unused:UNUSED_PRESERVE src0_sel:WORD_1
v_mfma_f32_32x32x16_bf16 v[96:111], v[40:43], v[176:179], v[96:111]
ds_read_u16 v154, v154
ds_read_u16 v152, v152
ds_read_b128 v[188:191], v251 offset:3072
v_and_b32_sdwa v155, s47, v153 dst_sel:DWORD dst_unused:UNUSED_PAD src0_sel:DWORD src1_sel:WORD_1
v_and_b32_e64 v153, s47, v153
v_pk_add_f16 v157, v157, 1.0 op_sel_hi:[1,0]
v_pk_add_f16 v159, v159, 1.0 op_sel_hi:[1,0]
v_rcp_f16_sdwa v157, v157 dst_sel:WORD_0 dst_unused:UNUSED_PRESERVE src0_sel:WORD_0
v_mfma_f32_32x32x16_bf16 v[160:175], v[20:23], v[180:183], v[160:175]
ds_read_u16 v155, v155
ds_read_u16 v153, v153
v_rcp_f16_sdwa v159, v159 dst_sel:WORD_0 dst_unused:UNUSED_PRESERVE src0_sel:WORD_0
v_rcp_f16_sdwa v157, v157 dst_sel:WORD_1 dst_unused:UNUSED_PRESERVE src0_sel:WORD_1
v_rcp_f16_sdwa v159, v159 dst_sel:WORD_1 dst_unused:UNUSED_PRESERVE src0_sel:WORD_1
v_mfma_f32_32x32x16_bf16 v[96:111], v[44:47], v[180:183], v[96:111]
ds_read_b128 v[176:179], v251 offset:4096
v_pk_mul_f16 v156, v156, v157
v_pk_mul_f16 v158, v158, v159
v_fma_mix_f32 v233, v156, v156, v233 op_sel_hi:[1,1,0]
s_nop 1
v_cvt_pkrtz_f16_f32 v160, v160, v161
v_fma_mix_f32 v233, v158, v158, v233 op_sel_hi:[1,1,0]
s_waitcnt lgkmcnt(7)
v_mfma_f32_32x32x16_bf16 v[112:127], v[0:3], v[184:187], 0
v_fma_mix_f32 v233, v156, v156, v233 op_sel:[1,1,0] op_sel_hi:[1,1,0]
v_cvt_pkrtz_f16_f32 v161, v162, v163
v_fma_mix_f32 v233, v158, v158, v233 op_sel:[1,1,0] op_sel_hi:[1,1,0]
v_lshrrev_b64 v[160:161], 2, v[160:161]
v_fma_mix_f32 v233, v144, v144, v233 op_sel_hi:[1,1,0]
v_and_b32_sdwa v162, s47, v160 dst_sel:DWORD dst_unused:UNUSED_PAD src0_sel:DWORD src1_sel:WORD_1
v_fma_mix_f32 v233, v145, v145, v233 op_sel_hi:[1,1,0]
v_and_b32_e64 v160, s47, v160
v_fma_mix_f32 v233, v146, v146, v233 op_sel_hi:[1,1,0]
v_cvt_pk_f16_f32 v172, v172, v173
v_fma_mix_f32 v233, v147, v147, v233 op_sel_hi:[1,1,0]
v_cvt_pk_f16_f32 v174, v174, v175
v_pk_fma_f16 v173, v172, v172, s48
v_mfma_f32_32x32x16_bf16 v[128:143], v[24:27], v[184:187], 0
ds_read_u16 v162, v162
ds_read_u16 v160, v160
v_fma_mix_f32 v233, v148, v148, v233 op_sel_hi:[1,1,0]
v_and_b32_sdwa v163, s47, v161 dst_sel:DWORD dst_unused:UNUSED_PAD src0_sel:DWORD src1_sel:WORD_1
s_waitcnt lgkmcnt(5)
v_fma_mix_f32 v233, v149, v149, v233 op_sel_hi:[1,1,0]
v_and_b32 v161, s47, v161
v_pk_fma_f16 v175, v174, v174, s48
v_pk_mul_f16 v173, v172, v173
v_pk_mul_f16 v175, v174, v175
v_fma_mix_f32 v233, v150, v150, v233 op_sel_hi:[1,1,0]
v_cvt_pkrtz_f16_f32 v164, v164, v165
v_fma_mix_f32 v233, v151, v151, v233 op_sel_hi:[1,1,0]
ds_read_u16 v163, v163
ds_read_u16 v161, v161
ds_read_b128 v[180:183], v251 offset:5120
v_cvt_pkrtz_f16_f32 v165, v166, v167
v_lshrrev_b64 v[164:165], 2, v[164:165]
v_and_b32_sdwa v166, s47, v164 dst_sel:DWORD dst_unused:UNUSED_PAD src0_sel:DWORD src1_sel:WORD_1
v_and_b32_e64 v164, s47, v164
v_exp_f16_sdwa v173, v173 dst_sel:WORD_0 dst_unused:UNUSED_PRESERVE src0_sel:WORD_0
v_mfma_f32_32x32x16_bf16 v[112:127], v[4:7], v[188:191], v[112:127]
ds_read_u16 v166, v166
ds_read_u16 v164, v164
v_fma_mix_f32 v233, v152, v152, v233 op_sel_hi:[1,1,0]
v_exp_f16_sdwa v175, v175 dst_sel:WORD_0 dst_unused:UNUSED_PRESERVE src0_sel:WORD_0
s_waitcnt lgkmcnt(7)
v_fma_mix_f32 v233, v153, v153, v233 op_sel_hi:[1,1,0]
v_and_b32_sdwa v167, s47, v165 dst_sel:DWORD dst_unused:UNUSED_PAD src0_sel:DWORD src1_sel:WORD_1
v_and_b32 v165, s47, v165
v_exp_f16_sdwa v173, v173 dst_sel:WORD_1 dst_unused:UNUSED_PRESERVE src0_sel:WORD_1
v_fma_mix_f32 v233, v154, v154, v233 op_sel_hi:[1,1,0]
v_cvt_pkrtz_f16_f32 v168, v168, v169
v_fma_mix_f32 v233, v155, v155, v233 op_sel_hi:[1,1,0]
v_cvt_pkrtz_f16_f32 v169, v170, v171
v_lshrrev_b64 v[168:169], 2, v[168:169]
ds_read_u16 v167, v167
ds_read_u16 v165, v165
v_and_b32_sdwa v170, s47, v168 dst_sel:DWORD dst_unused:UNUSED_PAD src0_sel:DWORD src1_sel:WORD_1
v_and_b32_e64 v168, s47, v168
v_exp_f16_sdwa v175, v175 dst_sel:WORD_1 dst_unused:UNUSED_PRESERVE src0_sel:WORD_1
v_mfma_f32_32x32x16_bf16 v[128:143], v[28:31], v[188:191], v[128:143]
ds_read_u16 v170, v170
ds_read_u16 v168, v168
ds_read_b128 v[184:187], v251 offset:6144
v_and_b32_sdwa v171, s47, v169 dst_sel:DWORD dst_unused:UNUSED_PAD src0_sel:DWORD src1_sel:WORD_1
v_and_b32_e64 v169, s47, v169
v_pk_add_f16 v173, v173, 1.0 op_sel_hi:[1,0]
v_pk_add_f16 v175, v175, 1.0 op_sel_hi:[1,0]
v_rcp_f16_sdwa v173, v173 dst_sel:WORD_0 dst_unused:UNUSED_PRESERVE src0_sel:WORD_0
v_mfma_f32_32x32x16_bf16 v[112:127], v[8:11], v[176:179], v[112:127]
ds_read_u16 v171, v171
ds_read_u16 v169, v169
v_rcp_f16_sdwa v175, v175 dst_sel:WORD_0 dst_unused:UNUSED_PRESERVE src0_sel:WORD_0
v_rcp_f16_sdwa v173, v173 dst_sel:WORD_1 dst_unused:UNUSED_PRESERVE src0_sel:WORD_1
v_rcp_f16_sdwa v175, v175 dst_sel:WORD_1 dst_unused:UNUSED_PRESERVE src0_sel:WORD_1
v_mfma_f32_32x32x16_bf16 v[128:143], v[32:35], v[176:179], v[128:143]
ds_read_b128 v[188:191], v251 offset:7168
v_pk_mul_f16 v172, v172, v173
v_pk_mul_f16 v174, v174, v175
v_fma_mix_f32 v234, v172, v172, v234 op_sel_hi:[1,1,0]
v_cvt_pkrtz_f16_f32 v96, v96, v97
v_fma_mix_f32 v234, v174, v174, v234 op_sel_hi:[1,1,0]
s_waitcnt lgkmcnt(7)
v_mfma_f32_32x32x16_bf16 v[112:127], v[12:15], v[180:183], v[112:127]
v_fma_mix_f32 v234, v172, v172, v234 op_sel:[1,1,0] op_sel_hi:[1,1,0]
v_cvt_pkrtz_f16_f32 v97, v98, v99
v_fma_mix_f32 v234, v174, v174, v234 op_sel:[1,1,0] op_sel_hi:[1,1,0]
v_lshrrev_b64 v[96:97], 2, v[96:97]
v_fma_mix_f32 v234, v160, v160, v234 op_sel_hi:[1,1,0]
v_and_b32_sdwa v98, s47, v96 dst_sel:DWORD dst_unused:UNUSED_PAD src0_sel:DWORD src1_sel:WORD_1
v_fma_mix_f32 v234, v161, v161, v234 op_sel_hi:[1,1,0]
v_and_b32 v96, s47, v96
v_fma_mix_f32 v234, v162, v162, v234 op_sel_hi:[1,1,0]
v_cvt_pk_f16_f32 v108, v108, v109
v_fma_mix_f32 v234, v163, v163, v234 op_sel_hi:[1,1,0]
v_cvt_pk_f16_f32 v110, v110, v111
v_pk_fma_f16 v109, v108, v108, s48
v_mfma_f32_32x32x16_bf16 v[128:143], v[36:39], v[180:183], v[128:143]
ds_read_u16 v98, v98
ds_read_u16 v96, v96
v_fma_mix_f32 v234, v164, v164, v234 op_sel_hi:[1,1,0]
v_and_b32_sdwa v99, s47, v97 dst_sel:DWORD dst_unused:UNUSED_PAD src0_sel:DWORD src1_sel:WORD_1
s_waitcnt lgkmcnt(5)
v_fma_mix_f32 v234, v165, v165, v234 op_sel_hi:[1,1,0]
v_and_b32 v97, s47, v97
v_pk_fma_f16 v111, v110, v110, s48
v_pk_mul_f16 v109, v108, v109
v_pk_mul_f16 v111, v110, v111
v_fma_mix_f32 v234, v166, v166, v234 op_sel_hi:[1,1,0]
v_cvt_pkrtz_f16_f32 v100, v100, v101
v_fma_mix_f32 v234, v167, v167, v234 op_sel_hi:[1,1,0]
ds_read_u16 v99, v99
ds_read_u16 v97, v97
v_cvt_pkrtz_f16_f32 v101, v102, v103
v_lshrrev_b64 v[100:101], 2, v[100:101]
v_and_b32_sdwa v102, s47, v100 dst_sel:DWORD dst_unused:UNUSED_PAD src0_sel:DWORD src1_sel:WORD_1
v_and_b32_e64 v100, s47, v100
v_exp_f16_sdwa v109, v109 dst_sel:WORD_0 dst_unused:UNUSED_PRESERVE src0_sel:WORD_0
v_mfma_f32_32x32x16_bf16 v[112:127], v[16:19], v[184:187], v[112:127]
ds_read_u16 v102, v102
ds_read_u16 v100, v100
v_fma_mix_f32 v234, v168, v168, v234 op_sel_hi:[1,1,0]
v_exp_f16_sdwa v111, v111 dst_sel:WORD_0 dst_unused:UNUSED_PRESERVE src0_sel:WORD_0
s_waitcnt lgkmcnt(6)
v_fma_mix_f32 v234, v169, v169, v234 op_sel_hi:[1,1,0]
v_and_b32_sdwa v103, s47, v101 dst_sel:DWORD dst_unused:UNUSED_PAD src0_sel:DWORD src1_sel:WORD_1
v_and_b32 v101, s47, v101
v_exp_f16_sdwa v109, v109 dst_sel:WORD_1 dst_unused:UNUSED_PRESERVE src0_sel:WORD_1
v_fma_mix_f32 v234, v170, v170, v234 op_sel_hi:[1,1,0]
v_cvt_pkrtz_f16_f32 v104, v104, v105
v_fma_mix_f32 v234, v171, v171, v234 op_sel_hi:[1,1,0]
v_cvt_pkrtz_f16_f32 v105, v106, v107
v_lshrrev_b64 v[104:105], 2, v[104:105]
ds_read_u16 v103, v103
ds_read_u16 v101, v101
v_and_b32_sdwa v106, s47, v104 dst_sel:DWORD dst_unused:UNUSED_PAD src0_sel:DWORD src1_sel:WORD_1
v_and_b32_e64 v104, s47, v104
v_exp_f16_sdwa v111, v111 dst_sel:WORD_1 dst_unused:UNUSED_PRESERVE src0_sel:WORD_1
v_mfma_f32_32x32x16_bf16 v[128:143], v[40:43], v[184:187], v[128:143]
ds_read_u16 v106, v106
ds_read_u16 v104, v104
v_and_b32_sdwa v107, s47, v105 dst_sel:DWORD dst_unused:UNUSED_PAD src0_sel:DWORD src1_sel:WORD_1
v_and_b32_e64 v105, s47, v105
v_pk_add_f16 v109, v109, 1.0 op_sel_hi:[1,0]
v_pk_add_f16 v111, v111, 1.0 op_sel_hi:[1,0]
v_rcp_f16_sdwa v109, v109 dst_sel:WORD_0 dst_unused:UNUSED_PRESERVE src0_sel:WORD_0
v_mfma_f32_32x32x16_bf16 v[112:127], v[20:23], v[188:191], v[112:127]
ds_read_u16 v107, v107
ds_read_u16 v105, v105
v_rcp_f16_sdwa v111, v111 dst_sel:WORD_0 dst_unused:UNUSED_PRESERVE src0_sel:WORD_0
v_rcp_f16_sdwa v109, v109 dst_sel:WORD_1 dst_unused:UNUSED_PRESERVE src0_sel:WORD_1
v_rcp_f16_sdwa v111, v111 dst_sel:WORD_1 dst_unused:UNUSED_PRESERVE src0_sel:WORD_1
v_mfma_f32_32x32x16_bf16 v[128:143], v[44:47], v[188:191], v[128:143]
v_pk_mul_f16 v108, v108, v109
v_pk_mul_f16 v110, v110, v111
v_fma_mix_f32 v234, v108, v108, v234 op_sel_hi:[1,1,0]
s_nop 2
v_cvt_pkrtz_f16_f32 v112, v112, v113
v_fma_mix_f32 v234, v110, v110, v234 op_sel_hi:[1,1,0]
v_cvt_pkrtz_f16_f32 v113, v114, v115
v_fma_mix_f32 v234, v108, v108, v234 op_sel:[1,1,0] op_sel_hi:[1,1,0]
v_lshrrev_b64 v[112:113], 2, v[112:113]
v_fma_mix_f32 v234, v110, v110, v234 op_sel:[1,1,0] op_sel_hi:[1,1,0]
v_and_b32_sdwa v114, s47, v112 dst_sel:DWORD dst_unused:UNUSED_PAD src0_sel:DWORD src1_sel:WORD_1
s_waitcnt lgkmcnt(4)
v_fma_mix_f32 v234, v96, v96, v234 op_sel_hi:[1,1,0]
v_and_b32_e64 v112, s47, v112
v_fma_mix_f32 v234, v97, v97, v234 op_sel_hi:[1,1,0]
v_cvt_pk_f16_f32 v124, v124, v125
v_fma_mix_f32 v234, v98, v98, v234 op_sel_hi:[1,1,0]
v_cvt_pk_f16_f32 v126, v126, v127
v_fma_mix_f32 v234, v99, v99, v234 op_sel_hi:[1,1,0]
v_pk_fma_f16 v125, v124, v124, s48
v_fma_mix_f32 v234, v100, v100, v234 op_sel_hi:[1,1,0]
v_and_b32_sdwa v115, s47, v113 dst_sel:DWORD dst_unused:UNUSED_PAD src0_sel:DWORD src1_sel:WORD_1
v_fma_mix_f32 v234, v101, v101, v234 op_sel_hi:[1,1,0]
v_and_b32_e64 v113, s47, v113
v_pk_fma_f16 v127, v126, v126, s48
ds_read_u16 v114, v114
ds_read_u16 v112, v112
ds_read_u16 v115, v115
ds_read_u16 v113, v113
s_add_u32 s43, s81, 6592
v_add_u32_e64 v212, s43, v246
v_subrev_u32 v222, 65920, v212
v_min_u32_e64 v212, v212, v222
v_add_u32 v212, 90112, v212
v_add_u32_e64 v213, s43, v246
v_add_u32 v213, 6592, v213
v_subrev_u32 v222, 65920, v213
v_min_u32_e64 v213, v213, v222
v_add_u32 v213, 90112, v213
v_add_u32_e64 v214, s43, v246
v_add_u32 v214, 13184, v214
v_add_u32_e64 v222, 16, v214
v_bfi_b32 v214, 48, v222, v214
v_subrev_u32 v222, 65920, v214
v_min_u32_e64 v214, v214, v222
v_add_u32 v214, 90112, v214
v_add_u32_e64 v215, s43, v246
v_add_u32 v215, 19776, v215
v_add_u32_e64 v222, 16, v215
v_bfi_b32 v215, 48, v222, v215
v_subrev_u32 v222, 65920, v215
v_min_u32_e64 v215, v215, v222
v_add_u32 v215, 90112, v215
v_pk_mul_f16 v125, v124, v125
v_pk_mul_f16 v127, v126, v127
v_fma_mix_f32 v234, v102, v102, v234 op_sel_hi:[1,1,0]
v_cvt_pkrtz_f16_f32 v116, v116, v117
v_fma_mix_f32 v234, v103, v103, v234 op_sel_hi:[1,1,0]
v_cvt_pkrtz_f16_f32 v117, v118, v119
v_lshrrev_b64 v[116:117], 2, v[116:117]
v_and_b32_sdwa v118, s47, v116 dst_sel:DWORD dst_unused:UNUSED_PAD src0_sel:DWORD src1_sel:WORD_1
v_and_b32 v116, s47, v116
v_exp_f16_sdwa v125, v125 dst_sel:WORD_0 dst_unused:UNUSED_PRESERVE src0_sel:WORD_0
s_waitcnt lgkmcnt(2)
v_fma_mix_f32 v234, v104, v104, v234 op_sel_hi:[1,1,0]
v_exp_f16_sdwa v127, v127 dst_sel:WORD_0 dst_unused:UNUSED_PRESERVE src0_sel:WORD_0
v_fma_mix_f32 v234, v105, v105, v234 op_sel_hi:[1,1,0]
v_and_b32_sdwa v119, s47, v117 dst_sel:DWORD dst_unused:UNUSED_PAD src0_sel:DWORD src1_sel:WORD_1
v_and_b32 v117, s47, v117
ds_read_u16 v118, v118
ds_read_u16 v116, v116
ds_read_u16 v119, v119
ds_read_u16 v117, v117
s_waitcnt vmcnt(0)
v_exp_f16_sdwa v125, v125 dst_sel:WORD_1 dst_unused:UNUSED_PRESERVE src0_sel:WORD_1
v_fma_mix_f32 v234, v106, v106, v234 op_sel_hi:[1,1,0]
v_cvt_pkrtz_f16_f32 v120, v120, v121
v_fma_mix_f32 v234, v107, v107, v234 op_sel_hi:[1,1,0]
v_cvt_pkrtz_f16_f32 v121, v122, v123
v_lshrrev_b64 v[120:121], 2, v[120:121]
v_and_b32_sdwa v122, s47, v120 dst_sel:DWORD dst_unused:UNUSED_PAD src0_sel:DWORD src1_sel:WORD_1
ds_read_b128 v[144:147], v212
ds_read_b64 v[196:197], v238
ds_read_b64 v[198:199], v239
v_and_b32_e64 v120, s47, v120
v_exp_f16_sdwa v127, v127 dst_sel:WORD_1 dst_unused:UNUSED_PRESERVE src0_sel:WORD_1
v_and_b32_sdwa v123, s47, v121 dst_sel:DWORD dst_unused:UNUSED_PAD src0_sel:DWORD src1_sel:WORD_1
v_and_b32_e64 v121, s47, v121
v_pk_add_f16 v125, v125, 1.0 op_sel_hi:[1,0]
v_pk_add_f16 v127, v127, 1.0 op_sel_hi:[1,0]
v_rcp_f16_sdwa v125, v125 dst_sel:WORD_0 dst_unused:UNUSED_PRESERVE src0_sel:WORD_0
ds_read_u16 v122, v122
ds_read_u16 v120, v120
ds_read_b128 v[148:151], v213
ds_read_b128 v[152:155], v214
ds_read_b64 v[200:201], v238 offset:2400
ds_read_b64 v[202:203], v239 offset:2400
s_waitcnt lgkmcnt(13)
ds_read_b128 v[156:159], v215
ds_read_u16 v123, v123
s_waitcnt lgkmcnt(14)
ds_read_u16 v121, v121
v_rcp_f16_sdwa v127, v127 dst_sel:WORD_0 dst_unused:UNUSED_PRESERVE src0_sel:WORD_0
v_rcp_f16_sdwa v125, v125 dst_sel:WORD_1 dst_unused:UNUSED_PRESERVE src0_sel:WORD_1
v_rcp_f16_sdwa v127, v127 dst_sel:WORD_1 dst_unused:UNUSED_PRESERVE src0_sel:WORD_1
v_pk_mul_f16 v124, v124, v125
v_pk_mul_f16 v126, v126, v127
v_fma_mix_f32 v235, v124, v124, v235 op_sel_hi:[1,1,0]
s_waitcnt lgkmcnt(14)
ds_read_b64 v[204:205], v238 offset:4800
s_waitcnt lgkmcnt(14)
ds_read_b64 v[206:207], v239 offset:4800
v_fma_mix_f32 v235, v126, v126, v235 op_sel_hi:[1,1,0]
v_cvt_pkrtz_f16_f32 v128, v128, v129
v_fma_mix_f32 v235, v124, v124, v235 op_sel:[1,1,0] op_sel_hi:[1,1,0]
v_cvt_pkrtz_f16_f32 v129, v130, v131
v_fma_mix_f32 v235, v126, v126, v235 op_sel:[1,1,0] op_sel_hi:[1,1,0]
v_lshrrev_b64 v[128:129], 2, v[128:129]
v_fma_mix_f32 v235, v112, v112, v235 op_sel_hi:[1,1,0]
s_waitcnt lgkmcnt(11)
v_mfma_f32_16x16x32_bf16 v[48:51], v[196:199], v[144:147], 0
ds_read_b128 v[160:163], v212 offset:16
ds_read_b64 v[208:209], v238 offset:200
ds_read_b64 v[210:211], v239 offset:200
v_fma_mix_f32 v235, v113, v113, v235 op_sel_hi:[1,1,0]
v_and_b32_sdwa v130, s47, v128 dst_sel:DWORD dst_unused:UNUSED_PAD src0_sel:DWORD src1_sel:WORD_1
v_fma_mix_f32 v235, v114, v114, v235 op_sel_hi:[1,1,0]
v_and_b32 v128, s47, v128
v_fma_mix_f32 v235, v115, v115, v235 op_sel_hi:[1,1,0]
v_cvt_pk_f16_f32 v140, v140, v141
v_cvt_pk_f16_f32 v142, v142, v143
ds_read_b128 v[164:167], v213 offset:16
s_waitcnt lgkmcnt(14)
ds_read_b128 v[168:171], v214 offset:16
v_pk_fma_f16 v141, v140, v140, s48
v_fma_mix_f32 v235, v116, v116, v235 op_sel_hi:[1,1,0]
s_waitcnt lgkmcnt(13)
v_mfma_f32_16x16x32_bf16 v[96:99], v[196:199], v[148:151], 0
ds_read_b64 v[192:193], v238 offset:2600
ds_read_b64 v[194:195], v239 offset:2600
v_fma_mix_f32 v235, v117, v117, v235 op_sel_hi:[1,1,0]
v_and_b32_sdwa v131, s47, v129 dst_sel:DWORD dst_unused:UNUSED_PAD src0_sel:DWORD src1_sel:WORD_1
v_and_b32 v129, s47, v129
s_waitcnt lgkmcnt(12)
v_mfma_f32_16x16x32_bf16 v[48:51], v[200:203], v[148:151], v[48:51]
ds_read_b128 v[172:175], v215 offset:16
ds_read_b64 v[196:197], v238 offset:5000
ds_read_b64 v[198:199], v239 offset:5000
v_mfma_f32_16x16x32_bf16 v[96:99], v[200:203], v[152:155], v[96:99]
v_pk_fma_f16 v143, v142, v142, s48
v_pk_mul_f16 v141, v140, v141
v_pk_mul_f16 v143, v142, v143
v_fma_mix_f32 v235, v118, v118, v235 op_sel_hi:[1,1,0]
v_cvt_pkrtz_f16_f32 v132, v132, v133
v_fma_mix_f32 v235, v119, v119, v235 op_sel_hi:[1,1,0]
v_cvt_pkrtz_f16_f32 v133, v134, v135
v_lshrrev_b64 v[132:133], 2, v[132:133]
v_and_b32_sdwa v134, s47, v132 dst_sel:DWORD dst_unused:UNUSED_PAD src0_sel:DWORD src1_sel:WORD_1
s_waitcnt lgkmcnt(14)
ds_read_b128 v[144:147], v212 offset:32
s_waitcnt lgkmcnt(14)
ds_read_b64 v[200:201], v238 offset:400
s_waitcnt lgkmcnt(14)
ds_read_b64 v[202:203], v239 offset:400
v_and_b32 v132, s47, v132
s_waitcnt lgkmcnt(13)
v_mfma_f32_16x16x32_bf16 v[48:51], v[204:207], v[152:155], v[48:51]
ds_read_b128 v[148:151], v213 offset:32
ds_read_b128 v[152:155], v214 offset:32
v_mfma_f32_16x16x32_bf16 v[96:99], v[204:207], v[156:159], v[96:99]
s_waitcnt lgkmcnt(14)
ds_read_b64 v[204:205], v238 offset:2800
s_waitcnt lgkmcnt(14)
ds_read_b64 v[206:207], v239 offset:2800
s_waitcnt lgkmcnt(14)
v_mfma_f32_16x16x32_bf16 v[52:55], v[208:211], v[160:163], 0
v_exp_f16_sdwa v141, v141 dst_sel:WORD_0 dst_unused:UNUSED_PRESERVE src0_sel:WORD_0
s_waitcnt lgkmcnt(13)
v_mfma_f32_16x16x32_bf16 v[100:103], v[208:211], v[164:167], 0
ds_read_b128 v[156:159], v215 offset:32
ds_read_b64 v[208:209], v238 offset:5200
v_fma_mix_f32 v235, v120, v120, v235 op_sel_hi:[1,1,0]
v_exp_f16_sdwa v143, v143 dst_sel:WORD_0 dst_unused:UNUSED_PRESERVE src0_sel:WORD_0
s_waitcnt lgkmcnt(12)
v_mfma_f32_16x16x32_bf16 v[52:55], v[192:195], v[164:167], v[52:55]
ds_read_b64 v[210:211], v239 offset:5200
ds_read_b128 v[160:163], v212 offset:48
v_mfma_f32_16x16x32_bf16 v[100:103], v[192:195], v[168:171], v[100:103]
ds_read_b64 v[192:193], v238 offset:600
s_waitcnt lgkmcnt(14)
ds_read_b64 v[194:195], v239 offset:600
s_waitcnt lgkmcnt(13)
v_mfma_f32_16x16x32_bf16 v[52:55], v[196:199], v[168:171], v[52:55]
ds_read_u16 v130, v130
ds_read_u16 v128, v128
v_mfma_f32_16x16x32_bf16 v[100:103], v[196:199], v[172:175], v[100:103]
s_waitcnt lgkmcnt(14)
ds_read_b128 v[164:167], v213 offset:48
s_waitcnt lgkmcnt(14)
ds_read_b128 v[168:171], v214 offset:48
s_waitcnt lgkmcnt(14)
v_mfma_f32_16x16x32_bf16 v[56:59], v[200:203], v[144:147], 0
ds_read_b64 v[196:197], v238 offset:3000
v_fma_mix_f32 v235, v121, v121, v235 op_sel_hi:[1,1,0]
s_waitcnt lgkmcnt(14)
v_mfma_f32_16x16x32_bf16 v[104:107], v[200:203], v[148:151], 0
ds_read_b64 v[198:199], v239 offset:3000
v_and_b32_sdwa v135, s47, v133 dst_sel:DWORD dst_unused:UNUSED_PAD src0_sel:DWORD src1_sel:WORD_1
v_and_b32 v133, s47, v133
s_waitcnt lgkmcnt(12)
v_mfma_f32_16x16x32_bf16 v[56:59], v[204:207], v[148:151], v[56:59]
ds_read_u16 v131, v131
ds_read_u16 v129, v129
ds_read_b128 v[172:175], v215 offset:48
v_mfma_f32_16x16x32_bf16 v[104:107], v[204:207], v[152:155], v[104:107]
s_waitcnt lgkmcnt(14)
ds_read_b64 v[200:201], v238 offset:5400
s_waitcnt lgkmcnt(14)
ds_read_b64 v[202:203], v239 offset:5400
s_waitcnt lgkmcnt(14)
v_mfma_f32_16x16x32_bf16 v[56:59], v[208:211], v[152:155], v[56:59]
v_exp_f16_sdwa v141, v141 dst_sel:WORD_1 dst_unused:UNUSED_PRESERVE src0_sel:WORD_1
v_mfma_f32_16x16x32_bf16 v[104:107], v[208:211], v[156:159], v[104:107]
ds_read_u16 v134, v134
s_waitcnt lgkmcnt(14)
ds_read_u16 v132, v132
s_waitcnt lgkmcnt(14)
ds_read_b128 v[144:147], v212 offset:64
s_waitcnt lgkmcnt(14)
v_mfma_f32_16x16x32_bf16 v[60:63], v[192:195], v[160:163], 0
v_fma_mix_f32 v235, v122, v122, v235 op_sel_hi:[1,1,0]
v_cvt_pkrtz_f16_f32 v136, v136, v137
v_fma_mix_f32 v235, v123, v123, v235 op_sel_hi:[1,1,0]
v_cvt_pkrtz_f16_f32 v137, v138, v139
v_lshrrev_b64 v[136:137], 2, v[136:137]
v_and_b32_sdwa v138, s47, v136 dst_sel:DWORD dst_unused:UNUSED_PAD src0_sel:DWORD src1_sel:WORD_1
v_and_b32 v136, s47, v136
v_exp_f16_sdwa v143, v143 dst_sel:WORD_1 dst_unused:UNUSED_PRESERVE src0_sel:WORD_1
ds_read_b64 v[204:205], v238 offset:800
s_waitcnt lgkmcnt(14)
ds_read_b64 v[206:207], v239 offset:800
s_waitcnt lgkmcnt(14)
ds_read_b128 v[148:151], v213 offset:64
s_waitcnt lgkmcnt(14)
v_mfma_f32_16x16x32_bf16 v[108:111], v[192:195], v[164:167], 0
v_and_b32_sdwa v139, s47, v137 dst_sel:DWORD dst_unused:UNUSED_PAD src0_sel:DWORD src1_sel:WORD_1
v_and_b32 v137, s47, v137
v_pk_add_f16 v141, v141, 1.0 op_sel_hi:[1,0]
v_pk_add_f16 v143, v143, 1.0 op_sel_hi:[1,0]
v_rcp_f16_sdwa v141, v141 dst_sel:WORD_0 dst_unused:UNUSED_PRESERVE src0_sel:WORD_0
s_waitcnt lgkmcnt(11)
v_mfma_f32_16x16x32_bf16 v[60:63], v[196:199], v[164:167], v[60:63]
ds_read_u16 v135, v135
ds_read_u16 v133, v133
ds_read_b128 v[152:155], v214 offset:64
ds_read_b64 v[208:209], v238 offset:3200
v_mfma_f32_16x16x32_bf16 v[108:111], v[196:199], v[168:171], v[108:111]
v_rcp_f16_sdwa v143, v143 dst_sel:WORD_0 dst_unused:UNUSED_PRESERVE src0_sel:WORD_0
v_rcp_f16_sdwa v141, v141 dst_sel:WORD_1 dst_unused:UNUSED_PRESERVE src0_sel:WORD_1
v_rcp_f16_sdwa v143, v143 dst_sel:WORD_1 dst_unused:UNUSED_PRESERVE src0_sel:WORD_1
s_waitcnt lgkmcnt(14)
ds_read_b64 v[210:211], v239 offset:3200
s_waitcnt lgkmcnt(14)
ds_read_b128 v[156:159], v215 offset:64
v_pk_mul_f16 v140, v140, v141
v_pk_mul_f16 v142, v142, v143
s_waitcnt lgkmcnt(12)
v_mfma_f32_16x16x32_bf16 v[60:63], v[200:203], v[168:171], v[60:63]
ds_read_b64 v[192:193], v238 offset:5600
ds_read_b64 v[194:195], v239 offset:5600
v_mfma_f32_16x16x32_bf16 v[108:111], v[200:203], v[172:175], v[108:111]
v_fma_mix_f32 v235, v140, v140, v235 op_sel_hi:[1,1,0]
ds_read_u16 v138, v138
s_waitcnt lgkmcnt(14)
ds_read_u16 v136, v136
v_fma_mix_f32 v235, v142, v142, v235 op_sel_hi:[1,1,0]
s_waitcnt lgkmcnt(14)
ds_read_b128 v[160:163], v212 offset:80
s_waitcnt lgkmcnt(14)
ds_read_b64 v[196:197], v238 offset:1000
s_waitcnt lgkmcnt(14)
ds_read_b64 v[198:199], v239 offset:1000
s_waitcnt lgkmcnt(14)
v_mfma_f32_16x16x32_bf16 v[64:67], v[204:207], v[144:147], 0
v_fma_mix_f32 v235, v140, v140, v235 op_sel:[1,1,0] op_sel_hi:[1,1,0]
ds_read_u16 v139, v139
s_waitcnt lgkmcnt(14)
v_mfma_f32_16x16x32_bf16 v[112:115], v[204:207], v[148:151], 0
ds_read_u16 v137, v137
s_waitcnt lgkmcnt(14)
ds_read_b128 v[164:167], v213 offset:80
v_fma_mix_f32 v235, v142, v142, v235 op_sel:[1,1,0] op_sel_hi:[1,1,0]
s_nop 0
v_fma_mix_f32 v235, v128, v128, v235 op_sel_hi:[1,1,0]
s_waitcnt lgkmcnt(14)
ds_read_b128 v[168:171], v214 offset:80
v_fma_mix_f32 v235, v129, v129, v235 op_sel_hi:[1,1,0]
s_waitcnt lgkmcnt(14)
ds_read_b64 v[200:201], v238 offset:3400
v_fma_mix_f32 v235, v130, v130, v235 op_sel_hi:[1,1,0]
s_waitcnt lgkmcnt(13)
v_mfma_f32_16x16x32_bf16 v[64:67], v[208:211], v[148:151], v[64:67]
ds_read_b64 v[202:203], v239 offset:3400
v_fma_mix_f32 v235, v131, v131, v235 op_sel_hi:[1,1,0]
v_mfma_f32_16x16x32_bf16 v[112:115], v[208:211], v[152:155], v[112:115]
ds_read_b128 v[172:175], v215 offset:80
s_waitcnt lgkmcnt(14)
ds_read_b64 v[204:205], v238 offset:5800
s_waitcnt lgkmcnt(14)
ds_read_b64 v[206:207], v239 offset:5800
s_waitcnt lgkmcnt(14)
v_mfma_f32_16x16x32_bf16 v[64:67], v[192:195], v[152:155], v[64:67]
v_fma_mix_f32 v235, v132, v132, v235 op_sel_hi:[1,1,0]
v_mfma_f32_16x16x32_bf16 v[112:115], v[192:195], v[156:159], v[112:115]
ds_read_b128 v[144:147], v212 offset:96
v_fma_mix_f32 v235, v133, v133, v235 op_sel_hi:[1,1,0]
s_waitcnt lgkmcnt(14)
ds_read_b64 v[208:209], v238 offset:1200
s_waitcnt lgkmcnt(14)
ds_read_b64 v[210:211], v239 offset:1200
v_fma_mix_f32 v235, v134, v134, v235 op_sel_hi:[1,1,0]
s_waitcnt lgkmcnt(14)
ds_read_b128 v[148:151], v213 offset:96
v_fma_mix_f32 v235, v135, v135, v235 op_sel_hi:[1,1,0]
s_waitcnt lgkmcnt(13)
v_mfma_f32_16x16x32_bf16 v[68:71], v[196:199], v[160:163], 0
ds_read_b128 v[152:155], v214 offset:96
ds_read_b64 v[192:193], v238 offset:3600
s_waitcnt lgkmcnt(14)
ds_read_b64 v[194:195], v239 offset:3600
s_waitcnt lgkmcnt(13)
v_mfma_f32_16x16x32_bf16 v[116:119], v[196:199], v[164:167], 0
ds_read_b128 v[156:159], v215 offset:96
ds_read_b64 v[196:197], v238 offset:6000
s_waitcnt lgkmcnt(14)
ds_read_b64 v[198:199], v239 offset:6000
s_waitcnt lgkmcnt(13)
v_mfma_f32_16x16x32_bf16 v[68:71], v[200:203], v[164:167], v[68:71]
ds_read_b128 v[160:163], v212 offset:112
v_fma_mix_f32 v235, v136, v136, v235 op_sel_hi:[1,1,0]
v_mfma_f32_16x16x32_bf16 v[116:119], v[200:203], v[168:171], v[116:119]
ds_read_b64 v[200:201], v238 offset:1400
s_waitcnt lgkmcnt(14)
ds_read_b64 v[202:203], v239 offset:1400
s_waitcnt lgkmcnt(13)
v_mfma_f32_16x16x32_bf16 v[68:71], v[204:207], v[168:171], v[68:71]
ds_read_b128 v[164:167], v213 offset:112
v_fma_mix_f32 v235, v137, v137, v235 op_sel_hi:[1,1,0]
v_mfma_f32_16x16x32_bf16 v[116:119], v[204:207], v[172:175], v[116:119]
ds_read_b128 v[168:171], v214 offset:112
s_waitcnt lgkmcnt(14)
ds_read_b64 v[204:205], v238 offset:3800
s_waitcnt lgkmcnt(13)
v_mfma_f32_16x16x32_bf16 v[72:75], v[208:211], v[144:147], 0
ds_read_b64 v[206:207], v239 offset:3800
ds_read_b128 v[172:175], v215 offset:112
s_waitcnt lgkmcnt(14)
v_mfma_f32_16x16x32_bf16 v[120:123], v[208:211], v[148:151], 0
v_fma_mix_f32 v235, v138, v138, v235 op_sel_hi:[1,1,0]
ds_read_b64 v[208:209], v238 offset:6200
v_fma_mix_f32 v235, v139, v139, v235 op_sel_hi:[1,1,0]
s_waitcnt lgkmcnt(14)
ds_read_b64 v[210:211], v239 offset:6200
s_waitcnt lgkmcnt(13)
v_mfma_f32_16x16x32_bf16 v[72:75], v[192:195], v[148:151], v[72:75]
ds_read_b128 v[144:147], v212 offset:128
ds_read_b128 v[148:151], v213 offset:128
v_mfma_f32_16x16x32_bf16 v[120:123], v[192:195], v[152:155], v[120:123]
s_waitcnt lgkmcnt(14)
ds_read_b64 v[192:193], v238 offset:1600
s_waitcnt lgkmcnt(14)
ds_read_b64 v[194:195], v239 offset:1600
s_waitcnt lgkmcnt(14)
v_mfma_f32_16x16x32_bf16 v[72:75], v[196:199], v[152:155], v[72:75]
ds_read_b128 v[152:155], v214 offset:128
v_mfma_f32_16x16x32_bf16 v[120:123], v[196:199], v[156:159], v[120:123]
s_waitcnt lgkmcnt(14)
ds_read_b64 v[196:197], v238 offset:4000
s_waitcnt lgkmcnt(14)
ds_read_b64 v[198:199], v239 offset:4000
s_waitcnt lgkmcnt(14)
v_mfma_f32_16x16x32_bf16 v[76:79], v[200:203], v[160:163], 0
ds_read_b128 v[156:159], v215 offset:128
s_waitcnt lgkmcnt(14)
v_mfma_f32_16x16x32_bf16 v[124:127], v[200:203], v[164:167], 0
ds_read_b64 v[200:201], v238 offset:6400
s_waitcnt lgkmcnt(14)
ds_read_b64 v[202:203], v239 offset:6400
s_waitcnt lgkmcnt(13)
v_mfma_f32_16x16x32_bf16 v[76:79], v[204:207], v[164:167], v[76:79]
ds_read_b128 v[160:163], v212 offset:144
ds_read_b128 v[164:167], v213 offset:144
v_mfma_f32_16x16x32_bf16 v[124:127], v[204:207], v[168:171], v[124:127]
s_waitcnt lgkmcnt(14)
ds_read_b64 v[204:205], v238 offset:1800
s_waitcnt lgkmcnt(14)
ds_read_b64 v[206:207], v239 offset:1800
s_waitcnt lgkmcnt(14)
v_mfma_f32_16x16x32_bf16 v[76:79], v[208:211], v[168:171], v[76:79]
ds_read_b128 v[168:171], v214 offset:144
v_mfma_f32_16x16x32_bf16 v[124:127], v[208:211], v[172:175], v[124:127]
s_waitcnt lgkmcnt(14)
ds_read_b64 v[208:209], v238 offset:4200
s_waitcnt lgkmcnt(14)
ds_read_b64 v[210:211], v239 offset:4200
s_waitcnt lgkmcnt(13)
v_mfma_f32_16x16x32_bf16 v[80:83], v[192:195], v[144:147], 0
ds_read_b128 v[172:175], v215 offset:144
ds_read_b128 v[144:147], v212 offset:160
v_mfma_f32_16x16x32_bf16 v[128:131], v[192:195], v[148:151], 0
s_waitcnt lgkmcnt(14)
ds_read_b64 v[192:193], v238 offset:6600
s_waitcnt lgkmcnt(14)
ds_read_b64 v[194:195], v239 offset:6600
s_waitcnt lgkmcnt(14)
v_mfma_f32_16x16x32_bf16 v[80:83], v[196:199], v[148:151], v[80:83]
ds_read_b128 v[148:151], v213 offset:160
v_mfma_f32_16x16x32_bf16 v[128:131], v[196:199], v[152:155], v[128:131]
s_waitcnt lgkmcnt(14)
ds_read_b64 v[196:197], v238 offset:2000
s_waitcnt lgkmcnt(14)
ds_read_b64 v[198:199], v239 offset:2000
s_waitcnt lgkmcnt(14)
v_mfma_f32_16x16x32_bf16 v[80:83], v[200:203], v[152:155], v[80:83]
ds_read_b128 v[152:155], v214 offset:160
v_mfma_f32_16x16x32_bf16 v[128:131], v[200:203], v[156:159], v[128:131]
s_waitcnt lgkmcnt(14)
ds_read_b64 v[200:201], v238 offset:4400
s_waitcnt lgkmcnt(14)
ds_read_b64 v[202:203], v239 offset:4400
s_waitcnt lgkmcnt(13)
v_mfma_f32_16x16x32_bf16 v[84:87], v[204:207], v[160:163], 0
ds_read_b128 v[156:159], v215 offset:160
ds_read_b128 v[160:163], v212 offset:176
v_mfma_f32_16x16x32_bf16 v[132:135], v[204:207], v[164:167], 0
s_waitcnt lgkmcnt(14)
ds_read_b64 v[204:205], v238 offset:6800
s_waitcnt lgkmcnt(14)
ds_read_b64 v[206:207], v239 offset:6800
s_waitcnt lgkmcnt(14)
v_mfma_f32_16x16x32_bf16 v[84:87], v[208:211], v[164:167], v[84:87]
ds_read_b128 v[164:167], v213 offset:176
v_mfma_f32_16x16x32_bf16 v[132:135], v[208:211], v[168:171], v[132:135]
s_waitcnt lgkmcnt(14)
ds_read_b64 v[208:209], v238 offset:2200
s_waitcnt lgkmcnt(14)
ds_read_b64 v[210:211], v239 offset:2200
s_waitcnt lgkmcnt(13)
v_mfma_f32_16x16x32_bf16 v[84:87], v[192:195], v[168:171], v[84:87]
ds_read_b128 v[168:171], v214 offset:176
v_mfma_f32_16x16x32_bf16 v[132:135], v[192:195], v[172:175], v[132:135]
ds_read_b64 v[192:193], v238 offset:4600
s_waitcnt lgkmcnt(14)
ds_read_b64 v[194:195], v239 offset:4600
s_waitcnt lgkmcnt(13)
v_mfma_f32_16x16x32_bf16 v[88:91], v[196:199], v[144:147], 0
ds_read_b128 v[172:175], v215 offset:176
v_mfma_f32_16x16x32_bf16 v[136:139], v[196:199], v[148:151], 0
ds_read_b64 v[196:197], v238 offset:7000
s_waitcnt lgkmcnt(14)
ds_read_b64 v[198:199], v239 offset:7000
s_waitcnt lgkmcnt(13)
v_mfma_f32_16x16x32_bf16 v[88:91], v[200:203], v[148:151], v[88:91]
v_mfma_f32_16x16x32_bf16 v[136:139], v[200:203], v[152:155], v[136:139]
s_waitcnt lgkmcnt(9)
v_mfma_f32_16x16x32_bf16 v[88:91], v[204:207], v[152:155], v[88:91]
v_mfma_f32_16x16x32_bf16 v[136:139], v[204:207], v[156:159], v[136:139]
s_waitcnt lgkmcnt(6)
v_mfma_f32_16x16x32_bf16 v[92:95], v[208:211], v[160:163], 0
v_mfma_f32_16x16x32_bf16 v[140:143], v[208:211], v[164:167], 0
s_waitcnt lgkmcnt(3)
v_mfma_f32_16x16x32_bf16 v[92:95], v[192:195], v[164:167], v[92:95]
v_mfma_f32_16x16x32_bf16 v[140:143], v[192:195], v[168:171], v[140:143]
s_waitcnt lgkmcnt(0)
v_mfma_f32_16x16x32_bf16 v[92:95], v[196:199], v[168:171], v[92:95]
v_mfma_f32_16x16x32_bf16 v[140:143], v[196:199], v[172:175], v[140:143]
v_mov_b32_e64 v223, 1
v_add_u32 v222, s83, v247
s_nop 7
s_mov_b64 exec, 1
ds_add_u32 v222, v223 offset:24
s_mov_b64 exec, -1
v_pk_mul_f32 v[242:243], v[48:49], v[48:49]
v_pk_add_f32 v[240:241], v[48:49], v[50:51]
v_pk_fma_f32 v[242:243], v[50:51], v[50:51], v[242:243]
v_pk_mul_f32 v[218:219], v[96:97], v[96:97]
v_pk_add_f32 v[216:217], v[96:97], v[98:99]
v_pk_fma_f32 v[218:219], v[98:99], v[98:99], v[218:219]
v_pk_fma_f32 v[242:243], v[52:53], v[52:53], v[242:243]
v_pk_add_f32 v[240:241], v[240:241], v[52:53]
v_pk_fma_f32 v[242:243], v[54:55], v[54:55], v[242:243]
v_pk_add_f32 v[240:241], v[240:241], v[54:55]
v_pk_fma_f32 v[218:219], v[100:101], v[100:101], v[218:219]
v_pk_add_f32 v[216:217], v[216:217], v[100:101]
v_pk_fma_f32 v[218:219], v[102:103], v[102:103], v[218:219]
v_pk_add_f32 v[216:217], v[216:217], v[102:103]
v_pk_fma_f32 v[242:243], v[56:57], v[56:57], v[242:243]
v_pk_add_f32 v[240:241], v[240:241], v[56:57]
v_pk_fma_f32 v[242:243], v[58:59], v[58:59], v[242:243]
v_pk_add_f32 v[240:241], v[240:241], v[58:59]
v_pk_fma_f32 v[218:219], v[104:105], v[104:105], v[218:219]
v_pk_add_f32 v[216:217], v[216:217], v[104:105]
v_pk_fma_f32 v[218:219], v[106:107], v[106:107], v[218:219]
v_pk_add_f32 v[216:217], v[216:217], v[106:107]
v_pk_fma_f32 v[242:243], v[60:61], v[60:61], v[242:243]
v_pk_add_f32 v[240:241], v[240:241], v[60:61]
v_pk_fma_f32 v[242:243], v[62:63], v[62:63], v[242:243]
v_pk_add_f32 v[240:241], v[240:241], v[62:63]
v_pk_fma_f32 v[218:219], v[108:109], v[108:109], v[218:219]
v_pk_add_f32 v[216:217], v[216:217], v[108:109]
v_pk_fma_f32 v[218:219], v[110:111], v[110:111], v[218:219]
v_pk_add_f32 v[216:217], v[216:217], v[110:111]
v_pk_fma_f32 v[242:243], v[64:65], v[64:65], v[242:243]
v_pk_add_f32 v[240:241], v[240:241], v[64:65]
v_pk_fma_f32 v[242:243], v[66:67], v[66:67], v[242:243]
v_pk_add_f32 v[240:241], v[240:241], v[66:67]
v_pk_fma_f32 v[218:219], v[112:113], v[112:113], v[218:219]
v_pk_add_f32 v[216:217], v[216:217], v[112:113]
v_pk_fma_f32 v[218:219], v[114:115], v[114:115], v[218:219]
v_pk_add_f32 v[216:217], v[216:217], v[114:115]
v_pk_fma_f32 v[242:243], v[68:69], v[68:69], v[242:243]
v_pk_add_f32 v[240:241], v[240:241], v[68:69]
v_pk_fma_f32 v[242:243], v[70:71], v[70:71], v[242:243]
v_pk_add_f32 v[240:241], v[240:241], v[70:71]
v_pk_fma_f32 v[218:219], v[116:117], v[116:117], v[218:219]
v_pk_add_f32 v[216:217], v[216:217], v[116:117]
v_pk_fma_f32 v[218:219], v[118:119], v[118:119], v[218:219]
v_pk_add_f32 v[216:217], v[216:217], v[118:119]
v_pk_fma_f32 v[242:243], v[72:73], v[72:73], v[242:243]
v_pk_add_f32 v[240:241], v[240:241], v[72:73]
v_pk_fma_f32 v[242:243], v[74:75], v[74:75], v[242:243]
v_pk_add_f32 v[240:241], v[240:241], v[74:75]
v_pk_fma_f32 v[218:219], v[120:121], v[120:121], v[218:219]
v_pk_add_f32 v[216:217], v[216:217], v[120:121]
v_pk_fma_f32 v[218:219], v[122:123], v[122:123], v[218:219]
v_pk_add_f32 v[216:217], v[216:217], v[122:123]
v_pk_fma_f32 v[242:243], v[76:77], v[76:77], v[242:243]
v_pk_add_f32 v[240:241], v[240:241], v[76:77]
v_pk_fma_f32 v[242:243], v[78:79], v[78:79], v[242:243]
v_pk_add_f32 v[240:241], v[240:241], v[78:79]
v_pk_fma_f32 v[218:219], v[124:125], v[124:125], v[218:219]
v_pk_add_f32 v[216:217], v[216:217], v[124:125]
v_pk_fma_f32 v[218:219], v[126:127], v[126:127], v[218:219]
v_pk_add_f32 v[216:217], v[216:217], v[126:127]
v_pk_fma_f32 v[242:243], v[80:81], v[80:81], v[242:243]
v_pk_add_f32 v[240:241], v[240:241], v[80:81]
v_pk_fma_f32 v[242:243], v[82:83], v[82:83], v[242:243]
v_pk_add_f32 v[240:241], v[240:241], v[82:83]
v_pk_fma_f32 v[218:219], v[128:129], v[128:129], v[218:219]
v_pk_add_f32 v[216:217], v[216:217], v[128:129]
v_pk_fma_f32 v[218:219], v[130:131], v[130:131], v[218:219]
v_pk_add_f32 v[216:217], v[216:217], v[130:131]
v_pk_fma_f32 v[242:243], v[84:85], v[84:85], v[242:243]
v_pk_add_f32 v[240:241], v[240:241], v[84:85]
v_pk_fma_f32 v[242:243], v[86:87], v[86:87], v[242:243]
v_pk_add_f32 v[240:241], v[240:241], v[86:87]
v_pk_fma_f32 v[218:219], v[132:133], v[132:133], v[218:219]
v_pk_add_f32 v[216:217], v[216:217], v[132:133]
v_pk_fma_f32 v[218:219], v[134:135], v[134:135], v[218:219]
v_pk_add_f32 v[216:217], v[216:217], v[134:135]
v_pk_fma_f32 v[242:243], v[88:89], v[88:89], v[242:243]
v_pk_add_f32 v[240:241], v[240:241], v[88:89]
v_pk_fma_f32 v[242:243], v[90:91], v[90:91], v[242:243]
v_pk_add_f32 v[240:241], v[240:241], v[90:91]
v_pk_fma_f32 v[218:219], v[136:137], v[136:137], v[218:219]
v_pk_add_f32 v[216:217], v[216:217], v[136:137]
v_pk_fma_f32 v[218:219], v[138:139], v[138:139], v[218:219]
v_pk_add_f32 v[216:217], v[216:217], v[138:139]
v_pk_fma_f32 v[242:243], v[92:93], v[92:93], v[242:243]
v_pk_add_f32 v[240:241], v[240:241], v[92:93]
v_pk_fma_f32 v[242:243], v[94:95], v[94:95], v[242:243]
v_pk_add_f32 v[240:241], v[240:241], v[94:95]
v_pk_fma_f32 v[218:219], v[140:141], v[140:141], v[218:219]
v_pk_add_f32 v[216:217], v[216:217], v[140:141]
v_pk_fma_f32 v[218:219], v[142:143], v[142:143], v[218:219]
v_pk_add_f32 v[216:217], v[216:217], v[142:143]
v_add_f32 v218, v218, v219
v_add_f32 v216, v216, v217
s_nop 1
v_permlane32_swap_b32 v216, v218
v_add_f32_e64 v216, v216, v218
v_mul_f32 v216, 1009429163, v216
v_mov_b32_e64 v218, v216
s_nop 1
v_permlane32_swap_b32 v216, v218
v_fma_f32 v218, -v216, v216, v218
v_max_f32_e64 v218, 0, v218
v_add_f32 v218, 925353388, v218
v_rsq_f32 v218, v218
v_add_f32 v240, v240, v241
v_mul_f32 v220, 3203396952, v218
v_mul_f32 v221, 3203396952, v218
v_mul_f32 v218, v216, v220
v_mul_f32 v219, v216, v220
v_add_f32 v242, v242, v243
s_nop 1
v_permlane32_swap_b32 v240, v242
v_add_f32 v240, v240, v242
v_mul_f32 v240, 1009429163, v240
v_mov_b32_e64 v242, v240
s_nop 1
v_permlane32_swap_b32 v240, v242
v_fma_f32 v242, -v240, v240, v242
v_max_f32_e64 v242, 0, v242
v_add_f32 v242, 925353388, v242
v_rsq_f32 v242, v242
s_nop 0
v_mul_f32 v244, 3203396952, v242
v_mul_f32 v245, 3203396952, v242
v_mul_f32 v242, v240, v244
v_mul_f32 v243, v240, v244
v_pk_fma_f32 v[48:49], v[48:49], v[244:245], v[242:243] neg_lo:[0,0,1] neg_hi:[0,0,1]
v_pk_fma_f32 v[50:51], v[50:51], v[244:245], v[242:243] neg_lo:[0,0,1] neg_hi:[0,0,1]
v_cvt_pk_bf16_f32 v48, v48, v49
v_cvt_pk_bf16_f32 v49, v50, v51
v_pk_fma_f32 v[52:53], v[52:53], v[244:245], v[242:243] neg_lo:[0,0,1] neg_hi:[0,0,1]
v_pk_fma_f32 v[54:55], v[54:55], v[244:245], v[242:243] neg_lo:[0,0,1] neg_hi:[0,0,1]
v_cvt_pk_bf16_f32 v50, v52, v53
v_cvt_pk_bf16_f32 v51, v54, v55
v_pk_fma_f32 v[56:57], v[56:57], v[244:245], v[242:243] neg_lo:[0,0,1] neg_hi:[0,0,1]
v_pk_fma_f32 v[58:59], v[58:59], v[244:245], v[242:243] neg_lo:[0,0,1] neg_hi:[0,0,1]
v_cvt_pk_bf16_f32 v52, v56, v57
v_cvt_pk_bf16_f32 v53, v58, v59
v_pk_fma_f32 v[60:61], v[60:61], v[244:245], v[242:243] neg_lo:[0,0,1] neg_hi:[0,0,1]
v_pk_fma_f32 v[62:63], v[62:63], v[244:245], v[242:243] neg_lo:[0,0,1] neg_hi:[0,0,1]
v_cvt_pk_bf16_f32 v54, v60, v61
v_cvt_pk_bf16_f32 v55, v62, v63
v_pk_fma_f32 v[64:65], v[64:65], v[244:245], v[242:243] neg_lo:[0,0,1] neg_hi:[0,0,1]
v_pk_fma_f32 v[66:67], v[66:67], v[244:245], v[242:243] neg_lo:[0,0,1] neg_hi:[0,0,1]
v_cvt_pk_bf16_f32 v56, v64, v65
v_cvt_pk_bf16_f32 v57, v66, v67
v_pk_fma_f32 v[68:69], v[68:69], v[244:245], v[242:243] neg_lo:[0,0,1] neg_hi:[0,0,1]
v_pk_fma_f32 v[70:71], v[70:71], v[244:245], v[242:243] neg_lo:[0,0,1] neg_hi:[0,0,1]
v_cvt_pk_bf16_f32 v58, v68, v69
v_cvt_pk_bf16_f32 v59, v70, v71
v_pk_fma_f32 v[72:73], v[72:73], v[244:245], v[242:243] neg_lo:[0,0,1] neg_hi:[0,0,1]
v_pk_fma_f32 v[74:75], v[74:75], v[244:245], v[242:243] neg_lo:[0,0,1] neg_hi:[0,0,1]
v_cvt_pk_bf16_f32 v60, v72, v73
v_cvt_pk_bf16_f32 v61, v74, v75
v_pk_fma_f32 v[76:77], v[76:77], v[244:245], v[242:243] neg_lo:[0,0,1] neg_hi:[0,0,1]
v_pk_fma_f32 v[78:79], v[78:79], v[244:245], v[242:243] neg_lo:[0,0,1] neg_hi:[0,0,1]
v_cvt_pk_bf16_f32 v62, v76, v77
v_cvt_pk_bf16_f32 v63, v78, v79
v_pk_fma_f32 v[80:81], v[80:81], v[244:245], v[242:243] neg_lo:[0,0,1] neg_hi:[0,0,1]
v_pk_fma_f32 v[82:83], v[82:83], v[244:245], v[242:243] neg_lo:[0,0,1] neg_hi:[0,0,1]
v_cvt_pk_bf16_f32 v64, v80, v81
v_cvt_pk_bf16_f32 v65, v82, v83
v_pk_fma_f32 v[84:85], v[84:85], v[244:245], v[242:243] neg_lo:[0,0,1] neg_hi:[0,0,1]
v_pk_fma_f32 v[86:87], v[86:87], v[244:245], v[242:243] neg_lo:[0,0,1] neg_hi:[0,0,1]
v_cvt_pk_bf16_f32 v66, v84, v85
v_cvt_pk_bf16_f32 v67, v86, v87
v_pk_fma_f32 v[88:89], v[88:89], v[244:245], v[242:243] neg_lo:[0,0,1] neg_hi:[0,0,1]
v_pk_fma_f32 v[90:91], v[90:91], v[244:245], v[242:243] neg_lo:[0,0,1] neg_hi:[0,0,1]
v_cvt_pk_bf16_f32 v68, v88, v89
v_cvt_pk_bf16_f32 v69, v90, v91
v_pk_fma_f32 v[92:93], v[92:93], v[244:245], v[242:243] neg_lo:[0,0,1] neg_hi:[0,0,1]
v_pk_fma_f32 v[94:95], v[94:95], v[244:245], v[242:243] neg_lo:[0,0,1] neg_hi:[0,0,1]
v_cvt_pk_bf16_f32 v70, v92, v93
v_cvt_pk_bf16_f32 v71, v94, v95
v_pk_fma_f32 v[96:97], v[96:97], v[220:221], v[218:219] neg_lo:[0,0,1] neg_hi:[0,0,1]
ds_read_b128 v[176:179], v250
v_cvt_pk_bf16_f32 v72, v96, v97
v_pk_fma_f32 v[98:99], v[98:99], v[220:221], v[218:219] neg_lo:[0,0,1] neg_hi:[0,0,1]
v_pk_fma_f32 v[100:101], v[100:101], v[220:221], v[218:219] neg_lo:[0,0,1] neg_hi:[0,0,1]
v_cvt_pk_bf16_f32 v73, v98, v99
v_cvt_pk_bf16_f32 v74, v100, v101
v_pk_fma_f32 v[102:103], v[102:103], v[220:221], v[218:219] neg_lo:[0,0,1] neg_hi:[0,0,1]
v_pk_fma_f32 v[104:105], v[104:105], v[220:221], v[218:219] neg_lo:[0,0,1] neg_hi:[0,0,1]
v_cvt_pk_bf16_f32 v75, v102, v103
v_cvt_pk_bf16_f32 v76, v104, v105
v_pk_fma_f32 v[106:107], v[106:107], v[220:221], v[218:219] neg_lo:[0,0,1] neg_hi:[0,0,1]
v_pk_fma_f32 v[108:109], v[108:109], v[220:221], v[218:219] neg_lo:[0,0,1] neg_hi:[0,0,1]
v_cvt_pk_bf16_f32 v77, v106, v107
v_cvt_pk_bf16_f32 v78, v108, v109
v_pk_fma_f32 v[110:111], v[110:111], v[220:221], v[218:219] neg_lo:[0,0,1] neg_hi:[0,0,1]
v_pk_fma_f32 v[112:113], v[112:113], v[220:221], v[218:219] neg_lo:[0,0,1] neg_hi:[0,0,1]
v_cvt_pk_bf16_f32 v79, v110, v111
v_cvt_pk_bf16_f32 v80, v112, v113
v_pk_fma_f32 v[114:115], v[114:115], v[220:221], v[218:219] neg_lo:[0,0,1] neg_hi:[0,0,1]
v_pk_fma_f32 v[116:117], v[116:117], v[220:221], v[218:219] neg_lo:[0,0,1] neg_hi:[0,0,1]
v_cvt_pk_bf16_f32 v81, v114, v115
v_cvt_pk_bf16_f32 v82, v116, v117
v_pk_fma_f32 v[118:119], v[118:119], v[220:221], v[218:219] neg_lo:[0,0,1] neg_hi:[0,0,1]
v_pk_fma_f32 v[120:121], v[120:121], v[220:221], v[218:219] neg_lo:[0,0,1] neg_hi:[0,0,1]
ds_read_b128 v[180:183], v250 offset:1024
v_cvt_pk_bf16_f32 v83, v118, v119
v_cvt_pk_bf16_f32 v84, v120, v121
v_pk_fma_f32 v[122:123], v[122:123], v[220:221], v[218:219] neg_lo:[0,0,1] neg_hi:[0,0,1]
v_pk_fma_f32 v[124:125], v[124:125], v[220:221], v[218:219] neg_lo:[0,0,1] neg_hi:[0,0,1]
v_cvt_pk_bf16_f32 v85, v122, v123
v_cvt_pk_bf16_f32 v86, v124, v125
v_pk_fma_f32 v[126:127], v[126:127], v[220:221], v[218:219] neg_lo:[0,0,1] neg_hi:[0,0,1]
v_pk_fma_f32 v[128:129], v[128:129], v[220:221], v[218:219] neg_lo:[0,0,1] neg_hi:[0,0,1]
v_cvt_pk_bf16_f32 v87, v126, v127
v_cvt_pk_bf16_f32 v88, v128, v129
v_pk_fma_f32 v[130:131], v[130:131], v[220:221], v[218:219] neg_lo:[0,0,1] neg_hi:[0,0,1]
v_pk_fma_f32 v[132:133], v[132:133], v[220:221], v[218:219] neg_lo:[0,0,1] neg_hi:[0,0,1]
v_cvt_pk_bf16_f32 v89, v130, v131
v_cvt_pk_bf16_f32 v90, v132, v133
v_pk_fma_f32 v[134:135], v[134:135], v[220:221], v[218:219] neg_lo:[0,0,1] neg_hi:[0,0,1]
v_pk_fma_f32 v[136:137], v[136:137], v[220:221], v[218:219] neg_lo:[0,0,1] neg_hi:[0,0,1]
v_cvt_pk_bf16_f32 v91, v134, v135
v_cvt_pk_bf16_f32 v92, v136, v137
v_pk_fma_f32 v[138:139], v[138:139], v[220:221], v[218:219] neg_lo:[0,0,1] neg_hi:[0,0,1]
v_pk_fma_f32 v[140:141], v[140:141], v[220:221], v[218:219] neg_lo:[0,0,1] neg_hi:[0,0,1]
v_cvt_pk_bf16_f32 v93, v138, v139
v_cvt_pk_bf16_f32 v94, v140, v141
v_pk_fma_f32 v[142:143], v[142:143], v[220:221], v[218:219] neg_lo:[0,0,1] neg_hi:[0,0,1]
ds_read_b128 v[184:187], v250 offset:2048
v_cvt_pk_bf16_f32 v95, v142, v143
v_cndmask_b32 v216, 0, v255, s[50:51]
v_and_b32 v216, 1006648320, v216
v_cndmask_b32 v217, 0, v255, s[52:53]
v_and_b32 v217, 1006648320, v217
v_cndmask_b32 v218, 0, v255, s[54:55]
v_and_b32 v218, 1006648320, v218
v_cndmask_b32 v219, 0, v255, s[56:57]
v_and_b32 v219, 1006648320, v219
v_cndmask_b32 v220, 0, v255, s[58:59]
v_and_b32 v220, 1006648320, v220
v_cndmask_b32 v221, 0, v255, s[60:61]
v_and_b32 v221, 1006648320, v221
v_cndmask_b32 v222, 0, v255, s[62:63]
v_and_b32 v222, 1006648320, v222
v_cndmask_b32 v223, 0, v255, s[64:65]
v_and_b32 v223, 1006648320, v223
s_waitcnt lgkmcnt(1)
v_mfma_f32_32x32x16_bf16 v[144:159], v[48:51], v[176:179], 0
s_cmp_lt_u32 s40, 4
s_cbranch_scc0 Lbk
s_setprio 2
Lbk:
ds_read_b128 v[188:191], v250 offset:3072
v_mfma_f32_32x32x16_bf16 v[160:175], v[72:75], v[176:179], 0
ds_read_b128 v[176:179], v250 offset:4096
v_mfma_f32_32x32x16_bf16 v[144:159], v[52:55], v[180:183], v[144:159]
v_mfma_f32_32x32x16_bf16 v[160:175], v[76:79], v[180:183], v[160:175]
ds_read_b128 v[180:183], v250 offset:5120
s_waitcnt lgkmcnt(3)
v_mfma_f32_32x32x16_bf16 v[144:159], v[56:59], v[184:187], v[144:159]
v_mfma_f32_32x32x16_bf16 v[160:175], v[80:83], v[184:187], v[160:175]
ds_read_b128 v[184:187], v250 offset:6144
s_waitcnt lgkmcnt(2)
v_mfma_f32_32x32x16_bf16 v[144:159], v[60:63], v[188:191], v[144:159]
v_mfma_f32_32x32x16_bf16 v[160:175], v[84:87], v[188:191], v[160:175]
ds_read_b128 v[188:191], v250 offset:7168
v_mfma_f32_32x32x16_bf16 v[144:159], v[64:67], v[176:179], v[144:159]
v_mfma_f32_32x32x16_bf16 v[160:175], v[88:91], v[176:179], v[160:175]
ds_read_b128 v[176:179], v250 offset:8192
s_waitcnt lgkmcnt(2)
v_mfma_f32_32x32x16_bf16 v[144:159], v[68:71], v[180:183], v[144:159]
v_mfma_f32_32x32x16_bf16 v[160:175], v[92:95], v[180:183], v[160:175]
ds_read_b128 v[180:183], v250 offset:9216
s_nop 9
v_cvt_pkrtz_f16_f32 v144, v144, v145
v_mfma_f32_32x32x16_bf16 v[112:127], v[48:51], v[184:187], 0
v_cvt_pkrtz_f16_f32 v145, v146, v147
v_lshrrev_b64 v[144:145], 2, v[144:145]
v_and_b32_sdwa v146, s47, v144 dst_sel:DWORD dst_unused:UNUSED_PAD src0_sel:DWORD src1_sel:WORD_1
v_and_b32_e64 v144, s47, v144
v_cvt_pk_f16_f32 v156, v156, v157
v_cvt_pk_f16_f32 v158, v158, v159
v_mfma_f32_32x32x16_bf16 v[128:143], v[72:75], v[184:187], 0
ds_read_u16 v146, v146
ds_read_u16 v144, v144
v_pk_fma_f16 v157, v156, v156, s48
v_and_b32_sdwa v147, s47, v145 dst_sel:DWORD dst_unused:UNUSED_PAD src0_sel:DWORD src1_sel:WORD_1
v_and_b32_e64 v145, s47, v145
v_pk_fma_f16 v159, v158, v158, s48
v_pk_mul_f16 v157, v156, v157
v_pk_mul_f16 v159, v158, v159
v_cvt_pkrtz_f16_f32 v148, v148, v149
v_cvt_pkrtz_f16_f32 v149, v150, v151
v_lshrrev_b64 v[148:149], 2, v[148:149]
ds_read_u16 v147, v147
ds_read_u16 v145, v145
v_and_b32_sdwa v150, s47, v148 dst_sel:DWORD dst_unused:UNUSED_PAD src0_sel:DWORD src1_sel:WORD_1
v_and_b32 v148, s47, v148
v_exp_f16_sdwa v157, v157 dst_sel:WORD_0 dst_unused:UNUSED_PRESERVE src0_sel:WORD_0
s_waitcnt lgkmcnt(4)
v_mfma_f32_32x32x16_bf16 v[112:127], v[52:55], v[188:191], v[112:127]
ds_read_u16 v150, v150
ds_read_u16 v148, v148
v_exp_f16_sdwa v159, v159 dst_sel:WORD_0 dst_unused:UNUSED_PRESERVE src0_sel:WORD_0
v_and_b32_sdwa v151, s47, v149 dst_sel:DWORD dst_unused:UNUSED_PAD src0_sel:DWORD src1_sel:WORD_1
v_and_b32_e64 v149, s47, v149
v_exp_f16_sdwa v157, v157 dst_sel:WORD_1 dst_unused:UNUSED_PRESERVE src0_sel:WORD_1
v_cvt_pkrtz_f16_f32 v152, v152, v153
v_cvt_pkrtz_f16_f32 v153, v154, v155
v_lshrrev_b64 v[152:153], 2, v[152:153]
v_and_b32_sdwa v154, s47, v152 dst_sel:DWORD dst_unused:UNUSED_PAD src0_sel:DWORD src1_sel:WORD_1
v_and_b32_e64 v152, s47, v152
ds_read_u16 v151, v151
ds_read_u16 v149, v149
ds_read_u16 v154, v154
ds_read_u16 v152, v152
v_mfma_f32_32x32x16_bf16 v[128:143], v[76:79], v[188:191], v[128:143]
v_exp_f16_sdwa v159, v159 dst_sel:WORD_1 dst_unused:UNUSED_PRESERVE src0_sel:WORD_1
v_and_b32_sdwa v155, s47, v153 dst_sel:DWORD dst_unused:UNUSED_PAD src0_sel:DWORD src1_sel:WORD_1
v_and_b32_e64 v153, s47, v153
v_pk_add_f16 v157, v157, 1.0 op_sel_hi:[1,0]
v_pk_add_f16 v159, v159, 1.0 op_sel_hi:[1,0]
v_rcp_f16_sdwa v157, v157 dst_sel:WORD_0 dst_unused:UNUSED_PRESERVE src0_sel:WORD_0
v_mfma_f32_32x32x16_bf16 v[112:127], v[56:59], v[176:179], v[112:127]
ds_read_b128 v[184:187], v250 offset:10240
ds_read_u16 v155, v155
ds_read_u16 v153, v153
v_rcp_f16_sdwa v159, v159 dst_sel:WORD_0 dst_unused:UNUSED_PRESERVE src0_sel:WORD_0
v_rcp_f16_sdwa v157, v157 dst_sel:WORD_1 dst_unused:UNUSED_PRESERVE src0_sel:WORD_1
v_mfma_f32_32x32x16_bf16 v[128:143], v[80:83], v[176:179], v[128:143]
v_rcp_f16_sdwa v159, v159 dst_sel:WORD_1 dst_unused:UNUSED_PRESERVE src0_sel:WORD_1
v_pk_mul_f16 v156, v156, v157
v_pk_mul_f16 v158, v158, v159
v_fma_mix_f32 v224, v156, v156, v224 op_sel_hi:[1,1,0]
v_mfma_f32_32x32x16_bf16 v[112:127], v[60:63], v[180:183], v[112:127]
ds_read_b128 v[188:191], v250 offset:11264
v_fma_mix_f32 v224, v158, v158, v224 op_sel_hi:[1,1,0]
v_cvt_pkrtz_f16_f32 v160, v160, v161
v_fma_mix_f32 v224, v156, v156, v224 op_sel:[1,1,0] op_sel_hi:[1,1,0]
v_cvt_pkrtz_f16_f32 v161, v162, v163
v_fma_mix_f32 v224, v158, v158, v224 op_sel:[1,1,0] op_sel_hi:[1,1,0]
v_lshrrev_b64 v[160:161], 2, v[160:161]
s_waitcnt lgkmcnt(7)
v_fma_mix_f32 v224, v144, v144, v224 op_sel_hi:[1,1,0]
v_and_b32_sdwa v162, s47, v160 dst_sel:DWORD dst_unused:UNUSED_PAD src0_sel:DWORD src1_sel:WORD_1
v_fma_mix_f32 v224, v145, v145, v224 op_sel_hi:[1,1,0]
v_and_b32 v160, s47, v160
v_fma_mix_f32 v224, v146, v146, v224 op_sel_hi:[1,1,0]
v_cvt_pk_f16_f32 v172, v172, v173
v_fma_mix_f32 v224, v147, v147, v224 op_sel_hi:[1,1,0]
v_cvt_pk_f16_f32 v174, v174, v175
v_mfma_f32_32x32x16_bf16 v[128:143], v[84:87], v[180:183], v[128:143]
ds_read_u16 v162, v162
ds_read_u16 v160, v160
v_pk_fma_f16 v173, v172, v172, s48
v_fma_mix_f32 v224, v148, v148, v224 op_sel_hi:[1,1,0]
v_and_b32_sdwa v163, s47, v161 dst_sel:DWORD dst_unused:UNUSED_PAD src0_sel:DWORD src1_sel:WORD_1
s_waitcnt lgkmcnt(6)
v_fma_mix_f32 v224, v149, v149, v224 op_sel_hi:[1,1,0]
v_and_b32 v161, s47, v161
v_pk_fma_f16 v175, v174, v174, s48
v_pk_mul_f16 v173, v172, v173
v_pk_mul_f16 v175, v174, v175
v_fma_mix_f32 v224, v150, v150, v224 op_sel_hi:[1,1,0]
v_cvt_pkrtz_f16_f32 v164, v164, v165
v_fma_mix_f32 v224, v151, v151, v224 op_sel_hi:[1,1,0]
ds_read_u16 v163, v163
ds_read_u16 v161, v161
ds_read_b128 v[176:179], v250 offset:12288
v_cvt_pkrtz_f16_f32 v165, v166, v167
v_lshrrev_b64 v[164:165], 2, v[164:165]
v_and_b32_sdwa v166, s47, v164 dst_sel:DWORD dst_unused:UNUSED_PAD src0_sel:DWORD src1_sel:WORD_1
v_and_b32 v164, s47, v164
v_exp_f16_sdwa v173, v173 dst_sel:WORD_0 dst_unused:UNUSED_PRESERVE src0_sel:WORD_0
s_waitcnt lgkmcnt(6)
v_mfma_f32_32x32x16_bf16 v[112:127], v[64:67], v[184:187], v[112:127]
ds_read_u16 v166, v166
ds_read_u16 v164, v164
v_fma_mix_f32 v224, v152, v152, v224 op_sel_hi:[1,1,0]
v_exp_f16_sdwa v175, v175 dst_sel:WORD_0 dst_unused:UNUSED_PRESERVE src0_sel:WORD_0
v_fma_mix_f32 v224, v153, v153, v224 op_sel_hi:[1,1,0]
v_and_b32_sdwa v167, s47, v165 dst_sel:DWORD dst_unused:UNUSED_PAD src0_sel:DWORD src1_sel:WORD_1
v_and_b32_e64 v165, s47, v165
v_exp_f16_sdwa v173, v173 dst_sel:WORD_1 dst_unused:UNUSED_PRESERVE src0_sel:WORD_1
v_fma_mix_f32 v224, v154, v154, v224 op_sel_hi:[1,1,0]
v_cvt_pkrtz_f16_f32 v168, v168, v169
v_fma_mix_f32 v224, v155, v155, v224 op_sel_hi:[1,1,0]
v_cvt_pkrtz_f16_f32 v169, v170, v171
v_lshrrev_b64 v[168:169], 2, v[168:169]
ds_read_u16 v167, v167
ds_read_u16 v165, v165
v_and_b32_sdwa v170, s47, v168 dst_sel:DWORD dst_unused:UNUSED_PAD src0_sel:DWORD src1_sel:WORD_1
v_and_b32_e64 v168, s47, v168
v_mfma_f32_32x32x16_bf16 v[128:143], v[88:91], v[184:187], v[128:143]
ds_read_u16 v170, v170
ds_read_u16 v168, v168
v_exp_f16_sdwa v175, v175 dst_sel:WORD_1 dst_unused:UNUSED_PRESERVE src0_sel:WORD_1
v_and_b32_sdwa v171, s47, v169 dst_sel:DWORD dst_unused:UNUSED_PAD src0_sel:DWORD src1_sel:WORD_1
v_and_b32 v169, s47, v169
v_pk_add_f16 v173, v173, 1.0 op_sel_hi:[1,0]
v_pk_add_f16 v175, v175, 1.0 op_sel_hi:[1,0]
v_rcp_f16_sdwa v173, v173 dst_sel:WORD_0 dst_unused:UNUSED_PRESERVE src0_sel:WORD_0
s_waitcnt lgkmcnt(6)
v_mfma_f32_32x32x16_bf16 v[112:127], v[68:71], v[188:191], v[112:127]
ds_read_b128 v[180:183], v250 offset:13312
ds_read_u16 v171, v171
ds_read_u16 v169, v169
v_rcp_f16_sdwa v175, v175 dst_sel:WORD_0 dst_unused:UNUSED_PRESERVE src0_sel:WORD_0
v_rcp_f16_sdwa v173, v173 dst_sel:WORD_1 dst_unused:UNUSED_PRESERVE src0_sel:WORD_1
v_mfma_f32_32x32x16_bf16 v[128:143], v[92:95], v[188:191], v[128:143]
v_rcp_f16_sdwa v175, v175 dst_sel:WORD_1 dst_unused:UNUSED_PRESERVE src0_sel:WORD_1
v_pk_mul_f16 v172, v172, v173
v_pk_mul_f16 v174, v174, v175
v_fma_mix_f32 v224, v172, v172, v224 op_sel_hi:[1,1,0]
v_mfma_f32_32x32x16_bf16 v[96:111], v[48:51], v[176:179], 0
ds_read_b128 v[184:187], v250 offset:14336
v_fma_mix_f32 v224, v174, v174, v224 op_sel_hi:[1,1,0]
v_cvt_pkrtz_f16_f32 v112, v112, v113
v_fma_mix_f32 v224, v172, v172, v224 op_sel:[1,1,0] op_sel_hi:[1,1,0]
v_cvt_pkrtz_f16_f32 v113, v114, v115
v_fma_mix_f32 v224, v174, v174, v224 op_sel:[1,1,0] op_sel_hi:[1,1,0]
v_lshrrev_b64 v[112:113], 2, v[112:113]
v_fma_mix_f32 v224, v160, v160, v224 op_sel_hi:[1,1,0]
v_and_b32_sdwa v114, s47, v112 dst_sel:DWORD dst_unused:UNUSED_PAD src0_sel:DWORD src1_sel:WORD_1
v_fma_mix_f32 v224, v161, v161, v224 op_sel_hi:[1,1,0]
v_and_b32_e64 v112, s47, v112
v_fma_mix_f32 v224, v162, v162, v224 op_sel_hi:[1,1,0]
v_cvt_pk_f16_f32 v124, v124, v125
v_fma_mix_f32 v224, v163, v163, v224 op_sel_hi:[1,1,0]
v_cvt_pk_f16_f32 v126, v126, v127
v_mfma_f32_32x32x16_bf16 v[144:159], v[176:179], v[72:75], 0
ds_read_u16 v114, v114
ds_read_u16 v112, v112
v_pk_fma_f16 v125, v124, v124, s48
s_waitcnt lgkmcnt(5)
v_fma_mix_f32 v224, v164, v164, v224 op_sel_hi:[1,1,0]
v_and_b32_sdwa v115, s47, v113 dst_sel:DWORD dst_unused:UNUSED_PAD src0_sel:DWORD src1_sel:WORD_1
v_fma_mix_f32 v224, v165, v165, v224 op_sel_hi:[1,1,0]
v_and_b32 v113, s47, v113
v_pk_fma_f16 v127, v126, v126, s48
v_pk_mul_f16 v125, v124, v125
v_pk_mul_f16 v127, v126, v127
v_fma_mix_f32 v224, v166, v166, v224 op_sel_hi:[1,1,0]
v_cvt_pkrtz_f16_f32 v116, v116, v117
v_fma_mix_f32 v224, v167, v167, v224 op_sel_hi:[1,1,0]
ds_read_u16 v115, v115
ds_read_u16 v113, v113
ds_read_b128 v[188:191], v250 offset:15360
v_cvt_pkrtz_f16_f32 v117, v118, v119
v_lshrrev_b64 v[116:117], 2, v[116:117]
v_and_b32_sdwa v118, s47, v116 dst_sel:DWORD dst_unused:UNUSED_PAD src0_sel:DWORD src1_sel:WORD_1
v_and_b32_e64 v116, s47, v116
v_exp_f16_sdwa v125, v125 dst_sel:WORD_0 dst_unused:UNUSED_PRESERVE src0_sel:WORD_0
v_mfma_f32_32x32x16_bf16 v[96:111], v[52:55], v[180:183], v[96:111]
ds_read_u16 v118, v118
ds_read_u16 v116, v116
v_fma_mix_f32 v224, v168, v168, v224 op_sel_hi:[1,1,0]
v_exp_f16_sdwa v127, v127 dst_sel:WORD_0 dst_unused:UNUSED_PRESERVE src0_sel:WORD_0
s_waitcnt lgkmcnt(7)
v_fma_mix_f32 v224, v169, v169, v224 op_sel_hi:[1,1,0]
v_and_b32_sdwa v119, s47, v117 dst_sel:DWORD dst_unused:UNUSED_PAD src0_sel:DWORD src1_sel:WORD_1
v_and_b32 v117, s47, v117
v_exp_f16_sdwa v125, v125 dst_sel:WORD_1 dst_unused:UNUSED_PRESERVE src0_sel:WORD_1
v_fma_mix_f32 v224, v170, v170, v224 op_sel_hi:[1,1,0]
v_cvt_pkrtz_f16_f32 v120, v120, v121
v_fma_mix_f32 v224, v171, v171, v224 op_sel_hi:[1,1,0]
v_cvt_pkrtz_f16_f32 v121, v122, v123
v_lshrrev_b64 v[120:121], 2, v[120:121]
ds_read_u16 v119, v119
ds_read_u16 v117, v117
v_and_b32_sdwa v122, s47, v120 dst_sel:DWORD dst_unused:UNUSED_PAD src0_sel:DWORD src1_sel:WORD_1
v_and_b32_e64 v120, s47, v120
v_mfma_f32_32x32x16_bf16 v[144:159], v[180:183], v[76:79], v[144:159]
ds_read_u16 v122, v122
ds_read_u16 v120, v120
v_exp_f16_sdwa v127, v127 dst_sel:WORD_1 dst_unused:UNUSED_PRESERVE src0_sel:WORD_1
v_and_b32_sdwa v123, s47, v121 dst_sel:DWORD dst_unused:UNUSED_PAD src0_sel:DWORD src1_sel:WORD_1
v_and_b32_e64 v121, s47, v121
v_pk_add_f16 v125, v125, 1.0 op_sel_hi:[1,0]
v_pk_add_f16 v127, v127, 1.0 op_sel_hi:[1,0]
v_rcp_f16_sdwa v125, v125 dst_sel:WORD_0 dst_unused:UNUSED_PRESERVE src0_sel:WORD_0
v_mfma_f32_32x32x16_bf16 v[96:111], v[56:59], v[184:187], v[96:111]
ds_read_b128 v[176:179], v250 offset:16384
ds_read_u16 v123, v123
ds_read_u16 v121, v121
v_rcp_f16_sdwa v127, v127 dst_sel:WORD_0 dst_unused:UNUSED_PRESERVE src0_sel:WORD_0
v_rcp_f16_sdwa v125, v125 dst_sel:WORD_1 dst_unused:UNUSED_PRESERVE src0_sel:WORD_1
v_mfma_f32_32x32x16_bf16 v[144:159], v[184:187], v[80:83], v[144:159]
v_rcp_f16_sdwa v127, v127 dst_sel:WORD_1 dst_unused:UNUSED_PRESERVE src0_sel:WORD_1
v_pk_mul_f16 v124, v124, v125
v_pk_mul_f16 v126, v126, v127
v_fma_mix_f32 v225, v124, v124, v225 op_sel_hi:[1,1,0]
s_waitcnt lgkmcnt(7)
v_mfma_f32_32x32x16_bf16 v[96:111], v[60:63], v[188:191], v[96:111]
ds_read_b128 v[180:183], v250 offset:17408
v_fma_mix_f32 v225, v126, v126, v225 op_sel_hi:[1,1,0]
v_cvt_pkrtz_f16_f32 v128, v128, v129
v_fma_mix_f32 v225, v124, v124, v225 op_sel:[1,1,0] op_sel_hi:[1,1,0]
v_cvt_pkrtz_f16_f32 v129, v130, v131
v_fma_mix_f32 v225, v126, v126, v225 op_sel:[1,1,0] op_sel_hi:[1,1,0]
v_lshrrev_b64 v[128:129], 2, v[128:129]
v_fma_mix_f32 v225, v112, v112, v225 op_sel_hi:[1,1,0]
v_and_b32_sdwa v130, s47, v128 dst_sel:DWORD dst_unused:UNUSED_PAD src0_sel:DWORD src1_sel:WORD_1
v_fma_mix_f32 v225, v113, v113, v225 op_sel_hi:[1,1,0]
v_and_b32 v128, s47, v128
v_fma_mix_f32 v225, v114, v114, v225 op_sel_hi:[1,1,0]
v_cvt_pk_f16_f32 v140, v140, v141
v_fma_mix_f32 v225, v115, v115, v225 op_sel_hi:[1,1,0]
v_cvt_pk_f16_f32 v142, v142, v143
v_mfma_f32_32x32x16_bf16 v[144:159], v[188:191], v[84:87], v[144:159]
ds_read_u16 v130, v130
ds_read_u16 v128, v128
v_pk_fma_f16 v141, v140, v140, s48
v_fma_mix_f32 v225, v116, v116, v225 op_sel_hi:[1,1,0]
v_and_b32_sdwa v131, s47, v129 dst_sel:DWORD dst_unused:UNUSED_PAD src0_sel:DWORD src1_sel:WORD_1
s_waitcnt lgkmcnt(5)
v_fma_mix_f32 v225, v117, v117, v225 op_sel_hi:[1,1,0]
v_and_b32 v129, s47, v129
v_pk_fma_f16 v143, v142, v142, s48
v_pk_mul_f16 v141, v140, v141
v_pk_mul_f16 v143, v142, v143
v_fma_mix_f32 v225, v118, v118, v225 op_sel_hi:[1,1,0]
v_cvt_pkrtz_f16_f32 v132, v132, v133
v_fma_mix_f32 v225, v119, v119, v225 op_sel_hi:[1,1,0]
ds_read_u16 v131, v131
ds_read_u16 v129, v129
ds_read_b128 v[184:187], v250 offset:18432
v_cvt_pkrtz_f16_f32 v133, v134, v135
v_lshrrev_b64 v[132:133], 2, v[132:133]
v_and_b32_sdwa v134, s47, v132 dst_sel:DWORD dst_unused:UNUSED_PAD src0_sel:DWORD src1_sel:WORD_1
v_and_b32_e64 v132, s47, v132
v_exp_f16_sdwa v141, v141 dst_sel:WORD_0 dst_unused:UNUSED_PRESERVE src0_sel:WORD_0
v_mfma_f32_32x32x16_bf16 v[96:111], v[64:67], v[176:179], v[96:111]
ds_read_u16 v134, v134
ds_read_u16 v132, v132
v_fma_mix_f32 v225, v120, v120, v225 op_sel_hi:[1,1,0]
v_exp_f16_sdwa v143, v143 dst_sel:WORD_0 dst_unused:UNUSED_PRESERVE src0_sel:WORD_0
s_waitcnt lgkmcnt(7)
v_fma_mix_f32 v225, v121, v121, v225 op_sel_hi:[1,1,0]
v_and_b32_sdwa v135, s47, v133 dst_sel:DWORD dst_unused:UNUSED_PAD src0_sel:DWORD src1_sel:WORD_1
v_and_b32 v133, s47, v133
v_exp_f16_sdwa v141, v141 dst_sel:WORD_1 dst_unused:UNUSED_PRESERVE src0_sel:WORD_1
v_fma_mix_f32 v225, v122, v122, v225 op_sel_hi:[1,1,0]
v_cvt_pkrtz_f16_f32 v136, v136, v137
v_fma_mix_f32 v225, v123, v123, v225 op_sel_hi:[1,1,0]
v_cvt_pkrtz_f16_f32 v137, v138, v139
v_lshrrev_b64 v[136:137], 2, v[136:137]
ds_read_u16 v135, v135
ds_read_u16 v133, v133
v_and_b32_sdwa v138, s47, v136 dst_sel:DWORD dst_unused:UNUSED_PAD src0_sel:DWORD src1_sel:WORD_1
v_and_b32_e64 v136, s47, v136
v_mfma_f32_32x32x16_bf16 v[144:159], v[176:179], v[88:91], v[144:159]
ds_read_u16 v138, v138
ds_read_u16 v136, v136
v_exp_f16_sdwa v143, v143 dst_sel:WORD_1 dst_unused:UNUSED_PRESERVE src0_sel:WORD_1
v_and_b32_sdwa v139, s47, v137 dst_sel:DWORD dst_unused:UNUSED_PAD src0_sel:DWORD src1_sel:WORD_1
v_and_b32_e64 v137, s47, v137
v_pk_add_f16 v141, v141, 1.0 op_sel_hi:[1,0]
v_pk_add_f16 v143, v143, 1.0 op_sel_hi:[1,0]
v_rcp_f16_sdwa v141, v141 dst_sel:WORD_0 dst_unused:UNUSED_PRESERVE src0_sel:WORD_0
v_mfma_f32_32x32x16_bf16 v[96:111], v[68:71], v[180:183], v[96:111]
ds_read_b128 v[188:191], v250 offset:19456
ds_read_u16 v139, v139
ds_read_u16 v137, v137
v_rcp_f16_sdwa v143, v143 dst_sel:WORD_0 dst_unused:UNUSED_PRESERVE src0_sel:WORD_0
v_rcp_f16_sdwa v141, v141 dst_sel:WORD_1 dst_unused:UNUSED_PRESERVE src0_sel:WORD_1
v_mfma_f32_32x32x16_bf16 v[144:159], v[180:183], v[92:95], v[144:159]
v_rcp_f16_sdwa v143, v143 dst_sel:WORD_1 dst_unused:UNUSED_PRESERVE src0_sel:WORD_1
v_pk_mul_f16 v140, v140, v141
v_pk_mul_f16 v142, v142, v143
v_fma_mix_f32 v225, v140, v140, v225 op_sel_hi:[1,1,0]
s_waitcnt lgkmcnt(7)
v_mfma_f32_32x32x16_bf16 v[160:175], v[48:51], v[184:187], 0
ds_read_b128 v[176:179], v250 offset:20480
v_fma_mix_f32 v225, v142, v142, v225 op_sel_hi:[1,1,0]
v_cvt_pkrtz_f16_f32 v96, v96, v97
v_fma_mix_f32 v225, v140, v140, v225 op_sel:[1,1,0] op_sel_hi:[1,1,0]
v_cvt_pkrtz_f16_f32 v97, v98, v99
v_fma_mix_f32 v225, v142, v142, v225 op_sel:[1,1,0] op_sel_hi:[1,1,0]
v_lshrrev_b64 v[96:97], 2, v[96:97]
v_fma_mix_f32 v225, v128, v128, v225 op_sel_hi:[1,1,0]
v_and_b32_sdwa v98, s47, v96 dst_sel:DWORD dst_unused:UNUSED_PAD src0_sel:DWORD src1_sel:WORD_1
v_fma_mix_f32 v225, v129, v129, v225 op_sel_hi:[1,1,0]
v_and_b32 v96, s47, v96
v_fma_mix_f32 v225, v130, v130, v225 op_sel_hi:[1,1,0]
v_cvt_pk_f16_f32 v108, v108, v109
v_fma_mix_f32 v225, v131, v131, v225 op_sel_hi:[1,1,0]
v_cvt_pk_f16_f32 v110, v110, v111
v_mfma_f32_32x32x16_bf16 v[112:127], v[184:187], v[72:75], 0
ds_read_u16 v98, v98
ds_read_u16 v96, v96
v_pk_fma_f16 v109, v108, v108, s48
v_fma_mix_f32 v225, v132, v132, v225 op_sel_hi:[1,1,0]
v_and_b32_sdwa v99, s47, v97 dst_sel:DWORD dst_unused:UNUSED_PAD src0_sel:DWORD src1_sel:WORD_1
s_waitcnt lgkmcnt(5)
v_fma_mix_f32 v225, v133, v133, v225 op_sel_hi:[1,1,0]
v_and_b32 v97, s47, v97
v_pk_fma_f16 v111, v110, v110, s48
v_pk_mul_f16 v109, v108, v109
v_pk_mul_f16 v111, v110, v111
v_fma_mix_f32 v225, v134, v134, v225 op_sel_hi:[1,1,0]
v_cvt_pkrtz_f16_f32 v100, v100, v101
v_fma_mix_f32 v225, v135, v135, v225 op_sel_hi:[1,1,0]
ds_read_u16 v99, v99
ds_read_u16 v97, v97
ds_read_b128 v[180:183], v250 offset:21504
v_cvt_pkrtz_f16_f32 v101, v102, v103
v_lshrrev_b64 v[100:101], 2, v[100:101]
v_and_b32_sdwa v102, s47, v100 dst_sel:DWORD dst_unused:UNUSED_PAD src0_sel:DWORD src1_sel:WORD_1
v_and_b32_e64 v100, s47, v100
v_exp_f16_sdwa v109, v109 dst_sel:WORD_0 dst_unused:UNUSED_PRESERVE src0_sel:WORD_0
v_mfma_f32_32x32x16_bf16 v[160:175], v[52:55], v[188:191], v[160:175]
ds_read_u16 v102, v102
ds_read_u16 v100, v100
v_fma_mix_f32 v225, v136, v136, v225 op_sel_hi:[1,1,0]
v_exp_f16_sdwa v111, v111 dst_sel:WORD_0 dst_unused:UNUSED_PRESERVE src0_sel:WORD_0
s_waitcnt lgkmcnt(7)
v_fma_mix_f32 v225, v137, v137, v225 op_sel_hi:[1,1,0]
v_and_b32_sdwa v103, s47, v101 dst_sel:DWORD dst_unused:UNUSED_PAD src0_sel:DWORD src1_sel:WORD_1
v_and_b32 v101, s47, v101
v_exp_f16_sdwa v109, v109 dst_sel:WORD_1 dst_unused:UNUSED_PRESERVE src0_sel:WORD_1
v_fma_mix_f32 v225, v138, v138, v225 op_sel_hi:[1,1,0]
v_cvt_pkrtz_f16_f32 v104, v104, v105
v_fma_mix_f32 v225, v139, v139, v225 op_sel_hi:[1,1,0]
v_cvt_pkrtz_f16_f32 v105, v106, v107
v_lshrrev_b64 v[104:105], 2, v[104:105]
ds_read_u16 v103, v103
ds_read_u16 v101, v101
v_and_b32_sdwa v106, s47, v104 dst_sel:DWORD dst_unused:UNUSED_PAD src0_sel:DWORD src1_sel:WORD_1
v_and_b32_e64 v104, s47, v104
v_mfma_f32_32x32x16_bf16 v[112:127], v[188:191], v[76:79], v[112:127]
ds_read_u16 v106, v106
ds_read_u16 v104, v104
v_exp_f16_sdwa v111, v111 dst_sel:WORD_1 dst_unused:UNUSED_PRESERVE src0_sel:WORD_1
v_and_b32_sdwa v107, s47, v105 dst_sel:DWORD dst_unused:UNUSED_PAD src0_sel:DWORD src1_sel:WORD_1
v_and_b32_e64 v105, s47, v105
v_pk_add_f16 v109, v109, 1.0 op_sel_hi:[1,0]
v_pk_add_f16 v111, v111, 1.0 op_sel_hi:[1,0]
v_rcp_f16_sdwa v109, v109 dst_sel:WORD_0 dst_unused:UNUSED_PRESERVE src0_sel:WORD_0
v_mfma_f32_32x32x16_bf16 v[160:175], v[56:59], v[176:179], v[160:175]
ds_read_b128 v[184:187], v250 offset:22528
ds_read_u16 v107, v107
ds_read_u16 v105, v105
v_rcp_f16_sdwa v111, v111 dst_sel:WORD_0 dst_unused:UNUSED_PRESERVE src0_sel:WORD_0
v_rcp_f16_sdwa v109, v109 dst_sel:WORD_1 dst_unused:UNUSED_PRESERVE src0_sel:WORD_1
v_mfma_f32_32x32x16_bf16 v[112:127], v[176:179], v[80:83], v[112:127]
v_rcp_f16_sdwa v111, v111 dst_sel:WORD_1 dst_unused:UNUSED_PRESERVE src0_sel:WORD_1
v_pk_mul_f16 v108, v108, v109
v_pk_mul_f16 v110, v110, v111
v_fma_mix_f32 v226, v108, v108, v226 op_sel_hi:[1,1,0]
s_waitcnt lgkmcnt(7)
v_mfma_f32_32x32x16_bf16 v[160:175], v[60:63], v[180:183], v[160:175]
ds_read_b128 v[188:191], v250 offset:23552
v_fma_mix_f32 v226, v110, v110, v226 op_sel_hi:[1,1,0]
v_cvt_pkrtz_f16_f32 v144, v144, v145
v_fma_mix_f32 v226, v108, v108, v226 op_sel:[1,1,0] op_sel_hi:[1,1,0]
v_cvt_pkrtz_f16_f32 v145, v146, v147
v_fma_mix_f32 v226, v110, v110, v226 op_sel:[1,1,0] op_sel_hi:[1,1,0]
v_lshrrev_b64 v[144:145], 2, v[144:145]
v_fma_mix_f32 v226, v96, v96, v226 op_sel_hi:[1,1,0]
v_and_b32_sdwa v146, s47, v144 dst_sel:DWORD dst_unused:UNUSED_PAD src0_sel:DWORD src1_sel:WORD_1
v_fma_mix_f32 v226, v97, v97, v226 op_sel_hi:[1,1,0]
v_and_b32 v144, s47, v144
v_fma_mix_f32 v226, v98, v98, v226 op_sel_hi:[1,1,0]
v_cvt_pk_f16_f32 v156, v156, v157
v_fma_mix_f32 v226, v99, v99, v226 op_sel_hi:[1,1,0]
v_cvt_pk_f16_f32 v158, v158, v159
v_mfma_f32_32x32x16_bf16 v[112:127], v[180:183], v[84:87], v[112:127]
ds_read_u16_d16_hi v146, v146
ds_read_u16 v144, v144
v_pk_fma_f16 v157, v156, v156, s48
v_fma_mix_f32 v226, v100, v100, v226 op_sel_hi:[1,1,0]
v_and_b32_sdwa v147, s47, v145 dst_sel:DWORD dst_unused:UNUSED_PAD src0_sel:DWORD src1_sel:WORD_1
s_waitcnt lgkmcnt(5)
v_fma_mix_f32 v226, v101, v101, v226 op_sel_hi:[1,1,0]
v_and_b32 v145, s47, v145
v_pk_fma_f16 v159, v158, v158, s48
v_pk_mul_f16 v157, v156, v157
v_fma_mix_f32 v226, v102, v102, v226 op_sel_hi:[1,1,0]
v_cvt_pkrtz_f16_f32 v148, v148, v149
v_fma_mix_f32 v226, v103, v103, v226 op_sel_hi:[1,1,0]
v_cvt_pkrtz_f16_f32 v149, v150, v151
ds_read_u16_d16_hi v147, v147
ds_read_u16 v145, v145
ds_read_b128 v[176:179], v250 offset:24576
v_lshrrev_b64 v[148:149], 2, v[148:149]
v_and_b32_sdwa v150, s47, v148 dst_sel:DWORD dst_unused:UNUSED_PAD src0_sel:DWORD src1_sel:WORD_1
v_and_b32_e64 v148, s47, v148
v_pk_mul_f16 v159, v158, v159
v_exp_f16_sdwa v157, v157 dst_sel:WORD_0 dst_unused:UNUSED_PRESERVE src0_sel:WORD_0
v_mfma_f32_32x32x16_bf16 v[160:175], v[64:67], v[184:187], v[160:175]
ds_read_u16_d16_hi v150, v150
ds_read_u16 v148, v148
v_fma_mix_f32 v226, v104, v104, v226 op_sel_hi:[1,1,0]
v_and_b32_sdwa v151, s47, v149 dst_sel:DWORD dst_unused:UNUSED_PAD src0_sel:DWORD src1_sel:WORD_1
s_waitcnt lgkmcnt(7)
v_fma_mix_f32 v226, v105, v105, v226 op_sel_hi:[1,1,0]
v_and_b32 v149, s47, v149
v_exp_f16_sdwa v159, v159 dst_sel:WORD_0 dst_unused:UNUSED_PRESERVE src0_sel:WORD_0
v_fma_mix_f32 v226, v106, v106, v226 op_sel_hi:[1,1,0]
v_cvt_pkrtz_f16_f32 v152, v152, v153
v_fma_mix_f32 v226, v107, v107, v226 op_sel_hi:[1,1,0]
v_cvt_pkrtz_f16_f32 v153, v154, v155
v_lshrrev_b64 v[152:153], 2, v[152:153]
ds_read_u16_d16_hi v151, v151
ds_read_u16 v149, v149
v_and_b32_sdwa v154, s47, v152 dst_sel:DWORD dst_unused:UNUSED_PAD src0_sel:DWORD src1_sel:WORD_1
v_and_b32_e64 v152, s47, v152
v_exp_f16_sdwa v157, v157 dst_sel:WORD_1 dst_unused:UNUSED_PRESERVE src0_sel:WORD_1
v_mfma_f32_32x32x16_bf16 v[112:127], v[184:187], v[88:91], v[112:127]
ds_read_u16_d16_hi v154, v154
ds_read_u16 v152, v152
ds_read_b128 v[180:183], v250 offset:25600
v_and_b32_sdwa v155, s47, v153 dst_sel:DWORD dst_unused:UNUSED_PAD src0_sel:DWORD src1_sel:WORD_1
v_and_b32_e64 v153, s47, v153
v_exp_f16_sdwa v159, v159 dst_sel:WORD_1 dst_unused:UNUSED_PRESERVE src0_sel:WORD_1
v_pk_add_f16 v157, v157, 1.0 op_sel_hi:[1,0]
v_mfma_f32_32x32x16_bf16 v[160:175], v[68:71], v[188:191], v[160:175]
ds_read_u16_d16_hi v155, v155
ds_read_u16 v153, v153
v_pk_add_f16 v159, v159, 1.0 op_sel_hi:[1,0]
v_rcp_f16_sdwa v157, v157 dst_sel:WORD_0 dst_unused:UNUSED_PRESERVE src0_sel:WORD_0
v_rcp_f16_sdwa v159, v159 dst_sel:WORD_0 dst_unused:UNUSED_PRESERVE src0_sel:WORD_0
v_mfma_f32_32x32x16_bf16 v[112:127], v[188:191], v[92:95], v[112:127]
ds_read_b128 v[184:187], v250 offset:26624
v_rcp_f16_sdwa v157, v157 dst_sel:WORD_1 dst_unused:UNUSED_PRESERVE src0_sel:WORD_1
v_rcp_f16_sdwa v159, v159 dst_sel:WORD_1 dst_unused:UNUSED_PRESERVE src0_sel:WORD_1
v_pk_mul_f16 v6, v156, v157
s_waitcnt lgkmcnt(8)
v_mfma_f32_32x32x16_bf16 v[128:143], v[48:51], v[176:179], 0
v_pk_mul_f16 v7, v158, v159
v_lshl_add_u64 v[0:1], v[144:145], 0, v[146:147]
v_cvt_pkrtz_f16_f32 v160, v160, v161
v_cvt_pkrtz_f16_f32 v161, v162, v163
v_lshrrev_b64 v[160:161], 2, v[160:161]
v_and_b32_sdwa v162, s47, v160 dst_sel:DWORD dst_unused:UNUSED_PAD src0_sel:DWORD src1_sel:WORD_1
v_and_b32 v160, s47, v160
v_cvt_pk_f16_f32 v172, v172, v173
v_cvt_pk_f16_f32 v174, v174, v175
v_mfma_f32_32x32x16_bf16 v[96:111], v[176:179], v[72:75], 0
ds_read_u16 v162, v162
ds_read_u16 v160, v160
v_pk_fma_f16 v173, v172, v172, s48
v_and_b32_sdwa v163, s47, v161 dst_sel:DWORD dst_unused:UNUSED_PAD src0_sel:DWORD src1_sel:WORD_1
v_and_b32 v161, s47, v161
v_pk_fma_f16 v175, v174, v174, s48
v_pk_mul_f16 v173, v172, v173
v_pk_mul_f16 v175, v174, v175
s_waitcnt lgkmcnt(6)
v_lshl_add_u64 v[4:5], v[148:149], 0, v[150:151]
v_cvt_pkrtz_f16_f32 v164, v164, v165
v_cvt_pkrtz_f16_f32 v165, v166, v167
ds_read_u16 v163, v163
ds_read_u16 v161, v161
ds_read_b128 v[188:191], v250 offset:27648
v_lshrrev_b64 v[164:165], 2, v[164:165]
v_and_b32_sdwa v166, s47, v164 dst_sel:DWORD dst_unused:UNUSED_PAD src0_sel:DWORD src1_sel:WORD_1
v_and_b32 v164, s47, v164
v_exp_f16_sdwa v173, v173 dst_sel:WORD_0 dst_unused:UNUSED_PRESERVE src0_sel:WORD_0
s_waitcnt lgkmcnt(7)
v_mfma_f32_32x32x16_bf16 v[128:143], v[52:55], v[180:183], v[128:143]
ds_read_u16 v166, v166
ds_read_u16 v164, v164
v_exp_f16_sdwa v175, v175 dst_sel:WORD_0 dst_unused:UNUSED_PRESERVE src0_sel:WORD_0
v_and_b32_sdwa v167, s47, v165 dst_sel:DWORD dst_unused:UNUSED_PAD src0_sel:DWORD src1_sel:WORD_1
v_and_b32 v165, s47, v165
v_exp_f16_sdwa v173, v173 dst_sel:WORD_1 dst_unused:UNUSED_PRESERVE src0_sel:WORD_1
s_waitcnt lgkmcnt(7)
v_lshl_add_u64 v[2:3], v[152:153], 0, v[154:155]
v_cvt_pkrtz_f16_f32 v168, v168, v169
v_cvt_pkrtz_f16_f32 v169, v170, v171
v_lshrrev_b64 v[168:169], 2, v[168:169]
v_and_b32_sdwa v170, s47, v168 dst_sel:DWORD dst_unused:UNUSED_PAD src0_sel:DWORD src1_sel:WORD_1
ds_read_u16 v167, v167
ds_read_u16 v165, v165
v_and_b32_e64 v168, s47, v168
v_mfma_f32_32x32x16_bf16 v[96:111], v[180:183], v[76:79], v[96:111]
ds_read_u16 v170, v170
ds_read_u16 v168, v168
v_exp_f16_sdwa v175, v175 dst_sel:WORD_1 dst_unused:UNUSED_PRESERVE src0_sel:WORD_1
v_and_b32_sdwa v171, s47, v169 dst_sel:DWORD dst_unused:UNUSED_PAD src0_sel:DWORD src1_sel:WORD_1
v_and_b32_e64 v169, s47, v169
v_mfma_f32_32x32x16_f16 v[144:159], v[0:3], v[216:219], 0
ds_read_b128 v[176:179], v250 offset:28672
ds_read_u16 v171, v171
ds_read_u16 v169, v169
v_pk_add_f16 v173, v173, 1.0 op_sel_hi:[1,0]
v_pk_add_f16 v175, v175, 1.0 op_sel_hi:[1,0]
v_rcp_f16_sdwa v173, v173 dst_sel:WORD_0 dst_unused:UNUSED_PRESERVE src0_sel:WORD_0
v_mfma_f32_32x32x16_f16 v[144:159], v[4:7], v[220:223], v[144:159]
v_permlane16_swap_b32 v0, v4
v_permlane16_swap_b32 v1, v5
v_permlane16_swap_b32 v2, v6
v_permlane16_swap_b32 v3, v7
v_rcp_f16_sdwa v175, v175 dst_sel:WORD_0 dst_unused:UNUSED_PRESERVE src0_sel:WORD_0
v_mfma_f32_32x32x16_bf16 v[128:143], v[56:59], v[184:187], v[128:143]
v_rcp_f16_sdwa v173, v173 dst_sel:WORD_1 dst_unused:UNUSED_PRESERVE src0_sel:WORD_1
v_rcp_f16_sdwa v175, v175 dst_sel:WORD_1 dst_unused:UNUSED_PRESERVE src0_sel:WORD_1
s_nop 3
v_fmac_f32 v226, v144, v144
v_mfma_f32_32x32x16_bf16 v[96:111], v[184:187], v[80:83], v[96:111]
ds_read_b128 v[180:183], v250 offset:29696
v_pk_mul_f16 v172, v172, v173
v_fmac_f32_e64 v226, v145, v145
v_pk_mul_f16 v174, v174, v175
v_fmac_f32 v226, v146, v146
v_fmac_f32 v226, v147, v147
v_fma_mix_f32 v227, v172, v172, v227 op_sel_hi:[1,1,0]
v_fmac_f32 v226, v148, v148
v_fmac_f32 v226, v149, v149
v_fma_mix_f32 v227, v174, v174, v227 op_sel_hi:[1,1,0]
s_waitcnt lgkmcnt(6)
v_mfma_f32_32x32x16_bf16 v[128:143], v[60:63], v[188:191], v[128:143]
v_fmac_f32 v226, v150, v150
v_fma_mix_f32 v227, v172, v172, v227 op_sel:[1,1,0] op_sel_hi:[1,1,0]
v_fmac_f32 v226, v151, v151
v_fmac_f32 v226, v152, v152
v_fma_mix_f32 v227, v174, v174, v227 op_sel:[1,1,0] op_sel_hi:[1,1,0]
v_fmac_f32_e64 v226, v153, v153
v_fma_mix_f32 v227, v160, v160, v227 op_sel_hi:[1,1,0]
v_fmac_f32_e64 v226, v154, v154
v_fma_mix_f32 v227, v161, v161, v227 op_sel_hi:[1,1,0]
v_cvt_pkrtz_f16_f32 v112, v112, v113
v_fma_mix_f32 v227, v162, v162, v227 op_sel_hi:[1,1,0]
v_cvt_pkrtz_f16_f32 v113, v114, v115
v_fma_mix_f32 v227, v163, v163, v227 op_sel_hi:[1,1,0]
v_lshrrev_b64 v[112:113], 2, v[112:113]
v_and_b32_sdwa v114, s47, v112 dst_sel:DWORD dst_unused:UNUSED_PAD src0_sel:DWORD src1_sel:WORD_1
v_and_b32_e64 v112, s47, v112
v_cvt_pk_f16_f32 v124, v124, v125
v_fmac_f32_e64 v226, v155, v155
v_cvt_pk_f16_f32 v126, v126, v127
v_fmac_f32 v226, v156, v156
v_fmac_f32 v226, v157, v157
v_mfma_f32_32x32x16_bf16 v[96:111], v[188:191], v[84:87], v[96:111]
ds_read_u16_d16_hi v114, v114
ds_read_u16 v112, v112
v_pk_fma_f16 v125, v124, v124, s48
v_fmac_f32_e64 v226, v158, v158
v_fma_mix_f32 v227, v164, v164, v227 op_sel_hi:[1,1,0]
v_and_b32_sdwa v115, s47, v113 dst_sel:DWORD dst_unused:UNUSED_PAD src0_sel:DWORD src1_sel:WORD_1
v_fma_mix_f32 v227, v165, v165, v227 op_sel_hi:[1,1,0]
v_and_b32 v113, s47, v113
v_fmac_f32 v226, v159, v159
v_pk_fma_f16 v127, v126, v126, s48
v_pk_mul_f16 v125, v124, v125
v_fma_mix_f32 v227, v166, v166, v227 op_sel_hi:[1,1,0]
v_cvt_pkrtz_f16_f32 v116, v116, v117
v_fma_mix_f32 v227, v167, v167, v227 op_sel_hi:[1,1,0]
ds_read_u16_d16_hi v115, v115
ds_read_u16 v113, v113
ds_read_b128 v[184:187], v250 offset:30720
v_cvt_pkrtz_f16_f32 v117, v118, v119
v_lshrrev_b64 v[116:117], 2, v[116:117]
v_and_b32_sdwa v118, s47, v116 dst_sel:DWORD dst_unused:UNUSED_PAD src0_sel:DWORD src1_sel:WORD_1
v_and_b32 v116, s47, v116
v_pk_mul_f16 v127, v126, v127
v_exp_f16_sdwa v125, v125 dst_sel:WORD_0 dst_unused:UNUSED_PRESERVE src0_sel:WORD_0
s_waitcnt lgkmcnt(5)
v_mfma_f32_32x32x16_bf16 v[128:143], v[64:67], v[176:179], v[128:143]
ds_read_u16_d16_hi v118, v118
ds_read_u16 v116, v116
v_fma_mix_f32 v227, v168, v168, v227 op_sel_hi:[1,1,0]
v_and_b32_sdwa v119, s47, v117 dst_sel:DWORD dst_unused:UNUSED_PAD src0_sel:DWORD src1_sel:WORD_1
v_fma_mix_f32 v227, v169, v169, v227 op_sel_hi:[1,1,0]
v_and_b32_e64 v117, s47, v117
v_exp_f16_sdwa v127, v127 dst_sel:WORD_0 dst_unused:UNUSED_PRESERVE src0_sel:WORD_0
v_fma_mix_f32 v227, v170, v170, v227 op_sel_hi:[1,1,0]
v_cvt_pkrtz_f16_f32 v120, v120, v121
v_fma_mix_f32 v227, v171, v171, v227 op_sel_hi:[1,1,0]
v_cvt_pkrtz_f16_f32 v121, v122, v123
v_lshrrev_b64 v[120:121], 2, v[120:121]
ds_read_u16_d16_hi v119, v119
ds_read_u16 v117, v117
v_and_b32_sdwa v122, s47, v120 dst_sel:DWORD dst_unused:UNUSED_PAD src0_sel:DWORD src1_sel:WORD_1
v_and_b32_e64 v120, s47, v120
v_exp_f16_sdwa v125, v125 dst_sel:WORD_1 dst_unused:UNUSED_PRESERVE src0_sel:WORD_1
v_mfma_f32_32x32x16_bf16 v[96:111], v[176:179], v[88:91], v[96:111]
ds_read_u16_d16_hi v122, v122
ds_read_u16 v120, v120
ds_read_b128 v[188:191], v250 offset:31744
v_and_b32_sdwa v123, s47, v121 dst_sel:DWORD dst_unused:UNUSED_PAD src0_sel:DWORD src1_sel:WORD_1
v_and_b32_e64 v121, s47, v121
v_exp_f16_sdwa v127, v127 dst_sel:WORD_1 dst_unused:UNUSED_PRESERVE src0_sel:WORD_1
v_pk_add_f16 v125, v125, 1.0 op_sel_hi:[1,0]
v_mfma_f32_32x32x16_bf16 v[128:143], v[68:71], v[180:183], v[128:143]
ds_read_u16_d16_hi v123, v123
ds_read_u16 v121, v121
v_pk_add_f16 v127, v127, 1.0 op_sel_hi:[1,0]
v_rcp_f16_sdwa v125, v125 dst_sel:WORD_0 dst_unused:UNUSED_PRESERVE src0_sel:WORD_0
v_rcp_f16_sdwa v127, v127 dst_sel:WORD_0 dst_unused:UNUSED_PRESERVE src0_sel:WORD_0
v_mfma_f32_32x32x16_bf16 v[96:111], v[180:183], v[92:95], v[96:111]
ds_read_b128 v[176:179], v250 offset:32768
v_rcp_f16_sdwa v125, v125 dst_sel:WORD_1 dst_unused:UNUSED_PRESERVE src0_sel:WORD_1
v_rcp_f16_sdwa v127, v127 dst_sel:WORD_1 dst_unused:UNUSED_PRESERVE src0_sel:WORD_1
s_cmp_lg_u32 s40, 0
s_cbranch_scc1 Lpix
v_and_b32 v244, 0x3ff, v250
buffer_load_dword v245, v244, s[28:31], 0 offen
buffer_load_dword v245, v244, s[24:27], 0 offen
v_mov_b32 v244, 0
Lpi:
buffer_load_dword v245, v244, s[36:39], 0 offen sc1
s_waitcnt vmcnt(0)
v_readfirstlane_b32 s43, v245
s_cmp_eq_u32 s76, 0
s_cbranch_scc1 Lpix
s_sub_u32 s76, s76, 1
s_cmp_lt_u32 s43, 256
s_cbranch_scc1 Lpi
Lpix:
s_waitcnt lgkmcnt(8)
v_mfma_f32_32x32x16_bf16 v[144:159], v[48:51], v[184:187], 0
v_pk_mul_f16 v14, v124, v125
v_pk_mul_f16 v15, v126, v127
v_lshl_add_u64 v[8:9], v[112:113], 0, v[114:115]
v_cvt_pkrtz_f16_f32 v128, v128, v129
v_cvt_pkrtz_f16_f32 v129, v130, v131
v_lshrrev_b64 v[128:129], 2, v[128:129]
v_and_b32_sdwa v130, s47, v128 dst_sel:DWORD dst_unused:UNUSED_PAD src0_sel:DWORD src1_sel:WORD_1
v_and_b32_e64 v128, s47, v128
v_cvt_pk_f16_f32 v140, v140, v141
v_cvt_pk_f16_f32 v142, v142, v143
v_mfma_f32_32x32x16_bf16 v[160:175], v[184:187], v[72:75], 0
ds_read_u16 v130, v130
ds_read_u16 v128, v128
v_pk_fma_f16 v141, v140, v140, s48
v_and_b32_sdwa v131, s47, v129 dst_sel:DWORD dst_unused:UNUSED_PAD src0_sel:DWORD src1_sel:WORD_1
v_and_b32 v129, s47, v129
v_pk_fma_f16 v143, v142, v142, s48
v_pk_mul_f16 v141, v140, v141
v_pk_mul_f16 v143, v142, v143
s_waitcnt lgkmcnt(6)
v_lshl_add_u64 v[12:13], v[116:117], 0, v[118:119]
v_cvt_pkrtz_f16_f32 v132, v132, v133
v_cvt_pkrtz_f16_f32 v133, v134, v135
ds_read_u16 v131, v131
ds_read_u16 v129, v129
ds_read_b128 v[180:183], v250 offset:33792
v_lshrrev_b64 v[132:133], 2, v[132:133]
v_and_b32_sdwa v134, s47, v132 dst_sel:DWORD dst_unused:UNUSED_PAD src0_sel:DWORD src1_sel:WORD_1
v_and_b32 v132, s47, v132
v_exp_f16_sdwa v141, v141 dst_sel:WORD_0 dst_unused:UNUSED_PRESERVE src0_sel:WORD_0
s_waitcnt lgkmcnt(7)
v_mfma_f32_32x32x16_bf16 v[144:159], v[52:55], v[188:191], v[144:159]
ds_read_u16 v134, v134
ds_read_u16 v132, v132
v_exp_f16_sdwa v143, v143 dst_sel:WORD_0 dst_unused:UNUSED_PRESERVE src0_sel:WORD_0
v_and_b32_sdwa v135, s47, v133 dst_sel:DWORD dst_unused:UNUSED_PAD src0_sel:DWORD src1_sel:WORD_1
v_and_b32 v133, s47, v133
v_exp_f16_sdwa v141, v141 dst_sel:WORD_1 dst_unused:UNUSED_PRESERVE src0_sel:WORD_1
s_waitcnt lgkmcnt(7)
v_lshl_add_u64 v[10:11], v[120:121], 0, v[122:123]
v_cvt_pkrtz_f16_f32 v136, v136, v137
v_cvt_pkrtz_f16_f32 v137, v138, v139
v_lshrrev_b64 v[136:137], 2, v[136:137]
v_and_b32_sdwa v138, s47, v136 dst_sel:DWORD dst_unused:UNUSED_PAD src0_sel:DWORD src1_sel:WORD_1
ds_read_u16 v135, v135
ds_read_u16 v133, v133
v_and_b32_e64 v136, s47, v136
v_mfma_f32_32x32x16_bf16 v[160:175], v[188:191], v[76:79], v[160:175]
ds_read_u16 v138, v138
ds_read_u16 v136, v136
v_exp_f16_sdwa v143, v143 dst_sel:WORD_1 dst_unused:UNUSED_PRESERVE src0_sel:WORD_1
v_and_b32_sdwa v139, s47, v137 dst_sel:DWORD dst_unused:UNUSED_PAD src0_sel:DWORD src1_sel:WORD_1
v_and_b32_e64 v137, s47, v137
v_mfma_f32_32x32x16_f16 v[112:127], v[8:11], v[216:219], 0
ds_read_b128 v[184:187], v250 offset:34816
ds_read_u16 v139, v139
ds_read_u16 v137, v137
v_pk_add_f16 v141, v141, 1.0 op_sel_hi:[1,0]
v_pk_add_f16 v143, v143, 1.0 op_sel_hi:[1,0]
v_rcp_f16_sdwa v141, v141 dst_sel:WORD_0 dst_unused:UNUSED_PRESERVE src0_sel:WORD_0
v_mfma_f32_32x32x16_f16 v[112:127], v[12:15], v[220:223], v[112:127]
v_permlane16_swap_b32 v8, v12
v_permlane16_swap_b32 v9, v13
v_permlane16_swap_b32 v10, v14
v_permlane16_swap_b32 v11, v15
v_rcp_f16_sdwa v143, v143 dst_sel:WORD_0 dst_unused:UNUSED_PRESERVE src0_sel:WORD_0
v_mfma_f32_32x32x16_bf16 v[144:159], v[56:59], v[176:179], v[144:159]
v_rcp_f16_sdwa v141, v141 dst_sel:WORD_1 dst_unused:UNUSED_PRESERVE src0_sel:WORD_1
v_rcp_f16_sdwa v143, v143 dst_sel:WORD_1 dst_unused:UNUSED_PRESERVE src0_sel:WORD_1
s_nop 3
v_fmac_f32 v227, v112, v112
v_mfma_f32_32x32x16_bf16 v[160:175], v[176:179], v[80:83], v[160:175]
ds_read_b128 v[188:191], v250 offset:35840
v_pk_mul_f16 v140, v140, v141
v_fmac_f32_e64 v227, v113, v113
v_pk_mul_f16 v142, v142, v143
v_fmac_f32 v227, v114, v114
v_fmac_f32 v227, v115, v115
v_fma_mix_f32 v228, v140, v140, v228 op_sel_hi:[1,1,0]
v_fmac_f32 v227, v116, v116
v_fmac_f32 v227, v117, v117
v_fma_mix_f32 v228, v142, v142, v228 op_sel_hi:[1,1,0]
s_waitcnt lgkmcnt(6)
v_mfma_f32_32x32x16_bf16 v[144:159], v[60:63], v[180:183], v[144:159]
v_fmac_f32 v227, v118, v118
v_fma_mix_f32 v228, v140, v140, v228 op_sel:[1,1,0] op_sel_hi:[1,1,0]
v_fmac_f32 v227, v119, v119
v_fmac_f32 v227, v120, v120
v_fma_mix_f32 v228, v142, v142, v228 op_sel:[1,1,0] op_sel_hi:[1,1,0]
v_fmac_f32_e64 v227, v121, v121
v_fma_mix_f32 v228, v128, v128, v228 op_sel_hi:[1,1,0]
v_fmac_f32_e64 v227, v122, v122
v_fma_mix_f32 v228, v129, v129, v228 op_sel_hi:[1,1,0]
v_cvt_pkrtz_f16_f32 v96, v96, v97
v_fma_mix_f32 v228, v130, v130, v228 op_sel_hi:[1,1,0]
v_cvt_pkrtz_f16_f32 v97, v98, v99
v_fma_mix_f32 v228, v131, v131, v228 op_sel_hi:[1,1,0]
v_lshrrev_b64 v[96:97], 2, v[96:97]
v_and_b32_sdwa v98, s47, v96 dst_sel:DWORD dst_unused:UNUSED_PAD src0_sel:DWORD src1_sel:WORD_1
v_and_b32_e64 v96, s47, v96
v_cvt_pk_f16_f32 v108, v108, v109
v_fmac_f32_e64 v227, v123, v123
v_cvt_pk_f16_f32 v110, v110, v111
v_fmac_f32 v227, v124, v124
v_fmac_f32 v227, v125, v125
v_mfma_f32_32x32x16_bf16 v[160:175], v[180:183], v[84:87], v[160:175]
ds_read_u16_d16_hi v98, v98
ds_read_u16 v96, v96
v_pk_fma_f16 v109, v108, v108, s48
v_fmac_f32_e64 v227, v126, v126
v_fma_mix_f32 v228, v132, v132, v228 op_sel_hi:[1,1,0]
v_and_b32_sdwa v99, s47, v97 dst_sel:DWORD dst_unused:UNUSED_PAD src0_sel:DWORD src1_sel:WORD_1
v_fma_mix_f32 v228, v133, v133, v228 op_sel_hi:[1,1,0]
v_and_b32 v97, s47, v97
v_fmac_f32 v227, v127, v127
v_pk_fma_f16 v111, v110, v110, s48
v_pk_mul_f16 v109, v108, v109
v_fma_mix_f32 v228, v134, v134, v228 op_sel_hi:[1,1,0]
v_cvt_pkrtz_f16_f32 v100, v100, v101
v_fma_mix_f32 v228, v135, v135, v228 op_sel_hi:[1,1,0]
ds_read_u16_d16_hi v99, v99
ds_read_u16 v97, v97
ds_read_b128 v[176:179], v250 offset:36864
v_cvt_pkrtz_f16_f32 v101, v102, v103
v_lshrrev_b64 v[100:101], 2, v[100:101]
v_and_b32_sdwa v102, s47, v100 dst_sel:DWORD dst_unused:UNUSED_PAD src0_sel:DWORD src1_sel:WORD_1
v_and_b32 v100, s47, v100
v_pk_mul_f16 v111, v110, v111
v_exp_f16_sdwa v109, v109 dst_sel:WORD_0 dst_unused:UNUSED_PRESERVE src0_sel:WORD_0
s_waitcnt lgkmcnt(5)
v_mfma_f32_32x32x16_bf16 v[144:159], v[64:67], v[184:187], v[144:159]
ds_read_u16_d16_hi v102, v102
ds_read_u16 v100, v100
v_fma_mix_f32 v228, v136, v136, v228 op_sel_hi:[1,1,0]
v_and_b32_sdwa v103, s47, v101 dst_sel:DWORD dst_unused:UNUSED_PAD src0_sel:DWORD src1_sel:WORD_1
v_fma_mix_f32 v228, v137, v137, v228 op_sel_hi:[1,1,0]
v_and_b32_e64 v101, s47, v101
v_exp_f16_sdwa v111, v111 dst_sel:WORD_0 dst_unused:UNUSED_PRESERVE src0_sel:WORD_0
v_fma_mix_f32 v228, v138, v138, v228 op_sel_hi:[1,1,0]
v_cvt_pkrtz_f16_f32 v104, v104, v105
v_fma_mix_f32 v228, v139, v139, v228 op_sel_hi:[1,1,0]
v_cvt_pkrtz_f16_f32 v105, v106, v107
v_lshrrev_b64 v[104:105], 2, v[104:105]
ds_read_u16_d16_hi v103, v103
ds_read_u16 v101, v101
v_and_b32_sdwa v106, s47, v104 dst_sel:DWORD dst_unused:UNUSED_PAD src0_sel:DWORD src1_sel:WORD_1
v_and_b32_e64 v104, s47, v104
v_exp_f16_sdwa v109, v109 dst_sel:WORD_1 dst_unused:UNUSED_PRESERVE src0_sel:WORD_1
v_mfma_f32_32x32x16_bf16 v[160:175], v[184:187], v[88:91], v[160:175]
ds_read_u16_d16_hi v106, v106
ds_read_u16 v104, v104
ds_read_b128 v[180:183], v250 offset:37888
v_and_b32_sdwa v107, s47, v105 dst_sel:DWORD dst_unused:UNUSED_PAD src0_sel:DWORD src1_sel:WORD_1
v_and_b32_e64 v105, s47, v105
v_exp_f16_sdwa v111, v111 dst_sel:WORD_1 dst_unused:UNUSED_PRESERVE src0_sel:WORD_1
v_pk_add_f16 v109, v109, 1.0 op_sel_hi:[1,0]
v_mfma_f32_32x32x16_bf16 v[144:159], v[68:71], v[188:191], v[144:159]
ds_read_u16_d16_hi v107, v107
ds_read_u16 v105, v105
v_pk_add_f16 v111, v111, 1.0 op_sel_hi:[1,0]
v_rcp_f16_sdwa v109, v109 dst_sel:WORD_0 dst_unused:UNUSED_PRESERVE src0_sel:WORD_0
v_rcp_f16_sdwa v111, v111 dst_sel:WORD_0 dst_unused:UNUSED_PRESERVE src0_sel:WORD_0
v_mfma_f32_32x32x16_bf16 v[160:175], v[188:191], v[92:95], v[160:175]
ds_read_b128 v[184:187], v250 offset:38912
v_rcp_f16_sdwa v109, v109 dst_sel:WORD_1 dst_unused:UNUSED_PRESERVE src0_sel:WORD_1
v_rcp_f16_sdwa v111, v111 dst_sel:WORD_1 dst_unused:UNUSED_PRESERVE src0_sel:WORD_1
v_pk_mul_f16 v22, v108, v109
s_waitcnt lgkmcnt(8)
v_mfma_f32_32x32x16_bf16 v[112:127], v[48:51], v[176:179], 0
v_pk_mul_f16 v23, v110, v111
v_lshl_add_u64 v[16:17], v[96:97], 0, v[98:99]
v_cvt_pkrtz_f16_f32 v144, v144, v145
v_cvt_pkrtz_f16_f32 v145, v146, v147
v_lshrrev_b64 v[144:145], 2, v[144:145]
v_and_b32_sdwa v146, s47, v144 dst_sel:DWORD dst_unused:UNUSED_PAD src0_sel:DWORD src1_sel:WORD_1
v_and_b32 v144, s47, v144
v_cvt_pk_f16_f32 v156, v156, v157
v_cvt_pk_f16_f32 v158, v158, v159
v_mfma_f32_32x32x16_bf16 v[128:143], v[176:179], v[72:75], 0
ds_read_u16 v146, v146
ds_read_u16 v144, v144
v_pk_fma_f16 v157, v156, v156, s48
v_and_b32_sdwa v147, s47, v145 dst_sel:DWORD dst_unused:UNUSED_PAD src0_sel:DWORD src1_sel:WORD_1
v_and_b32 v145, s47, v145
v_pk_fma_f16 v159, v158, v158, s48
v_pk_mul_f16 v157, v156, v157
v_pk_mul_f16 v159, v158, v159
s_waitcnt lgkmcnt(6)
v_lshl_add_u64 v[20:21], v[100:101], 0, v[102:103]
v_cvt_pkrtz_f16_f32 v148, v148, v149
v_cvt_pkrtz_f16_f32 v149, v150, v151
ds_read_u16 v147, v147
ds_read_u16 v145, v145
ds_read_b128 v[188:191], v250 offset:39936
v_lshrrev_b64 v[148:149], 2, v[148:149]
v_and_b32_sdwa v150, s47, v148 dst_sel:DWORD dst_unused:UNUSED_PAD src0_sel:DWORD src1_sel:WORD_1
v_and_b32 v148, s47, v148
v_exp_f16_sdwa v157, v157 dst_sel:WORD_0 dst_unused:UNUSED_PRESERVE src0_sel:WORD_0
s_waitcnt lgkmcnt(7)
v_mfma_f32_32x32x16_bf16 v[112:127], v[52:55], v[180:183], v[112:127]
ds_read_u16 v150, v150
ds_read_u16 v148, v148
v_exp_f16_sdwa v159, v159 dst_sel:WORD_0 dst_unused:UNUSED_PRESERVE src0_sel:WORD_0
v_and_b32_sdwa v151, s47, v149 dst_sel:DWORD dst_unused:UNUSED_PAD src0_sel:DWORD src1_sel:WORD_1
v_and_b32 v149, s47, v149
v_exp_f16_sdwa v157, v157 dst_sel:WORD_1 dst_unused:UNUSED_PRESERVE src0_sel:WORD_1
s_waitcnt lgkmcnt(7)
v_lshl_add_u64 v[18:19], v[104:105], 0, v[106:107]
v_cvt_pkrtz_f16_f32 v152, v152, v153
v_cvt_pkrtz_f16_f32 v153, v154, v155
v_lshrrev_b64 v[152:153], 2, v[152:153]
v_and_b32_sdwa v154, s47, v152 dst_sel:DWORD dst_unused:UNUSED_PAD src0_sel:DWORD src1_sel:WORD_1
ds_read_u16 v151, v151
ds_read_u16 v149, v149
v_and_b32_e64 v152, s47, v152
v_mfma_f32_32x32x16_bf16 v[128:143], v[180:183], v[76:79], v[128:143]
ds_read_u16 v154, v154
ds_read_u16 v152, v152
v_exp_f16_sdwa v159, v159 dst_sel:WORD_1 dst_unused:UNUSED_PRESERVE src0_sel:WORD_1
v_and_b32_sdwa v155, s47, v153 dst_sel:DWORD dst_unused:UNUSED_PAD src0_sel:DWORD src1_sel:WORD_1
v_and_b32_e64 v153, s47, v153
v_mfma_f32_32x32x16_f16 v[96:111], v[16:19], v[216:219], 0
ds_read_b128 v[176:179], v250 offset:40960
ds_read_u16 v155, v155
ds_read_u16 v153, v153
v_pk_add_f16 v157, v157, 1.0 op_sel_hi:[1,0]
v_pk_add_f16 v159, v159, 1.0 op_sel_hi:[1,0]
v_rcp_f16_sdwa v157, v157 dst_sel:WORD_0 dst_unused:UNUSED_PRESERVE src0_sel:WORD_0
v_mfma_f32_32x32x16_f16 v[96:111], v[20:23], v[220:223], v[96:111]
v_permlane16_swap_b32 v16, v20
v_permlane16_swap_b32 v17, v21
v_permlane16_swap_b32 v18, v22
v_permlane16_swap_b32 v19, v23
v_rcp_f16_sdwa v159, v159 dst_sel:WORD_0 dst_unused:UNUSED_PRESERVE src0_sel:WORD_0
v_mfma_f32_32x32x16_bf16 v[112:127], v[56:59], v[184:187], v[112:127]
v_rcp_f16_sdwa v157, v157 dst_sel:WORD_1 dst_unused:UNUSED_PRESERVE src0_sel:WORD_1
v_rcp_f16_sdwa v159, v159 dst_sel:WORD_1 dst_unused:UNUSED_PRESERVE src0_sel:WORD_1
s_nop 3
v_fmac_f32 v228, v96, v96
v_mfma_f32_32x32x16_bf16 v[128:143], v[184:187], v[80:83], v[128:143]
ds_read_b128 v[180:183], v250 offset:41984
v_pk_mul_f16 v156, v156, v157
v_fmac_f32_e64 v228, v97, v97
v_pk_mul_f16 v158, v158, v159
v_fmac_f32 v228, v98, v98
v_fmac_f32 v228, v99, v99
v_fma_mix_f32 v229, v156, v156, v229 op_sel_hi:[1,1,0]
v_fmac_f32 v228, v100, v100
v_fmac_f32 v228, v101, v101
v_fma_mix_f32 v229, v158, v158, v229 op_sel_hi:[1,1,0]
s_waitcnt lgkmcnt(6)
v_mfma_f32_32x32x16_bf16 v[112:127], v[60:63], v[188:191], v[112:127]
v_fmac_f32 v228, v102, v102
v_fma_mix_f32 v229, v156, v156, v229 op_sel:[1,1,0] op_sel_hi:[1,1,0]
v_fmac_f32 v228, v103, v103
v_fmac_f32 v228, v104, v104
v_fma_mix_f32 v229, v158, v158, v229 op_sel:[1,1,0] op_sel_hi:[1,1,0]
v_fmac_f32_e64 v228, v105, v105
v_fma_mix_f32 v229, v144, v144, v229 op_sel_hi:[1,1,0]
v_fmac_f32_e64 v228, v106, v106
v_fma_mix_f32 v229, v145, v145, v229 op_sel_hi:[1,1,0]
v_cvt_pkrtz_f16_f32 v160, v160, v161
v_fma_mix_f32 v229, v146, v146, v229 op_sel_hi:[1,1,0]
v_cvt_pkrtz_f16_f32 v161, v162, v163
v_fma_mix_f32 v229, v147, v147, v229 op_sel_hi:[1,1,0]
v_lshrrev_b64 v[160:161], 2, v[160:161]
v_and_b32_sdwa v162, s47, v160 dst_sel:DWORD dst_unused:UNUSED_PAD src0_sel:DWORD src1_sel:WORD_1
v_and_b32_e64 v160, s47, v160
v_cvt_pk_f16_f32 v172, v172, v173
v_fmac_f32_e64 v228, v107, v107
v_cvt_pk_f16_f32 v174, v174, v175
v_fmac_f32 v228, v108, v108
v_fmac_f32 v228, v109, v109
v_mfma_f32_32x32x16_bf16 v[128:143], v[188:191], v[84:87], v[128:143]
ds_read_u16_d16_hi v162, v162
ds_read_u16 v160, v160
v_pk_fma_f16 v173, v172, v172, s48
v_fmac_f32_e64 v228, v110, v110
v_fma_mix_f32 v229, v148, v148, v229 op_sel_hi:[1,1,0]
v_and_b32_sdwa v163, s47, v161 dst_sel:DWORD dst_unused:UNUSED_PAD src0_sel:DWORD src1_sel:WORD_1
v_fma_mix_f32 v229, v149, v149, v229 op_sel_hi:[1,1,0]
v_and_b32 v161, s47, v161
v_fmac_f32 v228, v111, v111
v_pk_fma_f16 v175, v174, v174, s48
v_pk_mul_f16 v173, v172, v173
v_fma_mix_f32 v229, v150, v150, v229 op_sel_hi:[1,1,0]
v_cvt_pkrtz_f16_f32 v164, v164, v165
v_fma_mix_f32 v229, v151, v151, v229 op_sel_hi:[1,1,0]
ds_read_u16_d16_hi v163, v163
ds_read_u16 v161, v161
ds_read_b128 v[184:187], v250 offset:43008
v_cvt_pkrtz_f16_f32 v165, v166, v167
v_lshrrev_b64 v[164:165], 2, v[164:165]
v_and_b32_sdwa v166, s47, v164 dst_sel:DWORD dst_unused:UNUSED_PAD src0_sel:DWORD src1_sel:WORD_1
v_and_b32 v164, s47, v164
v_pk_mul_f16 v175, v174, v175
v_exp_f16_sdwa v173, v173 dst_sel:WORD_0 dst_unused:UNUSED_PRESERVE src0_sel:WORD_0
s_waitcnt lgkmcnt(5)
v_mfma_f32_32x32x16_bf16 v[112:127], v[64:67], v[176:179], v[112:127]
ds_read_u16_d16_hi v166, v166
ds_read_u16 v164, v164
v_fma_mix_f32 v229, v152, v152, v229 op_sel_hi:[1,1,0]
v_and_b32_sdwa v167, s47, v165 dst_sel:DWORD dst_unused:UNUSED_PAD src0_sel:DWORD src1_sel:WORD_1
v_fma_mix_f32 v229, v153, v153, v229 op_sel_hi:[1,1,0]
v_and_b32_e64 v165, s47, v165
v_exp_f16_sdwa v175, v175 dst_sel:WORD_0 dst_unused:UNUSED_PRESERVE src0_sel:WORD_0
v_fma_mix_f32 v229, v154, v154, v229 op_sel_hi:[1,1,0]
v_cvt_pkrtz_f16_f32 v168, v168, v169
v_fma_mix_f32 v229, v155, v155, v229 op_sel_hi:[1,1,0]
v_cvt_pkrtz_f16_f32 v169, v170, v171
v_lshrrev_b64 v[168:169], 2, v[168:169]
ds_read_u16_d16_hi v167, v167
ds_read_u16 v165, v165
v_and_b32_sdwa v170, s47, v168 dst_sel:DWORD dst_unused:UNUSED_PAD src0_sel:DWORD src1_sel:WORD_1
v_and_b32_e64 v168, s47, v168
v_exp_f16_sdwa v173, v173 dst_sel:WORD_1 dst_unused:UNUSED_PRESERVE src0_sel:WORD_1
v_mfma_f32_32x32x16_bf16 v[128:143], v[176:179], v[88:91], v[128:143]
ds_read_u16_d16_hi v170, v170
ds_read_u16 v168, v168
ds_read_b128 v[188:191], v250 offset:44032
v_and_b32_sdwa v171, s47, v169 dst_sel:DWORD dst_unused:UNUSED_PAD src0_sel:DWORD src1_sel:WORD_1
v_and_b32_e64 v169, s47, v169
v_exp_f16_sdwa v175, v175 dst_sel:WORD_1 dst_unused:UNUSED_PRESERVE src0_sel:WORD_1
v_pk_add_f16 v173, v173, 1.0 op_sel_hi:[1,0]
v_mfma_f32_32x32x16_bf16 v[112:127], v[68:71], v[180:183], v[112:127]
ds_read_u16_d16_hi v171, v171
ds_read_u16 v169, v169
v_pk_add_f16 v175, v175, 1.0 op_sel_hi:[1,0]
v_rcp_f16_sdwa v173, v173 dst_sel:WORD_0 dst_unused:UNUSED_PRESERVE src0_sel:WORD_0
v_rcp_f16_sdwa v175, v175 dst_sel:WORD_0 dst_unused:UNUSED_PRESERVE src0_sel:WORD_0
v_mfma_f32_32x32x16_bf16 v[128:143], v[180:183], v[92:95], v[128:143]
ds_read_b128 v[176:179], v250 offset:45056
v_rcp_f16_sdwa v173, v173 dst_sel:WORD_1 dst_unused:UNUSED_PRESERVE src0_sel:WORD_1
v_rcp_f16_sdwa v175, v175 dst_sel:WORD_1 dst_unused:UNUSED_PRESERVE src0_sel:WORD_1
v_pk_mul_f16 v198, v172, v173
s_waitcnt lgkmcnt(8)
v_mfma_f32_32x32x16_bf16 v[96:111], v[48:51], v[184:187], 0
v_pk_mul_f16 v199, v174, v175
v_lshl_add_u64 v[192:193], v[160:161], 0, v[162:163]
v_cvt_pkrtz_f16_f32 v112, v112, v113
v_cvt_pkrtz_f16_f32 v113, v114, v115
v_lshrrev_b64 v[112:113], 2, v[112:113]
v_and_b32_sdwa v114, s47, v112 dst_sel:DWORD dst_unused:UNUSED_PAD src0_sel:DWORD src1_sel:WORD_1
v_and_b32 v112, s47, v112
v_cvt_pk_f16_f32 v124, v124, v125
v_cvt_pk_f16_f32 v126, v126, v127
v_mfma_f32_32x32x16_bf16 v[144:159], v[184:187], v[72:75], 0
ds_read_u16 v114, v114
ds_read_u16 v112, v112
v_pk_fma_f16 v125, v124, v124, s48
v_and_b32_sdwa v115, s47, v113 dst_sel:DWORD dst_unused:UNUSED_PAD src0_sel:DWORD src1_sel:WORD_1
v_and_b32 v113, s47, v113
v_pk_fma_f16 v127, v126, v126, s48
v_pk_mul_f16 v125, v124, v125
v_pk_mul_f16 v127, v126, v127
s_waitcnt lgkmcnt(6)
v_lshl_add_u64 v[196:197], v[164:165], 0, v[166:167]
v_cvt_pkrtz_f16_f32 v116, v116, v117
v_cvt_pkrtz_f16_f32 v117, v118, v119
ds_read_u16 v115, v115
ds_read_u16 v113, v113
ds_read_b128 v[180:183], v250 offset:46080
v_lshrrev_b64 v[116:117], 2, v[116:117]
v_and_b32_sdwa v118, s47, v116 dst_sel:DWORD dst_unused:UNUSED_PAD src0_sel:DWORD src1_sel:WORD_1
v_and_b32 v116, s47, v116
v_exp_f16_sdwa v125, v125 dst_sel:WORD_0 dst_unused:UNUSED_PRESERVE src0_sel:WORD_0
s_waitcnt lgkmcnt(7)
v_mfma_f32_32x32x16_bf16 v[96:111], v[52:55], v[188:191], v[96:111]
ds_read_u16 v118, v118
ds_read_u16 v116, v116
v_exp_f16_sdwa v127, v127 dst_sel:WORD_0 dst_unused:UNUSED_PRESERVE src0_sel:WORD_0
v_and_b32_sdwa v119, s47, v117 dst_sel:DWORD dst_unused:UNUSED_PAD src0_sel:DWORD src1_sel:WORD_1
v_and_b32 v117, s47, v117
v_exp_f16_sdwa v125, v125 dst_sel:WORD_1 dst_unused:UNUSED_PRESERVE src0_sel:WORD_1
s_waitcnt lgkmcnt(7)
v_lshl_add_u64 v[194:195], v[168:169], 0, v[170:171]
v_cvt_pkrtz_f16_f32 v120, v120, v121
v_cvt_pkrtz_f16_f32 v121, v122, v123
v_lshrrev_b64 v[120:121], 2, v[120:121]
v_and_b32_sdwa v122, s47, v120 dst_sel:DWORD dst_unused:UNUSED_PAD src0_sel:DWORD src1_sel:WORD_1
ds_read_u16 v119, v119
ds_read_u16 v117, v117
v_and_b32_e64 v120, s47, v120
v_mfma_f32_32x32x16_bf16 v[144:159], v[188:191], v[76:79], v[144:159]
ds_read_u16 v122, v122
ds_read_u16 v120, v120
v_exp_f16_sdwa v127, v127 dst_sel:WORD_1 dst_unused:UNUSED_PRESERVE src0_sel:WORD_1
v_and_b32_sdwa v123, s47, v121 dst_sel:DWORD dst_unused:UNUSED_PAD src0_sel:DWORD src1_sel:WORD_1
v_and_b32_e64 v121, s47, v121
v_mfma_f32_32x32x16_f16 v[160:175], v[192:195], v[216:219], 0
ds_read_b128 v[184:187], v250 offset:47104
ds_read_u16 v123, v123
ds_read_u16 v121, v121
v_pk_add_f16 v125, v125, 1.0 op_sel_hi:[1,0]
v_pk_add_f16 v127, v127, 1.0 op_sel_hi:[1,0]
v_rcp_f16_sdwa v125, v125 dst_sel:WORD_0 dst_unused:UNUSED_PRESERVE src0_sel:WORD_0
v_mfma_f32_32x32x16_f16 v[160:175], v[196:199], v[220:223], v[160:175]
v_permlane16_swap_b32 v192, v196
v_permlane16_swap_b32 v193, v197
v_permlane16_swap_b32 v194, v198
v_permlane16_swap_b32 v195, v199
v_rcp_f16_sdwa v127, v127 dst_sel:WORD_0 dst_unused:UNUSED_PRESERVE src0_sel:WORD_0
v_mfma_f32_32x32x16_bf16 v[96:111], v[56:59], v[176:179], v[96:111]
v_rcp_f16_sdwa v125, v125 dst_sel:WORD_1 dst_unused:UNUSED_PRESERVE src0_sel:WORD_1
v_rcp_f16_sdwa v127, v127 dst_sel:WORD_1 dst_unused:UNUSED_PRESERVE src0_sel:WORD_1
s_nop 3
v_fmac_f32 v229, v160, v160
v_mfma_f32_32x32x16_bf16 v[144:159], v[176:179], v[80:83], v[144:159]
ds_read_b128 v[188:191], v250 offset:48128
v_pk_mul_f16 v124, v124, v125
v_fmac_f32_e64 v229, v161, v161
v_pk_mul_f16 v126, v126, v127
v_fmac_f32 v229, v162, v162
v_fmac_f32 v229, v163, v163
v_fma_mix_f32 v230, v124, v124, v230 op_sel_hi:[1,1,0]
v_fmac_f32 v229, v164, v164
v_fmac_f32 v229, v165, v165
v_fma_mix_f32 v230, v126, v126, v230 op_sel_hi:[1,1,0]
s_waitcnt lgkmcnt(6)
v_mfma_f32_32x32x16_bf16 v[96:111], v[60:63], v[180:183], v[96:111]
v_fmac_f32 v229, v166, v166
v_fma_mix_f32 v230, v124, v124, v230 op_sel:[1,1,0] op_sel_hi:[1,1,0]
v_fmac_f32 v229, v167, v167
v_fmac_f32 v229, v168, v168
v_fma_mix_f32 v230, v126, v126, v230 op_sel:[1,1,0] op_sel_hi:[1,1,0]
v_fmac_f32_e64 v229, v169, v169
v_fma_mix_f32 v230, v112, v112, v230 op_sel_hi:[1,1,0]
v_fmac_f32_e64 v229, v170, v170
v_fma_mix_f32 v230, v113, v113, v230 op_sel_hi:[1,1,0]
v_cvt_pkrtz_f16_f32 v128, v128, v129
v_fma_mix_f32 v230, v114, v114, v230 op_sel_hi:[1,1,0]
v_cvt_pkrtz_f16_f32 v129, v130, v131
v_fma_mix_f32 v230, v115, v115, v230 op_sel_hi:[1,1,0]
v_lshrrev_b64 v[128:129], 2, v[128:129]
v_and_b32_sdwa v130, s47, v128 dst_sel:DWORD dst_unused:UNUSED_PAD src0_sel:DWORD src1_sel:WORD_1
v_and_b32_e64 v128, s47, v128
v_cvt_pk_f16_f32 v140, v140, v141
v_fmac_f32_e64 v229, v171, v171
v_cvt_pk_f16_f32 v142, v142, v143
v_fmac_f32 v229, v172, v172
v_fmac_f32 v229, v173, v173
v_mfma_f32_32x32x16_bf16 v[144:159], v[180:183], v[84:87], v[144:159]
ds_read_u16_d16_hi v130, v130
ds_read_u16 v128, v128
v_pk_fma_f16 v141, v140, v140, s48
v_fmac_f32_e64 v229, v174, v174
v_fma_mix_f32 v230, v116, v116, v230 op_sel_hi:[1,1,0]
v_and_b32_sdwa v131, s47, v129 dst_sel:DWORD dst_unused:UNUSED_PAD src0_sel:DWORD src1_sel:WORD_1
v_fma_mix_f32 v230, v117, v117, v230 op_sel_hi:[1,1,0]
v_and_b32 v129, s47, v129
v_fmac_f32 v229, v175, v175
v_pk_fma_f16 v143, v142, v142, s48
v_pk_mul_f16 v141, v140, v141
v_fma_mix_f32 v230, v118, v118, v230 op_sel_hi:[1,1,0]
v_cvt_pkrtz_f16_f32 v132, v132, v133
v_fma_mix_f32 v230, v119, v119, v230 op_sel_hi:[1,1,0]
ds_read_u16_d16_hi v131, v131
ds_read_u16 v129, v129
ds_read_b128 v[176:179], v250 offset:49152
v_cvt_pkrtz_f16_f32 v133, v134, v135
v_lshrrev_b64 v[132:133], 2, v[132:133]
v_and_b32_sdwa v134, s47, v132 dst_sel:DWORD dst_unused:UNUSED_PAD src0_sel:DWORD src1_sel:WORD_1
v_and_b32 v132, s47, v132
v_pk_mul_f16 v143, v142, v143
v_exp_f16_sdwa v141, v141 dst_sel:WORD_0 dst_unused:UNUSED_PRESERVE src0_sel:WORD_0
s_waitcnt lgkmcnt(5)
v_mfma_f32_32x32x16_bf16 v[96:111], v[64:67], v[184:187], v[96:111]
ds_read_u16_d16_hi v134, v134
ds_read_u16 v132, v132
v_fma_mix_f32 v230, v120, v120, v230 op_sel_hi:[1,1,0]
v_and_b32_sdwa v135, s47, v133 dst_sel:DWORD dst_unused:UNUSED_PAD src0_sel:DWORD src1_sel:WORD_1
v_fma_mix_f32 v230, v121, v121, v230 op_sel_hi:[1,1,0]
v_and_b32_e64 v133, s47, v133
v_exp_f16_sdwa v143, v143 dst_sel:WORD_0 dst_unused:UNUSED_PRESERVE src0_sel:WORD_0
v_fma_mix_f32 v230, v122, v122, v230 op_sel_hi:[1,1,0]
v_cvt_pkrtz_f16_f32 v136, v136, v137
v_fma_mix_f32 v230, v123, v123, v230 op_sel_hi:[1,1,0]
v_cvt_pkrtz_f16_f32 v137, v138, v139
v_lshrrev_b64 v[136:137], 2, v[136:137]
ds_read_u16_d16_hi v135, v135
ds_read_u16 v133, v133
v_and_b32_sdwa v138, s47, v136 dst_sel:DWORD dst_unused:UNUSED_PAD src0_sel:DWORD src1_sel:WORD_1
v_and_b32_e64 v136, s47, v136
v_exp_f16_sdwa v141, v141 dst_sel:WORD_1 dst_unused:UNUSED_PRESERVE src0_sel:WORD_1
v_mfma_f32_32x32x16_bf16 v[144:159], v[184:187], v[88:91], v[144:159]
ds_read_u16_d16_hi v138, v138
ds_read_u16 v136, v136
ds_read_b128 v[180:183], v250 offset:50176
v_and_b32_sdwa v139, s47, v137 dst_sel:DWORD dst_unused:UNUSED_PAD src0_sel:DWORD src1_sel:WORD_1
v_and_b32_e64 v137, s47, v137
v_exp_f16_sdwa v143, v143 dst_sel:WORD_1 dst_unused:UNUSED_PRESERVE src0_sel:WORD_1
v_pk_add_f16 v141, v141, 1.0 op_sel_hi:[1,0]
v_mfma_f32_32x32x16_bf16 v[96:111], v[68:71], v[188:191], v[96:111]
ds_read_u16_d16_hi v139, v139
ds_read_u16 v137, v137
v_pk_add_f16 v143, v143, 1.0 op_sel_hi:[1,0]
v_rcp_f16_sdwa v141, v141 dst_sel:WORD_0 dst_unused:UNUSED_PRESERVE src0_sel:WORD_0
v_rcp_f16_sdwa v143, v143 dst_sel:WORD_0 dst_unused:UNUSED_PRESERVE src0_sel:WORD_0
v_mfma_f32_32x32x16_bf16 v[144:159], v[188:191], v[92:95], v[144:159]
ds_read_b128 v[184:187], v250 offset:51200
v_rcp_f16_sdwa v141, v141 dst_sel:WORD_1 dst_unused:UNUSED_PRESERVE src0_sel:WORD_1
v_rcp_f16_sdwa v143, v143 dst_sel:WORD_1 dst_unused:UNUSED_PRESERVE src0_sel:WORD_1
v_mov_b32 v239, 0
s_branch Law5
Lax5:
s_sleep 2
Law5:
ds_read_b32 v239, v247 offset:28
s_sub_u32 s76, s76, 1
s_cselect_b32 s44, 4, 0
s_cselect_b32 s76, 0, s76
s_waitcnt lgkmcnt(0)
v_readfirstlane_b32 s43, v239
s_nop 1
s_max_u32 s43, s43, s44
s_cmp_lt_u32 s43, 4
s_cbranch_scc1 Lax5
v_bfe_u32 v237, v250, 4, 6
v_lshrrev_b32_e64 v246, 2, v237
v_mul_u32_u24 v246, 192, v246
v_and_b32_e64 v237, 3, v237
v_lshl_add_u32 v246, v237, 4, v246
v_mfma_f32_32x32x16_bf16 v[160:175], v[48:51], v[176:179], 0
v_permlane32_swap_b32 v224, v225
v_add_f32 v224, v224, v225
v_permlane32_swap_b32 v226, v227
v_add_f32 v226, v226, v227
v_permlane32_swap_b32 v228, v229
v_add_f32 v228, v228, v229
v_pk_mul_f16 v206, v140, v141
v_pk_mul_f16 v207, v142, v143
ds_write_b32 v248, v224 offset:5120
ds_write_b32 v248, v226 offset:5376
ds_write_b32 v248, v228 offset:5632
v_lshl_add_u64 v[200:201], v[128:129], 0, v[130:131]
v_cvt_pkrtz_f16_f32 v96, v96, v97
v_cvt_pkrtz_f16_f32 v97, v98, v99
v_lshrrev_b64 v[96:97], 2, v[96:97]
v_and_b32_sdwa v98, s47, v96 dst_sel:DWORD dst_unused:UNUSED_PAD src0_sel:DWORD src1_sel:WORD_1
v_and_b32_e64 v96, s47, v96
v_cvt_pk_f16_f32 v108, v108, v109
v_cvt_pk_f16_f32 v110, v110, v111
v_mfma_f32_32x32x16_bf16 v[112:127], v[176:179], v[72:75], 0
ds_read_u16 v98, v98
ds_read_u16 v96, v96
v_pk_fma_f16 v109, v108, v108, s48
v_and_b32_sdwa v99, s47, v97 dst_sel:DWORD dst_unused:UNUSED_PAD src0_sel:DWORD src1_sel:WORD_1
v_and_b32_e64 v97, s47, v97
v_pk_fma_f16 v111, v110, v110, s48
v_pk_mul_f16 v109, v108, v109
v_pk_mul_f16 v111, v110, v111
v_lshl_add_u64 v[204:205], v[132:133], 0, v[134:135]
v_cvt_pkrtz_f16_f32 v100, v100, v101
v_cvt_pkrtz_f16_f32 v101, v102, v103
ds_read_u16 v99, v99
ds_read_u16 v97, v97
ds_read_b128 v[188:191], v250 offset:52224
v_lshrrev_b64 v[100:101], 2, v[100:101]
v_and_b32_sdwa v102, s47, v100 dst_sel:DWORD dst_unused:UNUSED_PAD src0_sel:DWORD src1_sel:WORD_1
v_and_b32_e64 v100, s47, v100
v_exp_f16_sdwa v109, v109 dst_sel:WORD_0 dst_unused:UNUSED_PRESERVE src0_sel:WORD_0
v_mfma_f32_32x32x16_bf16 v[160:175], v[52:55], v[180:183], v[160:175]
ds_read_u16 v102, v102
ds_read_u16 v100, v100
s_add_u32 m0, s72, 0
s_add_u32 s43, s82, 0
buffer_load_dwordx4 v246, s[16:19], s43 offen lds
v_exp_f16_sdwa v111, v111 dst_sel:WORD_0 dst_unused:UNUSED_PRESERVE src0_sel:WORD_0
v_and_b32_sdwa v103, s47, v101 dst_sel:DWORD dst_unused:UNUSED_PAD src0_sel:DWORD src1_sel:WORD_1
v_and_b32_e64 v101, s47, v101
v_exp_f16_sdwa v109, v109 dst_sel:WORD_1 dst_unused:UNUSED_PRESERVE src0_sel:WORD_1
v_lshl_add_u64 v[202:203], v[136:137], 0, v[138:139]
v_cvt_pkrtz_f16_f32 v104, v104, v105
v_cvt_pkrtz_f16_f32 v105, v106, v107
v_lshrrev_b64 v[104:105], 2, v[104:105]
v_and_b32_sdwa v106, s47, v104 dst_sel:DWORD dst_unused:UNUSED_PAD src0_sel:DWORD src1_sel:WORD_1
ds_read_u16 v103, v103
ds_read_u16 v101, v101
v_and_b32_e64 v104, s47, v104
v_mfma_f32_32x32x16_bf16 v[112:127], v[180:183], v[76:79], v[112:127]
ds_read_u16 v106, v106
ds_read_u16 v104, v104
v_exp_f16_sdwa v111, v111 dst_sel:WORD_1 dst_unused:UNUSED_PRESERVE src0_sel:WORD_1
v_and_b32_sdwa v107, s47, v105 dst_sel:DWORD dst_unused:UNUSED_PAD src0_sel:DWORD src1_sel:WORD_1
v_and_b32 v105, s47, v105
v_mfma_f32_32x32x16_f16 v[128:143], v[200:203], v[216:219], 0
ds_read_b128 v[176:179], v250 offset:53248
s_waitcnt lgkmcnt(9)
ds_read_u16 v107, v107
ds_read_u16 v105, v105
v_pk_add_f16 v109, v109, 1.0 op_sel_hi:[1,0]
v_pk_add_f16 v111, v111, 1.0 op_sel_hi:[1,0]
v_rcp_f16_sdwa v109, v109 dst_sel:WORD_0 dst_unused:UNUSED_PRESERVE src0_sel:WORD_0
v_mfma_f32_32x32x16_f16 v[128:143], v[204:207], v[220:223], v[128:143]
v_permlane16_swap_b32 v200, v204
v_permlane16_swap_b32 v201, v205
v_permlane16_swap_b32 v202, v206
v_permlane16_swap_b32 v203, v207
v_rcp_f16_sdwa v111, v111 dst_sel:WORD_0 dst_unused:UNUSED_PRESERVE src0_sel:WORD_0
v_mfma_f32_32x32x16_bf16 v[160:175], v[56:59], v[184:187], v[160:175]
v_rcp_f16_sdwa v109, v109 dst_sel:WORD_1 dst_unused:UNUSED_PRESERVE src0_sel:WORD_1
s_add_u32 m0, s72, 1024
s_add_u32 s43, s82, 64
buffer_load_dwordx4 v246, s[16:19], s43 offen lds
v_rcp_f16_sdwa v111, v111 dst_sel:WORD_1 dst_unused:UNUSED_PRESERVE src0_sel:WORD_1
s_nop 0
v_fmac_f32_e64 v230, v128, v128
v_mfma_f32_32x32x16_bf16 v[112:127], v[184:187], v[80:83], v[112:127]
ds_read_b128 v[180:183], v250 offset:54272
v_pk_mul_f16 v108, v108, v109
v_fmac_f32_e64 v230, v129, v129
v_pk_mul_f16 v110, v110, v111
v_fmac_f32 v230, v130, v130
v_fmac_f32 v230, v131, v131
v_fma_mix_f32 v231, v108, v108, v231 op_sel_hi:[1,1,0]
v_fmac_f32 v230, v132, v132
v_fmac_f32 v230, v133, v133
v_fma_mix_f32 v231, v110, v110, v231 op_sel_hi:[1,1,0]
s_waitcnt lgkmcnt(6)
v_mfma_f32_32x32x16_bf16 v[160:175], v[60:63], v[188:191], v[160:175]
v_fmac_f32 v230, v134, v134
v_fma_mix_f32 v231, v108, v108, v231 op_sel:[1,1,0] op_sel_hi:[1,1,0]
v_fmac_f32 v230, v135, v135
v_fmac_f32 v230, v136, v136
v_fma_mix_f32 v231, v110, v110, v231 op_sel:[1,1,0] op_sel_hi:[1,1,0]
v_fmac_f32_e64 v230, v137, v137
v_fma_mix_f32 v231, v96, v96, v231 op_sel_hi:[1,1,0]
v_fmac_f32_e64 v230, v138, v138
v_fma_mix_f32 v231, v97, v97, v231 op_sel_hi:[1,1,0]
v_cvt_pkrtz_f16_f32 v144, v144, v145
v_fma_mix_f32 v231, v98, v98, v231 op_sel_hi:[1,1,0]
v_cvt_pkrtz_f16_f32 v145, v146, v147
v_fma_mix_f32 v231, v99, v99, v231 op_sel_hi:[1,1,0]
v_lshrrev_b64 v[144:145], 2, v[144:145]
v_and_b32_sdwa v146, s47, v144 dst_sel:DWORD dst_unused:UNUSED_PAD src0_sel:DWORD src1_sel:WORD_1
v_and_b32_e64 v144, s47, v144
v_cvt_pk_f16_f32 v156, v156, v157
v_fmac_f32_e64 v230, v139, v139
v_cvt_pk_f16_f32 v158, v158, v159
v_fmac_f32 v230, v140, v140
v_fmac_f32 v230, v141, v141
v_mfma_f32_32x32x16_bf16 v[112:127], v[188:191], v[84:87], v[112:127]
ds_read_u16_d16_hi v146, v146
ds_read_u16 v144, v144
v_pk_fma_f16 v157, v156, v156, s48
v_fmac_f32_e64 v230, v142, v142
v_fma_mix_f32 v231, v100, v100, v231 op_sel_hi:[1,1,0]
v_and_b32_sdwa v147, s47, v145 dst_sel:DWORD dst_unused:UNUSED_PAD src0_sel:DWORD src1_sel:WORD_1
v_fma_mix_f32 v231, v101, v101, v231 op_sel_hi:[1,1,0]
v_and_b32 v145, s47, v145
v_fmac_f32 v230, v143, v143
v_pk_fma_f16 v159, v158, v158, s48
v_pk_mul_f16 v157, v156, v157
v_fma_mix_f32 v231, v102, v102, v231 op_sel_hi:[1,1,0]
v_cvt_pkrtz_f16_f32 v148, v148, v149
v_fma_mix_f32 v231, v103, v103, v231 op_sel_hi:[1,1,0]
ds_read_u16_d16_hi v147, v147
ds_read_u16 v145, v145
ds_read_b128 v[184:187], v250 offset:55296
v_cvt_pkrtz_f16_f32 v149, v150, v151
v_lshrrev_b64 v[148:149], 2, v[148:149]
v_and_b32_sdwa v150, s47, v148 dst_sel:DWORD dst_unused:UNUSED_PAD src0_sel:DWORD src1_sel:WORD_1
v_and_b32 v148, s47, v148
v_pk_mul_f16 v159, v158, v159
v_exp_f16_sdwa v157, v157 dst_sel:WORD_0 dst_unused:UNUSED_PRESERVE src0_sel:WORD_0
s_waitcnt lgkmcnt(5)
v_mfma_f32_32x32x16_bf16 v[160:175], v[64:67], v[176:179], v[160:175]
ds_read_u16_d16_hi v150, v150
ds_read_u16 v148, v148
s_add_u32 m0, s72, 2048
s_add_u32 s43, s82, 128
buffer_load_dwordx4 v246, s[16:19], s43 offen lds
v_fma_mix_f32 v231, v104, v104, v231 op_sel_hi:[1,1,0]
v_and_b32_sdwa v151, s47, v149 dst_sel:DWORD dst_unused:UNUSED_PAD src0_sel:DWORD src1_sel:WORD_1
v_fma_mix_f32 v231, v105, v105, v231 op_sel_hi:[1,1,0]
v_and_b32_e64 v149, s47, v149
v_exp_f16_sdwa v159, v159 dst_sel:WORD_0 dst_unused:UNUSED_PRESERVE src0_sel:WORD_0
v_fma_mix_f32 v231, v106, v106, v231 op_sel_hi:[1,1,0]
v_cvt_pkrtz_f16_f32 v152, v152, v153
v_fma_mix_f32 v231, v107, v107, v231 op_sel_hi:[1,1,0]
v_cvt_pkrtz_f16_f32 v153, v154, v155
v_lshrrev_b64 v[152:153], 2, v[152:153]
ds_read_u16_d16_hi v151, v151
ds_read_u16 v149, v149
v_and_b32_sdwa v154, s47, v152 dst_sel:DWORD dst_unused:UNUSED_PAD src0_sel:DWORD src1_sel:WORD_1
v_and_b32_e64 v152, s47, v152
v_exp_f16_sdwa v157, v157 dst_sel:WORD_1 dst_unused:UNUSED_PRESERVE src0_sel:WORD_1
v_mfma_f32_32x32x16_bf16 v[112:127], v[176:179], v[88:91], v[112:127]
ds_read_u16_d16_hi v154, v154
ds_read_u16 v152, v152
ds_read_b128 v[188:191], v250 offset:56320
v_and_b32_sdwa v155, s47, v153 dst_sel:DWORD dst_unused:UNUSED_PAD src0_sel:DWORD src1_sel:WORD_1
v_and_b32_e64 v153, s47, v153
v_exp_f16_sdwa v159, v159 dst_sel:WORD_1 dst_unused:UNUSED_PRESERVE src0_sel:WORD_1
v_pk_add_f16 v157, v157, 1.0 op_sel_hi:[1,0]
v_mfma_f32_32x32x16_bf16 v[160:175], v[68:71], v[180:183], v[160:175]
ds_read_u16_d16_hi v155, v155
ds_read_u16 v153, v153
v_pk_add_f16 v159, v159, 1.0 op_sel_hi:[1,0]
v_rcp_f16_sdwa v157, v157 dst_sel:WORD_0 dst_unused:UNUSED_PRESERVE src0_sel:WORD_0
v_rcp_f16_sdwa v159, v159 dst_sel:WORD_0 dst_unused:UNUSED_PRESERVE src0_sel:WORD_0
s_add_u32 m0, s72, 3072
s_add_u32 s43, s82, 3072
buffer_load_dwordx4 v246, s[16:19], s43 offen lds
v_mfma_f32_32x32x16_bf16 v[112:127], v[180:183], v[92:95], v[112:127]
ds_read_b128 v[176:179], v250 offset:57344
v_rcp_f16_sdwa v157, v157 dst_sel:WORD_1 dst_unused:UNUSED_PRESERVE src0_sel:WORD_1
v_rcp_f16_sdwa v159, v159 dst_sel:WORD_1 dst_unused:UNUSED_PRESERVE src0_sel:WORD_1
v_pk_mul_f16 v214, v156, v157
s_waitcnt lgkmcnt(7)
v_mfma_f32_32x32x16_bf16 v[128:143], v[48:51], v[184:187], 0
v_pk_mul_f16 v215, v158, v159
v_lshl_add_u64 v[208:209], v[144:145], 0, v[146:147]
v_cvt_pkrtz_f16_f32 v160, v160, v161
v_cvt_pkrtz_f16_f32 v161, v162, v163
v_lshrrev_b64 v[160:161], 2, v[160:161]
v_and_b32_sdwa v162, s47, v160 dst_sel:DWORD dst_unused:UNUSED_PAD src0_sel:DWORD src1_sel:WORD_1
v_and_b32 v160, s47, v160
v_cvt_pk_f16_f32 v172, v172, v173
v_cvt_pk_f16_f32 v174, v174, v175
v_mfma_f32_32x32x16_bf16 v[96:111], v[72:75], v[184:187], 0
ds_read_u16 v162, v162
ds_read_u16 v160, v160
v_pk_fma_f16 v173, v172, v172, s48
v_and_b32_sdwa v163, s47, v161 dst_sel:DWORD dst_unused:UNUSED_PAD src0_sel:DWORD src1_sel:WORD_1
v_and_b32 v161, s47, v161
v_pk_fma_f16 v175, v174, v174, s48
v_pk_mul_f16 v173, v172, v173
v_pk_mul_f16 v175, v174, v175
s_waitcnt lgkmcnt(5)
v_lshl_add_u64 v[212:213], v[148:149], 0, v[150:151]
v_cvt_pkrtz_f16_f32 v164, v164, v165
v_cvt_pkrtz_f16_f32 v165, v166, v167
ds_read_u16 v163, v163
ds_read_u16 v161, v161
ds_read_b128 v[180:183], v250 offset:58368
v_lshrrev_b64 v[164:165], 2, v[164:165]
v_and_b32_sdwa v166, s47, v164 dst_sel:DWORD dst_unused:UNUSED_PAD src0_sel:DWORD src1_sel:WORD_1
v_and_b32_e64 v164, s47, v164
v_exp_f16_sdwa v173, v173 dst_sel:WORD_0 dst_unused:UNUSED_PRESERVE src0_sel:WORD_0
v_mfma_f32_32x32x16_bf16 v[128:143], v[52:55], v[188:191], v[128:143]
ds_read_u16 v166, v166
ds_read_u16 v164, v164
s_add_u32 m0, s72, 4096
s_add_u32 s43, s82, 3136
buffer_load_dwordx4 v246, s[16:19], s43 offen lds
v_exp_f16_sdwa v175, v175 dst_sel:WORD_0 dst_unused:UNUSED_PRESERVE src0_sel:WORD_0
v_and_b32_sdwa v167, s47, v165 dst_sel:DWORD dst_unused:UNUSED_PAD src0_sel:DWORD src1_sel:WORD_1
v_and_b32 v165, s47, v165
v_exp_f16_sdwa v173, v173 dst_sel:WORD_1 dst_unused:UNUSED_PRESERVE src0_sel:WORD_1
s_waitcnt lgkmcnt(7)
v_lshl_add_u64 v[210:211], v[152:153], 0, v[154:155]
v_cvt_pkrtz_f16_f32 v168, v168, v169
v_cvt_pkrtz_f16_f32 v169, v170, v171
v_lshrrev_b64 v[168:169], 2, v[168:169]
v_and_b32_sdwa v170, s47, v168 dst_sel:DWORD dst_unused:UNUSED_PAD src0_sel:DWORD src1_sel:WORD_1
ds_read_u16 v167, v167
ds_read_u16 v165, v165
v_and_b32_e64 v168, s47, v168
v_mfma_f32_32x32x16_bf16 v[96:111], v[76:79], v[188:191], v[96:111]
ds_read_u16 v170, v170
ds_read_u16 v168, v168
v_exp_f16_sdwa v175, v175 dst_sel:WORD_1 dst_unused:UNUSED_PRESERVE src0_sel:WORD_1
v_and_b32_sdwa v171, s47, v169 dst_sel:DWORD dst_unused:UNUSED_PAD src0_sel:DWORD src1_sel:WORD_1
v_and_b32_e64 v169, s47, v169
v_mfma_f32_32x32x16_f16 v[144:159], v[208:211], v[216:219], 0
ds_read_b128 v[184:187], v250 offset:59392
ds_read_u16 v171, v171
ds_read_u16 v169, v169
v_pk_add_f16 v173, v173, 1.0 op_sel_hi:[1,0]
v_pk_add_f16 v175, v175, 1.0 op_sel_hi:[1,0]
v_rcp_f16_sdwa v173, v173 dst_sel:WORD_0 dst_unused:UNUSED_PRESERVE src0_sel:WORD_0
v_mfma_f32_32x32x16_f16 v[144:159], v[212:215], v[220:223], v[144:159]
v_permlane16_swap_b32 v208, v212
v_permlane16_swap_b32 v209, v213
v_permlane16_swap_b32 v210, v214
v_permlane16_swap_b32 v211, v215
v_rcp_f16_sdwa v175, v175 dst_sel:WORD_0 dst_unused:UNUSED_PRESERVE src0_sel:WORD_0
v_mfma_f32_32x32x16_bf16 v[128:143], v[56:59], v[176:179], v[128:143]
v_rcp_f16_sdwa v173, v173 dst_sel:WORD_1 dst_unused:UNUSED_PRESERVE src0_sel:WORD_1
s_add_u32 m0, s72, 6144
s_add_u32 s43, s82, 6144
buffer_load_dwordx4 v246, s[16:19], s43 offen lds
v_rcp_f16_sdwa v175, v175 dst_sel:WORD_1 dst_unused:UNUSED_PRESERVE src0_sel:WORD_1
s_nop 0
v_fmac_f32 v231, v144, v144
v_mfma_f32_32x32x16_bf16 v[96:111], v[80:83], v[176:179], v[96:111]
ds_read_b128 v[188:191], v250 offset:60416
v_pk_mul_f16 v172, v172, v173
v_fmac_f32_e64 v231, v145, v145
v_pk_mul_f16 v174, v174, v175
v_fmac_f32 v231, v146, v146
v_fmac_f32 v231, v147, v147
v_fma_mix_f32 v232, v172, v172, v232 op_sel_hi:[1,1,0]
v_fmac_f32 v231, v148, v148
v_fmac_f32 v231, v149, v149
v_fma_mix_f32 v232, v174, v174, v232 op_sel_hi:[1,1,0]
s_waitcnt lgkmcnt(6)
v_mfma_f32_32x32x16_bf16 v[128:143], v[60:63], v[180:183], v[128:143]
v_fmac_f32 v231, v150, v150
v_fma_mix_f32 v232, v172, v172, v232 op_sel:[1,1,0] op_sel_hi:[1,1,0]
v_fmac_f32 v231, v151, v151
v_fmac_f32 v231, v152, v152
v_fma_mix_f32 v232, v174, v174, v232 op_sel:[1,1,0] op_sel_hi:[1,1,0]
v_fmac_f32_e64 v231, v153, v153
v_fma_mix_f32 v232, v160, v160, v232 op_sel_hi:[1,1,0]
v_fmac_f32_e64 v231, v154, v154
v_fma_mix_f32 v232, v161, v161, v232 op_sel_hi:[1,1,0]
v_cvt_pkrtz_f16_f32 v112, v112, v113
v_fma_mix_f32 v232, v162, v162, v232 op_sel_hi:[1,1,0]
v_cvt_pkrtz_f16_f32 v113, v114, v115
v_fma_mix_f32 v232, v163, v163, v232 op_sel_hi:[1,1,0]
v_lshrrev_b64 v[112:113], 2, v[112:113]
v_and_b32_sdwa v114, s47, v112 dst_sel:DWORD dst_unused:UNUSED_PAD src0_sel:DWORD src1_sel:WORD_1
v_and_b32_e64 v112, s47, v112
v_cvt_pk_f16_f32 v124, v124, v125
v_fmac_f32_e64 v231, v155, v155
v_cvt_pk_f16_f32 v126, v126, v127
v_fmac_f32 v231, v156, v156
v_fmac_f32 v231, v157, v157
v_mfma_f32_32x32x16_bf16 v[96:111], v[84:87], v[180:183], v[96:111]
ds_read_u16_d16_hi v114, v114
ds_read_u16 v112, v112
v_pk_fma_f16 v125, v124, v124, s48
v_fmac_f32_e64 v231, v158, v158
v_fma_mix_f32 v232, v164, v164, v232 op_sel_hi:[1,1,0]
v_and_b32_sdwa v115, s47, v113 dst_sel:DWORD dst_unused:UNUSED_PAD src0_sel:DWORD src1_sel:WORD_1
v_fma_mix_f32 v232, v165, v165, v232 op_sel_hi:[1,1,0]
v_and_b32 v113, s47, v113
v_fmac_f32 v231, v159, v159
s_nop 1
v_permlane32_swap_b32 v230, v231
v_add_f32_e64 v230, v230, v231
v_pk_fma_f16 v127, v126, v126, s48
v_pk_mul_f16 v125, v124, v125
v_fma_mix_f32 v232, v166, v166, v232 op_sel_hi:[1,1,0]
ds_read_u16_d16_hi v115, v115
ds_read_u16 v113, v113
ds_write_b32 v248, v230 offset:8192
ds_read_b128 v[176:179], v250 offset:61440
v_fma_mix_f32 v232, v167, v167, v232 op_sel_hi:[1,1,0]
v_cvt_pkrtz_f16_f32 v116, v116, v117
v_cvt_pkrtz_f16_f32 v117, v118, v119
v_lshrrev_b64 v[116:117], 2, v[116:117]
v_and_b32_sdwa v118, s47, v116 dst_sel:DWORD dst_unused:UNUSED_PAD src0_sel:DWORD src1_sel:WORD_1
v_and_b32 v116, s47, v116
v_pk_mul_f16 v127, v126, v127
v_exp_f16_sdwa v125, v125 dst_sel:WORD_0 dst_unused:UNUSED_PRESERVE src0_sel:WORD_0
s_waitcnt lgkmcnt(6)
v_mfma_f32_32x32x16_bf16 v[128:143], v[64:67], v[184:187], v[128:143]
ds_read_u16_d16_hi v118, v118
ds_read_u16 v116, v116
s_add_u32 m0, s72, 7168
s_add_u32 s43, s82, 6208
buffer_load_dwordx4 v246, s[16:19], s43 offen lds
v_fma_mix_f32 v232, v168, v168, v232 op_sel_hi:[1,1,0]
v_and_b32_sdwa v119, s47, v117 dst_sel:DWORD dst_unused:UNUSED_PAD src0_sel:DWORD src1_sel:WORD_1
v_fma_mix_f32 v232, v169, v169, v232 op_sel_hi:[1,1,0]
v_and_b32_e64 v117, s47, v117
v_exp_f16_sdwa v127, v127 dst_sel:WORD_0 dst_unused:UNUSED_PRESERVE src0_sel:WORD_0
v_fma_mix_f32 v232, v170, v170, v232 op_sel_hi:[1,1,0]
v_cvt_pkrtz_f16_f32 v120, v120, v121
v_fma_mix_f32 v232, v171, v171, v232 op_sel_hi:[1,1,0]
v_cvt_pkrtz_f16_f32 v121, v122, v123
v_lshrrev_b64 v[120:121], 2, v[120:121]
ds_read_u16_d16_hi v119, v119
ds_read_u16 v117, v117
v_and_b32_sdwa v122, s47, v120 dst_sel:DWORD dst_unused:UNUSED_PAD src0_sel:DWORD src1_sel:WORD_1
v_and_b32_e64 v120, s47, v120
v_exp_f16_sdwa v125, v125 dst_sel:WORD_1 dst_unused:UNUSED_PRESERVE src0_sel:WORD_1
v_mfma_f32_32x32x16_bf16 v[96:111], v[88:91], v[184:187], v[96:111]
ds_read_u16_d16_hi v122, v122
ds_read_u16 v120, v120
ds_read_b128 v[180:183], v250 offset:62464
v_and_b32_sdwa v123, s47, v121 dst_sel:DWORD dst_unused:UNUSED_PAD src0_sel:DWORD src1_sel:WORD_1
v_and_b32 v121, s47, v121
v_exp_f16_sdwa v127, v127 dst_sel:WORD_1 dst_unused:UNUSED_PRESERVE src0_sel:WORD_1
v_pk_add_f16 v125, v125, 1.0 op_sel_hi:[1,0]
v_mfma_f32_32x32x16_bf16 v[128:143], v[68:71], v[188:191], v[128:143]
ds_read_u16_d16_hi v123, v123
ds_read_u16 v121, v121
v_pk_add_f16 v127, v127, 1.0 op_sel_hi:[1,0]
v_rcp_f16_sdwa v125, v125 dst_sel:WORD_0 dst_unused:UNUSED_PRESERVE src0_sel:WORD_0
v_rcp_f16_sdwa v127, v127 dst_sel:WORD_0 dst_unused:UNUSED_PRESERVE src0_sel:WORD_0
v_mfma_f32_32x32x16_bf16 v[96:111], v[92:95], v[188:191], v[96:111]
s_waitcnt lgkmcnt(8)
ds_read_b128 v[184:187], v250 offset:63488
v_rcp_f16_sdwa v125, v125 dst_sel:WORD_1 dst_unused:UNUSED_PRESERVE src0_sel:WORD_1
v_rcp_f16_sdwa v127, v127 dst_sel:WORD_1 dst_unused:UNUSED_PRESERVE src0_sel:WORD_1
v_pk_mul_f16 v230, v124, v125
v_mfma_f32_32x32x16_bf16 v[144:159], v[48:51], v[176:179], 0
v_pk_mul_f16 v231, v126, v127
v_lshl_add_u64 v[224:225], v[112:113], 0, v[114:115]
v_cvt_pkrtz_f16_f32 v128, v128, v129
v_cvt_pkrtz_f16_f32 v129, v130, v131
v_lshrrev_b64 v[128:129], 2, v[128:129]
v_and_b32_sdwa v130, s47, v128 dst_sel:DWORD dst_unused:UNUSED_PAD src0_sel:DWORD src1_sel:WORD_1
v_and_b32_e64 v128, s47, v128
v_cvt_pk_f16_f32 v140, v140, v141
v_cvt_pk_f16_f32 v142, v142, v143
v_mfma_f32_32x32x16_bf16 v[160:175], v[176:179], v[72:75], 0
ds_read_u16 v130, v130
ds_read_u16 v128, v128
v_pk_fma_f16 v141, v140, v140, s48
v_and_b32_sdwa v131, s47, v129 dst_sel:DWORD dst_unused:UNUSED_PAD src0_sel:DWORD src1_sel:WORD_1
v_and_b32 v129, s47, v129
v_pk_fma_f16 v143, v142, v142, s48
v_pk_mul_f16 v141, v140, v141
v_pk_mul_f16 v143, v142, v143
s_waitcnt lgkmcnt(6)
v_lshl_add_u64 v[228:229], v[116:117], 0, v[118:119]
v_cvt_pkrtz_f16_f32 v132, v132, v133
v_cvt_pkrtz_f16_f32 v133, v134, v135
ds_read_u16 v131, v131
ds_read_u16 v129, v129
ds_read_b128 v[188:191], v250 offset:64512
v_lshrrev_b64 v[132:133], 2, v[132:133]
v_and_b32_sdwa v134, s47, v132 dst_sel:DWORD dst_unused:UNUSED_PAD src0_sel:DWORD src1_sel:WORD_1
v_and_b32 v132, s47, v132
v_exp_f16_sdwa v141, v141 dst_sel:WORD_0 dst_unused:UNUSED_PRESERVE src0_sel:WORD_0
s_waitcnt lgkmcnt(7)
v_mfma_f32_32x32x16_bf16 v[144:159], v[52:55], v[180:183], v[144:159]
ds_read_u16 v134, v134
ds_read_u16 v132, v132
v_exp_f16_sdwa v143, v143 dst_sel:WORD_0 dst_unused:UNUSED_PRESERVE src0_sel:WORD_0
v_and_b32_sdwa v135, s47, v133 dst_sel:DWORD dst_unused:UNUSED_PAD src0_sel:DWORD src1_sel:WORD_1
v_and_b32 v133, s47, v133
v_exp_f16_sdwa v141, v141 dst_sel:WORD_1 dst_unused:UNUSED_PRESERVE src0_sel:WORD_1
s_waitcnt lgkmcnt(7)
v_lshl_add_u64 v[226:227], v[120:121], 0, v[122:123]
v_cvt_pkrtz_f16_f32 v136, v136, v137
v_cvt_pkrtz_f16_f32 v137, v138, v139
v_lshrrev_b64 v[136:137], 2, v[136:137]
v_and_b32_sdwa v138, s47, v136 dst_sel:DWORD dst_unused:UNUSED_PAD src0_sel:DWORD src1_sel:WORD_1
ds_read_u16 v135, v135
ds_read_u16 v133, v133
v_and_b32_e64 v136, s47, v136
v_mfma_f32_32x32x16_bf16 v[160:175], v[180:183], v[76:79], v[160:175]
ds_read_u16 v138, v138
ds_read_u16 v136, v136
v_exp_f16_sdwa v143, v143 dst_sel:WORD_1 dst_unused:UNUSED_PRESERVE src0_sel:WORD_1
v_and_b32_sdwa v139, s47, v137 dst_sel:DWORD dst_unused:UNUSED_PAD src0_sel:DWORD src1_sel:WORD_1
v_and_b32_e64 v137, s47, v137
v_mfma_f32_32x32x16_f16 v[112:127], v[224:227], v[216:219], 0
ds_read_b128 v[176:179], v251
ds_read_u16 v139, v139
ds_read_u16 v137, v137
v_pk_add_f16 v141, v141, 1.0 op_sel_hi:[1,0]
v_pk_add_f16 v143, v143, 1.0 op_sel_hi:[1,0]
v_rcp_f16_sdwa v141, v141 dst_sel:WORD_0 dst_unused:UNUSED_PRESERVE src0_sel:WORD_0
v_mfma_f32_32x32x16_f16 v[112:127], v[228:231], v[220:223], v[112:127]
v_permlane16_swap_b32 v224, v228
v_permlane16_swap_b32 v225, v229
v_permlane16_swap_b32 v226, v230
v_permlane16_swap_b32 v227, v231
v_rcp_f16_sdwa v143, v143 dst_sel:WORD_0 dst_unused:UNUSED_PRESERVE src0_sel:WORD_0
v_mfma_f32_32x32x16_bf16 v[144:159], v[56:59], v[184:187], v[144:159]
v_rcp_f16_sdwa v141, v141 dst_sel:WORD_1 dst_unused:UNUSED_PRESERVE src0_sel:WORD_1
v_rcp_f16_sdwa v143, v143 dst_sel:WORD_1 dst_unused:UNUSED_PRESERVE src0_sel:WORD_1
s_nop 3
v_fmac_f32 v232, v112, v112
v_mfma_f32_32x32x16_bf16 v[160:175], v[184:187], v[80:83], v[160:175]
ds_read_b128 v[180:183], v251 offset:1024
v_pk_mul_f16 v140, v140, v141
v_fmac_f32_e64 v232, v113, v113
v_pk_mul_f16 v142, v142, v143
v_fmac_f32 v232, v114, v114
v_fmac_f32 v232, v115, v115
v_fma_mix_f32 v233, v140, v140, v233 op_sel_hi:[1,1,0]
v_fmac_f32 v232, v116, v116
v_fmac_f32 v232, v117, v117
v_fma_mix_f32 v233, v142, v142, v233 op_sel_hi:[1,1,0]
s_waitcnt lgkmcnt(6)
v_mfma_f32_32x32x16_bf16 v[144:159], v[60:63], v[188:191], v[144:159]
v_fmac_f32 v232, v118, v118
v_fma_mix_f32 v233, v140, v140, v233 op_sel:[1,1,0] op_sel_hi:[1,1,0]
v_fmac_f32 v232, v119, v119
v_fmac_f32 v232, v120, v120
v_fma_mix_f32 v233, v142, v142, v233 op_sel:[1,1,0] op_sel_hi:[1,1,0]
v_fmac_f32_e64 v232, v121, v121
v_fma_mix_f32 v233, v128, v128, v233 op_sel_hi:[1,1,0]
v_fmac_f32_e64 v232, v122, v122
v_fma_mix_f32 v233, v129, v129, v233 op_sel_hi:[1,1,0]
v_cvt_pkrtz_f16_f32 v96, v96, v97
v_fma_mix_f32 v233, v130, v130, v233 op_sel_hi:[1,1,0]
v_cvt_pkrtz_f16_f32 v97, v98, v99
v_fma_mix_f32 v233, v131, v131, v233 op_sel_hi:[1,1,0]
v_lshrrev_b64 v[96:97], 2, v[96:97]
v_and_b32_sdwa v98, s47, v96 dst_sel:DWORD dst_unused:UNUSED_PAD src0_sel:DWORD src1_sel:WORD_1
v_and_b32_e64 v96, s47, v96
v_cvt_pk_f16_f32 v108, v108, v109
v_fmac_f32_e64 v232, v123, v123
v_cvt_pk_f16_f32 v110, v110, v111
v_fmac_f32 v232, v124, v124
v_fmac_f32 v232, v125, v125
v_mfma_f32_32x32x16_bf16 v[160:175], v[188:191], v[84:87], v[160:175]
ds_read_u16 v98, v98
ds_read_u16 v96, v96
v_pk_fma_f16 v109, v108, v108, s48
v_fmac_f32_e64 v232, v126, v126
v_fma_mix_f32 v233, v132, v132, v233 op_sel_hi:[1,1,0]
v_and_b32_sdwa v99, s47, v97 dst_sel:DWORD dst_unused:UNUSED_PAD src0_sel:DWORD src1_sel:WORD_1
v_fma_mix_f32 v233, v133, v133, v233 op_sel_hi:[1,1,0]
v_and_b32 v97, s47, v97
v_fmac_f32 v232, v127, v127
v_pk_fma_f16 v111, v110, v110, s48
v_pk_mul_f16 v109, v108, v109
v_pk_mul_f16 v111, v110, v111
v_fma_mix_f32 v233, v134, v134, v233 op_sel_hi:[1,1,0]
v_cvt_pkrtz_f16_f32 v100, v100, v101
ds_read_u16 v99, v99
ds_read_u16 v97, v97
ds_read_b128 v[184:187], v251 offset:2048
v_fma_mix_f32 v233, v135, v135, v233 op_sel_hi:[1,1,0]
v_cvt_pkrtz_f16_f32 v101, v102, v103
v_lshrrev_b64 v[100:101], 2, v[100:101]
v_and_b32_sdwa v102, s47, v100 dst_sel:DWORD dst_unused:UNUSED_PAD src0_sel:DWORD src1_sel:WORD_1
v_and_b32 v100, s47, v100
v_exp_f16_sdwa v109, v109 dst_sel:WORD_0 dst_unused:UNUSED_PRESERVE src0_sel:WORD_0
s_waitcnt lgkmcnt(5)
v_mfma_f32_32x32x16_bf16 v[144:159], v[64:67], v[176:179], v[144:159]
ds_read_u16 v102, v102
ds_read_u16 v100, v100
v_fma_mix_f32 v233, v136, v136, v233 op_sel_hi:[1,1,0]
v_exp_f16_sdwa v111, v111 dst_sel:WORD_0 dst_unused:UNUSED_PRESERVE src0_sel:WORD_0
v_fma_mix_f32 v233, v137, v137, v233 op_sel_hi:[1,1,0]
v_and_b32_sdwa v103, s47, v101 dst_sel:DWORD dst_unused:UNUSED_PAD src0_sel:DWORD src1_sel:WORD_1
v_and_b32_e64 v101, s47, v101
v_exp_f16_sdwa v109, v109 dst_sel:WORD_1 dst_unused:UNUSED_PRESERVE src0_sel:WORD_1
v_fma_mix_f32 v233, v138, v138, v233 op_sel_hi:[1,1,0]
v_cvt_pkrtz_f16_f32 v104, v104, v105
v_fma_mix_f32 v233, v139, v139, v233 op_sel_hi:[1,1,0]
v_cvt_pkrtz_f16_f32 v105, v106, v107
v_lshrrev_b64 v[104:105], 2, v[104:105]
ds_read_u16 v103, v103
ds_read_u16 v101, v101
v_and_b32_sdwa v106, s47, v104 dst_sel:DWORD dst_unused:UNUSED_PAD src0_sel:DWORD src1_sel:WORD_1
v_and_b32_e64 v104, s47, v104
v_mfma_f32_32x32x16_bf16 v[160:175], v[176:179], v[88:91], v[160:175]
ds_read_u16 v106, v106
ds_read_u16 v104, v104
v_exp_f16_sdwa v111, v111 dst_sel:WORD_1 dst_unused:UNUSED_PRESERVE src0_sel:WORD_1
v_and_b32_sdwa v107, s47, v105 dst_sel:DWORD dst_unused:UNUSED_PAD src0_sel:DWORD src1_sel:WORD_1
v_and_b32_e64 v105, s47, v105
v_pk_add_f16 v109, v109, 1.0 op_sel_hi:[1,0]
v_pk_add_f16 v111, v111, 1.0 op_sel_hi:[1,0]
v_rcp_f16_sdwa v109, v109 dst_sel:WORD_0 dst_unused:UNUSED_PRESERVE src0_sel:WORD_0
v_mfma_f32_32x32x16_bf16 v[144:159], v[68:71], v[180:183], v[144:159]
ds_read_b128 v[188:191], v251 offset:3072
ds_read_u16 v107, v107
ds_read_u16 v105, v105
v_rcp_f16_sdwa v111, v111 dst_sel:WORD_0 dst_unused:UNUSED_PRESERVE src0_sel:WORD_0
v_rcp_f16_sdwa v109, v109 dst_sel:WORD_1 dst_unused:UNUSED_PRESERVE src0_sel:WORD_1
v_mfma_f32_32x32x16_bf16 v[160:175], v[180:183], v[92:95], v[160:175]
v_rcp_f16_sdwa v111, v111 dst_sel:WORD_1 dst_unused:UNUSED_PRESERVE src0_sel:WORD_1
v_pk_mul_f16 v108, v108, v109
v_pk_mul_f16 v110, v110, v111
v_fma_mix_f32 v233, v108, v108, v233 op_sel_hi:[1,1,0]
s_waitcnt lgkmcnt(6)
v_mfma_f32_32x32x16_bf16 v[112:127], v[48:51], v[184:187], 0
ds_read_b128 v[176:179], v251 offset:4096
v_fma_mix_f32 v233, v110, v110, v233 op_sel_hi:[1,1,0]
v_bfe_u32 v237, v250, 4, 6
v_min_u32 v237, 47, v237
v_lshlrev_b32_e64 v244, 5, v237
v_add_u32 v244, 95232, v244
v_add_u32 v245, 2304, v244
v_cmp_gt_u32 vcc, 24, v237
s_nop 1
v_cndmask_b32 v244, v245, v244, vcc
v_lshlrev_b32 v237, 13, v237
v_add_u32 v245, 4096, v237
v_fma_mix_f32 v233, v108, v108, v233 op_sel:[1,1,0] op_sel_hi:[1,1,0]
v_cvt_pkrtz_f16_f32 v144, v144, v145
v_fma_mix_f32 v233, v110, v110, v233 op_sel:[1,1,0] op_sel_hi:[1,1,0]
v_cvt_pkrtz_f16_f32 v145, v146, v147
v_fma_mix_f32 v233, v96, v96, v233 op_sel_hi:[1,1,0]
v_lshrrev_b64 v[144:145], 2, v[144:145]
v_fma_mix_f32 v233, v97, v97, v233 op_sel_hi:[1,1,0]
v_and_b32_sdwa v146, s47, v144 dst_sel:DWORD dst_unused:UNUSED_PAD src0_sel:DWORD src1_sel:WORD_1
v_fma_mix_f32 v233, v98, v98, v233 op_sel_hi:[1,1,0]
v_and_b32_e64 v144, s47, v144
v_fma_mix_f32 v233, v99, v99, v233 op_sel_hi:[1,1,0]
v_cvt_pk_f16_f32 v156, v156, v157
v_cvt_pk_f16_f32 v158, v158, v159
v_mfma_f32_32x32x16_bf16 v[128:143], v[184:187], v[72:75], 0
ds_read_u16 v146, v146
ds_read_u16 v144, v144
v_pk_fma_f16 v157, v156, v156, s48
v_fma_mix_f32 v233, v100, v100, v233 op_sel_hi:[1,1,0]
v_and_b32_sdwa v147, s47, v145 dst_sel:DWORD dst_unused:UNUSED_PAD src0_sel:DWORD src1_sel:WORD_1
s_waitcnt lgkmcnt(3)
v_fma_mix_f32 v233, v101, v101, v233 op_sel_hi:[1,1,0]
v_and_b32 v145, s47, v145
v_pk_fma_f16 v159, v158, v158, s48
v_pk_mul_f16 v157, v156, v157
v_pk_mul_f16 v159, v158, v159
v_fma_mix_f32 v233, v102, v102, v233 op_sel_hi:[1,1,0]
v_cvt_pkrtz_f16_f32 v148, v148, v149
v_fma_mix_f32 v233, v103, v103, v233 op_sel_hi:[1,1,0]
ds_read_u16 v147, v147
ds_read_u16 v145, v145
ds_read_b128 v[180:183], v251 offset:5120
v_cvt_pkrtz_f16_f32 v149, v150, v151
v_lshrrev_b64 v[148:149], 2, v[148:149]
v_and_b32_sdwa v150, s47, v148 dst_sel:DWORD dst_unused:UNUSED_PAD src0_sel:DWORD src1_sel:WORD_1
v_and_b32_e64 v148, s47, v148
v_exp_f16_sdwa v157, v157 dst_sel:WORD_0 dst_unused:UNUSED_PRESERVE src0_sel:WORD_0
v_mfma_f32_32x32x16_bf16 v[112:127], v[52:55], v[188:191], v[112:127]
ds_read_u16 v150, v150
ds_read_u16 v148, v148
v_fma_mix_f32 v233, v104, v104, v233 op_sel_hi:[1,1,0]
v_exp_f16_sdwa v159, v159 dst_sel:WORD_0 dst_unused:UNUSED_PRESERVE src0_sel:WORD_0
v_fma_mix_f32 v233, v105, v105, v233 op_sel_hi:[1,1,0]
v_and_b32_sdwa v151, s47, v149 dst_sel:DWORD dst_unused:UNUSED_PAD src0_sel:DWORD src1_sel:WORD_1
v_and_b32_e64 v149, s47, v149
v_exp_f16_sdwa v157, v157 dst_sel:WORD_1 dst_unused:UNUSED_PRESERVE src0_sel:WORD_1
v_fma_mix_f32 v233, v106, v106, v233 op_sel_hi:[1,1,0]
v_cvt_pkrtz_f16_f32 v152, v152, v153
v_fma_mix_f32 v233, v107, v107, v233 op_sel_hi:[1,1,0]
v_cvt_pkrtz_f16_f32 v153, v154, v155
v_lshrrev_b64 v[152:153], 2, v[152:153]
ds_read_u16 v151, v151
ds_read_u16 v149, v149
v_and_b32_sdwa v154, s47, v152 dst_sel:DWORD dst_unused:UNUSED_PAD src0_sel:DWORD src1_sel:WORD_1
v_and_b32_e64 v152, s47, v152
v_mfma_f32_32x32x16_bf16 v[128:143], v[188:191], v[76:79], v[128:143]
ds_read_u16 v154, v154
ds_read_u16 v152, v152
v_exp_f16_sdwa v159, v159 dst_sel:WORD_1 dst_unused:UNUSED_PRESERVE src0_sel:WORD_1
v_and_b32_sdwa v155, s47, v153 dst_sel:DWORD dst_unused:UNUSED_PAD src0_sel:DWORD src1_sel:WORD_1
v_and_b32 v153, s47, v153
v_pk_add_f16 v157, v157, 1.0 op_sel_hi:[1,0]
v_pk_add_f16 v159, v159, 1.0 op_sel_hi:[1,0]
v_rcp_f16_sdwa v157, v157 dst_sel:WORD_0 dst_unused:UNUSED_PRESERVE src0_sel:WORD_0
s_waitcnt lgkmcnt(6)
v_mfma_f32_32x32x16_bf16 v[112:127], v[56:59], v[176:179], v[112:127]
ds_read_b128 v[184:187], v251 offset:6144
ds_read_u16 v155, v155
ds_read_u16 v153, v153
v_rcp_f16_sdwa v159, v159 dst_sel:WORD_0 dst_unused:UNUSED_PRESERVE src0_sel:WORD_0
v_rcp_f16_sdwa v157, v157 dst_sel:WORD_1 dst_unused:UNUSED_PRESERVE src0_sel:WORD_1
v_mfma_f32_32x32x16_bf16 v[128:143], v[176:179], v[80:83], v[128:143]
v_rcp_f16_sdwa v159, v159 dst_sel:WORD_1 dst_unused:UNUSED_PRESERVE src0_sel:WORD_1
v_pk_mul_f16 v156, v156, v157
v_pk_mul_f16 v158, v158, v159
v_fma_mix_f32 v234, v156, v156, v234 op_sel_hi:[1,1,0]
v_mfma_f32_32x32x16_bf16 v[112:127], v[60:63], v[180:183], v[112:127]
ds_read_b128 v[188:191], v251 offset:7168
v_fma_mix_f32 v234, v158, v158, v234 op_sel_hi:[1,1,0]
v_permlane32_swap_b32 v232, v233
v_add_f32_e64 v232, v232, v233
s_setprio 1
ds_write_b32 v248, v232 offset:8448
v_fma_mix_f32 v234, v156, v156, v234 op_sel:[1,1,0] op_sel_hi:[1,1,0]
v_cvt_pkrtz_f16_f32 v160, v160, v161
v_fma_mix_f32 v234, v158, v158, v234 op_sel:[1,1,0] op_sel_hi:[1,1,0]
v_cvt_pkrtz_f16_f32 v161, v162, v163
v_fma_mix_f32 v234, v144, v144, v234 op_sel_hi:[1,1,0]
v_lshrrev_b64 v[160:161], 2, v[160:161]
v_fma_mix_f32 v234, v145, v145, v234 op_sel_hi:[1,1,0]
v_and_b32_sdwa v162, s47, v160 dst_sel:DWORD dst_unused:UNUSED_PAD src0_sel:DWORD src1_sel:WORD_1
v_fma_mix_f32 v234, v146, v146, v234 op_sel_hi:[1,1,0]
v_and_b32_e64 v160, s47, v160
v_fma_mix_f32 v234, v147, v147, v234 op_sel_hi:[1,1,0]
v_cvt_pk_f16_f32 v172, v172, v173
v_cvt_pk_f16_f32 v174, v174, v175
v_mfma_f32_32x32x16_bf16 v[128:143], v[180:183], v[84:87], v[128:143]
ds_read_u16_d16_hi v162, v162
ds_read_u16 v160, v160
v_pk_fma_f16 v173, v172, v172, s48
s_waitcnt lgkmcnt(6)
v_fma_mix_f32 v234, v148, v148, v234 op_sel_hi:[1,1,0]
v_and_b32_sdwa v163, s47, v161 dst_sel:DWORD dst_unused:UNUSED_PAD src0_sel:DWORD src1_sel:WORD_1
v_fma_mix_f32 v234, v149, v149, v234 op_sel_hi:[1,1,0]
v_and_b32 v161, s47, v161
v_pk_fma_f16 v175, v174, v174, s48
v_pk_mul_f16 v173, v172, v173
v_fma_mix_f32 v234, v150, v150, v234 op_sel_hi:[1,1,0]
v_cvt_pkrtz_f16_f32 v164, v164, v165
v_fma_mix_f32 v234, v151, v151, v234 op_sel_hi:[1,1,0]
v_cvt_pkrtz_f16_f32 v165, v166, v167
ds_read_u16_d16_hi v163, v163
ds_read_u16 v161, v161
v_lshrrev_b64 v[164:165], 2, v[164:165]
v_and_b32_sdwa v166, s47, v164 dst_sel:DWORD dst_unused:UNUSED_PAD src0_sel:DWORD src1_sel:WORD_1
v_and_b32_e64 v164, s47, v164
v_pk_mul_f16 v175, v174, v175
v_exp_f16_sdwa v173, v173 dst_sel:WORD_0 dst_unused:UNUSED_PRESERVE src0_sel:WORD_0
v_mfma_f32_32x32x16_bf16 v[112:127], v[64:67], v[184:187], v[112:127]
ds_read_u16_d16_hi v166, v166
ds_read_u16 v164, v164
v_fma_mix_f32 v234, v152, v152, v234 op_sel_hi:[1,1,0]
v_and_b32_sdwa v167, s47, v165 dst_sel:DWORD dst_unused:UNUSED_PAD src0_sel:DWORD src1_sel:WORD_1
s_waitcnt lgkmcnt(6)
v_fma_mix_f32 v234, v153, v153, v234 op_sel_hi:[1,1,0]
v_and_b32 v165, s47, v165
v_exp_f16_sdwa v175, v175 dst_sel:WORD_0 dst_unused:UNUSED_PRESERVE src0_sel:WORD_0
v_fma_mix_f32 v234, v154, v154, v234 op_sel_hi:[1,1,0]
v_cvt_pkrtz_f16_f32 v168, v168, v169
v_fma_mix_f32 v234, v155, v155, v234 op_sel_hi:[1,1,0]
v_cvt_pkrtz_f16_f32 v169, v170, v171
v_lshrrev_b64 v[168:169], 2, v[168:169]
ds_read_u16_d16_hi v167, v167
ds_read_u16 v165, v165
v_and_b32_sdwa v170, s47, v168 dst_sel:DWORD dst_unused:UNUSED_PAD src0_sel:DWORD src1_sel:WORD_1
v_and_b32_e64 v168, s47, v168
v_exp_f16_sdwa v173, v173 dst_sel:WORD_1 dst_unused:UNUSED_PRESERVE src0_sel:WORD_1
v_mfma_f32_32x32x16_bf16 v[128:143], v[184:187], v[88:91], v[128:143]
ds_read_u16_d16_hi v170, v170
ds_read_u16 v168, v168
v_and_b32_sdwa v171, s47, v169 dst_sel:DWORD dst_unused:UNUSED_PAD src0_sel:DWORD src1_sel:WORD_1
v_and_b32_e64 v169, s47, v169
v_exp_f16_sdwa v175, v175 dst_sel:WORD_1 dst_unused:UNUSED_PRESERVE src0_sel:WORD_1
v_pk_add_f16 v173, v173, 1.0 op_sel_hi:[1,0]
v_mfma_f32_32x32x16_bf16 v[112:127], v[68:71], v[188:191], v[112:127]
ds_read_u16_d16_hi v171, v171
ds_read_u16 v169, v169
v_pk_add_f16 v175, v175, 1.0 op_sel_hi:[1,0]
v_rcp_f16_sdwa v173, v173 dst_sel:WORD_0 dst_unused:UNUSED_PRESERVE src0_sel:WORD_0
v_rcp_f16_sdwa v175, v175 dst_sel:WORD_0 dst_unused:UNUSED_PRESERVE src0_sel:WORD_0
v_mfma_f32_32x32x16_bf16 v[128:143], v[188:191], v[92:95], v[128:143]
v_rcp_f16_sdwa v173, v173 dst_sel:WORD_1 dst_unused:UNUSED_PRESERVE src0_sel:WORD_1
v_rcp_f16_sdwa v175, v175 dst_sel:WORD_1 dst_unused:UNUSED_PRESERVE src0_sel:WORD_1
v_pk_mul_f16 v102, v172, v173
v_pk_mul_f16 v103, v174, v175
s_waitcnt lgkmcnt(5)
v_lshl_add_u64 v[96:97], v[160:161], 0, v[162:163]
s_waitcnt lgkmcnt(4)
v_lshl_add_u64 v[100:101], v[164:165], 0, v[166:167]
ds_read_b128 v[176:179], v250
ds_read_b128 v[180:183], v250 offset:1024
ds_read_b128 v[184:187], v250 offset:2048
s_nop 0
v_cvt_pkrtz_f16_f32 v128, v128, v129
v_cvt_pkrtz_f16_f32 v129, v130, v131
v_lshrrev_b64 v[128:129], 2, v[128:129]
v_and_b32_sdwa v130, s47, v128 dst_sel:DWORD dst_unused:UNUSED_PAD src0_sel:DWORD src1_sel:WORD_1
v_and_b32 v128, s47, v128
v_cvt_pk_f16_f32 v140, v140, v141
v_cvt_pk_f16_f32 v142, v142, v143
v_pk_fma_f16 v141, v140, v140, s48
v_and_b32_sdwa v131, s47, v129 dst_sel:DWORD dst_unused:UNUSED_PAD src0_sel:DWORD src1_sel:WORD_1
v_and_b32_e64 v129, s47, v129
v_pk_fma_f16 v143, v142, v142, s48
ds_read_u16_d16_hi v130, v130
ds_read_u16 v128, v128
ds_read_u16_d16_hi v131, v131
ds_read_u16 v129, v129
v_pk_mul_f16 v141, v140, v141
v_cvt_pkrtz_f16_f32 v132, v132, v133
v_cvt_pkrtz_f16_f32 v133, v134, v135
v_lshrrev_b64 v[132:133], 2, v[132:133]
v_and_b32_sdwa v134, s47, v132 dst_sel:DWORD dst_unused:UNUSED_PAD src0_sel:DWORD src1_sel:WORD_1
v_and_b32_e64 v132, s47, v132
v_pk_mul_f16 v143, v142, v143
v_exp_f16_sdwa v141, v141 dst_sel:WORD_0 dst_unused:UNUSED_PRESERVE src0_sel:WORD_0
v_and_b32_sdwa v135, s47, v133 dst_sel:DWORD dst_unused:UNUSED_PAD src0_sel:DWORD src1_sel:WORD_1
v_and_b32 v133, s47, v133
v_exp_f16_sdwa v143, v143 dst_sel:WORD_0 dst_unused:UNUSED_PRESERVE src0_sel:WORD_0
s_waitcnt lgkmcnt(6)
v_lshl_add_u64 v[98:99], v[168:169], 0, v[170:171]
ds_read_u16_d16_hi v134, v134
ds_read_u16 v132, v132
ds_read_u16_d16_hi v135, v135
ds_read_u16 v133, v133
v_cvt_pkrtz_f16_f32 v136, v136, v137
v_cvt_pkrtz_f16_f32 v137, v138, v139
v_lshrrev_b64 v[136:137], 2, v[136:137]
v_and_b32_sdwa v138, s47, v136 dst_sel:DWORD dst_unused:UNUSED_PAD src0_sel:DWORD src1_sel:WORD_1
v_and_b32_e64 v136, s47, v136
v_exp_f16_sdwa v141, v141 dst_sel:WORD_1 dst_unused:UNUSED_PRESERVE src0_sel:WORD_1
v_mfma_f32_32x32x16_f16 v[160:175], v[96:99], v[216:219], 0
ds_read_u16_d16_hi v138, v138
ds_read_u16 v136, v136
v_and_b32_sdwa v139, s47, v137 dst_sel:DWORD dst_unused:UNUSED_PAD src0_sel:DWORD src1_sel:WORD_1
v_and_b32_e64 v137, s47, v137
v_exp_f16_sdwa v143, v143 dst_sel:WORD_1 dst_unused:UNUSED_PRESERVE src0_sel:WORD_1
v_pk_add_f16 v141, v141, 1.0 op_sel_hi:[1,0]
v_mfma_f32_32x32x16_f16 v[160:175], v[100:103], v[220:223], v[160:175]
ds_read_u16_d16_hi v139, v139
ds_read_u16 v137, v137
v_pk_add_f16 v143, v143, 1.0 op_sel_hi:[1,0]
v_permlane16_swap_b32 v96, v100
v_permlane16_swap_b32 v97, v101
v_permlane16_swap_b32 v98, v102
v_permlane16_swap_b32 v99, v103
v_rcp_f16_sdwa v141, v141 dst_sel:WORD_0 dst_unused:UNUSED_PRESERVE src0_sel:WORD_0
v_rcp_f16_sdwa v143, v143 dst_sel:WORD_0 dst_unused:UNUSED_PRESERVE src0_sel:WORD_0
v_rcp_f16_sdwa v141, v141 dst_sel:WORD_1 dst_unused:UNUSED_PRESERVE src0_sel:WORD_1
s_nop 1
v_fmac_f32 v234, v160, v160
v_fmac_f32 v234, v161, v161
v_fmac_f32 v234, v162, v162
ds_read_b128 v[188:191], v250 offset:3072
v_rcp_f16_sdwa v143, v143 dst_sel:WORD_1 dst_unused:UNUSED_PRESERVE src0_sel:WORD_1
v_fmac_f32 v234, v163, v163
v_fmac_f32 v234, v164, v164
v_fmac_f32 v234, v165, v165
v_mfma_f32_32x32x16_bf16 v[144:159], v[176:179], v[72:75], 0
s_waitcnt lgkmcnt(7)
ds_read_b128 v[176:179], v250 offset:4096
v_fmac_f32_e64 v234, v166, v166
v_pk_mul_f16 v110, v140, v141
v_fmac_f32 v234, v167, v167
v_fmac_f32 v234, v168, v168
v_pk_mul_f16 v111, v142, v143
v_fmac_f32_e64 v234, v169, v169
v_lshl_add_u64 v[104:105], v[128:129], 0, v[130:131]
v_fmac_f32_e64 v234, v170, v170
v_cvt_pkrtz_f16_f32 v112, v112, v113
v_cvt_pkrtz_f16_f32 v113, v114, v115
v_lshrrev_b64 v[112:113], 2, v[112:113]
v_and_b32_sdwa v114, s47, v112 dst_sel:DWORD dst_unused:UNUSED_PAD src0_sel:DWORD src1_sel:WORD_1
v_and_b32_e64 v112, s47, v112
v_cvt_pk_f16_f32 v124, v124, v125
v_fmac_f32_e64 v234, v171, v171
v_cvt_pk_f16_f32 v126, v126, v127
v_fmac_f32 v234, v172, v172
v_fmac_f32 v234, v173, v173
v_mfma_f32_32x32x16_bf16 v[144:159], v[180:183], v[76:79], v[144:159]
ds_read_u16 v114, v114
ds_read_u16 v112, v112
ds_read_b128 v[180:183], v250 offset:5120
v_pk_fma_f16 v125, v124, v124, s48
v_fmac_f32_e64 v234, v174, v174
v_and_b32_sdwa v115, s47, v113 dst_sel:DWORD dst_unused:UNUSED_PAD src0_sel:DWORD src1_sel:WORD_1
v_and_b32_e64 v113, s47, v113
v_fmac_f32 v234, v175, v175
v_pk_fma_f16 v127, v126, v126, s48
v_pk_mul_f16 v125, v124, v125
v_pk_mul_f16 v127, v126, v127
s_waitcnt lgkmcnt(6)
v_lshl_add_u64 v[108:109], v[132:133], 0, v[134:135]
v_cvt_pkrtz_f16_f32 v116, v116, v117
ds_read_u16 v115, v115
ds_read_u16 v113, v113
v_cvt_pkrtz_f16_f32 v117, v118, v119
v_lshrrev_b64 v[116:117], 2, v[116:117]
v_and_b32_sdwa v118, s47, v116 dst_sel:DWORD dst_unused:UNUSED_PAD src0_sel:DWORD src1_sel:WORD_1
v_and_b32_e64 v116, s47, v116
v_exp_f16_sdwa v125, v125 dst_sel:WORD_0 dst_unused:UNUSED_PRESERVE src0_sel:WORD_0
v_mfma_f32_32x32x16_bf16 v[144:159], v[184:187], v[80:83], v[144:159]
ds_read_u16 v118, v118
ds_read_u16 v116, v116
ds_read_b128 v[184:187], v250 offset:6144
v_exp_f16_sdwa v127, v127 dst_sel:WORD_0 dst_unused:UNUSED_PRESERVE src0_sel:WORD_0
v_and_b32_sdwa v119, s47, v117 dst_sel:DWORD dst_unused:UNUSED_PAD src0_sel:DWORD src1_sel:WORD_1
v_and_b32 v117, s47, v117
v_exp_f16_sdwa v125, v125 dst_sel:WORD_1 dst_unused:UNUSED_PRESERVE src0_sel:WORD_1
s_waitcnt lgkmcnt(7)
v_lshl_add_u64 v[106:107], v[136:137], 0, v[138:139]
v_cvt_pkrtz_f16_f32 v120, v120, v121
v_cvt_pkrtz_f16_f32 v121, v122, v123
v_lshrrev_b64 v[120:121], 2, v[120:121]
v_and_b32_sdwa v122, s47, v120 dst_sel:DWORD dst_unused:UNUSED_PAD src0_sel:DWORD src1_sel:WORD_1
ds_read_u16 v119, v119
ds_read_u16 v117, v117
v_and_b32_e64 v120, s47, v120
v_mfma_f32_32x32x16_bf16 v[144:159], v[188:191], v[84:87], v[144:159]
ds_read_u16 v122, v122
ds_read_u16 v120, v120
ds_read_b128 v[188:191], v250 offset:7168
s_waitcnt vmcnt(0)
v_exp_f16_sdwa v127, v127 dst_sel:WORD_1 dst_unused:UNUSED_PRESERVE src0_sel:WORD_1
v_and_b32_sdwa v123, s47, v121 dst_sel:DWORD dst_unused:UNUSED_PAD src0_sel:DWORD src1_sel:WORD_1
v_mfma_f32_32x32x16_f16 v[128:143], v[104:107], v[216:219], 0
v_and_b32 v121, s47, v121
v_pk_add_f16 v125, v125, 1.0 op_sel_hi:[1,0]
v_pk_add_f16 v127, v127, 1.0 op_sel_hi:[1,0]
v_rcp_f16_sdwa v125, v125 dst_sel:WORD_0 dst_unused:UNUSED_PRESERVE src0_sel:WORD_0
v_mfma_f32_32x32x16_f16 v[128:143], v[108:111], v[220:223], v[128:143]
ds_read_u16 v123, v123
ds_read_u16 v121, v121
v_permlane16_swap_b32 v104, v108
v_permlane16_swap_b32 v105, v109
v_permlane16_swap_b32 v106, v110
v_permlane16_swap_b32 v107, v111
v_mfma_f32_32x32x16_bf16 v[144:159], v[176:179], v[88:91], v[144:159]
ds_read_b128 v[176:179], v250 offset:8192
v_rcp_f16_sdwa v127, v127 dst_sel:WORD_0 dst_unused:UNUSED_PRESERVE src0_sel:WORD_0
v_rcp_f16_sdwa v125, v125 dst_sel:WORD_1 dst_unused:UNUSED_PRESERVE src0_sel:WORD_1
v_rcp_f16_sdwa v127, v127 dst_sel:WORD_1 dst_unused:UNUSED_PRESERVE src0_sel:WORD_1
s_waitcnt lgkmcnt(8)
v_mfma_f32_32x32x16_bf16 v[144:159], v[180:183], v[92:95], v[144:159]
ds_read_b128 v[180:183], v250 offset:9216
v_fmac_f32 v235, v128, v128
v_pk_mul_f16 v124, v124, v125
v_fmac_f32_e64 v235, v129, v129
v_pk_mul_f16 v126, v126, v127
v_fmac_f32 v235, v130, v130
v_fmac_f32 v235, v131, v131
v_fmac_f32 v235, v132, v132
v_fmac_f32 v235, v133, v133
v_mfma_f32_32x32x16_bf16 v[160:175], v[184:187], v[72:75], 0
ds_read_b128 v[184:187], v250 offset:10240
v_permlane16_swap_b32 v48, v52
v_permlane16_swap_b32 v49, v53
v_permlane16_swap_b32 v50, v54
v_permlane16_swap_b32 v51, v55
v_permlane16_swap_b32 v56, v60
v_permlane16_swap_b32 v57, v61
v_permlane16_swap_b32 v58, v62
v_permlane16_swap_b32 v59, v63
v_permlane16_swap_b32 v64, v68
v_permlane16_swap_b32 v65, v69
v_permlane16_swap_b32 v66, v70
v_permlane16_swap_b32 v67, v71
v_permlane16_swap_b32 v24, v28
v_permlane16_swap_b32 v25, v29
v_permlane16_swap_b32 v26, v30
v_permlane16_swap_b32 v27, v31
v_permlane16_swap_b32 v32, v36
v_permlane16_swap_b32 v33, v37
v_permlane16_swap_b32 v34, v38
v_permlane16_swap_b32 v35, v39
v_permlane16_swap_b32 v40, v44
v_permlane16_swap_b32 v41, v45
v_permlane16_swap_b32 v42, v46
v_permlane16_swap_b32 v43, v47
v_fmac_f32 v235, v134, v134
v_fmac_f32 v235, v135, v135
v_fmac_f32 v235, v136, v136
v_fmac_f32 v235, v137, v137
v_fmac_f32_e64 v235, v138, v138
v_cvt_pkrtz_f16_f32 v144, v144, v145
v_cvt_pkrtz_f16_f32 v145, v146, v147
v_lshrrev_b64 v[144:145], 2, v[144:145]
v_and_b32_sdwa v146, s47, v144 dst_sel:DWORD dst_unused:UNUSED_PAD src0_sel:DWORD src1_sel:WORD_1
v_and_b32_e64 v144, s47, v144
v_cvt_pk_f16_f32 v156, v156, v157
v_fmac_f32_e64 v235, v139, v139
v_cvt_pk_f16_f32 v158, v158, v159
v_fmac_f32_e64 v235, v140, v140
v_fmac_f32 v235, v141, v141
s_waitcnt lgkmcnt(0)
v_mfma_f32_32x32x16_bf16 v[160:175], v[188:191], v[76:79], v[160:175]
ds_read_u16_d16_hi v146, v146
ds_read_u16 v144, v144
ds_read_b128 v[188:191], v250 offset:11264
v_pk_fma_f16 v157, v156, v156, s48
v_fmac_f32_e64 v235, v142, v142
v_and_b32_sdwa v147, s47, v145 dst_sel:DWORD dst_unused:UNUSED_PAD src0_sel:DWORD src1_sel:WORD_1
v_and_b32 v145, s47, v145
v_fmac_f32 v235, v143, v143
v_fma_mix_f32 v235, v124, v124, v235 op_sel_hi:[1,1,0]
v_pk_fma_f16 v159, v158, v158, s48
v_fma_mix_f32 v235, v126, v126, v235 op_sel_hi:[1,1,0]
v_pk_mul_f16 v157, v156, v157
v_fma_mix_f32 v235, v124, v124, v235 op_sel:[1,1,0] op_sel_hi:[1,1,0]
ds_read_u16_d16_hi v147, v147
ds_read_u16 v145, v145
v_fma_mix_f32 v235, v126, v126, v235 op_sel:[1,1,0] op_sel_hi:[1,1,0]
v_cvt_pkrtz_f16_f32 v148, v148, v149
v_fma_mix_f32 v235, v112, v112, v235 op_sel_hi:[1,1,0]
v_cvt_pkrtz_f16_f32 v149, v150, v151
v_fma_mix_f32 v235, v113, v113, v235 op_sel_hi:[1,1,0]
v_lshrrev_b64 v[148:149], 2, v[148:149]
v_fma_mix_f32 v235, v114, v114, v235 op_sel_hi:[1,1,0]
v_and_b32_sdwa v150, s47, v148 dst_sel:DWORD dst_unused:UNUSED_PAD src0_sel:DWORD src1_sel:WORD_1
v_fma_mix_f32 v235, v115, v115, v235 op_sel_hi:[1,1,0]
v_and_b32_e64 v148, s47, v148
v_fma_mix_f32 v235, v116, v116, v235 op_sel_hi:[1,1,0]
v_pk_mul_f16 v159, v158, v159
v_fma_mix_f32 v235, v117, v117, v235 op_sel_hi:[1,1,0]
v_exp_f16_sdwa v157, v157 dst_sel:WORD_0 dst_unused:UNUSED_PRESERVE src0_sel:WORD_0
v_fma_mix_f32 v235, v118, v118, v235 op_sel_hi:[1,1,0]
v_mfma_f32_32x32x16_bf16 v[160:175], v[176:179], v[80:83], v[160:175]
v_fma_mix_f32 v235, v119, v119, v235 op_sel_hi:[1,1,0]
v_and_b32_sdwa v151, s47, v149 dst_sel:DWORD dst_unused:UNUSED_PAD src0_sel:DWORD src1_sel:WORD_1
v_fma_mix_f32 v235, v120, v120, v235 op_sel_hi:[1,1,0]
v_and_b32_e64 v149, s47, v149
v_fma_mix_f32 v235, v121, v121, v235 op_sel_hi:[1,1,0]
v_exp_f16_sdwa v159, v159 dst_sel:WORD_0 dst_unused:UNUSED_PRESERVE src0_sel:WORD_0
v_fma_mix_f32 v235, v122, v122, v235 op_sel_hi:[1,1,0]
ds_read_u16_d16_hi v150, v150
ds_read_u16 v148, v148
ds_read_u16_d16_hi v151, v151
ds_read_u16 v149, v149
v_fma_mix_f32 v235, v123, v123, v235 op_sel_hi:[1,1,0]
v_cvt_pkrtz_f16_f32 v152, v152, v153
s_nop 0
v_permlane32_swap_b32 v234, v235
v_add_f32_e64 v234, v234, v235
v_cvt_pkrtz_f16_f32 v153, v154, v155
v_lshrrev_b64 v[152:153], 2, v[152:153]
v_and_b32_sdwa v154, s47, v152 dst_sel:DWORD dst_unused:UNUSED_PAD src0_sel:DWORD src1_sel:WORD_1
v_and_b32_e64 v152, s47, v152
v_exp_f16_sdwa v157, v157 dst_sel:WORD_1 dst_unused:UNUSED_PRESERVE src0_sel:WORD_1
v_mfma_f32_32x32x16_bf16 v[160:175], v[180:183], v[84:87], v[160:175]
ds_write_b32 v248, v234 offset:8704
s_setprio 3
v_mov_b32_e64 v238, 1
s_waitcnt lgkmcnt(0)
s_nop 9
s_mov_b64 exec, 1
ds_add_rtn_u32 v239, v247, v238 offset:0
s_mov_b64 exec, -1
s_waitcnt lgkmcnt(0)
v_readfirstlane_b32 s43, v239
s_nop 1
s_cmp_lg_u32 s43, 7
s_cbranch_scc1 Lnopub
ds_read_b128 v[128:131], v244
ds_read_b128 v[132:135], v244 offset:16
ds_read_b128 v[136:139], v244 offset:9216
ds_read_b128 v[140:143], v244 offset:9232
ds_read_b128 v[112:115], v244 offset:18432
ds_read_b128 v[116:119], v244 offset:18448
ds_read_b128 v[120:123], v244 offset:27648
ds_read_b128 v[124:127], v244 offset:27664
ds_read_b128 v[216:219], v244 offset:36864
ds_read_b128 v[220:223], v244 offset:36880
s_waitcnt lgkmcnt(7)
v_add_f32 v128, v128, v136
v_add_f32 v129, v129, v137
v_add_f32 v130, v130, v138
v_add_f32 v131, v131, v139
s_waitcnt lgkmcnt(6)
v_add_f32 v132, v132, v140
v_add_f32 v133, v133, v141
v_add_f32 v134, v134, v142
v_add_f32 v135, v135, v143
ds_read_b128 v[136:139], v244 offset:46080
ds_read_b128 v[140:143], v244 offset:46096
s_waitcnt lgkmcnt(7)
v_add_f32 v128, v128, v112
v_add_f32 v129, v129, v113
v_add_f32 v130, v130, v114
v_add_f32 v131, v131, v115
s_waitcnt lgkmcnt(6)
v_add_f32 v132, v132, v116
v_add_f32 v133, v133, v117
v_add_f32 v134, v134, v118
v_add_f32 v135, v135, v119
ds_read_b128 v[112:115], v244 offset:55296
ds_read_b128 v[116:119], v244 offset:55312
s_waitcnt lgkmcnt(7)
v_add_f32 v128, v128, v120
v_add_f32 v129, v129, v121
v_add_f32 v130, v130, v122
v_add_f32 v131, v131, v123
s_waitcnt lgkmcnt(6)
v_add_f32 v132, v132, v124
v_add_f32 v133, v133, v125
v_add_f32 v134, v134, v126
v_add_f32 v135, v135, v127
ds_read_b128 v[120:123], v244 offset:64512
ds_read_b128 v[124:127], v244 offset:64528
s_waitcnt lgkmcnt(7)
v_add_f32 v128, v128, v216
v_add_f32 v129, v129, v217
v_add_f32 v130, v130, v218
v_add_f32 v131, v131, v219
s_waitcnt lgkmcnt(6)
v_add_f32 v132, v132, v220
v_add_f32 v133, v133, v221
v_add_f32 v134, v134, v222
v_add_f32 v135, v135, v223
s_waitcnt lgkmcnt(5)
v_add_f32 v128, v128, v136
v_add_f32 v129, v129, v137
v_add_f32 v130, v130, v138
v_add_f32 v131, v131, v139
s_waitcnt lgkmcnt(4)
v_add_f32 v132, v132, v140
v_add_f32 v133, v133, v141
v_add_f32 v134, v134, v142
v_add_f32 v135, v135, v143
s_waitcnt lgkmcnt(3)
v_add_f32 v128, v128, v112
v_add_f32 v129, v129, v113
v_add_f32 v130, v130, v114
v_add_f32 v131, v131, v115
s_waitcnt lgkmcnt(2)
v_add_f32 v132, v132, v116
v_add_f32 v133, v133, v117
v_add_f32 v134, v134, v118
v_add_f32 v135, v135, v119
s_waitcnt lgkmcnt(1)
v_add_f32 v128, v128, v120
v_add_f32 v129, v129, v121
v_add_f32 v130, v130, v122
v_add_f32 v131, v131, v123
s_waitcnt lgkmcnt(0)
v_add_f32 v132, v132, v124
v_add_f32 v133, v133, v125
v_add_f32 v134, v134, v126
v_add_f32 v135, v135, v127
v_min_u32 v216, -2, v128
v_min_u32 v217, -2, v129
v_min_u32 v218, -2, v130
v_min_u32 v219, -2, v131
v_min_u32 v220, -2, v132
v_min_u32 v221, -2, v133
v_min_u32_e64 v222, -2, v134
v_min_u32 v223, -2, v135
s_lshl_b32 s43, s2, 4
buffer_store_dwordx4 v[216:219], v237, s[32:35], s43 offen sc1
buffer_store_dwordx4 v[220:223], v245, s[32:35], s43 offen sc1
ds_write_b32 v247, v238 offset:4
s_waitcnt lgkmcnt(0)
s_nop 1
Lnopub:
s_mov_b32 s77, 0
v_bfe_u32 v244, v250, 8, 2
v_lshlrev_b32 v244, 3, v244
s_cmp_lg_u32 s40, 0
s_cbranch_scc1 Lnorole
v_subrev_u32 v245, 16384, v250
v_lshrrev_b32_e64 v240, 1, v245
v_add_u32 v240, v240, v245
s_cmp_lt_u32 s2, 96
s_cselect_b32 s77, 1, 2
s_cbranch_scc1 Lred
s_and_b32 s44, s2, 7
s_lshl_b32 s44, s44, 11
s_add_u32 s44, s44, 393216
s_waitcnt lgkmcnt(0)
buffer_load_dwordx2 v[128:129], v240, s[32:35], s44 offen sc1
buffer_load_dwordx2 v[130:131], v240, s[32:35], s44 offen offset:8 sc1
buffer_load_dwordx2 v[132:133], v240, s[32:35], s44 offen offset:16 sc1
v_lshrrev_b32_e64 v241, 1, v240
buffer_load_dword v135, v241, s[24:27], 0 offen
buffer_load_dword v137, v241, s[24:27], 0 offen offset:4
buffer_load_dword v139, v241, s[24:27], 0 offen offset:8
s_branch Lnorole
Lred:
s_lshl_b32 s44, s2, 12
s_waitcnt vmcnt(4)
buffer_load_dwordx4 v[128:131], v245, s[32:35], s44 offen sc1
s_waitcnt vmcnt(3)
buffer_load_dwordx4 v[132:135], v245, s[32:35], s44 offen offset:1024 sc1
s_waitcnt vmcnt(2)
buffer_load_dwordx4 v[136:139], v245, s[32:35], s44 offen offset:2048 sc1
buffer_load_dwordx4 v[140:143], v245, s[32:35], s44 offen offset:3072 sc1
Lnorole:
s_setprio 0
ds_read_u16_d16_hi v154, v154
ds_read_u16 v152, v152
v_and_b32_sdwa v155, s47, v153 dst_sel:DWORD dst_unused:UNUSED_PAD src0_sel:DWORD src1_sel:WORD_1
v_and_b32_e64 v153, s47, v153
v_exp_f16_sdwa v159, v159 dst_sel:WORD_1 dst_unused:UNUSED_PRESERVE src0_sel:WORD_1
v_pk_add_f16 v157, v157, 1.0 op_sel_hi:[1,0]
v_mfma_f32_32x32x16_bf16 v[160:175], v[184:187], v[88:91], v[160:175]
ds_read_u16_d16_hi v155, v155
ds_read_u16 v153, v153
v_pk_add_f16 v159, v159, 1.0 op_sel_hi:[1,0]
v_rcp_f16_sdwa v157, v157 dst_sel:WORD_0 dst_unused:UNUSED_PRESERVE src0_sel:WORD_0
v_rcp_f16_sdwa v159, v159 dst_sel:WORD_0 dst_unused:UNUSED_PRESERVE src0_sel:WORD_0
v_mfma_f32_32x32x16_bf16 v[160:175], v[188:191], v[92:95], v[160:175]
ds_read_b128 v[176:179], v250 offset:55296
ds_read_b128 v[180:183], v250 offset:56320
ds_read_b128 v[184:187], v250 offset:57344
v_rcp_f16_sdwa v157, v157 dst_sel:WORD_1 dst_unused:UNUSED_PRESERVE src0_sel:WORD_1
v_rcp_f16_sdwa v159, v159 dst_sel:WORD_1 dst_unused:UNUSED_PRESERVE src0_sel:WORD_1
s_waitcnt lgkmcnt(7)
v_pk_mul_f16 v118, v156, v157
v_pk_mul_f16 v119, v158, v159
v_lshl_add_u64 v[112:113], v[144:145], 0, v[146:147]
v_lshl_add_u64 v[116:117], v[148:149], 0, v[150:151]
ds_read_b128 v[188:191], v250 offset:58368
s_nop 0
v_permlane16_swap_b32 v112, v116
v_cvt_pkrtz_f16_f32 v160, v160, v161
v_cvt_pkrtz_f16_f32 v161, v162, v163
v_lshrrev_b64 v[160:161], 2, v[160:161]
v_and_b32_sdwa v162, s47, v160 dst_sel:DWORD dst_unused:UNUSED_PAD src0_sel:DWORD src1_sel:WORD_1
v_and_b32 v160, s47, v160
v_cvt_pk_f16_f32 v172, v172, v173
v_cvt_pk_f16_f32 v174, v174, v175
v_pk_fma_f16 v173, v172, v172, s48
v_and_b32_sdwa v163, s47, v161 dst_sel:DWORD dst_unused:UNUSED_PAD src0_sel:DWORD src1_sel:WORD_1
v_and_b32_e64 v161, s47, v161
v_pk_fma_f16 v175, v174, v174, s48
ds_read_u16_d16_hi v162, v162
ds_read_u16 v160, v160
ds_read_u16_d16_hi v163, v163
ds_read_u16 v161, v161
v_pk_mul_f16 v173, v172, v173
s_cmp_eq_u32 s77, 0
s_cbranch_scc1 Lpp1
s_call_b64 s[78:79], Lpolln
Lpp1:
v_cvt_pkrtz_f16_f32 v164, v164, v165
v_cvt_pkrtz_f16_f32 v165, v166, v167
v_lshrrev_b64 v[164:165], 2, v[164:165]
v_and_b32_sdwa v166, s47, v164 dst_sel:DWORD dst_unused:UNUSED_PAD src0_sel:DWORD src1_sel:WORD_1
v_and_b32 v164, s47, v164
v_pk_mul_f16 v175, v174, v175
v_exp_f16_sdwa v173, v173 dst_sel:WORD_0 dst_unused:UNUSED_PRESERVE src0_sel:WORD_0
v_and_b32_sdwa v167, s47, v165 dst_sel:DWORD dst_unused:UNUSED_PAD src0_sel:DWORD src1_sel:WORD_1
v_and_b32 v165, s47, v165
v_exp_f16_sdwa v175, v175 dst_sel:WORD_0 dst_unused:UNUSED_PRESERVE src0_sel:WORD_0
s_waitcnt lgkmcnt(6)
v_lshl_add_u64 v[114:115], v[152:153], 0, v[154:155]
ds_read_u16_d16_hi v166, v166
ds_read_u16 v164, v164
ds_read_u16_d16_hi v167, v167
ds_read_u16 v165, v165
v_cvt_pkrtz_f16_f32 v168, v168, v169
v_cvt_pkrtz_f16_f32 v169, v170, v171
v_lshrrev_b64 v[168:169], 2, v[168:169]
v_and_b32_sdwa v170, s47, v168 dst_sel:DWORD dst_unused:UNUSED_PAD src0_sel:DWORD src1_sel:WORD_1
v_and_b32_e64 v168, s47, v168
v_exp_f16_sdwa v173, v173 dst_sel:WORD_1 dst_unused:UNUSED_PRESERVE src0_sel:WORD_1
v_mfma_f32_32x32x16_bf16 v[144:159], v[176:179], v[72:75], 0
ds_read_u16_d16_hi v170, v170
ds_read_u16 v168, v168
ds_read_b128 v[176:179], v250 offset:59392
v_permlane16_swap_b32 v113, v117
v_permlane16_swap_b32 v114, v118
v_permlane16_swap_b32 v115, v119
s_cmp_eq_u32 s77, 0
s_cbranch_scc1 Lpp2
s_call_b64 s[78:79], Lpolln
Lpp2:
v_and_b32_sdwa v171, s47, v169 dst_sel:DWORD dst_unused:UNUSED_PAD src0_sel:DWORD src1_sel:WORD_1
v_and_b32_e64 v169, s47, v169
v_exp_f16_sdwa v175, v175 dst_sel:WORD_1 dst_unused:UNUSED_PRESERVE src0_sel:WORD_1
v_mfma_f32_32x32x16_bf16 v[144:159], v[180:183], v[76:79], v[144:159]
ds_read_u16_d16_hi v171, v171
ds_read_u16 v169, v169
s_waitcnt lgkmcnt(10)
ds_read_b128 v[180:183], v250 offset:60416
v_pk_add_f16 v173, v173, 1.0 op_sel_hi:[1,0]
v_pk_add_f16 v175, v175, 1.0 op_sel_hi:[1,0]
v_rcp_f16_sdwa v173, v173 dst_sel:WORD_0 dst_unused:UNUSED_PRESERVE src0_sel:WORD_0
v_mfma_f32_32x32x16_bf16 v[144:159], v[184:187], v[80:83], v[144:159]
v_rcp_f16_sdwa v175, v175 dst_sel:WORD_0 dst_unused:UNUSED_PRESERVE src0_sel:WORD_0
v_rcp_f16_sdwa v173, v173 dst_sel:WORD_1 dst_unused:UNUSED_PRESERVE src0_sel:WORD_1
v_rcp_f16_sdwa v175, v175 dst_sel:WORD_1 dst_unused:UNUSED_PRESERVE src0_sel:WORD_1
v_mfma_f32_32x32x16_bf16 v[144:159], v[188:191], v[84:87], v[144:159]
v_pk_mul_f16 v222, v172, v173
v_pk_mul_f16 v223, v174, v175
s_waitcnt lgkmcnt(8)
v_lshl_add_u64 v[216:217], v[160:161], 0, v[162:163]
s_waitcnt lgkmcnt(6)
v_lshl_add_u64 v[220:221], v[164:165], 0, v[166:167]
s_waitcnt lgkmcnt(3)
v_mfma_f32_32x32x16_bf16 v[144:159], v[176:179], v[88:91], v[144:159]
s_cmp_eq_u32 s77, 0
s_cbranch_scc1 Lpp3
s_call_b64 s[78:79], Lpolln
Lpp3:
s_waitcnt lgkmcnt(0)
v_mfma_f32_32x32x16_bf16 v[144:159], v[180:183], v[92:95], v[144:159]
s_mul_i32 s43, s40, 96
buffer_load_dwordx2 v[176:177], v244, s[28:31], s43 offen
buffer_load_dwordx2 v[178:179], v244, s[28:31], s43 offen offset:32
buffer_load_dwordx2 v[180:181], v244, s[28:31], s43 offen offset:64
v_mov_b32 v249, 0
s_branch Law6
Lax6:
s_sleep 2
Law6:
ds_read_b32 v249, v247 offset:4
s_sub_u32 s76, s76, 1
s_cselect_b32 s44, 1, 0
s_cselect_b32 s76, 0, s76
s_waitcnt lgkmcnt(0)
v_readfirstlane_b32 s43, v249
s_nop 1
s_max_u32 s43, s43, s44
s_cmp_lt_u32 s43, 1
s_cbranch_scc1 Lax6
s_add_u32 m0, s72, 5120
s_add_u32 s43, s82, 3200
buffer_load_dwordx4 v246, s[16:19], s43 offen lds
s_mov_b32 s3, 0
s_add_u32 m0, s72, 8192
s_add_u32 s43, s82, 6272
buffer_load_dwordx4 v246, s[16:19], s43 offen lds
s_mov_b32 s3, 0
v_lshl_add_u64 v[218:219], v[168:169], 0, v[170:171]
v_cvt_pkrtz_f16_f32 v144, v144, v145
v_cvt_pkrtz_f16_f32 v145, v146, v147
v_lshrrev_b64 v[144:145], 2, v[144:145]
v_and_b32_sdwa v146, s47, v144 dst_sel:DWORD dst_unused:UNUSED_PAD src0_sel:DWORD src1_sel:WORD_1
v_and_b32_e64 v144, s47, v144
v_cvt_pk_f16_f32 v156, v156, v157
v_cvt_pk_f16_f32 v158, v158, v159
v_pk_fma_f16 v157, v156, v156, s48
v_and_b32_sdwa v147, s47, v145 dst_sel:DWORD dst_unused:UNUSED_PAD src0_sel:DWORD src1_sel:WORD_1
v_and_b32 v145, s47, v145
v_pk_fma_f16 v159, v158, v158, s48
ds_read_u16_d16_hi v146, v146
ds_read_u16 v144, v144
s_cmp_eq_u32 s77, 0
s_cbranch_scc1 Lpp4
s_call_b64 s[78:79], Lpolln
Lpp4:
ds_read_u16_d16_hi v147, v147
ds_read_u16 v145, v145
v_pk_mul_f16 v157, v156, v157
v_cvt_pkrtz_f16_f32 v148, v148, v149
v_cvt_pkrtz_f16_f32 v149, v150, v151
v_lshrrev_b64 v[148:149], 2, v[148:149]
v_and_b32_sdwa v150, s47, v148 dst_sel:DWORD dst_unused:UNUSED_PAD src0_sel:DWORD src1_sel:WORD_1
v_and_b32_e64 v148, s47, v148
v_pk_mul_f16 v159, v158, v159
v_exp_f16_sdwa v157, v157 dst_sel:WORD_0 dst_unused:UNUSED_PRESERVE src0_sel:WORD_0
v_and_b32_sdwa v151, s47, v149 dst_sel:DWORD dst_unused:UNUSED_PAD src0_sel:DWORD src1_sel:WORD_1
v_and_b32_e64 v149, s47, v149
v_exp_f16_sdwa v159, v159 dst_sel:WORD_0 dst_unused:UNUSED_PRESERVE src0_sel:WORD_0
v_cvt_pkrtz_f16_f32 v152, v152, v153
ds_read_u16_d16_hi v150, v150
ds_read_u16 v148, v148
ds_read_u16_d16_hi v151, v151
ds_read_u16 v149, v149
s_cmp_eq_u32 s77, 0
s_cbranch_scc1 Lpp5
s_call_b64 s[78:79], Lpolln
Lpp5:
s_setprio 3
v_cvt_pkrtz_f16_f32 v153, v154, v155
v_lshrrev_b64 v[152:153], 2, v[152:153]
v_and_b32_sdwa v154, s47, v152 dst_sel:DWORD dst_unused:UNUSED_PAD src0_sel:DWORD src1_sel:WORD_1
v_and_b32_e64 v152, s47, v152
v_exp_f16_sdwa v157, v157 dst_sel:WORD_1 dst_unused:UNUSED_PRESERVE src0_sel:WORD_1
v_permlane16_swap_b32 v216, v220
v_permlane16_swap_b32 v217, v221
v_permlane16_swap_b32 v218, v222
v_permlane16_swap_b32 v219, v223
v_and_b32_sdwa v155, s47, v153 dst_sel:DWORD dst_unused:UNUSED_PAD src0_sel:DWORD src1_sel:WORD_1
ds_read_u16_d16_hi v154, v154
ds_read_u16 v152, v152
v_and_b32_e64 v153, s47, v153
v_exp_f16_sdwa v159, v159 dst_sel:WORD_1 dst_unused:UNUSED_PRESERVE src0_sel:WORD_1
v_pk_add_f16 v157, v157, 1.0 op_sel_hi:[1,0]
v_pk_add_f16 v159, v159, 1.0 op_sel_hi:[1,0]
v_rcp_f16_sdwa v157, v157 dst_sel:WORD_0 dst_unused:UNUSED_PRESERVE src0_sel:WORD_0
v_rcp_f16_sdwa v159, v159 dst_sel:WORD_0 dst_unused:UNUSED_PRESERVE src0_sel:WORD_0
v_rcp_f16_sdwa v157, v157 dst_sel:WORD_1 dst_unused:UNUSED_PRESERVE src0_sel:WORD_1
ds_read_u16_d16_hi v155, v155
ds_read_u16 v153, v153
v_bfe_u32 v190, v250, 4, 6
v_lshl_add_u32 v186, v190, 4, s72
s_mul_i32 s43, s40, 3
s_add_u32 s43, s43, 0
s_and_b32 s44, s43, 1
s_mul_i32 s44, s44, 3064
s_mul_i32 s43, s43, 3072
s_sub_u32 s43, s43, s44
s_add_u32 s43, s43, 90112
v_lshl_add_u32 v173, v190, 4, s43
s_mul_i32 s43, s40, 3
s_add_u32 s43, s43, 1
s_and_b32 s44, s43, 1
s_mul_i32 s44, s44, 3064
s_mul_i32 s43, s43, 3072
s_sub_u32 s43, s43, s44
s_add_u32 s43, s43, 90112
v_lshl_add_u32 v174, v190, 4, s43
s_mul_i32 s43, s40, 3
s_add_u32 s43, s43, 2
s_and_b32 s44, s43, 1
s_mul_i32 s44, s44, 3064
s_mul_i32 s43, s43, 3072
s_sub_u32 s43, s43, s44
s_add_u32 s43, s43, 90112
v_lshl_add_u32 v175, v190, 4, s43
v_lshl_add_u32 v187, v244, 2, s72
v_and_b32_e64 v189, 3, v190
v_bfe_u32 v191, v190, 2, 1
v_lshl_add_u32 v189, v191, 3, v189
v_bfe_u32 v191, v190, 3, 1
v_lshl_add_u32 v189, v191, 2, v189
v_bfe_u32 v191, v190, 4, 1
v_lshl_add_u32 v189, v191, 6, v189
v_bfe_u32 v191, v190, 5, 1
v_lshl_add_u32 v189, v191, 5, v189
v_lshlrev_b32_e64 v189, 4, v189
v_add_u32 v248, 16384, v189
v_add_u32 v249, 53248, v189
v_min_u32 v189, 11, v190
s_mul_i32 s43, s40, 12
v_add_u32 v189, s43, v189
v_cmp_gt_u32 vcc, 64, v189
v_lshlrev_b32_e64 v189, 2, v189
v_add_u32 v172, 93312, v189
v_add_u32 v191, 16128, v189
v_add_u32 v189, 7680, v189
v_cndmask_b32 v189, v189, v191, vcc
v_add_u32 v188, s72, v244
v_lshrrev_b32 v191, 3, v190
v_mul_u32_u24 v191, 9120, v191
v_mul_u32_u24 v190, 12, v190
v_add_u32 v191, v191, v190
v_add_u32 v191, 93184, v191
ds_read_b64_tr_b16 v[72:73], v186
ds_read_b64_tr_b16 v[74:75], v186 offset:8
ds_read_b64_tr_b16 v[84:85], v186 offset:3072
s_waitcnt lgkmcnt(6)
ds_read_b64_tr_b16 v[86:87], v186 offset:3080
ds_read_b64_tr_b16 v[160:161], v186 offset:6144
ds_read_b64_tr_b16 v[162:163], v186 offset:6152
s_cmp_eq_u32 s77, 0
s_cbranch_scc1 Lpp6
s_call_b64 s[78:79], Lpolln
Lpp6:
s_cmp_eq_u32 s3, 1
s_cbranch_scc1 Lvw0
s_waitcnt vmcnt(2)
Lvw0:
ds_read_b64_tr_b16 v[76:77], v186 offset:1024
ds_read_b64_tr_b16 v[78:79], v186 offset:1032
ds_read_b64_tr_b16 v[88:89], v186 offset:4096
ds_read_b64_tr_b16 v[90:91], v186 offset:4104
ds_read_b64_tr_b16 v[164:165], v186 offset:7168
ds_read_b64_tr_b16 v[166:167], v186 offset:7176
v_rcp_f16_sdwa v159, v159 dst_sel:WORD_1 dst_unused:UNUSED_PRESERVE src0_sel:WORD_1
v_pk_mul_f16 v238, v156, v157
v_pk_mul_f16 v239, v158, v159
v_lshl_add_u64 v[232:233], v[144:145], 0, v[146:147]
v_lshl_add_u64 v[236:237], v[148:149], 0, v[150:151]
s_waitcnt lgkmcnt(12)
ds_read_b64_tr_b16 v[80:81], v186 offset:2048
ds_read_b64_tr_b16 v[82:83], v186 offset:2056
s_waitcnt lgkmcnt(13)
v_mfma_f32_16x16x16_bf16 v[120:123], v[72:73], v[176:177], 0
v_lshlrev_b32 v182, 16, v72
v_and_b32 v183, 4294901760, v72
s_waitcnt lgkmcnt(12)
v_mfma_f32_16x16x16_bf16 v[124:127], v[74:75], v[176:177], 0
v_cvt_pk_f16_f32 v72, v182, v183
v_lshlrev_b32 v184, 16, v73
s_waitcnt lgkmcnt(11)
v_mfma_f32_16x16x16_bf16 v[120:123], v[84:85], v[178:179], v[120:123]
v_and_b32 v185, 4294901760, v73
v_cvt_pk_f16_f32 v73, v184, v185
s_waitcnt lgkmcnt(10)
v_mfma_f32_16x16x16_bf16 v[124:127], v[86:87], v[178:179], v[124:127]
v_lshlrev_b32 v182, 16, v74
v_and_b32 v183, 4294901760, v74
s_waitcnt lgkmcnt(8)
v_mfma_f32_16x16x16_bf16 v[120:123], v[160:161], v[180:181], v[120:123]
v_cvt_pk_f16_f32 v74, v182, v183
v_lshlrev_b32 v184, 16, v75
v_mfma_f32_16x16x16_bf16 v[124:127], v[162:163], v[180:181], v[124:127]
s_setprio 2
s_cmp_eq_u32 s77, 0
s_cbranch_scc1 Lpp7
s_call_b64 s[78:79], Lpolln
Lpp7:
v_and_b32 v185, 4294901760, v75
v_cvt_pk_f16_f32 v75, v184, v185
v_lshlrev_b32_e64 v182, 16, v84
v_and_b32 v183, 4294901760, v84
v_lshlrev_b32 v184, 16, v85
v_and_b32 v185, 4294901760, v85
v_lshl_add_u64 v[234:235], v[152:153], 0, v[154:155]
v_permlane16_swap_b32 v232, v236
s_mov_b32 exec_lo, 65537
s_mov_b32 exec_hi, 65537
ds_write_b128 v187, v[120:123] offset:3200
ds_write_b128 v187, v[124:127] offset:3216
s_mov_b64 exec, -1
v_cvt_pk_f16_f32 v84, v182, v183
v_cvt_pk_f16_f32 v85, v184, v185
v_lshlrev_b32 v182, 16, v86
v_and_b32 v183, 4294901760, v86
v_cvt_pk_f16_f32 v86, v182, v183
v_lshlrev_b32_e64 v184, 16, v87
v_and_b32 v185, 4294901760, v87
v_cvt_pk_f16_f32 v87, v184, v185
v_lshlrev_b32_e64 v182, 16, v160
v_and_b32 v183, 4294901760, v160
v_cvt_pk_f16_f32 v160, v182, v183
v_lshlrev_b32_e64 v184, 16, v161
v_and_b32 v185, 4294901760, v161
v_cvt_pk_f16_f32 v161, v184, v185
v_lshlrev_b32_e64 v182, 16, v162
v_and_b32 v183, 4294901760, v162
v_cvt_pk_f16_f32 v162, v182, v183
s_cmp_eq_u32 s77, 0
s_cbranch_scc1 Lpp8
s_call_b64 s[78:79], Lpolln
Lpp8:
v_lshlrev_b32 v184, 16, v163
v_and_b32 v185, 4294901760, v163
v_cvt_pk_f16_f32 v163, v184, v185
s_waitcnt lgkmcnt(9)
v_mfma_f32_16x16x16_bf16 v[120:123], v[76:77], v[176:177], 0
v_lshlrev_b32_e64 v182, 16, v76
v_and_b32 v183, 4294901760, v76
s_waitcnt lgkmcnt(8)
v_mfma_f32_16x16x16_bf16 v[124:127], v[78:79], v[176:177], 0
v_cvt_pk_f16_f32 v76, v182, v183
v_lshlrev_b32 v184, 16, v77
s_waitcnt lgkmcnt(7)
v_mfma_f32_16x16x16_bf16 v[120:123], v[88:89], v[178:179], v[120:123]
v_and_b32 v185, 4294901760, v77
v_cvt_pk_f16_f32 v77, v184, v185
s_waitcnt lgkmcnt(6)
v_mfma_f32_16x16x16_bf16 v[124:127], v[90:91], v[178:179], v[124:127]
v_lshlrev_b32_e64 v182, 16, v78
v_and_b32 v183, 4294901760, v78
s_waitcnt lgkmcnt(5)
v_mfma_f32_16x16x16_bf16 v[120:123], v[164:165], v[180:181], v[120:123]
v_cvt_pk_f16_f32 v78, v182, v183
v_permlane16_swap_b32 v233, v237
s_waitcnt lgkmcnt(4)
v_mfma_f32_16x16x16_bf16 v[124:127], v[166:167], v[180:181], v[124:127]
s_setprio 1
v_permlane16_swap_b32 v234, v238
v_permlane16_swap_b32 v235, v239
v_lshlrev_b32 v184, 16, v79
v_and_b32 v185, 4294901760, v79
v_cvt_pk_f16_f32 v79, v184, v185
v_lshlrev_b32 v182, 16, v88
v_and_b32 v183, 4294901760, v88
v_cvt_pk_f16_f32 v88, v182, v183
s_nop 0
s_mov_b32 exec_lo, 65537
s_mov_b32 exec_hi, 65537
ds_write_b128 v187, v[120:123] offset:3328
ds_write_b128 v187, v[124:127] offset:3344
s_mov_b64 exec, -1
v_lshlrev_b32 v184, 16, v89
v_and_b32 v185, 4294901760, v89
v_cvt_pk_f16_f32 v89, v184, v185
s_cmp_eq_u32 s77, 0
s_cbranch_scc1 Lpp9
s_call_b64 s[78:79], Lpolln
Lpp9:
v_lshlrev_b32_e64 v182, 16, v90
v_and_b32 v183, 4294901760, v90
v_cvt_pk_f16_f32 v90, v182, v183
s_cmp_eq_u32 s3, 1
s_cbranch_scc1 Lvw1
s_waitcnt vmcnt(0)
Lvw1:
ds_read_b64_tr_b16 v[92:93], v186 offset:5120
ds_read_b64_tr_b16 v[94:95], v186 offset:5128
ds_read_b64_tr_b16 v[168:169], v186 offset:8192
ds_read_b64_tr_b16 v[170:171], v186 offset:8200
v_lshlrev_b32_e64 v184, 16, v91
v_and_b32 v185, 4294901760, v91
v_cvt_pk_f16_f32 v91, v184, v185
v_lshlrev_b32_e64 v182, 16, v164
v_and_b32 v183, 4294901760, v164
v_cvt_pk_f16_f32 v164, v182, v183
v_lshlrev_b32_e64 v184, 16, v165
v_and_b32 v185, 4294901760, v165
v_cvt_pk_f16_f32 v165, v184, v185
v_lshlrev_b32_e64 v182, 16, v166
v_and_b32 v183, 4294901760, v166
v_cvt_pk_f16_f32 v166, v182, v183
v_lshlrev_b32 v184, 16, v167
v_and_b32 v185, 4294901760, v167
v_cvt_pk_f16_f32 v167, v184, v185
s_waitcnt lgkmcnt(9)
v_mfma_f32_16x16x16_bf16 v[120:123], v[80:81], v[176:177], 0
v_lshlrev_b32 v182, 16, v80
v_and_b32 v183, 4294901760, v80
s_waitcnt lgkmcnt(8)
v_mfma_f32_16x16x16_bf16 v[124:127], v[82:83], v[176:177], 0
v_cvt_pk_f16_f32 v80, v182, v183
v_lshlrev_b32 v184, 16, v81
s_waitcnt lgkmcnt(3)
v_mfma_f32_16x16x16_bf16 v[120:123], v[92:93], v[178:179], v[120:123]
v_and_b32 v185, 4294901760, v81
v_cvt_pk_f16_f32 v81, v184, v185
s_waitcnt lgkmcnt(1)
v_mfma_f32_16x16x16_bf16 v[124:127], v[94:95], v[178:179], v[124:127]
v_lshlrev_b32 v182, 16, v82
v_and_b32 v183, 4294901760, v82
v_mfma_f32_16x16x16_bf16 v[120:123], v[168:169], v[180:181], v[120:123]
v_cvt_pk_f16_f32 v82, v182, v183
v_lshlrev_b32 v184, 16, v83
s_waitcnt lgkmcnt(0)
v_mfma_f32_16x16x16_bf16 v[124:127], v[170:171], v[180:181], v[124:127]
s_cmp_eq_u32 s77, 0
s_cbranch_scc1 Lpp10
s_call_b64 s[78:79], Lpolln
Lpp10:
s_setprio 0
v_and_b32 v185, 4294901760, v83
v_cvt_pk_f16_f32 v83, v184, v185
v_lshlrev_b32_e64 v182, 16, v92
v_and_b32 v183, 4294901760, v92
v_cvt_pk_f16_f32 v92, v182, v183
v_lshlrev_b32_e64 v184, 16, v93
v_and_b32 v185, 4294901760, v93
v_cvt_pk_f16_f32 v93, v184, v185
s_mov_b32 exec_lo, 65537
s_mov_b32 exec_hi, 65537
ds_write_b128 v187, v[120:123] offset:3456
ds_write_b128 v187, v[124:127] offset:3472
s_mov_b64 exec, -1
ds_read_b128 v[120:123], v248
ds_read_b128 v[124:127], v248 offset:2048
v_lshlrev_b32 v182, 16, v94
v_and_b32 v183, 4294901760, v94
v_cvt_pk_f16_f32 v94, v182, v183
v_lshlrev_b32_e64 v184, 16, v95
v_and_b32 v185, 4294901760, v95
v_cvt_pk_f16_f32 v95, v184, v185
s_cmp_eq_u32 s77, 0
s_cbranch_scc1 Lpp11
s_call_b64 s[78:79], Lpolln
Lpp11:
v_lshlrev_b32 v182, 16, v168
v_and_b32 v183, 4294901760, v168
v_cvt_pk_f16_f32 v168, v182, v183
v_lshlrev_b32_e64 v184, 16, v169
v_and_b32 v185, 4294901760, v169
v_cvt_pk_f16_f32 v169, v184, v185
v_lshlrev_b32_e64 v182, 16, v170
v_and_b32 v183, 4294901760, v170
v_cvt_pk_f16_f32 v170, v182, v183
v_lshlrev_b32_e64 v184, 16, v171
v_and_b32 v185, 4294901760, v171
v_cvt_pk_f16_f32 v171, v184, v185
s_cmp_eq_u32 s77, 0
s_cbranch_scc1 Lpp12
s_call_b64 s[78:79], Lpolln
Lpp12:
s_waitcnt lgkmcnt(0)
s_barrier
s_setprio 2
ds_read_b32 v176, v172
ds_read_b32 v177, v172 offset:9216
ds_read_b32 v178, v172 offset:18432
ds_read_b32 v179, v172 offset:27648
ds_read_b32 v180, v172 offset:36864
ds_read_b32 v181, v172 offset:46080
ds_read_b32 v182, v172 offset:55296
ds_read_b32 v183, v172 offset:64512
v_mfma_f32_16x16x32_bf16 v[144:147], v[120:123], v[48:51], 0
s_cmp_eq_u32 s77, 0
s_cbranch_scc1 Lpp13
s_call_b64 s[78:79], Lpolln
Lpp13:
v_mfma_f32_16x16x32_bf16 v[148:151], v[120:123], v[52:55], 0
v_mfma_f32_16x16x32_bf16 v[152:155], v[120:123], v[24:27], 0
ds_read_b128 v[120:123], v248 offset:4096
v_mfma_f32_16x16x32_bf16 v[144:147], v[124:127], v[56:59], v[144:147]
s_waitcnt lgkmcnt(7)
v_add_f32_e64 v176, v176, v177
v_mfma_f32_16x16x32_bf16 v[148:151], v[124:127], v[60:63], v[148:151]
s_waitcnt lgkmcnt(6)
v_add_f32 v176, v176, v178
s_waitcnt lgkmcnt(5)
v_add_f32 v176, v176, v179
s_cmp_eq_u32 s77, 0
s_cbranch_scc1 Lpp14
s_call_b64 s[78:79], Lpolln
Lpp14:
s_waitcnt lgkmcnt(4)
v_add_f32 v176, v176, v180
s_waitcnt lgkmcnt(3)
v_add_f32 v176, v176, v181
s_waitcnt lgkmcnt(2)
v_add_f32 v176, v176, v182
s_waitcnt lgkmcnt(1)
v_add_f32 v176, v176, v183
ds_write_b32 v189, v176
v_mfma_f32_16x16x32_bf16 v[152:155], v[124:127], v[32:35], v[152:155]
ds_read_b128 v[124:127], v248 offset:256
s_waitcnt lgkmcnt(2)
v_mfma_f32_16x16x32_bf16 v[144:147], v[120:123], v[64:67], v[144:147]
v_mfma_f32_16x16x32_bf16 v[148:151], v[120:123], v[68:71], v[148:151]
s_cmp_eq_u32 s77, 0
s_cbranch_scc1 Lpp15
s_call_b64 s[78:79], Lpolln
Lpp15:
v_mfma_f32_16x16x32_bf16 v[152:155], v[120:123], v[40:43], v[152:155]
ds_read_b128 v[120:123], v248 offset:2304
s_nop 2
v_cvt_pk_f16_f32 v144, v144, v145
v_cvt_pk_f16_f32 v146, v146, v147
v_pk_fma_f16 v145, v144, v144, s48
v_pk_fma_f16 v147, v146, v146, s48
v_cvt_pkrtz_f16_f32 v148, v148, v149
v_cvt_pkrtz_f16_f32 v149, v150, v151
v_lshrrev_b64 v[148:149], 2, v[148:149]
v_and_b32_sdwa v150, s47, v148 dst_sel:DWORD dst_unused:UNUSED_PAD src0_sel:DWORD src1_sel:WORD_1
v_and_b32 v148, s47, v148
s_waitcnt lgkmcnt(1)
v_mfma_f32_16x16x32_bf16 v[156:159], v[124:127], v[48:51], 0
ds_read_u16_d16_hi v150, v150
ds_read_u16 v148, v148
v_mfma_f32_16x16x32_bf16 v[176:179], v[124:127], v[52:55], 0
s_cmp_eq_u32 s77, 0
s_cbranch_scc1 Lpp16
s_call_b64 s[78:79], Lpolln
Lpp16:
v_and_b32_sdwa v151, s47, v149 dst_sel:DWORD dst_unused:UNUSED_PAD src0_sel:DWORD src1_sel:WORD_1
v_and_b32_e64 v149, s47, v149
v_mfma_f32_16x16x32_bf16 v[180:183], v[124:127], v[24:27], 0
ds_read_b128 v[124:127], v248 offset:4352
ds_read_u16_d16_hi v151, v151
s_waitcnt lgkmcnt(4)
v_mfma_f32_16x16x32_bf16 v[156:159], v[120:123], v[56:59], v[156:159]
ds_read_u16 v149, v149
v_pk_mul_f16 v145, v144, v145
v_mfma_f32_16x16x32_bf16 v[176:179], v[120:123], v[60:63], v[176:179]
v_pk_mul_f16 v147, v146, v147
v_cvt_pkrtz_f16_f32 v152, v152, v153
v_cvt_pkrtz_f16_f32 v153, v154, v155
v_lshrrev_b64 v[152:153], 2, v[152:153]
v_and_b32_sdwa v154, s47, v152 dst_sel:DWORD dst_unused:UNUSED_PAD src0_sel:DWORD src1_sel:WORD_1
v_and_b32_e64 v152, s47, v152
v_exp_f16_sdwa v145, v145 dst_sel:WORD_0 dst_unused:UNUSED_PRESERVE src0_sel:WORD_0
v_mfma_f32_16x16x32_bf16 v[180:183], v[120:123], v[32:35], v[180:183]
ds_read_u16_d16_hi v154, v154
ds_read_u16 v152, v152
s_cmp_eq_u32 s77, 0
s_cbranch_scc1 Lpp17
s_call_b64 s[78:79], Lpolln
Lpp17:
v_exp_f16_sdwa v147, v147 dst_sel:WORD_0 dst_unused:UNUSED_PRESERVE src0_sel:WORD_0
v_and_b32_sdwa v155, s47, v153 dst_sel:DWORD dst_unused:UNUSED_PAD src0_sel:DWORD src1_sel:WORD_1
v_and_b32 v153, s47, v153
v_exp_f16_sdwa v145, v145 dst_sel:WORD_1 dst_unused:UNUSED_PRESERVE src0_sel:WORD_1
s_waitcnt lgkmcnt(4)
v_mfma_f32_16x16x32_bf16 v[156:159], v[124:127], v[64:67], v[156:159]
ds_read_u16_d16_hi v155, v155
ds_read_u16 v153, v153
v_mfma_f32_16x16x32_bf16 v[176:179], v[124:127], v[68:71], v[176:179]
v_exp_f16_sdwa v147, v147 dst_sel:WORD_1 dst_unused:UNUSED_PRESERVE src0_sel:WORD_1
v_mfma_f32_16x16x32_bf16 v[180:183], v[124:127], v[40:43], v[180:183]
v_pk_add_f16 v145, v145, 1.0 op_sel_hi:[1,0]
v_pk_add_f16 v147, v147, 1.0 op_sel_hi:[1,0]
s_cmp_eq_u32 s77, 0
s_cbranch_scc1 Lpp18
s_call_b64 s[78:79], Lpolln
Lpp18:
v_rcp_f16_sdwa v145, v145 dst_sel:WORD_0 dst_unused:UNUSED_PRESERVE src0_sel:WORD_0
v_rcp_f16_sdwa v147, v147 dst_sel:WORD_0 dst_unused:UNUSED_PRESERVE src0_sel:WORD_0
v_cvt_pkrtz_f16_f32 v156, v156, v157
v_cvt_pkrtz_f16_f32 v157, v158, v159
v_lshrrev_b64 v[156:157], 2, v[156:157]
v_and_b32_sdwa v158, s47, v156 dst_sel:DWORD dst_unused:UNUSED_PAD src0_sel:DWORD src1_sel:WORD_1
v_and_b32_e64 v156, s47, v156
v_rcp_f16_sdwa v145, v145 dst_sel:WORD_1 dst_unused:UNUSED_PRESERVE src0_sel:WORD_1
v_and_b32_sdwa v159, s47, v157 dst_sel:DWORD dst_unused:UNUSED_PAD src0_sel:DWORD src1_sel:WORD_1
v_and_b32_e64 v157, s47, v157
v_rcp_f16_sdwa v147, v147 dst_sel:WORD_1 dst_unused:UNUSED_PRESERVE src0_sel:WORD_1
v_cvt_pkrtz_f16_f32 v176, v176, v177
v_cvt_pkrtz_f16_f32 v177, v178, v179
ds_read_u16_d16_hi v158, v158
ds_read_u16 v156, v156
ds_read_u16_d16_hi v159, v159
ds_read_u16 v157, v157
v_lshrrev_b64 v[176:177], 2, v[176:177]
v_and_b32_sdwa v178, s47, v176 dst_sel:DWORD dst_unused:UNUSED_PAD src0_sel:DWORD src1_sel:WORD_1
v_and_b32_e64 v176, s47, v176
v_pk_mul_f16 v144, v144, v145
v_and_b32_sdwa v179, s47, v177 dst_sel:DWORD dst_unused:UNUSED_PAD src0_sel:DWORD src1_sel:WORD_1
v_and_b32_e64 v177, s47, v177
v_pk_mul_f16 v145, v146, v147
s_waitcnt lgkmcnt(5)
v_lshl_add_u64 v[148:149], v[148:149], 0, v[150:151]
v_cvt_pkrtz_f16_f32 v180, v180, v181
ds_read_u16_d16_hi v178, v178
ds_read_u16 v176, v176
s_cmp_eq_u32 s77, 0
s_cbranch_scc1 Lpp19
s_call_b64 s[78:79], Lpolln
Lpp19:
ds_read_u16_d16_hi v179, v179
ds_read_u16 v177, v177
v_cvt_pkrtz_f16_f32 v181, v182, v183
v_lshrrev_b64 v[180:181], 2, v[180:181]
v_and_b32_sdwa v182, s47, v180 dst_sel:DWORD dst_unused:UNUSED_PAD src0_sel:DWORD src1_sel:WORD_1
v_and_b32_e64 v180, s47, v180
v_and_b32_sdwa v183, s47, v181 dst_sel:DWORD dst_unused:UNUSED_PAD src0_sel:DWORD src1_sel:WORD_1
v_and_b32 v181, s47, v181
s_waitcnt lgkmcnt(8)
v_lshl_add_u64 v[152:153], v[152:153], 0, v[154:155]
ds_read_u16_d16_hi v182, v182
ds_read_u16 v180, v180
ds_read_u16_d16_hi v183, v183
ds_read_u16 v181, v181
s_cmp_eq_u32 s77, 0
s_cbranch_scc1 Lpp20
s_call_b64 s[78:79], Lpolln
Lpp20:
s_cmp_eq_u32 s77, 0
s_cbranch_scc1 Lpp21
s_call_b64 s[78:79], Lpolln
Lpp21:
ds_read_b128 v[120:123], v248 offset:6144
s_waitcnt lgkmcnt(9)
v_lshl_add_u64 v[146:147], v[156:157], 0, v[158:159]
s_waitcnt lgkmcnt(5)
v_lshl_add_u64 v[150:151], v[176:177], 0, v[178:179]
s_waitcnt lgkmcnt(1)
v_lshl_add_u64 v[154:155], v[180:181], 0, v[182:183]
s_cmp_lg_u32 s40, 0
s_cbranch_scc1 Lspinx
s_setprio 3
Lspin:
s_cmp_eq_u32 s77, 0
s_cbranch_scc1 Lspiny
s_cmp_eq_u32 s76, 0
s_cbranch_scc1 Lspiny
s_sub_u32 s76, s76, 1
s_call_b64 s[78:79], Lpoll
s_branch Lspin
Lspiny:
ds_write_b32 v191, v128
ds_write_b32 v191, v129 offset:4
ds_write_b32 v191, v130 offset:8
s_waitcnt lgkmcnt(0)
Lspinx:
s_waitcnt lgkmcnt(0)
s_barrier
ds_read_b64 v[240:241], v188 offset:3072
ds_read_b64 v[242:243], v188 offset:3104
ds_read_b64 v[244:245], v188 offset:3136
ds_read_b128 v[128:131], v254 offset:8192
ds_read_b128 v[132:135], v254 offset:8208
ds_read_b128 v[136:139], v254 offset:8320
ds_read_b128 v[140:143], v254 offset:8336
s_waitcnt lgkmcnt(6)
v_pk_mul_f16 v72, v72, v240
v_pk_mul_f16 v73, v73, v241
v_and_b32 v72, s49, v72
v_and_b32 v73, s49, v73
s_waitcnt lgkmcnt(4)
v_pk_mul_f16 v74, v74, v240
v_pk_mul_f16 v75, v75, v241
v_and_b32 v74, s49, v74
v_and_b32 v75, s49, v75
v_pk_mul_f16 v76, v76, v240
v_pk_mul_f16 v77, v77, v241
v_and_b32 v76, s49, v76
v_and_b32 v77, s49, v77
v_pk_mul_f16 v78, v78, v240
v_pk_mul_f16 v79, v79, v241
ds_write_b64 v173, v[72:73]
ds_write_b64 v173, v[74:75] offset:3072
v_and_b32 v78, s49, v78
v_and_b32 v79, s49, v79
v_pk_mul_f16 v80, v80, v240
v_pk_mul_f16 v81, v81, v241
v_and_b32 v80, s49, v80
v_and_b32 v81, s49, v81
v_pk_mul_f16 v82, v82, v240
v_pk_mul_f16 v83, v83, v241
ds_write_b64 v173, v[76:77] offset:1024
ds_write_b64 v173, v[78:79] offset:4096
v_and_b32 v82, s49, v82
v_and_b32 v83, s49, v83
v_pk_mul_f16 v84, v84, v242
v_pk_mul_f16 v85, v85, v243
v_and_b32 v84, s49, v84
v_and_b32 v85, s49, v85
v_pk_mul_f16 v86, v86, v242
v_pk_mul_f16 v87, v87, v243
ds_write_b64 v173, v[80:81] offset:2048
ds_write_b64 v173, v[82:83] offset:5120
v_and_b32 v86, s49, v86
v_and_b32 v87, s49, v87
v_pk_mul_f16 v88, v88, v242
v_pk_mul_f16 v89, v89, v243
v_and_b32 v88, s49, v88
v_and_b32 v89, s49, v89
v_pk_mul_f16 v90, v90, v242
v_pk_mul_f16 v91, v91, v243
ds_write_b64 v174, v[84:85]
ds_write_b64 v174, v[86:87] offset:3072
v_and_b32 v90, s49, v90
v_and_b32 v91, s49, v91
v_pk_mul_f16 v92, v92, v242
v_pk_mul_f16 v93, v93, v243
v_and_b32 v92, s49, v92
v_and_b32 v93, s49, v93
v_pk_mul_f16 v94, v94, v242
v_pk_mul_f16 v95, v95, v243
ds_write_b64 v174, v[88:89] offset:1024
ds_write_b64 v174, v[90:91] offset:4096
v_and_b32 v94, s49, v94
v_and_b32 v95, s49, v95
v_pk_mul_f16 v160, v160, v244
v_pk_mul_f16 v161, v161, v245
v_and_b32 v160, s49, v160
v_and_b32 v161, s49, v161
v_pk_mul_f16 v162, v162, v244
v_pk_mul_f16 v163, v163, v245
ds_write_b64 v174, v[92:93] offset:2048
s_waitcnt lgkmcnt(6)
ds_write_b64 v174, v[94:95] offset:5120
v_and_b32 v162, s49, v162
v_and_b32_e64 v163, s49, v163
v_pk_mul_f16 v164, v164, v244
v_pk_mul_f16 v165, v165, v245
v_and_b32 v164, s49, v164
v_and_b32 v165, s49, v165
v_pk_mul_f16 v166, v166, v244
v_pk_mul_f16 v167, v167, v245
ds_write_b64 v175, v[160:161]
ds_write_b64 v175, v[162:163] offset:3072
v_and_b32 v166, s49, v166
v_and_b32 v167, s49, v167
v_pk_mul_f16 v168, v168, v244
v_pk_mul_f16 v169, v169, v245
v_and_b32 v168, s49, v168
v_and_b32 v169, s49, v169
v_pk_mul_f16 v170, v170, v244
v_pk_mul_f16 v171, v171, v245
ds_write_b64 v175, v[164:165] offset:1024
ds_write_b64 v175, v[166:167] offset:4096
v_and_b32_e64 v170, s49, v170
v_and_b32 v171, s49, v171
ds_write_b64 v175, v[168:169] offset:2048
ds_write_b64 v175, v[170:171] offset:5120
ds_read_b128 v[240:243], v254
ds_read_b128 v[244:247], v254 offset:16
s_waitcnt lgkmcnt(0)
s_barrier
ds_read_b128 v[124:127], v251 offset:20480
ds_read_b128 v[184:187], v251 offset:23552
ds_read_b128 v[188:191], v251 offset:21504
ds_read_b128 v[160:163], v251 offset:24576
buffer_load_dwordx4 v[164:167], v253, s[4:7], s71 offen
buffer_load_dwordx4 v[168:171], v253, s[4:7], s71 offen offset:64
v_mfma_f32_16x16x32_bf16 v[172:175], v[120:123], v[48:51], 0
s_setprio 3
v_mfma_f32_16x16x32_bf16 v[156:159], v[120:123], v[52:55], 0
v_mfma_f32_16x16x32_bf16 v[176:179], v[120:123], v[24:27], 0
ds_read_b128 v[120:123], v251 offset:22528
s_waitcnt lgkmcnt(4)
v_mfma_f32_16x16x32_f16 v[72:75], v[124:127], v[4:7], v[128:131]
v_mfma_f32_16x16x32_f16 v[128:131], v[124:127], v[0:3], v[128:131]
ds_read_b128 v[124:127], v248 offset:8192
s_waitcnt lgkmcnt(4)
v_mfma_f32_16x16x32_f16 v[76:79], v[184:187], v[4:7], v[132:135]
v_mfma_f32_16x16x32_f16 v[132:135], v[184:187], v[0:3], v[132:135]
ds_read_b128 v[184:187], v251 offset:25600
s_waitcnt lgkmcnt(4)
v_mfma_f32_16x16x32_f16 v[80:83], v[188:191], v[4:7], v[136:139]
v_mfma_f32_16x16x32_f16 v[136:139], v[188:191], v[0:3], v[136:139]
ds_read_b128 v[188:191], v251 offset:26624
s_waitcnt lgkmcnt(4)
v_mfma_f32_16x16x32_f16 v[84:87], v[160:163], v[4:7], v[140:143]
v_mfma_f32_16x16x32_f16 v[140:143], v[160:163], v[0:3], v[140:143]
ds_read_b128 v[160:163], v251 offset:29696
s_waitcnt lgkmcnt(4)
v_mfma_f32_16x16x32_f16 v[88:91], v[120:123], v[4:7], v[240:243]
s_waitcnt lgkmcnt(3)
v_mfma_f32_16x16x32_bf16 v[172:175], v[124:127], v[56:59], v[172:175]
v_mfma_f32_16x16x32_f16 v[240:243], v[120:123], v[0:3], v[240:243]
ds_read_b128 v[120:123], v251 offset:27648
s_waitcnt lgkmcnt(3)
v_mfma_f32_16x16x32_f16 v[92:95], v[184:187], v[4:7], v[244:247]
v_mfma_f32_16x16x32_f16 v[244:247], v[184:187], v[0:3], v[244:247]
ds_read_b128 v[184:187], v251 offset:30720
v_mfma_f32_16x16x32_bf16 v[156:159], v[124:127], v[60:63], v[156:159]
s_waitcnt lgkmcnt(3)
v_mfma_f32_16x16x32_f16 v[72:75], v[188:191], v[12:15], v[72:75]
v_mfma_f32_16x16x32_f16 v[128:131], v[188:191], v[8:11], v[128:131]
ds_read_b128 v[188:191], v251 offset:28672
s_waitcnt lgkmcnt(3)
v_mfma_f32_16x16x32_f16 v[76:79], v[160:163], v[12:15], v[76:79]
v_mfma_f32_16x16x32_bf16 v[176:179], v[124:127], v[32:35], v[176:179]
ds_read_b128 v[124:127], v248 offset:10240
v_mfma_f32_16x16x32_f16 v[132:135], v[160:163], v[8:11], v[132:135]
ds_read_b128 v[160:163], v251 offset:31744
s_waitcnt lgkmcnt(4)
v_mfma_f32_16x16x32_f16 v[80:83], v[120:123], v[12:15], v[80:83]
v_mfma_f32_16x16x32_f16 v[136:139], v[120:123], v[8:11], v[136:139]
ds_read_b128 v[120:123], v251 offset:32768
s_setprio 2
s_waitcnt lgkmcnt(4)
v_mfma_f32_16x16x32_f16 v[84:87], v[184:187], v[12:15], v[84:87]
v_mfma_f32_16x16x32_f16 v[140:143], v[184:187], v[8:11], v[140:143]
ds_read_b128 v[184:187], v248 offset:6400
s_waitcnt lgkmcnt(4)
v_mfma_f32_16x16x32_f16 v[88:91], v[188:191], v[12:15], v[88:91]
s_waitcnt lgkmcnt(3)
v_mfma_f32_16x16x32_bf16 v[172:175], v[124:127], v[64:67], v[172:175]
v_mfma_f32_16x16x32_bf16 v[156:159], v[124:127], v[68:71], v[156:159]
v_mfma_f32_16x16x32_f16 v[240:243], v[188:191], v[8:11], v[240:243]
ds_read_b128 v[188:191], v251 offset:33792
s_nop 4
v_cvt_pk_f16_f32 v172, v172, v173
s_waitcnt lgkmcnt(3)
v_mfma_f32_16x16x32_f16 v[92:95], v[160:163], v[12:15], v[92:95]
v_cvt_pk_f16_f32 v174, v174, v175
v_cvt_pkrtz_f16_f32 v156, v156, v157
v_mfma_f32_16x16x32_f16 v[244:247], v[160:163], v[8:11], v[244:247]
ds_read_b128 v[160:163], v251 offset:36864
v_cvt_pkrtz_f16_f32 v157, v158, v159
v_mfma_f32_16x16x32_bf16 v[176:179], v[124:127], v[40:43], v[176:179]
ds_read_b128 v[124:127], v251 offset:35840
v_lshrrev_b64 v[156:157], 2, v[156:157]
s_waitcnt lgkmcnt(3)
v_mfma_f32_16x16x32_f16 v[72:75], v[120:123], v[20:23], v[72:75]
v_and_b32_sdwa v158, s47, v156 dst_sel:DWORD dst_unused:UNUSED_PAD src0_sel:DWORD src1_sel:WORD_1
v_and_b32 v156, s47, v156
v_mfma_f32_16x16x32_f16 v[128:131], v[120:123], v[16:19], v[128:131]
ds_read_b128 v[120:123], v251 offset:34816
ds_read_u16_d16_hi v158, v158
v_mfma_f32_16x16x32_bf16 v[180:183], v[184:187], v[48:51], 0
ds_read_u16 v156, v156
v_pk_fma_f16 v173, v172, v172, s48
s_waitcnt lgkmcnt(5)
v_mfma_f32_16x16x32_f16 v[80:83], v[188:191], v[20:23], v[80:83]
v_and_b32_sdwa v159, s47, v157 dst_sel:DWORD dst_unused:UNUSED_PAD src0_sel:DWORD src1_sel:WORD_1
v_and_b32_e64 v157, s47, v157
v_mfma_f32_16x16x32_f16 v[136:139], v[188:191], v[16:19], v[136:139]
ds_read_b128 v[188:191], v252 offset:4096
ds_read_u16_d16_hi v159, v159
s_waitcnt lgkmcnt(5)
v_mfma_f32_16x16x32_f16 v[76:79], v[124:127], v[20:23], v[76:79]
ds_read_u16 v157, v157
v_pk_fma_f16 v175, v174, v174, s48
v_mfma_f32_16x16x32_f16 v[132:135], v[124:127], v[16:19], v[132:135]
ds_read_b128 v[124:127], v251 offset:37888
v_pk_mul_f16 v173, v172, v173
v_mfma_f32_16x16x32_bf16 v[0:3], v[184:187], v[52:55], 0
v_pk_mul_f16 v175, v174, v175
v_cvt_pkrtz_f16_f32 v176, v176, v177
v_mfma_f32_16x16x32_f16 v[84:87], v[160:163], v[20:23], v[84:87]
v_cvt_pkrtz_f16_f32 v177, v178, v179
v_lshrrev_b64 v[176:177], 2, v[176:177]
v_mfma_f32_16x16x32_f16 v[140:143], v[160:163], v[16:19], v[140:143]
ds_read_b128 v[160:163], v252 offset:7168
v_and_b32_sdwa v178, s47, v176 dst_sel:DWORD dst_unused:UNUSED_PAD src0_sel:DWORD src1_sel:WORD_1
s_waitcnt lgkmcnt(7)
v_mfma_f32_16x16x32_f16 v[88:91], v[120:123], v[20:23], v[88:91]
v_and_b32 v176, s47, v176
v_exp_f16_sdwa v173, v173 dst_sel:WORD_0 dst_unused:UNUSED_PRESERVE src0_sel:WORD_0
v_mfma_f32_16x16x32_bf16 v[4:7], v[184:187], v[24:27], 0
ds_read_b128 v[184:187], v248 offset:8448
ds_read_u16_d16_hi v178, v178
v_mfma_f32_16x16x32_f16 v[240:243], v[120:123], v[16:19], v[240:243]
ds_read_b128 v[120:123], v252 offset:5120
ds_read_u16 v176, v176
s_waitcnt lgkmcnt(8)
v_mfma_f32_16x16x32_f16 v[72:75], v[188:191], v[100:103], v[72:75]
s_setprio 1
v_exp_f16_sdwa v175, v175 dst_sel:WORD_0 dst_unused:UNUSED_PRESERVE src0_sel:WORD_0
v_mfma_f32_16x16x32_f16 v[128:131], v[188:191], v[96:99], v[128:131]
ds_read_b128 v[188:191], v252 offset:6144
v_and_b32_sdwa v179, s47, v177 dst_sel:DWORD dst_unused:UNUSED_PAD src0_sel:DWORD src1_sel:WORD_1
s_waitcnt lgkmcnt(6)
v_mfma_f32_16x16x32_f16 v[92:95], v[124:127], v[20:23], v[92:95]
v_mov_b32 v20, 0
v_mov_b32_e64 v21, 0
v_mfma_f32_16x16x32_f16 v[244:247], v[124:127], v[16:19], v[244:247]
ds_read_b128 v[124:127], v252 offset:8192
v_mov_b32 v16, 0
s_waitcnt lgkmcnt(5)
v_mfma_f32_16x16x32_bf16 v[180:183], v[184:187], v[56:59], v[180:183]
v_mov_b32_e64 v17, 0
v_cndmask_b32 v18, 0, v255, s[88:89]
v_cndmask_b32 v19, 0, v255, s[90:91]
v_mfma_f32_16x16x32_bf16 v[0:3], v[184:187], v[60:63], v[0:3]
v_and_b32 v177, s47, v177
v_exp_f16_sdwa v173, v173 dst_sel:WORD_1 dst_unused:UNUSED_PRESERVE src0_sel:WORD_1
v_mfma_f32_16x16x32_f16 v[76:79], v[160:163], v[100:103], v[76:79]
ds_read_u16_d16_hi v179, v179
ds_read_u16 v177, v177
v_mfma_f32_16x16x32_f16 v[132:135], v[160:163], v[96:99], v[132:135]
ds_read_b128 v[160:163], v252 offset:9216
v_exp_f16_sdwa v175, v175 dst_sel:WORD_1 dst_unused:UNUSED_PRESERVE src0_sel:WORD_1
s_waitcnt lgkmcnt(6)
v_mfma_f32_16x16x32_f16 v[80:83], v[120:123], v[100:103], v[80:83]
v_pk_add_f16 v173, v173, 1.0 op_sel_hi:[1,0]
v_pk_add_f16 v175, v175, 1.0 op_sel_hi:[1,0]
v_mfma_f32_16x16x32_bf16 v[4:7], v[184:187], v[32:35], v[4:7]
ds_read_b128 v[184:187], v248 offset:10496
v_rcp_f16_sdwa v173, v173 dst_sel:WORD_0 dst_unused:UNUSED_PRESERVE src0_sel:WORD_0
v_mfma_f32_16x16x32_f16 v[136:139], v[120:123], v[96:99], v[136:139]
ds_read_b128 v[120:123], v252 offset:10240
v_rcp_f16_sdwa v175, v175 dst_sel:WORD_0 dst_unused:UNUSED_PRESERVE src0_sel:WORD_0
s_waitcnt lgkmcnt(5)
v_mfma_f32_16x16x32_f16 v[84:87], v[124:127], v[100:103], v[84:87]
v_rcp_f16_sdwa v173, v173 dst_sel:WORD_1 dst_unused:UNUSED_PRESERVE src0_sel:WORD_1
v_mfma_f32_16x16x32_f16 v[140:143], v[124:127], v[96:99], v[140:143]
ds_read_b128 v[124:127], v252 offset:13312
v_rcp_f16_sdwa v175, v175 dst_sel:WORD_1 dst_unused:UNUSED_PRESERVE src0_sel:WORD_1
v_mfma_f32_16x16x32_f16 v[88:91], v[188:191], v[100:103], v[88:91]
v_mfma_f32_16x16x32_f16 v[240:243], v[188:191], v[96:99], v[240:243]
ds_read_b128 v[188:191], v248 offset:12288
s_waitcnt lgkmcnt(3)
v_mfma_f32_16x16x32_bf16 v[180:183], v[184:187], v[64:67], v[180:183]
v_mfma_f32_16x16x32_f16 v[92:95], v[160:163], v[100:103], v[92:95]
v_pk_mul_f16 v172, v172, v173
v_mfma_f32_16x16x32_bf16 v[0:3], v[184:187], v[68:71], v[0:3]
s_nop 4
v_cvt_pk_f16_f32 v180, v180, v181
v_mfma_f32_16x16x32_f16 v[244:247], v[160:163], v[96:99], v[244:247]
ds_read_b128 v[160:163], v252 offset:14336
v_cvt_pk_f16_f32 v182, v182, v183
s_waitcnt lgkmcnt(3)
v_mfma_f32_16x16x32_f16 v[72:75], v[120:123], v[108:111], v[72:75]
v_pk_fma_f16 v181, v180, v180, s48
v_cvt_pkrtz_f16_f32 v0, v0, v1
v_mfma_f32_16x16x32_f16 v[128:131], v[120:123], v[104:107], v[128:131]
ds_read_b128 v[120:123], v252 offset:12288
v_cvt_pkrtz_f16_f32 v1, v2, v3
v_mfma_f32_16x16x32_bf16 v[4:7], v[184:187], v[40:43], v[4:7]
ds_read_b128 v[184:187], v252 offset:11264
v_lshrrev_b64 v[0:1], 2, v[0:1]
s_waitcnt lgkmcnt(3)
v_mfma_f32_16x16x32_f16 v[76:79], v[124:127], v[108:111], v[76:79]
v_and_b32_sdwa v2, s47, v0 dst_sel:DWORD dst_unused:UNUSED_PAD src0_sel:DWORD src1_sel:WORD_1
v_and_b32 v0, s47, v0
v_mfma_f32_16x16x32_f16 v[132:135], v[124:127], v[104:107], v[132:135]
ds_read_b128 v[124:127], v252 offset:15360
s_setprio 0
ds_read_u16_d16_hi v2, v2
v_mfma_f32_16x16x32_bf16 v[8:11], v[188:191], v[48:51], 0
ds_read_u16 v0, v0
v_and_b32_sdwa v3, s47, v1 dst_sel:DWORD dst_unused:UNUSED_PAD src0_sel:DWORD src1_sel:WORD_1
s_waitcnt lgkmcnt(5)
v_mfma_f32_16x16x32_f16 v[84:87], v[160:163], v[108:111], v[84:87]
v_and_b32 v1, s47, v1
v_pk_fma_f16 v183, v182, v182, s48
v_mfma_f32_16x16x32_f16 v[140:143], v[160:163], v[104:107], v[140:143]
ds_read_b128 v[160:163], v251 offset:41984
ds_read_u16_d16_hi v3, v3
s_waitcnt lgkmcnt(5)
v_mfma_f32_16x16x32_f16 v[80:83], v[184:187], v[108:111], v[80:83]
ds_read_u16 v1, v1
v_pk_mul_f16 v181, v180, v181
v_mfma_f32_16x16x32_f16 v[136:139], v[184:187], v[104:107], v[136:139]
ds_read_b128 v[184:187], v251 offset:38912
v_pk_mul_f16 v183, v182, v183
v_mfma_f32_16x16x32_bf16 v[12:15], v[188:191], v[52:55], 0
v_cvt_pkrtz_f16_f32 v4, v4, v5
v_cvt_pkrtz_f16_f32 v5, v6, v7
v_mfma_f32_16x16x32_f16 v[88:91], v[120:123], v[108:111], v[88:91]
v_lshrrev_b64 v[4:5], 2, v[4:5]
v_and_b32_sdwa v6, s47, v4 dst_sel:DWORD dst_unused:UNUSED_PAD src0_sel:DWORD src1_sel:WORD_1
v_mfma_f32_16x16x32_f16 v[240:243], v[120:123], v[104:107], v[240:243]
ds_read_b128 v[120:123], v251 offset:39936
v_and_b32 v4, s47, v4
s_waitcnt lgkmcnt(7)
v_mfma_f32_16x16x32_f16 v[92:95], v[124:127], v[108:111], v[92:95]
ds_read_u16_d16_hi v6, v6
ds_read_u16 v4, v4
v_mfma_f32_16x16x32_bf16 v[96:99], v[188:191], v[24:27], 0
ds_read_b128 v[188:191], v248 offset:14336
v_pk_mul_f16 v173, v174, v175
v_mfma_f32_16x16x32_f16 v[244:247], v[124:127], v[104:107], v[244:247]
ds_read_b128 v[124:127], v251 offset:43008
buffer_load_dwordx4 v[100:103], v253, s[4:7], s71 offen offset:128
buffer_load_dwordx4 v[104:107], v253, s[4:7], s71 offen offset:192
s_waitcnt lgkmcnt(8)
v_mfma_f32_16x16x32_f16 v[76:79], v[160:163], v[196:199], v[76:79]
v_exp_f16_sdwa v181, v181 dst_sel:WORD_0 dst_unused:UNUSED_PRESERVE src0_sel:WORD_0
v_mfma_f32_16x16x32_f16 v[132:135], v[160:163], v[192:195], v[132:135]
ds_read_b128 v[160:163], v251 offset:44032
v_lshl_add_u64 v[156:157], v[156:157], 0, v[158:159]
s_waitcnt lgkmcnt(6)
v_mfma_f32_16x16x32_f16 v[72:75], v[184:187], v[196:199], v[72:75]
v_exp_f16_sdwa v183, v183 dst_sel:WORD_0 dst_unused:UNUSED_PRESERVE src0_sel:WORD_0
v_mfma_f32_16x16x32_f16 v[128:131], v[184:187], v[192:195], v[128:131]
ds_read_b128 v[184:187], v251 offset:40960
v_and_b32_sdwa v7, s47, v5 dst_sel:DWORD dst_unused:UNUSED_PAD src0_sel:DWORD src1_sel:WORD_1
s_waitcnt lgkmcnt(6)
v_mfma_f32_16x16x32_f16 v[80:83], v[120:123], v[196:199], v[80:83]
v_and_b32 v5, s47, v5
v_exp_f16_sdwa v181, v181 dst_sel:WORD_1 dst_unused:UNUSED_PRESERVE src0_sel:WORD_1
v_mfma_f32_16x16x32_f16 v[136:139], v[120:123], v[192:195], v[136:139]
ds_read_b128 v[120:123], v251 offset:45056
ds_read_u16_d16_hi v7, v7
ds_read_u16 v5, v5
s_waitcnt lgkmcnt(6)
v_mfma_f32_16x16x32_bf16 v[8:11], v[188:191], v[56:59], v[8:11]
v_lshl_add_u64 v[176:177], v[176:177], 0, v[178:179]
v_exp_f16_sdwa v183, v183 dst_sel:WORD_1 dst_unused:UNUSED_PRESERVE src0_sel:WORD_1
v_mfma_f32_16x16x32_bf16 v[12:15], v[188:191], v[60:63], v[12:15]
v_pk_add_f16 v181, v181, 1.0 op_sel_hi:[1,0]
v_pk_add_f16 v183, v183, 1.0 op_sel_hi:[1,0]
s_waitcnt lgkmcnt(5)
v_mfma_f32_16x16x32_f16 v[84:87], v[124:127], v[196:199], v[84:87]
v_rcp_f16_sdwa v181, v181 dst_sel:WORD_0 dst_unused:UNUSED_PRESERVE src0_sel:WORD_0
v_mfma_f32_16x16x32_f16 v[140:143], v[124:127], v[192:195], v[140:143]
ds_read_b128 v[124:127], v251 offset:48128
v_rcp_f16_sdwa v183, v183 dst_sel:WORD_0 dst_unused:UNUSED_PRESERVE src0_sel:WORD_0
v_mfma_f32_16x16x32_bf16 v[96:99], v[188:191], v[32:35], v[96:99]
ds_read_b128 v[188:191], v248 offset:16384
v_rcp_f16_sdwa v181, v181 dst_sel:WORD_1 dst_unused:UNUSED_PRESERVE src0_sel:WORD_1
s_waitcnt lgkmcnt(5)
v_mfma_f32_16x16x32_f16 v[88:91], v[184:187], v[196:199], v[88:91]
s_setprio 3
v_mfma_f32_16x16x32_f16 v[240:243], v[184:187], v[192:195], v[240:243]
ds_read_b128 v[184:187], v251 offset:46080
v_rcp_f16_sdwa v183, v183 dst_sel:WORD_1 dst_unused:UNUSED_PRESERVE src0_sel:WORD_1
v_mfma_f32_16x16x32_f16 v[92:95], v[160:163], v[196:199], v[92:95]
v_mfma_f32_16x16x32_f16 v[244:247], v[160:163], v[192:195], v[244:247]
ds_read_b128 v[160:163], v248 offset:12544
s_waitcnt lgkmcnt(4)
v_mfma_f32_16x16x32_f16 v[72:75], v[120:123], v[204:207], v[72:75]
s_waitcnt lgkmcnt(2)
v_mfma_f32_16x16x32_bf16 v[8:11], v[188:191], v[64:67], v[8:11]
v_pk_mul_f16 v174, v180, v181
v_mfma_f32_16x16x32_bf16 v[12:15], v[188:191], v[68:71], v[12:15]
v_mfma_f32_16x16x32_f16 v[128:131], v[120:123], v[200:203], v[128:131]
ds_read_b128 v[120:123], v251 offset:47104
v_pk_mul_f16 v175, v182, v183
v_mfma_f32_16x16x32_f16 v[76:79], v[124:127], v[204:207], v[76:79]
s_nop 1
v_cvt_pkrtz_f16_f32 v8, v8, v9
v_cvt_pkrtz_f16_f32 v9, v10, v11
v_mfma_f32_16x16x32_f16 v[132:135], v[124:127], v[200:203], v[132:135]
ds_read_b128 v[124:127], v251 offset:50176
v_lshrrev_b64 v[8:9], 2, v[8:9]
v_mfma_f32_16x16x32_bf16 v[96:99], v[188:191], v[40:43], v[96:99]
ds_read_b128 v[188:191], v251 offset:49152
v_and_b32_sdwa v10, s47, v8 dst_sel:DWORD dst_unused:UNUSED_PAD src0_sel:DWORD src1_sel:WORD_1
s_waitcnt lgkmcnt(3)
v_mfma_f32_16x16x32_f16 v[80:83], v[184:187], v[204:207], v[80:83]
v_and_b32_e64 v8, s47, v8
v_and_b32_sdwa v11, s47, v9 dst_sel:DWORD dst_unused:UNUSED_PAD src0_sel:DWORD src1_sel:WORD_1
v_mfma_f32_16x16x32_f16 v[136:139], v[184:187], v[200:203], v[136:139]
ds_read_b128 v[184:187], v251 offset:51200
ds_read_u16_d16_hi v10, v10
v_mfma_f32_16x16x32_bf16 v[108:111], v[160:163], v[48:51], 0
ds_read_u16 v8, v8
v_and_b32_e64 v9, s47, v9
s_waitcnt lgkmcnt(5)
v_mfma_f32_16x16x32_f16 v[88:91], v[120:123], v[204:207], v[88:91]
ds_read_u16_d16_hi v11, v11
ds_read_u16 v9, v9
v_mfma_f32_16x16x32_f16 v[240:243], v[120:123], v[200:203], v[240:243]
ds_read_b128 v[120:123], v251 offset:52224
v_cvt_pkrtz_f16_f32 v12, v12, v13
s_waitcnt lgkmcnt(6)
v_mfma_f32_16x16x32_f16 v[84:87], v[188:191], v[204:207], v[84:87]
v_cvt_pkrtz_f16_f32 v13, v14, v15
v_lshrrev_b64 v[12:13], 2, v[12:13]
v_mfma_f32_16x16x32_f16 v[140:143], v[188:191], v[200:203], v[140:143]
ds_read_b128 v[188:191], v251 offset:54272
v_and_b32_sdwa v14, s47, v12 dst_sel:DWORD dst_unused:UNUSED_PAD src0_sel:DWORD src1_sel:WORD_1
v_mfma_f32_16x16x32_bf16 v[192:195], v[160:163], v[52:55], 0
v_and_b32_e64 v12, s47, v12
v_and_b32_sdwa v15, s47, v13 dst_sel:DWORD dst_unused:UNUSED_PAD src0_sel:DWORD src1_sel:WORD_1
v_mfma_f32_16x16x32_f16 v[92:95], v[124:127], v[204:207], v[92:95]
ds_read_u16_d16_hi v14, v14
ds_read_u16 v12, v12
v_mfma_f32_16x16x32_f16 v[244:247], v[124:127], v[200:203], v[244:247]
ds_read_b128 v[124:127], v251 offset:55296
buffer_load_dwordx4 v[200:203], v253, s[4:7], s71 offen offset:256
buffer_load_dwordx4 v[204:207], v253, s[4:7], s71 offen offset:320
s_waitcnt lgkmcnt(9)
v_mfma_f32_16x16x32_f16 v[72:75], v[184:187], v[212:215], v[72:75]
v_and_b32 v13, s47, v13
v_lshl_add_u64 v[158:159], v[0:1], 0, v[2:3]
v_mfma_f32_16x16x32_bf16 v[196:199], v[160:163], v[24:27], 0
ds_read_b128 v[160:163], v248 offset:14592
ds_read_u16_d16_hi v15, v15
v_mfma_f32_16x16x32_f16 v[128:131], v[184:187], v[208:211], v[128:131]
ds_read_b128 v[184:187], v248 offset:16640
s_setprio 2
ds_read_u16 v13, v13
v_cvt_pkrtz_f16_f32 v96, v96, v97
v_cvt_pkrtz_f16_f32 v97, v98, v99
v_lshrrev_b64 v[96:97], 2, v[96:97]
s_waitcnt lgkmcnt(8)
v_mfma_f32_16x16x32_f16 v[80:83], v[120:123], v[212:215], v[80:83]
v_and_b32_sdwa v98, s47, v96 dst_sel:DWORD dst_unused:UNUSED_PAD src0_sel:DWORD src1_sel:WORD_1
v_and_b32 v96, s47, v96
s_waitcnt lgkmcnt(7)
v_mfma_f32_16x16x32_f16 v[76:79], v[188:191], v[212:215], v[76:79]
ds_read_u16_d16_hi v98, v98
ds_read_u16 v96, v96
v_mfma_f32_16x16x32_f16 v[132:135], v[188:191], v[208:211], v[132:135]
ds_read_b128 v[188:191], v251 offset:53248
v_and_b32_sdwa v99, s47, v97 dst_sel:DWORD dst_unused:UNUSED_PAD src0_sel:DWORD src1_sel:WORD_1
v_mfma_f32_16x16x32_f16 v[136:139], v[120:123], v[208:211], v[136:139]
ds_read_b128 v[120:123], v251 offset:57344
v_and_b32_e64 v97, s47, v97
v_lshl_add_u64 v[178:179], v[4:5], 0, v[6:7]
ds_read_u16_d16_hi v99, v99
ds_read_u16 v97, v97
s_waitcnt lgkmcnt(10)
v_mfma_f32_16x16x32_f16 v[84:87], v[124:127], v[212:215], v[84:87]
s_waitcnt lgkmcnt(9)
v_mfma_f32_16x16x32_bf16 v[108:111], v[160:163], v[56:59], v[108:111]
v_mfma_f32_16x16x32_bf16 v[192:195], v[160:163], v[60:63], v[192:195]
v_mfma_f32_16x16x32_bf16 v[196:199], v[160:163], v[32:35], v[196:199]
ds_read_b128 v[160:163], v251 offset:56320
v_mfma_f32_16x16x32_f16 v[140:143], v[124:127], v[208:211], v[140:143]
ds_read_b128 v[124:127], v248 offset:18432
s_waitcnt lgkmcnt(9)
v_mfma_f32_16x16x32_bf16 v[108:111], v[184:187], v[64:67], v[108:111]
v_mfma_f32_16x16x32_bf16 v[192:195], v[184:187], v[68:71], v[192:195]
v_mfma_f32_16x16x32_bf16 v[196:199], v[184:187], v[40:43], v[196:199]
ds_read_b128 v[184:187], v251 offset:60416
s_nop 4
v_cvt_pk_f16_f32 v108, v108, v109
v_cvt_pk_f16_f32 v110, v110, v111
v_pk_fma_f16 v109, v108, v108, s48
v_pk_fma_f16 v111, v110, v110, s48
v_cvt_pkrtz_f16_f32 v192, v192, v193
v_cvt_pkrtz_f16_f32 v193, v194, v195
s_waitcnt lgkmcnt(6)
v_mfma_f32_16x16x32_f16 v[88:91], v[188:191], v[212:215], v[88:91]
v_lshrrev_b64 v[192:193], 2, v[192:193]
v_and_b32_sdwa v194, s47, v192 dst_sel:DWORD dst_unused:UNUSED_PAD src0_sel:DWORD src1_sel:WORD_1
v_mfma_f32_16x16x32_f16 v[240:243], v[188:191], v[208:211], v[240:243]
ds_read_b128 v[188:191], v251 offset:58368
v_and_b32 v192, s47, v192
s_waitcnt lgkmcnt(6)
v_mfma_f32_16x16x32_f16 v[72:75], v[120:123], v[228:231], v[72:75]
s_setprio 1
ds_read_u16_d16_hi v194, v194
ds_read_u16 v192, v192
v_mfma_f32_16x16x32_f16 v[128:131], v[120:123], v[224:227], v[128:131]
ds_read_b128 v[120:123], v248 offset:20480
v_and_b32_sdwa v195, s47, v193 dst_sel:DWORD dst_unused:UNUSED_PAD src0_sel:DWORD src1_sel:WORD_1
v_and_b32 v193, s47, v193
v_pk_mul_f16 v109, v108, v109
v_pk_mul_f16 v111, v110, v111
s_waitcnt lgkmcnt(6)
v_mfma_f32_16x16x32_f16 v[92:95], v[160:163], v[212:215], v[92:95]
ds_read_u16_d16_hi v195, v195
ds_read_u16 v193, v193
v_mfma_f32_16x16x32_f16 v[244:247], v[160:163], v[208:211], v[244:247]
ds_read_b128 v[160:163], v251 offset:61440
v_cvt_pkrtz_f16_f32 v196, v196, v197
s_waitcnt lgkmcnt(8)
v_mfma_f32_16x16x32_bf16 v[208:211], v[124:127], v[48:51], 0
v_cvt_pkrtz_f16_f32 v197, v198, v199
v_lshrrev_b64 v[196:197], 2, v[196:197]
s_waitcnt lgkmcnt(7)
v_mfma_f32_16x16x32_f16 v[76:79], v[184:187], v[228:231], v[76:79]
v_and_b32_sdwa v198, s47, v196 dst_sel:DWORD dst_unused:UNUSED_PAD src0_sel:DWORD src1_sel:WORD_1
v_and_b32 v196, s47, v196
v_mfma_f32_16x16x32_bf16 v[212:215], v[124:127], v[52:55], 0
ds_read_u16_d16_hi v198, v198
ds_read_u16 v196, v196
v_mfma_f32_16x16x32_f16 v[132:135], v[184:187], v[224:227], v[132:135]
ds_read_b128 v[184:187], v251 offset:62464
v_lshl_add_u64 v[8:9], v[8:9], 0, v[10:11]
s_waitcnt lgkmcnt(9)
v_mfma_f32_16x16x32_f16 v[80:83], v[188:191], v[228:231], v[80:83]
v_exp_f16_sdwa v109, v109 dst_sel:WORD_0 dst_unused:UNUSED_PRESERVE src0_sel:WORD_0
v_mfma_f32_16x16x32_bf16 v[180:183], v[124:127], v[24:27], 0
ds_read_b128 v[124:127], v251 offset:59392
v_exp_f16_sdwa v111, v111 dst_sel:WORD_0 dst_unused:UNUSED_PRESERVE src0_sel:WORD_0
v_mfma_f32_16x16x32_f16 v[136:139], v[188:191], v[224:227], v[136:139]
ds_read_b128 v[188:191], v248 offset:22528
v_and_b32_sdwa v199, s47, v197 dst_sel:DWORD dst_unused:UNUSED_PAD src0_sel:DWORD src1_sel:WORD_1
s_waitcnt lgkmcnt(8)
v_mfma_f32_16x16x32_bf16 v[208:211], v[120:123], v[56:59], v[208:211]
v_and_b32 v197, s47, v197
v_lshl_add_u64 v[12:13], v[12:13], 0, v[14:15]
v_mfma_f32_16x16x32_bf16 v[212:215], v[120:123], v[60:63], v[212:215]
ds_read_u16_d16_hi v199, v199
ds_read_u16 v197, v197
s_waitcnt lgkmcnt(7)
v_mfma_f32_16x16x32_f16 v[84:87], v[160:163], v[228:231], v[84:87]
v_exp_f16_sdwa v109, v109 dst_sel:WORD_1 dst_unused:UNUSED_PRESERVE src0_sel:WORD_1
v_mfma_f32_16x16x32_f16 v[140:143], v[160:163], v[224:227], v[140:143]
ds_read_b128 v[160:163], v251 offset:8192
v_exp_f16_sdwa v111, v111 dst_sel:WORD_1 dst_unused:UNUSED_PRESERVE src0_sel:WORD_1
v_mfma_f32_16x16x32_bf16 v[180:183], v[120:123], v[32:35], v[180:183]
ds_read_b128 v[120:123], v251 offset:11264
v_lshl_add_u64 v[96:97], v[96:97], 0, v[98:99]
s_waitcnt lgkmcnt(6)
v_mfma_f32_16x16x32_f16 v[92:95], v[184:187], v[228:231], v[92:95]
s_setprio 0
v_pk_add_f16 v109, v109, 1.0 op_sel_hi:[1,0]
v_pk_add_f16 v111, v111, 1.0 op_sel_hi:[1,0]
s_waitcnt lgkmcnt(5)
v_mfma_f32_16x16x32_f16 v[88:91], v[124:127], v[228:231], v[88:91]
v_rcp_f16_sdwa v109, v109 dst_sel:WORD_0 dst_unused:UNUSED_PRESERVE src0_sel:WORD_0
v_mfma_f32_16x16x32_f16 v[240:243], v[124:127], v[224:227], v[240:243]
ds_read_b128 v[124:127], v251 offset:9216
v_rcp_f16_sdwa v111, v111 dst_sel:WORD_0 dst_unused:UNUSED_PRESERVE src0_sel:WORD_0
v_mfma_f32_16x16x32_f16 v[244:247], v[184:187], v[224:227], v[244:247]
ds_read_b128 v[184:187], v248 offset:18688
v_rcp_f16_sdwa v109, v109 dst_sel:WORD_1 dst_unused:UNUSED_PRESERVE src0_sel:WORD_1
s_waitcnt lgkmcnt(6)
v_mfma_f32_16x16x32_bf16 v[208:211], v[188:191], v[64:67], v[208:211]
v_rcp_f16_sdwa v111, v111 dst_sel:WORD_1 dst_unused:UNUSED_PRESERVE src0_sel:WORD_1
s_waitcnt lgkmcnt(3)
v_mfma_f32_16x16x32_f16 v[72:75], v[160:163], v[116:119], v[72:75]
v_mfma_f32_16x16x32_f16 v[128:131], v[160:163], v[112:115], v[128:131]
ds_read_b128 v[160:163], v251 offset:10240
s_nop 2
v_cvt_pk_f16_f32 v208, v208, v209
v_mfma_f32_16x16x32_bf16 v[212:215], v[188:191], v[68:71], v[212:215]
v_cvt_pk_f16_f32 v210, v210, v211
v_pk_fma_f16 v209, v208, v208, s48
s_waitcnt lgkmcnt(3)
v_mfma_f32_16x16x32_f16 v[76:79], v[120:123], v[116:119], v[76:79]
v_pk_fma_f16 v211, v210, v210, s48
v_pk_mul_f16 v209, v208, v209
v_mfma_f32_16x16x32_f16 v[132:135], v[120:123], v[112:115], v[132:135]
ds_read_b128 v[120:123], v251 offset:13312
v_cvt_pkrtz_f16_f32 v212, v212, v213
v_mfma_f32_16x16x32_bf16 v[180:183], v[188:191], v[40:43], v[180:183]
ds_read_b128 v[188:191], v251 offset:12288
v_cvt_pkrtz_f16_f32 v213, v214, v215
s_waitcnt lgkmcnt(3)
v_mfma_f32_16x16x32_f16 v[80:83], v[124:127], v[116:119], v[80:83]
v_lshrrev_b64 v[212:213], 2, v[212:213]
v_and_b32_sdwa v214, s47, v212 dst_sel:DWORD dst_unused:UNUSED_PAD src0_sel:DWORD src1_sel:WORD_1
v_mfma_f32_16x16x32_bf16 v[0:3], v[184:187], v[48:51], 0
v_and_b32 v212, s47, v212
v_and_b32_sdwa v215, s47, v213 dst_sel:DWORD dst_unused:UNUSED_PAD src0_sel:DWORD src1_sel:WORD_1
v_mfma_f32_16x16x32_f16 v[136:139], v[124:127], v[112:115], v[136:139]
ds_read_b128 v[124:127], v248 offset:20736
ds_read_u16_d16_hi v214, v214
v_mfma_f32_16x16x32_bf16 v[4:7], v[184:187], v[52:55], 0
ds_read_u16 v212, v212
v_and_b32 v213, s47, v213
s_waitcnt lgkmcnt(5)
v_mfma_f32_16x16x32_f16 v[88:91], v[160:163], v[116:119], v[88:91]
ds_read_u16_d16_hi v215, v215
ds_read_u16 v213, v213
s_waitcnt lgkmcnt(5)
v_mfma_f32_16x16x32_f16 v[84:87], v[188:191], v[116:119], v[84:87]
v_pk_mul_f16 v10, v108, v109
v_pk_mul_f16 v211, v210, v211
v_mfma_f32_16x16x32_f16 v[140:143], v[188:191], v[112:115], v[140:143]
ds_read_b128 v[188:191], v251 offset:17408
s_setprio 3
v_cvt_pkrtz_f16_f32 v180, v180, v181
v_mfma_f32_16x16x32_bf16 v[224:227], v[184:187], v[24:27], 0
ds_read_b128 v[184:187], v251 offset:14336
v_cvt_pkrtz_f16_f32 v181, v182, v183
v_mfma_f32_16x16x32_f16 v[240:243], v[160:163], v[112:115], v[240:243]
ds_read_b128 v[160:163], v248 offset:22784
v_lshrrev_b64 v[180:181], 2, v[180:181]
v_mfma_f32_16x16x32_f16 v[92:95], v[120:123], v[116:119], v[92:95]
v_and_b32_sdwa v182, s47, v180 dst_sel:DWORD dst_unused:UNUSED_PAD src0_sel:DWORD src1_sel:WORD_1
v_and_b32 v180, s47, v180
s_waitcnt lgkmcnt(7)
v_mfma_f32_16x16x32_bf16 v[0:3], v[124:127], v[56:59], v[0:3]
ds_read_u16_d16_hi v182, v182
ds_read_u16 v180, v180
v_mfma_f32_16x16x32_f16 v[244:247], v[120:123], v[112:115], v[244:247]
ds_read_b128 v[120:123], v251 offset:15360
v_pk_mul_f16 v11, v110, v111
s_waitcnt vmcnt(5)
v_mfma_f32_16x16x32_bf16 v[128:131], v[18:21], v[164:167], v[128:131]
v_exp_f16_sdwa v209, v209 dst_sel:WORD_0 dst_unused:UNUSED_PRESERVE src0_sel:WORD_0
v_mfma_f32_16x16x32_bf16 v[132:135], v[16:19], v[164:167], v[132:135]
v_lshl_add_u64 v[14:15], v[192:193], 0, v[194:195]
v_exp_f16_sdwa v211, v211 dst_sel:WORD_0 dst_unused:UNUSED_PRESERVE src0_sel:WORD_0
s_waitcnt vmcnt(4)
v_mfma_f32_16x16x32_bf16 v[136:139], v[18:21], v[168:171], v[136:139]
v_and_b32_sdwa v183, s47, v181 dst_sel:DWORD dst_unused:UNUSED_PAD src0_sel:DWORD src1_sel:WORD_1
v_and_b32 v181, s47, v181
v_mfma_f32_16x16x32_bf16 v[140:143], v[16:19], v[168:171], v[140:143]
ds_read_u16_d16_hi v183, v183
ds_read_u16 v181, v181
s_waitcnt lgkmcnt(6)
v_mfma_f32_16x16x32_f16 v[72:75], v[184:187], v[220:223], v[72:75]
v_exp_f16_sdwa v209, v209 dst_sel:WORD_1 dst_unused:UNUSED_PRESERVE src0_sel:WORD_1
v_mfma_f32_16x16x32_bf16 v[4:7], v[124:127], v[60:63], v[4:7]
v_lshl_add_u64 v[98:99], v[196:197], 0, v[198:199]
v_exp_f16_sdwa v211, v211 dst_sel:WORD_1 dst_unused:UNUSED_PRESERVE src0_sel:WORD_1
v_mfma_f32_16x16x32_f16 v[128:131], v[184:187], v[216:219], v[128:131]
ds_read_b128 v[184:187], v251 offset:16384
v_pk_add_f16 v209, v209, 1.0 op_sel_hi:[1,0]
v_mfma_f32_16x16x32_bf16 v[224:227], v[124:127], v[32:35], v[224:227]
ds_read_b128 v[124:127], v251 offset:18432
v_pk_add_f16 v211, v211, 1.0 op_sel_hi:[1,0]
v_mfma_f32_16x16x32_f16 v[76:79], v[188:191], v[220:223], v[76:79]
v_rcp_f16_sdwa v209, v209 dst_sel:WORD_0 dst_unused:UNUSED_PRESERVE src0_sel:WORD_0
v_mfma_f32_16x16x32_f16 v[132:135], v[188:191], v[216:219], v[132:135]
ds_read_b128 v[188:191], v248 offset:24576
v_rcp_f16_sdwa v211, v211 dst_sel:WORD_0 dst_unused:UNUSED_PRESERVE src0_sel:WORD_0
s_waitcnt lgkmcnt(5)
v_mfma_f32_16x16x32_bf16 v[0:3], v[160:163], v[64:67], v[0:3]
v_rcp_f16_sdwa v209, v209 dst_sel:WORD_1 dst_unused:UNUSED_PRESERVE src0_sel:WORD_1
v_mfma_f32_16x16x32_f16 v[80:83], v[120:123], v[220:223], v[80:83]
v_rcp_f16_sdwa v211, v211 dst_sel:WORD_1 dst_unused:UNUSED_PRESERVE src0_sel:WORD_1
v_mfma_f32_16x16x32_f16 v[136:139], v[120:123], v[216:219], v[136:139]
ds_read_b128 v[120:123], v251 offset:63488
s_nop 2
v_cvt_pkrtz_f16_f32 v0, v0, v1
v_mfma_f32_16x16x32_bf16 v[4:7], v[160:163], v[68:71], v[4:7]
v_cvt_pkrtz_f16_f32 v1, v2, v3
v_lshrrev_b64 v[0:1], 2, v[0:1]
s_waitcnt lgkmcnt(2)
v_mfma_f32_16x16x32_f16 v[84:87], v[124:127], v[220:223], v[84:87]
s_setprio 2
v_and_b32_sdwa v2, s47, v0 dst_sel:DWORD dst_unused:UNUSED_PAD src0_sel:DWORD src1_sel:WORD_1
v_and_b32_e64 v0, s47, v0
v_mfma_f32_16x16x32_f16 v[140:143], v[124:127], v[216:219], v[140:143]
ds_read_b128 v[124:127], v252 offset:1024
ds_read_u16_d16_hi v2, v2
v_mfma_f32_16x16x32_bf16 v[224:227], v[160:163], v[40:43], v[224:227]
ds_read_b128 v[160:163], v251 offset:19456
ds_read_u16 v0, v0
v_mfma_f32_16x16x32_f16 v[88:91], v[184:187], v[220:223], v[88:91]
v_and_b32_sdwa v3, s47, v1 dst_sel:DWORD dst_unused:UNUSED_PAD src0_sel:DWORD src1_sel:WORD_1
v_and_b32_e64 v1, s47, v1
v_mfma_f32_16x16x32_f16 v[240:243], v[184:187], v[216:219], v[240:243]
ds_read_b128 v[184:187], v248 offset:26624
ds_read_u16_d16_hi v3, v3
s_waitcnt lgkmcnt(7)
v_mfma_f32_16x16x32_bf16 v[228:231], v[188:191], v[48:51], 0
ds_read_u16 v1, v1
v_cvt_pkrtz_f16_f32 v4, v4, v5
v_mfma_f32_16x16x32_bf16 v[112:115], v[188:191], v[52:55], 0
v_cvt_pkrtz_f16_f32 v5, v6, v7
v_lshrrev_b64 v[4:5], 2, v[4:5]
s_waitcnt vmcnt(3)
v_mfma_f32_16x16x32_bf16 v[240:243], v[18:21], v[100:103], v[240:243]
v_and_b32_sdwa v6, s47, v4 dst_sel:DWORD dst_unused:UNUSED_PAD src0_sel:DWORD src1_sel:WORD_1
v_and_b32 v4, s47, v4
s_waitcnt vmcnt(2)
v_mfma_f32_16x16x32_bf16 v[72:75], v[18:21], v[104:107], v[72:75]
ds_read_u16_d16_hi v6, v6
ds_read_u16 v4, v4
v_mfma_f32_16x16x32_bf16 v[76:79], v[16:19], v[104:107], v[76:79]
v_pk_mul_f16 v208, v208, v209
v_and_b32_sdwa v7, s47, v5 dst_sel:DWORD dst_unused:UNUSED_PAD src0_sel:DWORD src1_sel:WORD_1
s_waitcnt lgkmcnt(6)
v_mfma_f32_16x16x32_f16 v[92:95], v[160:163], v[220:223], v[92:95]
v_and_b32 v5, s47, v5
v_pk_mul_f16 v209, v210, v211
v_mfma_f32_16x16x32_f16 v[244:247], v[160:163], v[216:219], v[244:247]
ds_read_b128 v[160:163], v252 offset:2048
ds_read_u16_d16_hi v7, v7
v_mfma_f32_16x16x32_bf16 v[244:247], v[16:19], v[100:103], v[244:247]
ds_read_u16 v5, v5
v_lshl_add_u64 v[212:213], v[212:213], 0, v[214:215]
v_mfma_f32_16x16x32_f16 v[72:75], v[120:123], v[236:239], v[72:75]
v_cvt_pkrtz_f16_f32 v224, v224, v225
v_cvt_pkrtz_f16_f32 v225, v226, v227
v_mfma_f32_16x16x32_bf16 v[116:119], v[188:191], v[24:27], 0
ds_read_b128 v[188:191], v251 offset:64512
v_lshrrev_b64 v[224:225], 2, v[224:225]
v_mfma_f32_16x16x32_f16 v[128:131], v[120:123], v[232:235], v[128:131]
ds_read_b128 v[120:123], v248 offset:28672
s_nop 0
v_cvt_pk_bf16_f32 v72, v72, v73
v_mfma_f32_16x16x32_f16 v[76:79], v[124:127], v[236:239], v[76:79]
v_cvt_pk_bf16_f32 v73, v74, v75
v_and_b32_sdwa v226, s47, v224 dst_sel:DWORD dst_unused:UNUSED_PAD src0_sel:DWORD src1_sel:WORD_1
s_waitcnt lgkmcnt(7)
v_mfma_f32_16x16x32_bf16 v[228:231], v[184:187], v[56:59], v[228:231]
v_and_b32_e64 v224, s47, v224
v_cvt_pk_bf16_f32 v128, v128, v129
v_mfma_f32_16x16x32_f16 v[132:135], v[124:127], v[232:235], v[132:135]
ds_read_b128 v[124:127], v252
v_cvt_pk_bf16_f32 v129, v130, v131
v_mfma_f32_16x16x32_bf16 v[112:115], v[184:187], v[60:63], v[112:115]
v_cvt_pk_bf16_f32 v74, v76, v77
v_cvt_pk_bf16_f32 v75, v78, v79
v_mfma_f32_16x16x32_bf16 v[116:119], v[184:187], v[32:35], v[116:119]
ds_read_b128 v[76:79], v254 offset:8208
s_nop 0
v_cvt_pk_bf16_f32 v130, v132, v133
v_cvt_pk_bf16_f32 v131, v134, v135
s_setprio 1
ds_read_b128 v[132:135], v254 offset:8192
ds_read_b128 v[184:187], v252 offset:3072
s_waitcnt lgkmcnt(8)
v_mfma_f32_16x16x32_f16 v[84:87], v[160:163], v[236:239], v[84:87]
ds_read_u16_d16_hi v226, v226
ds_read_u16 v224, v224
s_waitcnt lgkmcnt(7)
v_mfma_f32_16x16x32_f16 v[80:83], v[188:191], v[236:239], v[80:83]
v_and_b32_sdwa v227, s47, v225 dst_sel:DWORD dst_unused:UNUSED_PAD src0_sel:DWORD src1_sel:WORD_1
v_and_b32_e64 v225, s47, v225
v_mfma_f32_16x16x32_f16 v[136:139], v[188:191], v[232:235], v[136:139]
ds_read_b128 v[188:191], v251 offset:8192
ds_read_u16_d16_hi v227, v227
v_mfma_f32_16x16x32_f16 v[140:143], v[160:163], v[232:235], v[140:143]
ds_read_b128 v[160:163], v248 offset:24832
ds_read_u16 v225, v225
s_waitcnt lgkmcnt(10)
v_mfma_f32_16x16x32_bf16 v[228:231], v[120:123], v[64:67], v[228:231]
v_lshl_add_u64 v[180:181], v[180:181], 0, v[182:183]
v_cvt_pk_bf16_f32 v136, v136, v137
v_cvt_pk_bf16_f32 v137, v138, v139
s_waitcnt lgkmcnt(9)
v_mfma_f32_16x16x32_f16 v[88:91], v[124:127], v[236:239], v[88:91]
v_cvt_pk_bf16_f32 v138, v140, v141
v_cvt_pk_bf16_f32 v139, v142, v143
v_mfma_f32_16x16x32_f16 v[240:243], v[124:127], v[232:235], v[240:243]
ds_read_b128 v[140:143], v254 offset:8320
ds_read_b128 v[124:127], v248 offset:26880
v_mfma_f32_16x16x32_bf16 v[112:115], v[120:123], v[68:71], v[112:115]
v_cvt_pk_f16_f32 v228, v228, v229
v_cvt_pk_f16_f32 v230, v230, v231
s_waitcnt lgkmcnt(8)
v_mfma_f32_16x16x32_f16 v[92:95], v[184:187], v[236:239], v[92:95]
v_pk_fma_f16 v229, v228, v228, s48
v_cvt_pk_bf16_f32 v240, v240, v241
v_cvt_pk_bf16_f32 v241, v242, v243
v_mfma_f32_16x16x32_f16 v[244:247], v[184:187], v[232:235], v[244:247]
ds_read_b128 v[184:187], v251 offset:9216
v_cvt_pkrtz_f16_f32 v112, v112, v113
v_mfma_f32_16x16x32_bf16 v[116:119], v[120:123], v[40:43], v[116:119]
ds_read_b128 v[120:123], v251 offset:11264
v_cvt_pkrtz_f16_f32 v113, v114, v115
s_waitcnt vmcnt(1)
v_mfma_f32_16x16x32_bf16 v[80:83], v[18:21], v[200:203], v[80:83]
v_lshrrev_b64 v[112:113], 2, v[112:113]
v_cvt_pk_bf16_f32 v242, v244, v245
v_cvt_pk_bf16_f32 v243, v246, v247
v_mfma_f32_16x16x32_bf16 v[84:87], v[16:19], v[200:203], v[84:87]
ds_read_b128 v[244:247], v254
v_and_b32_sdwa v114, s47, v112 dst_sel:DWORD dst_unused:UNUSED_PAD src0_sel:DWORD src1_sel:WORD_1
s_waitcnt vmcnt(0)
v_mfma_f32_16x16x32_bf16 v[88:91], v[18:21], v[204:207], v[88:91]
v_cvt_pk_bf16_f32 v80, v80, v81
v_cvt_pk_bf16_f32 v81, v82, v83
v_mfma_f32_16x16x32_bf16 v[92:95], v[16:19], v[204:207], v[92:95]
v_and_b32_e64 v112, s47, v112
v_cvt_pk_bf16_f32 v82, v84, v85
v_cvt_pk_bf16_f32 v83, v86, v87
s_waitcnt lgkmcnt(5)
v_mfma_f32_16x16x32_f16 v[164:167], v[188:191], v[152:155], v[132:135]
ds_read_b128 v[84:87], v254 offset:8336
v_cvt_pk_bf16_f32 v88, v88, v89
v_cvt_pk_bf16_f32 v89, v90, v91
v_mfma_f32_16x16x32_bf16 v[108:111], v[160:163], v[48:51], 0
v_cvt_pk_bf16_f32 v90, v92, v93
v_cvt_pk_bf16_f32 v91, v94, v95
v_mfma_f32_16x16x32_f16 v[168:171], v[188:191], v[148:151], v[132:135]
ds_read_b128 v[92:95], v254 offset:16
buffer_store_dwordx4 v[128:131], v253, s[8:11], s71 offen sc1
buffer_store_dwordx4 v[136:139], v253, s[8:11], s71 offen offset:64 sc1
v_mfma_f32_16x16x32_f16 v[132:135], v[188:191], v[144:147], v[132:135]
ds_read_b128 v[188:191], v251 offset:12288
ds_read_u16_d16_hi v114, v114
v_mfma_f32_16x16x32_bf16 v[192:195], v[160:163], v[52:55], 0
ds_read_u16 v112, v112
v_and_b32_sdwa v115, s47, v113 dst_sel:DWORD dst_unused:UNUSED_PAD src0_sel:DWORD src1_sel:WORD_1
s_waitcnt lgkmcnt(5)
v_mfma_f32_16x16x32_f16 v[216:219], v[120:123], v[152:155], v[76:79]
s_setprio 0
v_and_b32_e64 v113, s47, v113
v_pk_fma_f16 v231, v230, v230, s48
v_mfma_f32_16x16x32_bf16 v[196:199], v[160:163], v[24:27], 0
ds_read_b128 v[160:163], v248 offset:28928
ds_read_u16_d16_hi v115, v115
v_mfma_f32_16x16x32_f16 v[220:223], v[120:123], v[148:151], v[76:79]
ds_read_u16 v113, v113
v_pk_mul_f16 v229, v228, v229
v_mfma_f32_16x16x32_f16 v[76:79], v[120:123], v[144:147], v[76:79]
ds_read_b128 v[120:123], v251 offset:10240
v_pk_mul_f16 v231, v230, v231
v_mfma_f32_16x16x32_bf16 v[108:111], v[124:127], v[56:59], v[108:111]
v_cvt_pkrtz_f16_f32 v116, v116, v117
v_cvt_pkrtz_f16_f32 v117, v118, v119
v_mfma_f32_16x16x32_f16 v[100:103], v[184:187], v[152:155], v[140:143]
v_lshrrev_b64 v[116:117], 2, v[116:117]
v_and_b32_sdwa v118, s47, v116 dst_sel:DWORD dst_unused:UNUSED_PAD src0_sel:DWORD src1_sel:WORD_1
v_mfma_f32_16x16x32_bf16 v[192:195], v[124:127], v[60:63], v[192:195]
v_and_b32_e64 v116, s47, v116
v_lshl_add_u64 v[210:211], v[0:1], 0, v[2:3]
v_mfma_f32_16x16x32_f16 v[104:107], v[184:187], v[148:151], v[140:143]
ds_read_u16_d16_hi v118, v118
ds_read_u16 v116, v116
v_exp_f16_sdwa v229, v229 dst_sel:WORD_0 dst_unused:UNUSED_PRESERVE src0_sel:WORD_0
v_mfma_f32_16x16x32_f16 v[140:143], v[184:187], v[144:147], v[140:143]
ds_read_b128 v[184:187], v251 offset:13312
v_exp_f16_sdwa v231, v231 dst_sel:WORD_0 dst_unused:UNUSED_PRESERVE src0_sel:WORD_0
v_mfma_f32_16x16x32_bf16 v[196:199], v[124:127], v[32:35], v[196:199]
ds_read_b128 v[124:127], v248 offset:30720
v_and_b32_sdwa v119, s47, v117 dst_sel:DWORD dst_unused:UNUSED_PAD src0_sel:DWORD src1_sel:WORD_1
s_waitcnt lgkmcnt(7)
v_mfma_f32_16x16x32_f16 v[232:235], v[188:191], v[152:155], v[84:87]
v_and_b32 v117, s47, v117
v_lshl_add_u64 v[214:215], v[4:5], 0, v[6:7]
v_mfma_f32_16x16x32_f16 v[236:239], v[188:191], v[148:151], v[84:87]
ds_read_u16_d16_hi v119, v119
ds_read_u16 v117, v117
v_mfma_f32_16x16x32_bf16 v[108:111], v[160:163], v[64:67], v[108:111]
v_exp_f16_sdwa v229, v229 dst_sel:WORD_1 dst_unused:UNUSED_PRESERVE src0_sel:WORD_1
v_mfma_f32_16x16x32_f16 v[84:87], v[188:191], v[144:147], v[84:87]
ds_read_b128 v[188:191], v251 offset:14336
v_exp_f16_sdwa v231, v231 dst_sel:WORD_1 dst_unused:UNUSED_PRESERVE src0_sel:WORD_1
v_mfma_f32_16x16x32_bf16 v[192:195], v[160:163], v[68:71], v[192:195]
v_lshl_add_u64 v[182:183], v[224:225], 0, v[226:227]
v_pk_add_f16 v229, v229, 1.0 op_sel_hi:[1,0]
s_waitcnt lgkmcnt(6)
v_mfma_f32_16x16x32_f16 v[200:203], v[120:123], v[152:155], v[244:247]
s_setprio 3
v_pk_add_f16 v231, v231, 1.0 op_sel_hi:[1,0]
v_rcp_f16_sdwa v229, v229 dst_sel:WORD_0 dst_unused:UNUSED_PRESERVE src0_sel:WORD_0
v_mfma_f32_16x16x32_f16 v[204:207], v[120:123], v[148:151], v[244:247]
v_rcp_f16_sdwa v231, v231 dst_sel:WORD_0 dst_unused:UNUSED_PRESERVE src0_sel:WORD_0
v_mfma_f32_16x16x32_bf16 v[196:199], v[160:163], v[40:43], v[196:199]
ds_read_b128 v[160:163], v248 offset:32768
v_cvt_pkrtz_f16_f32 v192, v192, v193
v_mfma_f32_16x16x32_f16 v[244:247], v[120:123], v[144:147], v[244:247]
ds_read_b128 v[120:123], v251 offset:17408
v_cvt_pkrtz_f16_f32 v193, v194, v195
s_waitcnt lgkmcnt(4)
v_mfma_f32_16x16x32_bf16 v[128:131], v[124:127], v[48:51], 0
v_lshrrev_b64 v[192:193], 2, v[192:193]
v_and_b32_sdwa v194, s47, v192 dst_sel:DWORD dst_unused:UNUSED_PAD src0_sel:DWORD src1_sel:WORD_1
v_mfma_f32_16x16x32_f16 v[4:7], v[184:187], v[152:155], v[92:95]
v_and_b32 v192, s47, v192
v_cvt_pk_f16_f32 v108, v108, v109
v_mfma_f32_16x16x32_f16 v[224:227], v[184:187], v[148:151], v[92:95]
ds_read_u16_d16_hi v194, v194
ds_read_u16 v192, v192
v_mfma_f32_16x16x32_bf16 v[136:139], v[124:127], v[52:55], 0
v_rcp_f16_sdwa v229, v229 dst_sel:WORD_1 dst_unused:UNUSED_PRESERVE src0_sel:WORD_1
v_mfma_f32_16x16x32_f16 v[92:95], v[184:187], v[144:147], v[92:95]
ds_read_b128 v[184:187], v251 offset:15360
v_cvt_pk_f16_f32 v110, v110, v111
v_mfma_f32_16x16x32_bf16 v[0:3], v[124:127], v[24:27], 0
ds_read_b128 v[124:127], v248 offset:34816
v_pk_fma_f16 v109, v108, v108, s48
s_waitcnt lgkmcnt(5)
v_mfma_f32_16x16x32_f16 v[164:167], v[188:191], v[176:179], v[164:167]
v_rcp_f16_sdwa v231, v231 dst_sel:WORD_1 dst_unused:UNUSED_PRESERVE src0_sel:WORD_1
v_mfma_f32_16x16x32_f16 v[168:171], v[188:191], v[156:159], v[168:171]
v_and_b32_sdwa v195, s47, v193 dst_sel:DWORD dst_unused:UNUSED_PAD src0_sel:DWORD src1_sel:WORD_1
v_and_b32 v193, s47, v193
v_mfma_f32_16x16x32_bf16 v[128:131], v[160:163], v[56:59], v[128:131]
ds_read_u16_d16_hi v195, v195
ds_read_u16 v193, v193
v_pk_fma_f16 v111, v110, v110, s48
v_mfma_f32_16x16x32_f16 v[132:135], v[188:191], v[172:175], v[132:135]
ds_read_b128 v[188:191], v251 offset:18432
v_pk_mul_f16 v109, v108, v109
v_pk_mul_f16 v228, v228, v229
v_mfma_f32_16x16x32_bf16 v[136:139], v[160:163], v[60:63], v[136:139]
v_pk_mul_f16 v111, v110, v111
v_cvt_pkrtz_f16_f32 v196, v196, v197
s_waitcnt lgkmcnt(6)
v_mfma_f32_16x16x32_f16 v[216:219], v[120:123], v[176:179], v[216:219]
v_cvt_pkrtz_f16_f32 v197, v198, v199
v_lshrrev_b64 v[196:197], 2, v[196:197]
v_and_b32_sdwa v198, s47, v196 dst_sel:DWORD dst_unused:UNUSED_PAD src0_sel:DWORD src1_sel:WORD_1
v_and_b32 v196, s47, v196
v_pk_mul_f16 v229, v230, v231
v_exp_f16_sdwa v109, v109 dst_sel:WORD_0 dst_unused:UNUSED_PRESERVE src0_sel:WORD_0
v_lshl_add_u64 v[112:113], v[112:113], 0, v[114:115]
v_mfma_f32_16x16x32_f16 v[220:223], v[120:123], v[156:159], v[220:223]
ds_read_u16_d16_hi v198, v198
ds_read_u16 v196, v196
s_setprio 2
v_mfma_f32_16x16x32_bf16 v[0:3], v[160:163], v[32:35], v[0:3]
ds_read_b128 v[160:163], v248 offset:30976
v_exp_f16_sdwa v111, v111 dst_sel:WORD_0 dst_unused:UNUSED_PRESERVE src0_sel:WORD_0
v_and_b32_sdwa v199, s47, v197 dst_sel:DWORD dst_unused:UNUSED_PAD src0_sel:DWORD src1_sel:WORD_1
v_and_b32_e64 v197, s47, v197
v_mfma_f32_16x16x32_f16 v[76:79], v[120:123], v[172:175], v[76:79]
ds_read_u16_d16_hi v199, v199
ds_read_u16 v197, v197
ds_read_b128 v[120:123], v251 offset:16384
s_waitcnt lgkmcnt(7)
v_mfma_f32_16x16x32_bf16 v[128:131], v[124:127], v[64:67], v[128:131]
v_exp_f16_sdwa v109, v109 dst_sel:WORD_1 dst_unused:UNUSED_PRESERVE src0_sel:WORD_1
v_mfma_f32_16x16x32_f16 v[100:103], v[184:187], v[176:179], v[100:103]
v_lshl_add_u64 v[116:117], v[116:117], 0, v[118:119]
v_exp_f16_sdwa v111, v111 dst_sel:WORD_1 dst_unused:UNUSED_PRESERVE src0_sel:WORD_1
v_mfma_f32_16x16x32_f16 v[104:107], v[184:187], v[156:159], v[104:107]
v_pk_add_f16 v109, v109, 1.0 op_sel_hi:[1,0]
v_pk_add_f16 v111, v111, 1.0 op_sel_hi:[1,0]
v_mfma_f32_16x16x32_bf16 v[136:139], v[124:127], v[68:71], v[136:139]
v_rcp_f16_sdwa v109, v109 dst_sel:WORD_0 dst_unused:UNUSED_PRESERVE src0_sel:WORD_0
v_mfma_f32_16x16x32_f16 v[140:143], v[184:187], v[172:175], v[140:143]
ds_read_b128 v[184:187], v251 offset:19456
v_rcp_f16_sdwa v111, v111 dst_sel:WORD_0 dst_unused:UNUSED_PRESERVE src0_sel:WORD_0
v_mfma_f32_16x16x32_bf16 v[0:3], v[124:127], v[40:43], v[0:3]
ds_read_b128 v[124:127], v248 offset:33024
v_cvt_pkrtz_f16_f32 v128, v128, v129
s_waitcnt lgkmcnt(6)
v_mfma_f32_16x16x32_f16 v[232:235], v[188:191], v[176:179], v[232:235]
v_cvt_pkrtz_f16_f32 v129, v130, v131
v_lshrrev_b64 v[128:129], 2, v[128:129]
v_mfma_f32_16x16x32_f16 v[236:239], v[188:191], v[156:159], v[236:239]
v_and_b32_sdwa v130, s47, v128 dst_sel:DWORD dst_unused:UNUSED_PAD src0_sel:DWORD src1_sel:WORD_1
v_and_b32_e64 v128, s47, v128
s_waitcnt lgkmcnt(4)
v_mfma_f32_16x16x32_bf16 v[144:147], v[160:163], v[48:51], 0
ds_read_u16_d16_hi v130, v130
ds_read_u16 v128, v128
v_mfma_f32_16x16x32_f16 v[84:87], v[188:191], v[172:175], v[84:87]
ds_read_b128 v[188:191], v248 offset:35072
v_rcp_f16_sdwa v109, v109 dst_sel:WORD_1 dst_unused:UNUSED_PRESERVE src0_sel:WORD_1
v_mfma_f32_16x16x32_bf16 v[148:151], v[160:163], v[52:55], 0
v_and_b32_sdwa v131, s47, v129 dst_sel:DWORD dst_unused:UNUSED_PAD src0_sel:DWORD src1_sel:WORD_1
v_and_b32_e64 v129, s47, v129
s_waitcnt lgkmcnt(5)
v_mfma_f32_16x16x32_f16 v[200:203], v[120:123], v[176:179], v[200:203]
s_setprio 1
buffer_store_dwordx4 v[240:243], v253, s[8:11], s71 offen offset:128 sc1
buffer_store_dwordx4 v[72:75], v253, s[8:11], s71 offen offset:192 sc1
ds_read_u16_d16_hi v131, v131
v_mfma_f32_16x16x32_f16 v[204:207], v[120:123], v[156:159], v[204:207]
ds_read_u16 v129, v129
v_rcp_f16_sdwa v111, v111 dst_sel:WORD_1 dst_unused:UNUSED_PRESERVE src0_sel:WORD_1
v_mfma_f32_16x16x32_bf16 v[152:155], v[160:163], v[24:27], 0
ds_read_b128 v[160:163], v251 offset:23552
v_cvt_pkrtz_f16_f32 v136, v136, v137
v_mfma_f32_16x16x32_f16 v[244:247], v[120:123], v[172:175], v[244:247]
ds_read_b128 v[120:123], v249
buffer_load_dwordx4 v[240:243], v253, s[4:7], s70 offen
buffer_load_dwordx4 v[72:75], v253, s[4:7], s70 offen offset:64
s_waitcnt lgkmcnt(7)
v_mfma_f32_16x16x32_bf16 v[144:147], v[124:127], v[56:59], v[144:147]
v_cvt_pkrtz_f16_f32 v137, v138, v139
v_lshrrev_b64 v[136:137], 2, v[136:137]
v_mfma_f32_16x16x32_f16 v[4:7], v[184:187], v[176:179], v[4:7]
ds_read_b128 v[176:179], v251 offset:20480
v_and_b32_sdwa v138, s47, v136 dst_sel:DWORD dst_unused:UNUSED_PAD src0_sel:DWORD src1_sel:WORD_1
v_and_b32 v136, s47, v136
v_mfma_f32_16x16x32_f16 v[224:227], v[184:187], v[156:159], v[224:227]
ds_read_u16_d16_hi v138, v138
ds_read_u16 v136, v136
v_pk_mul_f16 v230, v108, v109
v_mfma_f32_16x16x32_bf16 v[148:151], v[124:127], v[60:63], v[148:151]
v_and_b32_sdwa v139, s47, v137 dst_sel:DWORD dst_unused:UNUSED_PAD src0_sel:DWORD src1_sel:WORD_1
v_and_b32_e64 v137, s47, v137
v_pk_mul_f16 v231, v110, v111
v_mfma_f32_16x16x32_f16 v[92:95], v[184:187], v[172:175], v[92:95]
ds_read_u16_d16_hi v139, v139
ds_read_u16 v137, v137
ds_read_b128 v[184:187], v251 offset:24576
v_lshl_add_u64 v[114:115], v[192:193], 0, v[194:195]
v_mfma_f32_16x16x32_bf16 v[152:155], v[124:127], v[32:35], v[152:155]
ds_read_b128 v[124:127], v251 offset:21504
buffer_load_dwordx4 v[172:175], v253, s[4:7], s70 offen offset:128
buffer_load_dwordx4 v[156:159], v253, s[4:7], s70 offen offset:192
s_waitcnt lgkmcnt(6)
v_mfma_f32_16x16x32_f16 v[164:167], v[176:179], v[96:99], v[164:167]
v_cvt_pkrtz_f16_f32 v0, v0, v1
v_cvt_pkrtz_f16_f32 v1, v2, v3
v_lshrrev_b64 v[0:1], 2, v[0:1]
v_and_b32_sdwa v2, s47, v0 dst_sel:DWORD dst_unused:UNUSED_PAD src0_sel:DWORD src1_sel:WORD_1
v_and_b32 v0, s47, v0
v_mfma_f32_16x16x32_f16 v[168:171], v[176:179], v[12:15], v[168:171]
ds_read_u16_d16_hi v2, v2
ds_read_u16 v0, v0
v_and_b32_sdwa v3, s47, v1 dst_sel:DWORD dst_unused:UNUSED_PAD src0_sel:DWORD src1_sel:WORD_1
v_and_b32_e64 v1, s47, v1
v_mfma_f32_16x16x32_bf16 v[144:147], v[188:191], v[64:67], v[144:147]
ds_read_u16_d16_hi v3, v3
ds_read_u16 v1, v1
v_mfma_f32_16x16x32_f16 v[132:135], v[176:179], v[8:11], v[132:135]
ds_read_b128 v[176:179], v249 offset:2048
v_lshl_add_u64 v[118:119], v[196:197], 0, v[198:199]
v_mfma_f32_16x16x32_bf16 v[148:151], v[188:191], v[68:71], v[148:151]
s_nop 1
v_cvt_pk_f16_f32 v144, v144, v145
v_mfma_f32_16x16x32_f16 v[216:219], v[160:163], v[96:99], v[216:219]
s_setprio 0
v_cvt_pk_f16_f32 v146, v146, v147
v_pk_fma_f16 v145, v144, v144, s48
v_mfma_f32_16x16x32_f16 v[220:223], v[160:163], v[12:15], v[220:223]
v_cvt_pkrtz_f16_f32 v148, v148, v149
v_cvt_pkrtz_f16_f32 v149, v150, v151
v_mfma_f32_16x16x32_bf16 v[152:155], v[188:191], v[40:43], v[152:155]
ds_read_b128 v[188:191], v251 offset:22528
v_lshrrev_b64 v[148:149], 2, v[148:149]
v_mfma_f32_16x16x32_f16 v[76:79], v[160:163], v[8:11], v[76:79]
ds_read_b128 v[160:163], v251 offset:25600
v_and_b32_sdwa v150, s47, v148 dst_sel:DWORD dst_unused:UNUSED_PAD src0_sel:DWORD src1_sel:WORD_1
v_mfma_f32_16x16x32_bf16 v[108:111], v[120:123], v[48:51], 0
v_and_b32 v148, s47, v148
v_and_b32_sdwa v151, s47, v149 dst_sel:DWORD dst_unused:UNUSED_PAD src0_sel:DWORD src1_sel:WORD_1
s_waitcnt lgkmcnt(6)
v_mfma_f32_16x16x32_f16 v[100:103], v[124:127], v[96:99], v[100:103]
ds_read_u16_d16_hi v150, v150
ds_read_u16 v148, v148
v_mfma_f32_16x16x32_f16 v[104:107], v[124:127], v[12:15], v[104:107]
v_and_b32_e64 v149, s47, v149
v_pk_fma_f16 v147, v146, v146, s48
v_mfma_f32_16x16x32_bf16 v[192:195], v[120:123], v[52:55], 0
ds_read_u16_d16_hi v151, v151
ds_read_u16 v149, v149
v_mfma_f32_16x16x32_f16 v[140:143], v[124:127], v[8:11], v[140:143]
ds_read_b128 v[124:127], v251 offset:26624
v_pk_mul_f16 v145, v144, v145
v_mfma_f32_16x16x32_f16 v[232:235], v[184:187], v[96:99], v[232:235]
v_pk_mul_f16 v147, v146, v147
v_cvt_pkrtz_f16_f32 v152, v152, v153
v_mfma_f32_16x16x32_bf16 v[196:199], v[120:123], v[24:27], 0
ds_read_b128 v[120:123], v249 offset:4096
v_cvt_pkrtz_f16_f32 v153, v154, v155
v_mfma_f32_16x16x32_f16 v[236:239], v[184:187], v[12:15], v[236:239]
v_lshrrev_b64 v[152:153], 2, v[152:153]
v_and_b32_sdwa v154, s47, v152 dst_sel:DWORD dst_unused:UNUSED_PAD src0_sel:DWORD src1_sel:WORD_1
s_waitcnt lgkmcnt(7)
v_mfma_f32_16x16x32_bf16 v[108:111], v[176:179], v[56:59], v[108:111]
v_and_b32 v152, s47, v152
v_lshl_add_u64 v[128:129], v[128:129], 0, v[130:131]
v_mfma_f32_16x16x32_f16 v[84:87], v[184:187], v[8:11], v[84:87]
ds_read_b128 v[184:187], v249 offset:256
ds_read_u16_d16_hi v154, v154
v_mfma_f32_16x16x32_f16 v[200:203], v[188:191], v[96:99], v[200:203]
s_setprio 3
ds_read_u16 v152, v152
v_exp_f16_sdwa v145, v145 dst_sel:WORD_0 dst_unused:UNUSED_PRESERVE src0_sel:WORD_0
v_mfma_f32_16x16x32_bf16 v[192:195], v[176:179], v[60:63], v[192:195]
v_exp_f16_sdwa v147, v147 dst_sel:WORD_0 dst_unused:UNUSED_PRESERVE src0_sel:WORD_0
v_mfma_f32_16x16x32_f16 v[204:207], v[188:191], v[12:15], v[204:207]
v_and_b32_sdwa v155, s47, v153 dst_sel:DWORD dst_unused:UNUSED_PAD src0_sel:DWORD src1_sel:WORD_1
v_and_b32 v153, s47, v153
v_mfma_f32_16x16x32_bf16 v[196:199], v[176:179], v[32:35], v[196:199]
ds_read_b128 v[176:179], v251 offset:29696
ds_read_u16_d16_hi v155, v155
v_mfma_f32_16x16x32_f16 v[244:247], v[188:191], v[8:11], v[244:247]
ds_read_b128 v[188:191], v251 offset:27648
ds_read_u16 v153, v153
s_waitcnt lgkmcnt(8)
v_mfma_f32_16x16x32_f16 v[4:7], v[160:163], v[96:99], v[4:7]
v_lshl_add_u64 v[136:137], v[136:137], 0, v[138:139]
v_exp_f16_sdwa v145, v145 dst_sel:WORD_1 dst_unused:UNUSED_PRESERVE src0_sel:WORD_1
s_waitcnt lgkmcnt(7)
v_mfma_f32_16x16x32_bf16 v[108:111], v[120:123], v[64:67], v[108:111]
v_exp_f16_sdwa v147, v147 dst_sel:WORD_1 dst_unused:UNUSED_PRESERVE src0_sel:WORD_1
v_mfma_f32_16x16x32_f16 v[224:227], v[160:163], v[12:15], v[224:227]
v_lshl_add_u64 v[0:1], v[0:1], 0, v[2:3]
v_pk_add_f16 v145, v145, 1.0 op_sel_hi:[1,0]
v_mfma_f32_16x16x32_bf16 v[192:195], v[120:123], v[68:71], v[192:195]
v_pk_add_f16 v147, v147, 1.0 op_sel_hi:[1,0]
v_rcp_f16_sdwa v145, v145 dst_sel:WORD_0 dst_unused:UNUSED_PRESERVE src0_sel:WORD_0
v_mfma_f32_16x16x32_f16 v[92:95], v[160:163], v[8:11], v[92:95]
ds_read_b128 v[160:163], v249 offset:2304
v_rcp_f16_sdwa v147, v147 dst_sel:WORD_0 dst_unused:UNUSED_PRESERVE src0_sel:WORD_0
v_mfma_f32_16x16x32_f16 v[164:167], v[124:127], v[180:183], v[164:167]
s_nop 1
v_cvt_pkrtz_f16_f32 v192, v192, v193
v_cvt_pkrtz_f16_f32 v193, v194, v195
v_mfma_f32_16x16x32_bf16 v[196:199], v[120:123], v[40:43], v[196:199]
ds_read_b128 v[120:123], v251 offset:30720
v_lshrrev_b64 v[192:193], 2, v[192:193]
v_mfma_f32_16x16x32_f16 v[168:171], v[124:127], v[212:215], v[168:171]
v_and_b32_sdwa v194, s47, v192 dst_sel:DWORD dst_unused:UNUSED_PAD src0_sel:DWORD src1_sel:WORD_1
v_and_b32 v192, s47, v192
s_waitcnt lgkmcnt(3)
v_mfma_f32_16x16x32_bf16 v[8:11], v[184:187], v[48:51], 0
ds_read_u16_d16_hi v194, v194
ds_read_u16 v192, v192
v_mfma_f32_16x16x32_f16 v[132:135], v[124:127], v[208:211], v[132:135]
ds_read_b128 v[124:127], v249 offset:4352
s_setprio 2
v_cvt_pk_f16_f32 v108, v108, v109
v_mfma_f32_16x16x32_f16 v[216:219], v[176:179], v[180:183], v[216:219]
v_rcp_f16_sdwa v145, v145 dst_sel:WORD_1 dst_unused:UNUSED_PRESERVE src0_sel:WORD_1
v_mfma_f32_16x16x32_bf16 v[12:15], v[184:187], v[52:55], 0
v_cvt_pk_f16_f32 v110, v110, v111
v_pk_fma_f16 v109, v108, v108, s48
v_mfma_f32_16x16x32_f16 v[220:223], v[176:179], v[212:215], v[220:223]
v_rcp_f16_sdwa v147, v147 dst_sel:WORD_1 dst_unused:UNUSED_PRESERVE src0_sel:WORD_1
v_mfma_f32_16x16x32_bf16 v[96:99], v[184:187], v[24:27], 0
ds_read_b128 v[184:187], v251 offset:28672
v_and_b32_sdwa v195, s47, v193 dst_sel:DWORD dst_unused:UNUSED_PAD src0_sel:DWORD src1_sel:WORD_1
v_mfma_f32_16x16x32_f16 v[76:79], v[176:179], v[208:211], v[76:79]
ds_read_b128 v[176:179], v251 offset:31744
v_and_b32 v193, s47, v193
v_mfma_f32_16x16x32_f16 v[100:103], v[188:191], v[180:183], v[100:103]
buffer_store_dwordx4 v[80:83], v253, s[8:11], s71 offen offset:256 sc1
buffer_store_dwordx4 v[88:91], v253, s[8:11], s71 offen offset:320 sc1
buffer_load_dwordx4 v[80:83], v253, s[4:7], s70 offen offset:256
buffer_load_dwordx4 v[88:91], v253, s[4:7], s70 offen offset:320
s_waitcnt lgkmcnt(5)
v_mfma_f32_16x16x32_bf16 v[8:11], v[160:163], v[56:59], v[8:11]
ds_read_u16_d16_hi v195, v195
ds_read_u16 v193, v193
v_pk_fma_f16 v111, v110, v110, s48
v_mfma_f32_16x16x32_f16 v[104:107], v[188:191], v[212:215], v[104:107]
v_pk_mul_f16 v109, v108, v109
v_pk_mul_f16 v130, v144, v145
v_mfma_f32_16x16x32_bf16 v[12:15], v[160:163], v[60:63], v[12:15]
v_pk_mul_f16 v111, v110, v111
v_cvt_pkrtz_f16_f32 v196, v196, v197
v_mfma_f32_16x16x32_f16 v[140:143], v[188:191], v[208:211], v[140:143]
ds_read_b128 v[188:191], v249 offset:6144
v_cvt_pkrtz_f16_f32 v197, v198, v199
v_lshrrev_b64 v[196:197], 2, v[196:197]
v_and_b32_sdwa v198, s47, v196 dst_sel:DWORD dst_unused:UNUSED_PAD src0_sel:DWORD src1_sel:WORD_1
v_and_b32_e64 v196, s47, v196
v_pk_mul_f16 v131, v146, v147
v_exp_f16_sdwa v109, v109 dst_sel:WORD_0 dst_unused:UNUSED_PRESERVE src0_sel:WORD_0
v_mfma_f32_16x16x32_f16 v[232:235], v[120:123], v[180:183], v[232:235]
ds_read_u16_d16_hi v198, v198
ds_read_u16 v196, v196
v_lshl_add_u64 v[138:139], v[148:149], 0, v[150:151]
v_mfma_f32_16x16x32_bf16 v[96:99], v[160:163], v[32:35], v[96:99]
ds_read_b128 v[160:163], v251 offset:32768
v_exp_f16_sdwa v111, v111 dst_sel:WORD_0 dst_unused:UNUSED_PRESERVE src0_sel:WORD_0
v_mfma_f32_16x16x32_f16 v[236:239], v[120:123], v[212:215], v[236:239]
v_and_b32_sdwa v199, s47, v197 dst_sel:DWORD dst_unused:UNUSED_PAD src0_sel:DWORD src1_sel:WORD_1
v_and_b32_e64 v197, s47, v197
s_waitcnt lgkmcnt(5)
v_mfma_f32_16x16x32_bf16 v[8:11], v[124:127], v[64:67], v[8:11]
ds_read_u16_d16_hi v199, v199
ds_read_u16 v197, v197
v_mfma_f32_16x16x32_f16 v[84:87], v[120:123], v[208:211], v[84:87]
ds_read_b128 v[120:123], v249 offset:8192
v_exp_f16_sdwa v109, v109 dst_sel:WORD_1 dst_unused:UNUSED_PRESERVE src0_sel:WORD_1
s_setprio 1
v_mfma_f32_16x16x32_f16 v[200:203], v[184:187], v[180:183], v[200:203]
v_lshl_add_u64 v[2:3], v[152:153], 0, v[154:155]
v_exp_f16_sdwa v111, v111 dst_sel:WORD_1 dst_unused:UNUSED_PRESERVE src0_sel:WORD_1
v_mfma_f32_16x16x32_bf16 v[12:15], v[124:127], v[68:71], v[12:15]
v_pk_add_f16 v109, v109, 1.0 op_sel_hi:[1,0]
v_pk_add_f16 v111, v111, 1.0 op_sel_hi:[1,0]
v_mfma_f32_16x16x32_f16 v[204:207], v[184:187], v[212:215], v[204:207]
v_rcp_f16_sdwa v109, v109 dst_sel:WORD_0 dst_unused:UNUSED_PRESERVE src0_sel:WORD_0
v_mfma_f32_16x16x32_bf16 v[96:99], v[124:127], v[40:43], v[96:99]
ds_read_b128 v[124:127], v251 offset:35840
v_rcp_f16_sdwa v111, v111 dst_sel:WORD_0 dst_unused:UNUSED_PRESERVE src0_sel:WORD_0
v_mfma_f32_16x16x32_f16 v[244:247], v[184:187], v[208:211], v[244:247]
ds_read_b128 v[184:187], v251 offset:33792
v_cvt_pkrtz_f16_f32 v8, v8, v9
v_mfma_f32_16x16x32_f16 v[4:7], v[176:179], v[180:183], v[4:7]
v_cvt_pkrtz_f16_f32 v9, v10, v11
v_lshrrev_b64 v[8:9], 2, v[8:9]
s_waitcnt lgkmcnt(4)
v_mfma_f32_16x16x32_bf16 v[144:147], v[188:191], v[48:51], 0
v_and_b32_sdwa v10, s47, v8 dst_sel:DWORD dst_unused:UNUSED_PAD src0_sel:DWORD src1_sel:WORD_1
v_and_b32 v8, s47, v8
v_mfma_f32_16x16x32_f16 v[224:227], v[176:179], v[212:215], v[224:227]
ds_read_u16_d16_hi v10, v10
ds_read_u16 v8, v8
v_mfma_f32_16x16x32_bf16 v[148:151], v[188:191], v[52:55], 0
v_rcp_f16_sdwa v109, v109 dst_sel:WORD_1 dst_unused:UNUSED_PRESERVE src0_sel:WORD_1
v_mfma_f32_16x16x32_f16 v[92:95], v[176:179], v[208:211], v[92:95]
ds_read_b128 v[176:179], v249 offset:10240
v_and_b32_sdwa v11, s47, v9 dst_sel:DWORD dst_unused:UNUSED_PAD src0_sel:DWORD src1_sel:WORD_1
v_mfma_f32_16x16x32_f16 v[164:167], v[160:163], v[116:119], v[164:167]
v_and_b32_e64 v9, s47, v9
v_rcp_f16_sdwa v111, v111 dst_sel:WORD_1 dst_unused:UNUSED_PRESERVE src0_sel:WORD_1
v_mfma_f32_16x16x32_bf16 v[152:155], v[188:191], v[24:27], 0
ds_read_b128 v[188:191], v251 offset:36864
ds_read_u16_d16_hi v11, v11
v_mfma_f32_16x16x32_f16 v[168:171], v[160:163], v[112:115], v[168:171]
ds_read_u16 v9, v9
v_cvt_pkrtz_f16_f32 v12, v12, v13
s_waitcnt lgkmcnt(6)
v_mfma_f32_16x16x32_bf16 v[144:147], v[120:123], v[56:59], v[144:147]
v_cvt_pkrtz_f16_f32 v13, v14, v15
v_lshrrev_b64 v[12:13], 2, v[12:13]
v_mfma_f32_16x16x32_f16 v[132:135], v[160:163], v[228:231], v[132:135]
ds_read_b128 v[160:163], v249 offset:6400
v_and_b32_sdwa v14, s47, v12 dst_sel:DWORD dst_unused:UNUSED_PAD src0_sel:DWORD src1_sel:WORD_1
v_and_b32 v12, s47, v12
v_mfma_f32_16x16x32_f16 v[216:219], v[124:127], v[116:119], v[216:219]
ds_read_u16_d16_hi v14, v14
ds_read_u16 v12, v12
s_setprio 0
v_pk_mul_f16 v108, v108, v109
v_mfma_f32_16x16x32_bf16 v[148:151], v[120:123], v[60:63], v[148:151]
v_and_b32_sdwa v15, s47, v13 dst_sel:DWORD dst_unused:UNUSED_PAD src0_sel:DWORD src1_sel:WORD_1
v_and_b32 v13, s47, v13
v_pk_mul_f16 v109, v110, v111
v_mfma_f32_16x16x32_f16 v[220:223], v[124:127], v[112:115], v[220:223]
ds_read_u16_d16_hi v15, v15
ds_read_u16 v13, v13
v_lshl_add_u64 v[192:193], v[192:193], 0, v[194:195]
v_mfma_f32_16x16x32_bf16 v[152:155], v[120:123], v[32:35], v[152:155]
ds_read_b128 v[120:123], v251 offset:34816
v_cvt_pkrtz_f16_f32 v96, v96, v97
v_mfma_f32_16x16x32_f16 v[76:79], v[124:127], v[228:231], v[76:79]
ds_read_b128 v[124:127], v251 offset:37888
v_cvt_pkrtz_f16_f32 v97, v98, v99
v_lshrrev_b64 v[96:97], 2, v[96:97]
v_and_b32_sdwa v98, s47, v96 dst_sel:DWORD dst_unused:UNUSED_PAD src0_sel:DWORD src1_sel:WORD_1
v_and_b32_e64 v96, s47, v96
v_mfma_f32_16x16x32_f16 v[100:103], v[184:187], v[116:119], v[100:103]
ds_read_u16_d16_hi v98, v98
ds_read_u16 v96, v96
v_and_b32_sdwa v99, s47, v97 dst_sel:DWORD dst_unused:UNUSED_PAD src0_sel:DWORD src1_sel:WORD_1
v_and_b32 v97, s47, v97
s_waitcnt lgkmcnt(8)
v_mfma_f32_16x16x32_bf16 v[144:147], v[176:179], v[64:67], v[144:147]
ds_read_u16_d16_hi v99, v99
ds_read_u16 v97, v97
v_mfma_f32_16x16x32_f16 v[104:107], v[184:187], v[112:115], v[104:107]
v_lshl_add_u64 v[196:197], v[196:197], 0, v[198:199]
v_mfma_f32_16x16x32_f16 v[140:143], v[184:187], v[228:231], v[140:143]
ds_read_b128 v[184:187], v249 offset:8448
s_nop 1
v_cvt_pk_f16_f32 v144, v144, v145
v_mfma_f32_16x16x32_bf16 v[148:151], v[176:179], v[68:71], v[148:151]
v_cvt_pk_f16_f32 v146, v146, v147
v_pk_fma_f16 v145, v144, v144, s48
v_mfma_f32_16x16x32_f16 v[232:235], v[188:191], v[116:119], v[232:235]
v_pk_fma_f16 v147, v146, v146, s48
v_pk_mul_f16 v145, v144, v145
v_mfma_f32_16x16x32_bf16 v[152:155], v[176:179], v[40:43], v[152:155]
ds_read_b128 v[176:179], v251 offset:38912
s_nop 0
v_cvt_pkrtz_f16_f32 v148, v148, v149
v_mfma_f32_16x16x32_f16 v[236:239], v[188:191], v[112:115], v[236:239]
v_cvt_pkrtz_f16_f32 v149, v150, v151
v_lshrrev_b64 v[148:149], 2, v[148:149]
v_mfma_f32_16x16x32_f16 v[84:87], v[188:191], v[228:231], v[84:87]
ds_read_b128 v[188:191], v249 offset:10496
v_and_b32_sdwa v150, s47, v148 dst_sel:DWORD dst_unused:UNUSED_PAD src0_sel:DWORD src1_sel:WORD_1
v_mfma_f32_16x16x32_bf16 v[208:211], v[160:163], v[48:51], 0
s_setprio 3
v_and_b32_e64 v148, s47, v148
v_and_b32_sdwa v151, s47, v149 dst_sel:DWORD dst_unused:UNUSED_PAD src0_sel:DWORD src1_sel:WORD_1
s_waitcnt lgkmcnt(6)
v_mfma_f32_16x16x32_f16 v[200:203], v[120:123], v[116:119], v[200:203]
ds_read_u16_d16_hi v150, v150
ds_read_u16 v148, v148
v_mfma_f32_16x16x32_bf16 v[212:215], v[160:163], v[52:55], 0
v_and_b32_e64 v149, s47, v149
v_pk_mul_f16 v147, v146, v147
v_mfma_f32_16x16x32_f16 v[204:207], v[120:123], v[112:115], v[204:207]
ds_read_u16_d16_hi v151, v151
ds_read_u16 v149, v149
v_mfma_f32_16x16x32_f16 v[244:247], v[120:123], v[228:231], v[244:247]
ds_read_b128 v[120:123], v251 offset:39936
v_cvt_pkrtz_f16_f32 v152, v152, v153
v_mfma_f32_16x16x32_bf16 v[180:183], v[160:163], v[24:27], 0
ds_read_b128 v[160:163], v251 offset:41984
v_cvt_pkrtz_f16_f32 v153, v154, v155
v_mfma_f32_16x16x32_f16 v[4:7], v[124:127], v[116:119], v[4:7]
v_lshrrev_b64 v[152:153], 2, v[152:153]
v_and_b32_sdwa v154, s47, v152 dst_sel:DWORD dst_unused:UNUSED_PAD src0_sel:DWORD src1_sel:WORD_1
s_waitcnt lgkmcnt(7)
v_mfma_f32_16x16x32_bf16 v[208:211], v[184:187], v[56:59], v[208:211]
v_and_b32 v152, s47, v152
v_lshl_add_u64 v[110:111], v[8:9], 0, v[10:11]
v_mfma_f32_16x16x32_f16 v[224:227], v[124:127], v[112:115], v[224:227]
ds_read_u16_d16_hi v154, v154
ds_read_u16 v152, v152
v_mfma_f32_16x16x32_f16 v[92:95], v[124:127], v[228:231], v[92:95]
ds_read_b128 v[124:127], v249 offset:12288
v_exp_f16_sdwa v145, v145 dst_sel:WORD_0 dst_unused:UNUSED_PRESERVE src0_sel:WORD_0
v_mfma_f32_16x16x32_bf16 v[212:215], v[184:187], v[60:63], v[212:215]
v_exp_f16_sdwa v147, v147 dst_sel:WORD_0 dst_unused:UNUSED_PRESERVE src0_sel:WORD_0
s_waitcnt vmcnt(7)
v_mfma_f32_16x16x32_bf16 v[132:135], v[18:21], v[240:243], v[132:135]
v_and_b32_sdwa v155, s47, v153 dst_sel:DWORD dst_unused:UNUSED_PAD src0_sel:DWORD src1_sel:WORD_1
v_and_b32_e64 v153, s47, v153
v_mfma_f32_16x16x32_bf16 v[76:79], v[16:19], v[240:243], v[76:79]
ds_read_u16_d16_hi v155, v155
ds_read_u16 v153, v153
s_waitcnt vmcnt(6)
v_mfma_f32_16x16x32_bf16 v[140:143], v[18:21], v[72:75], v[140:143]
v_lshl_add_u64 v[194:195], v[12:13], 0, v[14:15]
v_exp_f16_sdwa v145, v145 dst_sel:WORD_1 dst_unused:UNUSED_PRESERVE src0_sel:WORD_1
v_mfma_f32_16x16x32_bf16 v[84:87], v[16:19], v[72:75], v[84:87]
buffer_load_dwordx4 v[228:231], v253, s[4:7], s69 offen
buffer_load_dwordx4 v[112:115], v253, s[4:7], s69 offen offset:64
v_exp_f16_sdwa v147, v147 dst_sel:WORD_1 dst_unused:UNUSED_PRESERVE src0_sel:WORD_1
v_mfma_f32_16x16x32_f16 v[164:167], v[176:179], v[0:3], v[164:167]
v_lshl_add_u64 v[198:199], v[96:97], 0, v[98:99]
v_pk_add_f16 v145, v145, 1.0 op_sel_hi:[1,0]
v_mfma_f32_16x16x32_bf16 v[180:183], v[184:187], v[32:35], v[180:183]
ds_read_b128 v[184:187], v251 offset:43008
v_pk_add_f16 v147, v147, 1.0 op_sel_hi:[1,0]
v_mfma_f32_16x16x32_f16 v[168:171], v[176:179], v[136:139], v[168:171]
v_rcp_f16_sdwa v145, v145 dst_sel:WORD_0 dst_unused:UNUSED_PRESERVE src0_sel:WORD_0
v_mfma_f32_16x16x32_f16 v[132:135], v[176:179], v[128:131], v[132:135]
ds_read_b128 v[176:179], v249 offset:14336
v_rcp_f16_sdwa v147, v147 dst_sel:WORD_0 dst_unused:UNUSED_PRESERVE src0_sel:WORD_0
s_waitcnt lgkmcnt(4)
v_mfma_f32_16x16x32_bf16 v[208:211], v[188:191], v[64:67], v[208:211]
s_setprio 2
v_rcp_f16_sdwa v145, v145 dst_sel:WORD_1 dst_unused:UNUSED_PRESERVE src0_sel:WORD_1
v_mfma_f32_16x16x32_f16 v[216:219], v[160:163], v[0:3], v[216:219]
v_rcp_f16_sdwa v147, v147 dst_sel:WORD_1 dst_unused:UNUSED_PRESERVE src0_sel:WORD_1
v_mfma_f32_16x16x32_bf16 v[212:215], v[188:191], v[68:71], v[212:215]
s_nop 2
v_cvt_pk_f16_f32 v208, v208, v209
v_cvt_pk_f16_f32 v210, v210, v211
v_mfma_f32_16x16x32_f16 v[220:223], v[160:163], v[136:139], v[220:223]
v_pk_fma_f16 v209, v208, v208, s48
v_pk_fma_f16 v211, v210, v210, s48
v_mfma_f32_16x16x32_f16 v[76:79], v[160:163], v[128:131], v[76:79]
ds_read_b128 v[160:163], v251 offset:44032
v_cvt_pkrtz_f16_f32 v212, v212, v213
v_mfma_f32_16x16x32_bf16 v[180:183], v[188:191], v[40:43], v[180:183]
ds_read_b128 v[188:191], v251 offset:40960
v_cvt_pkrtz_f16_f32 v213, v214, v215
v_mfma_f32_16x16x32_f16 v[100:103], v[120:123], v[0:3], v[100:103]
v_lshrrev_b64 v[212:213], 2, v[212:213]
v_and_b32_sdwa v214, s47, v212 dst_sel:DWORD dst_unused:UNUSED_PAD src0_sel:DWORD src1_sel:WORD_1
v_mfma_f32_16x16x32_bf16 v[116:119], v[124:127], v[48:51], 0
v_and_b32 v212, s47, v212
v_and_b32_sdwa v215, s47, v213 dst_sel:DWORD dst_unused:UNUSED_PAD src0_sel:DWORD src1_sel:WORD_1
v_mfma_f32_16x16x32_f16 v[104:107], v[120:123], v[136:139], v[104:107]
ds_read_u16_d16_hi v214, v214
ds_read_u16 v212, v212
v_mfma_f32_16x16x32_f16 v[140:143], v[120:123], v[128:131], v[140:143]
ds_read_b128 v[120:123], v249 offset:16384
v_and_b32 v213, s47, v213
v_mfma_f32_16x16x32_bf16 v[240:243], v[124:127], v[52:55], 0
ds_read_u16_d16_hi v215, v215
ds_read_u16 v213, v213
s_waitcnt lgkmcnt(7)
v_mfma_f32_16x16x32_f16 v[232:235], v[184:187], v[0:3], v[232:235]
v_pk_mul_f16 v209, v208, v209
v_pk_mul_f16 v144, v144, v145
v_mfma_f32_16x16x32_bf16 v[72:75], v[124:127], v[24:27], 0
ds_read_b128 v[124:127], v251 offset:45056
v_pk_mul_f16 v211, v210, v211
v_mfma_f32_16x16x32_f16 v[236:239], v[184:187], v[136:139], v[236:239]
v_cvt_pkrtz_f16_f32 v180, v180, v181
v_cvt_pkrtz_f16_f32 v181, v182, v183
v_mfma_f32_16x16x32_f16 v[84:87], v[184:187], v[128:131], v[84:87]
ds_read_b128 v[184:187], v249 offset:12544
v_lshrrev_b64 v[180:181], 2, v[180:181]
v_mfma_f32_16x16x32_bf16 v[116:119], v[176:179], v[56:59], v[116:119]
s_setprio 1
v_and_b32_sdwa v182, s47, v180 dst_sel:DWORD dst_unused:UNUSED_PAD src0_sel:DWORD src1_sel:WORD_1
v_and_b32_e64 v180, s47, v180
s_waitcnt lgkmcnt(7)
v_mfma_f32_16x16x32_f16 v[200:203], v[188:191], v[0:3], v[200:203]
ds_read_u16_d16_hi v182, v182
ds_read_u16 v180, v180
v_mfma_f32_16x16x32_bf16 v[240:243], v[176:179], v[60:63], v[240:243]
v_pk_mul_f16 v145, v146, v147
v_exp_f16_sdwa v209, v209 dst_sel:WORD_0 dst_unused:UNUSED_PRESERVE src0_sel:WORD_0
v_mfma_f32_16x16x32_f16 v[204:207], v[188:191], v[136:139], v[204:207]
v_lshl_add_u64 v[148:149], v[148:149], 0, v[150:151]
v_exp_f16_sdwa v211, v211 dst_sel:WORD_0 dst_unused:UNUSED_PRESERVE src0_sel:WORD_0
v_mfma_f32_16x16x32_f16 v[244:247], v[188:191], v[128:131], v[244:247]
ds_read_b128 v[188:191], v251 offset:46080
v_and_b32_sdwa v183, s47, v181 dst_sel:DWORD dst_unused:UNUSED_PAD src0_sel:DWORD src1_sel:WORD_1
v_mfma_f32_16x16x32_bf16 v[72:75], v[176:179], v[32:35], v[72:75]
ds_read_b128 v[176:179], v251 offset:48128
v_and_b32 v181, s47, v181
v_mfma_f32_16x16x32_f16 v[4:7], v[160:163], v[0:3], v[4:7]
ds_read_u16_d16_hi v183, v183
ds_read_u16 v181, v181
s_waitcnt lgkmcnt(8)
v_mfma_f32_16x16x32_bf16 v[116:119], v[120:123], v[64:67], v[116:119]
v_exp_f16_sdwa v209, v209 dst_sel:WORD_1 dst_unused:UNUSED_PRESERVE src0_sel:WORD_1
v_mfma_f32_16x16x32_f16 v[224:227], v[160:163], v[136:139], v[224:227]
v_lshl_add_u64 v[152:153], v[152:153], 0, v[154:155]
v_exp_f16_sdwa v211, v211 dst_sel:WORD_1 dst_unused:UNUSED_PRESERVE src0_sel:WORD_1
v_mfma_f32_16x16x32_f16 v[92:95], v[160:163], v[128:131], v[92:95]
ds_read_b128 v[160:163], v249 offset:14592
v_pk_add_f16 v209, v209, 1.0 op_sel_hi:[1,0]
v_mfma_f32_16x16x32_bf16 v[240:243], v[120:123], v[68:71], v[240:243]
v_pk_add_f16 v211, v211, 1.0 op_sel_hi:[1,0]
v_rcp_f16_sdwa v209, v209 dst_sel:WORD_0 dst_unused:UNUSED_PRESERVE src0_sel:WORD_0
s_waitcnt vmcnt(7)
v_mfma_f32_16x16x32_bf16 v[244:247], v[18:21], v[172:175], v[244:247]
v_rcp_f16_sdwa v211, v211 dst_sel:WORD_0 dst_unused:UNUSED_PRESERVE src0_sel:WORD_0
v_mfma_f32_16x16x32_bf16 v[92:95], v[16:19], v[172:175], v[92:95]
v_cvt_pkrtz_f16_f32 v116, v116, v117
v_cvt_pkrtz_f16_f32 v117, v118, v119
s_waitcnt vmcnt(6)
v_mfma_f32_16x16x32_bf16 v[168:171], v[18:21], v[156:159], v[168:171]
v_lshrrev_b64 v[116:117], 2, v[116:117]
v_and_b32_sdwa v118, s47, v116 dst_sel:DWORD dst_unused:UNUSED_PAD src0_sel:DWORD src1_sel:WORD_1
v_mfma_f32_16x16x32_bf16 v[220:223], v[16:19], v[156:159], v[220:223]
v_and_b32 v116, s47, v116
v_rcp_f16_sdwa v209, v209 dst_sel:WORD_1 dst_unused:UNUSED_PRESERVE src0_sel:WORD_1
s_waitcnt lgkmcnt(1)
v_mfma_f32_16x16x32_f16 v[164:167], v[124:127], v[196:199], v[164:167]
ds_read_u16_d16_hi v118, v118
ds_read_u16 v116, v116
v_mfma_f32_16x16x32_bf16 v[72:75], v[120:123], v[40:43], v[72:75]
ds_read_b128 v[120:123], v251 offset:49152
v_and_b32_sdwa v119, s47, v117 dst_sel:DWORD dst_unused:UNUSED_PAD src0_sel:DWORD src1_sel:WORD_1
v_mfma_f32_16x16x32_f16 v[168:171], v[124:127], v[192:195], v[168:171]
v_and_b32 v117, s47, v117
v_rcp_f16_sdwa v211, v211 dst_sel:WORD_1 dst_unused:UNUSED_PRESERVE src0_sel:WORD_1
v_mfma_f32_16x16x32_f16 v[132:135], v[124:127], v[108:111], v[132:135]
ds_read_b128 v[124:127], v249 offset:16640
ds_read_u16_d16_hi v119, v119
v_mfma_f32_16x16x32_bf16 v[8:11], v[184:187], v[48:51], 0
s_setprio 0
ds_read_u16 v117, v117
v_cvt_pkrtz_f16_f32 v240, v240, v241
v_mfma_f32_16x16x32_f16 v[216:219], v[176:179], v[196:199], v[216:219]
v_cvt_pkrtz_f16_f32 v241, v242, v243
v_lshrrev_b64 v[240:241], 2, v[240:241]
v_mfma_f32_16x16x32_bf16 v[12:15], v[184:187], v[52:55], 0
v_and_b32_sdwa v242, s47, v240 dst_sel:DWORD dst_unused:UNUSED_PAD src0_sel:DWORD src1_sel:WORD_1
v_and_b32_e64 v240, s47, v240
v_mfma_f32_16x16x32_f16 v[220:223], v[176:179], v[192:195], v[220:223]
ds_read_u16_d16_hi v242, v242
ds_read_u16 v240, v240
v_mfma_f32_16x16x32_f16 v[76:79], v[176:179], v[108:111], v[76:79]
ds_read_b128 v[176:179], v251 offset:50176
v_pk_mul_f16 v146, v208, v209
v_mfma_f32_16x16x32_bf16 v[96:99], v[184:187], v[24:27], 0
ds_read_b128 v[184:187], v251 offset:47104
v_and_b32_sdwa v243, s47, v241 dst_sel:DWORD dst_unused:UNUSED_PAD src0_sel:DWORD src1_sel:WORD_1
v_mfma_f32_16x16x32_f16 v[100:103], v[188:191], v[196:199], v[100:103]
v_and_b32 v241, s47, v241
v_pk_mul_f16 v147, v210, v211
v_mfma_f32_16x16x32_f16 v[104:107], v[188:191], v[192:195], v[104:107]
ds_read_u16_d16_hi v243, v243
ds_read_u16 v241, v241
s_waitcnt lgkmcnt(8)
v_mfma_f32_16x16x32_bf16 v[8:11], v[160:163], v[56:59], v[8:11]
v_lshl_add_u64 v[150:151], v[212:213], 0, v[214:215]
v_cvt_pkrtz_f16_f32 v72, v72, v73
v_mfma_f32_16x16x32_f16 v[140:143], v[188:191], v[108:111], v[140:143]
ds_read_b128 v[188:191], v249 offset:18432
v_cvt_pkrtz_f16_f32 v73, v74, v75
v_mfma_f32_16x16x32_bf16 v[12:15], v[160:163], v[60:63], v[12:15]
v_lshrrev_b64 v[72:73], 2, v[72:73]
v_and_b32_sdwa v74, s47, v72 dst_sel:DWORD dst_unused:UNUSED_PAD src0_sel:DWORD src1_sel:WORD_1
v_mfma_f32_16x16x32_f16 v[232:235], v[120:123], v[196:199], v[232:235]
v_and_b32_e64 v72, s47, v72
v_and_b32_sdwa v75, s47, v73 dst_sel:DWORD dst_unused:UNUSED_PAD src0_sel:DWORD src1_sel:WORD_1
v_mfma_f32_16x16x32_f16 v[236:239], v[120:123], v[192:195], v[236:239]
ds_read_u16_d16_hi v74, v74
ds_read_u16 v72, v72
v_mfma_f32_16x16x32_bf16 v[96:99], v[160:163], v[32:35], v[96:99]
ds_read_b128 v[160:163], v251 offset:51200
v_and_b32_e64 v73, s47, v73
v_mfma_f32_16x16x32_f16 v[84:87], v[120:123], v[108:111], v[84:87]
ds_read_b128 v[120:123], v249 offset:20480
ds_read_u16_d16_hi v75, v75
ds_read_u16 v73, v73
s_setprio 3
v_mfma_f32_16x16x32_bf16 v[8:11], v[124:127], v[64:67], v[8:11]
v_lshl_add_u64 v[154:155], v[180:181], 0, v[182:183]
s_waitcnt lgkmcnt(9)
v_mfma_f32_16x16x32_f16 v[200:203], v[184:187], v[196:199], v[200:203]
v_mfma_f32_16x16x32_f16 v[204:207], v[184:187], v[192:195], v[204:207]
s_nop 3
v_cvt_pk_f16_f32 v8, v8, v9
v_mfma_f32_16x16x32_bf16 v[12:15], v[124:127], v[68:71], v[12:15]
v_cvt_pk_f16_f32 v10, v10, v11
v_pk_fma_f16 v9, v8, v8, s48
v_mfma_f32_16x16x32_f16 v[244:247], v[184:187], v[108:111], v[244:247]
ds_read_b128 v[184:187], v249 offset:22528
v_pk_fma_f16 v11, v10, v10, s48
v_mfma_f32_16x16x32_bf16 v[96:99], v[124:127], v[40:43], v[96:99]
ds_read_b128 v[124:127], v251 offset:54272
s_nop 0
v_cvt_pkrtz_f16_f32 v12, v12, v13
v_mfma_f32_16x16x32_f16 v[4:7], v[176:179], v[196:199], v[4:7]
v_cvt_pkrtz_f16_f32 v13, v14, v15
v_lshrrev_b64 v[12:13], 2, v[12:13]
v_mfma_f32_16x16x32_f16 v[224:227], v[176:179], v[192:195], v[224:227]
buffer_load_dwordx4 v[128:131], v250, s[32:35], s80 offen
s_add_u32 s46, s80, 2097152
buffer_load_dwordx4 v[136:139], v250, s[32:35], s46 offen
v_and_b32_sdwa v14, s47, v12 dst_sel:DWORD dst_unused:UNUSED_PAD src0_sel:DWORD src1_sel:WORD_1
s_waitcnt lgkmcnt(5)
v_mfma_f32_16x16x32_bf16 v[0:3], v[188:191], v[48:51], 0
v_and_b32 v12, s47, v12
v_and_b32_sdwa v15, s47, v13 dst_sel:DWORD dst_unused:UNUSED_PAD src0_sel:DWORD src1_sel:WORD_1
v_mfma_f32_16x16x32_f16 v[92:95], v[176:179], v[108:111], v[92:95]
ds_read_b128 v[176:179], v251 offset:52224
ds_read_u16_d16_hi v14, v14
v_mfma_f32_16x16x32_bf16 v[172:175], v[188:191], v[52:55], 0
ds_read_u16 v12, v12
v_and_b32_e64 v13, s47, v13
v_mfma_f32_16x16x32_f16 v[164:167], v[160:163], v[152:155], v[164:167]
ds_read_u16_d16_hi v15, v15
ds_read_u16 v13, v13
v_mfma_f32_16x16x32_bf16 v[156:159], v[188:191], v[24:27], 0
ds_read_b128 v[188:191], v249 offset:18688
v_pk_mul_f16 v9, v8, v9
v_mfma_f32_16x16x32_f16 v[168:171], v[160:163], v[148:151], v[168:171]
s_setprio 2
v_pk_mul_f16 v11, v10, v11
v_cvt_pkrtz_f16_f32 v96, v96, v97
s_waitcnt lgkmcnt(6)
v_mfma_f32_16x16x32_bf16 v[0:3], v[120:123], v[56:59], v[0:3]
v_cvt_pkrtz_f16_f32 v97, v98, v99
v_lshrrev_b64 v[96:97], 2, v[96:97]
v_mfma_f32_16x16x32_f16 v[132:135], v[160:163], v[144:147], v[132:135]
ds_read_b128 v[160:163], v251 offset:55296
v_and_b32_sdwa v98, s47, v96 dst_sel:DWORD dst_unused:UNUSED_PAD src0_sel:DWORD src1_sel:WORD_1
v_mfma_f32_16x16x32_bf16 v[172:175], v[120:123], v[60:63], v[172:175]
v_and_b32_e64 v96, s47, v96
v_lshl_add_u64 v[116:117], v[116:117], 0, v[118:119]
v_mfma_f32_16x16x32_f16 v[216:219], v[124:127], v[152:155], v[216:219]
ds_read_u16_d16_hi v98, v98
ds_read_u16 v96, v96
v_exp_f16_sdwa v9, v9 dst_sel:WORD_0 dst_unused:UNUSED_PRESERVE src0_sel:WORD_0
v_mfma_f32_16x16x32_bf16 v[156:159], v[120:123], v[32:35], v[156:159]
ds_read_b128 v[120:123], v249 offset:20736
v_exp_f16_sdwa v11, v11 dst_sel:WORD_0 dst_unused:UNUSED_PRESERVE src0_sel:WORD_0
v_mfma_f32_16x16x32_f16 v[220:223], v[124:127], v[148:151], v[220:223]
v_and_b32_sdwa v99, s47, v97 dst_sel:DWORD dst_unused:UNUSED_PAD src0_sel:DWORD src1_sel:WORD_1
v_and_b32_e64 v97, s47, v97
v_mfma_f32_16x16x32_bf16 v[0:3], v[184:187], v[64:67], v[0:3]
ds_read_u16_d16_hi v99, v99
ds_read_u16 v97, v97
v_lshl_add_u64 v[240:241], v[240:241], 0, v[242:243]
v_mfma_f32_16x16x32_f16 v[76:79], v[124:127], v[144:147], v[76:79]
ds_read_b128 v[124:127], v251 offset:53248
v_exp_f16_sdwa v9, v9 dst_sel:WORD_1 dst_unused:UNUSED_PRESERVE src0_sel:WORD_1
v_mfma_f32_16x16x32_bf16 v[172:175], v[184:187], v[68:71], v[172:175]
v_exp_f16_sdwa v11, v11 dst_sel:WORD_1 dst_unused:UNUSED_PRESERVE src0_sel:WORD_1
s_waitcnt lgkmcnt(7)
v_mfma_f32_16x16x32_f16 v[100:103], v[176:179], v[152:155], v[100:103]
v_lshl_add_u64 v[72:73], v[72:73], 0, v[74:75]
v_pk_add_f16 v9, v9, 1.0 op_sel_hi:[1,0]
v_mfma_f32_16x16x32_bf16 v[156:159], v[184:187], v[40:43], v[156:159]
ds_read_b128 v[184:187], v249 offset:22784
v_pk_add_f16 v11, v11, 1.0 op_sel_hi:[1,0]
v_mfma_f32_16x16x32_f16 v[104:107], v[176:179], v[148:151], v[104:107]
s_setprio 1
v_rcp_f16_sdwa v9, v9 dst_sel:WORD_0 dst_unused:UNUSED_PRESERVE src0_sel:WORD_0
v_mfma_f32_16x16x32_bf16 v[208:211], v[188:191], v[48:51], 0
v_rcp_f16_sdwa v11, v11 dst_sel:WORD_0 dst_unused:UNUSED_PRESERVE src0_sel:WORD_0
v_mfma_f32_16x16x32_f16 v[140:143], v[176:179], v[144:147], v[140:143]
ds_read_b128 v[176:179], v251 offset:56320
v_cvt_pkrtz_f16_f32 v172, v172, v173
v_mfma_f32_16x16x32_bf16 v[212:215], v[188:191], v[52:55], 0
v_cvt_pkrtz_f16_f32 v173, v174, v175
v_lshrrev_b64 v[172:173], 2, v[172:173]
s_waitcnt lgkmcnt(4)
v_mfma_f32_16x16x32_f16 v[232:235], v[160:163], v[152:155], v[232:235]
v_and_b32_sdwa v174, s47, v172 dst_sel:DWORD dst_unused:UNUSED_PAD src0_sel:DWORD src1_sel:WORD_1
v_and_b32 v172, s47, v172
v_cvt_pk_f16_f32 v0, v0, v1
v_mfma_f32_16x16x32_bf16 v[180:183], v[188:191], v[24:27], 0
ds_read_u16_d16_hi v174, v174
ds_read_u16 v172, v172
ds_read_b128 v[188:191], v249 offset:24576
v_rcp_f16_sdwa v9, v9 dst_sel:WORD_1 dst_unused:UNUSED_PRESERVE src0_sel:WORD_1
v_mfma_f32_16x16x32_f16 v[236:239], v[160:163], v[148:151], v[236:239]
v_cvt_pk_f16_f32 v2, v2, v3
v_pk_fma_f16 v1, v0, v0, s48
v_rcp_f16_sdwa v11, v11 dst_sel:WORD_1 dst_unused:UNUSED_PRESERVE src0_sel:WORD_1
s_add_u32 s46, s80, 4194304
buffer_load_dwordx4 v[108:111], v250, s[32:35], s46 offen
s_add_u32 s46, s80, 6291456
buffer_load_dwordx4 v[192:195], v250, s[32:35], s46 offen
v_mfma_f32_16x16x32_bf16 v[208:211], v[120:123], v[56:59], v[208:211]
v_and_b32_sdwa v175, s47, v173 dst_sel:DWORD dst_unused:UNUSED_PAD src0_sel:DWORD src1_sel:WORD_1
v_and_b32_e64 v173, s47, v173
v_pk_fma_f16 v3, v2, v2, s48
v_mfma_f32_16x16x32_f16 v[84:87], v[160:163], v[144:147], v[84:87]
ds_read_u16_d16_hi v175, v175
ds_read_u16 v173, v173
ds_read_b128 v[160:163], v251 offset:57344
v_pk_mul_f16 v1, v0, v1
v_pk_mul_f16 v118, v8, v9
v_mfma_f32_16x16x32_bf16 v[212:215], v[120:123], v[60:63], v[212:215]
v_pk_mul_f16 v3, v2, v3
buffer_load_dwordx4 v[196:199], v253, s[4:7], s69 offen offset:128
s_waitcnt lgkmcnt(6)
v_mfma_f32_16x16x32_f16 v[200:203], v[124:127], v[152:155], v[200:203]
v_cvt_pkrtz_f16_f32 v156, v156, v157
v_cvt_pkrtz_f16_f32 v157, v158, v159
v_lshrrev_b64 v[156:157], 2, v[156:157]
v_and_b32_sdwa v158, s47, v156 dst_sel:DWORD dst_unused:UNUSED_PAD src0_sel:DWORD src1_sel:WORD_1
v_and_b32 v156, s47, v156
v_pk_mul_f16 v119, v10, v11
v_exp_f16_sdwa v1, v1 dst_sel:WORD_0 dst_unused:UNUSED_PRESERVE src0_sel:WORD_0
v_lshl_add_u64 v[242:243], v[12:13], 0, v[14:15]
v_mfma_f32_16x16x32_bf16 v[180:183], v[120:123], v[32:35], v[180:183]
ds_read_u16_d16_hi v158, v158
ds_read_u16 v156, v156
ds_read_b128 v[120:123], v249 offset:26624
v_mfma_f32_16x16x32_f16 v[204:207], v[124:127], v[148:151], v[204:207]
v_exp_f16_sdwa v3, v3 dst_sel:WORD_0 dst_unused:UNUSED_PRESERVE src0_sel:WORD_0
v_and_b32_sdwa v159, s47, v157 dst_sel:DWORD dst_unused:UNUSED_PAD src0_sel:DWORD src1_sel:WORD_1
v_and_b32 v157, s47, v157
v_mfma_f32_16x16x32_bf16 v[208:211], v[184:187], v[64:67], v[208:211]
ds_read_u16_d16_hi v159, v159
ds_read_u16 v157, v157
s_setprio 0
v_mfma_f32_16x16x32_f16 v[244:247], v[124:127], v[144:147], v[244:247]
ds_read_b128 v[124:127], v251 offset:60416
v_exp_f16_sdwa v1, v1 dst_sel:WORD_1 dst_unused:UNUSED_PRESERVE src0_sel:WORD_1
v_mfma_f32_16x16x32_bf16 v[212:215], v[184:187], v[68:71], v[212:215]
v_lshl_add_u64 v[74:75], v[96:97], 0, v[98:99]
v_exp_f16_sdwa v3, v3 dst_sel:WORD_1 dst_unused:UNUSED_PRESERVE src0_sel:WORD_1
v_mfma_f32_16x16x32_f16 v[4:7], v[176:179], v[152:155], v[4:7]
v_pk_add_f16 v1, v1, 1.0 op_sel_hi:[1,0]
v_pk_add_f16 v3, v3, 1.0 op_sel_hi:[1,0]
v_mfma_f32_16x16x32_bf16 v[180:183], v[184:187], v[40:43], v[180:183]
ds_read_b128 v[184:187], v249 offset:28672
v_rcp_f16_sdwa v1, v1 dst_sel:WORD_0 dst_unused:UNUSED_PRESERVE src0_sel:WORD_0
v_mfma_f32_16x16x32_f16 v[224:227], v[176:179], v[148:151], v[224:227]
v_rcp_f16_sdwa v3, v3 dst_sel:WORD_0 dst_unused:UNUSED_PRESERVE src0_sel:WORD_0
s_waitcnt lgkmcnt(6)
v_mfma_f32_16x16x32_bf16 v[8:11], v[188:191], v[48:51], 0
v_cvt_pkrtz_f16_f32 v208, v208, v209
v_cvt_pkrtz_f16_f32 v209, v210, v211
v_mfma_f32_16x16x32_f16 v[92:95], v[176:179], v[144:147], v[92:95]
ds_read_b128 v[176:179], v251 offset:58368
v_lshrrev_b64 v[208:209], 2, v[208:209]
s_waitcnt vmcnt(8)
v_mfma_f32_16x16x32_bf16 v[104:107], v[18:21], v[80:83], v[104:107]
v_and_b32_sdwa v210, s47, v208 dst_sel:DWORD dst_unused:UNUSED_PAD src0_sel:DWORD src1_sel:WORD_1
v_and_b32 v208, s47, v208
v_mfma_f32_16x16x32_bf16 v[236:239], v[16:19], v[80:83], v[236:239]
ds_read_u16_d16_hi v210, v210
ds_read_u16 v208, v208
s_waitcnt vmcnt(7)
v_mfma_f32_16x16x32_bf16 v[204:207], v[18:21], v[88:91], v[204:207]
v_rcp_f16_sdwa v1, v1 dst_sel:WORD_1 dst_unused:UNUSED_PRESERVE src0_sel:WORD_1
v_mfma_f32_16x16x32_bf16 v[224:227], v[16:19], v[88:91], v[224:227]
v_and_b32_sdwa v211, s47, v209 dst_sel:DWORD dst_unused:UNUSED_PAD src0_sel:DWORD src1_sel:WORD_1
v_and_b32_e64 v209, s47, v209
v_mfma_f32_16x16x32_bf16 v[12:15], v[188:191], v[52:55], 0
ds_read_u16_d16_hi v211, v211
ds_read_u16 v209, v209
v_mfma_f32_16x16x32_f16 v[164:167], v[160:163], v[72:75], v[164:167]
v_rcp_f16_sdwa v3, v3 dst_sel:WORD_1 dst_unused:UNUSED_PRESERVE src0_sel:WORD_1
v_mfma_f32_16x16x32_bf16 v[96:99], v[188:191], v[24:27], 0
ds_read_b128 v[188:191], v249 offset:24832
v_cvt_pkrtz_f16_f32 v212, v212, v213
v_mfma_f32_16x16x32_f16 v[168:171], v[160:163], v[240:243], v[168:171]
s_setprio 3
v_cvt_pkrtz_f16_f32 v213, v214, v215
v_lshrrev_b64 v[212:213], 2, v[212:213]
s_waitcnt lgkmcnt(5)
v_mfma_f32_16x16x32_bf16 v[8:11], v[120:123], v[56:59], v[8:11]
v_and_b32_sdwa v214, s47, v212 dst_sel:DWORD dst_unused:UNUSED_PAD src0_sel:DWORD src1_sel:WORD_1
v_and_b32_e64 v212, s47, v212
v_mfma_f32_16x16x32_f16 v[132:135], v[160:163], v[116:119], v[132:135]
ds_read_b128 v[160:163], v251 offset:61440
ds_read_u16_d16_hi v214, v214
ds_read_u16 v212, v212
v_pk_mul_f16 v0, v0, v1
v_mfma_f32_16x16x32_bf16 v[12:15], v[120:123], v[60:63], v[12:15]
v_and_b32_sdwa v215, s47, v213 dst_sel:DWORD dst_unused:UNUSED_PAD src0_sel:DWORD src1_sel:WORD_1
v_and_b32_e64 v213, s47, v213
v_mfma_f32_16x16x32_f16 v[216:219], v[124:127], v[72:75], v[216:219]
ds_read_u16_d16_hi v215, v215
ds_read_u16 v213, v213
v_pk_mul_f16 v1, v2, v3
v_lshl_add_u64 v[172:173], v[172:173], 0, v[174:175]
v_mfma_f32_16x16x32_bf16 v[96:99], v[120:123], v[32:35], v[96:99]
ds_read_b128 v[120:123], v249 offset:26880
v_cvt_pkrtz_f16_f32 v180, v180, v181
v_cvt_pkrtz_f16_f32 v181, v182, v183
v_lshrrev_b64 v[180:181], 2, v[180:181]
v_and_b32_sdwa v182, s47, v180 dst_sel:DWORD dst_unused:UNUSED_PAD src0_sel:DWORD src1_sel:WORD_1
v_and_b32_e64 v180, s47, v180
v_mfma_f32_16x16x32_f16 v[220:223], v[124:127], v[240:243], v[220:223]
ds_read_u16_d16_hi v182, v182
ds_read_u16 v180, v180
v_and_b32_sdwa v183, s47, v181 dst_sel:DWORD dst_unused:UNUSED_PAD src0_sel:DWORD src1_sel:WORD_1
v_and_b32 v181, s47, v181
v_mfma_f32_16x16x32_bf16 v[8:11], v[184:187], v[64:67], v[8:11]
ds_read_u16_d16_hi v183, v183
ds_read_u16 v181, v181
s_add_u32 s46, s80, 8388608
buffer_load_dwordx4 v[144:147], v250, s[32:35], s46 offen
s_add_u32 s46, s80, 10485760
buffer_load_dwordx4 v[148:151], v250, s[32:35], s46 offen
v_mfma_f32_16x16x32_f16 v[76:79], v[124:127], v[116:119], v[76:79]
s_waitcnt lgkmcnt(9)
ds_read_b128 v[124:127], v251 offset:59392
v_lshl_add_u64 v[156:157], v[156:157], 0, v[158:159]
v_mfma_f32_16x16x32_bf16 v[12:15], v[184:187], v[68:71], v[12:15]
v_cvt_pk_f16_f32 v8, v8, v9
v_cvt_pk_f16_f32 v10, v10, v11
v_mfma_f32_16x16x32_f16 v[100:103], v[176:179], v[72:75], v[100:103]
v_pk_fma_f16 v9, v8, v8, s48
v_pk_fma_f16 v11, v10, v10, s48
v_mfma_f32_16x16x32_bf16 v[96:99], v[184:187], v[40:43], v[96:99]
ds_read_b128 v[184:187], v249 offset:28928
s_nop 0
v_cvt_pkrtz_f16_f32 v12, v12, v13
v_mfma_f32_16x16x32_f16 v[104:107], v[176:179], v[240:243], v[104:107]
s_setprio 2
v_cvt_pkrtz_f16_f32 v13, v14, v15
v_lshrrev_b64 v[12:13], 2, v[12:13]
v_mfma_f32_16x16x32_bf16 v[152:155], v[188:191], v[48:51], 0
v_and_b32_sdwa v14, s47, v12 dst_sel:DWORD dst_unused:UNUSED_PAD src0_sel:DWORD src1_sel:WORD_1
v_and_b32_e64 v12, s47, v12
v_mfma_f32_16x16x32_f16 v[140:143], v[176:179], v[116:119], v[140:143]
ds_read_b128 v[176:179], v251 offset:62464
ds_read_u16_d16_hi v14, v14
v_mfma_f32_16x16x32_bf16 v[80:83], v[188:191], v[52:55], 0
ds_read_u16 v12, v12
v_and_b32_sdwa v15, s47, v13 dst_sel:DWORD dst_unused:UNUSED_PAD src0_sel:DWORD src1_sel:WORD_1
v_mfma_f32_16x16x32_f16 v[232:235], v[160:163], v[72:75], v[232:235]
v_and_b32 v13, s47, v13
v_pk_mul_f16 v9, v8, v9
v_mfma_f32_16x16x32_bf16 v[88:91], v[188:191], v[24:27], 0
ds_read_b128 v[188:191], v249 offset:30720
s_waitcnt lgkmcnt(8)
ds_read_u16_d16_hi v15, v15
v_mfma_f32_16x16x32_f16 v[236:239], v[160:163], v[240:243], v[236:239]
ds_read_u16 v13, v13
v_pk_mul_f16 v11, v10, v11
v_mfma_f32_16x16x32_bf16 v[152:155], v[120:123], v[56:59], v[152:155]
v_cvt_pkrtz_f16_f32 v96, v96, v97
v_cvt_pkrtz_f16_f32 v97, v98, v99
v_mfma_f32_16x16x32_f16 v[84:87], v[160:163], v[116:119], v[84:87]
ds_read_b128 v[160:163], v251 offset:63488
v_lshrrev_b64 v[96:97], 2, v[96:97]
v_mfma_f32_16x16x32_bf16 v[80:83], v[120:123], v[60:63], v[80:83]
v_and_b32_sdwa v98, s47, v96 dst_sel:DWORD dst_unused:UNUSED_PAD src0_sel:DWORD src1_sel:WORD_1
v_and_b32 v96, s47, v96
s_waitcnt lgkmcnt(7)
v_mfma_f32_16x16x32_f16 v[200:203], v[124:127], v[72:75], v[200:203]
ds_read_u16_d16_hi v98, v98
ds_read_u16 v96, v96
v_lshl_add_u64 v[2:3], v[208:209], 0, v[210:211]
v_exp_f16_sdwa v9, v9 dst_sel:WORD_0 dst_unused:UNUSED_PRESERVE src0_sel:WORD_0
v_mfma_f32_16x16x32_bf16 v[88:91], v[120:123], v[32:35], v[88:91]
ds_read_b128 v[120:123], v249 offset:32768
v_exp_f16_sdwa v11, v11 dst_sel:WORD_0 dst_unused:UNUSED_PRESERVE src0_sel:WORD_0
v_mfma_f32_16x16x32_f16 v[204:207], v[124:127], v[240:243], v[204:207]
s_setprio 1
v_and_b32_sdwa v99, s47, v97 dst_sel:DWORD dst_unused:UNUSED_PAD src0_sel:DWORD src1_sel:WORD_1
v_and_b32_e64 v97, s47, v97
v_mfma_f32_16x16x32_bf16 v[152:155], v[184:187], v[64:67], v[152:155]
ds_read_u16_d16_hi v99, v99
ds_read_u16 v97, v97
v_lshl_add_u64 v[174:175], v[212:213], 0, v[214:215]
v_mfma_f32_16x16x32_f16 v[244:247], v[124:127], v[116:119], v[244:247]
ds_read_b128 v[124:127], v252 offset:1024
v_exp_f16_sdwa v9, v9 dst_sel:WORD_1 dst_unused:UNUSED_PRESERVE src0_sel:WORD_1
v_mfma_f32_16x16x32_bf16 v[80:83], v[184:187], v[68:71], v[80:83]
v_exp_f16_sdwa v11, v11 dst_sel:WORD_1 dst_unused:UNUSED_PRESERVE src0_sel:WORD_1
s_waitcnt lgkmcnt(7)
v_mfma_f32_16x16x32_f16 v[4:7], v[176:179], v[72:75], v[4:7]
v_lshl_add_u64 v[158:159], v[180:181], 0, v[182:183]
v_pk_add_f16 v9, v9, 1.0 op_sel_hi:[1,0]
v_mfma_f32_16x16x32_bf16 v[88:91], v[184:187], v[40:43], v[88:91]
ds_read_b128 v[184:187], v249 offset:34816
v_pk_add_f16 v11, v11, 1.0 op_sel_hi:[1,0]
v_mfma_f32_16x16x32_f16 v[224:227], v[176:179], v[240:243], v[224:227]
v_rcp_f16_sdwa v9, v9 dst_sel:WORD_0 dst_unused:UNUSED_PRESERVE src0_sel:WORD_0
v_mfma_f32_16x16x32_bf16 v[208:211], v[188:191], v[48:51], 0
v_rcp_f16_sdwa v11, v11 dst_sel:WORD_0 dst_unused:UNUSED_PRESERVE src0_sel:WORD_0
v_mfma_f32_16x16x32_f16 v[92:95], v[176:179], v[116:119], v[92:95]
ds_read_b128 v[176:179], v251 offset:64512
v_cvt_pkrtz_f16_f32 v80, v80, v81
v_mfma_f32_16x16x32_bf16 v[212:215], v[188:191], v[52:55], 0
v_cvt_pkrtz_f16_f32 v81, v82, v83
v_lshrrev_b64 v[80:81], 2, v[80:81]
s_waitcnt lgkmcnt(5)
v_mfma_f32_16x16x32_f16 v[164:167], v[160:163], v[156:159], v[164:167]
v_and_b32_sdwa v82, s47, v80 dst_sel:DWORD dst_unused:UNUSED_PAD src0_sel:DWORD src1_sel:WORD_1
v_and_b32 v80, s47, v80
v_cvt_pk_f16_f32 v152, v152, v153
v_mfma_f32_16x16x32_bf16 v[180:183], v[188:191], v[24:27], 0
ds_read_u16_d16_hi v82, v82
ds_read_u16 v80, v80
ds_read_b128 v[188:191], v249 offset:30976
v_rcp_f16_sdwa v9, v9 dst_sel:WORD_1 dst_unused:UNUSED_PRESERVE src0_sel:WORD_1
s_setprio 0
v_mfma_f32_16x16x32_f16 v[168:171], v[160:163], v[172:175], v[168:171]
v_cvt_pk_f16_f32 v154, v154, v155
v_pk_fma_f16 v153, v152, v152, s48
v_rcp_f16_sdwa v11, v11 dst_sel:WORD_1 dst_unused:UNUSED_PRESERVE src0_sel:WORD_1
v_mfma_f32_16x16x32_bf16 v[208:211], v[120:123], v[56:59], v[208:211]
v_and_b32_sdwa v83, s47, v81 dst_sel:DWORD dst_unused:UNUSED_PAD src0_sel:DWORD src1_sel:WORD_1
v_and_b32 v81, s47, v81
v_pk_fma_f16 v155, v154, v154, s48
v_mfma_f32_16x16x32_f16 v[132:135], v[160:163], v[0:3], v[132:135]
ds_read_u16_d16_hi v83, v83
ds_read_u16 v81, v81
ds_read_b128 v[160:163], v252 offset:2048
v_pk_mul_f16 v153, v152, v153
v_pk_mul_f16 v8, v8, v9
v_mfma_f32_16x16x32_bf16 v[212:215], v[120:123], v[60:63], v[212:215]
v_pk_mul_f16 v155, v154, v155
v_cvt_pkrtz_f16_f32 v88, v88, v89
s_waitcnt lgkmcnt(6)
v_mfma_f32_16x16x32_f16 v[216:219], v[124:127], v[156:159], v[216:219]
v_cvt_pkrtz_f16_f32 v89, v90, v91
v_lshrrev_b64 v[88:89], 2, v[88:89]
v_and_b32_sdwa v90, s47, v88 dst_sel:DWORD dst_unused:UNUSED_PAD src0_sel:DWORD src1_sel:WORD_1
v_and_b32 v88, s47, v88
v_pk_mul_f16 v9, v10, v11
v_exp_f16_sdwa v153, v153 dst_sel:WORD_0 dst_unused:UNUSED_PRESERVE src0_sel:WORD_0
v_lshl_add_u64 v[12:13], v[12:13], 0, v[14:15]
v_mfma_f32_16x16x32_bf16 v[180:183], v[120:123], v[32:35], v[180:183]
ds_read_u16_d16_hi v90, v90
ds_read_u16 v88, v88
v_mfma_f32_16x16x32_f16 v[220:223], v[124:127], v[172:175], v[220:223]
ds_read_b128 v[120:123], v249 offset:35072
v_exp_f16_sdwa v155, v155 dst_sel:WORD_0 dst_unused:UNUSED_PRESERVE src0_sel:WORD_0
v_and_b32_sdwa v91, s47, v89 dst_sel:DWORD dst_unused:UNUSED_PAD src0_sel:DWORD src1_sel:WORD_1
v_and_b32_e64 v89, s47, v89
v_mfma_f32_16x16x32_bf16 v[208:211], v[184:187], v[64:67], v[208:211]
ds_read_u16_d16_hi v91, v91
ds_read_u16 v89, v89
s_waitcnt vmcnt(5)
v_permlane16_swap_b32 v128, v136
v_permlane16_swap_b32 v129, v137
v_permlane16_swap_b32 v130, v138
v_permlane16_swap_b32 v131, v139
s_waitcnt vmcnt(3)
v_permlane16_swap_b32 v108, v192
v_permlane16_swap_b32 v109, v193
v_permlane16_swap_b32 v110, v194
v_permlane16_swap_b32 v111, v195
v_mfma_f32_16x16x32_f16 v[76:79], v[124:127], v[0:3], v[76:79]
v_exp_f16_sdwa v153, v153 dst_sel:WORD_1 dst_unused:UNUSED_PRESERVE src0_sel:WORD_1
v_mfma_f32_16x16x32_bf16 v[212:215], v[184:187], v[68:71], v[212:215]
ds_read_b128 v[124:127], v252 offset:3072
v_lshl_add_u64 v[96:97], v[96:97], 0, v[98:99]
v_mfma_f32_16x16x32_f16 v[100:103], v[176:179], v[156:159], v[100:103]
v_exp_f16_sdwa v155, v155 dst_sel:WORD_1 dst_unused:UNUSED_PRESERVE src0_sel:WORD_1
v_mfma_f32_16x16x32_bf16 v[180:183], v[184:187], v[40:43], v[180:183]
s_setprio 3
v_pk_add_f16 v153, v153, 1.0 op_sel_hi:[1,0]
v_pk_add_f16 v155, v155, 1.0 op_sel_hi:[1,0]
v_mfma_f32_16x16x32_f16 v[104:107], v[176:179], v[172:175], v[104:107]
ds_read_b128 v[184:187], v248
v_rcp_f16_sdwa v153, v153 dst_sel:WORD_0 dst_unused:UNUSED_PRESERVE src0_sel:WORD_0
s_waitcnt lgkmcnt(4)
v_mfma_f32_16x16x32_bf16 v[116:119], v[188:191], v[48:51], 0
ds_read_b128 v[48:51], v252
v_rcp_f16_sdwa v155, v155 dst_sel:WORD_0 dst_unused:UNUSED_PRESERVE src0_sel:WORD_0
v_mfma_f32_16x16x32_f16 v[140:143], v[176:179], v[0:3], v[140:143]
ds_read_b128 v[176:179], v252 offset:4096
v_cvt_pkrtz_f16_f32 v208, v208, v209
v_mfma_f32_16x16x32_bf16 v[240:243], v[188:191], v[52:55], 0
ds_read_b128 v[52:55], v249 offset:33024
v_cvt_pkrtz_f16_f32 v209, v210, v211
v_mfma_f32_16x16x32_f16 v[232:235], v[160:163], v[156:159], v[232:235]
v_lshrrev_b64 v[208:209], 2, v[208:209]
v_and_b32_sdwa v210, s47, v208 dst_sel:DWORD dst_unused:UNUSED_PAD src0_sel:DWORD src1_sel:WORD_1
v_and_b32_e64 v208, s47, v208
v_mfma_f32_16x16x32_bf16 v[72:75], v[188:191], v[24:27], 0
ds_read_u16_d16_hi v210, v210
ds_read_u16 v208, v208
v_rcp_f16_sdwa v153, v153 dst_sel:WORD_1 dst_unused:UNUSED_PRESERVE src0_sel:WORD_1
v_mfma_f32_16x16x32_f16 v[236:239], v[160:163], v[172:175], v[236:239]
ds_read_b128 v[188:191], v248 offset:2048
v_and_b32_sdwa v211, s47, v209 dst_sel:DWORD dst_unused:UNUSED_PAD src0_sel:DWORD src1_sel:WORD_1
v_and_b32_e64 v209, s47, v209
v_rcp_f16_sdwa v155, v155 dst_sel:WORD_1 dst_unused:UNUSED_PRESERVE src0_sel:WORD_1
ds_read_u16_d16_hi v211, v211
ds_read_u16 v209, v209
s_waitcnt lgkmcnt(5)
v_mfma_f32_16x16x32_bf16 v[116:119], v[52:55], v[56:59], v[116:119]
s_waitcnt vmcnt(0)
v_permlane16_swap_b32 v144, v148
v_permlane16_swap_b32 v145, v149
v_permlane16_swap_b32 v146, v150
v_permlane16_swap_b32 v147, v151
v_mfma_f32_16x16x32_f16 v[84:87], v[160:163], v[0:3], v[84:87]
v_cvt_pkrtz_f16_f32 v212, v212, v213
v_cvt_pkrtz_f16_f32 v213, v214, v215
v_lshrrev_b64 v[212:213], 2, v[212:213]
v_and_b32_sdwa v214, s47, v212 dst_sel:DWORD dst_unused:UNUSED_PAD src0_sel:DWORD src1_sel:WORD_1
v_and_b32_e64 v212, s47, v212
v_pk_mul_f16 v10, v152, v153
v_mfma_f32_16x16x32_bf16 v[240:243], v[52:55], v[60:63], v[240:243]
ds_read_u16_d16_hi v214, v214
ds_read_u16 v212, v212
ds_read_b128 v[160:163], v252 offset:7168
v_mfma_f32_16x16x32_f16 v[200:203], v[48:51], v[156:159], v[200:203]
v_and_b32_sdwa v215, s47, v213 dst_sel:DWORD dst_unused:UNUSED_PAD src0_sel:DWORD src1_sel:WORD_1
v_and_b32_e64 v213, s47, v213
v_pk_mul_f16 v11, v154, v155
v_lshl_add_u64 v[14:15], v[80:81], 0, v[82:83]
v_mfma_f32_16x16x32_bf16 v[72:75], v[52:55], v[32:35], v[72:75]
ds_read_u16_d16_hi v215, v215
ds_read_u16 v213, v213
s_setprio 2
v_cvt_pkrtz_f16_f32 v180, v180, v181
v_cvt_pkrtz_f16_f32 v181, v182, v183
v_lshrrev_b64 v[180:181], 2, v[180:181]
v_and_b32_sdwa v182, s47, v180 dst_sel:DWORD dst_unused:UNUSED_PAD src0_sel:DWORD src1_sel:WORD_1
v_and_b32 v180, s47, v180
v_mfma_f32_16x16x32_f16 v[204:207], v[48:51], v[172:175], v[204:207]
ds_read_u16_d16_hi v182, v182
ds_read_u16 v180, v180
ds_read_b128 v[52:55], v248 offset:4096
v_and_b32_sdwa v183, s47, v181 dst_sel:DWORD dst_unused:UNUSED_PAD src0_sel:DWORD src1_sel:WORD_1
v_and_b32_e64 v181, s47, v181
v_mfma_f32_16x16x32_bf16 v[116:119], v[120:123], v[64:67], v[116:119]
ds_read_u16_d16_hi v183, v183
ds_read_u16 v181, v181
v_mfma_f32_16x16x32_f16 v[244:247], v[48:51], v[0:3], v[244:247]
s_waitcnt lgkmcnt(10)
ds_read_b128 v[48:51], v252 offset:5120
v_lshl_add_u64 v[98:99], v[88:89], 0, v[90:91]
v_mfma_f32_16x16x32_bf16 v[240:243], v[120:123], v[68:71], v[240:243]
s_nop 0
v_cvt_pk_f16_f32 v116, v116, v117
v_mfma_f32_16x16x32_f16 v[4:7], v[124:127], v[156:159], v[4:7]
v_cvt_pk_f16_f32 v118, v118, v119
v_pk_fma_f16 v117, v116, v116, s48
v_mfma_f32_16x16x32_bf16 v[72:75], v[120:123], v[40:43], v[72:75]
ds_read_b128 v[120:123], v248 offset:256
s_nop 0
v_cvt_pkrtz_f16_f32 v240, v240, v241
v_mfma_f32_16x16x32_f16 v[224:227], v[124:127], v[172:175], v[224:227]
v_cvt_pkrtz_f16_f32 v241, v242, v243
v_lshrrev_b64 v[240:241], 2, v[240:241]
v_mfma_f32_16x16x32_bf16 v[24:27], v[184:187], v[28:31], 0
v_and_b32_sdwa v242, s47, v240 dst_sel:DWORD dst_unused:UNUSED_PAD src0_sel:DWORD src1_sel:WORD_1
v_and_b32 v240, s47, v240
v_mfma_f32_16x16x32_f16 v[92:95], v[124:127], v[0:3], v[92:95]
ds_read_b128 v[124:127], v252 offset:8192
ds_read_u16_d16_hi v242, v242
v_mfma_f32_16x16x32_bf16 v[164:167], v[18:21], v[228:231], v[164:167]
ds_read_u16 v240, v240
v_and_b32_sdwa v243, s47, v241 dst_sel:DWORD dst_unused:UNUSED_PAD src0_sel:DWORD src1_sel:WORD_1
v_mfma_f32_16x16x32_bf16 v[216:219], v[16:19], v[228:231], v[216:219]
v_and_b32 v241, s47, v241
v_pk_fma_f16 v119, v118, v118, s48
v_mfma_f32_16x16x32_bf16 v[100:103], v[18:21], v[112:115], v[100:103]
s_waitcnt lgkmcnt(8)
ds_read_u16_d16_hi v243, v243
ds_read_u16 v241, v241
v_mfma_f32_16x16x32_bf16 v[232:235], v[16:19], v[112:115], v[232:235]
v_pk_mul_f16 v117, v116, v117
v_pk_mul_f16 v119, v118, v119
v_mfma_f32_16x16x32_bf16 v[56:59], v[184:187], v[128:131], 0
v_cvt_pkrtz_f16_f32 v72, v72, v73
v_cvt_pkrtz_f16_f32 v73, v74, v75
v_mfma_f32_16x16x32_f16 v[164:167], v[176:179], v[96:99], v[164:167]
s_setprio 1
v_lshrrev_b64 v[72:73], 2, v[72:73]
v_and_b32_sdwa v74, s47, v72 dst_sel:DWORD dst_unused:UNUSED_PAD src0_sel:DWORD src1_sel:WORD_1
v_mfma_f32_16x16x32_bf16 v[60:63], v[184:187], v[136:139], 0
ds_read_b128 v[184:187], v248 offset:2304
v_and_b32 v72, s47, v72
v_mfma_f32_16x16x32_f16 v[168:171], v[176:179], v[12:15], v[168:171]
ds_read_u16_d16_hi v74, v74
ds_read_u16 v72, v72
v_mfma_f32_16x16x32_bf16 v[24:27], v[188:191], v[36:39], v[24:27]
v_lshl_add_u64 v[208:209], v[208:209], 0, v[210:211]
v_exp_f16_sdwa v117, v117 dst_sel:WORD_0 dst_unused:UNUSED_PRESERVE src0_sel:WORD_0
v_mfma_f32_16x16x32_f16 v[132:135], v[176:179], v[8:11], v[132:135]
ds_read_b128 v[176:179], v252 offset:6144
v_exp_f16_sdwa v119, v119 dst_sel:WORD_0 dst_unused:UNUSED_PRESERVE src0_sel:WORD_0
v_mfma_f32_16x16x32_bf16 v[56:59], v[188:191], v[108:111], v[56:59]
v_and_b32_sdwa v75, s47, v73 dst_sel:DWORD dst_unused:UNUSED_PAD src0_sel:DWORD src1_sel:WORD_1
v_and_b32 v73, s47, v73
v_mfma_f32_16x16x32_f16 v[216:219], v[160:163], v[96:99], v[216:219]
ds_read_u16_d16_hi v75, v75
s_waitcnt lgkmcnt(7)
ds_read_u16 v73, v73
v_mfma_f32_16x16x32_bf16 v[60:63], v[188:191], v[192:195], v[60:63]
ds_read_b128 v[188:191], v248 offset:4352
v_lshl_add_u64 v[212:213], v[212:213], 0, v[214:215]
v_mfma_f32_16x16x32_f16 v[220:223], v[160:163], v[12:15], v[220:223]
v_exp_f16_sdwa v117, v117 dst_sel:WORD_1 dst_unused:UNUSED_PRESERVE src0_sel:WORD_1
v_mfma_f32_16x16x32_bf16 v[24:27], v[52:55], v[44:47], v[24:27]
v_exp_f16_sdwa v119, v119 dst_sel:WORD_1 dst_unused:UNUSED_PRESERVE src0_sel:WORD_1
v_mfma_f32_16x16x32_f16 v[76:79], v[160:163], v[8:11], v[76:79]
ds_read_b128 v[160:163], v252 offset:9216
v_lshl_add_u64 v[180:181], v[180:181], 0, v[182:183]
v_mfma_f32_16x16x32_bf16 v[56:59], v[52:55], v[144:147], v[56:59]
v_pk_add_f16 v117, v117, 1.0 op_sel_hi:[1,0]
v_pk_add_f16 v119, v119, 1.0 op_sel_hi:[1,0]
v_mfma_f32_16x16x32_f16 v[100:103], v[48:51], v[96:99], v[100:103]
s_setprio 0
v_rcp_f16_sdwa v117, v117 dst_sel:WORD_0 dst_unused:UNUSED_PRESERVE src0_sel:WORD_0
v_mfma_f32_16x16x32_bf16 v[60:63], v[52:55], v[148:151], v[60:63]
ds_read_b128 v[52:55], v248 offset:6144
v_rcp_f16_sdwa v119, v119 dst_sel:WORD_0 dst_unused:UNUSED_PRESERVE src0_sel:WORD_0
v_mfma_f32_16x16x32_f16 v[104:107], v[48:51], v[12:15], v[104:107]
v_cvt_pkrtz_f16_f32 v24, v24, v25
v_cvt_pkrtz_f16_f32 v25, v26, v27
v_mfma_f32_16x16x32_bf16 v[32:35], v[120:123], v[28:31], 0
v_lshrrev_b64 v[24:25], 2, v[24:25]
v_and_b32_sdwa v26, s47, v24 dst_sel:DWORD dst_unused:UNUSED_PAD src0_sel:DWORD src1_sel:WORD_1
v_mfma_f32_16x16x32_f16 v[140:143], v[48:51], v[8:11], v[140:143]
ds_read_b128 v[48:51], v252 offset:10240
v_and_b32 v24, s47, v24
v_mfma_f32_16x16x32_bf16 v[152:155], v[120:123], v[128:131], 0
ds_read_u16_d16_hi v26, v26
ds_read_u16 v24, v24
v_mfma_f32_16x16x32_f16 v[232:235], v[124:127], v[96:99], v[232:235]
v_rcp_f16_sdwa v117, v117 dst_sel:WORD_1 dst_unused:UNUSED_PRESERVE src0_sel:WORD_1
v_mfma_f32_16x16x32_bf16 v[80:83], v[120:123], v[136:139], 0
ds_read_b128 v[120:123], v248 offset:8192
v_and_b32_sdwa v27, s47, v25 dst_sel:DWORD dst_unused:UNUSED_PAD src0_sel:DWORD src1_sel:WORD_1
v_mfma_f32_16x16x32_f16 v[236:239], v[124:127], v[12:15], v[236:239]
v_and_b32 v25, s47, v25
v_rcp_f16_sdwa v119, v119 dst_sel:WORD_1 dst_unused:UNUSED_PRESERVE src0_sel:WORD_1
s_waitcnt lgkmcnt(4)
v_mfma_f32_16x16x32_bf16 v[32:35], v[184:187], v[36:39], v[32:35]
ds_read_u16_d16_hi v27, v27
ds_read_u16 v25, v25
v_mfma_f32_16x16x32_f16 v[84:87], v[124:127], v[8:11], v[84:87]
v_cvt_pkrtz_f16_f32 v56, v56, v57
v_cvt_pkrtz_f16_f32 v57, v58, v59
v_lshrrev_b64 v[56:57], 2, v[56:57]
v_and_b32_sdwa v58, s47, v56 dst_sel:DWORD dst_unused:UNUSED_PAD src0_sel:DWORD src1_sel:WORD_1
v_and_b32_e64 v56, s47, v56
v_pk_mul_f16 v210, v116, v117
v_mfma_f32_16x16x32_bf16 v[152:155], v[184:187], v[108:111], v[152:155]
ds_read_u16_d16_hi v58, v58
ds_read_u16 v56, v56
ds_read_b128 v[124:127], v252 offset:13312
v_mfma_f32_16x16x32_f16 v[200:203], v[176:179], v[96:99], v[200:203]
v_and_b32_sdwa v59, s47, v57 dst_sel:DWORD dst_unused:UNUSED_PAD src0_sel:DWORD src1_sel:WORD_1
v_and_b32_e64 v57, s47, v57
v_pk_mul_f16 v211, v118, v119
v_lshl_add_u64 v[214:215], v[240:241], 0, v[242:243]
v_mfma_f32_16x16x32_bf16 v[80:83], v[184:187], v[192:195], v[80:83]
ds_read_u16_d16_hi v59, v59
ds_read_u16 v57, v57
s_setprio 3
v_cvt_pkrtz_f16_f32 v60, v60, v61
v_cvt_pkrtz_f16_f32 v61, v62, v63
v_lshrrev_b64 v[60:61], 2, v[60:61]
v_and_b32_sdwa v62, s47, v60 dst_sel:DWORD dst_unused:UNUSED_PAD src0_sel:DWORD src1_sel:WORD_1
v_and_b32 v60, s47, v60
v_mfma_f32_16x16x32_f16 v[204:207], v[176:179], v[12:15], v[204:207]
ds_read_u16_d16_hi v62, v62
ds_read_u16 v60, v60
ds_read_b128 v[184:187], v248 offset:10240
v_and_b32_sdwa v63, s47, v61 dst_sel:DWORD dst_unused:UNUSED_PAD src0_sel:DWORD src1_sel:WORD_1
v_and_b32 v61, s47, v61
v_mfma_f32_16x16x32_bf16 v[32:35], v[188:191], v[44:47], v[32:35]
ds_read_u16_d16_hi v63, v63
s_waitcnt lgkmcnt(9)
ds_read_u16 v61, v61
v_mfma_f32_16x16x32_f16 v[244:247], v[176:179], v[8:11], v[244:247]
ds_read_b128 v[176:179], v252 offset:11264
v_lshl_add_u64 v[182:183], v[72:73], 0, v[74:75]
v_mfma_f32_16x16x32_bf16 v[152:155], v[188:191], v[144:147], v[152:155]
s_nop 0
v_cvt_pk_f16_f32 v32, v32, v33
v_mfma_f32_16x16x32_f16 v[4:7], v[160:163], v[96:99], v[4:7]
v_cvt_pk_f16_f32 v34, v34, v35
v_pk_fma_f16 v33, v32, v32, s48
v_mfma_f32_16x16x32_bf16 v[80:83], v[188:191], v[148:151], v[80:83]
ds_read_b128 v[188:191], v248 offset:6400
s_nop 0
v_cvt_pkrtz_f16_f32 v152, v152, v153
v_mfma_f32_16x16x32_f16 v[224:227], v[160:163], v[12:15], v[224:227]
v_cvt_pkrtz_f16_f32 v153, v154, v155
v_lshrrev_b64 v[152:153], 2, v[152:153]
v_mfma_f32_16x16x32_bf16 v[88:91], v[52:55], v[28:31], 0
v_and_b32_sdwa v154, s47, v152 dst_sel:DWORD dst_unused:UNUSED_PAD src0_sel:DWORD src1_sel:WORD_1
v_and_b32_e64 v152, s47, v152
v_mfma_f32_16x16x32_f16 v[92:95], v[160:163], v[8:11], v[92:95]
ds_read_b128 v[160:163], v252 offset:14336
ds_read_u16_d16_hi v154, v154
v_mfma_f32_16x16x32_bf16 v[64:67], v[52:55], v[128:131], 0
ds_read_u16 v152, v152
v_and_b32_sdwa v155, s47, v153 dst_sel:DWORD dst_unused:UNUSED_PAD src0_sel:DWORD src1_sel:WORD_1
v_mfma_f32_16x16x32_f16 v[164:167], v[48:51], v[180:183], v[164:167]
s_setprio 2
v_and_b32_e64 v153, s47, v153
v_pk_fma_f16 v35, v34, v34, s48
v_mfma_f32_16x16x32_bf16 v[68:71], v[52:55], v[136:139], 0
s_waitcnt lgkmcnt(8)
ds_read_b128 v[52:55], v248 offset:8448
ds_read_u16_d16_hi v155, v155
v_mfma_f32_16x16x32_f16 v[168:171], v[48:51], v[212:215], v[168:171]
ds_read_u16 v153, v153
v_pk_mul_f16 v33, v32, v33
v_mfma_f32_16x16x32_bf16 v[88:91], v[120:123], v[36:39], v[88:91]
v_pk_mul_f16 v35, v34, v35
v_cvt_pkrtz_f16_f32 v80, v80, v81
v_mfma_f32_16x16x32_f16 v[132:135], v[48:51], v[208:211], v[132:135]
ds_read_b128 v[48:51], v252 offset:12288
v_cvt_pkrtz_f16_f32 v81, v82, v83
v_mfma_f32_16x16x32_bf16 v[64:67], v[120:123], v[108:111], v[64:67]
v_lshrrev_b64 v[80:81], 2, v[80:81]
v_and_b32_sdwa v82, s47, v80 dst_sel:DWORD dst_unused:UNUSED_PAD src0_sel:DWORD src1_sel:WORD_1
v_mfma_f32_16x16x32_f16 v[216:219], v[124:127], v[180:183], v[216:219]
v_and_b32_e64 v80, s47, v80
v_lshl_add_u64 v[24:25], v[24:25], 0, v[26:27]
v_exp_f16_sdwa v33, v33 dst_sel:WORD_0 dst_unused:UNUSED_PRESERVE src0_sel:WORD_0
v_mfma_f32_16x16x32_bf16 v[68:71], v[120:123], v[192:195], v[68:71]
ds_read_u16_d16_hi v82, v82
ds_read_u16 v80, v80
v_mfma_f32_16x16x32_f16 v[220:223], v[124:127], v[212:215], v[220:223]
ds_read_b128 v[120:123], v248 offset:10496
v_exp_f16_sdwa v35, v35 dst_sel:WORD_0 dst_unused:UNUSED_PRESERVE src0_sel:WORD_0
v_and_b32_sdwa v83, s47, v81 dst_sel:DWORD dst_unused:UNUSED_PAD src0_sel:DWORD src1_sel:WORD_1
v_and_b32_e64 v81, s47, v81
s_waitcnt lgkmcnt(8)
v_mfma_f32_16x16x32_bf16 v[88:91], v[184:187], v[44:47], v[88:91]
ds_read_u16_d16_hi v83, v83
ds_read_u16 v81, v81
v_lshl_add_u64 v[56:57], v[56:57], 0, v[58:59]
v_mfma_f32_16x16x32_f16 v[76:79], v[124:127], v[208:211], v[76:79]
v_exp_f16_sdwa v33, v33 dst_sel:WORD_1 dst_unused:UNUSED_PRESERVE src0_sel:WORD_1
v_mfma_f32_16x16x32_bf16 v[64:67], v[184:187], v[144:147], v[64:67]
ds_read_b128 v[124:127], v252 offset:15360
s_setprio 1
v_exp_f16_sdwa v35, v35 dst_sel:WORD_1 dst_unused:UNUSED_PRESERVE src0_sel:WORD_1
v_mfma_f32_16x16x32_f16 v[100:103], v[176:179], v[180:183], v[100:103]
v_lshl_add_u64 v[60:61], v[60:61], 0, v[62:63]
v_pk_add_f16 v33, v33, 1.0 op_sel_hi:[1,0]
v_mfma_f32_16x16x32_bf16 v[68:71], v[184:187], v[148:151], v[68:71]
ds_read_b128 v[184:187], v248 offset:12288
v_pk_add_f16 v35, v35, 1.0 op_sel_hi:[1,0]
v_mfma_f32_16x16x32_f16 v[104:107], v[176:179], v[212:215], v[104:107]
v_rcp_f16_sdwa v33, v33 dst_sel:WORD_0 dst_unused:UNUSED_PRESERVE src0_sel:WORD_0
v_mfma_f32_16x16x32_bf16 v[40:43], v[188:191], v[28:31], 0
v_rcp_f16_sdwa v35, v35 dst_sel:WORD_0 dst_unused:UNUSED_PRESERVE src0_sel:WORD_0
v_mfma_f32_16x16x32_f16 v[140:143], v[176:179], v[208:211], v[140:143]
ds_read_b128 v[176:179], v251 offset:8192
v_cvt_pkrtz_f16_f32 v64, v64, v65
v_mfma_f32_16x16x32_bf16 v[0:3], v[188:191], v[128:131], 0
v_cvt_pkrtz_f16_f32 v65, v66, v67
v_lshrrev_b64 v[64:65], 2, v[64:65]
v_mfma_f32_16x16x32_f16 v[232:235], v[160:163], v[180:183], v[232:235]
v_and_b32_sdwa v66, s47, v64 dst_sel:DWORD dst_unused:UNUSED_PAD src0_sel:DWORD src1_sel:WORD_1
v_and_b32_e64 v64, s47, v64
v_cvt_pk_f16_f32 v88, v88, v89
v_mfma_f32_16x16x32_bf16 v[172:175], v[188:191], v[136:139], 0
ds_read_u16_d16_hi v66, v66
ds_read_u16 v64, v64
v_rcp_f16_sdwa v33, v33 dst_sel:WORD_1 dst_unused:UNUSED_PRESERVE src0_sel:WORD_1
v_mfma_f32_16x16x32_f16 v[236:239], v[160:163], v[212:215], v[236:239]
v_cvt_pk_f16_f32 v90, v90, v91
v_pk_fma_f16 v89, v88, v88, s48
v_rcp_f16_sdwa v35, v35 dst_sel:WORD_1 dst_unused:UNUSED_PRESERVE src0_sel:WORD_1
s_waitcnt lgkmcnt(3)
v_mfma_f32_16x16x32_bf16 v[40:43], v[52:55], v[36:39], v[40:43]
ds_read_b128 v[188:191], v248 offset:14336
v_and_b32_sdwa v67, s47, v65 dst_sel:DWORD dst_unused:UNUSED_PAD src0_sel:DWORD src1_sel:WORD_1
v_and_b32 v65, s47, v65
v_pk_fma_f16 v91, v90, v90, s48
v_mfma_f32_16x16x32_f16 v[84:87], v[160:163], v[208:211], v[84:87]
ds_read_u16_d16_hi v67, v67
ds_read_u16 v65, v65
ds_read_b128 v[160:163], v251 offset:11264
v_pk_mul_f16 v89, v88, v89
v_pk_mul_f16 v26, v32, v33
v_mfma_f32_16x16x32_bf16 v[0:3], v[52:55], v[108:111], v[0:3]
s_setprio 0
v_pk_mul_f16 v91, v90, v91
v_cvt_pkrtz_f16_f32 v68, v68, v69
v_mfma_f32_16x16x32_f16 v[200:203], v[48:51], v[180:183], v[200:203]
v_cvt_pkrtz_f16_f32 v69, v70, v71
v_lshrrev_b64 v[68:69], 2, v[68:69]
v_and_b32_sdwa v70, s47, v68 dst_sel:DWORD dst_unused:UNUSED_PAD src0_sel:DWORD src1_sel:WORD_1
v_and_b32 v68, s47, v68
v_pk_mul_f16 v27, v34, v35
v_exp_f16_sdwa v89, v89 dst_sel:WORD_0 dst_unused:UNUSED_PRESERVE src0_sel:WORD_0
v_lshl_add_u64 v[58:59], v[152:153], 0, v[154:155]
v_mfma_f32_16x16x32_bf16 v[172:175], v[52:55], v[192:195], v[172:175]
ds_read_u16_d16_hi v70, v70
ds_read_u16 v68, v68
v_mfma_f32_16x16x32_f16 v[204:207], v[48:51], v[212:215], v[204:207]
ds_read_b128 v[52:55], v248 offset:16384
v_exp_f16_sdwa v91, v91 dst_sel:WORD_0 dst_unused:UNUSED_PRESERVE src0_sel:WORD_0
v_and_b32_sdwa v71, s47, v69 dst_sel:DWORD dst_unused:UNUSED_PAD src0_sel:DWORD src1_sel:WORD_1
v_and_b32_e64 v69, s47, v69
v_mfma_f32_16x16x32_bf16 v[40:43], v[120:123], v[44:47], v[40:43]
ds_read_u16_d16_hi v71, v71
ds_read_u16 v69, v69
v_mfma_f32_16x16x32_f16 v[244:247], v[48:51], v[208:211], v[244:247]
v_cvt_pk_bf16_f32 v132, v132, v133
v_cvt_pk_bf16_f32 v133, v134, v135
v_cvt_pk_bf16_f32 v134, v76, v77
v_cvt_pk_bf16_f32 v135, v78, v79
v_cvt_pk_bf16_f32 v168, v168, v169
v_cvt_pk_bf16_f32 v169, v170, v171
v_cvt_pk_bf16_f32 v170, v220, v221
v_cvt_pk_bf16_f32 v171, v222, v223
v_cvt_pk_bf16_f32 v164, v164, v165
v_cvt_pk_bf16_f32 v165, v166, v167
v_cvt_pk_bf16_f32 v166, v216, v217
v_cvt_pk_bf16_f32 v167, v218, v219
v_exp_f16_sdwa v89, v89 dst_sel:WORD_1 dst_unused:UNUSED_PRESERVE src0_sel:WORD_1
v_cvt_pk_bf16_f32 v140, v140, v141
v_cvt_pk_bf16_f32 v141, v142, v143
v_cvt_pk_bf16_f32 v142, v84, v85
v_cvt_pk_bf16_f32 v143, v86, v87
v_cvt_pk_bf16_f32 v104, v104, v105
ds_read_b128 v[76:79], v254 offset:8192
ds_read_b128 v[220:223], v254 offset:8208
ds_read_b128 v[48:51], v251 offset:9216
v_cvt_pk_bf16_f32 v105, v106, v107
v_cvt_pk_bf16_f32 v106, v236, v237
v_cvt_pk_bf16_f32 v107, v238, v239
v_cvt_pk_bf16_f32 v100, v100, v101
v_cvt_pk_bf16_f32 v101, v102, v103
v_cvt_pk_bf16_f32 v102, v232, v233
v_cvt_pk_bf16_f32 v103, v234, v235
v_mfma_f32_16x16x32_bf16 v[0:3], v[120:123], v[144:147], v[0:3]
s_waitcnt lgkmcnt(5)
ds_read_b128 v[84:87], v254 offset:8320
ds_read_b128 v[236:239], v254 offset:8336
v_mfma_f32_16x16x32_f16 v[4:7], v[124:127], v[180:183], v[4:7]
v_lshl_add_u64 v[62:63], v[80:81], 0, v[82:83]
v_exp_f16_sdwa v91, v91 dst_sel:WORD_1 dst_unused:UNUSED_PRESERVE src0_sel:WORD_1
v_cvt_pk_bf16_f32 v244, v244, v245
v_cvt_pk_bf16_f32 v245, v246, v247
v_cvt_pk_bf16_f32 v204, v204, v205
v_cvt_pk_bf16_f32 v205, v206, v207
v_mfma_f32_16x16x32_bf16 v[172:175], v[120:123], v[148:151], v[172:175]
v_pk_add_f16 v89, v89, 1.0 op_sel_hi:[1,0]
v_pk_add_f16 v91, v91, 1.0 op_sel_hi:[1,0]
v_mfma_f32_16x16x32_f16 v[224:227], v[124:127], v[212:215], v[224:227]
ds_read_b128 v[120:123], v248 offset:12544
v_rcp_f16_sdwa v89, v89 dst_sel:WORD_0 dst_unused:UNUSED_PRESERVE src0_sel:WORD_0
v_mfma_f32_16x16x32_bf16 v[156:159], v[184:187], v[28:31], 0
v_rcp_f16_sdwa v91, v91 dst_sel:WORD_0 dst_unused:UNUSED_PRESERVE src0_sel:WORD_0
v_mfma_f32_16x16x32_f16 v[92:95], v[124:127], v[208:211], v[92:95]
s_nop 2
v_cvt_pk_bf16_f32 v206, v224, v225
v_cvt_pk_bf16_f32 v207, v226, v227
v_mfma_f32_16x16x32_bf16 v[200:203], v[18:21], v[196:199], v[200:203]
ds_read_b128 v[224:227], v254 offset:16
ds_read_b128 v[124:127], v251 offset:12288
v_mfma_f32_16x16x32_bf16 v[4:7], v[16:19], v[196:199], v[4:7]
v_cvt_pkrtz_f16_f32 v40, v40, v41
v_cvt_pk_bf16_f32 v246, v92, v93
v_cvt_pk_bf16_f32 v247, v94, v95
v_mfma_f32_16x16x32_bf16 v[228:231], v[184:187], v[128:131], 0
ds_read_b128 v[92:95], v254
v_cvt_pk_bf16_f32 v200, v200, v201
v_cvt_pk_bf16_f32 v201, v202, v203
s_setprio 3
v_cvt_pk_bf16_f32 v202, v4, v5
v_cvt_pk_bf16_f32 v203, v6, v7
s_waitcnt lgkmcnt(4)
v_mfma_f32_16x16x32_f16 v[116:119], v[176:179], v[60:63], v[76:79]
v_cvt_pkrtz_f16_f32 v41, v42, v43
v_lshrrev_b64 v[40:41], 2, v[40:41]
v_and_b32_sdwa v42, s47, v40 dst_sel:DWORD dst_unused:UNUSED_PAD src0_sel:DWORD src1_sel:WORD_1
v_and_b32_e64 v40, s47, v40
v_mfma_f32_16x16x32_bf16 v[112:115], v[184:187], v[136:139], 0
ds_read_u16_d16_hi v42, v42
ds_read_u16 v40, v40
v_rcp_f16_sdwa v89, v89 dst_sel:WORD_1 dst_unused:UNUSED_PRESERVE src0_sel:WORD_1
buffer_store_dwordx4 v[132:135], v253, s[8:11], s70 offen sc1
buffer_store_dwordx4 v[140:143], v253, s[8:11], s70 offen offset:64 sc1
v_mfma_f32_16x16x32_f16 v[240:243], v[176:179], v[56:59], v[76:79]
ds_read_b128 v[184:187], v248 offset:14592
v_and_b32_sdwa v43, s47, v41 dst_sel:DWORD dst_unused:UNUSED_PAD src0_sel:DWORD src1_sel:WORD_1
v_and_b32_e64 v41, s47, v41
v_rcp_f16_sdwa v91, v91 dst_sel:WORD_1 dst_unused:UNUSED_PRESERVE src0_sel:WORD_1
v_mfma_f32_16x16x32_bf16 v[156:159], v[188:191], v[36:39], v[156:159]
ds_read_u16_d16_hi v43, v43
ds_read_u16 v41, v41
v_mfma_f32_16x16x32_f16 v[76:79], v[176:179], v[24:27], v[76:79]
v_cvt_pkrtz_f16_f32 v0, v0, v1
v_cvt_pkrtz_f16_f32 v1, v2, v3
v_lshrrev_b64 v[0:1], 2, v[0:1]
v_and_b32_sdwa v2, s47, v0 dst_sel:DWORD dst_unused:UNUSED_PAD src0_sel:DWORD src1_sel:WORD_1
v_and_b32_e64 v0, s47, v0
v_pk_mul_f16 v88, v88, v89
v_mfma_f32_16x16x32_bf16 v[228:231], v[188:191], v[108:111], v[228:231]
ds_read_u16_d16_hi v2, v2
ds_read_u16 v0, v0
ds_read_b128 v[176:179], v251 offset:10240
v_mfma_f32_16x16x32_f16 v[72:75], v[160:163], v[60:63], v[220:223]
v_and_b32_sdwa v3, s47, v1 dst_sel:DWORD dst_unused:UNUSED_PAD src0_sel:DWORD src1_sel:WORD_1
v_and_b32_e64 v1, s47, v1
v_pk_mul_f16 v89, v90, v91
v_lshl_add_u64 v[64:65], v[64:65], 0, v[66:67]
v_mfma_f32_16x16x32_bf16 v[112:115], v[188:191], v[192:195], v[112:115]
ds_read_u16_d16_hi v3, v3
ds_read_u16 v1, v1
v_cvt_pkrtz_f16_f32 v172, v172, v173
v_cvt_pkrtz_f16_f32 v173, v174, v175
v_lshrrev_b64 v[172:173], 2, v[172:173]
v_and_b32_sdwa v174, s47, v172 dst_sel:DWORD dst_unused:UNUSED_PAD src0_sel:DWORD src1_sel:WORD_1
v_and_b32 v172, s47, v172
v_mfma_f32_16x16x32_f16 v[8:11], v[160:163], v[56:59], v[220:223]
ds_read_u16_d16_hi v174, v174
s_waitcnt lgkmcnt(7)
ds_read_u16 v172, v172
ds_read_b128 v[188:191], v248 offset:16640
v_and_b32_sdwa v175, s47, v173 dst_sel:DWORD dst_unused:UNUSED_PAD src0_sel:DWORD src1_sel:WORD_1
v_and_b32_e64 v173, s47, v173
v_mfma_f32_16x16x32_bf16 v[156:159], v[52:55], v[44:47], v[156:159]
ds_read_u16_d16_hi v175, v175
ds_read_u16 v173, v173
v_mfma_f32_16x16x32_f16 v[220:223], v[160:163], v[24:27], v[220:223]
ds_read_b128 v[160:163], v251 offset:13312
s_setprio 2
v_lshl_add_u64 v[68:69], v[68:69], 0, v[70:71]
v_mfma_f32_16x16x32_bf16 v[228:231], v[52:55], v[144:147], v[228:231]
s_nop 0
v_cvt_pk_f16_f32 v156, v156, v157
v_mfma_f32_16x16x32_f16 v[12:15], v[48:51], v[60:63], v[84:87]
v_cvt_pk_f16_f32 v158, v158, v159
v_pk_fma_f16 v157, v156, v156, s48
v_mfma_f32_16x16x32_bf16 v[112:115], v[52:55], v[148:151], v[112:115]
ds_read_b128 v[52:55], v248 offset:18432
s_nop 0
v_cvt_pkrtz_f16_f32 v228, v228, v229
v_mfma_f32_16x16x32_f16 v[96:99], v[48:51], v[56:59], v[84:87]
v_cvt_pkrtz_f16_f32 v229, v230, v231
v_lshrrev_b64 v[228:229], 2, v[228:229]
v_mfma_f32_16x16x32_bf16 v[32:35], v[120:123], v[28:31], 0
v_and_b32_sdwa v230, s47, v228 dst_sel:DWORD dst_unused:UNUSED_PAD src0_sel:DWORD src1_sel:WORD_1
v_and_b32 v228, s47, v228
v_mfma_f32_16x16x32_f16 v[84:87], v[48:51], v[24:27], v[84:87]
ds_read_b128 v[48:51], v251 offset:14336
ds_read_u16_d16_hi v230, v230
v_mfma_f32_16x16x32_bf16 v[152:155], v[120:123], v[128:131], 0
s_waitcnt lgkmcnt(9)
ds_read_u16 v228, v228
v_and_b32_sdwa v231, s47, v229 dst_sel:DWORD dst_unused:UNUSED_PAD src0_sel:DWORD src1_sel:WORD_1
v_mfma_f32_16x16x32_f16 v[208:211], v[124:127], v[60:63], v[236:239]
v_and_b32 v229, s47, v229
v_pk_fma_f16 v159, v158, v158, s48
v_mfma_f32_16x16x32_bf16 v[80:83], v[120:123], v[136:139], 0
ds_read_b128 v[120:123], v248 offset:20480
ds_read_u16_d16_hi v231, v231
v_mfma_f32_16x16x32_f16 v[212:215], v[124:127], v[56:59], v[236:239]
ds_read_u16 v229, v229
v_pk_mul_f16 v157, v156, v157
v_mfma_f32_16x16x32_bf16 v[32:35], v[184:187], v[36:39], v[32:35]
v_pk_mul_f16 v159, v158, v159
v_cvt_pkrtz_f16_f32 v112, v112, v113
v_mfma_f32_16x16x32_f16 v[236:239], v[124:127], v[24:27], v[236:239]
ds_read_b128 v[124:127], v251 offset:17408
s_setprio 1
v_cvt_pkrtz_f16_f32 v113, v114, v115
v_mfma_f32_16x16x32_bf16 v[152:155], v[184:187], v[108:111], v[152:155]
v_lshrrev_b64 v[112:113], 2, v[112:113]
v_and_b32_sdwa v114, s47, v112 dst_sel:DWORD dst_unused:UNUSED_PAD src0_sel:DWORD src1_sel:WORD_1
v_mfma_f32_16x16x32_f16 v[180:183], v[176:179], v[60:63], v[92:95]
v_and_b32 v112, s47, v112
v_lshl_add_u64 v[90:91], v[40:41], 0, v[42:43]
v_exp_f16_sdwa v157, v157 dst_sel:WORD_0 dst_unused:UNUSED_PRESERVE src0_sel:WORD_0
v_mfma_f32_16x16x32_bf16 v[80:83], v[184:187], v[192:195], v[80:83]
ds_read_u16_d16_hi v114, v114
s_waitcnt lgkmcnt(7)
ds_read_u16 v112, v112
v_mfma_f32_16x16x32_f16 v[196:199], v[176:179], v[56:59], v[92:95]
ds_read_b128 v[184:187], v248 offset:22528
v_exp_f16_sdwa v159, v159 dst_sel:WORD_0 dst_unused:UNUSED_PRESERVE src0_sel:WORD_0
v_and_b32_sdwa v115, s47, v113 dst_sel:DWORD dst_unused:UNUSED_PAD src0_sel:DWORD src1_sel:WORD_1
v_and_b32 v113, s47, v113
v_mfma_f32_16x16x32_bf16 v[32:35], v[188:191], v[44:47], v[32:35]
ds_read_u16_d16_hi v115, v115
ds_read_u16 v113, v113
v_lshl_add_u64 v[66:67], v[0:1], 0, v[2:3]
v_mfma_f32_16x16x32_f16 v[92:95], v[176:179], v[24:27], v[92:95]
v_exp_f16_sdwa v157, v157 dst_sel:WORD_1 dst_unused:UNUSED_PRESERVE src0_sel:WORD_1
v_mfma_f32_16x16x32_bf16 v[152:155], v[188:191], v[144:147], v[152:155]
ds_read_b128 v[176:179], v251 offset:15360
v_exp_f16_sdwa v159, v159 dst_sel:WORD_1 dst_unused:UNUSED_PRESERVE src0_sel:WORD_1
v_mfma_f32_16x16x32_f16 v[216:219], v[160:163], v[60:63], v[224:227]
v_lshl_add_u64 v[70:71], v[172:173], 0, v[174:175]
v_pk_add_f16 v157, v157, 1.0 op_sel_hi:[1,0]
v_mfma_f32_16x16x32_bf16 v[80:83], v[188:191], v[148:151], v[80:83]
ds_read_b128 v[188:191], v248 offset:18688
v_pk_add_f16 v159, v159, 1.0 op_sel_hi:[1,0]
v_mfma_f32_16x16x32_f16 v[232:235], v[160:163], v[56:59], v[224:227]
v_rcp_f16_sdwa v157, v157 dst_sel:WORD_0 dst_unused:UNUSED_PRESERVE src0_sel:WORD_0
v_mfma_f32_16x16x32_bf16 v[4:7], v[52:55], v[28:31], 0
v_rcp_f16_sdwa v159, v159 dst_sel:WORD_0 dst_unused:UNUSED_PRESERVE src0_sel:WORD_0
v_mfma_f32_16x16x32_f16 v[224:227], v[160:163], v[24:27], v[224:227]
s_setprio 0
ds_read_b128 v[160:163], v251 offset:18432
v_cvt_pkrtz_f16_f32 v152, v152, v153
v_mfma_f32_16x16x32_bf16 v[132:135], v[52:55], v[128:131], 0
v_cvt_pkrtz_f16_f32 v153, v154, v155
v_lshrrev_b64 v[152:153], 2, v[152:153]
v_mfma_f32_16x16x32_f16 v[116:119], v[48:51], v[68:71], v[116:119]
v_and_b32_sdwa v154, s47, v152 dst_sel:DWORD dst_unused:UNUSED_PAD src0_sel:DWORD src1_sel:WORD_1
v_and_b32_e64 v152, s47, v152
v_cvt_pk_f16_f32 v32, v32, v33
v_mfma_f32_16x16x32_bf16 v[140:143], v[52:55], v[136:139], 0
ds_read_u16_d16_hi v154, v154
s_waitcnt lgkmcnt(5)
ds_read_u16 v152, v152
v_rcp_f16_sdwa v157, v157 dst_sel:WORD_1 dst_unused:UNUSED_PRESERVE src0_sel:WORD_1
v_mfma_f32_16x16x32_f16 v[240:243], v[48:51], v[64:67], v[240:243]
v_cvt_pk_f16_f32 v34, v34, v35
v_pk_fma_f16 v33, v32, v32, s48
v_rcp_f16_sdwa v159, v159 dst_sel:WORD_1 dst_unused:UNUSED_PRESERVE src0_sel:WORD_1
v_mfma_f32_16x16x32_bf16 v[4:7], v[120:123], v[36:39], v[4:7]
ds_read_b128 v[52:55], v248 offset:20736
v_and_b32_sdwa v155, s47, v153 dst_sel:DWORD dst_unused:UNUSED_PAD src0_sel:DWORD src1_sel:WORD_1
v_and_b32_e64 v153, s47, v153
v_pk_fma_f16 v35, v34, v34, s48
v_mfma_f32_16x16x32_f16 v[76:79], v[48:51], v[88:91], v[76:79]
ds_read_u16_d16_hi v155, v155
ds_read_u16 v153, v153
buffer_store_dwordx4 v[244:247], v253, s[8:11], s70 offen offset:128 sc1
buffer_store_dwordx4 v[168:171], v253, s[8:11], s70 offen offset:192 sc1
ds_read_b128 v[48:51], v251 offset:16384
v_pk_mul_f16 v33, v32, v33
v_pk_mul_f16 v156, v156, v157
v_mfma_f32_16x16x32_bf16 v[132:135], v[120:123], v[108:111], v[132:135]
v_pk_mul_f16 v35, v34, v35
v_cvt_pkrtz_f16_f32 v80, v80, v81
v_mfma_f32_16x16x32_f16 v[72:75], v[124:127], v[68:71], v[72:75]
v_cvt_pkrtz_f16_f32 v81, v82, v83
v_lshrrev_b64 v[80:81], 2, v[80:81]
v_and_b32_sdwa v82, s47, v80 dst_sel:DWORD dst_unused:UNUSED_PAD src0_sel:DWORD src1_sel:WORD_1
v_and_b32_e64 v80, s47, v80
v_pk_mul_f16 v157, v158, v159
v_exp_f16_sdwa v33, v33 dst_sel:WORD_0 dst_unused:UNUSED_PRESERVE src0_sel:WORD_0
v_lshl_add_u64 v[228:229], v[228:229], 0, v[230:231]
v_mfma_f32_16x16x32_bf16 v[140:143], v[120:123], v[192:195], v[140:143]
ds_read_u16_d16_hi v82, v82
ds_read_u16 v80, v80
v_mfma_f32_16x16x32_f16 v[8:11], v[124:127], v[64:67], v[8:11]
ds_read_b128 v[120:123], v248 offset:22784
v_exp_f16_sdwa v35, v35 dst_sel:WORD_0 dst_unused:UNUSED_PRESERVE src0_sel:WORD_0
v_and_b32_sdwa v83, s47, v81 dst_sel:DWORD dst_unused:UNUSED_PAD src0_sel:DWORD src1_sel:WORD_1
v_and_b32_e64 v81, s47, v81
v_mfma_f32_16x16x32_bf16 v[4:7], v[184:187], v[44:47], v[4:7]
ds_read_u16_d16_hi v83, v83
ds_read_u16 v81, v81
v_mfma_f32_16x16x32_f16 v[220:223], v[124:127], v[88:91], v[220:223]
v_exp_f16_sdwa v33, v33 dst_sel:WORD_1 dst_unused:UNUSED_PRESERVE src0_sel:WORD_1
s_setprio 3
s_waitcnt lgkmcnt(6)
ds_read_b128 v[124:127], v251 offset:19456
v_mfma_f32_16x16x32_bf16 v[132:135], v[184:187], v[144:147], v[132:135]
v_lshl_add_u64 v[112:113], v[112:113], 0, v[114:115]
v_exp_f16_sdwa v35, v35 dst_sel:WORD_1 dst_unused:UNUSED_PRESERVE src0_sel:WORD_1
v_mfma_f32_16x16x32_f16 v[12:15], v[176:179], v[68:71], v[12:15]
v_pk_add_f16 v33, v33, 1.0 op_sel_hi:[1,0]
v_pk_add_f16 v35, v35, 1.0 op_sel_hi:[1,0]
v_mfma_f32_16x16x32_bf16 v[140:143], v[184:187], v[148:151], v[140:143]
ds_read_b128 v[184:187], v248 offset:24576
v_rcp_f16_sdwa v33, v33 dst_sel:WORD_0 dst_unused:UNUSED_PRESERVE src0_sel:WORD_0
v_mfma_f32_16x16x32_f16 v[96:99], v[176:179], v[64:67], v[96:99]
v_rcp_f16_sdwa v35, v35 dst_sel:WORD_0 dst_unused:UNUSED_PRESERVE src0_sel:WORD_0
v_mfma_f32_16x16x32_bf16 v[40:43], v[188:191], v[28:31], 0
v_cvt_pkrtz_f16_f32 v4, v4, v5
v_cvt_pkrtz_f16_f32 v5, v6, v7
v_mfma_f32_16x16x32_f16 v[84:87], v[176:179], v[88:91], v[84:87]
ds_read_b128 v[176:179], v251 offset:20480
v_lshrrev_b64 v[4:5], 2, v[4:5]
v_mfma_f32_16x16x32_bf16 v[0:3], v[188:191], v[128:131], 0
v_and_b32_sdwa v6, s47, v4 dst_sel:DWORD dst_unused:UNUSED_PAD src0_sel:DWORD src1_sel:WORD_1
v_and_b32_e64 v4, s47, v4
v_mfma_f32_16x16x32_f16 v[208:211], v[160:163], v[68:71], v[208:211]
ds_read_u16_d16_hi v6, v6
ds_read_u16 v4, v4
v_mfma_f32_16x16x32_bf16 v[172:175], v[188:191], v[136:139], 0
v_rcp_f16_sdwa v33, v33 dst_sel:WORD_1 dst_unused:UNUSED_PRESERVE src0_sel:WORD_1
v_mfma_f32_16x16x32_f16 v[212:215], v[160:163], v[64:67], v[212:215]
ds_read_b128 v[188:191], v248 offset:26624
v_and_b32_sdwa v7, s47, v5 dst_sel:DWORD dst_unused:UNUSED_PAD src0_sel:DWORD src1_sel:WORD_1
v_and_b32 v5, s47, v5
v_rcp_f16_sdwa v35, v35 dst_sel:WORD_1 dst_unused:UNUSED_PRESERVE src0_sel:WORD_1
v_mfma_f32_16x16x32_bf16 v[40:43], v[52:55], v[36:39], v[40:43]
ds_read_u16_d16_hi v7, v7
ds_read_u16 v5, v5
v_mfma_f32_16x16x32_f16 v[236:239], v[160:163], v[88:91], v[236:239]
s_setprio 2
v_cvt_pkrtz_f16_f32 v132, v132, v133
v_cvt_pkrtz_f16_f32 v133, v134, v135
v_lshrrev_b64 v[132:133], 2, v[132:133]
v_and_b32_sdwa v134, s47, v132 dst_sel:DWORD dst_unused:UNUSED_PAD src0_sel:DWORD src1_sel:WORD_1
v_and_b32 v132, s47, v132
v_pk_mul_f16 v158, v32, v33
v_mfma_f32_16x16x32_bf16 v[0:3], v[52:55], v[108:111], v[0:3]
ds_read_u16_d16_hi v134, v134
s_waitcnt lgkmcnt(6)
ds_read_u16 v132, v132
ds_read_b128 v[160:163], v251 offset:23552
v_mfma_f32_16x16x32_f16 v[180:183], v[48:51], v[68:71], v[180:183]
v_and_b32_sdwa v135, s47, v133 dst_sel:DWORD dst_unused:UNUSED_PAD src0_sel:DWORD src1_sel:WORD_1
v_and_b32_e64 v133, s47, v133
v_pk_mul_f16 v159, v34, v35
v_lshl_add_u64 v[230:231], v[152:153], 0, v[154:155]
v_mfma_f32_16x16x32_bf16 v[172:175], v[52:55], v[192:195], v[172:175]
ds_read_u16_d16_hi v135, v135
ds_read_u16 v133, v133
v_cvt_pkrtz_f16_f32 v140, v140, v141
v_cvt_pkrtz_f16_f32 v141, v142, v143
v_lshrrev_b64 v[140:141], 2, v[140:141]
v_and_b32_sdwa v142, s47, v140 dst_sel:DWORD dst_unused:UNUSED_PAD src0_sel:DWORD src1_sel:WORD_1
v_and_b32_e64 v140, s47, v140
v_mfma_f32_16x16x32_f16 v[196:199], v[48:51], v[64:67], v[196:199]
ds_read_u16_d16_hi v142, v142
ds_read_u16 v140, v140
ds_read_b128 v[52:55], v248 offset:28672
v_and_b32_sdwa v143, s47, v141 dst_sel:DWORD dst_unused:UNUSED_PAD src0_sel:DWORD src1_sel:WORD_1
v_and_b32_e64 v141, s47, v141
v_mfma_f32_16x16x32_bf16 v[40:43], v[120:123], v[44:47], v[40:43]
ds_read_u16_d16_hi v143, v143
ds_read_u16 v141, v141
v_mfma_f32_16x16x32_f16 v[92:95], v[48:51], v[88:91], v[92:95]
s_waitcnt lgkmcnt(10)
ds_read_b128 v[48:51], v251 offset:21504
v_lshl_add_u64 v[114:115], v[80:81], 0, v[82:83]
v_mfma_f32_16x16x32_bf16 v[0:3], v[120:123], v[144:147], v[0:3]
s_nop 0
v_cvt_pk_f16_f32 v40, v40, v41
v_mfma_f32_16x16x32_f16 v[216:219], v[124:127], v[68:71], v[216:219]
v_cvt_pk_f16_f32 v42, v42, v43
v_pk_fma_f16 v41, v40, v40, s48
v_mfma_f32_16x16x32_bf16 v[172:175], v[120:123], v[148:151], v[172:175]
ds_read_b128 v[120:123], v248 offset:24832
s_nop 0
v_cvt_pkrtz_f16_f32 v0, v0, v1
v_mfma_f32_16x16x32_f16 v[232:235], v[124:127], v[64:67], v[232:235]
v_cvt_pkrtz_f16_f32 v1, v2, v3
v_lshrrev_b64 v[0:1], 2, v[0:1]
v_mfma_f32_16x16x32_bf16 v[24:27], v[184:187], v[28:31], 0
s_setprio 1
v_and_b32_sdwa v2, s47, v0 dst_sel:DWORD dst_unused:UNUSED_PAD src0_sel:DWORD src1_sel:WORD_1
v_and_b32_e64 v0, s47, v0
v_mfma_f32_16x16x32_f16 v[224:227], v[124:127], v[88:91], v[224:227]
ds_read_b128 v[124:127], v251 offset:24576
ds_read_u16_d16_hi v2, v2
v_mfma_f32_16x16x32_bf16 v[56:59], v[184:187], v[128:131], 0
ds_read_u16 v0, v0
v_and_b32_sdwa v3, s47, v1 dst_sel:DWORD dst_unused:UNUSED_PAD src0_sel:DWORD src1_sel:WORD_1
v_mfma_f32_16x16x32_f16 v[116:119], v[176:179], v[112:115], v[116:119]
v_and_b32 v1, s47, v1
v_pk_fma_f16 v43, v42, v42, s48
v_mfma_f32_16x16x32_bf16 v[60:63], v[184:187], v[136:139], 0
s_waitcnt lgkmcnt(8)
ds_read_b128 v[184:187], v248 offset:26880
ds_read_u16_d16_hi v3, v3
v_mfma_f32_16x16x32_f16 v[240:243], v[176:179], v[228:231], v[240:243]
ds_read_u16 v1, v1
v_pk_mul_f16 v41, v40, v41
v_mfma_f32_16x16x32_bf16 v[24:27], v[188:191], v[36:39], v[24:27]
v_pk_mul_f16 v43, v42, v43
v_cvt_pkrtz_f16_f32 v172, v172, v173
v_mfma_f32_16x16x32_f16 v[76:79], v[176:179], v[156:159], v[76:79]
ds_read_b128 v[176:179], v251 offset:22528
v_cvt_pkrtz_f16_f32 v173, v174, v175
v_mfma_f32_16x16x32_bf16 v[56:59], v[188:191], v[108:111], v[56:59]
v_lshrrev_b64 v[172:173], 2, v[172:173]
v_and_b32_sdwa v174, s47, v172 dst_sel:DWORD dst_unused:UNUSED_PAD src0_sel:DWORD src1_sel:WORD_1
v_mfma_f32_16x16x32_f16 v[72:75], v[160:163], v[112:115], v[72:75]
v_and_b32_e64 v172, s47, v172
v_lshl_add_u64 v[4:5], v[4:5], 0, v[6:7]
v_exp_f16_sdwa v41, v41 dst_sel:WORD_0 dst_unused:UNUSED_PRESERVE src0_sel:WORD_0
v_mfma_f32_16x16x32_bf16 v[60:63], v[188:191], v[192:195], v[60:63]
ds_read_u16_d16_hi v174, v174
ds_read_u16 v172, v172
buffer_store_dwordx4 v[104:107], v253, s[8:11], s70 offen offset:256 sc1
buffer_store_dwordx4 v[204:207], v253, s[8:11], s70 offen offset:320 sc1
v_mfma_f32_16x16x32_f16 v[8:11], v[160:163], v[228:231], v[8:11]
ds_read_b128 v[188:191], v248 offset:28928
v_exp_f16_sdwa v43, v43 dst_sel:WORD_0 dst_unused:UNUSED_PRESERVE src0_sel:WORD_0
v_and_b32_sdwa v175, s47, v173 dst_sel:DWORD dst_unused:UNUSED_PAD src0_sel:DWORD src1_sel:WORD_1
v_and_b32_e64 v173, s47, v173
s_waitcnt lgkmcnt(8)
v_mfma_f32_16x16x32_bf16 v[24:27], v[52:55], v[44:47], v[24:27]
ds_read_u16_d16_hi v175, v175
ds_read_u16 v173, v173
s_setprio 0
v_lshl_add_u64 v[132:133], v[132:133], 0, v[134:135]
v_mfma_f32_16x16x32_f16 v[220:223], v[160:163], v[156:159], v[220:223]
v_exp_f16_sdwa v41, v41 dst_sel:WORD_1 dst_unused:UNUSED_PRESERVE src0_sel:WORD_1
v_mfma_f32_16x16x32_bf16 v[56:59], v[52:55], v[144:147], v[56:59]
ds_read_b128 v[160:163], v251 offset:25600
v_exp_f16_sdwa v43, v43 dst_sel:WORD_1 dst_unused:UNUSED_PRESERVE src0_sel:WORD_1
v_mfma_f32_16x16x32_f16 v[12:15], v[48:51], v[112:115], v[12:15]
v_lshl_add_u64 v[140:141], v[140:141], 0, v[142:143]
v_pk_add_f16 v41, v41, 1.0 op_sel_hi:[1,0]
v_mfma_f32_16x16x32_bf16 v[60:63], v[52:55], v[148:151], v[60:63]
ds_read_b128 v[52:55], v248 offset:30720
v_pk_add_f16 v43, v43, 1.0 op_sel_hi:[1,0]
v_mfma_f32_16x16x32_f16 v[96:99], v[48:51], v[228:231], v[96:99]
v_rcp_f16_sdwa v41, v41 dst_sel:WORD_0 dst_unused:UNUSED_PRESERVE src0_sel:WORD_0
v_mfma_f32_16x16x32_bf16 v[244:247], v[120:123], v[28:31], 0
v_rcp_f16_sdwa v43, v43 dst_sel:WORD_0 dst_unused:UNUSED_PRESERVE src0_sel:WORD_0
v_mfma_f32_16x16x32_f16 v[84:87], v[48:51], v[156:159], v[84:87]
ds_read_b128 v[48:51], v251 offset:26624
v_cvt_pkrtz_f16_f32 v56, v56, v57
v_mfma_f32_16x16x32_bf16 v[168:171], v[120:123], v[128:131], 0
v_cvt_pkrtz_f16_f32 v57, v58, v59
v_lshrrev_b64 v[56:57], 2, v[56:57]
v_mfma_f32_16x16x32_f16 v[208:211], v[124:127], v[112:115], v[208:211]
v_and_b32_sdwa v58, s47, v56 dst_sel:DWORD dst_unused:UNUSED_PAD src0_sel:DWORD src1_sel:WORD_1
v_and_b32_e64 v56, s47, v56
v_cvt_pk_f16_f32 v24, v24, v25
v_mfma_f32_16x16x32_bf16 v[32:35], v[120:123], v[136:139], 0
ds_read_u16_d16_hi v58, v58
ds_read_u16 v56, v56
v_rcp_f16_sdwa v41, v41 dst_sel:WORD_1 dst_unused:UNUSED_PRESERVE src0_sel:WORD_1
v_mfma_f32_16x16x32_f16 v[212:215], v[124:127], v[228:231], v[212:215]
v_cvt_pk_f16_f32 v26, v26, v27
v_pk_fma_f16 v25, v24, v24, s48
v_rcp_f16_sdwa v43, v43 dst_sel:WORD_1 dst_unused:UNUSED_PRESERVE src0_sel:WORD_1
s_waitcnt lgkmcnt(3)
v_mfma_f32_16x16x32_bf16 v[244:247], v[184:187], v[36:39], v[244:247]
ds_read_b128 v[120:123], v248 offset:32768
s_setprio 3
v_and_b32_sdwa v59, s47, v57 dst_sel:DWORD dst_unused:UNUSED_PAD src0_sel:DWORD src1_sel:WORD_1
v_and_b32_e64 v57, s47, v57
v_pk_fma_f16 v27, v26, v26, s48
v_mfma_f32_16x16x32_f16 v[236:239], v[124:127], v[156:159], v[236:239]
ds_read_u16_d16_hi v59, v59
ds_read_u16 v57, v57
ds_read_b128 v[124:127], v251 offset:29696
v_pk_mul_f16 v25, v24, v25
v_pk_mul_f16 v6, v40, v41
v_mfma_f32_16x16x32_bf16 v[168:171], v[184:187], v[108:111], v[168:171]
v_pk_mul_f16 v27, v26, v27
buffer_load_dwordx4 v[152:155], v253, s[4:7], s69 offen offset:192
v_mfma_f32_16x16x32_f16 v[180:183], v[176:179], v[112:115], v[180:183]
v_cvt_pkrtz_f16_f32 v60, v60, v61
v_cvt_pkrtz_f16_f32 v61, v62, v63
v_lshrrev_b64 v[60:61], 2, v[60:61]
v_and_b32_sdwa v62, s47, v60 dst_sel:DWORD dst_unused:UNUSED_PAD src0_sel:DWORD src1_sel:WORD_1
v_and_b32_e64 v60, s47, v60
v_pk_mul_f16 v7, v42, v43
v_exp_f16_sdwa v25, v25 dst_sel:WORD_0 dst_unused:UNUSED_PRESERVE src0_sel:WORD_0
v_lshl_add_u64 v[134:135], v[0:1], 0, v[2:3]
v_mfma_f32_16x16x32_bf16 v[32:35], v[184:187], v[192:195], v[32:35]
ds_read_u16_d16_hi v62, v62
ds_read_u16 v60, v60
v_mfma_f32_16x16x32_f16 v[196:199], v[176:179], v[228:231], v[196:199]
ds_read_b128 v[184:187], v248 offset:34816
v_exp_f16_sdwa v27, v27 dst_sel:WORD_0 dst_unused:UNUSED_PRESERVE src0_sel:WORD_0
v_and_b32_sdwa v63, s47, v61 dst_sel:DWORD dst_unused:UNUSED_PAD src0_sel:DWORD src1_sel:WORD_1
v_and_b32_e64 v61, s47, v61
v_mfma_f32_16x16x32_bf16 v[244:247], v[188:191], v[44:47], v[244:247]
ds_read_u16_d16_hi v63, v63
ds_read_u16 v61, v61
v_mfma_f32_16x16x32_f16 v[92:95], v[176:179], v[156:159], v[92:95]
v_exp_f16_sdwa v25, v25 dst_sel:WORD_1 dst_unused:UNUSED_PRESERVE src0_sel:WORD_1
v_mfma_f32_16x16x32_bf16 v[168:171], v[188:191], v[144:147], v[168:171]
ds_read_b128 v[176:179], v251 offset:27648
v_lshl_add_u64 v[142:143], v[172:173], 0, v[174:175]
v_mfma_f32_16x16x32_f16 v[216:219], v[160:163], v[112:115], v[216:219]
v_exp_f16_sdwa v27, v27 dst_sel:WORD_1 dst_unused:UNUSED_PRESERVE src0_sel:WORD_1
v_mfma_f32_16x16x32_bf16 v[32:35], v[188:191], v[148:151], v[32:35]
v_pk_add_f16 v25, v25, 1.0 op_sel_hi:[1,0]
v_pk_add_f16 v27, v27, 1.0 op_sel_hi:[1,0]
v_mfma_f32_16x16x32_f16 v[232:235], v[160:163], v[228:231], v[232:235]
ds_read_b128 v[188:191], v248 offset:30976
s_setprio 2
v_rcp_f16_sdwa v25, v25 dst_sel:WORD_0 dst_unused:UNUSED_PRESERVE src0_sel:WORD_0
v_mfma_f32_16x16x32_bf16 v[80:83], v[52:55], v[28:31], 0
v_rcp_f16_sdwa v27, v27 dst_sel:WORD_0 dst_unused:UNUSED_PRESERVE src0_sel:WORD_0
v_mfma_f32_16x16x32_f16 v[224:227], v[160:163], v[156:159], v[224:227]
ds_read_b128 v[160:163], v251 offset:30720
v_cvt_pkrtz_f16_f32 v244, v244, v245
v_mfma_f32_16x16x32_bf16 v[88:91], v[52:55], v[128:131], 0
v_cvt_pkrtz_f16_f32 v245, v246, v247
v_lshrrev_b64 v[244:245], 2, v[244:245]
s_waitcnt lgkmcnt(4)
v_mfma_f32_16x16x32_f16 v[116:119], v[48:51], v[140:143], v[116:119]
v_and_b32_sdwa v246, s47, v244 dst_sel:DWORD dst_unused:UNUSED_PAD src0_sel:DWORD src1_sel:WORD_1
v_and_b32_e64 v244, s47, v244
v_mfma_f32_16x16x32_bf16 v[64:67], v[52:55], v[136:139], 0
ds_read_u16_d16_hi v246, v246
ds_read_u16 v244, v244
v_rcp_f16_sdwa v25, v25 dst_sel:WORD_1 dst_unused:UNUSED_PRESERVE src0_sel:WORD_1
v_mfma_f32_16x16x32_f16 v[240:243], v[48:51], v[132:135], v[240:243]
ds_read_b128 v[52:55], v248 offset:33024
v_and_b32_sdwa v247, s47, v245 dst_sel:DWORD dst_unused:UNUSED_PAD src0_sel:DWORD src1_sel:WORD_1
v_and_b32_e64 v245, s47, v245
v_rcp_f16_sdwa v27, v27 dst_sel:WORD_1 dst_unused:UNUSED_PRESERVE src0_sel:WORD_1
v_mfma_f32_16x16x32_bf16 v[80:83], v[120:123], v[36:39], v[80:83]
ds_read_u16_d16_hi v247, v247
ds_read_u16 v245, v245
v_mfma_f32_16x16x32_f16 v[76:79], v[48:51], v[4:7], v[76:79]
v_cvt_pkrtz_f16_f32 v168, v168, v169
v_cvt_pkrtz_f16_f32 v169, v170, v171
v_lshrrev_b64 v[168:169], 2, v[168:169]
v_and_b32_sdwa v170, s47, v168 dst_sel:DWORD dst_unused:UNUSED_PAD src0_sel:DWORD src1_sel:WORD_1
v_and_b32_e64 v168, s47, v168
v_pk_mul_f16 v24, v24, v25
v_mfma_f32_16x16x32_bf16 v[88:91], v[120:123], v[108:111], v[88:91]
ds_read_u16_d16_hi v170, v170
ds_read_u16 v168, v168
ds_read_b128 v[48:51], v251 offset:28672
v_mfma_f32_16x16x32_f16 v[72:75], v[124:127], v[140:143], v[72:75]
v_and_b32_sdwa v171, s47, v169 dst_sel:DWORD dst_unused:UNUSED_PAD src0_sel:DWORD src1_sel:WORD_1
v_and_b32_e64 v169, s47, v169
v_pk_mul_f16 v25, v26, v27
v_lshl_add_u64 v[56:57], v[56:57], 0, v[58:59]
v_mfma_f32_16x16x32_bf16 v[64:67], v[120:123], v[192:195], v[64:67]
ds_read_u16_d16_hi v171, v171
ds_read_u16 v169, v169
v_cvt_pkrtz_f16_f32 v32, v32, v33
v_cvt_pkrtz_f16_f32 v33, v34, v35
v_lshrrev_b64 v[32:33], 2, v[32:33]
v_and_b32_sdwa v34, s47, v32 dst_sel:DWORD dst_unused:UNUSED_PAD src0_sel:DWORD src1_sel:WORD_1
v_and_b32_e64 v32, s47, v32
v_mfma_f32_16x16x32_f16 v[8:11], v[124:127], v[132:135], v[8:11]
ds_read_u16_d16_hi v34, v34
s_waitcnt lgkmcnt(8)
ds_read_u16 v32, v32
ds_read_b128 v[120:123], v248 offset:35072
s_setprio 1
buffer_store_dwordx4 v[164:167], v253, s[8:11], s69 offen sc1
buffer_store_dwordx4 v[100:103], v253, s[8:11], s69 offen offset:64 sc1
v_and_b32_sdwa v35, s47, v33 dst_sel:DWORD dst_unused:UNUSED_PAD src0_sel:DWORD src1_sel:WORD_1
v_and_b32 v33, s47, v33
v_mfma_f32_16x16x32_bf16 v[80:83], v[184:187], v[44:47], v[80:83]
ds_read_u16_d16_hi v35, v35
ds_read_u16 v33, v33
v_mfma_f32_16x16x32_f16 v[220:223], v[124:127], v[4:7], v[220:223]
ds_read_b128 v[124:127], v251 offset:31744
v_lshl_add_u64 v[60:61], v[60:61], 0, v[62:63]
v_mfma_f32_16x16x32_bf16 v[88:91], v[184:187], v[144:147], v[88:91]
s_nop 1
v_cvt_pk_f16_f32 v80, v80, v81
v_mfma_f32_16x16x32_f16 v[12:15], v[176:179], v[140:143], v[12:15]
v_cvt_pk_f16_f32 v82, v82, v83
v_pk_fma_f16 v81, v80, v80, s48
v_mfma_f32_16x16x32_bf16 v[64:67], v[184:187], v[148:151], v[64:67]
ds_read_b128 v[184:187], v249
v_cvt_pkrtz_f16_f32 v88, v88, v89
v_mfma_f32_16x16x32_f16 v[96:99], v[176:179], v[132:135], v[96:99]
v_cvt_pkrtz_f16_f32 v89, v90, v91
v_lshrrev_b64 v[88:89], 2, v[88:89]
v_mfma_f32_16x16x32_bf16 v[68:71], v[188:191], v[28:31], 0
v_and_b32_sdwa v90, s47, v88 dst_sel:DWORD dst_unused:UNUSED_PAD src0_sel:DWORD src1_sel:WORD_1
v_and_b32 v88, s47, v88
v_mfma_f32_16x16x32_f16 v[84:87], v[176:179], v[4:7], v[84:87]
ds_read_b128 v[176:179], v251 offset:32768
s_waitcnt lgkmcnt(8)
ds_read_u16_d16_hi v90, v90
v_mfma_f32_16x16x32_bf16 v[104:107], v[188:191], v[128:131], 0
ds_read_u16 v88, v88
v_and_b32_sdwa v91, s47, v89 dst_sel:DWORD dst_unused:UNUSED_PAD src0_sel:DWORD src1_sel:WORD_1
v_mfma_f32_16x16x32_f16 v[208:211], v[160:163], v[140:143], v[208:211]
v_and_b32 v89, s47, v89
v_pk_fma_f16 v83, v82, v82, s48
v_mfma_f32_16x16x32_bf16 v[204:207], v[188:191], v[136:139], 0
ds_read_b128 v[188:191], v249 offset:2048
ds_read_u16_d16_hi v91, v91
v_mfma_f32_16x16x32_f16 v[212:215], v[160:163], v[132:135], v[212:215]
s_setprio 0
ds_read_u16 v89, v89
v_pk_mul_f16 v81, v80, v81
v_mfma_f32_16x16x32_bf16 v[68:71], v[52:55], v[36:39], v[68:71]
v_pk_mul_f16 v83, v82, v83
v_cvt_pkrtz_f16_f32 v64, v64, v65
v_mfma_f32_16x16x32_f16 v[236:239], v[160:163], v[4:7], v[236:239]
ds_read_b128 v[160:163], v251 offset:35840
v_cvt_pkrtz_f16_f32 v65, v66, v67
v_mfma_f32_16x16x32_bf16 v[104:107], v[52:55], v[108:111], v[104:107]
buffer_load_dwordx4 v[40:43], v253, s[4:7], s69 offen offset:256
buffer_load_dwordx4 v[0:3], v253, s[4:7], s69 offen offset:320
v_lshrrev_b64 v[64:65], 2, v[64:65]
v_mfma_f32_16x16x32_f16 v[180:183], v[48:51], v[140:143], v[180:183]
v_and_b32_sdwa v66, s47, v64 dst_sel:DWORD dst_unused:UNUSED_PAD src0_sel:DWORD src1_sel:WORD_1
v_and_b32 v64, s47, v64
v_lshl_add_u64 v[26:27], v[244:245], 0, v[246:247]
v_exp_f16_sdwa v81, v81 dst_sel:WORD_0 dst_unused:UNUSED_PRESERVE src0_sel:WORD_0
v_mfma_f32_16x16x32_bf16 v[204:207], v[52:55], v[192:195], v[204:207]
ds_read_u16_d16_hi v66, v66
s_waitcnt lgkmcnt(7)
ds_read_u16 v64, v64
v_mfma_f32_16x16x32_f16 v[196:199], v[48:51], v[132:135], v[196:199]
ds_read_b128 v[52:55], v249 offset:4096
v_exp_f16_sdwa v83, v83 dst_sel:WORD_0 dst_unused:UNUSED_PRESERVE src0_sel:WORD_0
v_and_b32_sdwa v67, s47, v65 dst_sel:DWORD dst_unused:UNUSED_PAD src0_sel:DWORD src1_sel:WORD_1
v_and_b32_e64 v65, s47, v65
v_mfma_f32_16x16x32_bf16 v[68:71], v[120:123], v[44:47], v[68:71]
ds_read_u16_d16_hi v67, v67
ds_read_u16 v65, v65
v_lshl_add_u64 v[58:59], v[168:169], 0, v[170:171]
v_mfma_f32_16x16x32_f16 v[92:95], v[48:51], v[4:7], v[92:95]
v_exp_f16_sdwa v81, v81 dst_sel:WORD_1 dst_unused:UNUSED_PRESERVE src0_sel:WORD_1
v_mfma_f32_16x16x32_bf16 v[104:107], v[120:123], v[144:147], v[104:107]
ds_read_b128 v[48:51], v251 offset:33792
v_exp_f16_sdwa v83, v83 dst_sel:WORD_1 dst_unused:UNUSED_PRESERVE src0_sel:WORD_1
v_mfma_f32_16x16x32_f16 v[216:219], v[124:127], v[140:143], v[216:219]
v_lshl_add_u64 v[62:63], v[32:33], 0, v[34:35]
v_pk_add_f16 v81, v81, 1.0 op_sel_hi:[1,0]
v_mfma_f32_16x16x32_bf16 v[204:207], v[120:123], v[148:151], v[204:207]
ds_read_b128 v[120:123], v249 offset:256
v_pk_add_f16 v83, v83, 1.0 op_sel_hi:[1,0]
v_mfma_f32_16x16x32_f16 v[232:235], v[124:127], v[132:135], v[232:235]
s_setprio 3
v_rcp_f16_sdwa v81, v81 dst_sel:WORD_0 dst_unused:UNUSED_PRESERVE src0_sel:WORD_0
v_mfma_f32_16x16x32_bf16 v[172:175], v[184:187], v[28:31], 0
v_rcp_f16_sdwa v83, v83 dst_sel:WORD_0 dst_unused:UNUSED_PRESERVE src0_sel:WORD_0
v_mfma_f32_16x16x32_f16 v[224:227], v[124:127], v[4:7], v[224:227]
ds_read_b128 v[124:127], v251 offset:36864
v_cvt_pkrtz_f16_f32 v104, v104, v105
v_mfma_f32_16x16x32_bf16 v[156:159], v[184:187], v[128:131], 0
v_cvt_pkrtz_f16_f32 v105, v106, v107
v_lshrrev_b64 v[104:105], 2, v[104:105]
v_mfma_f32_16x16x32_f16 v[116:119], v[176:179], v[60:63], v[116:119]
v_and_b32_sdwa v106, s47, v104 dst_sel:DWORD dst_unused:UNUSED_PAD src0_sel:DWORD src1_sel:WORD_1
v_and_b32_e64 v104, s47, v104
v_cvt_pk_f16_f32 v68, v68, v69
v_mfma_f32_16x16x32_bf16 v[228:231], v[184:187], v[136:139], 0
ds_read_u16_d16_hi v106, v106
s_waitcnt lgkmcnt(5)
ds_read_u16 v104, v104
v_rcp_f16_sdwa v81, v81 dst_sel:WORD_1 dst_unused:UNUSED_PRESERVE src0_sel:WORD_1
v_mfma_f32_16x16x32_f16 v[240:243], v[176:179], v[56:59], v[240:243]
v_cvt_pk_f16_f32 v70, v70, v71
v_pk_fma_f16 v69, v68, v68, s48
v_rcp_f16_sdwa v83, v83 dst_sel:WORD_1 dst_unused:UNUSED_PRESERVE src0_sel:WORD_1
v_mfma_f32_16x16x32_bf16 v[172:175], v[188:191], v[36:39], v[172:175]
ds_read_b128 v[184:187], v249 offset:2304
v_and_b32_sdwa v107, s47, v105 dst_sel:DWORD dst_unused:UNUSED_PAD src0_sel:DWORD src1_sel:WORD_1
v_and_b32_e64 v105, s47, v105
v_pk_fma_f16 v71, v70, v70, s48
v_mfma_f32_16x16x32_f16 v[76:79], v[176:179], v[24:27], v[76:79]
ds_read_u16_d16_hi v107, v107
ds_read_u16 v105, v105
ds_read_b128 v[176:179], v251 offset:34816
v_pk_mul_f16 v69, v68, v69
v_pk_mul_f16 v80, v80, v81
v_mfma_f32_16x16x32_bf16 v[156:159], v[188:191], v[108:111], v[156:159]
v_pk_mul_f16 v71, v70, v71
v_cvt_pkrtz_f16_f32 v204, v204, v205
v_mfma_f32_16x16x32_f16 v[72:75], v[160:163], v[60:63], v[72:75]
v_cvt_pkrtz_f16_f32 v205, v206, v207
v_lshrrev_b64 v[204:205], 2, v[204:205]
v_and_b32_sdwa v206, s47, v204 dst_sel:DWORD dst_unused:UNUSED_PAD src0_sel:DWORD src1_sel:WORD_1
v_and_b32_e64 v204, s47, v204
v_pk_mul_f16 v81, v82, v83
v_exp_f16_sdwa v69, v69 dst_sel:WORD_0 dst_unused:UNUSED_PRESERVE src0_sel:WORD_0
v_lshl_add_u64 v[88:89], v[88:89], 0, v[90:91]
v_mfma_f32_16x16x32_bf16 v[228:231], v[188:191], v[192:195], v[228:231]
ds_read_u16_d16_hi v206, v206
ds_read_u16 v204, v204
v_mfma_f32_16x16x32_f16 v[8:11], v[160:163], v[56:59], v[8:11]
s_setprio 2
ds_read_b128 v[188:191], v249 offset:4352
v_exp_f16_sdwa v71, v71 dst_sel:WORD_0 dst_unused:UNUSED_PRESERVE src0_sel:WORD_0
v_and_b32_sdwa v207, s47, v205 dst_sel:DWORD dst_unused:UNUSED_PAD src0_sel:DWORD src1_sel:WORD_1
v_and_b32_e64 v205, s47, v205
v_mfma_f32_16x16x32_bf16 v[172:175], v[52:55], v[44:47], v[172:175]
ds_read_u16_d16_hi v207, v207
ds_read_u16 v205, v205
v_mfma_f32_16x16x32_f16 v[220:223], v[160:163], v[24:27], v[220:223]
v_exp_f16_sdwa v69, v69 dst_sel:WORD_1 dst_unused:UNUSED_PRESERVE src0_sel:WORD_1
v_mfma_f32_16x16x32_bf16 v[156:159], v[52:55], v[144:147], v[156:159]
s_waitcnt lgkmcnt(6)
ds_read_b128 v[160:163], v251 offset:37888
buffer_store_dwordx4 v[200:203], v253, s[8:11], s69 offen offset:128 sc1
v_lshl_add_u64 v[64:65], v[64:65], 0, v[66:67]
v_mfma_f32_16x16x32_f16 v[12:15], v[48:51], v[60:63], v[12:15]
v_exp_f16_sdwa v71, v71 dst_sel:WORD_1 dst_unused:UNUSED_PRESERVE src0_sel:WORD_1
v_mfma_f32_16x16x32_bf16 v[228:231], v[52:55], v[148:151], v[228:231]
v_pk_add_f16 v69, v69, 1.0 op_sel_hi:[1,0]
v_pk_add_f16 v71, v71, 1.0 op_sel_hi:[1,0]
v_mfma_f32_16x16x32_f16 v[96:99], v[48:51], v[56:59], v[96:99]
ds_read_b128 v[52:55], v249 offset:6144
v_rcp_f16_sdwa v69, v69 dst_sel:WORD_0 dst_unused:UNUSED_PRESERVE src0_sel:WORD_0
v_mfma_f32_16x16x32_bf16 v[112:115], v[120:123], v[28:31], 0
v_rcp_f16_sdwa v71, v71 dst_sel:WORD_0 dst_unused:UNUSED_PRESERVE src0_sel:WORD_0
v_mfma_f32_16x16x32_f16 v[84:87], v[48:51], v[24:27], v[84:87]
ds_read_b128 v[48:51], v251 offset:38912
v_cvt_pkrtz_f16_f32 v172, v172, v173
v_mfma_f32_16x16x32_bf16 v[164:167], v[120:123], v[128:131], 0
v_cvt_pkrtz_f16_f32 v173, v174, v175
v_lshrrev_b64 v[172:173], 2, v[172:173]
v_mfma_f32_16x16x32_f16 v[208:211], v[124:127], v[60:63], v[208:211]
v_and_b32_sdwa v174, s47, v172 dst_sel:DWORD dst_unused:UNUSED_PAD src0_sel:DWORD src1_sel:WORD_1
v_and_b32_e64 v172, s47, v172
v_mfma_f32_16x16x32_bf16 v[100:103], v[120:123], v[136:139], 0
ds_read_u16_d16_hi v174, v174
ds_read_u16 v172, v172
v_rcp_f16_sdwa v69, v69 dst_sel:WORD_1 dst_unused:UNUSED_PRESERVE src0_sel:WORD_1
s_setprio 1
v_mfma_f32_16x16x32_f16 v[212:215], v[124:127], v[56:59], v[212:215]
ds_read_b128 v[120:123], v249 offset:8192
v_and_b32_sdwa v175, s47, v173 dst_sel:DWORD dst_unused:UNUSED_PAD src0_sel:DWORD src1_sel:WORD_1
v_and_b32 v173, s47, v173
v_rcp_f16_sdwa v71, v71 dst_sel:WORD_1 dst_unused:UNUSED_PRESERVE src0_sel:WORD_1
v_mfma_f32_16x16x32_bf16 v[112:115], v[184:187], v[36:39], v[112:115]
ds_read_u16_d16_hi v175, v175
ds_read_u16 v173, v173
v_mfma_f32_16x16x32_f16 v[236:239], v[124:127], v[24:27], v[236:239]
v_cvt_pkrtz_f16_f32 v156, v156, v157
v_cvt_pkrtz_f16_f32 v157, v158, v159
v_lshrrev_b64 v[156:157], 2, v[156:157]
v_and_b32_sdwa v158, s47, v156 dst_sel:DWORD dst_unused:UNUSED_PAD src0_sel:DWORD src1_sel:WORD_1
v_and_b32 v156, s47, v156
v_pk_mul_f16 v82, v68, v69
v_mfma_f32_16x16x32_bf16 v[164:167], v[184:187], v[108:111], v[164:167]
ds_read_u16_d16_hi v158, v158
s_waitcnt lgkmcnt(6)
ds_read_u16 v156, v156
ds_read_b128 v[124:127], v251 offset:41984
buffer_load_dwordx4 v[244:247], v253, s[4:7], s68 offen
buffer_load_dwordx4 v[168:171], v253, s[4:7], s68 offen offset:64
v_mfma_f32_16x16x32_f16 v[180:183], v[176:179], v[60:63], v[180:183]
v_and_b32_sdwa v159, s47, v157 dst_sel:DWORD dst_unused:UNUSED_PAD src0_sel:DWORD src1_sel:WORD_1
v_and_b32_e64 v157, s47, v157
v_pk_mul_f16 v83, v70, v71
v_lshl_add_u64 v[90:91], v[104:105], 0, v[106:107]
v_mfma_f32_16x16x32_bf16 v[100:103], v[184:187], v[192:195], v[100:103]
ds_read_u16_d16_hi v159, v159
ds_read_u16 v157, v157
v_cvt_pkrtz_f16_f32 v228, v228, v229
v_cvt_pkrtz_f16_f32 v229, v230, v231
v_lshrrev_b64 v[228:229], 2, v[228:229]
v_and_b32_sdwa v230, s47, v228 dst_sel:DWORD dst_unused:UNUSED_PAD src0_sel:DWORD src1_sel:WORD_1
v_and_b32_e64 v228, s47, v228
v_mfma_f32_16x16x32_f16 v[196:199], v[176:179], v[56:59], v[196:199]
ds_read_u16_d16_hi v230, v230
ds_read_u16 v228, v228
ds_read_b128 v[184:187], v249 offset:10240
v_and_b32_sdwa v231, s47, v229 dst_sel:DWORD dst_unused:UNUSED_PAD src0_sel:DWORD src1_sel:WORD_1
v_and_b32 v229, s47, v229
v_mfma_f32_16x16x32_bf16 v[112:115], v[188:191], v[44:47], v[112:115]
ds_read_u16_d16_hi v231, v231
ds_read_u16 v229, v229
v_mfma_f32_16x16x32_f16 v[92:95], v[176:179], v[24:27], v[92:95]
s_waitcnt lgkmcnt(10)
ds_read_b128 v[176:179], v251 offset:39936
v_lshl_add_u64 v[66:67], v[204:205], 0, v[206:207]
v_mfma_f32_16x16x32_bf16 v[164:167], v[188:191], v[144:147], v[164:167]
s_nop 0
v_cvt_pk_f16_f32 v112, v112, v113
v_mfma_f32_16x16x32_f16 v[216:219], v[160:163], v[60:63], v[216:219]
v_cvt_pk_f16_f32 v114, v114, v115
v_pk_fma_f16 v113, v112, v112, s48
v_mfma_f32_16x16x32_bf16 v[100:103], v[188:191], v[148:151], v[100:103]
s_setprio 0
ds_read_b128 v[188:191], v249 offset:6400
v_cvt_pkrtz_f16_f32 v164, v164, v165
v_mfma_f32_16x16x32_f16 v[232:235], v[160:163], v[56:59], v[232:235]
v_cvt_pkrtz_f16_f32 v165, v166, v167
v_lshrrev_b64 v[164:165], 2, v[164:165]
v_mfma_f32_16x16x32_bf16 v[32:35], v[52:55], v[28:31], 0
v_and_b32_sdwa v166, s47, v164 dst_sel:DWORD dst_unused:UNUSED_PAD src0_sel:DWORD src1_sel:WORD_1
v_and_b32_e64 v164, s47, v164
v_mfma_f32_16x16x32_f16 v[224:227], v[160:163], v[24:27], v[224:227]
ds_read_b128 v[160:163], v251 offset:43008
ds_read_u16_d16_hi v166, v166
v_mfma_f32_16x16x32_bf16 v[4:7], v[52:55], v[128:131], 0
ds_read_u16 v164, v164
v_and_b32_sdwa v167, s47, v165 dst_sel:DWORD dst_unused:UNUSED_PAD src0_sel:DWORD src1_sel:WORD_1
v_mfma_f32_16x16x32_f16 v[116:119], v[48:51], v[64:67], v[116:119]
v_and_b32 v165, s47, v165
v_pk_fma_f16 v115, v114, v114, s48
v_mfma_f32_16x16x32_bf16 v[132:135], v[52:55], v[136:139], 0
s_waitcnt lgkmcnt(8)
ds_read_b128 v[52:55], v249 offset:8448
ds_read_u16_d16_hi v167, v167
v_mfma_f32_16x16x32_f16 v[240:243], v[48:51], v[88:91], v[240:243]
ds_read_u16 v165, v165
v_pk_mul_f16 v113, v112, v113
v_mfma_f32_16x16x32_bf16 v[32:35], v[120:123], v[36:39], v[32:35]
v_pk_mul_f16 v115, v114, v115
v_cvt_pkrtz_f16_f32 v100, v100, v101
v_mfma_f32_16x16x32_f16 v[76:79], v[48:51], v[80:83], v[76:79]
ds_read_b128 v[48:51], v251 offset:40960
v_cvt_pkrtz_f16_f32 v101, v102, v103
v_mfma_f32_16x16x32_bf16 v[4:7], v[120:123], v[108:111], v[4:7]
v_lshrrev_b64 v[100:101], 2, v[100:101]
v_and_b32_sdwa v102, s47, v100 dst_sel:DWORD dst_unused:UNUSED_PAD src0_sel:DWORD src1_sel:WORD_1
v_mfma_f32_16x16x32_f16 v[72:75], v[124:127], v[64:67], v[72:75]
v_and_b32 v100, s47, v100
v_lshl_add_u64 v[172:173], v[172:173], 0, v[174:175]
v_exp_f16_sdwa v113, v113 dst_sel:WORD_0 dst_unused:UNUSED_PRESERVE src0_sel:WORD_0
v_mfma_f32_16x16x32_bf16 v[132:135], v[120:123], v[192:195], v[132:135]
ds_read_u16_d16_hi v102, v102
ds_read_u16 v100, v100
s_setprio 3
v_mfma_f32_16x16x32_f16 v[8:11], v[124:127], v[88:91], v[8:11]
ds_read_b128 v[120:123], v249 offset:10496
v_exp_f16_sdwa v115, v115 dst_sel:WORD_0 dst_unused:UNUSED_PRESERVE src0_sel:WORD_0
v_and_b32_sdwa v103, s47, v101 dst_sel:DWORD dst_unused:UNUSED_PAD src0_sel:DWORD src1_sel:WORD_1
v_and_b32 v101, s47, v101
s_waitcnt lgkmcnt(8)
v_mfma_f32_16x16x32_bf16 v[32:35], v[184:187], v[44:47], v[32:35]
ds_read_u16_d16_hi v103, v103
ds_read_u16 v101, v101
v_lshl_add_u64 v[156:157], v[156:157], 0, v[158:159]
v_mfma_f32_16x16x32_f16 v[220:223], v[124:127], v[80:83], v[220:223]
v_exp_f16_sdwa v113, v113 dst_sel:WORD_1 dst_unused:UNUSED_PRESERVE src0_sel:WORD_1
v_mfma_f32_16x16x32_bf16 v[4:7], v[184:187], v[144:147], v[4:7]
ds_read_b128 v[124:127], v251 offset:44032
v_exp_f16_sdwa v115, v115 dst_sel:WORD_1 dst_unused:UNUSED_PRESERVE src0_sel:WORD_1
v_mfma_f32_16x16x32_f16 v[12:15], v[176:179], v[64:67], v[12:15]
v_lshl_add_u64 v[228:229], v[228:229], 0, v[230:231]
v_pk_add_f16 v113, v113, 1.0 op_sel_hi:[1,0]
v_mfma_f32_16x16x32_bf16 v[132:135], v[184:187], v[148:151], v[132:135]
ds_read_b128 v[184:187], v249 offset:12288
v_pk_add_f16 v115, v115, 1.0 op_sel_hi:[1,0]
v_mfma_f32_16x16x32_f16 v[96:99], v[176:179], v[88:91], v[96:99]
v_rcp_f16_sdwa v113, v113 dst_sel:WORD_0 dst_unused:UNUSED_PRESERVE src0_sel:WORD_0
v_mfma_f32_16x16x32_bf16 v[140:143], v[188:191], v[28:31], 0
v_rcp_f16_sdwa v115, v115 dst_sel:WORD_0 dst_unused:UNUSED_PRESERVE src0_sel:WORD_0
v_mfma_f32_16x16x32_f16 v[84:87], v[176:179], v[80:83], v[84:87]
ds_read_b128 v[176:179], v251 offset:45056
v_cvt_pkrtz_f16_f32 v4, v4, v5
v_mfma_f32_16x16x32_bf16 v[200:203], v[188:191], v[128:131], 0
v_cvt_pkrtz_f16_f32 v5, v6, v7
v_lshrrev_b64 v[4:5], 2, v[4:5]
v_mfma_f32_16x16x32_f16 v[208:211], v[160:163], v[64:67], v[208:211]
v_and_b32_sdwa v6, s47, v4 dst_sel:DWORD dst_unused:UNUSED_PAD src0_sel:DWORD src1_sel:WORD_1
v_and_b32 v4, s47, v4
v_cvt_pk_f16_f32 v32, v32, v33
s_setprio 2
ds_read_u16_d16_hi v6, v6
ds_read_u16 v4, v4
v_mfma_f32_16x16x32_bf16 v[68:71], v[188:191], v[136:139], 0
v_rcp_f16_sdwa v113, v113 dst_sel:WORD_1 dst_unused:UNUSED_PRESERVE src0_sel:WORD_1
v_mfma_f32_16x16x32_f16 v[212:215], v[160:163], v[88:91], v[212:215]
v_cvt_pk_f16_f32 v34, v34, v35
v_pk_fma_f16 v33, v32, v32, s48
v_rcp_f16_sdwa v115, v115 dst_sel:WORD_1 dst_unused:UNUSED_PRESERVE src0_sel:WORD_1
s_waitcnt lgkmcnt(4)
v_mfma_f32_16x16x32_bf16 v[140:143], v[52:55], v[36:39], v[140:143]
ds_read_b128 v[188:191], v249 offset:14336
v_and_b32_sdwa v7, s47, v5 dst_sel:DWORD dst_unused:UNUSED_PAD src0_sel:DWORD src1_sel:WORD_1
v_and_b32 v5, s47, v5
v_pk_fma_f16 v35, v34, v34, s48
v_mfma_f32_16x16x32_f16 v[236:239], v[160:163], v[80:83], v[236:239]
ds_read_u16_d16_hi v7, v7
ds_read_u16 v5, v5
ds_read_b128 v[160:163], v251 offset:48128
v_pk_mul_f16 v33, v32, v33
v_pk_mul_f16 v174, v112, v113
v_mfma_f32_16x16x32_bf16 v[200:203], v[52:55], v[108:111], v[200:203]
v_pk_mul_f16 v35, v34, v35
buffer_load_dwordx4 v[104:107], v253, s[4:7], s68 offen offset:128
buffer_load_dwordx4 v[204:207], v253, s[4:7], s68 offen offset:192
v_mfma_f32_16x16x32_f16 v[180:183], v[48:51], v[64:67], v[180:183]
v_cvt_pkrtz_f16_f32 v132, v132, v133
v_cvt_pkrtz_f16_f32 v133, v134, v135
v_lshrrev_b64 v[132:133], 2, v[132:133]
v_and_b32_sdwa v134, s47, v132 dst_sel:DWORD dst_unused:UNUSED_PAD src0_sel:DWORD src1_sel:WORD_1
v_and_b32_e64 v132, s47, v132
v_pk_mul_f16 v175, v114, v115
v_exp_f16_sdwa v33, v33 dst_sel:WORD_0 dst_unused:UNUSED_PRESERVE src0_sel:WORD_0
v_lshl_add_u64 v[158:159], v[164:165], 0, v[166:167]
v_mfma_f32_16x16x32_bf16 v[68:71], v[52:55], v[192:195], v[68:71]
ds_read_u16_d16_hi v134, v134
ds_read_u16 v132, v132
v_mfma_f32_16x16x32_f16 v[196:199], v[48:51], v[88:91], v[196:199]
ds_read_b128 v[52:55], v249 offset:16384
v_exp_f16_sdwa v35, v35 dst_sel:WORD_0 dst_unused:UNUSED_PRESERVE src0_sel:WORD_0
v_and_b32_sdwa v135, s47, v133 dst_sel:DWORD dst_unused:UNUSED_PAD src0_sel:DWORD src1_sel:WORD_1
v_and_b32_e64 v133, s47, v133
v_mfma_f32_16x16x32_bf16 v[140:143], v[120:123], v[44:47], v[140:143]
ds_read_u16_d16_hi v135, v135
ds_read_u16 v133, v133
v_mfma_f32_16x16x32_f16 v[92:95], v[48:51], v[80:83], v[92:95]
v_exp_f16_sdwa v33, v33 dst_sel:WORD_1 dst_unused:UNUSED_PRESERVE src0_sel:WORD_1
v_mfma_f32_16x16x32_bf16 v[200:203], v[120:123], v[144:147], v[200:203]
ds_read_b128 v[48:51], v251 offset:46080
v_lshl_add_u64 v[230:231], v[100:101], 0, v[102:103]
v_mfma_f32_16x16x32_f16 v[216:219], v[124:127], v[64:67], v[216:219]
v_exp_f16_sdwa v35, v35 dst_sel:WORD_1 dst_unused:UNUSED_PRESERVE src0_sel:WORD_1
s_setprio 1
v_mfma_f32_16x16x32_bf16 v[68:71], v[120:123], v[148:151], v[68:71]
v_pk_add_f16 v33, v33, 1.0 op_sel_hi:[1,0]
v_pk_add_f16 v35, v35, 1.0 op_sel_hi:[1,0]
v_mfma_f32_16x16x32_f16 v[232:235], v[124:127], v[88:91], v[232:235]
ds_read_b128 v[120:123], v249 offset:12544
v_rcp_f16_sdwa v33, v33 dst_sel:WORD_0 dst_unused:UNUSED_PRESERVE src0_sel:WORD_0
s_waitcnt lgkmcnt(6)
v_mfma_f32_16x16x32_bf16 v[24:27], v[184:187], v[28:31], 0
v_rcp_f16_sdwa v35, v35 dst_sel:WORD_0 dst_unused:UNUSED_PRESERVE src0_sel:WORD_0
v_mfma_f32_16x16x32_f16 v[224:227], v[124:127], v[80:83], v[224:227]
ds_read_b128 v[124:127], v251 offset:49152
v_cvt_pkrtz_f16_f32 v140, v140, v141
v_mfma_f32_16x16x32_bf16 v[56:59], v[184:187], v[128:131], 0
v_cvt_pkrtz_f16_f32 v141, v142, v143
v_lshrrev_b64 v[140:141], 2, v[140:141]
v_mfma_f32_16x16x32_f16 v[116:119], v[176:179], v[228:231], v[116:119]
v_and_b32_sdwa v142, s47, v140 dst_sel:DWORD dst_unused:UNUSED_PAD src0_sel:DWORD src1_sel:WORD_1
v_and_b32_e64 v140, s47, v140
v_mfma_f32_16x16x32_bf16 v[60:63], v[184:187], v[136:139], 0
ds_read_u16_d16_hi v142, v142
ds_read_u16 v140, v140
v_rcp_f16_sdwa v33, v33 dst_sel:WORD_1 dst_unused:UNUSED_PRESERVE src0_sel:WORD_1
v_mfma_f32_16x16x32_f16 v[240:243], v[176:179], v[156:159], v[240:243]
ds_read_b128 v[184:187], v249 offset:14592
v_and_b32_sdwa v143, s47, v141 dst_sel:DWORD dst_unused:UNUSED_PAD src0_sel:DWORD src1_sel:WORD_1
v_and_b32_e64 v141, s47, v141
v_rcp_f16_sdwa v35, v35 dst_sel:WORD_1 dst_unused:UNUSED_PRESERVE src0_sel:WORD_1
v_mfma_f32_16x16x32_bf16 v[24:27], v[188:191], v[36:39], v[24:27]
ds_read_u16_d16_hi v143, v143
ds_read_u16 v141, v141
v_mfma_f32_16x16x32_f16 v[76:79], v[176:179], v[172:175], v[76:79]
v_cvt_pkrtz_f16_f32 v200, v200, v201
v_cvt_pkrtz_f16_f32 v201, v202, v203
v_lshrrev_b64 v[200:201], 2, v[200:201]
v_and_b32_sdwa v202, s47, v200 dst_sel:DWORD dst_unused:UNUSED_PAD src0_sel:DWORD src1_sel:WORD_1
v_and_b32_e64 v200, s47, v200
v_pk_mul_f16 v32, v32, v33
v_mfma_f32_16x16x32_bf16 v[56:59], v[188:191], v[108:111], v[56:59]
ds_read_u16_d16_hi v202, v202
ds_read_u16 v200, v200
ds_read_b128 v[176:179], v251 offset:47104
v_mfma_f32_16x16x32_f16 v[72:75], v[160:163], v[228:231], v[72:75]
v_and_b32_sdwa v203, s47, v201 dst_sel:DWORD dst_unused:UNUSED_PAD src0_sel:DWORD src1_sel:WORD_1
v_and_b32_e64 v201, s47, v201
v_pk_mul_f16 v33, v34, v35
v_lshl_add_u64 v[4:5], v[4:5], 0, v[6:7]
v_mfma_f32_16x16x32_bf16 v[60:63], v[188:191], v[192:195], v[60:63]
s_waitcnt lgkmcnt(7)
ds_read_u16_d16_hi v203, v203
ds_read_u16 v201, v201
s_setprio 0
v_cvt_pkrtz_f16_f32 v68, v68, v69
v_cvt_pkrtz_f16_f32 v69, v70, v71
v_lshrrev_b64 v[68:69], 2, v[68:69]
v_and_b32_sdwa v70, s47, v68 dst_sel:DWORD dst_unused:UNUSED_PAD src0_sel:DWORD src1_sel:WORD_1
v_and_b32_e64 v68, s47, v68
v_mfma_f32_16x16x32_f16 v[8:11], v[160:163], v[156:159], v[8:11]
ds_read_u16_d16_hi v70, v70
ds_read_u16 v68, v68
ds_read_b128 v[188:191], v249 offset:16640
v_and_b32_sdwa v71, s47, v69 dst_sel:DWORD dst_unused:UNUSED_PAD src0_sel:DWORD src1_sel:WORD_1
v_and_b32_e64 v69, s47, v69
v_mfma_f32_16x16x32_bf16 v[24:27], v[52:55], v[44:47], v[24:27]
ds_read_u16_d16_hi v71, v71
ds_read_u16 v69, v69
v_mfma_f32_16x16x32_f16 v[220:223], v[160:163], v[172:175], v[220:223]
ds_read_b128 v[160:163], v251 offset:50176
v_lshl_add_u64 v[132:133], v[132:133], 0, v[134:135]
v_mfma_f32_16x16x32_bf16 v[56:59], v[52:55], v[144:147], v[56:59]
s_nop 1
v_cvt_pk_f16_f32 v24, v24, v25
v_mfma_f32_16x16x32_f16 v[12:15], v[48:51], v[228:231], v[12:15]
v_cvt_pk_f16_f32 v26, v26, v27
v_pk_fma_f16 v25, v24, v24, s48
v_mfma_f32_16x16x32_bf16 v[60:63], v[52:55], v[148:151], v[60:63]
s_waitcnt lgkmcnt(9)
ds_read_b128 v[52:55], v249 offset:18432
v_cvt_pkrtz_f16_f32 v56, v56, v57
v_mfma_f32_16x16x32_f16 v[96:99], v[48:51], v[156:159], v[96:99]
v_cvt_pkrtz_f16_f32 v57, v58, v59
v_lshrrev_b64 v[56:57], 2, v[56:57]
v_mfma_f32_16x16x32_bf16 v[112:115], v[120:123], v[28:31], 0
v_and_b32_sdwa v58, s47, v56 dst_sel:DWORD dst_unused:UNUSED_PAD src0_sel:DWORD src1_sel:WORD_1
v_and_b32_e64 v56, s47, v56
v_mfma_f32_16x16x32_f16 v[84:87], v[48:51], v[172:175], v[84:87]
ds_read_b128 v[48:51], v251 offset:51200
ds_read_u16_d16_hi v58, v58
v_mfma_f32_16x16x32_bf16 v[164:167], v[120:123], v[128:131], 0
ds_read_u16 v56, v56
v_and_b32_sdwa v59, s47, v57 dst_sel:DWORD dst_unused:UNUSED_PAD src0_sel:DWORD src1_sel:WORD_1
v_mfma_f32_16x16x32_f16 v[208:211], v[124:127], v[228:231], v[208:211]
s_setprio 3
v_and_b32_e64 v57, s47, v57
v_pk_fma_f16 v27, v26, v26, s48
v_mfma_f32_16x16x32_bf16 v[100:103], v[120:123], v[136:139], 0
ds_read_b128 v[120:123], v249 offset:20480
ds_read_u16_d16_hi v59, v59
v_mfma_f32_16x16x32_f16 v[212:215], v[124:127], v[156:159], v[212:215]
s_waitcnt lgkmcnt(10)
ds_read_u16 v57, v57
v_pk_mul_f16 v25, v24, v25
v_mfma_f32_16x16x32_bf16 v[112:115], v[184:187], v[36:39], v[112:115]
v_pk_mul_f16 v27, v26, v27
v_cvt_pkrtz_f16_f32 v60, v60, v61
v_mfma_f32_16x16x32_f16 v[236:239], v[124:127], v[172:175], v[236:239]
ds_read_b128 v[124:127], v251 offset:54272
v_cvt_pkrtz_f16_f32 v61, v62, v63
v_mfma_f32_16x16x32_bf16 v[164:167], v[184:187], v[108:111], v[164:167]
buffer_load_dwordx4 v[80:83], v253, s[4:7], s68 offen offset:256
buffer_load_dwordx4 v[88:91], v253, s[4:7], s68 offen offset:320
v_lshrrev_b64 v[60:61], 2, v[60:61]
v_mfma_f32_16x16x32_f16 v[180:183], v[176:179], v[228:231], v[180:183]
v_and_b32_sdwa v62, s47, v60 dst_sel:DWORD dst_unused:UNUSED_PAD src0_sel:DWORD src1_sel:WORD_1
v_and_b32_e64 v60, s47, v60
v_lshl_add_u64 v[34:35], v[140:141], 0, v[142:143]
v_exp_f16_sdwa v25, v25 dst_sel:WORD_0 dst_unused:UNUSED_PRESERVE src0_sel:WORD_0
v_mfma_f32_16x16x32_bf16 v[100:103], v[184:187], v[192:195], v[100:103]
ds_read_u16_d16_hi v62, v62
ds_read_u16 v60, v60
v_mfma_f32_16x16x32_f16 v[196:199], v[176:179], v[156:159], v[196:199]
ds_read_b128 v[184:187], v249 offset:22528
v_exp_f16_sdwa v27, v27 dst_sel:WORD_0 dst_unused:UNUSED_PRESERVE src0_sel:WORD_0
v_and_b32_sdwa v63, s47, v61 dst_sel:DWORD dst_unused:UNUSED_PAD src0_sel:DWORD src1_sel:WORD_1
v_and_b32 v61, s47, v61
s_waitcnt lgkmcnt(8)
v_mfma_f32_16x16x32_bf16 v[112:115], v[188:191], v[44:47], v[112:115]
ds_read_u16_d16_hi v63, v63
ds_read_u16 v61, v61
v_lshl_add_u64 v[6:7], v[200:201], 0, v[202:203]
v_mfma_f32_16x16x32_f16 v[92:95], v[176:179], v[172:175], v[92:95]
v_exp_f16_sdwa v25, v25 dst_sel:WORD_1 dst_unused:UNUSED_PRESERVE src0_sel:WORD_1
v_mfma_f32_16x16x32_bf16 v[164:167], v[188:191], v[144:147], v[164:167]
ds_read_b128 v[176:179], v251 offset:52224
v_exp_f16_sdwa v27, v27 dst_sel:WORD_1 dst_unused:UNUSED_PRESERVE src0_sel:WORD_1
v_mfma_f32_16x16x32_f16 v[216:219], v[160:163], v[228:231], v[216:219]
s_setprio 2
v_lshl_add_u64 v[134:135], v[68:69], 0, v[70:71]
v_pk_add_f16 v25, v25, 1.0 op_sel_hi:[1,0]
v_mfma_f32_16x16x32_bf16 v[100:103], v[188:191], v[148:151], v[100:103]
ds_read_b128 v[188:191], v249 offset:18688
v_pk_add_f16 v27, v27, 1.0 op_sel_hi:[1,0]
v_mfma_f32_16x16x32_f16 v[232:235], v[160:163], v[156:159], v[232:235]
v_rcp_f16_sdwa v25, v25 dst_sel:WORD_0 dst_unused:UNUSED_PRESERVE src0_sel:WORD_0
v_mfma_f32_16x16x32_bf16 v[64:67], v[52:55], v[28:31], 0
v_rcp_f16_sdwa v27, v27 dst_sel:WORD_0 dst_unused:UNUSED_PRESERVE src0_sel:WORD_0
v_mfma_f32_16x16x32_f16 v[224:227], v[160:163], v[172:175], v[224:227]
ds_read_b128 v[160:163], v251 offset:55296
v_cvt_pkrtz_f16_f32 v164, v164, v165
s_waitcnt vmcnt(11)
v_mfma_f32_16x16x32_bf16 v[76:79], v[18:21], v[152:155], v[76:79]
v_cvt_pkrtz_f16_f32 v165, v166, v167
v_lshrrev_b64 v[164:165], 2, v[164:165]
v_mfma_f32_16x16x32_bf16 v[220:223], v[16:19], v[152:155], v[220:223]
v_and_b32_sdwa v166, s47, v164 dst_sel:DWORD dst_unused:UNUSED_PAD src0_sel:DWORD src1_sel:WORD_1
v_and_b32_e64 v164, s47, v164
v_mfma_f32_16x16x32_bf16 v[140:143], v[52:55], v[128:131], 0
ds_read_u16_d16_hi v166, v166
ds_read_u16 v164, v164
v_mfma_f32_16x16x32_f16 v[116:119], v[48:51], v[132:135], v[116:119]
v_cvt_pk_f16_f32 v112, v112, v113
v_rcp_f16_sdwa v25, v25 dst_sel:WORD_1 dst_unused:UNUSED_PRESERVE src0_sel:WORD_1
v_mfma_f32_16x16x32_bf16 v[200:203], v[52:55], v[136:139], 0
v_cvt_pk_f16_f32 v114, v114, v115
v_pk_fma_f16 v113, v112, v112, s48
v_mfma_f32_16x16x32_f16 v[240:243], v[48:51], v[4:7], v[240:243]
s_waitcnt lgkmcnt(3)
ds_read_b128 v[52:55], v249 offset:20736
v_rcp_f16_sdwa v27, v27 dst_sel:WORD_1 dst_unused:UNUSED_PRESERVE src0_sel:WORD_1
v_mfma_f32_16x16x32_bf16 v[64:67], v[120:123], v[36:39], v[64:67]
v_and_b32_sdwa v167, s47, v165 dst_sel:DWORD dst_unused:UNUSED_PAD src0_sel:DWORD src1_sel:WORD_1
v_and_b32 v165, s47, v165
v_pk_fma_f16 v115, v114, v114, s48
v_mfma_f32_16x16x32_f16 v[76:79], v[48:51], v[32:35], v[76:79]
ds_read_u16_d16_hi v167, v167
ds_read_u16 v165, v165
ds_read_b128 v[48:51], v251 offset:53248
v_pk_mul_f16 v113, v112, v113
v_pk_mul_f16 v24, v24, v25
v_mfma_f32_16x16x32_bf16 v[140:143], v[120:123], v[108:111], v[140:143]
v_pk_mul_f16 v115, v114, v115
s_setprio 1
v_cvt_pkrtz_f16_f32 v100, v100, v101
v_mfma_f32_16x16x32_f16 v[72:75], v[124:127], v[132:135], v[72:75]
v_cvt_pkrtz_f16_f32 v101, v102, v103
v_lshrrev_b64 v[100:101], 2, v[100:101]
v_and_b32_sdwa v102, s47, v100 dst_sel:DWORD dst_unused:UNUSED_PAD src0_sel:DWORD src1_sel:WORD_1
v_and_b32 v100, s47, v100
v_pk_mul_f16 v25, v26, v27
v_exp_f16_sdwa v113, v113 dst_sel:WORD_0 dst_unused:UNUSED_PRESERVE src0_sel:WORD_0
v_lshl_add_u64 v[56:57], v[56:57], 0, v[58:59]
v_mfma_f32_16x16x32_bf16 v[200:203], v[120:123], v[192:195], v[200:203]
ds_read_u16_d16_hi v102, v102
ds_read_u16 v100, v100
v_mfma_f32_16x16x32_f16 v[8:11], v[124:127], v[4:7], v[8:11]
ds_read_b128 v[120:123], v249 offset:22784
v_exp_f16_sdwa v115, v115 dst_sel:WORD_0 dst_unused:UNUSED_PRESERVE src0_sel:WORD_0
v_and_b32_sdwa v103, s47, v101 dst_sel:DWORD dst_unused:UNUSED_PAD src0_sel:DWORD src1_sel:WORD_1
v_and_b32_e64 v101, s47, v101
v_mfma_f32_16x16x32_bf16 v[64:67], v[184:187], v[44:47], v[64:67]
ds_read_u16_d16_hi v103, v103
ds_read_u16 v101, v101
v_mfma_f32_16x16x32_f16 v[220:223], v[124:127], v[32:35], v[220:223]
v_exp_f16_sdwa v113, v113 dst_sel:WORD_1 dst_unused:UNUSED_PRESERVE src0_sel:WORD_1
v_mfma_f32_16x16x32_bf16 v[140:143], v[184:187], v[144:147], v[140:143]
ds_read_b128 v[124:127], v251 offset:56320
v_lshl_add_u64 v[60:61], v[60:61], 0, v[62:63]
v_mfma_f32_16x16x32_f16 v[12:15], v[176:179], v[132:135], v[12:15]
v_exp_f16_sdwa v115, v115 dst_sel:WORD_1 dst_unused:UNUSED_PRESERVE src0_sel:WORD_1
v_mfma_f32_16x16x32_bf16 v[200:203], v[184:187], v[148:151], v[200:203]
v_pk_add_f16 v113, v113, 1.0 op_sel_hi:[1,0]
v_pk_add_f16 v115, v115, 1.0 op_sel_hi:[1,0]
v_mfma_f32_16x16x32_f16 v[96:99], v[176:179], v[4:7], v[96:99]
ds_read_b128 v[184:187], v249 offset:24576
v_rcp_f16_sdwa v113, v113 dst_sel:WORD_0 dst_unused:UNUSED_PRESERVE src0_sel:WORD_0
v_mfma_f32_16x16x32_bf16 v[68:71], v[188:191], v[28:31], 0
v_rcp_f16_sdwa v115, v115 dst_sel:WORD_0 dst_unused:UNUSED_PRESERVE src0_sel:WORD_0
v_mfma_f32_16x16x32_f16 v[84:87], v[176:179], v[32:35], v[84:87]
ds_read_b128 v[176:179], v251 offset:57344
v_cvt_pkrtz_f16_f32 v64, v64, v65
v_mfma_f32_16x16x32_bf16 v[172:175], v[188:191], v[128:131], 0
s_setprio 0
v_cvt_pkrtz_f16_f32 v65, v66, v67
v_lshrrev_b64 v[64:65], 2, v[64:65]
s_waitcnt lgkmcnt(4)
v_mfma_f32_16x16x32_f16 v[208:211], v[160:163], v[132:135], v[208:211]
v_and_b32_sdwa v66, s47, v64 dst_sel:DWORD dst_unused:UNUSED_PAD src0_sel:DWORD src1_sel:WORD_1
v_and_b32_e64 v64, s47, v64
v_mfma_f32_16x16x32_bf16 v[156:159], v[188:191], v[136:139], 0
ds_read_u16_d16_hi v66, v66
ds_read_u16 v64, v64
v_rcp_f16_sdwa v113, v113 dst_sel:WORD_1 dst_unused:UNUSED_PRESERVE src0_sel:WORD_1
v_mfma_f32_16x16x32_f16 v[212:215], v[160:163], v[4:7], v[212:215]
ds_read_b128 v[188:191], v249 offset:26624
v_and_b32_sdwa v67, s47, v65 dst_sel:DWORD dst_unused:UNUSED_PAD src0_sel:DWORD src1_sel:WORD_1
v_and_b32_e64 v65, s47, v65
v_rcp_f16_sdwa v115, v115 dst_sel:WORD_1 dst_unused:UNUSED_PRESERVE src0_sel:WORD_1
v_mfma_f32_16x16x32_bf16 v[68:71], v[52:55], v[36:39], v[68:71]
ds_read_u16_d16_hi v67, v67
ds_read_u16 v65, v65
v_mfma_f32_16x16x32_f16 v[236:239], v[160:163], v[32:35], v[236:239]
v_cvt_pkrtz_f16_f32 v140, v140, v141
v_cvt_pkrtz_f16_f32 v141, v142, v143
v_lshrrev_b64 v[140:141], 2, v[140:141]
v_and_b32_sdwa v142, s47, v140 dst_sel:DWORD dst_unused:UNUSED_PAD src0_sel:DWORD src1_sel:WORD_1
v_and_b32_e64 v140, s47, v140
v_pk_mul_f16 v26, v112, v113
v_mfma_f32_16x16x32_bf16 v[172:175], v[52:55], v[108:111], v[172:175]
ds_read_u16_d16_hi v142, v142
ds_read_u16 v140, v140
ds_read_b128 v[160:163], v251 offset:60416
v_mfma_f32_16x16x32_f16 v[180:183], v[48:51], v[132:135], v[180:183]
v_and_b32_sdwa v143, s47, v141 dst_sel:DWORD dst_unused:UNUSED_PAD src0_sel:DWORD src1_sel:WORD_1
v_and_b32_e64 v141, s47, v141
v_pk_mul_f16 v27, v114, v115
v_lshl_add_u64 v[58:59], v[164:165], 0, v[166:167]
v_mfma_f32_16x16x32_bf16 v[156:159], v[52:55], v[192:195], v[156:159]
ds_read_u16_d16_hi v143, v143
ds_read_u16 v141, v141
v_cvt_pkrtz_f16_f32 v200, v200, v201
v_cvt_pkrtz_f16_f32 v201, v202, v203
v_lshrrev_b64 v[200:201], 2, v[200:201]
v_and_b32_sdwa v202, s47, v200 dst_sel:DWORD dst_unused:UNUSED_PAD src0_sel:DWORD src1_sel:WORD_1
v_and_b32 v200, s47, v200
v_mfma_f32_16x16x32_f16 v[196:199], v[48:51], v[4:7], v[196:199]
ds_read_u16_d16_hi v202, v202
s_waitcnt lgkmcnt(8)
ds_read_u16 v200, v200
ds_read_b128 v[52:55], v249 offset:28672
v_and_b32_sdwa v203, s47, v201 dst_sel:DWORD dst_unused:UNUSED_PAD src0_sel:DWORD src1_sel:WORD_1
v_and_b32_e64 v201, s47, v201
v_mfma_f32_16x16x32_bf16 v[68:71], v[120:123], v[44:47], v[68:71]
ds_read_u16_d16_hi v203, v203
ds_read_u16 v201, v201
v_mfma_f32_16x16x32_f16 v[92:95], v[48:51], v[32:35], v[92:95]
ds_read_b128 v[48:51], v251 offset:58368
s_setprio 3
v_lshl_add_u64 v[62:63], v[100:101], 0, v[102:103]
v_mfma_f32_16x16x32_bf16 v[172:175], v[120:123], v[144:147], v[172:175]
s_nop 0
v_cvt_pk_f16_f32 v68, v68, v69
v_mfma_f32_16x16x32_f16 v[216:219], v[124:127], v[132:135], v[216:219]
v_cvt_pk_f16_f32 v70, v70, v71
v_pk_fma_f16 v69, v68, v68, s48
v_mfma_f32_16x16x32_bf16 v[156:159], v[120:123], v[148:151], v[156:159]
ds_read_b128 v[120:123], v249 offset:24832
s_nop 0
v_cvt_pkrtz_f16_f32 v172, v172, v173
v_mfma_f32_16x16x32_f16 v[232:235], v[124:127], v[4:7], v[232:235]
v_cvt_pkrtz_f16_f32 v173, v174, v175
v_lshrrev_b64 v[172:173], 2, v[172:173]
v_mfma_f32_16x16x32_bf16 v[228:231], v[184:187], v[28:31], 0
v_and_b32_sdwa v174, s47, v172 dst_sel:DWORD dst_unused:UNUSED_PAD src0_sel:DWORD src1_sel:WORD_1
v_and_b32 v172, s47, v172
v_mfma_f32_16x16x32_f16 v[224:227], v[124:127], v[32:35], v[224:227]
ds_read_b128 v[124:127], v251 offset:61440
s_waitcnt lgkmcnt(8)
ds_read_u16_d16_hi v174, v174
s_waitcnt vmcnt(8)
v_mfma_f32_16x16x32_bf16 v[84:87], v[18:21], v[40:43], v[84:87]
ds_read_u16 v172, v172
v_and_b32_sdwa v175, s47, v173 dst_sel:DWORD dst_unused:UNUSED_PAD src0_sel:DWORD src1_sel:WORD_1
v_mfma_f32_16x16x32_bf16 v[236:239], v[16:19], v[40:43], v[236:239]
v_and_b32 v173, s47, v173
v_pk_fma_f16 v71, v70, v70, s48
s_waitcnt vmcnt(7)
v_mfma_f32_16x16x32_bf16 v[92:95], v[18:21], v[0:3], v[92:95]
ds_read_u16_d16_hi v175, v175
ds_read_u16 v173, v173
v_mfma_f32_16x16x32_bf16 v[224:227], v[16:19], v[0:3], v[224:227]
v_pk_mul_f16 v69, v68, v69
v_pk_mul_f16 v71, v70, v71
v_mfma_f32_16x16x32_bf16 v[152:155], v[184:187], v[128:131], 0
v_cvt_pkrtz_f16_f32 v156, v156, v157
v_cvt_pkrtz_f16_f32 v157, v158, v159
v_mfma_f32_16x16x32_f16 v[116:119], v[176:179], v[60:63], v[116:119]
v_lshrrev_b64 v[156:157], 2, v[156:157]
v_and_b32_sdwa v158, s47, v156 dst_sel:DWORD dst_unused:UNUSED_PAD src0_sel:DWORD src1_sel:WORD_1
v_mfma_f32_16x16x32_bf16 v[112:115], v[184:187], v[136:139], 0
ds_read_b128 v[184:187], v249 offset:26880
v_and_b32_e64 v156, s47, v156
v_mfma_f32_16x16x32_f16 v[240:243], v[176:179], v[56:59], v[240:243]
ds_read_u16_d16_hi v158, v158
ds_read_u16 v156, v156
v_mfma_f32_16x16x32_bf16 v[228:231], v[188:191], v[36:39], v[228:231]
v_lshl_add_u64 v[64:65], v[64:65], 0, v[66:67]
v_exp_f16_sdwa v69, v69 dst_sel:WORD_0 dst_unused:UNUSED_PRESERVE src0_sel:WORD_0
v_mfma_f32_16x16x32_f16 v[76:79], v[176:179], v[24:27], v[76:79]
s_waitcnt lgkmcnt(7)
ds_read_b128 v[176:179], v251 offset:59392
s_setprio 2
v_exp_f16_sdwa v71, v71 dst_sel:WORD_0 dst_unused:UNUSED_PRESERVE src0_sel:WORD_0
v_mfma_f32_16x16x32_bf16 v[152:155], v[188:191], v[108:111], v[152:155]
v_and_b32_sdwa v159, s47, v157 dst_sel:DWORD dst_unused:UNUSED_PAD src0_sel:DWORD src1_sel:WORD_1
v_and_b32_e64 v157, s47, v157
v_mfma_f32_16x16x32_f16 v[72:75], v[160:163], v[60:63], v[72:75]
ds_read_u16_d16_hi v159, v159
ds_read_u16 v157, v157
v_mfma_f32_16x16x32_bf16 v[112:115], v[188:191], v[192:195], v[112:115]
ds_read_b128 v[188:191], v249 offset:28928
v_lshl_add_u64 v[140:141], v[140:141], 0, v[142:143]
v_mfma_f32_16x16x32_f16 v[8:11], v[160:163], v[56:59], v[8:11]
v_exp_f16_sdwa v69, v69 dst_sel:WORD_1 dst_unused:UNUSED_PRESERVE src0_sel:WORD_1
v_mfma_f32_16x16x32_bf16 v[228:231], v[52:55], v[44:47], v[228:231]
v_exp_f16_sdwa v71, v71 dst_sel:WORD_1 dst_unused:UNUSED_PRESERVE src0_sel:WORD_1
v_mfma_f32_16x16x32_f16 v[220:223], v[160:163], v[24:27], v[220:223]
ds_read_b128 v[160:163], v251 offset:62464
v_lshl_add_u64 v[200:201], v[200:201], 0, v[202:203]
v_mfma_f32_16x16x32_bf16 v[152:155], v[52:55], v[144:147], v[152:155]
v_pk_add_f16 v69, v69, 1.0 op_sel_hi:[1,0]
v_pk_add_f16 v71, v71, 1.0 op_sel_hi:[1,0]
v_mfma_f32_16x16x32_f16 v[12:15], v[48:51], v[60:63], v[12:15]
v_rcp_f16_sdwa v69, v69 dst_sel:WORD_0 dst_unused:UNUSED_PRESERVE src0_sel:WORD_0
v_mfma_f32_16x16x32_bf16 v[112:115], v[52:55], v[148:151], v[112:115]
ds_read_b128 v[52:55], v249 offset:30720
v_rcp_f16_sdwa v71, v71 dst_sel:WORD_0 dst_unused:UNUSED_PRESERVE src0_sel:WORD_0
v_mfma_f32_16x16x32_f16 v[96:99], v[48:51], v[56:59], v[96:99]
v_cvt_pkrtz_f16_f32 v152, v152, v153
v_cvt_pkrtz_f16_f32 v153, v154, v155
v_mfma_f32_16x16x32_bf16 v[164:167], v[120:123], v[28:31], 0
v_lshrrev_b64 v[152:153], 2, v[152:153]
v_and_b32_sdwa v154, s47, v152 dst_sel:DWORD dst_unused:UNUSED_PAD src0_sel:DWORD src1_sel:WORD_1
v_mfma_f32_16x16x32_f16 v[84:87], v[48:51], v[24:27], v[84:87]
ds_read_b128 v[48:51], v251 offset:63488
s_setprio 1
v_and_b32_e64 v152, s47, v152
v_mfma_f32_16x16x32_bf16 v[100:103], v[120:123], v[128:131], 0
ds_read_u16_d16_hi v154, v154
s_waitcnt lgkmcnt(5)
ds_read_u16 v152, v152
v_mfma_f32_16x16x32_f16 v[208:211], v[124:127], v[60:63], v[208:211]
v_cvt_pk_f16_f32 v228, v228, v229
v_rcp_f16_sdwa v69, v69 dst_sel:WORD_1 dst_unused:UNUSED_PRESERVE src0_sel:WORD_1
v_mfma_f32_16x16x32_bf16 v[32:35], v[120:123], v[136:139], 0
v_cvt_pk_f16_f32 v230, v230, v231
v_pk_fma_f16 v229, v228, v228, s48
v_mfma_f32_16x16x32_f16 v[212:215], v[124:127], v[56:59], v[212:215]
ds_read_b128 v[120:123], v249 offset:32768
v_rcp_f16_sdwa v71, v71 dst_sel:WORD_1 dst_unused:UNUSED_PRESERVE src0_sel:WORD_1
v_mfma_f32_16x16x32_bf16 v[164:167], v[184:187], v[36:39], v[164:167]
v_and_b32_sdwa v155, s47, v153 dst_sel:DWORD dst_unused:UNUSED_PAD src0_sel:DWORD src1_sel:WORD_1
v_and_b32_e64 v153, s47, v153
v_pk_fma_f16 v231, v230, v230, s48
v_mfma_f32_16x16x32_f16 v[236:239], v[124:127], v[24:27], v[236:239]
ds_read_u16_d16_hi v155, v155
ds_read_u16 v153, v153
ds_read_b128 v[124:127], v252 offset:1024
v_pk_mul_f16 v229, v228, v229
v_pk_mul_f16 v66, v68, v69
v_mfma_f32_16x16x32_bf16 v[100:103], v[184:187], v[108:111], v[100:103]
v_pk_mul_f16 v231, v230, v231
v_cvt_pkrtz_f16_f32 v112, v112, v113
v_mfma_f32_16x16x32_f16 v[180:183], v[176:179], v[60:63], v[180:183]
v_cvt_pkrtz_f16_f32 v113, v114, v115
v_lshrrev_b64 v[112:113], 2, v[112:113]
v_and_b32_sdwa v114, s47, v112 dst_sel:DWORD dst_unused:UNUSED_PAD src0_sel:DWORD src1_sel:WORD_1
v_and_b32_e64 v112, s47, v112
v_pk_mul_f16 v67, v70, v71
v_exp_f16_sdwa v229, v229 dst_sel:WORD_0 dst_unused:UNUSED_PRESERVE src0_sel:WORD_0
v_lshl_add_u64 v[142:143], v[172:173], 0, v[174:175]
v_mfma_f32_16x16x32_bf16 v[32:35], v[184:187], v[192:195], v[32:35]
ds_read_u16_d16_hi v114, v114
ds_read_u16 v112, v112
v_mfma_f32_16x16x32_f16 v[196:199], v[176:179], v[56:59], v[196:199]
ds_read_b128 v[184:187], v249 offset:34816
v_exp_f16_sdwa v231, v231 dst_sel:WORD_0 dst_unused:UNUSED_PRESERVE src0_sel:WORD_0
v_and_b32_sdwa v115, s47, v113 dst_sel:DWORD dst_unused:UNUSED_PAD src0_sel:DWORD src1_sel:WORD_1
v_and_b32_e64 v113, s47, v113
s_waitcnt lgkmcnt(6)
v_mfma_f32_16x16x32_bf16 v[164:167], v[188:191], v[44:47], v[164:167]
ds_read_u16_d16_hi v115, v115
ds_read_u16 v113, v113
v_mfma_f32_16x16x32_f16 v[92:95], v[176:179], v[24:27], v[92:95]
v_exp_f16_sdwa v229, v229 dst_sel:WORD_1 dst_unused:UNUSED_PRESERVE src0_sel:WORD_1
s_setprio 0
ds_read_b128 v[176:179], v251 offset:64512
v_mfma_f32_16x16x32_bf16 v[100:103], v[188:191], v[144:147], v[100:103]
v_lshl_add_u64 v[202:203], v[156:157], 0, v[158:159]
v_exp_f16_sdwa v231, v231 dst_sel:WORD_1 dst_unused:UNUSED_PRESERVE src0_sel:WORD_1
v_mfma_f32_16x16x32_f16 v[216:219], v[160:163], v[60:63], v[216:219]
v_pk_add_f16 v229, v229, 1.0 op_sel_hi:[1,0]
v_pk_add_f16 v231, v231, 1.0 op_sel_hi:[1,0]
v_mfma_f32_16x16x32_bf16 v[32:35], v[188:191], v[148:151], v[32:35]
ds_read_b128 v[188:191], v249 offset:30976
v_rcp_f16_sdwa v229, v229 dst_sel:WORD_0 dst_unused:UNUSED_PRESERVE src0_sel:WORD_0
v_mfma_f32_16x16x32_f16 v[232:235], v[160:163], v[56:59], v[232:235]
v_rcp_f16_sdwa v231, v231 dst_sel:WORD_0 dst_unused:UNUSED_PRESERVE src0_sel:WORD_0
v_mfma_f32_16x16x32_bf16 v[4:7], v[52:55], v[28:31], 0
v_cvt_pkrtz_f16_f32 v164, v164, v165
v_cvt_pkrtz_f16_f32 v165, v166, v167
v_mfma_f32_16x16x32_f16 v[224:227], v[160:163], v[24:27], v[224:227]
ds_read_b128 v[160:163], v252 offset:2048
v_lshrrev_b64 v[164:165], 2, v[164:165]
s_waitcnt vmcnt(5)
v_mfma_f32_16x16x32_bf16 v[240:243], v[18:21], v[244:247], v[240:243]
v_and_b32_sdwa v166, s47, v164 dst_sel:DWORD dst_unused:UNUSED_PAD src0_sel:DWORD src1_sel:WORD_1
v_and_b32_e64 v164, s47, v164
v_mfma_f32_16x16x32_bf16 v[8:11], v[16:19], v[244:247], v[8:11]
ds_read_u16_d16_hi v166, v166
ds_read_u16 v164, v164
s_waitcnt vmcnt(4)
v_mfma_f32_16x16x32_bf16 v[96:99], v[18:21], v[168:171], v[96:99]
v_rcp_f16_sdwa v229, v229 dst_sel:WORD_1 dst_unused:UNUSED_PRESERVE src0_sel:WORD_1
v_mfma_f32_16x16x32_bf16 v[212:215], v[16:19], v[168:171], v[212:215]
v_and_b32_sdwa v167, s47, v165 dst_sel:DWORD dst_unused:UNUSED_PAD src0_sel:DWORD src1_sel:WORD_1
v_and_b32 v165, s47, v165
v_mfma_f32_16x16x32_bf16 v[132:135], v[52:55], v[128:131], 0
ds_read_u16_d16_hi v167, v167
ds_read_u16 v165, v165
v_mfma_f32_16x16x32_f16 v[116:119], v[48:51], v[200:203], v[116:119]
v_rcp_f16_sdwa v231, v231 dst_sel:WORD_1 dst_unused:UNUSED_PRESERVE src0_sel:WORD_1
v_mfma_f32_16x16x32_bf16 v[40:43], v[52:55], v[136:139], 0
s_waitcnt lgkmcnt(5)
ds_read_b128 v[52:55], v249 offset:33024
v_cvt_pkrtz_f16_f32 v100, v100, v101
v_mfma_f32_16x16x32_f16 v[240:243], v[48:51], v[140:143], v[240:243]
v_cvt_pkrtz_f16_f32 v101, v102, v103
v_lshrrev_b64 v[100:101], 2, v[100:101]
v_mfma_f32_16x16x32_bf16 v[4:7], v[120:123], v[36:39], v[4:7]
v_and_b32_sdwa v102, s47, v100 dst_sel:DWORD dst_unused:UNUSED_PAD src0_sel:DWORD src1_sel:WORD_1
v_and_b32 v100, s47, v100
v_mfma_f32_16x16x32_f16 v[76:79], v[48:51], v[64:67], v[76:79]
s_setprio 3
ds_read_u16_d16_hi v102, v102
ds_read_u16 v100, v100
ds_read_b128 v[48:51], v252
v_pk_mul_f16 v228, v228, v229
v_mfma_f32_16x16x32_bf16 v[132:135], v[120:123], v[108:111], v[132:135]
v_and_b32_sdwa v103, s47, v101 dst_sel:DWORD dst_unused:UNUSED_PAD src0_sel:DWORD src1_sel:WORD_1
v_and_b32_e64 v101, s47, v101
v_mfma_f32_16x16x32_f16 v[72:75], v[124:127], v[200:203], v[72:75]
ds_read_u16_d16_hi v103, v103
ds_read_u16 v101, v101
v_pk_mul_f16 v229, v230, v231
v_lshl_add_u64 v[152:153], v[152:153], 0, v[154:155]
v_mfma_f32_16x16x32_bf16 v[40:43], v[120:123], v[192:195], v[40:43]
v_cvt_pkrtz_f16_f32 v32, v32, v33
v_cvt_pkrtz_f16_f32 v33, v34, v35
v_lshrrev_b64 v[32:33], 2, v[32:33]
v_and_b32_sdwa v34, s47, v32 dst_sel:DWORD dst_unused:UNUSED_PAD src0_sel:DWORD src1_sel:WORD_1
v_and_b32_e64 v32, s47, v32
v_mfma_f32_16x16x32_f16 v[8:11], v[124:127], v[140:143], v[8:11]
ds_read_u16_d16_hi v34, v34
ds_read_u16 v32, v32
ds_read_b128 v[120:123], v249 offset:35072
v_and_b32_sdwa v35, s47, v33 dst_sel:DWORD dst_unused:UNUSED_PAD src0_sel:DWORD src1_sel:WORD_1
v_and_b32 v33, s47, v33
v_mfma_f32_16x16x32_bf16 v[4:7], v[184:187], v[44:47], v[4:7]
ds_read_u16_d16_hi v35, v35
s_waitcnt lgkmcnt(9)
ds_read_u16 v33, v33
v_mfma_f32_16x16x32_f16 v[220:223], v[124:127], v[64:67], v[220:223]
ds_read_b128 v[124:127], v252 offset:3072
v_lshl_add_u64 v[112:113], v[112:113], 0, v[114:115]
v_mfma_f32_16x16x32_bf16 v[132:135], v[184:187], v[144:147], v[132:135]
s_nop 0
v_cvt_pk_f16_f32 v4, v4, v5
v_mfma_f32_16x16x32_f16 v[12:15], v[176:179], v[200:203], v[12:15]
v_cvt_pk_f16_f32 v6, v6, v7
v_pk_fma_f16 v5, v4, v4, s48
v_mfma_f32_16x16x32_bf16 v[40:43], v[184:187], v[148:151], v[40:43]
ds_read_b128 v[184:187], v252 offset:4096
s_nop 0
v_cvt_pkrtz_f16_f32 v132, v132, v133
v_mfma_f32_16x16x32_f16 v[96:99], v[176:179], v[140:143], v[96:99]
v_cvt_pkrtz_f16_f32 v133, v134, v135
v_lshrrev_b64 v[132:133], 2, v[132:133]
v_mfma_f32_16x16x32_bf16 v[0:3], v[188:191], v[28:31], 0
v_and_b32_sdwa v134, s47, v132 dst_sel:DWORD dst_unused:UNUSED_PAD src0_sel:DWORD src1_sel:WORD_1
v_and_b32 v132, s47, v132
v_mfma_f32_16x16x32_f16 v[84:87], v[176:179], v[64:67], v[84:87]
s_setprio 2
ds_read_u16_d16_hi v134, v134
ds_read_u16 v132, v132
v_mfma_f32_16x16x32_bf16 v[68:71], v[188:191], v[128:131], 0
v_and_b32_sdwa v135, s47, v133 dst_sel:DWORD dst_unused:UNUSED_PAD src0_sel:DWORD src1_sel:WORD_1
v_and_b32 v133, s47, v133
v_mfma_f32_16x16x32_f16 v[208:211], v[160:163], v[200:203], v[208:211]
ds_read_u16_d16_hi v135, v135
s_waitcnt lgkmcnt(8)
ds_read_u16 v133, v133
v_mfma_f32_16x16x32_bf16 v[172:175], v[188:191], v[136:139], 0
v_pk_fma_f16 v7, v6, v6, s48
v_pk_mul_f16 v5, v4, v5
v_mfma_f32_16x16x32_f16 v[212:215], v[160:163], v[140:143], v[212:215]
ds_read_b128 v[176:179], v252 offset:7168
v_pk_mul_f16 v7, v6, v7
v_mfma_f32_16x16x32_bf16 v[0:3], v[52:55], v[36:39], v[0:3]
v_cvt_pkrtz_f16_f32 v40, v40, v41
v_cvt_pkrtz_f16_f32 v41, v42, v43
v_mfma_f32_16x16x32_f16 v[236:239], v[160:163], v[64:67], v[236:239]
v_lshrrev_b64 v[40:41], 2, v[40:41]
v_and_b32_sdwa v42, s47, v40 dst_sel:DWORD dst_unused:UNUSED_PAD src0_sel:DWORD src1_sel:WORD_1
v_mfma_f32_16x16x32_bf16 v[68:71], v[52:55], v[108:111], v[68:71]
v_and_b32_e64 v40, s47, v40
v_lshl_add_u64 v[230:231], v[164:165], 0, v[166:167]
v_mfma_f32_16x16x32_f16 v[180:183], v[48:51], v[200:203], v[180:183]
ds_read_u16_d16_hi v42, v42
ds_read_u16 v40, v40
v_exp_f16_sdwa v5, v5 dst_sel:WORD_0 dst_unused:UNUSED_PRESERVE src0_sel:WORD_0
v_mfma_f32_16x16x32_bf16 v[172:175], v[52:55], v[192:195], v[172:175]
v_exp_f16_sdwa v7, v7 dst_sel:WORD_0 dst_unused:UNUSED_PRESERVE src0_sel:WORD_0
v_mfma_f32_16x16x32_f16 v[196:199], v[48:51], v[140:143], v[196:199]
v_and_b32_sdwa v43, s47, v41 dst_sel:DWORD dst_unused:UNUSED_PAD src0_sel:DWORD src1_sel:WORD_1
v_and_b32_e64 v41, s47, v41
s_waitcnt lgkmcnt(5)
v_mfma_f32_16x16x32_bf16 v[0:3], v[120:123], v[44:47], v[0:3]
ds_read_u16_d16_hi v43, v43
ds_read_u16 v41, v41
v_lshl_add_u64 v[154:155], v[100:101], 0, v[102:103]
s_setprio 1
v_mfma_f32_16x16x32_f16 v[92:95], v[48:51], v[64:67], v[92:95]
v_exp_f16_sdwa v5, v5 dst_sel:WORD_1 dst_unused:UNUSED_PRESERVE src0_sel:WORD_1
v_mfma_f32_16x16x32_bf16 v[68:71], v[120:123], v[144:147], v[68:71]
ds_read_b128 v[188:191], v252 offset:5120
v_exp_f16_sdwa v7, v7 dst_sel:WORD_1 dst_unused:UNUSED_PRESERVE src0_sel:WORD_1
v_mfma_f32_16x16x32_f16 v[216:219], v[124:127], v[200:203], v[216:219]
v_lshl_add_u64 v[114:115], v[32:33], 0, v[34:35]
v_pk_add_f16 v5, v5, 1.0 op_sel_hi:[1,0]
v_mfma_f32_16x16x32_bf16 v[172:175], v[120:123], v[148:151], v[172:175]
v_pk_add_f16 v7, v7, 1.0 op_sel_hi:[1,0]
v_rcp_f16_sdwa v5, v5 dst_sel:WORD_0 dst_unused:UNUSED_PRESERVE src0_sel:WORD_0
v_mfma_f32_16x16x32_f16 v[232:235], v[124:127], v[140:143], v[232:235]
ds_read_b128 v[160:163], v252 offset:8192
v_rcp_f16_sdwa v7, v7 dst_sel:WORD_0 dst_unused:UNUSED_PRESERVE src0_sel:WORD_0
v_mfma_f32_16x16x32_f16 v[224:227], v[124:127], v[64:67], v[224:227]
v_cvt_pkrtz_f16_f32 v68, v68, v69
v_cvt_pkrtz_f16_f32 v69, v70, v71
s_waitcnt vmcnt(3)
v_mfma_f32_16x16x32_bf16 v[196:199], v[18:21], v[104:107], v[196:199]
v_lshrrev_b64 v[68:69], 2, v[68:69]
v_and_b32_sdwa v70, s47, v68 dst_sel:DWORD dst_unused:UNUSED_PAD src0_sel:DWORD src1_sel:WORD_1
v_mfma_f32_16x16x32_bf16 v[232:235], v[16:19], v[104:107], v[232:235]
v_and_b32_e64 v68, s47, v68
v_cvt_pk_f16_f32 v0, v0, v1
s_waitcnt vmcnt(2)
v_mfma_f32_16x16x32_bf16 v[116:119], v[18:21], v[204:207], v[116:119]
ds_read_u16_d16_hi v70, v70
ds_read_u16 v68, v68
v_mfma_f32_16x16x32_bf16 v[72:75], v[16:19], v[204:207], v[72:75]
v_rcp_f16_sdwa v5, v5 dst_sel:WORD_1 dst_unused:UNUSED_PRESERVE src0_sel:WORD_1
v_mfma_f32_16x16x32_f16 v[116:119], v[184:187], v[112:115], v[116:119]
v_cvt_pk_f16_f32 v2, v2, v3
v_pk_fma_f16 v1, v0, v0, s48
v_mfma_f32_16x16x32_f16 v[240:243], v[184:187], v[152:155], v[240:243]
v_rcp_f16_sdwa v7, v7 dst_sel:WORD_1 dst_unused:UNUSED_PRESERVE src0_sel:WORD_1
s_setprio 0
v_and_b32_sdwa v71, s47, v69 dst_sel:DWORD dst_unused:UNUSED_PAD src0_sel:DWORD src1_sel:WORD_1
v_and_b32 v69, s47, v69
v_pk_fma_f16 v3, v2, v2, s48
v_mfma_f32_16x16x32_f16 v[76:79], v[184:187], v[228:231], v[76:79]
ds_read_u16_d16_hi v71, v71
ds_read_u16 v69, v69
ds_read_b128 v[52:55], v252 offset:6144
v_pk_mul_f16 v1, v0, v1
v_pk_mul_f16 v4, v4, v5
v_pk_mul_f16 v3, v2, v3
s_waitcnt lgkmcnt(5)
v_mfma_f32_16x16x32_f16 v[72:75], v[176:179], v[112:115], v[72:75]
v_cvt_pkrtz_f16_f32 v172, v172, v173
v_cvt_pkrtz_f16_f32 v173, v174, v175
v_lshrrev_b64 v[172:173], 2, v[172:173]
v_and_b32_sdwa v174, s47, v172 dst_sel:DWORD dst_unused:UNUSED_PAD src0_sel:DWORD src1_sel:WORD_1
v_and_b32 v172, s47, v172
v_pk_mul_f16 v5, v6, v7
v_exp_f16_sdwa v1, v1 dst_sel:WORD_0 dst_unused:UNUSED_PRESERVE src0_sel:WORD_0
v_lshl_add_u64 v[132:133], v[132:133], 0, v[134:135]
v_mfma_f32_16x16x32_f16 v[8:11], v[176:179], v[152:155], v[8:11]
ds_read_u16_d16_hi v174, v174
ds_read_u16 v172, v172
v_exp_f16_sdwa v3, v3 dst_sel:WORD_0 dst_unused:UNUSED_PRESERVE src0_sel:WORD_0
v_and_b32_sdwa v175, s47, v173 dst_sel:DWORD dst_unused:UNUSED_PAD src0_sel:DWORD src1_sel:WORD_1
v_and_b32 v173, s47, v173
v_mfma_f32_16x16x32_f16 v[220:223], v[176:179], v[228:231], v[220:223]
ds_read_u16_d16_hi v175, v175
ds_read_u16 v173, v173
v_exp_f16_sdwa v1, v1 dst_sel:WORD_1 dst_unused:UNUSED_PRESERVE src0_sel:WORD_1
v_mfma_f32_16x16x32_f16 v[12:15], v[188:191], v[112:115], v[12:15]
ds_read_b128 v[48:51], v252 offset:9216
v_lshl_add_u64 v[40:41], v[40:41], 0, v[42:43]
v_exp_f16_sdwa v3, v3 dst_sel:WORD_1 dst_unused:UNUSED_PRESERVE src0_sel:WORD_1
v_mfma_f32_16x16x32_f16 v[96:99], v[188:191], v[152:155], v[96:99]
v_pk_add_f16 v1, v1, 1.0 op_sel_hi:[1,0]
v_pk_add_f16 v3, v3, 1.0 op_sel_hi:[1,0]
s_setprio 3
v_rcp_f16_sdwa v1, v1 dst_sel:WORD_0 dst_unused:UNUSED_PRESERVE src0_sel:WORD_0
v_mfma_f32_16x16x32_f16 v[84:87], v[188:191], v[228:231], v[84:87]
ds_read_b128 v[120:123], v252 offset:10240
v_rcp_f16_sdwa v3, v3 dst_sel:WORD_0 dst_unused:UNUSED_PRESERVE src0_sel:WORD_0
v_mfma_f32_16x16x32_f16 v[208:211], v[160:163], v[112:115], v[208:211]
ds_read_b128 v[124:127], v252 offset:13312
v_rcp_f16_sdwa v1, v1 dst_sel:WORD_1 dst_unused:UNUSED_PRESERVE src0_sel:WORD_1
v_mfma_f32_16x16x32_f16 v[212:215], v[160:163], v[152:155], v[212:215]
v_rcp_f16_sdwa v3, v3 dst_sel:WORD_1 dst_unused:UNUSED_PRESERVE src0_sel:WORD_1
v_mfma_f32_16x16x32_f16 v[236:239], v[160:163], v[228:231], v[236:239]
ds_read_b128 v[184:187], v252 offset:11264
v_pk_mul_f16 v6, v0, v1
s_waitcnt lgkmcnt(6)
v_mfma_f32_16x16x32_f16 v[180:183], v[52:55], v[112:115], v[180:183]
v_pk_mul_f16 v7, v2, v3
v_lshl_add_u64 v[134:135], v[68:69], 0, v[70:71]
v_mfma_f32_16x16x32_f16 v[196:199], v[52:55], v[152:155], v[196:199]
ds_read_b128 v[176:179], v252 offset:14336
s_setprio 2
ds_read_b128 v[188:191], v252 offset:12288
v_mfma_f32_16x16x32_f16 v[92:95], v[52:55], v[228:231], v[92:95]
s_waitcnt lgkmcnt(5)
v_lshl_add_u64 v[42:43], v[172:173], 0, v[174:175]
ds_read_b128 v[160:163], v252 offset:15360
v_mfma_f32_16x16x32_f16 v[216:219], v[48:51], v[112:115], v[216:219]
v_mfma_f32_16x16x32_f16 v[232:235], v[48:51], v[152:155], v[232:235]
v_mfma_f32_16x16x32_f16 v[224:227], v[48:51], v[228:231], v[224:227]
s_waitcnt vmcnt(1)
v_mfma_f32_16x16x32_bf16 v[12:15], v[18:21], v[80:83], v[12:15]
v_mfma_f32_16x16x32_bf16 v[208:211], v[16:19], v[80:83], v[208:211]
s_waitcnt vmcnt(0)
v_mfma_f32_16x16x32_bf16 v[180:183], v[18:21], v[88:91], v[180:183]
v_mfma_f32_16x16x32_bf16 v[216:219], v[16:19], v[88:91], v[216:219]
s_waitcnt lgkmcnt(2)
v_mfma_f32_16x16x32_f16 v[116:119], v[120:123], v[40:43], v[116:119]
v_mfma_f32_16x16x32_f16 v[240:243], v[120:123], v[132:135], v[240:243]
v_mfma_f32_16x16x32_f16 v[76:79], v[120:123], v[4:7], v[76:79]
s_nop 5
v_cvt_pk_bf16_f32 v116, v116, v117
v_mfma_f32_16x16x32_f16 v[72:75], v[124:127], v[40:43], v[72:75]
s_setprio 1
v_cvt_pk_bf16_f32 v117, v118, v119
v_cvt_pk_bf16_f32 v240, v240, v241
v_mfma_f32_16x16x32_f16 v[8:11], v[124:127], v[132:135], v[8:11]
v_cvt_pk_bf16_f32 v76, v76, v77
v_cvt_pk_bf16_f32 v77, v78, v79
v_mfma_f32_16x16x32_f16 v[220:223], v[124:127], v[4:7], v[220:223]
v_cvt_pk_bf16_f32 v241, v242, v243
v_cvt_pk_bf16_f32 v118, v72, v73
v_mfma_f32_16x16x32_f16 v[12:15], v[184:187], v[40:43], v[12:15]
s_nop 1
v_cvt_pk_bf16_f32 v242, v8, v9
v_cvt_pk_bf16_f32 v243, v10, v11
v_mfma_f32_16x16x32_f16 v[96:99], v[184:187], v[132:135], v[96:99]
v_cvt_pk_bf16_f32 v78, v220, v221
v_cvt_pk_bf16_f32 v79, v222, v223
v_mfma_f32_16x16x32_f16 v[84:87], v[184:187], v[4:7], v[84:87]
v_cvt_pk_bf16_f32 v119, v74, v75
v_cvt_pk_bf16_f32 v12, v12, v13
v_mfma_f32_16x16x32_f16 v[208:211], v[176:179], v[40:43], v[208:211]
s_nop 1
v_cvt_pk_bf16_f32 v96, v96, v97
v_cvt_pk_bf16_f32 v97, v98, v99
v_mfma_f32_16x16x32_f16 v[212:215], v[176:179], v[132:135], v[212:215]
v_cvt_pk_bf16_f32 v84, v84, v85
v_cvt_pk_bf16_f32 v85, v86, v87
v_mfma_f32_16x16x32_f16 v[236:239], v[176:179], v[4:7], v[236:239]
v_cvt_pk_bf16_f32 v13, v14, v15
v_cvt_pk_bf16_f32 v14, v208, v209
v_cvt_pk_bf16_f32 v15, v210, v211
s_waitcnt lgkmcnt(0)
v_mfma_f32_16x16x32_f16 v[180:183], v[188:191], v[40:43], v[180:183]
v_cvt_pk_bf16_f32 v98, v212, v213
v_cvt_pk_bf16_f32 v99, v214, v215
v_mfma_f32_16x16x32_f16 v[196:199], v[188:191], v[132:135], v[196:199]
v_cvt_pk_bf16_f32 v86, v236, v237
v_cvt_pk_bf16_f32 v87, v238, v239
v_mfma_f32_16x16x32_f16 v[92:95], v[188:191], v[4:7], v[92:95]
s_nop 1
v_cvt_pk_bf16_f32 v180, v180, v181
v_cvt_pk_bf16_f32 v181, v182, v183
v_mfma_f32_16x16x32_f16 v[216:219], v[160:163], v[40:43], v[216:219]
v_cvt_pk_bf16_f32 v196, v196, v197
v_cvt_pk_bf16_f32 v197, v198, v199
v_mfma_f32_16x16x32_f16 v[232:235], v[160:163], v[132:135], v[232:235]
v_cvt_pk_bf16_f32 v92, v92, v93
v_cvt_pk_bf16_f32 v93, v94, v95
s_setprio 0
v_mfma_f32_16x16x32_f16 v[224:227], v[160:163], v[4:7], v[224:227]
s_nop 0
v_cvt_pk_bf16_f32 v182, v216, v217
v_cvt_pk_bf16_f32 v183, v218, v219
s_nop 0
v_cvt_pk_bf16_f32 v198, v232, v233
v_cvt_pk_bf16_f32 v199, v234, v235
s_nop 1
v_cvt_pk_bf16_f32 v94, v224, v225
v_cvt_pk_bf16_f32 v95, v226, v227
buffer_store_dwordx4 v[76:79], v253, s[8:11], s69 offen offset:192 sc1
buffer_store_dwordx4 v[84:87], v253, s[8:11], s69 offen offset:256 sc1
buffer_store_dwordx4 v[92:95], v253, s[8:11], s69 offen offset:320 sc1
buffer_store_dwordx4 v[240:243], v253, s[8:11], s68 offen sc1
buffer_store_dwordx4 v[96:99], v253, s[8:11], s68 offen offset:64 sc1
buffer_store_dwordx4 v[196:199], v253, s[8:11], s68 offen offset:128 sc1
buffer_store_dwordx4 v[116:119], v253, s[8:11], s68 offen offset:192 sc1
buffer_store_dwordx4 v[12:15], v253, s[8:11], s68 offen offset:256 sc1
buffer_store_dwordx4 v[180:183], v253, s[8:11], s68 offen offset:320 sc1
s_endpgm
Lpolln:
s_getreg_b32 s43, hwreg(HW_REG_IB_STS, 0, 4)
s_cmp_eq_u32 s43, 0
s_cbranch_scc1 Lpoll
s_setpc_b64 s[78:79]
Lpoll:
s_waitcnt vmcnt(0)
s_mov_b32 s3, 1
s_cmp_eq_u32 s77, 2
s_cbranch_scc1 LpollC
v_max_u32 v241, v128, v129
v_max3_u32 v241, v241, v130, v131
v_max3_u32 v241, v241, v132, v133
v_max3_u32 v241, v241, v134, v135
v_max3_u32 v241, v241, v136, v137
v_max3_u32 v241, v241, v138, v139
v_max3_u32 v241, v241, v140, v141
v_max3_u32 v241, v241, v142, v143
v_cmp_eq_u32 vcc, -1, v241
s_nop 4
s_cbranch_vccz LpollR
s_lshl_b32 s44, s2, 12
buffer_load_dwordx4 v[128:131], v245, s[32:35], s44 offen sc1
buffer_load_dwordx4 v[132:135], v245, s[32:35], s44 offen offset:1024 sc1
buffer_load_dwordx4 v[136:139], v245, s[32:35], s44 offen offset:2048 sc1
buffer_load_dwordx4 v[140:143], v245, s[32:35], s44 offen offset:3072 sc1
s_setpc_b64 s[78:79]
LpollR:
v_add_f32 v128, v128, v132
v_add_f32 v140, v136, v140
v_add_f32 v140, v128, v140
v_add_f32 v129, v129, v133
v_add_f32 v141, v137, v141
v_add_f32 v141, v129, v141
v_add_f32 v130, v130, v134
v_add_f32 v142, v138, v142
v_add_f32 v142, v130, v142
v_add_f32 v131, v131, v135
v_add_f32 v143, v139, v143
v_add_f32 v143, v131, v143
v_permlane32_swap_b32 v140, v141
s_nop 0
v_permlane32_swap_b32 v142, v143
v_add_f32 v140, v140, v141
v_add_f32 v142, v142, v143
v_bfe_u32 v241, v245, 4, 4
v_lshlrev_b32 v241, 11, v241
v_permlane16_swap_b32 v140, v142
v_add_f32 v140, v140, v142
v_bfe_u32 v242, v245, 8, 1
v_lshl_add_u32 v241, v242, 3, v241
v_add_f32_dpp v140, v140, v140 row_ror:8 row_mask:0xf bank_mask:0xf
v_bfe_u32 v242, v245, 9, 1
v_lshl_add_u32 v241, v242, 2, v241
v_add_f32_dpp v140, v140, v140 row_ror:4 row_mask:0xf bank_mask:0xf
s_lshl_b32 s44, s2, 4
s_add_u32 s44, s44, 393216
v_add_f32_dpp v140, v140, v140 row_ror:2 row_mask:0xf bank_mask:0xf
s_mov_b32 s43, 1083289508
v_mov_b32 v242, 897988541
v_add_f32_dpp v140, v140, v140 row_ror:1 row_mask:0xf bank_mask:0xf
v_fma_f32 v140, v140, s43, v242
v_sqrt_f32_e64 v140, v140
s_mov_b32 exec_lo, 16711935
s_mov_b32 exec_hi, 16711935
v_min_u32_e64 v140, -2, v140
buffer_store_dword v140, v241, s[32:35], s44 offen sc1
s_mov_b64 exec, -1
s_mov_b32 s77, 2
s_and_b32 s44, s2, 7
s_lshl_b32 s44, s44, 11
s_add_u32 s44, s44, 393216
buffer_load_dwordx2 v[128:129], v240, s[32:35], s44 offen sc1
buffer_load_dwordx2 v[130:131], v240, s[32:35], s44 offen offset:8 sc1
buffer_load_dwordx2 v[132:133], v240, s[32:35], s44 offen offset:16 sc1
v_lshrrev_b32 v241, 1, v240
buffer_load_dword v135, v241, s[24:27], 0 offen
buffer_load_dword v137, v241, s[24:27], 0 offen offset:4
buffer_load_dword v139, v241, s[24:27], 0 offen offset:8
s_setpc_b64 s[78:79]
LpollC:
v_max3_u32 v241, v128, v129, v130
v_max3_u32 v241, v241, v131, v132
v_max_u32 v241, v241, v133
v_cmp_eq_u32 vcc, -1, v241
s_nop 4
s_cbranch_vccz LpollS
s_and_b32 s44, s2, 7
s_lshl_b32 s44, s44, 11
s_add_u32 s44, s44, 393216
buffer_load_dwordx2 v[128:129], v240, s[32:35], s44 offen sc1
buffer_load_dwordx2 v[130:131], v240, s[32:35], s44 offen offset:8 sc1
buffer_load_dwordx2 v[132:133], v240, s[32:35], s44 offen offset:16 sc1
s_setpc_b64 s[78:79]
LpollS:
v_add_f32 v243, v128, v129
v_add_f32 v243, v243, v130
v_add_f32 v243, v243, v131
v_add_f32 v243, v243, v132
v_add_f32 v243, v243, v133
v_lshlrev_b32_e64 v134, 16, v135
v_and_b32 v135, 4294901760, v135
v_add_f32_dpp v243, v243, v243 row_ror:8 row_mask:0xf bank_mask:0xf
v_lshlrev_b32_e64 v136, 16, v137
v_and_b32 v137, 4294901760, v137
v_add_f32_dpp v243, v243, v243 row_ror:4 row_mask:0xf bank_mask:0xf
v_lshlrev_b32_e64 v138, 16, v139
v_and_b32 v139, 4294901760, v139
v_add_f32_dpp v243, v243, v243 row_ror:2 row_mask:0xf bank_mask:0xf
v_mul_f32 v128, v128, v134
v_mul_f32 v129, v129, v135
v_add_f32_dpp v243, v243, v243 row_ror:1 row_mask:0xf bank_mask:0xf
v_mov_b32 v241, v243
v_mul_f32 v130, v130, v136
v_mul_f32 v131, v131, v137
v_permlane16_swap_b32 v243, v241
v_add_f32 v243, v243, v241
v_mov_b32 v241, v243
v_mul_f32 v132, v132, v138
v_mul_f32 v133, v133, v139
v_permlane32_swap_b32 v243, v241
v_add_f32 v243, v243, v241
v_mov_b32 v242, 3036348137
s_mov_b32 s43, 3131020332
v_fma_f32 v243, v243, s43, v242
v_rcp_f32_e64 v243, v243
s_mov_b32 s43, 3221808330
v_fma_f32 v128, v128, v243, s43
v_fma_f32 v129, v129, v243, s43
v_fma_f32 v130, v130, v243, s43
v_fma_f32 v131, v131, v243, s43
v_fma_f32 v132, v132, v243, s43
v_fma_f32 v133, v133, v243, s43
v_cvt_pk_f16_f32 v128, v128, v129
v_cvt_pk_f16_f32 v129, v130, v131
v_cvt_pk_f16_f32 v130, v132, v133
s_mov_b32 s77, 0
s_nop 1
s_setpc_b64 s[78:79]
Lend:
s_endpgm

.section .rodata,"a"
.p2align 6
.amdhsa_kernel standalone__modern_conv_block_convnext_v2__vision_kernel
  .amdhsa_next_free_vgpr 256
  .amdhsa_next_free_sgpr 102
  .amdhsa_accum_offset 256
  .amdhsa_group_segment_fixed_size 0
  .amdhsa_kernarg_size 72
  .amdhsa_user_sgpr_count 2
  .amdhsa_user_sgpr_kernarg_segment_ptr 1
  .amdhsa_system_sgpr_workgroup_id_x 1
.end_amdhsa_kernel
```

```asm
; @launch grid=(256,1,1) block=(512,1,1) lds=163840
.amdgcn_target "amdgcn-amd-amdhsa--gfx950"
.text
.globl standalone__modern_conv_block_convnext_v2__vision_kernel
.p2align 8
.type standalone__modern_conv_block_convnext_v2__vision_kernel,@function
standalone__modern_conv_block_convnext_v2__vision_kernel:
s_cmp_ge_u32 s2, 256
s_cbranch_scc1 Lend
s_load_dwordx16 s[80:95], s[0:1], 0
s_load_dwordx2 s[96:97], s[0:1], 64
v_mov_b32 v119, v0
v_and_b32 v118, 63, v0
v_lshrrev_b32 v120, 6, v0
s_nop 0
v_readfirstlane_b32 s40, v120
s_getpc_b64 s[74:75]
Lpc:
s_lshr_b32 s43, s2, 3
s_and_b32 s43, s43, 15
s_lshl_b32 s43, s43, 13
v_lshrrev_b32_e64 v122, 3, v0
v_lshl_add_u32 v122, v122, 7, s43
v_min_u32 v122, Lend-Lpc, v122
global_load_dword v112, v122, s[74:75]
s_and_b32 s43, s2, 7
s_lshr_b32 s44, s2, 3
s_and_b32 s41, s43, 3
s_lshl_b32 s41, s41, 2
s_and_b32 s45, s44, 3
s_add_u32 s41, s41, s45
s_lshr_b32 s42, s43, 2
s_lshl_b32 s42, s42, 3
s_lshr_b32 s45, s44, 2
s_add_u32 s42, s42, s45
s_lshl_b32 s41, s41, 5
s_lshl_b32 s42, s42, 5
s_and_b32 s43, s40, 3
s_mul_i32 s43, s43, 1536
s_add_u32 s67, s43, 90112
s_mul_i32 s44, s41, 192
s_add_u32 s43, s43, s44
s_sub_u32 s43, s43, 192
v_lshl_add_u32 v121, v118, 4, s43
v_add_u32 v123, 896, v121
v_mov_b32 v122, 2147483648
s_mov_b32 s44, 98304
v_cmp_gt_u32 vcc, s44, v121
s_nop 1
v_cndmask_b32 v236, v122, v121, vcc
v_cmp_gt_u32 vcc, s44, v123
s_nop 1
v_cndmask_b32 v237, v122, v123, vcc
s_mul_i32 s66, s42, 98304
v_min_u32 v128, 215, v119
v_lshlrev_b32_e64 v130, 3, v128
v_lshlrev_b32 v250, 4, v118
s_waitcnt lgkmcnt(0)
s_mov_b32 s4, s80
s_and_b32 s5, s81, 65535
s_mov_b32 s6, 50331648
s_mov_b32 s7, 131072
s_cmp_ge_u32 s40, 4
s_cbranch_scc1 Lrowb
s_mov_b32 s20, s82
s_and_b32 s21, s83, 65535
s_mov_b32 s22, 1728
s_mov_b32 s23, 131072
buffer_load_dwordx2 v[126:127], v130, s[20:23], 0 offen
s_add_u32 m0, s67, 0
s_sub_u32 s45, s66, 98304
s_cmp_eq_u32 s42, 0
s_cselect_b32 s45, 1073741824, s45
buffer_load_dwordx4 v236, s[4:7], s45 offen lds
s_add_u32 m0, s67, 6592
s_nop 0
buffer_load_dwordx4 v236, s[4:7], s66 offen lds
s_add_u32 m0, s67, 13200
s_add_u32 s66, s66, 98304
buffer_load_dwordx4 v236, s[4:7], s66 offen lds
s_add_u32 m0, s67, 19792
s_add_u32 s66, s66, 98304
buffer_load_dwordx4 v236, s[4:7], s66 offen lds
s_add_u32 m0, s67, 26400
s_add_u32 s66, s66, 98304
buffer_load_dwordx4 v236, s[4:7], s66 offen lds
s_add_u32 m0, s67, 32992
s_add_u32 s66, s66, 98304
buffer_load_dwordx4 v236, s[4:7], s66 offen lds
s_add_u32 m0, s67, 39600
s_add_u32 s66, s66, 98304
buffer_load_dwordx4 v236, s[4:7], s66 offen lds
s_add_u32 m0, s67, 46192
s_add_u32 s66, s66, 98304
buffer_load_dwordx4 v236, s[4:7], s66 offen lds
s_add_u32 m0, s67, 52736
s_add_u32 s66, s66, 98304
buffer_load_dwordx4 v236, s[4:7], s66 offen lds
s_add_u32 m0, s67, 59328
s_add_u32 s66, s66, 98304
buffer_load_dwordx4 v236, s[4:7], s66 offen lds
Lrowb:
s_mov_b32 s12, s84
s_and_b32 s13, s85, 65535
s_mov_b32 s14, 73728
s_mov_b32 s15, 131072
s_mov_b32 s16, s86
s_and_b32 s17, s87, 65535
s_mov_b32 s18, 73728
s_mov_b32 s19, 131072
s_mov_b32 s24, s88
s_and_b32 s25, s89, 65535
s_mov_b32 s26, 768
s_mov_b32 s27, 131072
s_mov_b32 s28, s90
s_and_b32 s29, s91, 65535
s_mov_b32 s30, 768
s_mov_b32 s31, 131072
s_mov_b32 s8, s92
s_and_b32 s9, s93, 65535
s_mov_b32 s10, 50331648
s_mov_b32 s11, 131072
s_mov_b32 s36, s94
s_and_b32 s37, s95, 65535
s_mov_b32 s38, 256
s_mov_b32 s39, 131072
s_mov_b32 s32, s96
s_and_b32 s33, s97, 65535
s_mov_b32 s34, 83886080
s_mov_b32 s35, 131072
v_lshlrev_b32 v250, 4, v118
v_add_u32 v250, 16384, v250
v_lshlrev_b32_e64 v251, 4, v118
v_add_u32 v251, 81920, v251
v_lshlrev_b32_e64 v252, 4, v118
v_add_u32 v252, 147456, v252
s_lshl_b32 s73, s2, 3
s_add_u32 s73, s73, s40
s_lshl_b32 s80, s73, 10
s_add_u32 s80, s80, 4177920
s_mul_i32 s73, s73, 16
s_add_u32 s73, s73, 1048576
s_mov_b32 s48, 1156203754
s_mov_b32 s49, 4294508536
s_mov_b32 s47, 16382
v_and_b32 v131, 15, v118
v_lshrrev_b32 v132, 4, v118
v_and_b32_e64 v133, 3, v131
v_mul_u32_u24 v134, 13200, v133
v_lshrrev_b32_e64 v133, 2, v131
v_lshl_add_u32 v133, v133, 1, v132
v_mul_u32_u24 v133, 192, v133
s_sub_u32 s43, s67, 90112
v_add3_u32 v246, v133, v134, s43
v_bfe_u32 v133, v131, 2, 1
v_sub_u32 v133, v132, v133
v_lshrrev_b32 v134, 3, v131
v_and_b32_e64 v135, 3, v131
v_lshl_add_u32 v135, v134, 2, v135
v_lshlrev_b32_e64 v136, 6, v133
v_lshl_add_u32 v136, v135, 3, v136
v_add_u32 v136, 156040, v136
v_mov_b32 v137, 156032
v_cmp_gt_u32 vcc, 3, v133
s_nop 1
v_cndmask_b32 v136, v137, v136, vcc
v_cmp_eq_u32 vcc, 0, v134
s_nop 1
v_cndmask_b32 v238, v137, v136, vcc
v_cndmask_b32 v239, v136, v137, vcc
v_lshrrev_b32 v133, 2, v131
v_bfe_u32 v135, v131, 1, 1
v_cmp_eq_u32 vcc, v133, v132
s_nop 1
v_cndmask_b32 v135, 8, v135, vcc
v_cmp_eq_u32 s[88:89], 0, v135
v_cmp_eq_u32 s[90:91], 1, v135
v_lshlrev_b32 v254, 5, v132
v_add_u32 v254, 7936, v254
v_lshlrev_b32 v253, 4, v132
v_and_b32 v131, 31, v118
v_lshrrev_b32_e64 v132, 5, v118
v_bfe_u32 v133, v131, 2, 1
v_bfe_u32 v134, v131, 3, 1
v_bfe_u32 v135, v131, 1, 1
v_lshrrev_b32 v136, 4, v131
v_lshl_add_u32 v135, v136, 1, v135
v_lshl_add_u32 v135, v134, 2, v135
v_cmp_eq_u32 vcc, v133, v132
s_nop 1
v_cndmask_b32 v135, 8, v135, vcc
v_cmp_eq_u32 s[50:51], 0, v135
v_cmp_eq_u32 s[52:53], 1, v135
v_cmp_eq_u32 s[54:55], 2, v135
v_cmp_eq_u32 s[56:57], 3, v135
v_cmp_eq_u32 s[58:59], 4, v135
v_cmp_eq_u32 s[60:61], 5, v135
v_cmp_eq_u32 s[62:63], 6, v135
v_cmp_eq_u32 s[64:65], 7, v135
v_and_b32 v136, 1, v131
v_lshlrev_b32 v136, 4, v136
v_mov_b32 v255, 16256
v_lshlrev_b32 v255, v136, v255
v_and_b32 v137, 19, v131
v_lshl_add_u32 v137, v133, 3, v137
v_lshl_add_u32 v137, v134, 2, v137
v_lshlrev_b32_e64 v137, 2, v137
v_lshl_add_u32 v137, v132, 7, v137
s_mul_i32 s82, s40, 9216
s_add_u32 s72, s82, 90112
v_add_u32 v248, s72, v137
v_and_b32 v133, 3, v118
v_mul_u32_u24 v134, 196608, v133
v_bfe_u32 v133, v118, 2, 2
v_mul_u32_u24 v133, 384, v133
v_add3_u32 v253, v253, v133, v134
s_mul_i32 s46, s41, 192
s_add_u32 s46, s46, s67
s_sub_u32 s46, s46, 90112
s_and_b32 s83, s40, 4
s_lshl_b32 s44, s83, 1
s_add_u32 s44, s44, s42
s_add_u32 s43, s44, 0
s_mul_i32 s43, s43, 98304
s_add_u32 s68, s43, s46
s_add_u32 s43, s44, 1
s_mul_i32 s43, s43, 98304
s_add_u32 s69, s43, s46
s_add_u32 s43, s44, 16
s_mul_i32 s43, s43, 98304
s_add_u32 s70, s43, s46
s_add_u32 s43, s44, 17
s_mul_i32 s43, s43, 98304
s_add_u32 s71, s43, s46
s_mov_b32 s92, 2863311530
s_mov_b32 s94, 3435973836
s_mov_b32 s93, 2863311530
s_mov_b32 s95, 3435973836
s_mov_b32 s81, 59328
s_mov_b32 s76, 200000
v_mov_b32 v247, 8128
v_mov_b32 v224, 0
v_mov_b32 v225, 0
v_mov_b32 v226, 0
v_mov_b32 v227, 0
v_mov_b32 v228, 0
v_mov_b32 v229, 0
v_mov_b32 v230, 0
v_mov_b32 v231, 0
v_mov_b32 v232, 0
v_mov_b32 v233, 0
v_mov_b32 v234, 0
v_mov_b32 v235, 0
s_cmp_ge_u32 s40, 4
s_cbranch_scc1 Lwa
v_mov_b32 v65, 0
v_mov_b32 v67, 0
v_mov_b32 v68, 0
v_mov_b32 v70, 0
v_mov_b32 v72, 0
v_mov_b32 v73, 0
v_min_u32_e64 v140, 35, v119
v_mul_u32_u24 v140, 200, v140
v_add_u32 v140, 156032, v140
v_and_b32 v141, 31, v119
v_lshlrev_b32 v141, 3, v141
v_bfe_u32 v142, v119, 5, 1
v_lshl_add_u32 v141, v142, 13, v141
v_add_u32 v141, 7936, v141
v_cmp_gt_u32 vcc, 64, v119
s_nop 1
v_cndmask_b32 v140, v141, v140, vcc
ds_write_b64 v140, v[72:73]
v_lshrrev_b32 v140, 1, v128
v_mul_u32_u24 v141, 57, v140
v_lshrrev_b32 v141, 11, v141
v_mul_u32_u24 v142, 171, v140
v_lshrrev_b32_e64 v142, 11, v142
v_mul_u32_u24 v140, 200, v140
v_mul_u32_u24 v142, 2336, v142
v_mul_u32_u24 v141, 2208, v141
v_sub_u32 v140, v140, v142
v_add_u32 v140, v140, v141
v_and_b32_e64 v141, 1, v128
v_lshl_add_u32 v140, v141, 5, v140
v_add_u32 v140, 156040, v140
v_and_b32 v120, 255, v119
v_lshlrev_b32 v121, 8, v120
v_add_u32 v0, 4, v121
v_cvt_f32_f16 v0, v0
v_add_u32 v1, 12, v121
v_cvt_f32_f16 v1, v1
v_add_u32 v2, 20, v121
v_cvt_f32_f16 v2, v2
v_add_u32 v3, 28, v121
v_cvt_f32_f16 v3, v3
v_add_u32 v4, 36, v121
v_cvt_f32_f16 v4, v4
v_add_u32 v5, 44, v121
v_cvt_f32_f16 v5, v5
v_add_u32 v6, 52, v121
v_cvt_f32_f16 v6, v6
v_add_u32 v7, 60, v121
v_cvt_f32_f16_e64 v7, v7
v_add_u32 v8, 68, v121
v_cvt_f32_f16_e64 v8, v8
v_add_u32 v9, 76, v121
v_cvt_f32_f16_e64 v9, v9
v_add_u32 v10, 84, v121
v_cvt_f32_f16_e64 v10, v10
v_add_u32 v11, 92, v121
v_cvt_f32_f16_e64 v11, v11
v_add_u32 v12, 100, v121
v_cvt_f32_f16_e64 v12, v12
v_add_u32 v13, 108, v121
v_cvt_f32_f16_e64 v13, v13
v_add_u32 v14, 116, v121
v_cvt_f32_f16_e64 v14, v14
v_add_u32 v15, 124, v121
v_cvt_f32_f16_e64 v15, v15
v_add_u32 v16, 132, v121
v_cvt_f32_f16_e64 v16, v16
v_add_u32 v17, 140, v121
v_cvt_f32_f16_e64 v17, v17
v_add_u32 v18, 148, v121
v_cvt_f32_f16_e64 v18, v18
v_add_u32 v19, 156, v121
v_cvt_f32_f16_e64 v19, v19
v_add_u32 v20, 164, v121
v_cvt_f32_f16_e64 v20, v20
v_add_u32 v21, 172, v121
v_cvt_f32_f16_e64 v21, v21
v_add_u32 v22, 180, v121
v_cvt_f32_f16_e64 v22, v22
v_add_u32 v23, 188, v121
v_cvt_f32_f16_e64 v23, v23
v_add_u32 v24, 196, v121
v_cvt_f32_f16_e64 v24, v24
v_add_u32 v25, 204, v121
v_cvt_f32_f16_e64 v25, v25
v_add_u32 v26, 212, v121
v_cvt_f32_f16_e64 v26, v26
v_add_u32 v27, 220, v121
v_cvt_f32_f16_e64 v27, v27
v_add_u32 v28, 228, v121
v_cvt_f32_f16_e64 v28, v28
v_add_u32 v29, 236, v121
v_cvt_f32_f16_e64 v29, v29
v_add_u32 v30, 244, v121
v_cvt_f32_f16_e64 v30, v30
v_add_u32 v31, 252, v121
v_cvt_f32_f16_e64 v31, v31
v_fmaak_f32 v32, v0, v0, 0x409d30fc
v_mul_f32_e64 v32, v0, v32
v_fmaak_f32 v33, v1, v1, 0x409d30fc
v_mul_f32_e64 v33, v1, v33
v_fmaak_f32 v34, v2, v2, 0x409d30fc
v_mul_f32_e64 v34, v2, v34
v_fmaak_f32 v35, v3, v3, 0x409d30fc
v_mul_f32_e64 v35, v3, v35
v_fmaak_f32 v36, v4, v4, 0x409d30fc
v_mul_f32_e64 v36, v4, v36
v_fmaak_f32 v37, v5, v5, 0x409d30fc
v_mul_f32_e64 v37, v5, v37
v_fmaak_f32 v38, v6, v6, 0x409d30fc
v_mul_f32_e64 v38, v6, v38
v_fmaak_f32 v39, v7, v7, 0x409d30fc
v_mul_f32_e64 v39, v7, v39
v_fmaak_f32 v40, v8, v8, 0x409d30fc
v_mul_f32_e64 v40, v8, v40
v_fmaak_f32 v41, v9, v9, 0x409d30fc
v_mul_f32_e64 v41, v9, v41
v_fmaak_f32 v42, v10, v10, 0x409d30fc
v_mul_f32_e64 v42, v10, v42
v_fmaak_f32 v43, v11, v11, 0x409d30fc
v_mul_f32_e64 v43, v11, v43
v_fmaak_f32 v44, v12, v12, 0x409d30fc
v_mul_f32_e64 v44, v12, v44
v_fmaak_f32 v45, v13, v13, 0x409d30fc
v_mul_f32_e64 v45, v13, v45
v_fmaak_f32 v46, v14, v14, 0x409d30fc
v_mul_f32_e64 v46, v14, v46
v_fmaak_f32 v47, v15, v15, 0x409d30fc
v_mul_f32_e64 v47, v15, v47
v_fmaak_f32 v48, v16, v16, 0x409d30fc
v_mul_f32_e64 v48, v16, v48
v_fmaak_f32 v49, v17, v17, 0x409d30fc
v_mul_f32_e64 v49, v17, v49
v_fmaak_f32 v50, v18, v18, 0x409d30fc
v_mul_f32_e64 v50, v18, v50
v_fmaak_f32 v51, v19, v19, 0x409d30fc
v_mul_f32_e64 v51, v19, v51
v_fmaak_f32 v52, v20, v20, 0x409d30fc
v_mul_f32_e64 v52, v20, v52
v_fmaak_f32 v53, v21, v21, 0x409d30fc
v_mul_f32_e64 v53, v21, v53
v_fmaak_f32 v54, v22, v22, 0x409d30fc
v_mul_f32_e64 v54, v22, v54
v_fmaak_f32 v55, v23, v23, 0x409d30fc
v_mul_f32_e64 v55, v23, v55
v_fmaak_f32 v56, v24, v24, 0x409d30fc
v_mul_f32_e64 v56, v24, v56
v_fmaak_f32 v57, v25, v25, 0x409d30fc
v_mul_f32_e64 v57, v25, v57
v_fmaak_f32 v58, v26, v26, 0x409d30fc
v_mul_f32_e64 v58, v26, v58
v_fmaak_f32 v59, v27, v27, 0x409d30fc
v_mul_f32_e64 v59, v27, v59
v_fmaak_f32 v60, v28, v28, 0x409d30fc
v_mul_f32_e64 v60, v28, v60
v_fmaak_f32 v61, v29, v29, 0x409d30fc
v_mul_f32_e64 v61, v29, v61
v_fmaak_f32 v62, v30, v30, 0x409d30fc
v_mul_f32_e64 v62, v30, v62
v_fmaak_f32 v63, v31, v31, 0x409d30fc
v_mul_f32 v63, v31, v63
v_exp_f32 v32, v32
v_exp_f32 v33, v33
v_exp_f32 v34, v34
v_exp_f32 v35, v35
v_exp_f32 v36, v36
v_exp_f32 v37, v37
v_exp_f32 v38, v38
v_exp_f32 v39, v39
v_exp_f32 v40, v40
v_exp_f32 v41, v41
v_exp_f32 v42, v42
v_exp_f32 v43, v43
v_exp_f32 v44, v44
v_exp_f32 v45, v45
v_exp_f32 v46, v46
v_exp_f32 v47, v47
v_exp_f32 v48, v48
v_exp_f32 v49, v49
v_exp_f32 v50, v50
v_exp_f32 v51, v51
v_exp_f32 v52, v52
v_exp_f32 v53, v53
v_exp_f32 v54, v54
v_exp_f32 v55, v55
v_exp_f32 v56, v56
v_exp_f32 v57, v57
v_exp_f32 v58, v58
v_exp_f32 v59, v59
v_exp_f32 v60, v60
v_exp_f32 v61, v61
v_exp_f32 v62, v62
v_exp_f32 v63, v63
v_add_f32 v32, 1.0, v32
v_add_f32 v33, 1.0, v33
v_add_f32 v34, 1.0, v34
v_add_f32 v35, 1.0, v35
v_add_f32 v36, 1.0, v36
v_add_f32 v37, 1.0, v37
v_add_f32 v38, 1.0, v38
v_add_f32 v39, 1.0, v39
v_add_f32 v40, 1.0, v40
v_add_f32 v41, 1.0, v41
v_add_f32 v42, 1.0, v42
v_add_f32 v43, 1.0, v43
v_add_f32 v44, 1.0, v44
v_add_f32 v45, 1.0, v45
v_add_f32 v46, 1.0, v46
v_add_f32 v47, 1.0, v47
v_add_f32 v48, 1.0, v48
v_add_f32 v49, 1.0, v49
v_add_f32 v50, 1.0, v50
v_add_f32 v51, 1.0, v51
v_add_f32 v52, 1.0, v52
v_add_f32 v53, 1.0, v53
v_add_f32 v54, 1.0, v54
v_add_f32 v55, 1.0, v55
v_add_f32 v56, 1.0, v56
v_add_f32 v57, 1.0, v57
v_add_f32 v58, 1.0, v58
v_add_f32 v59, 1.0, v59
v_add_f32 v60, 1.0, v60
v_add_f32 v61, 1.0, v61
v_add_f32 v62, 1.0, v62
v_add_f32 v63, 1.0, v63
v_rcp_f32 v32, v32
v_rcp_f32 v33, v33
v_rcp_f32 v34, v34
v_rcp_f32 v35, v35
v_rcp_f32 v36, v36
v_rcp_f32 v37, v37
v_rcp_f32 v38, v38
v_rcp_f32 v39, v39
v_rcp_f32 v40, v40
v_rcp_f32 v41, v41
v_rcp_f32 v42, v42
v_rcp_f32 v43, v43
v_rcp_f32 v44, v44
v_rcp_f32 v45, v45
v_rcp_f32 v46, v46
v_rcp_f32 v47, v47
v_rcp_f32 v48, v48
v_rcp_f32 v49, v49
v_rcp_f32 v50, v50
v_rcp_f32 v51, v51
v_rcp_f32 v52, v52
v_rcp_f32 v53, v53
v_rcp_f32 v54, v54
v_rcp_f32 v55, v55
v_rcp_f32 v56, v56
v_rcp_f32 v57, v57
v_rcp_f32 v58, v58
v_rcp_f32 v59, v59
v_rcp_f32 v60, v60
v_rcp_f32 v61, v61
v_rcp_f32 v62, v62
v_rcp_f32 v63, v63
v_mul_f32 v0, v0, v32
v_mul_f32 v1, v1, v33
v_mul_f32 v2, v2, v34
v_mul_f32 v3, v3, v35
v_mul_f32 v4, v4, v36
v_mul_f32 v5, v5, v37
v_mul_f32 v6, v6, v38
v_mul_f32 v7, v7, v39
v_mul_f32 v8, v8, v40
v_mul_f32 v9, v9, v41
v_mul_f32 v10, v10, v42
v_mul_f32 v11, v11, v43
v_mul_f32 v12, v12, v44
v_mul_f32 v13, v13, v45
v_mul_f32 v14, v14, v46
v_mul_f32 v15, v15, v47
v_mul_f32 v16, v16, v48
v_mul_f32 v17, v17, v49
v_mul_f32 v18, v18, v50
v_mul_f32 v19, v19, v51
v_mul_f32 v20, v20, v52
v_mul_f32 v21, v21, v53
v_mul_f32 v22, v22, v54
v_mul_f32 v23, v23, v55
v_mul_f32 v24, v24, v56
v_mul_f32 v25, v25, v57
v_mul_f32 v26, v26, v58
v_mul_f32 v27, v27, v59
v_mul_f32 v28, v28, v60
v_mul_f32 v29, v29, v61
v_mul_f32 v30, v30, v62
v_mul_f32_e64 v31, v31, v63
v_cvt_pk_f16_f32 v32, v0, v1
v_cvt_pk_f16_f32 v33, v2, v3
v_cvt_pk_f16_f32 v34, v4, v5
v_cvt_pk_f16_f32 v35, v6, v7
v_cvt_pk_f16_f32 v36, v8, v9
v_cvt_pk_f16_f32 v37, v10, v11
v_cvt_pk_f16_f32 v38, v12, v13
v_cvt_pk_f16_f32 v39, v14, v15
v_cvt_pk_f16_f32 v40, v16, v17
v_cvt_pk_f16_f32 v41, v18, v19
v_cvt_pk_f16_f32 v42, v20, v21
v_cvt_pk_f16_f32 v43, v22, v23
v_cvt_pk_f16_f32 v44, v24, v25
v_cvt_pk_f16_f32 v45, v26, v27
v_cvt_pk_f16_f32 v46, v28, v29
v_cvt_pk_f16_f32 v47, v30, v31
v_add_u32 v32, 131074, v32
v_and_b32 v32, 4294770684, v32
v_add_u32 v33, 131074, v33
v_and_b32 v33, 4294770684, v33
v_add_u32 v34, 131074, v34
v_and_b32 v34, 4294770684, v34
v_add_u32 v35, 131074, v35
v_and_b32 v35, 4294770684, v35
v_add_u32 v36, 131074, v36
v_and_b32 v36, 4294770684, v36
v_add_u32 v37, 131074, v37
v_and_b32 v37, 4294770684, v37
v_add_u32 v38, 131074, v38
v_and_b32 v38, 4294770684, v38
v_add_u32 v39, 131074, v39
v_and_b32 v39, 4294770684, v39
v_add_u32 v40, 131074, v40
v_and_b32 v40, 4294770684, v40
v_add_u32 v41, 131074, v41
v_and_b32 v41, 4294770684, v41
v_add_u32 v42, 131074, v42
v_and_b32 v42, 4294770684, v42
v_add_u32 v43, 131074, v43
v_and_b32 v43, 4294770684, v43
v_add_u32 v44, 131074, v44
v_and_b32 v44, 4294770684, v44
v_add_u32 v45, 131074, v45
v_and_b32 v45, 4294770684, v45
v_add_u32 v46, 131074, v46
v_and_b32 v46, 4294770684, v46
v_add_u32 v47, 131074, v47
v_and_b32 v47, 4294770684, v47
v_lshlrev_b32_e64 v121, 6, v120
v_bfe_u32 v120, v120, 2, 5
v_cmp_ne_u32 vcc, 31, v120
s_and_saveexec_b64 s[74:75], vcc
ds_write_b128 v121, v[32:35]
ds_write_b128 v121, v[36:39] offset:16
ds_write_b128 v121, v[40:43] offset:32
ds_write_b128 v121, v[44:47] offset:48
s_mov_b64 exec, s[74:75]
s_waitcnt vmcnt(10)
v_and_b32 v64, 65535, v126
v_and_b32 v66, 4294901760, v126
v_and_b32 v69, 65535, v127
v_and_b32 v71, 4294901760, v127
v_and_b32_e64 v141, 1, v128
v_cmp_gt_u32 vcc, 72, v128
v_mov_b32_e64 v142, 2
s_nop 0
v_cndmask_b32 v141, v141, v142, vcc
v_and_b32 v143, 65535, v126
v_cmp_eq_u32 vcc, 0, v141
s_nop 1
v_cndmask_b32 v64, v64, v143, vcc
v_cmp_ne_u32 vcc, 1, v141
s_nop 1
v_cndmask_b32 v64, 0, v64, vcc
v_cmp_eq_u32 vcc, 1, v141
s_nop 1
v_cndmask_b32 v65, v65, v143, vcc
v_cmp_ne_u32 vcc, 0, v141
s_nop 1
v_cndmask_b32 v65, 0, v65, vcc
v_lshrrev_b32_e64 v143, 16, v126
v_cmp_eq_u32 vcc, 0, v141
s_nop 1
v_cndmask_b32 v66, v66, v143, vcc
v_cmp_ne_u32 vcc, 1, v141
s_nop 1
v_cndmask_b32 v66, 0, v66, vcc
v_cmp_eq_u32 vcc, 1, v141
s_nop 1
v_cndmask_b32 v67, v67, v143, vcc
v_cmp_ne_u32 vcc, 0, v141
s_nop 1
v_cndmask_b32 v67, 0, v67, vcc
v_and_b32 v143, 65535, v127
v_cmp_eq_u32 vcc, 0, v141
s_nop 1
v_cndmask_b32 v68, v68, v143, vcc
v_cmp_ne_u32 vcc, 1, v141
s_nop 1
v_cndmask_b32 v68, 0, v68, vcc
v_cmp_eq_u32 vcc, 1, v141
s_nop 1
v_cndmask_b32 v69, v69, v143, vcc
v_cmp_ne_u32 vcc, 0, v141
s_nop 1
v_cndmask_b32 v69, 0, v69, vcc
v_lshrrev_b32_e64 v143, 16, v127
v_cmp_eq_u32 vcc, 0, v141
s_nop 1
v_cndmask_b32 v70, v70, v143, vcc
v_cmp_ne_u32 vcc, 1, v141
s_nop 1
v_cndmask_b32 v70, 0, v70, vcc
v_cmp_eq_u32 vcc, 1, v141
s_nop 1
v_cndmask_b32 v71, v71, v143, vcc
v_cmp_ne_u32 vcc, 0, v141
s_nop 1
v_cndmask_b32 v71, 0, v71, vcc
ds_write_b64 v140, v[64:65]
ds_write_b64 v140, v[66:67] offset:8
ds_write_b64 v140, v[68:69] offset:16
ds_write_b64 v140, v[70:71] offset:24
s_add_u32 s43, s81, 6592
v_add_u32_e64 v212, s43, v246
v_subrev_u32 v222, 65920, v212
v_min_u32_e64 v212, v212, v222
v_add_u32 v212, 90112, v212
v_add_u32_e64 v213, s43, v246
v_add_u32 v213, 6592, v213
v_subrev_u32 v222, 65920, v213
v_min_u32_e64 v213, v213, v222
v_add_u32 v213, 90112, v213
v_add_u32_e64 v214, s43, v246
v_add_u32 v214, 13184, v214
v_add_u32_e64 v222, 16, v214
v_bfi_b32 v214, 48, v222, v214
v_subrev_u32 v222, 65920, v214
v_min_u32_e64 v214, v214, v222
v_add_u32 v214, 90112, v214
v_add_u32_e64 v215, s43, v246
v_add_u32 v215, 19776, v215
v_add_u32_e64 v222, 16, v215
v_bfi_b32 v215, 48, v222, v215
v_subrev_u32 v222, 65920, v215
v_min_u32 v215, v215, v222
v_add_u32 v215, 90112, v215
v_max_u32 v240, v238, v239
v_bfe_u32 v241, v250, 4, 2
v_bfe_u32 v222, v250, 7, 1
v_lshl_add_u32 v243, v222, 2, v241
v_bfe_u32 v222, v250, 9, 1
v_mul_u32_u24 v222, 300, v222
v_add_u32_e64 v243, v243, v222
v_bfe_u32 v222, v250, 8, 1
v_bfe_u32 v223, v250, 6, 1
v_lshlrev_b32 v222, 1, v222
v_sub_u32 v223, v222, v223
v_lshl_add_u32 v243, v223, 3, v243
v_lshlrev_b32_e64 v243, 3, v243
v_add_u32 v243, 156040, v243
v_bfe_u32 v222, v250, 9, 1
v_mul_u32_u24 v222, 2400, v222
v_add_u32 v222, 156032, v222
v_cmp_ne_u32 vcc, -1, v223
s_nop 1
v_cndmask_b32 v240, v222, v243, vcc
v_add_u32_e64 v243, 64, v243
v_cmp_ne_u32 vcc, 2, v223
s_nop 1
v_cndmask_b32 v242, v222, v243, vcc
v_mul_u32_u24 v241, 21845, v241
v_xor_b32 v241, 17476, v241
s_waitcnt vmcnt(0) lgkmcnt(0)
s_barrier
s_branch Lwb
Lwa:
s_add_u32 m0, s67, 896
s_sub_u32 s45, s66, 98304
s_cmp_eq_u32 s42, 0
s_cselect_b32 s45, 1073741824, s45
buffer_load_dwordx4 v237, s[4:7], s45 offen lds
s_add_u32 m0, s67, 7488
s_nop 0
buffer_load_dwordx4 v237, s[4:7], s66 offen lds
s_add_u32 m0, s67, 14096
s_add_u32 s66, s66, 98304
buffer_load_dwordx4 v237, s[4:7], s66 offen lds
s_add_u32 m0, s67, 20688
s_add_u32 s66, s66, 98304
buffer_load_dwordx4 v237, s[4:7], s66 offen lds
s_add_u32 m0, s67, 27296
s_add_u32 s66, s66, 98304
buffer_load_dwordx4 v237, s[4:7], s66 offen lds
s_add_u32 m0, s67, 33888
s_add_u32 s66, s66, 98304
buffer_load_dwordx4 v237, s[4:7], s66 offen lds
s_add_u32 m0, s67, 40496
s_add_u32 s66, s66, 98304
buffer_load_dwordx4 v237, s[4:7], s66 offen lds
s_add_u32 m0, s67, 47088
s_add_u32 s66, s66, 98304
buffer_load_dwordx4 v237, s[4:7], s66 offen lds
s_add_u32 m0, s67, 53632
s_add_u32 s66, s66, 98304
buffer_load_dwordx4 v237, s[4:7], s66 offen lds
s_add_u32 m0, s67, 60224
s_add_u32 s66, s66, 98304
buffer_load_dwordx4 v237, s[4:7], s66 offen lds
v_lshrrev_b32_e64 v115, 2, v118
v_mul_u32_u24 v115, 768, v115
v_and_b32_e64 v125, 3, v118
v_lshl_add_u32 v115, v125, 4, v115
s_and_b32 s43, s40, 3
s_add_u32 s43, s43, 0
s_mul_i32 s44, s43, 43
s_lshr_b32 s44, s44, 8
s_lshl_b32 s46, s43, 10
s_add_u32 m0, s46, 16384
s_mul_i32 s46, s44, 6
s_sub_u32 s43, s43, s46
s_mul_i32 s43, s43, 12288
s_lshl_b32 s44, s44, 6
s_add_u32 s43, s43, s44
buffer_load_dwordx4 v115, s[12:15], s43 offen lds
s_and_b32 s43, s40, 3
s_add_u32 s43, s43, 4
s_mul_i32 s44, s43, 43
s_lshr_b32 s44, s44, 8
s_lshl_b32 s46, s43, 10
s_add_u32 m0, s46, 16384
s_mul_i32 s46, s44, 6
s_sub_u32 s43, s43, s46
s_mul_i32 s43, s43, 12288
s_lshl_b32 s44, s44, 6
s_add_u32 s43, s43, s44
buffer_load_dwordx4 v115, s[12:15], s43 offen lds
s_and_b32 s43, s40, 3
s_add_u32 s43, s43, 8
s_mul_i32 s44, s43, 43
s_lshr_b32 s44, s44, 8
s_lshl_b32 s46, s43, 10
s_add_u32 m0, s46, 16384
s_mul_i32 s46, s44, 6
s_sub_u32 s43, s43, s46
s_mul_i32 s43, s43, 12288
s_lshl_b32 s44, s44, 6
s_add_u32 s43, s43, s44
buffer_load_dwordx4 v115, s[12:15], s43 offen lds
s_and_b32 s43, s40, 3
s_add_u32 s43, s43, 12
s_mul_i32 s44, s43, 43
s_lshr_b32 s44, s44, 8
s_lshl_b32 s46, s43, 10
s_add_u32 m0, s46, 16384
s_mul_i32 s46, s44, 6
s_sub_u32 s43, s43, s46
s_mul_i32 s43, s43, 12288
s_lshl_b32 s44, s44, 6
s_add_u32 s43, s43, s44
buffer_load_dwordx4 v115, s[12:15], s43 offen lds
s_and_b32 s43, s40, 3
s_add_u32 s43, s43, 16
s_mul_i32 s44, s43, 43
s_lshr_b32 s44, s44, 8
s_lshl_b32 s46, s43, 10
s_add_u32 m0, s46, 16384
s_mul_i32 s46, s44, 6
s_sub_u32 s43, s43, s46
s_mul_i32 s43, s43, 12288
s_lshl_b32 s44, s44, 6
s_add_u32 s43, s43, s44
buffer_load_dwordx4 v115, s[12:15], s43 offen lds
s_and_b32 s43, s40, 3
s_add_u32 s43, s43, 20
s_mul_i32 s44, s43, 43
s_lshr_b32 s44, s44, 8
s_lshl_b32 s46, s43, 10
s_add_u32 m0, s46, 16384
s_mul_i32 s46, s44, 6
s_sub_u32 s43, s43, s46
s_mul_i32 s43, s43, 12288
s_lshl_b32 s44, s44, 6
s_add_u32 s43, s43, s44
buffer_load_dwordx4 v115, s[12:15], s43 offen lds
v_bfe_u32 v141, v250, 4, 6
v_and_b32 v140, 15, v141
v_lshlrev_b32 v140, 7, v140
v_lshrrev_b32 v141, 4, v141
v_mul_u32_u24 v141, 98304, v141
s_sub_u32 s43, s67, -8000
s_mul_i32 s44, s41, 192
s_add_u32 s43, s43, s44
v_add3_u32 v140, v140, v141, s43
s_mov_b32 m0, 163840
s_add_u32 s44, s66, 393216
buffer_load_dword v140, s[4:7], s66 offen lds
buffer_load_dword v140, s[4:7], s44 offen lds
v_lshrrev_b32 v148, 5, v118
v_lshlrev_b32 v116, 8, v148
v_bfe_u32 v148, v118, 2, 2
v_lshl_add_u32 v116, v148, 6, v116
v_bfe_u32 v148, v118, 4, 1
v_lshl_add_u32 v116, v148, 5, v116
v_and_b32_e64 v148, 1, v118
v_lshl_add_u32 v116, v148, 4, v116
v_bfe_u32 v148, v118, 1, 1
v_lshl_add_u32 v116, v148, 3, v116
s_and_b32 s43, s40, 3
s_lshl_b32 s43, s43, 10
s_add_u32 s43, s43, 16384
v_lshl_add_u32 v117, v118, 4, s43
v_add_u32 v116, s43, v116
v_mov_b32 v247, 8128
s_waitcnt vmcnt(8)
s_barrier
s_setprio 0
s_and_b32 s43, s40, 3
s_add_u32 s43, s43, 24
s_mul_i32 s44, s43, 43
s_lshr_b32 s44, s44, 8
s_lshl_b32 s46, s43, 10
s_add_u32 m0, s46, 16384
s_mul_i32 s46, s44, 6
s_sub_u32 s43, s43, s46
s_mul_i32 s43, s43, 12288
s_lshl_b32 s44, s44, 6
s_add_u32 s43, s43, s44
buffer_load_dwordx4 v115, s[12:15], s43 offen lds
s_and_b32 s43, s40, 3
s_add_u32 s43, s43, 28
s_mul_i32 s44, s43, 43
s_lshr_b32 s44, s44, 8
s_lshl_b32 s46, s43, 10
s_add_u32 m0, s46, 16384
s_mul_i32 s46, s44, 6
s_sub_u32 s43, s43, s46
s_mul_i32 s43, s43, 12288
s_lshl_b32 s44, s44, 6
s_add_u32 s43, s43, s44
buffer_load_dwordx4 v115, s[12:15], s43 offen lds
s_and_b32 s43, s40, 3
s_add_u32 s43, s43, 32
s_mul_i32 s44, s43, 43
s_lshr_b32 s44, s44, 8
s_lshl_b32 s46, s43, 10
s_add_u32 m0, s46, 16384
s_mul_i32 s46, s44, 6
s_sub_u32 s43, s43, s46
s_mul_i32 s43, s43, 12288
s_lshl_b32 s44, s44, 6
s_add_u32 s43, s43, s44
buffer_load_dwordx4 v115, s[12:15], s43 offen lds
s_and_b32 s43, s40, 3
s_add_u32 s43, s43, 36
s_mul_i32 s44, s43, 43
s_lshr_b32 s44, s44, 8
s_lshl_b32 s46, s43, 10
s_add_u32 m0, s46, 16384
s_mul_i32 s46, s44, 6
s_sub_u32 s43, s43, s46
s_mul_i32 s43, s43, 12288
s_lshl_b32 s44, s44, 6
s_add_u32 s43, s43, s44
buffer_load_dwordx4 v115, s[12:15], s43 offen lds
s_and_b32 s43, s40, 3
s_add_u32 s43, s43, 40
s_mul_i32 s44, s43, 43
s_lshr_b32 s44, s44, 8
s_lshl_b32 s46, s43, 10
s_add_u32 m0, s46, 16384
s_mul_i32 s46, s44, 6
s_sub_u32 s43, s43, s46
s_mul_i32 s43, s43, 12288
s_lshl_b32 s44, s44, 6
s_add_u32 s43, s43, s44
buffer_load_dwordx4 v115, s[12:15], s43 offen lds
s_and_b32 s43, s40, 3
s_add_u32 s43, s43, 44
s_mul_i32 s44, s43, 43
s_lshr_b32 s44, s44, 8
s_lshl_b32 s46, s43, 10
s_add_u32 m0, s46, 16384
s_mul_i32 s46, s44, 6
s_sub_u32 s43, s43, s46
s_mul_i32 s43, s43, 12288
s_lshl_b32 s44, s44, 6
s_add_u32 s43, s43, s44
buffer_load_dwordx4 v115, s[12:15], s43 offen lds
s_and_b32 s43, s40, 3
s_add_u32 s43, s43, 48
s_mul_i32 s44, s43, 43
s_lshr_b32 s44, s44, 8
s_lshl_b32 s46, s43, 10
s_add_u32 m0, s46, 16384
s_mul_i32 s46, s44, 6
s_sub_u32 s43, s43, s46
s_mul_i32 s43, s43, 12288
s_lshl_b32 s44, s44, 6
s_add_u32 s43, s43, s44
buffer_load_dwordx4 v115, s[12:15], s43 offen lds
s_and_b32 s43, s40, 3
s_add_u32 s43, s43, 52
s_mul_i32 s44, s43, 43
s_lshr_b32 s44, s44, 8
s_lshl_b32 s46, s43, 10
s_add_u32 m0, s46, 16384
s_mul_i32 s46, s44, 6
s_sub_u32 s43, s43, s46
s_mul_i32 s43, s43, 12288
s_lshl_b32 s44, s44, 6
s_add_u32 s43, s43, s44
buffer_load_dwordx4 v115, s[12:15], s43 offen lds
s_and_b32 s43, s40, 3
s_add_u32 s43, s43, 56
s_mul_i32 s44, s43, 43
s_lshr_b32 s44, s44, 8
s_lshl_b32 s46, s43, 10
s_add_u32 m0, s46, 16384
s_mul_i32 s46, s44, 6
s_sub_u32 s43, s43, s46
s_mul_i32 s43, s43, 12288
s_lshl_b32 s44, s44, 6
s_add_u32 s43, s43, s44
buffer_load_dwordx4 v115, s[12:15], s43 offen lds
s_and_b32 s43, s40, 3
s_add_u32 s43, s43, 60
s_mul_i32 s44, s43, 43
s_lshr_b32 s44, s44, 8
s_lshl_b32 s46, s43, 10
s_add_u32 m0, s46, 16384
s_mul_i32 s46, s44, 6
s_sub_u32 s43, s43, s46
s_mul_i32 s43, s43, 12288
s_lshl_b32 s44, s44, 6
s_add_u32 s43, s43, s44
buffer_load_dwordx4 v115, s[12:15], s43 offen lds
s_and_b32 s43, s40, 3
s_add_u32 s43, s43, 64
s_mul_i32 s44, s43, 43
s_lshr_b32 s44, s44, 8
s_lshl_b32 s46, s43, 10
s_add_u32 m0, s46, 16384
s_mul_i32 s46, s44, 6
s_sub_u32 s43, s43, s46
s_mul_i32 s43, s43, 12288
s_lshl_b32 s44, s44, 6
s_add_u32 s43, s43, s44
buffer_load_dwordx4 v115, s[12:15], s43 offen lds
s_and_b32 s43, s40, 3
s_add_u32 s43, s43, 68
s_mul_i32 s44, s43, 43
s_lshr_b32 s44, s44, 8
s_lshl_b32 s46, s43, 10
s_add_u32 m0, s46, 16384
s_mul_i32 s46, s44, 6
s_sub_u32 s43, s43, s46
s_mul_i32 s43, s43, 12288
s_lshl_b32 s44, s44, 6
s_add_u32 s43, s43, s44
buffer_load_dwordx4 v115, s[12:15], s43 offen lds
s_waitcnt vmcnt(14)
v_add_u32 v113, 65536, v116
v_add_u32 v114, 65536, v117
ds_read_b64_tr_b16 v[0:1], v116
ds_read_b64_tr_b16 v[2:3], v116 offset:512
ds_read_b64_tr_b16 v[4:5], v116 offset:4096
ds_read_b64_tr_b16 v[6:7], v116 offset:4608
ds_read_b64_tr_b16 v[8:9], v116 offset:8192
ds_read_b64_tr_b16 v[10:11], v116 offset:8704
ds_read_b64_tr_b16 v[12:13], v116 offset:12288
ds_read_b64_tr_b16 v[14:15], v116 offset:12800
ds_read_b64_tr_b16 v[16:17], v116 offset:16384
ds_read_b64_tr_b16 v[18:19], v116 offset:16896
ds_read_b64_tr_b16 v[20:21], v116 offset:20480
ds_read_b64_tr_b16 v[22:23], v116 offset:20992
s_waitcnt lgkmcnt(10)
ds_write_b128 v117, v[0:3]
s_waitcnt lgkmcnt(9)
ds_write_b128 v117, v[4:7] offset:4096
s_waitcnt lgkmcnt(8)
ds_write_b128 v117, v[8:11] offset:8192
s_waitcnt lgkmcnt(7)
ds_write_b128 v117, v[12:15] offset:12288
s_waitcnt lgkmcnt(6)
ds_write_b128 v117, v[16:19] offset:16384
s_waitcnt lgkmcnt(5)
ds_write_b128 v117, v[20:23] offset:20480
v_mov_b32_e64 v223, 1
s_waitcnt lgkmcnt(0)
s_mov_b64 exec, 1
ds_add_u32 v247, v223 offset:8
s_mov_b64 exec, -1
Lwb:
s_cmp_lt_u32 s40, 4
s_cbranch_scc1 Lsu1
s_waitcnt vmcnt(0)
v_add_u32 v113, 65536, v116
v_add_u32 v114, 65536, v117
ds_read_b64_tr_b16 v[0:1], v116 offset:24576
ds_read_b64_tr_b16 v[2:3], v116 offset:25088
ds_read_b64_tr_b16 v[4:5], v116 offset:28672
ds_read_b64_tr_b16 v[6:7], v116 offset:29184
ds_read_b64_tr_b16 v[8:9], v116 offset:32768
ds_read_b64_tr_b16 v[10:11], v116 offset:33280
ds_read_b64_tr_b16 v[12:13], v116 offset:36864
ds_read_b64_tr_b16 v[14:15], v116 offset:37376
ds_read_b64_tr_b16 v[16:17], v116 offset:40960
ds_read_b64_tr_b16 v[18:19], v116 offset:41472
ds_read_b64_tr_b16 v[20:21], v116 offset:45056
ds_read_b64_tr_b16 v[22:23], v116 offset:45568
ds_read_b64_tr_b16 v[24:25], v116 offset:49152
ds_read_b64_tr_b16 v[26:27], v116 offset:49664
ds_read_b64_tr_b16 v[28:29], v116 offset:53248
s_waitcnt lgkmcnt(14)
ds_read_b64_tr_b16 v[30:31], v116 offset:53760
s_waitcnt lgkmcnt(14)
ds_read_b64_tr_b16 v[32:33], v116 offset:57344
s_waitcnt lgkmcnt(14)
ds_read_b64_tr_b16 v[34:35], v116 offset:57856
s_waitcnt lgkmcnt(14)
ds_read_b64_tr_b16 v[36:37], v116 offset:61440
s_waitcnt lgkmcnt(14)
ds_read_b64_tr_b16 v[38:39], v116 offset:61952
s_waitcnt lgkmcnt(14)
ds_read_b64_tr_b16 v[40:41], v113
s_waitcnt lgkmcnt(14)
ds_read_b64_tr_b16 v[42:43], v113 offset:512
s_waitcnt lgkmcnt(14)
ds_read_b64_tr_b16 v[44:45], v113 offset:4096
s_waitcnt lgkmcnt(14)
ds_read_b64_tr_b16 v[46:47], v113 offset:4608
s_waitcnt lgkmcnt(14)
ds_write_b128 v117, v[0:3] offset:24576
s_waitcnt lgkmcnt(14)
ds_write_b128 v117, v[4:7] offset:28672
s_waitcnt lgkmcnt(14)
ds_write_b128 v117, v[8:11] offset:32768
s_waitcnt lgkmcnt(14)
ds_write_b128 v117, v[12:15] offset:36864
s_waitcnt lgkmcnt(14)
ds_write_b128 v117, v[16:19] offset:40960
s_waitcnt lgkmcnt(14)
ds_write_b128 v117, v[20:23] offset:45056
s_waitcnt lgkmcnt(14)
ds_write_b128 v117, v[24:27] offset:49152
s_waitcnt lgkmcnt(14)
ds_write_b128 v117, v[28:31] offset:53248
s_waitcnt lgkmcnt(14)
ds_write_b128 v117, v[32:35] offset:57344
s_waitcnt lgkmcnt(14)
s_waitcnt lgkmcnt(13)
ds_write_b128 v117, v[36:39] offset:61440
s_waitcnt lgkmcnt(12)
ds_write_b128 v114, v[40:43]
s_waitcnt lgkmcnt(11)
ds_write_b128 v114, v[44:47] offset:4096
v_mov_b32_e64 v223, 1
s_waitcnt lgkmcnt(0)
s_mov_b64 exec, 1
ds_add_u32 v247, v223 offset:12
s_mov_b64 exec, -1
s_nop 0
v_mov_b32 v223, 0
s_branch Law1
Lax1:
s_sleep 2
Law1:
ds_read_b32 v223, v247 offset:16
s_sub_u32 s76, s76, 1
s_cselect_b32 s44, 4, 0
s_cselect_b32 s76, 0, s76
s_waitcnt lgkmcnt(0)
v_readfirstlane_b32 s43, v223
s_nop 1
s_max_u32 s43, s43, s44
s_cmp_lt_u32 s43, 4
s_cbranch_scc1 Lax1
s_add_u32 s81, s81, 6592
s_cmp_eq_u32 s81, 65920
s_cselect_b32 s81, 0, s81
s_add_u32 s43, s81, s67
s_add_u32 m0, s43, 16
s_add_u32 s66, s66, 98304
buffer_load_dwordx4 v236, s[4:7], s66 offen lds
s_add_u32 m0, s43, 912
s_nop 0
buffer_load_dwordx4 v237, s[4:7], s66 offen lds
s_add_u32 s81, s81, 6592
s_cmp_eq_u32 s81, 65920
s_cselect_b32 s81, 0, s81
s_add_u32 s43, s81, s67
s_add_u32 m0, s43, 16
s_add_u32 s66, s66, 98304
buffer_load_dwordx4 v236, s[4:7], s66 offen lds
s_add_u32 m0, s43, 912
s_nop 0
buffer_load_dwordx4 v237, s[4:7], s66 offen lds
s_add_u32 s81, s81, 6592
s_cmp_eq_u32 s81, 65920
s_cselect_b32 s81, 0, s81
s_add_u32 s43, s81, s67
s_add_u32 m0, s43, 32
s_add_u32 s66, s66, 98304
buffer_load_dwordx4 v236, s[4:7], s66 offen lds
s_add_u32 m0, s43, 928
s_nop 0
buffer_load_dwordx4 v237, s[4:7], s66 offen lds
s_add_u32 s81, s81, 6592
s_cmp_eq_u32 s81, 65920
s_cselect_b32 s81, 0, s81
s_add_u32 s43, s81, s67
s_add_u32 m0, s43, 32
s_add_u32 s66, s66, 98304
buffer_load_dwordx4 v236, s[4:7], s66 offen lds
s_add_u32 m0, s43, 928
s_nop 0
buffer_load_dwordx4 v237, s[4:7], s66 offen lds
s_add_u32 s81, s81, 6592
s_cmp_eq_u32 s81, 65920
s_cselect_b32 s81, 0, s81
s_add_u32 s43, s81, s67
s_add_u32 m0, s43, 48
s_add_u32 s66, s66, 98304
buffer_load_dwordx4 v236, s[4:7], s66 offen lds
s_add_u32 m0, s43, 944
s_nop 0
buffer_load_dwordx4 v237, s[4:7], s66 offen lds
s_add_u32 s81, s81, 6592
s_cmp_eq_u32 s81, 65920
s_cselect_b32 s81, 0, s81
s_add_u32 s43, s81, s67
s_add_u32 m0, s43, 48
s_add_u32 s66, s66, 98304
buffer_load_dwordx4 v236, s[4:7], s66 offen lds
s_add_u32 m0, s43, 944
s_nop 0
buffer_load_dwordx4 v237, s[4:7], s66 offen lds
s_add_u32 s81, s81, 6592
s_cmp_eq_u32 s81, 65920
s_cselect_b32 s81, 0, s81
s_add_u32 s43, s81, s67
s_add_u32 m0, s43, 0
s_add_u32 s66, s66, 98304
buffer_load_dwordx4 v236, s[4:7], s66 offen lds
s_add_u32 m0, s43, 896
s_nop 0
buffer_load_dwordx4 v237, s[4:7], s66 offen lds
s_add_u32 s81, s81, 6592
s_cmp_eq_u32 s81, 65920
s_cselect_b32 s81, 0, s81
s_add_u32 s43, s81, s67
s_add_u32 m0, s43, 0
s_add_u32 s66, s66, 98304
buffer_load_dwordx4 v236, s[4:7], s66 offen lds
s_add_u32 m0, s43, 896
s_nop 0
buffer_load_dwordx4 v237, s[4:7], s66 offen lds
s_add_u32 s43, s81, 6592
v_add_u32_e64 v212, s43, v246
v_subrev_u32 v222, 65920, v212
v_min_u32_e64 v212, v212, v222
v_add_u32 v212, 90112, v212
v_add_u32_e64 v213, s43, v246
v_add_u32 v213, 6592, v213
v_subrev_u32 v222, 65920, v213
v_min_u32_e64 v213, v213, v222
v_add_u32 v213, 90112, v213
v_add_u32_e64 v214, s43, v246
v_add_u32 v214, 13184, v214
v_add_u32_e64 v222, 16, v214
v_bfi_b32 v214, 48, v222, v214
v_subrev_u32 v222, 65920, v214
v_min_u32_e64 v214, v214, v222
v_add_u32 v214, 90112, v214
v_add_u32_e64 v215, s43, v246
v_add_u32 v215, 19776, v215
v_add_u32_e64 v222, 16, v215
v_bfi_b32 v215, 48, v222, v215
v_subrev_u32 v222, 65920, v215
v_min_u32 v215, v215, v222
v_add_u32 v215, 90112, v215
v_max_u32 v240, v238, v239
v_bfe_u32 v241, v250, 4, 2
v_bfe_u32 v222, v250, 7, 1
v_lshl_add_u32 v243, v222, 2, v241
v_bfe_u32 v222, v250, 9, 1
v_mul_u32_u24 v222, 300, v222
v_add_u32_e64 v243, v243, v222
v_bfe_u32 v222, v250, 8, 1
v_bfe_u32 v223, v250, 6, 1
v_lshlrev_b32 v222, 1, v222
v_sub_u32 v223, v222, v223
v_lshl_add_u32 v243, v223, 3, v243
v_lshlrev_b32_e64 v243, 3, v243
v_add_u32 v243, 156040, v243
v_bfe_u32 v222, v250, 9, 1
v_mul_u32_u24 v222, 2400, v222
v_add_u32 v222, 156032, v222
v_cmp_ne_u32 vcc, -1, v223
s_nop 1
v_cndmask_b32 v240, v222, v243, vcc
v_add_u32_e64 v243, 64, v243
v_cmp_ne_u32 vcc, 2, v223
s_nop 1
v_cndmask_b32 v242, v222, v243, vcc
v_mul_u32_u24 v241, 21845, v241
v_xor_b32 v241, 17476, v241
s_cmp_lg_u32 s40, 7
s_cbranch_scc1 Lnosent
v_bfe_u32 v104, v250, 4, 6
v_mov_b32 v108, -1
v_mov_b32 v109, -1
v_mov_b32 v110, -1
v_mov_b32 v111, -1
v_lshlrev_b32_e64 v100, 12, v104
v_add_u32 v101, 262144, v100
v_cmp_gt_u32 vcc, 32, v104
v_mov_b32 v105, 2147483648
s_nop 0
v_cndmask_b32 v101, v105, v101, vcc
s_lshl_b32 s43, s2, 4
buffer_store_dwordx4 v[108:111], v100, s[32:35], s43 offen sc1
buffer_store_dwordx4 v[108:111], v101, s[32:35], s43 offen sc1
s_add_u32 s43, s43, 393216
s_cmp_lt_u32 s2, 96
s_cselect_b32 s43, s43, 1073741824
v_lshlrev_b32 v103, 11, v104
s_mov_b64 exec, 0xff
buffer_store_dwordx4 v[108:111], v103, s[32:35], s43 offen sc1
s_mov_b64 exec, -1
s_nop 1
Lnosent:
s_setprio 3
s_waitcnt vmcnt(0)
s_cmp_lg_u32 s40, 7
s_cbranch_scc1 Lnoinit
s_waitcnt vmcnt(0)
v_mov_b32 v222, 1
v_mov_b32 v223, 0
s_mov_b64 exec, 1
buffer_atomic_add v222, v223, s[36:39], 0 offen
s_mov_b64 exec, -1
s_nop 1
Lnoinit:
Lsu1:
ds_read_b128 v[144:147], v212
ds_read_b64 v[192:193], v238
ds_read_b64 v[194:195], v239
ds_read_b128 v[148:151], v213
ds_read_b128 v[152:155], v214
ds_read_b128 v[156:159], v215
ds_read_b64 v[196:197], v240 offset:2400
ds_read_b64 v[198:199], v242 offset:2400
ds_read_b128 v[160:163], v212 offset:16
ds_read_b64 v[200:201], v238 offset:200
ds_read_b64 v[202:203], v239 offset:200
ds_read_b128 v[164:167], v213 offset:16
ds_read_b128 v[168:171], v214 offset:16
ds_read_b128 v[172:175], v215 offset:16
ds_read_b64 v[204:205], v240 offset:2600
s_waitcnt lgkmcnt(14)
ds_read_b64 v[206:207], v242 offset:2600
s_waitcnt lgkmcnt(13)
v_mfma_f32_16x16x32_bf16 v[0:3], v[192:195], v[144:147], 0
ds_read_b128 v[144:147], v212 offset:32
ds_read_b64 v[208:209], v238 offset:400
s_waitcnt lgkmcnt(14)
v_mfma_f32_16x16x32_bf16 v[48:51], v[192:195], v[148:151], 0
ds_read_b64 v[210:211], v239 offset:400
s_waitcnt lgkmcnt(14)
ds_read_b64 v[192:193], v240 offset:2800
s_waitcnt lgkmcnt(14)
ds_read_b64 v[194:195], v242 offset:2800
s_waitcnt lgkmcnt(13)
v_smfmac_f32_16x16x64_bf16 v[0:3], v[196:199], v[148:155], v241
ds_read_b128 v[148:151], v213 offset:32
v_smfmac_f32_16x16x64_bf16 v[48:51], v[196:199], v[152:159], v241
ds_read_b128 v[152:155], v214 offset:32
s_waitcnt lgkmcnt(12)
v_mfma_f32_16x16x32_bf16 v[4:7], v[200:203], v[160:163], 0
ds_read_b128 v[156:159], v215 offset:32
ds_read_b128 v[160:163], v212 offset:48
s_waitcnt lgkmcnt(13)
v_mfma_f32_16x16x32_bf16 v[52:55], v[200:203], v[164:167], 0
ds_read_b64 v[196:197], v238 offset:600
ds_read_b64 v[198:199], v239 offset:600
s_waitcnt lgkmcnt(14)
ds_read_b64 v[200:201], v240 offset:3000
s_waitcnt lgkmcnt(14)
ds_read_b64 v[202:203], v242 offset:3000
s_waitcnt lgkmcnt(13)
v_smfmac_f32_16x16x64_bf16 v[4:7], v[204:207], v[164:171], v241
ds_read_b128 v[164:167], v213 offset:48
v_smfmac_f32_16x16x64_bf16 v[52:55], v[204:207], v[168:175], v241
ds_read_b128 v[168:171], v214 offset:48
s_waitcnt lgkmcnt(12)
v_mfma_f32_16x16x32_bf16 v[8:11], v[208:211], v[144:147], 0
ds_read_b128 v[172:175], v215 offset:48
ds_read_b128 v[144:147], v212 offset:64
ds_read_b64 v[204:205], v238 offset:800
s_waitcnt lgkmcnt(14)
ds_read_b64 v[206:207], v239 offset:800
s_waitcnt lgkmcnt(13)
v_mfma_f32_16x16x32_bf16 v[56:59], v[208:211], v[148:151], 0
ds_read_b64 v[208:209], v240 offset:3200
ds_read_b64 v[210:211], v242 offset:3200
s_waitcnt lgkmcnt(14)
v_smfmac_f32_16x16x64_bf16 v[8:11], v[192:195], v[148:155], v241
ds_read_b128 v[148:151], v213 offset:64
s_waitcnt lgkmcnt(14)
v_smfmac_f32_16x16x64_bf16 v[56:59], v[192:195], v[152:159], v241
ds_read_b128 v[152:155], v214 offset:64
s_waitcnt lgkmcnt(14)
ds_read_b128 v[156:159], v215 offset:64
s_waitcnt lgkmcnt(13)
v_mfma_f32_16x16x32_bf16 v[12:15], v[196:199], v[160:163], 0
ds_read_b128 v[160:163], v212 offset:80
ds_read_b64 v[192:193], v238 offset:1000
s_waitcnt lgkmcnt(14)
ds_read_b64 v[194:195], v239 offset:1000
s_waitcnt lgkmcnt(13)
v_mfma_f32_16x16x32_bf16 v[60:63], v[196:199], v[164:167], 0
ds_read_b64 v[196:197], v240 offset:3400
ds_read_b64 v[198:199], v242 offset:3400
s_waitcnt lgkmcnt(14)
v_smfmac_f32_16x16x64_bf16 v[12:15], v[200:203], v[164:171], v241
ds_read_b128 v[164:167], v213 offset:80
s_waitcnt lgkmcnt(14)
v_smfmac_f32_16x16x64_bf16 v[60:63], v[200:203], v[168:175], v241
ds_read_b128 v[168:171], v214 offset:80
s_waitcnt lgkmcnt(14)
ds_read_b128 v[172:175], v215 offset:80
s_waitcnt lgkmcnt(13)
v_mfma_f32_16x16x32_bf16 v[16:19], v[204:207], v[144:147], 0
ds_read_b128 v[144:147], v212 offset:96
ds_read_b64 v[200:201], v238 offset:1200
s_waitcnt lgkmcnt(14)
ds_read_b64 v[202:203], v239 offset:1200
s_waitcnt lgkmcnt(13)
v_mfma_f32_16x16x32_bf16 v[64:67], v[204:207], v[148:151], 0
ds_read_b64 v[204:205], v240 offset:3600
ds_read_b64 v[206:207], v242 offset:3600
s_waitcnt lgkmcnt(14)
v_smfmac_f32_16x16x64_bf16 v[16:19], v[208:211], v[148:155], v241
ds_read_b128 v[148:151], v213 offset:96
s_waitcnt lgkmcnt(14)
v_smfmac_f32_16x16x64_bf16 v[64:67], v[208:211], v[152:159], v241
ds_read_b128 v[152:155], v214 offset:96
s_waitcnt lgkmcnt(14)
ds_read_b128 v[156:159], v215 offset:96
s_waitcnt lgkmcnt(13)
v_mfma_f32_16x16x32_bf16 v[20:23], v[192:195], v[160:163], 0
ds_read_b128 v[160:163], v212 offset:112
ds_read_b64 v[208:209], v238 offset:1400
s_waitcnt lgkmcnt(14)
ds_read_b64 v[210:211], v239 offset:1400
s_waitcnt lgkmcnt(13)
v_mfma_f32_16x16x32_bf16 v[68:71], v[192:195], v[164:167], 0
ds_read_b64 v[192:193], v240 offset:3800
ds_read_b64 v[194:195], v242 offset:3800
s_waitcnt lgkmcnt(14)
v_smfmac_f32_16x16x64_bf16 v[20:23], v[196:199], v[164:171], v241
ds_read_b128 v[164:167], v213 offset:112
s_waitcnt lgkmcnt(14)
v_smfmac_f32_16x16x64_bf16 v[68:71], v[196:199], v[168:175], v241
ds_read_b128 v[168:171], v214 offset:112
s_waitcnt lgkmcnt(14)
ds_read_b128 v[172:175], v215 offset:112
s_waitcnt lgkmcnt(13)
v_mfma_f32_16x16x32_bf16 v[24:27], v[200:203], v[144:147], 0
ds_read_b128 v[144:147], v212 offset:128
ds_read_b64 v[196:197], v238 offset:1600
s_waitcnt lgkmcnt(14)
ds_read_b64 v[198:199], v239 offset:1600
s_waitcnt lgkmcnt(13)
v_mfma_f32_16x16x32_bf16 v[72:75], v[200:203], v[148:151], 0
ds_read_b64 v[200:201], v240 offset:4000
ds_read_b64 v[202:203], v242 offset:4000
s_waitcnt lgkmcnt(14)
v_smfmac_f32_16x16x64_bf16 v[24:27], v[204:207], v[148:155], v241
ds_read_b128 v[148:151], v213 offset:128
s_waitcnt lgkmcnt(14)
v_smfmac_f32_16x16x64_bf16 v[72:75], v[204:207], v[152:159], v241
ds_read_b128 v[152:155], v214 offset:128
s_waitcnt lgkmcnt(14)
ds_read_b128 v[156:159], v215 offset:128
s_waitcnt lgkmcnt(13)
v_mfma_f32_16x16x32_bf16 v[28:31], v[208:211], v[160:163], 0
ds_read_b128 v[160:163], v212 offset:144
ds_read_b64 v[204:205], v238 offset:1800
s_waitcnt lgkmcnt(14)
ds_read_b64 v[206:207], v239 offset:1800
s_waitcnt lgkmcnt(13)
v_mfma_f32_16x16x32_bf16 v[76:79], v[208:211], v[164:167], 0
ds_read_b64 v[208:209], v240 offset:4200
ds_read_b64 v[210:211], v242 offset:4200
s_waitcnt lgkmcnt(14)
v_smfmac_f32_16x16x64_bf16 v[28:31], v[192:195], v[164:171], v241
ds_read_b128 v[164:167], v213 offset:144
s_waitcnt lgkmcnt(14)
v_smfmac_f32_16x16x64_bf16 v[76:79], v[192:195], v[168:175], v241
ds_read_b128 v[168:171], v214 offset:144
s_waitcnt lgkmcnt(14)
ds_read_b128 v[172:175], v215 offset:144
s_waitcnt lgkmcnt(13)
v_mfma_f32_16x16x32_bf16 v[32:35], v[196:199], v[144:147], 0
ds_read_b128 v[144:147], v212 offset:160
ds_read_b64 v[192:193], v238 offset:2000
s_waitcnt lgkmcnt(14)
ds_read_b64 v[194:195], v239 offset:2000
s_waitcnt lgkmcnt(13)
v_mfma_f32_16x16x32_bf16 v[80:83], v[196:199], v[148:151], 0
ds_read_b64 v[196:197], v240 offset:4400
ds_read_b64 v[198:199], v242 offset:4400
s_waitcnt lgkmcnt(14)
v_smfmac_f32_16x16x64_bf16 v[32:35], v[200:203], v[148:155], v241
ds_read_b128 v[148:151], v213 offset:160
s_waitcnt lgkmcnt(14)
v_smfmac_f32_16x16x64_bf16 v[80:83], v[200:203], v[152:159], v241
ds_read_b128 v[152:155], v214 offset:160
s_waitcnt lgkmcnt(14)
ds_read_b128 v[156:159], v215 offset:160
s_waitcnt lgkmcnt(13)
v_mfma_f32_16x16x32_bf16 v[36:39], v[204:207], v[160:163], 0
ds_read_b128 v[160:163], v212 offset:176
ds_read_b64 v[200:201], v238 offset:2200
s_waitcnt lgkmcnt(14)
ds_read_b64 v[202:203], v239 offset:2200
s_waitcnt lgkmcnt(13)
v_mfma_f32_16x16x32_bf16 v[84:87], v[204:207], v[164:167], 0
ds_read_b64 v[204:205], v240 offset:4600
ds_read_b64 v[206:207], v242 offset:4600
s_waitcnt lgkmcnt(14)
v_smfmac_f32_16x16x64_bf16 v[36:39], v[208:211], v[164:171], v241
ds_read_b128 v[164:167], v213 offset:176
s_waitcnt lgkmcnt(14)
v_smfmac_f32_16x16x64_bf16 v[84:87], v[208:211], v[168:175], v241
ds_read_b128 v[168:171], v214 offset:176
s_waitcnt lgkmcnt(14)
ds_read_b128 v[172:175], v215 offset:176
s_waitcnt lgkmcnt(13)
v_mfma_f32_16x16x32_bf16 v[40:43], v[192:195], v[144:147], 0
s_waitcnt lgkmcnt(10)
v_mfma_f32_16x16x32_bf16 v[88:91], v[192:195], v[148:151], 0
s_waitcnt lgkmcnt(9)
v_smfmac_f32_16x16x64_bf16 v[40:43], v[196:199], v[148:155], v241
s_waitcnt lgkmcnt(8)
v_smfmac_f32_16x16x64_bf16 v[88:91], v[196:199], v[152:159], v241
s_waitcnt lgkmcnt(5)
v_mfma_f32_16x16x32_bf16 v[44:47], v[200:203], v[160:163], 0
s_waitcnt lgkmcnt(2)
v_mfma_f32_16x16x32_bf16 v[92:95], v[200:203], v[164:167], 0
s_waitcnt lgkmcnt(1)
v_smfmac_f32_16x16x64_bf16 v[44:47], v[204:207], v[164:171], v241
s_waitcnt lgkmcnt(0)
v_smfmac_f32_16x16x64_bf16 v[92:95], v[204:207], v[168:175], v241
v_mov_b32 v223, 1
v_add_u32 v222, s83, v247
s_nop 7
s_mov_b64 exec, 1
ds_add_u32 v222, v223 offset:16
s_mov_b64 exec, -1
v_pk_mul_f32 v[242:243], v[0:1], v[0:1]
v_pk_add_f32 v[240:241], v[0:1], v[2:3]
v_pk_fma_f32 v[242:243], v[2:3], v[2:3], v[242:243]
v_pk_mul_f32 v[218:219], v[48:49], v[48:49]
v_pk_add_f32 v[216:217], v[48:49], v[50:51]
v_pk_fma_f32 v[218:219], v[50:51], v[50:51], v[218:219]
v_pk_fma_f32 v[242:243], v[4:5], v[4:5], v[242:243]
v_pk_add_f32 v[240:241], v[240:241], v[4:5]
v_pk_fma_f32 v[242:243], v[6:7], v[6:7], v[242:243]
v_pk_add_f32 v[240:241], v[240:241], v[6:7]
v_pk_fma_f32 v[218:219], v[52:53], v[52:53], v[218:219]
v_pk_add_f32 v[216:217], v[216:217], v[52:53]
v_pk_fma_f32 v[218:219], v[54:55], v[54:55], v[218:219]
v_pk_add_f32 v[216:217], v[216:217], v[54:55]
v_pk_fma_f32 v[242:243], v[8:9], v[8:9], v[242:243]
v_pk_add_f32 v[240:241], v[240:241], v[8:9]
v_pk_fma_f32 v[242:243], v[10:11], v[10:11], v[242:243]
v_pk_add_f32 v[240:241], v[240:241], v[10:11]
v_pk_fma_f32 v[218:219], v[56:57], v[56:57], v[218:219]
v_pk_add_f32 v[216:217], v[216:217], v[56:57]
v_pk_fma_f32 v[218:219], v[58:59], v[58:59], v[218:219]
v_pk_add_f32 v[216:217], v[216:217], v[58:59]
v_pk_fma_f32 v[242:243], v[12:13], v[12:13], v[242:243]
v_pk_add_f32 v[240:241], v[240:241], v[12:13]
v_pk_fma_f32 v[242:243], v[14:15], v[14:15], v[242:243]
v_pk_add_f32 v[240:241], v[240:241], v[14:15]
v_pk_fma_f32 v[218:219], v[60:61], v[60:61], v[218:219]
v_pk_add_f32 v[216:217], v[216:217], v[60:61]
v_pk_fma_f32 v[218:219], v[62:63], v[62:63], v[218:219]
v_pk_add_f32 v[216:217], v[216:217], v[62:63]
v_pk_fma_f32 v[242:243], v[16:17], v[16:17], v[242:243]
v_pk_add_f32 v[240:241], v[240:241], v[16:17]
v_pk_fma_f32 v[242:243], v[18:19], v[18:19], v[242:243]
v_pk_add_f32 v[240:241], v[240:241], v[18:19]
v_pk_fma_f32 v[218:219], v[64:65], v[64:65], v[218:219]
v_pk_add_f32 v[216:217], v[216:217], v[64:65]
v_pk_fma_f32 v[218:219], v[66:67], v[66:67], v[218:219]
v_pk_add_f32 v[216:217], v[216:217], v[66:67]
v_pk_fma_f32 v[242:243], v[20:21], v[20:21], v[242:243]
v_pk_add_f32 v[240:241], v[240:241], v[20:21]
v_pk_fma_f32 v[242:243], v[22:23], v[22:23], v[242:243]
v_pk_add_f32 v[240:241], v[240:241], v[22:23]
v_pk_fma_f32 v[218:219], v[68:69], v[68:69], v[218:219]
v_pk_add_f32 v[216:217], v[216:217], v[68:69]
v_pk_fma_f32 v[218:219], v[70:71], v[70:71], v[218:219]
v_pk_add_f32 v[216:217], v[216:217], v[70:71]
v_pk_fma_f32 v[242:243], v[24:25], v[24:25], v[242:243]
v_pk_add_f32 v[240:241], v[240:241], v[24:25]
v_pk_fma_f32 v[242:243], v[26:27], v[26:27], v[242:243]
v_pk_add_f32 v[240:241], v[240:241], v[26:27]
v_pk_fma_f32 v[218:219], v[72:73], v[72:73], v[218:219]
v_pk_add_f32 v[216:217], v[216:217], v[72:73]
v_pk_fma_f32 v[218:219], v[74:75], v[74:75], v[218:219]
v_pk_add_f32 v[216:217], v[216:217], v[74:75]
v_pk_fma_f32 v[242:243], v[28:29], v[28:29], v[242:243]
v_pk_add_f32 v[240:241], v[240:241], v[28:29]
v_pk_fma_f32 v[242:243], v[30:31], v[30:31], v[242:243]
v_pk_add_f32 v[240:241], v[240:241], v[30:31]
v_pk_fma_f32 v[218:219], v[76:77], v[76:77], v[218:219]
v_pk_add_f32 v[216:217], v[216:217], v[76:77]
v_pk_fma_f32 v[218:219], v[78:79], v[78:79], v[218:219]
v_pk_add_f32 v[216:217], v[216:217], v[78:79]
v_pk_fma_f32 v[242:243], v[32:33], v[32:33], v[242:243]
v_pk_add_f32 v[240:241], v[240:241], v[32:33]
v_pk_fma_f32 v[242:243], v[34:35], v[34:35], v[242:243]
v_pk_add_f32 v[240:241], v[240:241], v[34:35]
v_pk_fma_f32 v[218:219], v[80:81], v[80:81], v[218:219]
v_pk_add_f32 v[216:217], v[216:217], v[80:81]
v_pk_fma_f32 v[218:219], v[82:83], v[82:83], v[218:219]
v_pk_add_f32 v[216:217], v[216:217], v[82:83]
v_pk_fma_f32 v[242:243], v[36:37], v[36:37], v[242:243]
v_pk_add_f32 v[240:241], v[240:241], v[36:37]
v_pk_fma_f32 v[242:243], v[38:39], v[38:39], v[242:243]
v_pk_add_f32 v[240:241], v[240:241], v[38:39]
v_pk_fma_f32 v[218:219], v[84:85], v[84:85], v[218:219]
v_pk_add_f32 v[216:217], v[216:217], v[84:85]
v_pk_fma_f32 v[218:219], v[86:87], v[86:87], v[218:219]
v_pk_add_f32 v[216:217], v[216:217], v[86:87]
v_pk_fma_f32 v[242:243], v[40:41], v[40:41], v[242:243]
v_pk_add_f32 v[240:241], v[240:241], v[40:41]
v_pk_fma_f32 v[242:243], v[42:43], v[42:43], v[242:243]
v_pk_add_f32 v[240:241], v[240:241], v[42:43]
v_pk_fma_f32 v[218:219], v[88:89], v[88:89], v[218:219]
v_pk_add_f32 v[216:217], v[216:217], v[88:89]
v_pk_fma_f32 v[218:219], v[90:91], v[90:91], v[218:219]
v_pk_add_f32 v[216:217], v[216:217], v[90:91]
v_pk_fma_f32 v[242:243], v[44:45], v[44:45], v[242:243]
v_pk_add_f32 v[240:241], v[240:241], v[44:45]
v_pk_fma_f32 v[242:243], v[46:47], v[46:47], v[242:243]
v_pk_add_f32 v[240:241], v[240:241], v[46:47]
v_pk_fma_f32 v[218:219], v[92:93], v[92:93], v[218:219]
v_pk_add_f32 v[216:217], v[216:217], v[92:93]
v_pk_fma_f32 v[218:219], v[94:95], v[94:95], v[218:219]
v_pk_add_f32 v[216:217], v[216:217], v[94:95]
v_add_f32 v218, v218, v219
v_add_f32 v216, v216, v217
s_nop 1
v_permlane32_swap_b32 v216, v218
v_add_f32_e64 v216, v216, v218
v_mul_f32 v216, 1009429163, v216
v_mov_b32_e64 v218, v216
s_nop 1
v_permlane32_swap_b32 v216, v218
v_fma_f32 v218, -v216, v216, v218
v_max_f32_e64 v218, 0, v218
v_add_f32 v218, 925353388, v218
v_rsq_f32 v218, v218
v_add_f32 v240, v240, v241
v_mul_f32 v220, 3203396952, v218
v_mul_f32 v221, 3203396952, v218
v_mul_f32 v218, v216, v220
v_mul_f32 v219, v216, v220
v_add_f32 v242, v242, v243
s_nop 1
v_permlane32_swap_b32 v240, v242
v_add_f32 v240, v240, v242
v_mul_f32 v240, 1009429163, v240
v_mov_b32_e64 v242, v240
s_nop 1
v_permlane32_swap_b32 v240, v242
v_fma_f32 v242, -v240, v240, v242
v_max_f32_e64 v242, 0, v242
v_add_f32 v242, 925353388, v242
v_rsq_f32 v242, v242
s_nop 0
v_mul_f32 v244, 3203396952, v242
v_mul_f32 v245, 3203396952, v242
v_mul_f32 v242, v240, v244
v_mul_f32 v243, v240, v244
v_pk_fma_f32 v[0:1], v[0:1], v[244:245], v[242:243] neg_lo:[0,0,1] neg_hi:[0,0,1]
v_pk_fma_f32 v[2:3], v[2:3], v[244:245], v[242:243] neg_lo:[0,0,1] neg_hi:[0,0,1]
v_cvt_pk_bf16_f32 v0, v0, v1
v_cvt_pk_bf16_f32 v1, v2, v3
v_pk_fma_f32 v[4:5], v[4:5], v[244:245], v[242:243] neg_lo:[0,0,1] neg_hi:[0,0,1]
v_pk_fma_f32 v[6:7], v[6:7], v[244:245], v[242:243] neg_lo:[0,0,1] neg_hi:[0,0,1]
v_cvt_pk_bf16_f32 v2, v4, v5
v_cvt_pk_bf16_f32 v3, v6, v7
v_pk_fma_f32 v[8:9], v[8:9], v[244:245], v[242:243] neg_lo:[0,0,1] neg_hi:[0,0,1]
v_pk_fma_f32 v[10:11], v[10:11], v[244:245], v[242:243] neg_lo:[0,0,1] neg_hi:[0,0,1]
v_cvt_pk_bf16_f32 v4, v8, v9
v_cvt_pk_bf16_f32 v5, v10, v11
v_pk_fma_f32 v[12:13], v[12:13], v[244:245], v[242:243] neg_lo:[0,0,1] neg_hi:[0,0,1]
v_pk_fma_f32 v[14:15], v[14:15], v[244:245], v[242:243] neg_lo:[0,0,1] neg_hi:[0,0,1]
v_cvt_pk_bf16_f32 v6, v12, v13
v_cvt_pk_bf16_f32 v7, v14, v15
v_pk_fma_f32 v[16:17], v[16:17], v[244:245], v[242:243] neg_lo:[0,0,1] neg_hi:[0,0,1]
v_pk_fma_f32 v[18:19], v[18:19], v[244:245], v[242:243] neg_lo:[0,0,1] neg_hi:[0,0,1]
v_cvt_pk_bf16_f32 v8, v16, v17
v_cvt_pk_bf16_f32 v9, v18, v19
v_pk_fma_f32 v[20:21], v[20:21], v[244:245], v[242:243] neg_lo:[0,0,1] neg_hi:[0,0,1]
v_pk_fma_f32 v[22:23], v[22:23], v[244:245], v[242:243] neg_lo:[0,0,1] neg_hi:[0,0,1]
v_cvt_pk_bf16_f32 v10, v20, v21
v_cvt_pk_bf16_f32 v11, v22, v23
v_pk_fma_f32 v[24:25], v[24:25], v[244:245], v[242:243] neg_lo:[0,0,1] neg_hi:[0,0,1]
v_pk_fma_f32 v[26:27], v[26:27], v[244:245], v[242:243] neg_lo:[0,0,1] neg_hi:[0,0,1]
v_cvt_pk_bf16_f32 v12, v24, v25
v_cvt_pk_bf16_f32 v13, v26, v27
v_mov_b32 v223, 0
s_branch Law2
Lax2:
s_sleep 2
Law2:
ds_read_b32 v223, v247 offset:8
s_sub_u32 s76, s76, 1
s_cselect_b32 s44, 4, 0
s_cselect_b32 s76, 0, s76
s_waitcnt lgkmcnt(0)
v_readfirstlane_b32 s43, v223
s_nop 1
s_max_u32 s43, s43, s44
s_cmp_lt_u32 s43, 4
s_cbranch_scc1 Lax2
v_pk_fma_f32 v[28:29], v[28:29], v[244:245], v[242:243] neg_lo:[0,0,1] neg_hi:[0,0,1]
v_pk_fma_f32 v[30:31], v[30:31], v[244:245], v[242:243] neg_lo:[0,0,1] neg_hi:[0,0,1]
v_cvt_pk_bf16_f32 v14, v28, v29
v_cvt_pk_bf16_f32 v15, v30, v31
v_pk_fma_f32 v[32:33], v[32:33], v[244:245], v[242:243] neg_lo:[0,0,1] neg_hi:[0,0,1]
v_pk_fma_f32 v[34:35], v[34:35], v[244:245], v[242:243] neg_lo:[0,0,1] neg_hi:[0,0,1]
v_cvt_pk_bf16_f32 v16, v32, v33
v_cvt_pk_bf16_f32 v17, v34, v35
v_pk_fma_f32 v[36:37], v[36:37], v[244:245], v[242:243] neg_lo:[0,0,1] neg_hi:[0,0,1]
v_pk_fma_f32 v[38:39], v[38:39], v[244:245], v[242:243] neg_lo:[0,0,1] neg_hi:[0,0,1]
v_cvt_pk_bf16_f32 v18, v36, v37
v_cvt_pk_bf16_f32 v19, v38, v39
v_pk_fma_f32 v[40:41], v[40:41], v[244:245], v[242:243] neg_lo:[0,0,1] neg_hi:[0,0,1]
v_pk_fma_f32 v[42:43], v[42:43], v[244:245], v[242:243] neg_lo:[0,0,1] neg_hi:[0,0,1]
v_cvt_pk_bf16_f32 v20, v40, v41
v_cvt_pk_bf16_f32 v21, v42, v43
v_pk_fma_f32 v[44:45], v[44:45], v[244:245], v[242:243] neg_lo:[0,0,1] neg_hi:[0,0,1]
v_pk_fma_f32 v[46:47], v[46:47], v[244:245], v[242:243] neg_lo:[0,0,1] neg_hi:[0,0,1]
v_cvt_pk_bf16_f32 v22, v44, v45
v_cvt_pk_bf16_f32 v23, v46, v47
v_pk_fma_f32 v[48:49], v[48:49], v[220:221], v[218:219] neg_lo:[0,0,1] neg_hi:[0,0,1]
ds_read_b128 v[176:179], v250
v_cvt_pk_bf16_f32 v24, v48, v49
v_pk_fma_f32 v[50:51], v[50:51], v[220:221], v[218:219] neg_lo:[0,0,1] neg_hi:[0,0,1]
v_pk_fma_f32 v[52:53], v[52:53], v[220:221], v[218:219] neg_lo:[0,0,1] neg_hi:[0,0,1]
v_cvt_pk_bf16_f32 v25, v50, v51
v_cvt_pk_bf16_f32 v26, v52, v53
v_pk_fma_f32 v[54:55], v[54:55], v[220:221], v[218:219] neg_lo:[0,0,1] neg_hi:[0,0,1]
v_pk_fma_f32 v[56:57], v[56:57], v[220:221], v[218:219] neg_lo:[0,0,1] neg_hi:[0,0,1]
v_cvt_pk_bf16_f32 v27, v54, v55
v_cvt_pk_bf16_f32 v28, v56, v57
v_pk_fma_f32 v[58:59], v[58:59], v[220:221], v[218:219] neg_lo:[0,0,1] neg_hi:[0,0,1]
v_pk_fma_f32 v[60:61], v[60:61], v[220:221], v[218:219] neg_lo:[0,0,1] neg_hi:[0,0,1]
v_cvt_pk_bf16_f32 v29, v58, v59
v_cvt_pk_bf16_f32 v30, v60, v61
v_pk_fma_f32 v[62:63], v[62:63], v[220:221], v[218:219] neg_lo:[0,0,1] neg_hi:[0,0,1]
v_pk_fma_f32 v[64:65], v[64:65], v[220:221], v[218:219] neg_lo:[0,0,1] neg_hi:[0,0,1]
v_cvt_pk_bf16_f32 v31, v62, v63
v_cvt_pk_bf16_f32 v32, v64, v65
v_pk_fma_f32 v[66:67], v[66:67], v[220:221], v[218:219] neg_lo:[0,0,1] neg_hi:[0,0,1]
v_pk_fma_f32 v[68:69], v[68:69], v[220:221], v[218:219] neg_lo:[0,0,1] neg_hi:[0,0,1]
v_cvt_pk_bf16_f32 v33, v66, v67
v_cvt_pk_bf16_f32 v34, v68, v69
v_pk_fma_f32 v[70:71], v[70:71], v[220:221], v[218:219] neg_lo:[0,0,1] neg_hi:[0,0,1]
v_pk_fma_f32 v[72:73], v[72:73], v[220:221], v[218:219] neg_lo:[0,0,1] neg_hi:[0,0,1]
ds_read_b128 v[180:183], v250 offset:1024
v_cvt_pk_bf16_f32 v35, v70, v71
v_cvt_pk_bf16_f32 v36, v72, v73
v_pk_fma_f32 v[74:75], v[74:75], v[220:221], v[218:219] neg_lo:[0,0,1] neg_hi:[0,0,1]
v_pk_fma_f32 v[76:77], v[76:77], v[220:221], v[218:219] neg_lo:[0,0,1] neg_hi:[0,0,1]
v_cvt_pk_bf16_f32 v37, v74, v75
v_cvt_pk_bf16_f32 v38, v76, v77
v_pk_fma_f32 v[78:79], v[78:79], v[220:221], v[218:219] neg_lo:[0,0,1] neg_hi:[0,0,1]
v_pk_fma_f32 v[80:81], v[80:81], v[220:221], v[218:219] neg_lo:[0,0,1] neg_hi:[0,0,1]
v_cvt_pk_bf16_f32 v39, v78, v79
v_cvt_pk_bf16_f32 v40, v80, v81
v_pk_fma_f32 v[82:83], v[82:83], v[220:221], v[218:219] neg_lo:[0,0,1] neg_hi:[0,0,1]
v_pk_fma_f32 v[84:85], v[84:85], v[220:221], v[218:219] neg_lo:[0,0,1] neg_hi:[0,0,1]
v_cvt_pk_bf16_f32 v41, v82, v83
v_cvt_pk_bf16_f32 v42, v84, v85
v_pk_fma_f32 v[86:87], v[86:87], v[220:221], v[218:219] neg_lo:[0,0,1] neg_hi:[0,0,1]
v_pk_fma_f32 v[88:89], v[88:89], v[220:221], v[218:219] neg_lo:[0,0,1] neg_hi:[0,0,1]
v_cvt_pk_bf16_f32 v43, v86, v87
v_cvt_pk_bf16_f32 v44, v88, v89
v_pk_fma_f32 v[90:91], v[90:91], v[220:221], v[218:219] neg_lo:[0,0,1] neg_hi:[0,0,1]
v_pk_fma_f32 v[92:93], v[92:93], v[220:221], v[218:219] neg_lo:[0,0,1] neg_hi:[0,0,1]
v_cvt_pk_bf16_f32 v45, v90, v91
v_cvt_pk_bf16_f32 v46, v92, v93
v_pk_fma_f32 v[94:95], v[94:95], v[220:221], v[218:219] neg_lo:[0,0,1] neg_hi:[0,0,1]
ds_read_b128 v[184:187], v250 offset:2048
v_cvt_pk_bf16_f32 v47, v94, v95
s_waitcnt lgkmcnt(2)
v_mfma_f32_32x32x16_bf16 v[160:175], v[0:3], v[176:179], 0
ds_read_b128 v[188:191], v250 offset:3072
v_mfma_f32_32x32x16_bf16 v[96:111], v[24:27], v[176:179], 0
ds_read_b128 v[176:179], v250 offset:4096
s_waitcnt lgkmcnt(3)
v_mfma_f32_32x32x16_bf16 v[160:175], v[4:7], v[180:183], v[160:175]
v_mfma_f32_32x32x16_bf16 v[96:111], v[28:31], v[180:183], v[96:111]
ds_read_b128 v[180:183], v250 offset:5120
s_waitcnt lgkmcnt(3)
v_mfma_f32_32x32x16_bf16 v[160:175], v[8:11], v[184:187], v[160:175]
v_mfma_f32_32x32x16_bf16 v[96:111], v[32:35], v[184:187], v[96:111]
ds_read_b128 v[184:187], v250 offset:6144
s_waitcnt lgkmcnt(2)
v_mfma_f32_32x32x16_bf16 v[160:175], v[12:15], v[188:191], v[160:175]
v_mfma_f32_32x32x16_bf16 v[96:111], v[36:39], v[188:191], v[96:111]
ds_read_b128 v[188:191], v250 offset:7168
v_mfma_f32_32x32x16_bf16 v[160:175], v[16:19], v[176:179], v[160:175]
v_mfma_f32_32x32x16_bf16 v[96:111], v[40:43], v[176:179], v[96:111]
ds_read_b128 v[176:179], v250 offset:8192
s_waitcnt lgkmcnt(2)
v_mfma_f32_32x32x16_bf16 v[160:175], v[20:23], v[180:183], v[160:175]
v_mfma_f32_32x32x16_bf16 v[96:111], v[44:47], v[180:183], v[96:111]
ds_read_b128 v[180:183], v250 offset:9216
s_nop 9
v_cvt_pkrtz_f16_f32 v160, v160, v161
v_mfma_f32_32x32x16_bf16 v[112:127], v[0:3], v[184:187], 0
v_cvt_pkrtz_f16_f32 v161, v162, v163
v_lshrrev_b64 v[160:161], 2, v[160:161]
v_and_b32_sdwa v162, s47, v160 dst_sel:DWORD dst_unused:UNUSED_PAD src0_sel:DWORD src1_sel:WORD_1
v_and_b32_e64 v160, s47, v160
v_cvt_pk_f16_f32 v172, v172, v173
v_cvt_pk_f16_f32 v174, v174, v175
v_pk_fma_f16 v173, v172, v172, s48
v_mfma_f32_32x32x16_bf16 v[128:143], v[24:27], v[184:187], 0
ds_read_u16 v162, v162
ds_read_u16 v160, v160
v_and_b32_sdwa v163, s47, v161 dst_sel:DWORD dst_unused:UNUSED_PAD src0_sel:DWORD src1_sel:WORD_1
v_and_b32_e64 v161, s47, v161
v_pk_fma_f16 v175, v174, v174, s48
v_pk_mul_f16 v173, v172, v173
v_pk_mul_f16 v175, v174, v175
v_cvt_pkrtz_f16_f32 v164, v164, v165
v_cvt_pkrtz_f16_f32 v165, v166, v167
v_lshrrev_b64 v[164:165], 2, v[164:165]
ds_read_u16 v163, v163
ds_read_u16 v161, v161
v_and_b32_sdwa v166, s47, v164 dst_sel:DWORD dst_unused:UNUSED_PAD src0_sel:DWORD src1_sel:WORD_1
v_and_b32 v164, s47, v164
v_exp_f16_sdwa v173, v173 dst_sel:WORD_0 dst_unused:UNUSED_PRESERVE src0_sel:WORD_0
s_waitcnt lgkmcnt(4)
v_mfma_f32_32x32x16_bf16 v[112:127], v[4:7], v[188:191], v[112:127]
ds_read_u16 v166, v166
ds_read_u16 v164, v164
v_exp_f16_sdwa v175, v175 dst_sel:WORD_0 dst_unused:UNUSED_PRESERVE src0_sel:WORD_0
v_and_b32_sdwa v167, s47, v165 dst_sel:DWORD dst_unused:UNUSED_PAD src0_sel:DWORD src1_sel:WORD_1
v_and_b32_e64 v165, s47, v165
v_exp_f16_sdwa v173, v173 dst_sel:WORD_1 dst_unused:UNUSED_PRESERVE src0_sel:WORD_1
v_cvt_pkrtz_f16_f32 v168, v168, v169
v_cvt_pkrtz_f16_f32 v169, v170, v171
v_lshrrev_b64 v[168:169], 2, v[168:169]
v_and_b32_sdwa v170, s47, v168 dst_sel:DWORD dst_unused:UNUSED_PAD src0_sel:DWORD src1_sel:WORD_1
v_and_b32_e64 v168, s47, v168
ds_read_u16 v167, v167
ds_read_u16 v165, v165
ds_read_u16 v170, v170
ds_read_u16 v168, v168
v_exp_f16_sdwa v175, v175 dst_sel:WORD_1 dst_unused:UNUSED_PRESERVE src0_sel:WORD_1
v_mfma_f32_32x32x16_bf16 v[128:143], v[28:31], v[188:191], v[128:143]
ds_read_b128 v[184:187], v250 offset:10240
v_and_b32_sdwa v171, s47, v169 dst_sel:DWORD dst_unused:UNUSED_PAD src0_sel:DWORD src1_sel:WORD_1
v_and_b32_e64 v169, s47, v169
v_pk_add_f16 v173, v173, 1.0 op_sel_hi:[1,0]
v_pk_add_f16 v175, v175, 1.0 op_sel_hi:[1,0]
v_rcp_f16_sdwa v173, v173 dst_sel:WORD_0 dst_unused:UNUSED_PRESERVE src0_sel:WORD_0
v_mfma_f32_32x32x16_bf16 v[112:127], v[8:11], v[176:179], v[112:127]
ds_read_u16 v171, v171
ds_read_u16 v169, v169
v_rcp_f16_sdwa v175, v175 dst_sel:WORD_0 dst_unused:UNUSED_PRESERVE src0_sel:WORD_0
v_rcp_f16_sdwa v173, v173 dst_sel:WORD_1 dst_unused:UNUSED_PRESERVE src0_sel:WORD_1
v_rcp_f16_sdwa v175, v175 dst_sel:WORD_1 dst_unused:UNUSED_PRESERVE src0_sel:WORD_1
v_mfma_f32_32x32x16_bf16 v[128:143], v[32:35], v[176:179], v[128:143]
ds_read_b128 v[188:191], v250 offset:11264
v_pk_mul_f16 v172, v172, v173
v_pk_mul_f16 v174, v174, v175
v_fma_mix_f32 v224, v172, v172, v224 op_sel_hi:[1,1,0]
v_cvt_pkrtz_f16_f32 v96, v96, v97
v_fma_mix_f32 v224, v174, v174, v224 op_sel_hi:[1,1,0]
v_mfma_f32_32x32x16_bf16 v[112:127], v[12:15], v[180:183], v[112:127]
v_fma_mix_f32 v224, v172, v172, v224 op_sel:[1,1,0] op_sel_hi:[1,1,0]
v_cvt_pkrtz_f16_f32 v97, v98, v99
v_fma_mix_f32 v224, v174, v174, v224 op_sel:[1,1,0] op_sel_hi:[1,1,0]
v_lshrrev_b64 v[96:97], 2, v[96:97]
s_waitcnt lgkmcnt(7)
v_fma_mix_f32 v224, v160, v160, v224 op_sel_hi:[1,1,0]
v_and_b32_sdwa v98, s47, v96 dst_sel:DWORD dst_unused:UNUSED_PAD src0_sel:DWORD src1_sel:WORD_1
v_fma_mix_f32 v224, v161, v161, v224 op_sel_hi:[1,1,0]
v_and_b32 v96, s47, v96
v_fma_mix_f32 v224, v162, v162, v224 op_sel_hi:[1,1,0]
v_cvt_pk_f16_f32 v108, v108, v109
v_fma_mix_f32 v224, v163, v163, v224 op_sel_hi:[1,1,0]
v_cvt_pk_f16_f32 v110, v110, v111
v_pk_fma_f16 v109, v108, v108, s48
v_mfma_f32_32x32x16_bf16 v[128:143], v[36:39], v[180:183], v[128:143]
ds_read_u16 v98, v98
ds_read_u16 v96, v96
v_fma_mix_f32 v224, v164, v164, v224 op_sel_hi:[1,1,0]
v_and_b32_sdwa v99, s47, v97 dst_sel:DWORD dst_unused:UNUSED_PAD src0_sel:DWORD src1_sel:WORD_1
s_waitcnt lgkmcnt(6)
v_fma_mix_f32 v224, v165, v165, v224 op_sel_hi:[1,1,0]
v_and_b32 v97, s47, v97
v_pk_fma_f16 v111, v110, v110, s48
v_pk_mul_f16 v109, v108, v109
v_pk_mul_f16 v111, v110, v111
v_fma_mix_f32 v224, v166, v166, v224 op_sel_hi:[1,1,0]
v_cvt_pkrtz_f16_f32 v100, v100, v101
v_fma_mix_f32 v224, v167, v167, v224 op_sel_hi:[1,1,0]
ds_read_u16 v99, v99
ds_read_u16 v97, v97
ds_read_b128 v[176:179], v250 offset:12288
v_cvt_pkrtz_f16_f32 v101, v102, v103
v_lshrrev_b64 v[100:101], 2, v[100:101]
v_and_b32_sdwa v102, s47, v100 dst_sel:DWORD dst_unused:UNUSED_PAD src0_sel:DWORD src1_sel:WORD_1
v_and_b32 v100, s47, v100
v_exp_f16_sdwa v109, v109 dst_sel:WORD_0 dst_unused:UNUSED_PRESERVE src0_sel:WORD_0
s_waitcnt lgkmcnt(6)
v_mfma_f32_32x32x16_bf16 v[112:127], v[16:19], v[184:187], v[112:127]
ds_read_u16 v102, v102
ds_read_u16 v100, v100
v_exp_f16_sdwa v111, v111 dst_sel:WORD_0 dst_unused:UNUSED_PRESERVE src0_sel:WORD_0
v_fma_mix_f32 v224, v168, v168, v224 op_sel_hi:[1,1,0]
v_and_b32_sdwa v103, s47, v101 dst_sel:DWORD dst_unused:UNUSED_PAD src0_sel:DWORD src1_sel:WORD_1
v_fma_mix_f32 v224, v169, v169, v224 op_sel_hi:[1,1,0]
v_and_b32_e64 v101, s47, v101
v_exp_f16_sdwa v109, v109 dst_sel:WORD_1 dst_unused:UNUSED_PRESERVE src0_sel:WORD_1
v_fma_mix_f32 v224, v170, v170, v224 op_sel_hi:[1,1,0]
v_cvt_pkrtz_f16_f32 v104, v104, v105
v_fma_mix_f32 v224, v171, v171, v224 op_sel_hi:[1,1,0]
v_cvt_pkrtz_f16_f32 v105, v106, v107
v_lshrrev_b64 v[104:105], 2, v[104:105]
ds_read_u16 v103, v103
ds_read_u16 v101, v101
v_and_b32_sdwa v106, s47, v104 dst_sel:DWORD dst_unused:UNUSED_PAD src0_sel:DWORD src1_sel:WORD_1
v_and_b32_e64 v104, s47, v104
v_exp_f16_sdwa v111, v111 dst_sel:WORD_1 dst_unused:UNUSED_PRESERVE src0_sel:WORD_1
v_mfma_f32_32x32x16_bf16 v[128:143], v[40:43], v[184:187], v[128:143]
ds_read_u16 v106, v106
ds_read_u16 v104, v104
ds_read_b128 v[180:183], v250 offset:13312
v_and_b32_sdwa v107, s47, v105 dst_sel:DWORD dst_unused:UNUSED_PAD src0_sel:DWORD src1_sel:WORD_1
v_and_b32_e64 v105, s47, v105
v_pk_add_f16 v109, v109, 1.0 op_sel_hi:[1,0]
v_pk_add_f16 v111, v111, 1.0 op_sel_hi:[1,0]
v_rcp_f16_sdwa v109, v109 dst_sel:WORD_0 dst_unused:UNUSED_PRESERVE src0_sel:WORD_0
s_waitcnt lgkmcnt(7)
v_mfma_f32_32x32x16_bf16 v[112:127], v[20:23], v[188:191], v[112:127]
ds_read_u16 v107, v107
ds_read_u16 v105, v105
v_rcp_f16_sdwa v111, v111 dst_sel:WORD_0 dst_unused:UNUSED_PRESERVE src0_sel:WORD_0
v_rcp_f16_sdwa v109, v109 dst_sel:WORD_1 dst_unused:UNUSED_PRESERVE src0_sel:WORD_1
v_rcp_f16_sdwa v111, v111 dst_sel:WORD_1 dst_unused:UNUSED_PRESERVE src0_sel:WORD_1
v_mfma_f32_32x32x16_bf16 v[128:143], v[44:47], v[188:191], v[128:143]
ds_read_b128 v[184:187], v250 offset:14336
v_pk_mul_f16 v108, v108, v109
v_pk_mul_f16 v110, v110, v111
v_fma_mix_f32 v224, v108, v108, v224 op_sel_hi:[1,1,0]
s_nop 1
v_cvt_pkrtz_f16_f32 v112, v112, v113
v_fma_mix_f32 v224, v110, v110, v224 op_sel_hi:[1,1,0]
v_mfma_f32_32x32x16_bf16 v[144:159], v[0:3], v[176:179], 0
v_fma_mix_f32 v224, v108, v108, v224 op_sel:[1,1,0] op_sel_hi:[1,1,0]
v_cvt_pkrtz_f16_f32 v113, v114, v115
v_fma_mix_f32 v224, v110, v110, v224 op_sel:[1,1,0] op_sel_hi:[1,1,0]
v_lshrrev_b64 v[112:113], 2, v[112:113]
v_fma_mix_f32 v224, v96, v96, v224 op_sel_hi:[1,1,0]
v_and_b32_sdwa v114, s47, v112 dst_sel:DWORD dst_unused:UNUSED_PAD src0_sel:DWORD src1_sel:WORD_1
v_fma_mix_f32 v224, v97, v97, v224 op_sel_hi:[1,1,0]
v_and_b32_e64 v112, s47, v112
v_fma_mix_f32 v224, v98, v98, v224 op_sel_hi:[1,1,0]
v_cvt_pk_f16_f32 v124, v124, v125
v_fma_mix_f32 v224, v99, v99, v224 op_sel_hi:[1,1,0]
v_cvt_pk_f16_f32 v126, v126, v127
v_pk_fma_f16 v125, v124, v124, s48
v_mfma_f32_32x32x16_bf16 v[160:175], v[24:27], v[176:179], 0
ds_read_u16 v114, v114
ds_read_u16 v112, v112
s_waitcnt lgkmcnt(5)
v_fma_mix_f32 v224, v100, v100, v224 op_sel_hi:[1,1,0]
v_and_b32_sdwa v115, s47, v113 dst_sel:DWORD dst_unused:UNUSED_PAD src0_sel:DWORD src1_sel:WORD_1
v_fma_mix_f32 v224, v101, v101, v224 op_sel_hi:[1,1,0]
v_and_b32 v113, s47, v113
v_pk_fma_f16 v127, v126, v126, s48
v_pk_mul_f16 v125, v124, v125
v_pk_mul_f16 v127, v126, v127
v_fma_mix_f32 v224, v102, v102, v224 op_sel_hi:[1,1,0]
v_cvt_pkrtz_f16_f32 v116, v116, v117
v_fma_mix_f32 v224, v103, v103, v224 op_sel_hi:[1,1,0]
ds_read_u16 v115, v115
ds_read_u16 v113, v113
ds_read_b128 v[188:191], v250 offset:15360
v_cvt_pkrtz_f16_f32 v117, v118, v119
v_lshrrev_b64 v[116:117], 2, v[116:117]
v_and_b32_sdwa v118, s47, v116 dst_sel:DWORD dst_unused:UNUSED_PAD src0_sel:DWORD src1_sel:WORD_1
v_and_b32_e64 v116, s47, v116
v_exp_f16_sdwa v125, v125 dst_sel:WORD_0 dst_unused:UNUSED_PRESERVE src0_sel:WORD_0
v_mfma_f32_32x32x16_bf16 v[144:159], v[4:7], v[180:183], v[144:159]
ds_read_u16 v118, v118
ds_read_u16 v116, v116
v_exp_f16_sdwa v127, v127 dst_sel:WORD_0 dst_unused:UNUSED_PRESERVE src0_sel:WORD_0
v_fma_mix_f32 v224, v104, v104, v224 op_sel_hi:[1,1,0]
v_and_b32_sdwa v119, s47, v117 dst_sel:DWORD dst_unused:UNUSED_PAD src0_sel:DWORD src1_sel:WORD_1
s_waitcnt lgkmcnt(7)
v_fma_mix_f32 v224, v105, v105, v224 op_sel_hi:[1,1,0]
v_and_b32 v117, s47, v117
v_exp_f16_sdwa v125, v125 dst_sel:WORD_1 dst_unused:UNUSED_PRESERVE src0_sel:WORD_1
v_fma_mix_f32 v224, v106, v106, v224 op_sel_hi:[1,1,0]
v_cvt_pkrtz_f16_f32 v120, v120, v121
v_fma_mix_f32 v224, v107, v107, v224 op_sel_hi:[1,1,0]
v_cvt_pkrtz_f16_f32 v121, v122, v123
v_lshrrev_b64 v[120:121], 2, v[120:121]
ds_read_u16 v119, v119
ds_read_u16 v117, v117
v_and_b32_sdwa v122, s47, v120 dst_sel:DWORD dst_unused:UNUSED_PAD src0_sel:DWORD src1_sel:WORD_1
v_and_b32_e64 v120, s47, v120
v_exp_f16_sdwa v127, v127 dst_sel:WORD_1 dst_unused:UNUSED_PRESERVE src0_sel:WORD_1
v_mfma_f32_32x32x16_bf16 v[160:175], v[28:31], v[180:183], v[160:175]
ds_read_u16 v122, v122
ds_read_u16 v120, v120
ds_read_b128 v[176:179], v250 offset:16384
v_and_b32_sdwa v123, s47, v121 dst_sel:DWORD dst_unused:UNUSED_PAD src0_sel:DWORD src1_sel:WORD_1
v_and_b32_e64 v121, s47, v121
v_pk_add_f16 v125, v125, 1.0 op_sel_hi:[1,0]
v_pk_add_f16 v127, v127, 1.0 op_sel_hi:[1,0]
v_rcp_f16_sdwa v125, v125 dst_sel:WORD_0 dst_unused:UNUSED_PRESERVE src0_sel:WORD_0
v_mfma_f32_32x32x16_bf16 v[144:159], v[8:11], v[184:187], v[144:159]
ds_read_u16 v123, v123
ds_read_u16 v121, v121
v_rcp_f16_sdwa v127, v127 dst_sel:WORD_0 dst_unused:UNUSED_PRESERVE src0_sel:WORD_0
v_rcp_f16_sdwa v125, v125 dst_sel:WORD_1 dst_unused:UNUSED_PRESERVE src0_sel:WORD_1
v_rcp_f16_sdwa v127, v127 dst_sel:WORD_1 dst_unused:UNUSED_PRESERVE src0_sel:WORD_1
v_mfma_f32_32x32x16_bf16 v[160:175], v[32:35], v[184:187], v[160:175]
ds_read_b128 v[180:183], v250 offset:17408
v_pk_mul_f16 v124, v124, v125
v_pk_mul_f16 v126, v126, v127
v_fma_mix_f32 v225, v124, v124, v225 op_sel_hi:[1,1,0]
v_cvt_pkrtz_f16_f32 v128, v128, v129
v_fma_mix_f32 v225, v126, v126, v225 op_sel_hi:[1,1,0]
s_waitcnt lgkmcnt(7)
v_mfma_f32_32x32x16_bf16 v[144:159], v[12:15], v[188:191], v[144:159]
v_fma_mix_f32 v225, v124, v124, v225 op_sel:[1,1,0] op_sel_hi:[1,1,0]
v_cvt_pkrtz_f16_f32 v129, v130, v131
v_fma_mix_f32 v225, v126, v126, v225 op_sel:[1,1,0] op_sel_hi:[1,1,0]
v_lshrrev_b64 v[128:129], 2, v[128:129]
v_fma_mix_f32 v225, v112, v112, v225 op_sel_hi:[1,1,0]
v_and_b32_sdwa v130, s47, v128 dst_sel:DWORD dst_unused:UNUSED_PAD src0_sel:DWORD src1_sel:WORD_1
v_fma_mix_f32 v225, v113, v113, v225 op_sel_hi:[1,1,0]
v_and_b32 v128, s47, v128
v_fma_mix_f32 v225, v114, v114, v225 op_sel_hi:[1,1,0]
v_cvt_pk_f16_f32 v140, v140, v141
v_fma_mix_f32 v225, v115, v115, v225 op_sel_hi:[1,1,0]
v_cvt_pk_f16_f32 v142, v142, v143
v_pk_fma_f16 v141, v140, v140, s48
v_mfma_f32_32x32x16_bf16 v[160:175], v[36:39], v[188:191], v[160:175]
ds_read_u16 v130, v130
ds_read_u16 v128, v128
v_fma_mix_f32 v225, v116, v116, v225 op_sel_hi:[1,1,0]
v_and_b32_sdwa v131, s47, v129 dst_sel:DWORD dst_unused:UNUSED_PAD src0_sel:DWORD src1_sel:WORD_1
s_waitcnt lgkmcnt(5)
v_fma_mix_f32 v225, v117, v117, v225 op_sel_hi:[1,1,0]
v_and_b32 v129, s47, v129
v_pk_fma_f16 v143, v142, v142, s48
v_pk_mul_f16 v141, v140, v141
v_pk_mul_f16 v143, v142, v143
v_fma_mix_f32 v225, v118, v118, v225 op_sel_hi:[1,1,0]
v_cvt_pkrtz_f16_f32 v132, v132, v133
v_fma_mix_f32 v225, v119, v119, v225 op_sel_hi:[1,1,0]
ds_read_u16 v131, v131
ds_read_u16 v129, v129
ds_read_b128 v[184:187], v250 offset:18432
v_cvt_pkrtz_f16_f32 v133, v134, v135
v_lshrrev_b64 v[132:133], 2, v[132:133]
v_and_b32_sdwa v134, s47, v132 dst_sel:DWORD dst_unused:UNUSED_PAD src0_sel:DWORD src1_sel:WORD_1
v_and_b32_e64 v132, s47, v132
v_exp_f16_sdwa v141, v141 dst_sel:WORD_0 dst_unused:UNUSED_PRESERVE src0_sel:WORD_0
v_mfma_f32_32x32x16_bf16 v[144:159], v[16:19], v[176:179], v[144:159]
ds_read_u16 v134, v134
ds_read_u16 v132, v132
v_exp_f16_sdwa v143, v143 dst_sel:WORD_0 dst_unused:UNUSED_PRESERVE src0_sel:WORD_0
v_fma_mix_f32 v225, v120, v120, v225 op_sel_hi:[1,1,0]
v_and_b32_sdwa v135, s47, v133 dst_sel:DWORD dst_unused:UNUSED_PAD src0_sel:DWORD src1_sel:WORD_1
s_waitcnt lgkmcnt(7)
v_fma_mix_f32 v225, v121, v121, v225 op_sel_hi:[1,1,0]
v_and_b32 v133, s47, v133
v_exp_f16_sdwa v141, v141 dst_sel:WORD_1 dst_unused:UNUSED_PRESERVE src0_sel:WORD_1
v_fma_mix_f32 v225, v122, v122, v225 op_sel_hi:[1,1,0]
v_cvt_pkrtz_f16_f32 v136, v136, v137
v_fma_mix_f32 v225, v123, v123, v225 op_sel_hi:[1,1,0]
v_cvt_pkrtz_f16_f32 v137, v138, v139
v_lshrrev_b64 v[136:137], 2, v[136:137]
ds_read_u16 v135, v135
ds_read_u16 v133, v133
v_and_b32_sdwa v138, s47, v136 dst_sel:DWORD dst_unused:UNUSED_PAD src0_sel:DWORD src1_sel:WORD_1
v_and_b32_e64 v136, s47, v136
v_exp_f16_sdwa v143, v143 dst_sel:WORD_1 dst_unused:UNUSED_PRESERVE src0_sel:WORD_1
v_mfma_f32_32x32x16_bf16 v[160:175], v[40:43], v[176:179], v[160:175]
ds_read_u16 v138, v138
ds_read_u16 v136, v136
ds_read_b128 v[188:191], v250 offset:19456
v_and_b32_sdwa v139, s47, v137 dst_sel:DWORD dst_unused:UNUSED_PAD src0_sel:DWORD src1_sel:WORD_1
v_and_b32_e64 v137, s47, v137
v_pk_add_f16 v141, v141, 1.0 op_sel_hi:[1,0]
v_pk_add_f16 v143, v143, 1.0 op_sel_hi:[1,0]
v_rcp_f16_sdwa v141, v141 dst_sel:WORD_0 dst_unused:UNUSED_PRESERVE src0_sel:WORD_0
v_mfma_f32_32x32x16_bf16 v[144:159], v[20:23], v[180:183], v[144:159]
ds_read_u16 v139, v139
ds_read_u16 v137, v137
v_rcp_f16_sdwa v143, v143 dst_sel:WORD_0 dst_unused:UNUSED_PRESERVE src0_sel:WORD_0
v_rcp_f16_sdwa v141, v141 dst_sel:WORD_1 dst_unused:UNUSED_PRESERVE src0_sel:WORD_1
v_rcp_f16_sdwa v143, v143 dst_sel:WORD_1 dst_unused:UNUSED_PRESERVE src0_sel:WORD_1
v_mfma_f32_32x32x16_bf16 v[160:175], v[44:47], v[180:183], v[160:175]
ds_read_b128 v[176:179], v250 offset:20480
v_pk_mul_f16 v140, v140, v141
v_pk_mul_f16 v142, v142, v143
v_fma_mix_f32 v225, v140, v140, v225 op_sel_hi:[1,1,0]
s_nop 1
v_cvt_pkrtz_f16_f32 v144, v144, v145
v_fma_mix_f32 v225, v142, v142, v225 op_sel_hi:[1,1,0]
s_waitcnt lgkmcnt(7)
v_mfma_f32_32x32x16_bf16 v[96:111], v[0:3], v[184:187], 0
v_fma_mix_f32 v225, v140, v140, v225 op_sel:[1,1,0] op_sel_hi:[1,1,0]
v_cvt_pkrtz_f16_f32 v145, v146, v147
v_fma_mix_f32 v225, v142, v142, v225 op_sel:[1,1,0] op_sel_hi:[1,1,0]
v_lshrrev_b64 v[144:145], 2, v[144:145]
v_fma_mix_f32 v225, v128, v128, v225 op_sel_hi:[1,1,0]
v_and_b32_sdwa v146, s47, v144 dst_sel:DWORD dst_unused:UNUSED_PAD src0_sel:DWORD src1_sel:WORD_1
v_fma_mix_f32 v225, v129, v129, v225 op_sel_hi:[1,1,0]
v_and_b32_e64 v144, s47, v144
v_fma_mix_f32 v225, v130, v130, v225 op_sel_hi:[1,1,0]
v_cvt_pk_f16_f32 v156, v156, v157
v_fma_mix_f32 v225, v131, v131, v225 op_sel_hi:[1,1,0]
v_cvt_pk_f16_f32 v158, v158, v159
v_pk_fma_f16 v157, v156, v156, s48
v_mfma_f32_32x32x16_bf16 v[112:127], v[24:27], v[184:187], 0
ds_read_u16 v146, v146
ds_read_u16 v144, v144
v_fma_mix_f32 v225, v132, v132, v225 op_sel_hi:[1,1,0]
v_and_b32_sdwa v147, s47, v145 dst_sel:DWORD dst_unused:UNUSED_PAD src0_sel:DWORD src1_sel:WORD_1
s_waitcnt lgkmcnt(5)
v_fma_mix_f32 v225, v133, v133, v225 op_sel_hi:[1,1,0]
v_and_b32 v145, s47, v145
v_pk_fma_f16 v159, v158, v158, s48
v_pk_mul_f16 v157, v156, v157
v_pk_mul_f16 v159, v158, v159
v_fma_mix_f32 v225, v134, v134, v225 op_sel_hi:[1,1,0]
v_cvt_pkrtz_f16_f32 v148, v148, v149
v_fma_mix_f32 v225, v135, v135, v225 op_sel_hi:[1,1,0]
ds_read_u16 v147, v147
ds_read_u16 v145, v145
ds_read_b128 v[180:183], v250 offset:21504
v_cvt_pkrtz_f16_f32 v149, v150, v151
v_lshrrev_b64 v[148:149], 2, v[148:149]
v_and_b32_sdwa v150, s47, v148 dst_sel:DWORD dst_unused:UNUSED_PAD src0_sel:DWORD src1_sel:WORD_1
v_and_b32_e64 v148, s47, v148
v_exp_f16_sdwa v157, v157 dst_sel:WORD_0 dst_unused:UNUSED_PRESERVE src0_sel:WORD_0
v_mfma_f32_32x32x16_bf16 v[96:111], v[4:7], v[188:191], v[96:111]
ds_read_u16 v150, v150
ds_read_u16 v148, v148
v_exp_f16_sdwa v159, v159 dst_sel:WORD_0 dst_unused:UNUSED_PRESERVE src0_sel:WORD_0
v_fma_mix_f32 v225, v136, v136, v225 op_sel_hi:[1,1,0]
v_and_b32_sdwa v151, s47, v149 dst_sel:DWORD dst_unused:UNUSED_PAD src0_sel:DWORD src1_sel:WORD_1
s_waitcnt lgkmcnt(7)
v_fma_mix_f32 v225, v137, v137, v225 op_sel_hi:[1,1,0]
v_and_b32 v149, s47, v149
v_exp_f16_sdwa v157, v157 dst_sel:WORD_1 dst_unused:UNUSED_PRESERVE src0_sel:WORD_1
v_fma_mix_f32 v225, v138, v138, v225 op_sel_hi:[1,1,0]
v_cvt_pkrtz_f16_f32 v152, v152, v153
v_fma_mix_f32 v225, v139, v139, v225 op_sel_hi:[1,1,0]
v_cvt_pkrtz_f16_f32 v153, v154, v155
v_lshrrev_b64 v[152:153], 2, v[152:153]
ds_read_u16 v151, v151
ds_read_u16 v149, v149
v_and_b32_sdwa v154, s47, v152 dst_sel:DWORD dst_unused:UNUSED_PAD src0_sel:DWORD src1_sel:WORD_1
v_and_b32_e64 v152, s47, v152
v_exp_f16_sdwa v159, v159 dst_sel:WORD_1 dst_unused:UNUSED_PRESERVE src0_sel:WORD_1
v_mfma_f32_32x32x16_bf16 v[112:127], v[28:31], v[188:191], v[112:127]
ds_read_u16 v154, v154
ds_read_u16 v152, v152
ds_read_b128 v[184:187], v250 offset:22528
v_and_b32_sdwa v155, s47, v153 dst_sel:DWORD dst_unused:UNUSED_PAD src0_sel:DWORD src1_sel:WORD_1
v_and_b32_e64 v153, s47, v153
v_pk_add_f16 v157, v157, 1.0 op_sel_hi:[1,0]
v_pk_add_f16 v159, v159, 1.0 op_sel_hi:[1,0]
v_rcp_f16_sdwa v157, v157 dst_sel:WORD_0 dst_unused:UNUSED_PRESERVE src0_sel:WORD_0
v_mfma_f32_32x32x16_bf16 v[96:111], v[8:11], v[176:179], v[96:111]
ds_read_u16 v155, v155
ds_read_u16 v153, v153
v_rcp_f16_sdwa v159, v159 dst_sel:WORD_0 dst_unused:UNUSED_PRESERVE src0_sel:WORD_0
v_rcp_f16_sdwa v157, v157 dst_sel:WORD_1 dst_unused:UNUSED_PRESERVE src0_sel:WORD_1
v_rcp_f16_sdwa v159, v159 dst_sel:WORD_1 dst_unused:UNUSED_PRESERVE src0_sel:WORD_1
v_mfma_f32_32x32x16_bf16 v[112:127], v[32:35], v[176:179], v[112:127]
ds_read_b128 v[188:191], v250 offset:23552
v_mov_b32 v223, 0
s_branch Law3
Lax3:
s_sleep 2
Law3:
ds_read_b32 v223, v247 offset:12
s_sub_u32 s76, s76, 1
s_cselect_b32 s44, 4, 0
s_cselect_b32 s76, 0, s76
s_waitcnt lgkmcnt(0)
v_readfirstlane_b32 s43, v223
s_nop 1
s_max_u32 s43, s43, s44
s_cmp_lt_u32 s43, 4
s_cbranch_scc1 Lax3
v_pk_mul_f16 v156, v156, v157
v_pk_mul_f16 v158, v158, v159
v_fma_mix_f32 v226, v156, v156, v226 op_sel_hi:[1,1,0]
v_mfma_f32_32x32x16_bf16 v[96:111], v[12:15], v[180:183], v[96:111]
v_fma_mix_f32 v226, v158, v158, v226 op_sel_hi:[1,1,0]
v_cvt_pkrtz_f16_f32 v160, v160, v161
v_fma_mix_f32 v226, v156, v156, v226 op_sel:[1,1,0] op_sel_hi:[1,1,0]
v_cvt_pkrtz_f16_f32 v161, v162, v163
v_fma_mix_f32 v226, v158, v158, v226 op_sel:[1,1,0] op_sel_hi:[1,1,0]
v_lshrrev_b64 v[160:161], 2, v[160:161]
v_fma_mix_f32 v226, v144, v144, v226 op_sel_hi:[1,1,0]
v_and_b32_sdwa v162, s47, v160 dst_sel:DWORD dst_unused:UNUSED_PAD src0_sel:DWORD src1_sel:WORD_1
v_fma_mix_f32 v226, v145, v145, v226 op_sel_hi:[1,1,0]
v_and_b32_e64 v160, s47, v160
v_fma_mix_f32 v226, v146, v146, v226 op_sel_hi:[1,1,0]
v_cvt_pk_f16_f32 v172, v172, v173
v_fma_mix_f32 v226, v147, v147, v226 op_sel_hi:[1,1,0]
v_cvt_pk_f16_f32 v174, v174, v175
v_pk_fma_f16 v173, v172, v172, s48
v_mfma_f32_32x32x16_bf16 v[112:127], v[36:39], v[180:183], v[112:127]
ds_read_u16 v162, v162
ds_read_u16 v160, v160
v_fma_mix_f32 v226, v148, v148, v226 op_sel_hi:[1,1,0]
v_and_b32_sdwa v163, s47, v161 dst_sel:DWORD dst_unused:UNUSED_PAD src0_sel:DWORD src1_sel:WORD_1
v_fma_mix_f32 v226, v149, v149, v226 op_sel_hi:[1,1,0]
v_and_b32_e64 v161, s47, v161
v_pk_fma_f16 v175, v174, v174, s48
v_pk_mul_f16 v173, v172, v173
v_pk_mul_f16 v175, v174, v175
v_fma_mix_f32 v226, v150, v150, v226 op_sel_hi:[1,1,0]
v_cvt_pkrtz_f16_f32 v164, v164, v165
v_fma_mix_f32 v226, v151, v151, v226 op_sel_hi:[1,1,0]
ds_read_u16 v163, v163
ds_read_u16 v161, v161
ds_read_b128 v[176:179], v250 offset:24576
v_cvt_pkrtz_f16_f32 v165, v166, v167
v_lshrrev_b64 v[164:165], 2, v[164:165]
v_and_b32_sdwa v166, s47, v164 dst_sel:DWORD dst_unused:UNUSED_PAD src0_sel:DWORD src1_sel:WORD_1
v_and_b32_e64 v164, s47, v164
v_exp_f16_sdwa v173, v173 dst_sel:WORD_0 dst_unused:UNUSED_PRESERVE src0_sel:WORD_0
v_mfma_f32_32x32x16_bf16 v[96:111], v[16:19], v[184:187], v[96:111]
ds_read_u16 v166, v166
ds_read_u16 v164, v164
v_exp_f16_sdwa v175, v175 dst_sel:WORD_0 dst_unused:UNUSED_PRESERVE src0_sel:WORD_0
v_fma_mix_f32 v226, v152, v152, v226 op_sel_hi:[1,1,0]
v_and_b32_sdwa v167, s47, v165 dst_sel:DWORD dst_unused:UNUSED_PAD src0_sel:DWORD src1_sel:WORD_1
v_fma_mix_f32 v226, v153, v153, v226 op_sel_hi:[1,1,0]
v_and_b32_e64 v165, s47, v165
v_exp_f16_sdwa v173, v173 dst_sel:WORD_1 dst_unused:UNUSED_PRESERVE src0_sel:WORD_1
v_fma_mix_f32 v226, v154, v154, v226 op_sel_hi:[1,1,0]
v_cvt_pkrtz_f16_f32 v168, v168, v169
v_fma_mix_f32 v226, v155, v155, v226 op_sel_hi:[1,1,0]
v_cvt_pkrtz_f16_f32 v169, v170, v171
v_lshrrev_b64 v[168:169], 2, v[168:169]
ds_read_u16 v167, v167
ds_read_u16 v165, v165
v_and_b32_sdwa v170, s47, v168 dst_sel:DWORD dst_unused:UNUSED_PAD src0_sel:DWORD src1_sel:WORD_1
v_and_b32_e64 v168, s47, v168
v_exp_f16_sdwa v175, v175 dst_sel:WORD_1 dst_unused:UNUSED_PRESERVE src0_sel:WORD_1
v_mfma_f32_32x32x16_bf16 v[112:127], v[40:43], v[184:187], v[112:127]
ds_read_u16 v170, v170
ds_read_u16 v168, v168
ds_read_b128 v[180:183], v250 offset:25600
v_and_b32_sdwa v171, s47, v169 dst_sel:DWORD dst_unused:UNUSED_PAD src0_sel:DWORD src1_sel:WORD_1
v_and_b32_e64 v169, s47, v169
v_pk_add_f16 v173, v173, 1.0 op_sel_hi:[1,0]
v_pk_add_f16 v175, v175, 1.0 op_sel_hi:[1,0]
v_rcp_f16_sdwa v173, v173 dst_sel:WORD_0 dst_unused:UNUSED_PRESERVE src0_sel:WORD_0
v_mfma_f32_32x32x16_bf16 v[96:111], v[20:23], v[188:191], v[96:111]
ds_read_u16 v171, v171
ds_read_u16 v169, v169
v_rcp_f16_sdwa v175, v175 dst_sel:WORD_0 dst_unused:UNUSED_PRESERVE src0_sel:WORD_0
v_rcp_f16_sdwa v173, v173 dst_sel:WORD_1 dst_unused:UNUSED_PRESERVE src0_sel:WORD_1
v_rcp_f16_sdwa v175, v175 dst_sel:WORD_1 dst_unused:UNUSED_PRESERVE src0_sel:WORD_1
v_mfma_f32_32x32x16_bf16 v[112:127], v[44:47], v[188:191], v[112:127]
ds_read_b128 v[184:187], v250 offset:26624
v_pk_mul_f16 v172, v172, v173
v_pk_mul_f16 v174, v174, v175
v_fma_mix_f32 v226, v172, v172, v226 op_sel_hi:[1,1,0]
s_nop 1
v_cvt_pkrtz_f16_f32 v96, v96, v97
v_fma_mix_f32 v226, v174, v174, v226 op_sel_hi:[1,1,0]
s_waitcnt lgkmcnt(7)
v_mfma_f32_32x32x16_bf16 v[128:143], v[0:3], v[176:179], 0
v_fma_mix_f32 v226, v172, v172, v226 op_sel:[1,1,0] op_sel_hi:[1,1,0]
v_cvt_pkrtz_f16_f32 v97, v98, v99
v_fma_mix_f32 v226, v174, v174, v226 op_sel:[1,1,0] op_sel_hi:[1,1,0]
v_lshrrev_b64 v[96:97], 2, v[96:97]
v_fma_mix_f32 v226, v160, v160, v226 op_sel_hi:[1,1,0]
v_and_b32_sdwa v98, s47, v96 dst_sel:DWORD dst_unused:UNUSED_PAD src0_sel:DWORD src1_sel:WORD_1
v_fma_mix_f32 v226, v161, v161, v226 op_sel_hi:[1,1,0]
v_and_b32_e64 v96, s47, v96
v_fma_mix_f32 v226, v162, v162, v226 op_sel_hi:[1,1,0]
v_cvt_pk_f16_f32 v108, v108, v109
v_fma_mix_f32 v226, v163, v163, v226 op_sel_hi:[1,1,0]
v_cvt_pk_f16_f32 v110, v110, v111
v_pk_fma_f16 v109, v108, v108, s48
v_mfma_f32_32x32x16_bf16 v[144:159], v[24:27], v[176:179], 0
ds_read_u16 v98, v98
ds_read_u16 v96, v96
v_fma_mix_f32 v226, v164, v164, v226 op_sel_hi:[1,1,0]
v_and_b32_sdwa v99, s47, v97 dst_sel:DWORD dst_unused:UNUSED_PAD src0_sel:DWORD src1_sel:WORD_1
s_waitcnt lgkmcnt(5)
v_fma_mix_f32 v226, v165, v165, v226 op_sel_hi:[1,1,0]
v_and_b32 v97, s47, v97
v_pk_fma_f16 v111, v110, v110, s48
v_pk_mul_f16 v109, v108, v109
v_pk_mul_f16 v111, v110, v111
v_fma_mix_f32 v226, v166, v166, v226 op_sel_hi:[1,1,0]
v_cvt_pkrtz_f16_f32 v100, v100, v101
v_fma_mix_f32 v226, v167, v167, v226 op_sel_hi:[1,1,0]
ds_read_u16 v99, v99
ds_read_u16 v97, v97
ds_read_b128 v[188:191], v250 offset:27648
v_cvt_pkrtz_f16_f32 v101, v102, v103
v_lshrrev_b64 v[100:101], 2, v[100:101]
v_and_b32_sdwa v102, s47, v100 dst_sel:DWORD dst_unused:UNUSED_PAD src0_sel:DWORD src1_sel:WORD_1
v_and_b32_e64 v100, s47, v100
v_exp_f16_sdwa v109, v109 dst_sel:WORD_0 dst_unused:UNUSED_PRESERVE src0_sel:WORD_0
v_mfma_f32_32x32x16_bf16 v[128:143], v[4:7], v[180:183], v[128:143]
ds_read_u16 v102, v102
ds_read_u16 v100, v100
v_exp_f16_sdwa v111, v111 dst_sel:WORD_0 dst_unused:UNUSED_PRESERVE src0_sel:WORD_0
v_fma_mix_f32 v226, v168, v168, v226 op_sel_hi:[1,1,0]
v_and_b32_sdwa v103, s47, v101 dst_sel:DWORD dst_unused:UNUSED_PAD src0_sel:DWORD src1_sel:WORD_1
s_waitcnt lgkmcnt(7)
v_fma_mix_f32 v226, v169, v169, v226 op_sel_hi:[1,1,0]
v_and_b32 v101, s47, v101
v_exp_f16_sdwa v109, v109 dst_sel:WORD_1 dst_unused:UNUSED_PRESERVE src0_sel:WORD_1
v_fma_mix_f32 v226, v170, v170, v226 op_sel_hi:[1,1,0]
v_cvt_pkrtz_f16_f32 v104, v104, v105
v_fma_mix_f32 v226, v171, v171, v226 op_sel_hi:[1,1,0]
v_cvt_pkrtz_f16_f32 v105, v106, v107
v_lshrrev_b64 v[104:105], 2, v[104:105]
ds_read_u16 v103, v103
ds_read_u16 v101, v101
v_and_b32_sdwa v106, s47, v104 dst_sel:DWORD dst_unused:UNUSED_PAD src0_sel:DWORD src1_sel:WORD_1
v_and_b32_e64 v104, s47, v104
v_exp_f16_sdwa v111, v111 dst_sel:WORD_1 dst_unused:UNUSED_PRESERVE src0_sel:WORD_1
v_mfma_f32_32x32x16_bf16 v[144:159], v[28:31], v[180:183], v[144:159]
ds_read_u16 v106, v106
ds_read_u16 v104, v104
ds_read_b128 v[176:179], v250 offset:28672
v_and_b32_sdwa v107, s47, v105 dst_sel:DWORD dst_unused:UNUSED_PAD src0_sel:DWORD src1_sel:WORD_1
v_and_b32_e64 v105, s47, v105
v_pk_add_f16 v109, v109, 1.0 op_sel_hi:[1,0]
v_pk_add_f16 v111, v111, 1.0 op_sel_hi:[1,0]
v_rcp_f16_sdwa v109, v109 dst_sel:WORD_0 dst_unused:UNUSED_PRESERVE src0_sel:WORD_0
v_mfma_f32_32x32x16_bf16 v[128:143], v[8:11], v[184:187], v[128:143]
ds_read_u16 v107, v107
ds_read_u16 v105, v105
v_rcp_f16_sdwa v111, v111 dst_sel:WORD_0 dst_unused:UNUSED_PRESERVE src0_sel:WORD_0
v_rcp_f16_sdwa v109, v109 dst_sel:WORD_1 dst_unused:UNUSED_PRESERVE src0_sel:WORD_1
v_rcp_f16_sdwa v111, v111 dst_sel:WORD_1 dst_unused:UNUSED_PRESERVE src0_sel:WORD_1
v_mfma_f32_32x32x16_bf16 v[144:159], v[32:35], v[184:187], v[144:159]
ds_read_b128 v[180:183], v250 offset:29696
v_pk_mul_f16 v108, v108, v109
v_pk_mul_f16 v110, v110, v111
v_fma_mix_f32 v227, v108, v108, v227 op_sel_hi:[1,1,0]
v_cvt_pkrtz_f16_f32 v112, v112, v113
v_fma_mix_f32 v227, v110, v110, v227 op_sel_hi:[1,1,0]
s_waitcnt lgkmcnt(7)
v_mfma_f32_32x32x16_bf16 v[128:143], v[12:15], v[188:191], v[128:143]
v_fma_mix_f32 v227, v108, v108, v227 op_sel:[1,1,0] op_sel_hi:[1,1,0]
v_cvt_pkrtz_f16_f32 v113, v114, v115
v_fma_mix_f32 v227, v110, v110, v227 op_sel:[1,1,0] op_sel_hi:[1,1,0]
v_lshrrev_b64 v[112:113], 2, v[112:113]
v_fma_mix_f32 v227, v96, v96, v227 op_sel_hi:[1,1,0]
v_and_b32_sdwa v114, s47, v112 dst_sel:DWORD dst_unused:UNUSED_PAD src0_sel:DWORD src1_sel:WORD_1
v_fma_mix_f32 v227, v97, v97, v227 op_sel_hi:[1,1,0]
v_and_b32 v112, s47, v112
v_fma_mix_f32 v227, v98, v98, v227 op_sel_hi:[1,1,0]
v_cvt_pk_f16_f32 v124, v124, v125
v_fma_mix_f32 v227, v99, v99, v227 op_sel_hi:[1,1,0]
v_cvt_pk_f16_f32 v126, v126, v127
v_pk_fma_f16 v125, v124, v124, s48
v_mfma_f32_32x32x16_bf16 v[144:159], v[36:39], v[188:191], v[144:159]
ds_read_u16 v114, v114
ds_read_u16 v112, v112
v_fma_mix_f32 v227, v100, v100, v227 op_sel_hi:[1,1,0]
v_and_b32_sdwa v115, s47, v113 dst_sel:DWORD dst_unused:UNUSED_PAD src0_sel:DWORD src1_sel:WORD_1
s_waitcnt lgkmcnt(5)
v_fma_mix_f32 v227, v101, v101, v227 op_sel_hi:[1,1,0]
v_and_b32 v113, s47, v113
v_pk_fma_f16 v127, v126, v126, s48
v_pk_mul_f16 v125, v124, v125
v_pk_mul_f16 v127, v126, v127
v_fma_mix_f32 v227, v102, v102, v227 op_sel_hi:[1,1,0]
v_cvt_pkrtz_f16_f32 v116, v116, v117
v_fma_mix_f32 v227, v103, v103, v227 op_sel_hi:[1,1,0]
ds_read_u16 v115, v115
ds_read_u16 v113, v113
ds_read_b128 v[184:187], v250 offset:30720
v_cvt_pkrtz_f16_f32 v117, v118, v119
v_lshrrev_b64 v[116:117], 2, v[116:117]
v_and_b32_sdwa v118, s47, v116 dst_sel:DWORD dst_unused:UNUSED_PAD src0_sel:DWORD src1_sel:WORD_1
v_and_b32_e64 v116, s47, v116
v_exp_f16_sdwa v125, v125 dst_sel:WORD_0 dst_unused:UNUSED_PRESERVE src0_sel:WORD_0
v_mfma_f32_32x32x16_bf16 v[128:143], v[16:19], v[176:179], v[128:143]
ds_read_u16 v118, v118
ds_read_u16 v116, v116
v_exp_f16_sdwa v127, v127 dst_sel:WORD_0 dst_unused:UNUSED_PRESERVE src0_sel:WORD_0
v_fma_mix_f32 v227, v104, v104, v227 op_sel_hi:[1,1,0]
v_and_b32_sdwa v119, s47, v117 dst_sel:DWORD dst_unused:UNUSED_PAD src0_sel:DWORD src1_sel:WORD_1
s_waitcnt lgkmcnt(7)
v_fma_mix_f32 v227, v105, v105, v227 op_sel_hi:[1,1,0]
v_and_b32 v117, s47, v117
v_exp_f16_sdwa v125, v125 dst_sel:WORD_1 dst_unused:UNUSED_PRESERVE src0_sel:WORD_1
v_fma_mix_f32 v227, v106, v106, v227 op_sel_hi:[1,1,0]
v_cvt_pkrtz_f16_f32 v120, v120, v121
v_fma_mix_f32 v227, v107, v107, v227 op_sel_hi:[1,1,0]
v_cvt_pkrtz_f16_f32 v121, v122, v123
v_lshrrev_b64 v[120:121], 2, v[120:121]
ds_read_u16 v119, v119
ds_read_u16 v117, v117
v_and_b32_sdwa v122, s47, v120 dst_sel:DWORD dst_unused:UNUSED_PAD src0_sel:DWORD src1_sel:WORD_1
v_and_b32_e64 v120, s47, v120
v_exp_f16_sdwa v127, v127 dst_sel:WORD_1 dst_unused:UNUSED_PRESERVE src0_sel:WORD_1
v_mfma_f32_32x32x16_bf16 v[144:159], v[40:43], v[176:179], v[144:159]
ds_read_u16 v122, v122
ds_read_u16 v120, v120
ds_read_b128 v[188:191], v250 offset:31744
v_and_b32_sdwa v123, s47, v121 dst_sel:DWORD dst_unused:UNUSED_PAD src0_sel:DWORD src1_sel:WORD_1
v_and_b32_e64 v121, s47, v121
v_pk_add_f16 v125, v125, 1.0 op_sel_hi:[1,0]
v_pk_add_f16 v127, v127, 1.0 op_sel_hi:[1,0]
v_rcp_f16_sdwa v125, v125 dst_sel:WORD_0 dst_unused:UNUSED_PRESERVE src0_sel:WORD_0
v_mfma_f32_32x32x16_bf16 v[128:143], v[20:23], v[180:183], v[128:143]
ds_read_u16 v123, v123
ds_read_u16 v121, v121
v_rcp_f16_sdwa v127, v127 dst_sel:WORD_0 dst_unused:UNUSED_PRESERVE src0_sel:WORD_0
v_rcp_f16_sdwa v125, v125 dst_sel:WORD_1 dst_unused:UNUSED_PRESERVE src0_sel:WORD_1
v_rcp_f16_sdwa v127, v127 dst_sel:WORD_1 dst_unused:UNUSED_PRESERVE src0_sel:WORD_1
v_mfma_f32_32x32x16_bf16 v[144:159], v[44:47], v[180:183], v[144:159]
ds_read_b128 v[176:179], v250 offset:32768
v_pk_mul_f16 v124, v124, v125
v_pk_mul_f16 v126, v126, v127
v_fma_mix_f32 v227, v124, v124, v227 op_sel_hi:[1,1,0]
s_nop 1
v_cvt_pkrtz_f16_f32 v128, v128, v129
v_fma_mix_f32 v227, v126, v126, v227 op_sel_hi:[1,1,0]
s_waitcnt lgkmcnt(7)
v_mfma_f32_32x32x16_bf16 v[160:175], v[0:3], v[184:187], 0
v_fma_mix_f32 v227, v124, v124, v227 op_sel:[1,1,0] op_sel_hi:[1,1,0]
v_cvt_pkrtz_f16_f32 v129, v130, v131
v_fma_mix_f32 v227, v126, v126, v227 op_sel:[1,1,0] op_sel_hi:[1,1,0]
v_lshrrev_b64 v[128:129], 2, v[128:129]
v_fma_mix_f32 v227, v112, v112, v227 op_sel_hi:[1,1,0]
v_and_b32_sdwa v130, s47, v128 dst_sel:DWORD dst_unused:UNUSED_PAD src0_sel:DWORD src1_sel:WORD_1
v_fma_mix_f32 v227, v113, v113, v227 op_sel_hi:[1,1,0]
v_and_b32_e64 v128, s47, v128
v_fma_mix_f32 v227, v114, v114, v227 op_sel_hi:[1,1,0]
v_cvt_pk_f16_f32 v140, v140, v141
v_fma_mix_f32 v227, v115, v115, v227 op_sel_hi:[1,1,0]
v_cvt_pk_f16_f32 v142, v142, v143
v_pk_fma_f16 v141, v140, v140, s48
v_mfma_f32_32x32x16_bf16 v[96:111], v[24:27], v[184:187], 0
ds_read_u16 v130, v130
ds_read_u16 v128, v128
v_fma_mix_f32 v227, v116, v116, v227 op_sel_hi:[1,1,0]
v_and_b32_sdwa v131, s47, v129 dst_sel:DWORD dst_unused:UNUSED_PAD src0_sel:DWORD src1_sel:WORD_1
s_waitcnt lgkmcnt(5)
v_fma_mix_f32 v227, v117, v117, v227 op_sel_hi:[1,1,0]
v_and_b32 v129, s47, v129
v_pk_fma_f16 v143, v142, v142, s48
v_pk_mul_f16 v141, v140, v141
v_pk_mul_f16 v143, v142, v143
v_fma_mix_f32 v227, v118, v118, v227 op_sel_hi:[1,1,0]
v_cvt_pkrtz_f16_f32 v132, v132, v133
v_fma_mix_f32 v227, v119, v119, v227 op_sel_hi:[1,1,0]
ds_read_u16 v131, v131
ds_read_u16 v129, v129
ds_read_b128 v[180:183], v250 offset:33792
v_cvt_pkrtz_f16_f32 v133, v134, v135
v_lshrrev_b64 v[132:133], 2, v[132:133]
v_and_b32_sdwa v134, s47, v132 dst_sel:DWORD dst_unused:UNUSED_PAD src0_sel:DWORD src1_sel:WORD_1
v_and_b32_e64 v132, s47, v132
v_exp_f16_sdwa v141, v141 dst_sel:WORD_0 dst_unused:UNUSED_PRESERVE src0_sel:WORD_0
v_mfma_f32_32x32x16_bf16 v[160:175], v[4:7], v[188:191], v[160:175]
ds_read_u16 v134, v134
ds_read_u16 v132, v132
v_exp_f16_sdwa v143, v143 dst_sel:WORD_0 dst_unused:UNUSED_PRESERVE src0_sel:WORD_0
v_fma_mix_f32 v227, v120, v120, v227 op_sel_hi:[1,1,0]
v_and_b32_sdwa v135, s47, v133 dst_sel:DWORD dst_unused:UNUSED_PAD src0_sel:DWORD src1_sel:WORD_1
s_waitcnt lgkmcnt(7)
v_fma_mix_f32 v227, v121, v121, v227 op_sel_hi:[1,1,0]
v_and_b32 v133, s47, v133
v_exp_f16_sdwa v141, v141 dst_sel:WORD_1 dst_unused:UNUSED_PRESERVE src0_sel:WORD_1
v_fma_mix_f32 v227, v122, v122, v227 op_sel_hi:[1,1,0]
v_cvt_pkrtz_f16_f32 v136, v136, v137
v_fma_mix_f32 v227, v123, v123, v227 op_sel_hi:[1,1,0]
v_cvt_pkrtz_f16_f32 v137, v138, v139
v_lshrrev_b64 v[136:137], 2, v[136:137]
ds_read_u16 v135, v135
ds_read_u16 v133, v133
v_and_b32_sdwa v138, s47, v136 dst_sel:DWORD dst_unused:UNUSED_PAD src0_sel:DWORD src1_sel:WORD_1
v_and_b32_e64 v136, s47, v136
v_exp_f16_sdwa v143, v143 dst_sel:WORD_1 dst_unused:UNUSED_PRESERVE src0_sel:WORD_1
v_mfma_f32_32x32x16_bf16 v[96:111], v[28:31], v[188:191], v[96:111]
ds_read_u16 v138, v138
ds_read_u16 v136, v136
ds_read_b128 v[184:187], v250 offset:34816
v_and_b32_sdwa v139, s47, v137 dst_sel:DWORD dst_unused:UNUSED_PAD src0_sel:DWORD src1_sel:WORD_1
v_and_b32_e64 v137, s47, v137
v_pk_add_f16 v141, v141, 1.0 op_sel_hi:[1,0]
v_pk_add_f16 v143, v143, 1.0 op_sel_hi:[1,0]
v_rcp_f16_sdwa v141, v141 dst_sel:WORD_0 dst_unused:UNUSED_PRESERVE src0_sel:WORD_0
v_mfma_f32_32x32x16_bf16 v[160:175], v[8:11], v[176:179], v[160:175]
ds_read_u16 v139, v139
ds_read_u16 v137, v137
v_rcp_f16_sdwa v143, v143 dst_sel:WORD_0 dst_unused:UNUSED_PRESERVE src0_sel:WORD_0
v_rcp_f16_sdwa v141, v141 dst_sel:WORD_1 dst_unused:UNUSED_PRESERVE src0_sel:WORD_1
v_rcp_f16_sdwa v143, v143 dst_sel:WORD_1 dst_unused:UNUSED_PRESERVE src0_sel:WORD_1
v_mfma_f32_32x32x16_bf16 v[96:111], v[32:35], v[176:179], v[96:111]
ds_read_b128 v[188:191], v250 offset:35840
v_pk_mul_f16 v140, v140, v141
v_pk_mul_f16 v142, v142, v143
v_fma_mix_f32 v228, v140, v140, v228 op_sel_hi:[1,1,0]
s_add_u32 s66, s66, 786432
s_sub_u32 s81, s81, 13184
v_bfe_u32 v223, v250, 4, 6
v_and_b32 v222, 15, v223
v_lshlrev_b32 v222, 7, v222
v_lshrrev_b32 v223, 4, v223
v_mul_u32_u24 v223, 98304, v223
s_sub_u32 s43, s67, -8000
s_mul_i32 s44, s41, 192
s_add_u32 s43, s43, s44
v_add3_u32 v222, v222, v223, s43
s_mov_b32 m0, 163840
s_add_u32 s44, s66, 393216
buffer_load_dword v222, s[4:7], s66 offen lds
buffer_load_dword v222, s[4:7], s44 offen lds
v_fma_mix_f32 v228, v142, v142, v228 op_sel_hi:[1,1,0]
s_waitcnt lgkmcnt(6)
v_mfma_f32_32x32x16_bf16 v[160:175], v[12:15], v[180:183], v[160:175]
s_setprio 3
v_fma_mix_f32 v228, v140, v140, v228 op_sel:[1,1,0] op_sel_hi:[1,1,0]
v_cvt_pkrtz_f16_f32 v144, v144, v145
v_fma_mix_f32 v228, v142, v142, v228 op_sel:[1,1,0] op_sel_hi:[1,1,0]
v_cvt_pkrtz_f16_f32 v145, v146, v147
v_fma_mix_f32 v228, v128, v128, v228 op_sel_hi:[1,1,0]
v_lshrrev_b64 v[144:145], 2, v[144:145]
v_fma_mix_f32 v228, v129, v129, v228 op_sel_hi:[1,1,0]
v_and_b32_sdwa v146, s47, v144 dst_sel:DWORD dst_unused:UNUSED_PAD src0_sel:DWORD src1_sel:WORD_1
v_fma_mix_f32 v228, v130, v130, v228 op_sel_hi:[1,1,0]
v_and_b32_e64 v144, s47, v144
v_fma_mix_f32 v228, v131, v131, v228 op_sel_hi:[1,1,0]
v_cvt_pk_f16_f32 v156, v156, v157
v_cvt_pk_f16_f32 v158, v158, v159
v_pk_fma_f16 v157, v156, v156, s48
v_mfma_f32_32x32x16_bf16 v[96:111], v[36:39], v[180:183], v[96:111]
ds_read_u16 v146, v146
ds_read_u16 v144, v144
v_fma_mix_f32 v228, v132, v132, v228 op_sel_hi:[1,1,0]
v_and_b32_sdwa v147, s47, v145 dst_sel:DWORD dst_unused:UNUSED_PAD src0_sel:DWORD src1_sel:WORD_1
v_fma_mix_f32 v228, v133, v133, v228 op_sel_hi:[1,1,0]
v_and_b32_e64 v145, s47, v145
v_pk_fma_f16 v159, v158, v158, s48
v_pk_mul_f16 v157, v156, v157
v_pk_mul_f16 v159, v158, v159
v_fma_mix_f32 v228, v134, v134, v228 op_sel_hi:[1,1,0]
v_cvt_pkrtz_f16_f32 v148, v148, v149
v_fma_mix_f32 v228, v135, v135, v228 op_sel_hi:[1,1,0]
ds_read_u16 v147, v147
ds_read_u16 v145, v145
ds_read_b128 v[176:179], v250 offset:36864
v_cvt_pkrtz_f16_f32 v149, v150, v151
v_lshrrev_b64 v[148:149], 2, v[148:149]
v_and_b32_sdwa v150, s47, v148 dst_sel:DWORD dst_unused:UNUSED_PAD src0_sel:DWORD src1_sel:WORD_1
v_and_b32 v148, s47, v148
v_exp_f16_sdwa v157, v157 dst_sel:WORD_0 dst_unused:UNUSED_PRESERVE src0_sel:WORD_0
s_waitcnt lgkmcnt(5)
v_mfma_f32_32x32x16_bf16 v[160:175], v[16:19], v[184:187], v[160:175]
ds_read_u16 v150, v150
ds_read_u16 v148, v148
v_exp_f16_sdwa v159, v159 dst_sel:WORD_0 dst_unused:UNUSED_PRESERVE src0_sel:WORD_0
v_fma_mix_f32 v228, v136, v136, v228 op_sel_hi:[1,1,0]
v_and_b32_sdwa v151, s47, v149 dst_sel:DWORD dst_unused:UNUSED_PAD src0_sel:DWORD src1_sel:WORD_1
v_fma_mix_f32 v228, v137, v137, v228 op_sel_hi:[1,1,0]
v_and_b32_e64 v149, s47, v149
v_exp_f16_sdwa v157, v157 dst_sel:WORD_1 dst_unused:UNUSED_PRESERVE src0_sel:WORD_1
v_fma_mix_f32 v228, v138, v138, v228 op_sel_hi:[1,1,0]
v_cvt_pkrtz_f16_f32 v152, v152, v153
v_fma_mix_f32 v228, v139, v139, v228 op_sel_hi:[1,1,0]
v_cvt_pkrtz_f16_f32 v153, v154, v155
v_lshrrev_b64 v[152:153], 2, v[152:153]
ds_read_u16 v151, v151
ds_read_u16 v149, v149
v_and_b32_sdwa v154, s47, v152 dst_sel:DWORD dst_unused:UNUSED_PAD src0_sel:DWORD src1_sel:WORD_1
v_and_b32_e64 v152, s47, v152
v_exp_f16_sdwa v159, v159 dst_sel:WORD_1 dst_unused:UNUSED_PRESERVE src0_sel:WORD_1
v_mfma_f32_32x32x16_bf16 v[96:111], v[40:43], v[184:187], v[96:111]
ds_read_u16 v154, v154
ds_read_u16 v152, v152
ds_read_b128 v[180:183], v250 offset:37888
v_and_b32_sdwa v155, s47, v153 dst_sel:DWORD dst_unused:UNUSED_PAD src0_sel:DWORD src1_sel:WORD_1
v_and_b32_e64 v153, s47, v153
v_pk_add_f16 v157, v157, 1.0 op_sel_hi:[1,0]
v_pk_add_f16 v159, v159, 1.0 op_sel_hi:[1,0]
v_rcp_f16_sdwa v157, v157 dst_sel:WORD_0 dst_unused:UNUSED_PRESERVE src0_sel:WORD_0
v_mfma_f32_32x32x16_bf16 v[160:175], v[20:23], v[188:191], v[160:175]
ds_read_u16 v155, v155
ds_read_u16 v153, v153
v_rcp_f16_sdwa v159, v159 dst_sel:WORD_0 dst_unused:UNUSED_PRESERVE src0_sel:WORD_0
v_rcp_f16_sdwa v157, v157 dst_sel:WORD_1 dst_unused:UNUSED_PRESERVE src0_sel:WORD_1
v_rcp_f16_sdwa v159, v159 dst_sel:WORD_1 dst_unused:UNUSED_PRESERVE src0_sel:WORD_1
v_mfma_f32_32x32x16_bf16 v[96:111], v[44:47], v[188:191], v[96:111]
ds_read_b128 v[184:187], v250 offset:38912
v_pk_mul_f16 v156, v156, v157
v_pk_mul_f16 v158, v158, v159
v_fma_mix_f32 v228, v156, v156, v228 op_sel_hi:[1,1,0]
buffer_store_dwordx4 v[0:3], v250, s[32:35], s80 offen sc1
v_fma_mix_f32 v228, v158, v158, v228 op_sel_hi:[1,1,0]
s_waitcnt lgkmcnt(7)
v_mfma_f32_32x32x16_bf16 v[112:127], v[0:3], v[176:179], 0
v_fma_mix_f32 v228, v156, v156, v228 op_sel:[1,1,0] op_sel_hi:[1,1,0]
v_cvt_pkrtz_f16_f32 v160, v160, v161
v_fma_mix_f32 v228, v158, v158, v228 op_sel:[1,1,0] op_sel_hi:[1,1,0]
v_cvt_pkrtz_f16_f32 v161, v162, v163
v_fma_mix_f32 v228, v144, v144, v228 op_sel_hi:[1,1,0]
v_lshrrev_b64 v[160:161], 2, v[160:161]
v_fma_mix_f32 v228, v145, v145, v228 op_sel_hi:[1,1,0]
v_and_b32_sdwa v162, s47, v160 dst_sel:DWORD dst_unused:UNUSED_PAD src0_sel:DWORD src1_sel:WORD_1
v_fma_mix_f32 v228, v146, v146, v228 op_sel_hi:[1,1,0]
v_and_b32 v160, s47, v160
v_fma_mix_f32 v228, v147, v147, v228 op_sel_hi:[1,1,0]
v_cvt_pk_f16_f32 v172, v172, v173
v_cvt_pk_f16_f32 v174, v174, v175
v_pk_fma_f16 v173, v172, v172, s48
v_mfma_f32_32x32x16_bf16 v[128:143], v[24:27], v[176:179], 0
ds_read_u16 v162, v162
ds_read_u16 v160, v160
v_fma_mix_f32 v228, v148, v148, v228 op_sel_hi:[1,1,0]
v_and_b32_sdwa v163, s47, v161 dst_sel:DWORD dst_unused:UNUSED_PAD src0_sel:DWORD src1_sel:WORD_1
s_waitcnt lgkmcnt(5)
v_fma_mix_f32 v228, v149, v149, v228 op_sel_hi:[1,1,0]
v_and_b32 v161, s47, v161
v_pk_fma_f16 v175, v174, v174, s48
v_pk_mul_f16 v173, v172, v173
v_pk_mul_f16 v175, v174, v175
v_fma_mix_f32 v228, v150, v150, v228 op_sel_hi:[1,1,0]
v_cvt_pkrtz_f16_f32 v164, v164, v165
v_fma_mix_f32 v228, v151, v151, v228 op_sel_hi:[1,1,0]
ds_read_u16 v163, v163
ds_read_u16 v161, v161
ds_read_b128 v[188:191], v250 offset:39936
v_cvt_pkrtz_f16_f32 v165, v166, v167
v_lshrrev_b64 v[164:165], 2, v[164:165]
v_and_b32_sdwa v166, s47, v164 dst_sel:DWORD dst_unused:UNUSED_PAD src0_sel:DWORD src1_sel:WORD_1
v_and_b32_e64 v164, s47, v164
v_exp_f16_sdwa v173, v173 dst_sel:WORD_0 dst_unused:UNUSED_PRESERVE src0_sel:WORD_0
v_mfma_f32_32x32x16_bf16 v[112:127], v[4:7], v[180:183], v[112:127]
ds_read_u16 v166, v166
ds_read_u16 v164, v164
v_fma_mix_f32 v228, v152, v152, v228 op_sel_hi:[1,1,0]
v_exp_f16_sdwa v175, v175 dst_sel:WORD_0 dst_unused:UNUSED_PRESERVE src0_sel:WORD_0
s_waitcnt lgkmcnt(7)
v_fma_mix_f32 v228, v153, v153, v228 op_sel_hi:[1,1,0]
v_and_b32_sdwa v167, s47, v165 dst_sel:DWORD dst_unused:UNUSED_PAD src0_sel:DWORD src1_sel:WORD_1
v_and_b32 v165, s47, v165
v_exp_f16_sdwa v173, v173 dst_sel:WORD_1 dst_unused:UNUSED_PRESERVE src0_sel:WORD_1
v_fma_mix_f32 v228, v154, v154, v228 op_sel_hi:[1,1,0]
v_cvt_pkrtz_f16_f32 v168, v168, v169
v_fma_mix_f32 v228, v155, v155, v228 op_sel_hi:[1,1,0]
v_cvt_pkrtz_f16_f32 v169, v170, v171
v_lshrrev_b64 v[168:169], 2, v[168:169]
ds_read_u16 v167, v167
ds_read_u16 v165, v165
v_and_b32_sdwa v170, s47, v168 dst_sel:DWORD dst_unused:UNUSED_PAD src0_sel:DWORD src1_sel:WORD_1
v_and_b32_e64 v168, s47, v168
v_exp_f16_sdwa v175, v175 dst_sel:WORD_1 dst_unused:UNUSED_PRESERVE src0_sel:WORD_1
v_mfma_f32_32x32x16_bf16 v[128:143], v[28:31], v[180:183], v[128:143]
ds_read_u16 v170, v170
ds_read_u16 v168, v168
ds_read_b128 v[176:179], v250 offset:40960
v_and_b32_sdwa v171, s47, v169 dst_sel:DWORD dst_unused:UNUSED_PAD src0_sel:DWORD src1_sel:WORD_1
v_and_b32_e64 v169, s47, v169
v_pk_add_f16 v173, v173, 1.0 op_sel_hi:[1,0]
v_pk_add_f16 v175, v175, 1.0 op_sel_hi:[1,0]
v_rcp_f16_sdwa v173, v173 dst_sel:WORD_0 dst_unused:UNUSED_PRESERVE src0_sel:WORD_0
v_mfma_f32_32x32x16_bf16 v[112:127], v[8:11], v[184:187], v[112:127]
ds_read_u16 v171, v171
ds_read_u16 v169, v169
v_rcp_f16_sdwa v175, v175 dst_sel:WORD_0 dst_unused:UNUSED_PRESERVE src0_sel:WORD_0
v_rcp_f16_sdwa v173, v173 dst_sel:WORD_1 dst_unused:UNUSED_PRESERVE src0_sel:WORD_1
v_rcp_f16_sdwa v175, v175 dst_sel:WORD_1 dst_unused:UNUSED_PRESERVE src0_sel:WORD_1
v_mfma_f32_32x32x16_bf16 v[128:143], v[32:35], v[184:187], v[128:143]
ds_read_b128 v[180:183], v250 offset:41984
v_pk_mul_f16 v172, v172, v173
v_pk_mul_f16 v174, v174, v175
v_fma_mix_f32 v229, v172, v172, v229 op_sel_hi:[1,1,0]
v_cvt_pkrtz_f16_f32 v96, v96, v97
v_fma_mix_f32 v229, v174, v174, v229 op_sel_hi:[1,1,0]
s_waitcnt lgkmcnt(7)
v_mfma_f32_32x32x16_bf16 v[112:127], v[12:15], v[188:191], v[112:127]
v_fma_mix_f32 v229, v172, v172, v229 op_sel:[1,1,0] op_sel_hi:[1,1,0]
v_cvt_pkrtz_f16_f32 v97, v98, v99
v_fma_mix_f32 v229, v174, v174, v229 op_sel:[1,1,0] op_sel_hi:[1,1,0]
v_lshrrev_b64 v[96:97], 2, v[96:97]
v_fma_mix_f32 v229, v160, v160, v229 op_sel_hi:[1,1,0]
v_and_b32_sdwa v98, s47, v96 dst_sel:DWORD dst_unused:UNUSED_PAD src0_sel:DWORD src1_sel:WORD_1
v_fma_mix_f32 v229, v161, v161, v229 op_sel_hi:[1,1,0]
v_and_b32 v96, s47, v96
v_fma_mix_f32 v229, v162, v162, v229 op_sel_hi:[1,1,0]
v_cvt_pk_f16_f32 v108, v108, v109
v_fma_mix_f32 v229, v163, v163, v229 op_sel_hi:[1,1,0]
v_cvt_pk_f16_f32 v110, v110, v111
v_pk_fma_f16 v109, v108, v108, s48
v_mfma_f32_32x32x16_bf16 v[128:143], v[36:39], v[188:191], v[128:143]
ds_read_u16 v98, v98
ds_read_u16 v96, v96
v_fma_mix_f32 v229, v164, v164, v229 op_sel_hi:[1,1,0]
v_and_b32_sdwa v99, s47, v97 dst_sel:DWORD dst_unused:UNUSED_PAD src0_sel:DWORD src1_sel:WORD_1
s_waitcnt lgkmcnt(5)
v_fma_mix_f32 v229, v165, v165, v229 op_sel_hi:[1,1,0]
v_and_b32 v97, s47, v97
v_pk_fma_f16 v111, v110, v110, s48
v_pk_mul_f16 v109, v108, v109
v_pk_mul_f16 v111, v110, v111
v_fma_mix_f32 v229, v166, v166, v229 op_sel_hi:[1,1,0]
v_cvt_pkrtz_f16_f32 v100, v100, v101
v_fma_mix_f32 v229, v167, v167, v229 op_sel_hi:[1,1,0]
ds_read_u16 v99, v99
ds_read_u16 v97, v97
s_add_u32 s46, s80, 2097152
buffer_store_dwordx4 v[4:7], v250, s[32:35], s46 offen sc1
ds_read_b128 v[184:187], v250 offset:43008
v_cvt_pkrtz_f16_f32 v101, v102, v103
v_lshrrev_b64 v[100:101], 2, v[100:101]
v_and_b32_sdwa v102, s47, v100 dst_sel:DWORD dst_unused:UNUSED_PAD src0_sel:DWORD src1_sel:WORD_1
v_and_b32_e64 v100, s47, v100
v_exp_f16_sdwa v109, v109 dst_sel:WORD_0 dst_unused:UNUSED_PRESERVE src0_sel:WORD_0
v_mfma_f32_32x32x16_bf16 v[112:127], v[16:19], v[176:179], v[112:127]
ds_read_u16 v102, v102
ds_read_u16 v100, v100
v_fma_mix_f32 v229, v168, v168, v229 op_sel_hi:[1,1,0]
v_exp_f16_sdwa v111, v111 dst_sel:WORD_0 dst_unused:UNUSED_PRESERVE src0_sel:WORD_0
s_waitcnt lgkmcnt(7)
v_fma_mix_f32 v229, v169, v169, v229 op_sel_hi:[1,1,0]
v_and_b32_sdwa v103, s47, v101 dst_sel:DWORD dst_unused:UNUSED_PAD src0_sel:DWORD src1_sel:WORD_1
v_and_b32 v101, s47, v101
v_exp_f16_sdwa v109, v109 dst_sel:WORD_1 dst_unused:UNUSED_PRESERVE src0_sel:WORD_1
v_fma_mix_f32 v229, v170, v170, v229 op_sel_hi:[1,1,0]
v_cvt_pkrtz_f16_f32 v104, v104, v105
v_fma_mix_f32 v229, v171, v171, v229 op_sel_hi:[1,1,0]
v_cvt_pkrtz_f16_f32 v105, v106, v107
v_lshrrev_b64 v[104:105], 2, v[104:105]
ds_read_u16 v103, v103
ds_read_u16 v101, v101
v_and_b32_sdwa v106, s47, v104 dst_sel:DWORD dst_unused:UNUSED_PAD src0_sel:DWORD src1_sel:WORD_1
v_and_b32_e64 v104, s47, v104
v_exp_f16_sdwa v111, v111 dst_sel:WORD_1 dst_unused:UNUSED_PRESERVE src0_sel:WORD_1
v_mfma_f32_32x32x16_bf16 v[128:143], v[40:43], v[176:179], v[128:143]
ds_read_u16 v106, v106
ds_read_u16 v104, v104
ds_read_b128 v[188:191], v250 offset:44032
v_and_b32_sdwa v107, s47, v105 dst_sel:DWORD dst_unused:UNUSED_PAD src0_sel:DWORD src1_sel:WORD_1
v_and_b32_e64 v105, s47, v105
v_pk_add_f16 v109, v109, 1.0 op_sel_hi:[1,0]
v_pk_add_f16 v111, v111, 1.0 op_sel_hi:[1,0]
v_rcp_f16_sdwa v109, v109 dst_sel:WORD_0 dst_unused:UNUSED_PRESERVE src0_sel:WORD_0
v_mfma_f32_32x32x16_bf16 v[112:127], v[20:23], v[180:183], v[112:127]
ds_read_u16 v107, v107
ds_read_u16 v105, v105
v_rcp_f16_sdwa v111, v111 dst_sel:WORD_0 dst_unused:UNUSED_PRESERVE src0_sel:WORD_0
v_rcp_f16_sdwa v109, v109 dst_sel:WORD_1 dst_unused:UNUSED_PRESERVE src0_sel:WORD_1
v_rcp_f16_sdwa v111, v111 dst_sel:WORD_1 dst_unused:UNUSED_PRESERVE src0_sel:WORD_1
v_mfma_f32_32x32x16_bf16 v[128:143], v[44:47], v[180:183], v[128:143]
ds_read_b128 v[176:179], v250 offset:45056
v_pk_mul_f16 v108, v108, v109
v_pk_mul_f16 v110, v110, v111
v_fma_mix_f32 v229, v108, v108, v229 op_sel_hi:[1,1,0]
s_nop 1
v_cvt_pkrtz_f16_f32 v112, v112, v113
v_fma_mix_f32 v229, v110, v110, v229 op_sel_hi:[1,1,0]
s_waitcnt lgkmcnt(7)
v_mfma_f32_32x32x16_bf16 v[144:159], v[0:3], v[184:187], 0
v_fma_mix_f32 v229, v108, v108, v229 op_sel:[1,1,0] op_sel_hi:[1,1,0]
v_cvt_pkrtz_f16_f32 v113, v114, v115
v_fma_mix_f32 v229, v110, v110, v229 op_sel:[1,1,0] op_sel_hi:[1,1,0]
v_lshrrev_b64 v[112:113], 2, v[112:113]
v_fma_mix_f32 v229, v96, v96, v229 op_sel_hi:[1,1,0]
v_and_b32_sdwa v114, s47, v112 dst_sel:DWORD dst_unused:UNUSED_PAD src0_sel:DWORD src1_sel:WORD_1
v_fma_mix_f32 v229, v97, v97, v229 op_sel_hi:[1,1,0]
v_and_b32_e64 v112, s47, v112
v_fma_mix_f32 v229, v98, v98, v229 op_sel_hi:[1,1,0]
v_cvt_pk_f16_f32 v124, v124, v125
v_fma_mix_f32 v229, v99, v99, v229 op_sel_hi:[1,1,0]
v_cvt_pk_f16_f32 v126, v126, v127
v_pk_fma_f16 v125, v124, v124, s48
v_mfma_f32_32x32x16_bf16 v[160:175], v[24:27], v[184:187], 0
ds_read_u16 v114, v114
ds_read_u16 v112, v112
v_fma_mix_f32 v229, v100, v100, v229 op_sel_hi:[1,1,0]
v_and_b32_sdwa v115, s47, v113 dst_sel:DWORD dst_unused:UNUSED_PAD src0_sel:DWORD src1_sel:WORD_1
s_waitcnt lgkmcnt(5)
v_fma_mix_f32 v229, v101, v101, v229 op_sel_hi:[1,1,0]
v_and_b32 v113, s47, v113
v_pk_fma_f16 v127, v126, v126, s48
v_pk_mul_f16 v125, v124, v125
v_pk_mul_f16 v127, v126, v127
v_fma_mix_f32 v229, v102, v102, v229 op_sel_hi:[1,1,0]
v_cvt_pkrtz_f16_f32 v116, v116, v117
v_fma_mix_f32 v229, v103, v103, v229 op_sel_hi:[1,1,0]
ds_read_u16 v115, v115
ds_read_u16 v113, v113
ds_read_b128 v[180:183], v250 offset:46080
v_cvt_pkrtz_f16_f32 v117, v118, v119
v_lshrrev_b64 v[116:117], 2, v[116:117]
v_and_b32_sdwa v118, s47, v116 dst_sel:DWORD dst_unused:UNUSED_PAD src0_sel:DWORD src1_sel:WORD_1
v_and_b32_e64 v116, s47, v116
v_exp_f16_sdwa v125, v125 dst_sel:WORD_0 dst_unused:UNUSED_PRESERVE src0_sel:WORD_0
v_mfma_f32_32x32x16_bf16 v[144:159], v[4:7], v[188:191], v[144:159]
ds_read_u16 v118, v118
ds_read_u16 v116, v116
v_fma_mix_f32 v229, v104, v104, v229 op_sel_hi:[1,1,0]
v_exp_f16_sdwa v127, v127 dst_sel:WORD_0 dst_unused:UNUSED_PRESERVE src0_sel:WORD_0
s_waitcnt lgkmcnt(7)
v_fma_mix_f32 v229, v105, v105, v229 op_sel_hi:[1,1,0]
v_and_b32_sdwa v119, s47, v117 dst_sel:DWORD dst_unused:UNUSED_PAD src0_sel:DWORD src1_sel:WORD_1
v_and_b32 v117, s47, v117
v_exp_f16_sdwa v125, v125 dst_sel:WORD_1 dst_unused:UNUSED_PRESERVE src0_sel:WORD_1
v_fma_mix_f32 v229, v106, v106, v229 op_sel_hi:[1,1,0]
v_cvt_pkrtz_f16_f32 v120, v120, v121
v_fma_mix_f32 v229, v107, v107, v229 op_sel_hi:[1,1,0]
v_cvt_pkrtz_f16_f32 v121, v122, v123
v_lshrrev_b64 v[120:121], 2, v[120:121]
ds_read_u16 v119, v119
ds_read_u16 v117, v117
s_add_u32 s46, s80, 4194304
buffer_store_dwordx4 v[8:11], v250, s[32:35], s46 offen sc1
v_and_b32_sdwa v122, s47, v120 dst_sel:DWORD dst_unused:UNUSED_PAD src0_sel:DWORD src1_sel:WORD_1
v_and_b32_e64 v120, s47, v120
v_exp_f16_sdwa v127, v127 dst_sel:WORD_1 dst_unused:UNUSED_PRESERVE src0_sel:WORD_1
v_mfma_f32_32x32x16_bf16 v[160:175], v[28:31], v[188:191], v[160:175]
ds_read_u16 v122, v122
ds_read_u16 v120, v120
ds_read_b128 v[184:187], v250 offset:47104
v_and_b32_sdwa v123, s47, v121 dst_sel:DWORD dst_unused:UNUSED_PAD src0_sel:DWORD src1_sel:WORD_1
v_and_b32_e64 v121, s47, v121
v_pk_add_f16 v125, v125, 1.0 op_sel_hi:[1,0]
v_pk_add_f16 v127, v127, 1.0 op_sel_hi:[1,0]
v_rcp_f16_sdwa v125, v125 dst_sel:WORD_0 dst_unused:UNUSED_PRESERVE src0_sel:WORD_0
v_mfma_f32_32x32x16_bf16 v[144:159], v[8:11], v[176:179], v[144:159]
ds_read_u16 v123, v123
ds_read_u16 v121, v121
v_rcp_f16_sdwa v127, v127 dst_sel:WORD_0 dst_unused:UNUSED_PRESERVE src0_sel:WORD_0
v_rcp_f16_sdwa v125, v125 dst_sel:WORD_1 dst_unused:UNUSED_PRESERVE src0_sel:WORD_1
v_rcp_f16_sdwa v127, v127 dst_sel:WORD_1 dst_unused:UNUSED_PRESERVE src0_sel:WORD_1
v_mfma_f32_32x32x16_bf16 v[160:175], v[32:35], v[176:179], v[160:175]
ds_read_b128 v[188:191], v250 offset:48128
v_pk_mul_f16 v124, v124, v125
v_pk_mul_f16 v126, v126, v127
v_fma_mix_f32 v230, v124, v124, v230 op_sel_hi:[1,1,0]
v_cvt_pkrtz_f16_f32 v128, v128, v129
v_fma_mix_f32 v230, v126, v126, v230 op_sel_hi:[1,1,0]
s_waitcnt lgkmcnt(7)
v_mfma_f32_32x32x16_bf16 v[144:159], v[12:15], v[180:183], v[144:159]
v_fma_mix_f32 v230, v124, v124, v230 op_sel:[1,1,0] op_sel_hi:[1,1,0]
v_cvt_pkrtz_f16_f32 v129, v130, v131
v_fma_mix_f32 v230, v126, v126, v230 op_sel:[1,1,0] op_sel_hi:[1,1,0]
v_lshrrev_b64 v[128:129], 2, v[128:129]
v_fma_mix_f32 v230, v112, v112, v230 op_sel_hi:[1,1,0]
v_and_b32_sdwa v130, s47, v128 dst_sel:DWORD dst_unused:UNUSED_PAD src0_sel:DWORD src1_sel:WORD_1
v_fma_mix_f32 v230, v113, v113, v230 op_sel_hi:[1,1,0]
v_and_b32 v128, s47, v128
v_fma_mix_f32 v230, v114, v114, v230 op_sel_hi:[1,1,0]
v_cvt_pk_f16_f32 v140, v140, v141
v_fma_mix_f32 v230, v115, v115, v230 op_sel_hi:[1,1,0]
v_cvt_pk_f16_f32 v142, v142, v143
v_pk_fma_f16 v141, v140, v140, s48
v_mfma_f32_32x32x16_bf16 v[160:175], v[36:39], v[180:183], v[160:175]
ds_read_u16 v130, v130
ds_read_u16 v128, v128
v_fma_mix_f32 v230, v116, v116, v230 op_sel_hi:[1,1,0]
v_and_b32_sdwa v131, s47, v129 dst_sel:DWORD dst_unused:UNUSED_PAD src0_sel:DWORD src1_sel:WORD_1
s_waitcnt lgkmcnt(5)
v_fma_mix_f32 v230, v117, v117, v230 op_sel_hi:[1,1,0]
v_and_b32 v129, s47, v129
v_pk_fma_f16 v143, v142, v142, s48
v_pk_mul_f16 v141, v140, v141
v_pk_mul_f16 v143, v142, v143
v_fma_mix_f32 v230, v118, v118, v230 op_sel_hi:[1,1,0]
v_cvt_pkrtz_f16_f32 v132, v132, v133
v_fma_mix_f32 v230, v119, v119, v230 op_sel_hi:[1,1,0]
ds_read_u16 v131, v131
ds_read_u16 v129, v129
ds_read_b128 v[176:179], v250 offset:49152
v_cvt_pkrtz_f16_f32 v133, v134, v135
v_lshrrev_b64 v[132:133], 2, v[132:133]
v_and_b32_sdwa v134, s47, v132 dst_sel:DWORD dst_unused:UNUSED_PAD src0_sel:DWORD src1_sel:WORD_1
v_and_b32_e64 v132, s47, v132
v_exp_f16_sdwa v141, v141 dst_sel:WORD_0 dst_unused:UNUSED_PRESERVE src0_sel:WORD_0
v_mfma_f32_32x32x16_bf16 v[144:159], v[16:19], v[184:187], v[144:159]
ds_read_u16 v134, v134
ds_read_u16 v132, v132
v_fma_mix_f32 v230, v120, v120, v230 op_sel_hi:[1,1,0]
v_exp_f16_sdwa v143, v143 dst_sel:WORD_0 dst_unused:UNUSED_PRESERVE src0_sel:WORD_0
s_waitcnt lgkmcnt(7)
v_fma_mix_f32 v230, v121, v121, v230 op_sel_hi:[1,1,0]
v_and_b32_sdwa v135, s47, v133 dst_sel:DWORD dst_unused:UNUSED_PAD src0_sel:DWORD src1_sel:WORD_1
v_and_b32 v133, s47, v133
v_exp_f16_sdwa v141, v141 dst_sel:WORD_1 dst_unused:UNUSED_PRESERVE src0_sel:WORD_1
v_fma_mix_f32 v230, v122, v122, v230 op_sel_hi:[1,1,0]
v_cvt_pkrtz_f16_f32 v136, v136, v137
v_fma_mix_f32 v230, v123, v123, v230 op_sel_hi:[1,1,0]
v_cvt_pkrtz_f16_f32 v137, v138, v139
v_lshrrev_b64 v[136:137], 2, v[136:137]
ds_read_u16 v135, v135
ds_read_u16 v133, v133
v_and_b32_sdwa v138, s47, v136 dst_sel:DWORD dst_unused:UNUSED_PAD src0_sel:DWORD src1_sel:WORD_1
v_and_b32_e64 v136, s47, v136
v_exp_f16_sdwa v143, v143 dst_sel:WORD_1 dst_unused:UNUSED_PRESERVE src0_sel:WORD_1
v_mfma_f32_32x32x16_bf16 v[160:175], v[40:43], v[184:187], v[160:175]
ds_read_u16 v138, v138
ds_read_u16 v136, v136
ds_read_b128 v[180:183], v250 offset:50176
v_and_b32_sdwa v139, s47, v137 dst_sel:DWORD dst_unused:UNUSED_PAD src0_sel:DWORD src1_sel:WORD_1
v_and_b32_e64 v137, s47, v137
v_pk_add_f16 v141, v141, 1.0 op_sel_hi:[1,0]
v_pk_add_f16 v143, v143, 1.0 op_sel_hi:[1,0]
v_rcp_f16_sdwa v141, v141 dst_sel:WORD_0 dst_unused:UNUSED_PRESERVE src0_sel:WORD_0
v_mfma_f32_32x32x16_bf16 v[144:159], v[20:23], v[188:191], v[144:159]
ds_read_u16 v139, v139
ds_read_u16 v137, v137
s_add_u32 s46, s80, 6291456
buffer_store_dwordx4 v[12:15], v250, s[32:35], s46 offen sc1
v_rcp_f16_sdwa v143, v143 dst_sel:WORD_0 dst_unused:UNUSED_PRESERVE src0_sel:WORD_0
v_rcp_f16_sdwa v141, v141 dst_sel:WORD_1 dst_unused:UNUSED_PRESERVE src0_sel:WORD_1
v_rcp_f16_sdwa v143, v143 dst_sel:WORD_1 dst_unused:UNUSED_PRESERVE src0_sel:WORD_1
v_mfma_f32_32x32x16_bf16 v[160:175], v[44:47], v[188:191], v[160:175]
ds_read_b128 v[184:187], v250 offset:51200
v_pk_mul_f16 v140, v140, v141
v_pk_mul_f16 v142, v142, v143
v_fma_mix_f32 v230, v140, v140, v230 op_sel_hi:[1,1,0]
v_cvt_pkrtz_f16_f32 v144, v144, v145
v_fma_mix_f32 v230, v142, v142, v230 op_sel_hi:[1,1,0]
s_waitcnt lgkmcnt(7)
v_mfma_f32_32x32x16_bf16 v[96:111], v[0:3], v[176:179], 0
v_fma_mix_f32 v230, v140, v140, v230 op_sel:[1,1,0] op_sel_hi:[1,1,0]
v_cvt_pkrtz_f16_f32 v145, v146, v147
v_fma_mix_f32 v230, v142, v142, v230 op_sel:[1,1,0] op_sel_hi:[1,1,0]
v_lshrrev_b64 v[144:145], 2, v[144:145]
v_fma_mix_f32 v230, v128, v128, v230 op_sel_hi:[1,1,0]
v_and_b32_sdwa v146, s47, v144 dst_sel:DWORD dst_unused:UNUSED_PAD src0_sel:DWORD src1_sel:WORD_1
v_fma_mix_f32 v230, v129, v129, v230 op_sel_hi:[1,1,0]
v_and_b32 v144, s47, v144
v_fma_mix_f32 v230, v130, v130, v230 op_sel_hi:[1,1,0]
v_cvt_pk_f16_f32 v156, v156, v157
v_fma_mix_f32 v230, v131, v131, v230 op_sel_hi:[1,1,0]
v_cvt_pk_f16_f32 v158, v158, v159
v_pk_fma_f16 v157, v156, v156, s48
v_mfma_f32_32x32x16_bf16 v[112:127], v[24:27], v[176:179], 0
ds_read_u16 v146, v146
ds_read_u16 v144, v144
v_fma_mix_f32 v230, v132, v132, v230 op_sel_hi:[1,1,0]
v_and_b32_sdwa v147, s47, v145 dst_sel:DWORD dst_unused:UNUSED_PAD src0_sel:DWORD src1_sel:WORD_1
s_waitcnt lgkmcnt(5)
v_fma_mix_f32 v230, v133, v133, v230 op_sel_hi:[1,1,0]
v_and_b32 v145, s47, v145
v_pk_fma_f16 v159, v158, v158, s48
v_pk_mul_f16 v157, v156, v157
v_pk_mul_f16 v159, v158, v159
v_fma_mix_f32 v230, v134, v134, v230 op_sel_hi:[1,1,0]
v_cvt_pkrtz_f16_f32 v148, v148, v149
v_fma_mix_f32 v230, v135, v135, v230 op_sel_hi:[1,1,0]
ds_read_u16 v147, v147
ds_read_u16 v145, v145
ds_read_b128 v[188:191], v250 offset:52224
v_cvt_pkrtz_f16_f32 v149, v150, v151
v_lshrrev_b64 v[148:149], 2, v[148:149]
v_and_b32_sdwa v150, s47, v148 dst_sel:DWORD dst_unused:UNUSED_PAD src0_sel:DWORD src1_sel:WORD_1
v_and_b32_e64 v148, s47, v148
v_exp_f16_sdwa v157, v157 dst_sel:WORD_0 dst_unused:UNUSED_PRESERVE src0_sel:WORD_0
v_mfma_f32_32x32x16_bf16 v[96:111], v[4:7], v[180:183], v[96:111]
ds_read_u16 v150, v150
ds_read_u16 v148, v148
v_fma_mix_f32 v230, v136, v136, v230 op_sel_hi:[1,1,0]
v_exp_f16_sdwa v159, v159 dst_sel:WORD_0 dst_unused:UNUSED_PRESERVE src0_sel:WORD_0
s_waitcnt lgkmcnt(7)
v_fma_mix_f32 v230, v137, v137, v230 op_sel_hi:[1,1,0]
v_and_b32_sdwa v151, s47, v149 dst_sel:DWORD dst_unused:UNUSED_PAD src0_sel:DWORD src1_sel:WORD_1
v_and_b32 v149, s47, v149
v_exp_f16_sdwa v157, v157 dst_sel:WORD_1 dst_unused:UNUSED_PRESERVE src0_sel:WORD_1
v_fma_mix_f32 v230, v138, v138, v230 op_sel_hi:[1,1,0]
v_cvt_pkrtz_f16_f32 v152, v152, v153
v_fma_mix_f32 v230, v139, v139, v230 op_sel_hi:[1,1,0]
v_cvt_pkrtz_f16_f32 v153, v154, v155
v_lshrrev_b64 v[152:153], 2, v[152:153]
ds_read_u16 v151, v151
ds_read_u16 v149, v149
v_and_b32_sdwa v154, s47, v152 dst_sel:DWORD dst_unused:UNUSED_PAD src0_sel:DWORD src1_sel:WORD_1
v_and_b32_e64 v152, s47, v152
v_exp_f16_sdwa v159, v159 dst_sel:WORD_1 dst_unused:UNUSED_PRESERVE src0_sel:WORD_1
v_mfma_f32_32x32x16_bf16 v[112:127], v[28:31], v[180:183], v[112:127]
ds_read_u16 v154, v154
ds_read_u16 v152, v152
ds_read_b128 v[176:179], v250 offset:53248
v_and_b32_sdwa v155, s47, v153 dst_sel:DWORD dst_unused:UNUSED_PAD src0_sel:DWORD src1_sel:WORD_1
v_and_b32_e64 v153, s47, v153
v_pk_add_f16 v157, v157, 1.0 op_sel_hi:[1,0]
v_pk_add_f16 v159, v159, 1.0 op_sel_hi:[1,0]
v_rcp_f16_sdwa v157, v157 dst_sel:WORD_0 dst_unused:UNUSED_PRESERVE src0_sel:WORD_0
v_mfma_f32_32x32x16_bf16 v[96:111], v[8:11], v[184:187], v[96:111]
ds_read_u16 v155, v155
ds_read_u16 v153, v153
v_rcp_f16_sdwa v159, v159 dst_sel:WORD_0 dst_unused:UNUSED_PRESERVE src0_sel:WORD_0
v_rcp_f16_sdwa v157, v157 dst_sel:WORD_1 dst_unused:UNUSED_PRESERVE src0_sel:WORD_1
s_add_u32 s46, s80, 8388608
buffer_store_dwordx4 v[16:19], v250, s[32:35], s46 offen sc1
v_rcp_f16_sdwa v159, v159 dst_sel:WORD_1 dst_unused:UNUSED_PRESERVE src0_sel:WORD_1
v_mfma_f32_32x32x16_bf16 v[112:127], v[32:35], v[184:187], v[112:127]
ds_read_b128 v[180:183], v250 offset:54272
v_pk_mul_f16 v156, v156, v157
v_pk_mul_f16 v158, v158, v159
v_fma_mix_f32 v231, v156, v156, v231 op_sel_hi:[1,1,0]
v_cvt_pkrtz_f16_f32 v160, v160, v161
v_fma_mix_f32 v231, v158, v158, v231 op_sel_hi:[1,1,0]
s_waitcnt lgkmcnt(7)
v_mfma_f32_32x32x16_bf16 v[96:111], v[12:15], v[188:191], v[96:111]
v_fma_mix_f32 v231, v156, v156, v231 op_sel:[1,1,0] op_sel_hi:[1,1,0]
v_cvt_pkrtz_f16_f32 v161, v162, v163
v_fma_mix_f32 v231, v158, v158, v231 op_sel:[1,1,0] op_sel_hi:[1,1,0]
v_lshrrev_b64 v[160:161], 2, v[160:161]
v_fma_mix_f32 v231, v144, v144, v231 op_sel_hi:[1,1,0]
v_and_b32_sdwa v162, s47, v160 dst_sel:DWORD dst_unused:UNUSED_PAD src0_sel:DWORD src1_sel:WORD_1
v_fma_mix_f32 v231, v145, v145, v231 op_sel_hi:[1,1,0]
v_and_b32 v160, s47, v160
v_fma_mix_f32 v231, v146, v146, v231 op_sel_hi:[1,1,0]
v_cvt_pk_f16_f32 v172, v172, v173
v_fma_mix_f32 v231, v147, v147, v231 op_sel_hi:[1,1,0]
v_cvt_pk_f16_f32 v174, v174, v175
v_pk_fma_f16 v173, v172, v172, s48
v_mfma_f32_32x32x16_bf16 v[112:127], v[36:39], v[188:191], v[112:127]
ds_read_u16 v162, v162
ds_read_u16 v160, v160
v_fma_mix_f32 v231, v148, v148, v231 op_sel_hi:[1,1,0]
v_and_b32_sdwa v163, s47, v161 dst_sel:DWORD dst_unused:UNUSED_PAD src0_sel:DWORD src1_sel:WORD_1
s_waitcnt lgkmcnt(5)
v_fma_mix_f32 v231, v149, v149, v231 op_sel_hi:[1,1,0]
v_and_b32 v161, s47, v161
v_pk_fma_f16 v175, v174, v174, s48
v_pk_mul_f16 v173, v172, v173
v_pk_mul_f16 v175, v174, v175
v_fma_mix_f32 v231, v150, v150, v231 op_sel_hi:[1,1,0]
v_cvt_pkrtz_f16_f32 v164, v164, v165
v_fma_mix_f32 v231, v151, v151, v231 op_sel_hi:[1,1,0]
ds_read_u16 v163, v163
ds_read_u16 v161, v161
ds_read_b128 v[184:187], v250 offset:55296
v_cvt_pkrtz_f16_f32 v165, v166, v167
v_lshrrev_b64 v[164:165], 2, v[164:165]
v_and_b32_sdwa v166, s47, v164 dst_sel:DWORD dst_unused:UNUSED_PAD src0_sel:DWORD src1_sel:WORD_1
v_and_b32_e64 v164, s47, v164
v_exp_f16_sdwa v173, v173 dst_sel:WORD_0 dst_unused:UNUSED_PRESERVE src0_sel:WORD_0
v_mfma_f32_32x32x16_bf16 v[96:111], v[16:19], v[176:179], v[96:111]
ds_read_u16 v166, v166
ds_read_u16 v164, v164
v_fma_mix_f32 v231, v152, v152, v231 op_sel_hi:[1,1,0]
v_exp_f16_sdwa v175, v175 dst_sel:WORD_0 dst_unused:UNUSED_PRESERVE src0_sel:WORD_0
s_waitcnt lgkmcnt(7)
v_fma_mix_f32 v231, v153, v153, v231 op_sel_hi:[1,1,0]
v_and_b32_sdwa v167, s47, v165 dst_sel:DWORD dst_unused:UNUSED_PAD src0_sel:DWORD src1_sel:WORD_1
v_and_b32 v165, s47, v165
v_exp_f16_sdwa v173, v173 dst_sel:WORD_1 dst_unused:UNUSED_PRESERVE src0_sel:WORD_1
v_fma_mix_f32 v231, v154, v154, v231 op_sel_hi:[1,1,0]
v_cvt_pkrtz_f16_f32 v168, v168, v169
v_fma_mix_f32 v231, v155, v155, v231 op_sel_hi:[1,1,0]
v_cvt_pkrtz_f16_f32 v169, v170, v171
v_lshrrev_b64 v[168:169], 2, v[168:169]
ds_read_u16 v167, v167
ds_read_u16 v165, v165
v_and_b32_sdwa v170, s47, v168 dst_sel:DWORD dst_unused:UNUSED_PAD src0_sel:DWORD src1_sel:WORD_1
v_and_b32_e64 v168, s47, v168
v_exp_f16_sdwa v175, v175 dst_sel:WORD_1 dst_unused:UNUSED_PRESERVE src0_sel:WORD_1
v_mfma_f32_32x32x16_bf16 v[112:127], v[40:43], v[176:179], v[112:127]
ds_read_u16 v170, v170
ds_read_u16 v168, v168
ds_read_b128 v[188:191], v250 offset:56320
v_and_b32_sdwa v171, s47, v169 dst_sel:DWORD dst_unused:UNUSED_PAD src0_sel:DWORD src1_sel:WORD_1
v_and_b32_e64 v169, s47, v169
v_pk_add_f16 v173, v173, 1.0 op_sel_hi:[1,0]
v_pk_add_f16 v175, v175, 1.0 op_sel_hi:[1,0]
v_rcp_f16_sdwa v173, v173 dst_sel:WORD_0 dst_unused:UNUSED_PRESERVE src0_sel:WORD_0
v_mfma_f32_32x32x16_bf16 v[96:111], v[20:23], v[180:183], v[96:111]
ds_read_u16 v171, v171
ds_read_u16 v169, v169
v_rcp_f16_sdwa v175, v175 dst_sel:WORD_0 dst_unused:UNUSED_PRESERVE src0_sel:WORD_0
v_rcp_f16_sdwa v173, v173 dst_sel:WORD_1 dst_unused:UNUSED_PRESERVE src0_sel:WORD_1
v_rcp_f16_sdwa v175, v175 dst_sel:WORD_1 dst_unused:UNUSED_PRESERVE src0_sel:WORD_1
v_mfma_f32_32x32x16_bf16 v[112:127], v[44:47], v[180:183], v[112:127]
ds_read_b128 v[176:179], v250 offset:57344
v_pk_mul_f16 v172, v172, v173
v_pk_mul_f16 v174, v174, v175
v_fma_mix_f32 v231, v172, v172, v231 op_sel_hi:[1,1,0]
s_add_u32 s46, s80, 10485760
buffer_store_dwordx4 v[20:23], v250, s[32:35], s46 offen sc1
v_fma_mix_f32 v231, v174, v174, v231 op_sel_hi:[1,1,0]
s_waitcnt lgkmcnt(7)
v_mfma_f32_32x32x16_bf16 v[128:143], v[0:3], v[184:187], 0
v_fma_mix_f32 v231, v172, v172, v231 op_sel:[1,1,0] op_sel_hi:[1,1,0]
v_cvt_pkrtz_f16_f32 v96, v96, v97
v_fma_mix_f32 v231, v174, v174, v231 op_sel:[1,1,0] op_sel_hi:[1,1,0]
v_cvt_pkrtz_f16_f32 v97, v98, v99
v_fma_mix_f32 v231, v160, v160, v231 op_sel_hi:[1,1,0]
v_lshrrev_b64 v[96:97], 2, v[96:97]
v_fma_mix_f32 v231, v161, v161, v231 op_sel_hi:[1,1,0]
v_and_b32_sdwa v98, s47, v96 dst_sel:DWORD dst_unused:UNUSED_PAD src0_sel:DWORD src1_sel:WORD_1
v_fma_mix_f32 v231, v162, v162, v231 op_sel_hi:[1,1,0]
v_and_b32 v96, s47, v96
v_fma_mix_f32 v231, v163, v163, v231 op_sel_hi:[1,1,0]
v_cvt_pk_f16_f32 v108, v108, v109
v_cvt_pk_f16_f32 v110, v110, v111
v_pk_fma_f16 v109, v108, v108, s48
v_mfma_f32_32x32x16_bf16 v[144:159], v[24:27], v[184:187], 0
ds_read_u16 v98, v98
ds_read_u16 v96, v96
v_fma_mix_f32 v231, v164, v164, v231 op_sel_hi:[1,1,0]
v_and_b32_sdwa v99, s47, v97 dst_sel:DWORD dst_unused:UNUSED_PAD src0_sel:DWORD src1_sel:WORD_1
s_waitcnt lgkmcnt(5)
v_fma_mix_f32 v231, v165, v165, v231 op_sel_hi:[1,1,0]
v_and_b32 v97, s47, v97
v_pk_fma_f16 v111, v110, v110, s48
v_pk_mul_f16 v109, v108, v109
v_pk_mul_f16 v111, v110, v111
v_fma_mix_f32 v231, v166, v166, v231 op_sel_hi:[1,1,0]
v_cvt_pkrtz_f16_f32 v100, v100, v101
v_fma_mix_f32 v231, v167, v167, v231 op_sel_hi:[1,1,0]
ds_read_u16 v99, v99
ds_read_u16 v97, v97
ds_read_b128 v[180:183], v250 offset:58368
v_cvt_pkrtz_f16_f32 v101, v102, v103
v_lshrrev_b64 v[100:101], 2, v[100:101]
v_and_b32_sdwa v102, s47, v100 dst_sel:DWORD dst_unused:UNUSED_PAD src0_sel:DWORD src1_sel:WORD_1
v_and_b32_e64 v100, s47, v100
v_exp_f16_sdwa v109, v109 dst_sel:WORD_0 dst_unused:UNUSED_PRESERVE src0_sel:WORD_0
v_mfma_f32_32x32x16_bf16 v[128:143], v[4:7], v[188:191], v[128:143]
ds_read_u16 v102, v102
ds_read_u16 v100, v100
v_fma_mix_f32 v231, v168, v168, v231 op_sel_hi:[1,1,0]
v_exp_f16_sdwa v111, v111 dst_sel:WORD_0 dst_unused:UNUSED_PRESERVE src0_sel:WORD_0
s_waitcnt lgkmcnt(7)
v_fma_mix_f32 v231, v169, v169, v231 op_sel_hi:[1,1,0]
v_and_b32_sdwa v103, s47, v101 dst_sel:DWORD dst_unused:UNUSED_PAD src0_sel:DWORD src1_sel:WORD_1
v_and_b32 v101, s47, v101
v_exp_f16_sdwa v109, v109 dst_sel:WORD_1 dst_unused:UNUSED_PRESERVE src0_sel:WORD_1
v_fma_mix_f32 v231, v170, v170, v231 op_sel_hi:[1,1,0]
v_cvt_pkrtz_f16_f32 v104, v104, v105
v_fma_mix_f32 v231, v171, v171, v231 op_sel_hi:[1,1,0]
v_cvt_pkrtz_f16_f32 v105, v106, v107
v_lshrrev_b64 v[104:105], 2, v[104:105]
ds_read_u16 v103, v103
ds_read_u16 v101, v101
v_and_b32_sdwa v106, s47, v104 dst_sel:DWORD dst_unused:UNUSED_PAD src0_sel:DWORD src1_sel:WORD_1
v_and_b32_e64 v104, s47, v104
v_exp_f16_sdwa v111, v111 dst_sel:WORD_1 dst_unused:UNUSED_PRESERVE src0_sel:WORD_1
v_mfma_f32_32x32x16_bf16 v[144:159], v[28:31], v[188:191], v[144:159]
ds_read_u16 v106, v106
ds_read_u16 v104, v104
ds_read_b128 v[184:187], v250 offset:59392
v_and_b32_sdwa v107, s47, v105 dst_sel:DWORD dst_unused:UNUSED_PAD src0_sel:DWORD src1_sel:WORD_1
v_and_b32_e64 v105, s47, v105
v_pk_add_f16 v109, v109, 1.0 op_sel_hi:[1,0]
v_pk_add_f16 v111, v111, 1.0 op_sel_hi:[1,0]
v_rcp_f16_sdwa v109, v109 dst_sel:WORD_0 dst_unused:UNUSED_PRESERVE src0_sel:WORD_0
v_mfma_f32_32x32x16_bf16 v[128:143], v[8:11], v[176:179], v[128:143]
ds_read_u16 v107, v107
ds_read_u16 v105, v105
v_rcp_f16_sdwa v111, v111 dst_sel:WORD_0 dst_unused:UNUSED_PRESERVE src0_sel:WORD_0
v_rcp_f16_sdwa v109, v109 dst_sel:WORD_1 dst_unused:UNUSED_PRESERVE src0_sel:WORD_1
v_rcp_f16_sdwa v111, v111 dst_sel:WORD_1 dst_unused:UNUSED_PRESERVE src0_sel:WORD_1
v_mfma_f32_32x32x16_bf16 v[144:159], v[32:35], v[176:179], v[144:159]
ds_read_b128 v[188:191], v250 offset:60416
v_pk_mul_f16 v108, v108, v109
v_pk_mul_f16 v110, v110, v111
v_fma_mix_f32 v232, v108, v108, v232 op_sel_hi:[1,1,0]
v_add_u32_e64 v222, s83, v247
v_mov_b32 v223, 0
s_branch Law4
Lax4:
s_sleep 2
Law4:
ds_read_b32 v223, v222 offset:20
s_sub_u32 s76, s76, 1
s_cselect_b32 s44, 4, 0
s_cselect_b32 s76, 0, s76
s_waitcnt lgkmcnt(0)
v_readfirstlane_b32 s43, v223
s_nop 1
s_max_u32 s43, s43, s44
s_cmp_lt_u32 s43, 4
s_cbranch_scc1 Lax4
v_mfma_f32_32x32x16_bf16 v[128:143], v[12:15], v[180:183], v[128:143]
s_add_u32 s81, s81, 6592
s_cmp_eq_u32 s81, 65920
s_cselect_b32 s81, 0, s81
s_add_u32 s43, s81, s67
s_add_u32 m0, s43, 16
s_add_u32 s66, s66, 98304
buffer_load_dwordx4 v236, s[4:7], s66 offen lds
s_add_u32 m0, s43, 912
s_nop 0
buffer_load_dwordx4 v237, s[4:7], s66 offen lds
v_fma_mix_f32 v232, v110, v110, v232 op_sel_hi:[1,1,0]
v_cvt_pkrtz_f16_f32 v112, v112, v113
v_fma_mix_f32 v232, v108, v108, v232 op_sel:[1,1,0] op_sel_hi:[1,1,0]
v_cvt_pkrtz_f16_f32 v113, v114, v115
v_fma_mix_f32 v232, v110, v110, v232 op_sel:[1,1,0] op_sel_hi:[1,1,0]
v_lshrrev_b64 v[112:113], 2, v[112:113]
v_fma_mix_f32 v232, v96, v96, v232 op_sel_hi:[1,1,0]
v_and_b32_sdwa v114, s47, v112 dst_sel:DWORD dst_unused:UNUSED_PAD src0_sel:DWORD src1_sel:WORD_1
v_fma_mix_f32 v232, v97, v97, v232 op_sel_hi:[1,1,0]
v_and_b32_e64 v112, s47, v112
v_fma_mix_f32 v232, v98, v98, v232 op_sel_hi:[1,1,0]
v_cvt_pk_f16_f32 v124, v124, v125
v_fma_mix_f32 v232, v99, v99, v232 op_sel_hi:[1,1,0]
v_cvt_pk_f16_f32 v126, v126, v127
v_pk_fma_f16 v125, v124, v124, s48
v_mfma_f32_32x32x16_bf16 v[144:159], v[36:39], v[180:183], v[144:159]
ds_read_u16 v114, v114
ds_read_u16 v112, v112
v_fma_mix_f32 v232, v100, v100, v232 op_sel_hi:[1,1,0]
v_and_b32_sdwa v115, s47, v113 dst_sel:DWORD dst_unused:UNUSED_PAD src0_sel:DWORD src1_sel:WORD_1
v_fma_mix_f32 v232, v101, v101, v232 op_sel_hi:[1,1,0]
v_and_b32_e64 v113, s47, v113
v_pk_fma_f16 v127, v126, v126, s48
v_pk_mul_f16 v125, v124, v125
v_pk_mul_f16 v127, v126, v127
v_fma_mix_f32 v232, v102, v102, v232 op_sel_hi:[1,1,0]
v_cvt_pkrtz_f16_f32 v116, v116, v117
v_fma_mix_f32 v232, v103, v103, v232 op_sel_hi:[1,1,0]
ds_read_u16 v115, v115
ds_read_u16 v113, v113
ds_read_b128 v[176:179], v250 offset:61440
v_cvt_pkrtz_f16_f32 v117, v118, v119
v_lshrrev_b64 v[116:117], 2, v[116:117]
v_and_b32_sdwa v118, s47, v116 dst_sel:DWORD dst_unused:UNUSED_PAD src0_sel:DWORD src1_sel:WORD_1
v_and_b32_e64 v116, s47, v116
v_exp_f16_sdwa v125, v125 dst_sel:WORD_0 dst_unused:UNUSED_PRESERVE src0_sel:WORD_0
v_mfma_f32_32x32x16_bf16 v[128:143], v[16:19], v[184:187], v[128:143]
ds_read_u16 v118, v118
ds_read_u16 v116, v116
s_add_u32 s81, s81, 6592
s_cmp_eq_u32 s81, 65920
s_cselect_b32 s81, 0, s81
s_add_u32 s43, s81, s67
s_add_u32 m0, s43, 16
s_add_u32 s66, s66, 98304
buffer_load_dwordx4 v236, s[4:7], s66 offen lds
s_add_u32 m0, s43, 912
s_nop 0
buffer_load_dwordx4 v237, s[4:7], s66 offen lds
v_fma_mix_f32 v232, v104, v104, v232 op_sel_hi:[1,1,0]
v_exp_f16_sdwa v127, v127 dst_sel:WORD_0 dst_unused:UNUSED_PRESERVE src0_sel:WORD_0
v_fma_mix_f32 v232, v105, v105, v232 op_sel_hi:[1,1,0]
v_and_b32_sdwa v119, s47, v117 dst_sel:DWORD dst_unused:UNUSED_PAD src0_sel:DWORD src1_sel:WORD_1
v_and_b32_e64 v117, s47, v117
v_exp_f16_sdwa v125, v125 dst_sel:WORD_1 dst_unused:UNUSED_PRESERVE src0_sel:WORD_1
v_fma_mix_f32 v232, v106, v106, v232 op_sel_hi:[1,1,0]
v_cvt_pkrtz_f16_f32 v120, v120, v121
v_fma_mix_f32 v232, v107, v107, v232 op_sel_hi:[1,1,0]
v_cvt_pkrtz_f16_f32 v121, v122, v123
v_lshrrev_b64 v[120:121], 2, v[120:121]
ds_read_u16 v119, v119
ds_read_u16 v117, v117
v_and_b32_sdwa v122, s47, v120 dst_sel:DWORD dst_unused:UNUSED_PAD src0_sel:DWORD src1_sel:WORD_1
v_and_b32_e64 v120, s47, v120
v_exp_f16_sdwa v127, v127 dst_sel:WORD_1 dst_unused:UNUSED_PRESERVE src0_sel:WORD_1
v_mfma_f32_32x32x16_bf16 v[144:159], v[40:43], v[184:187], v[144:159]
ds_read_u16 v122, v122
ds_read_u16 v120, v120
ds_read_b128 v[180:183], v250 offset:62464
v_and_b32_sdwa v123, s47, v121 dst_sel:DWORD dst_unused:UNUSED_PAD src0_sel:DWORD src1_sel:WORD_1
v_and_b32_e64 v121, s47, v121
v_pk_add_f16 v125, v125, 1.0 op_sel_hi:[1,0]
v_pk_add_f16 v127, v127, 1.0 op_sel_hi:[1,0]
v_rcp_f16_sdwa v125, v125 dst_sel:WORD_0 dst_unused:UNUSED_PRESERVE src0_sel:WORD_0
v_mfma_f32_32x32x16_bf16 v[128:143], v[20:23], v[188:191], v[128:143]
ds_read_u16 v123, v123
ds_read_u16 v121, v121
s_add_u32 s81, s81, 6592
s_cmp_eq_u32 s81, 65920
s_cselect_b32 s81, 0, s81
s_add_u32 s43, s81, s67
s_add_u32 m0, s43, 32
s_add_u32 s66, s66, 98304
buffer_load_dwordx4 v236, s[4:7], s66 offen lds
s_add_u32 m0, s43, 928
s_nop 0
buffer_load_dwordx4 v237, s[4:7], s66 offen lds
v_rcp_f16_sdwa v127, v127 dst_sel:WORD_0 dst_unused:UNUSED_PRESERVE src0_sel:WORD_0
v_rcp_f16_sdwa v125, v125 dst_sel:WORD_1 dst_unused:UNUSED_PRESERVE src0_sel:WORD_1
v_rcp_f16_sdwa v127, v127 dst_sel:WORD_1 dst_unused:UNUSED_PRESERVE src0_sel:WORD_1
v_mfma_f32_32x32x16_bf16 v[144:159], v[44:47], v[188:191], v[144:159]
ds_read_b128 v[184:187], v250 offset:63488
v_pk_mul_f16 v124, v124, v125
v_pk_mul_f16 v126, v126, v127
s_add_u32 s81, s81, 6592
s_cmp_eq_u32 s81, 65920
s_cselect_b32 s81, 0, s81
s_add_u32 s43, s81, s67
s_add_u32 m0, s43, 32
s_add_u32 s66, s66, 98304
buffer_load_dwordx4 v236, s[4:7], s66 offen lds
s_add_u32 m0, s43, 928
s_nop 0
buffer_load_dwordx4 v237, s[4:7], s66 offen lds
v_fma_mix_f32 v232, v124, v124, v232 op_sel_hi:[1,1,0]
v_cvt_pkrtz_f16_f32 v128, v128, v129
s_waitcnt lgkmcnt(7)
v_mfma_f32_32x32x16_bf16 v[160:175], v[0:3], v[176:179], 0
v_fma_mix_f32 v232, v126, v126, v232 op_sel_hi:[1,1,0]
v_cvt_pkrtz_f16_f32 v129, v130, v131
v_fma_mix_f32 v232, v124, v124, v232 op_sel:[1,1,0] op_sel_hi:[1,1,0]
v_lshrrev_b64 v[128:129], 2, v[128:129]
v_fma_mix_f32 v232, v126, v126, v232 op_sel:[1,1,0] op_sel_hi:[1,1,0]
v_and_b32_sdwa v130, s47, v128 dst_sel:DWORD dst_unused:UNUSED_PAD src0_sel:DWORD src1_sel:WORD_1
v_fma_mix_f32 v232, v112, v112, v232 op_sel_hi:[1,1,0]
v_and_b32 v128, s47, v128
v_fma_mix_f32 v232, v113, v113, v232 op_sel_hi:[1,1,0]
v_cvt_pk_f16_f32 v140, v140, v141
v_fma_mix_f32 v232, v114, v114, v232 op_sel_hi:[1,1,0]
v_cvt_pk_f16_f32 v142, v142, v143
v_fma_mix_f32 v232, v115, v115, v232 op_sel_hi:[1,1,0]
v_pk_fma_f16 v141, v140, v140, s48
v_mfma_f32_32x32x16_bf16 v[96:111], v[24:27], v[176:179], 0
ds_read_u16 v130, v130
ds_read_u16 v128, v128
v_fma_mix_f32 v232, v116, v116, v232 op_sel_hi:[1,1,0]
v_and_b32_sdwa v131, s47, v129 dst_sel:DWORD dst_unused:UNUSED_PAD src0_sel:DWORD src1_sel:WORD_1
s_waitcnt lgkmcnt(5)
v_fma_mix_f32 v232, v117, v117, v232 op_sel_hi:[1,1,0]
v_and_b32 v129, s47, v129
v_pk_fma_f16 v143, v142, v142, s48
v_pk_mul_f16 v141, v140, v141
v_pk_mul_f16 v143, v142, v143
v_fma_mix_f32 v232, v118, v118, v232 op_sel_hi:[1,1,0]
v_cvt_pkrtz_f16_f32 v132, v132, v133
v_fma_mix_f32 v232, v119, v119, v232 op_sel_hi:[1,1,0]
ds_read_u16 v131, v131
ds_read_u16 v129, v129
ds_read_b128 v[188:191], v250 offset:64512
s_add_u32 s81, s81, 6592
s_cmp_eq_u32 s81, 65920
s_cselect_b32 s81, 0, s81
s_add_u32 s43, s81, s67
s_add_u32 m0, s43, 48
s_add_u32 s66, s66, 98304
buffer_load_dwordx4 v236, s[4:7], s66 offen lds
s_add_u32 m0, s43, 944
s_nop 0
buffer_load_dwordx4 v237, s[4:7], s66 offen lds
v_cvt_pkrtz_f16_f32 v133, v134, v135
v_lshrrev_b64 v[132:133], 2, v[132:133]
v_and_b32_sdwa v134, s47, v132 dst_sel:DWORD dst_unused:UNUSED_PAD src0_sel:DWORD src1_sel:WORD_1
v_and_b32_e64 v132, s47, v132
v_exp_f16_sdwa v141, v141 dst_sel:WORD_0 dst_unused:UNUSED_PRESERVE src0_sel:WORD_0
v_mfma_f32_32x32x16_bf16 v[160:175], v[4:7], v[180:183], v[160:175]
ds_read_u16 v134, v134
ds_read_u16 v132, v132
v_fma_mix_f32 v232, v120, v120, v232 op_sel_hi:[1,1,0]
v_exp_f16_sdwa v143, v143 dst_sel:WORD_0 dst_unused:UNUSED_PRESERVE src0_sel:WORD_0
s_waitcnt lgkmcnt(7)
v_fma_mix_f32 v232, v121, v121, v232 op_sel_hi:[1,1,0]
v_and_b32_sdwa v135, s47, v133 dst_sel:DWORD dst_unused:UNUSED_PAD src0_sel:DWORD src1_sel:WORD_1
v_and_b32 v133, s47, v133
v_exp_f16_sdwa v141, v141 dst_sel:WORD_1 dst_unused:UNUSED_PRESERVE src0_sel:WORD_1
v_fma_mix_f32 v232, v122, v122, v232 op_sel_hi:[1,1,0]
v_cvt_pkrtz_f16_f32 v136, v136, v137
v_fma_mix_f32 v232, v123, v123, v232 op_sel_hi:[1,1,0]
v_cvt_pkrtz_f16_f32 v137, v138, v139
v_lshrrev_b64 v[136:137], 2, v[136:137]
ds_read_u16 v135, v135
ds_read_u16 v133, v133
v_and_b32_sdwa v138, s47, v136 dst_sel:DWORD dst_unused:UNUSED_PAD src0_sel:DWORD src1_sel:WORD_1
v_and_b32_e64 v136, s47, v136
v_exp_f16_sdwa v143, v143 dst_sel:WORD_1 dst_unused:UNUSED_PRESERVE src0_sel:WORD_1
v_mfma_f32_32x32x16_bf16 v[96:111], v[28:31], v[180:183], v[96:111]
ds_read_u16 v138, v138
ds_read_u16 v136, v136
ds_read_b128 v[176:179], v251
v_and_b32_sdwa v139, s47, v137 dst_sel:DWORD dst_unused:UNUSED_PAD src0_sel:DWORD src1_sel:WORD_1
v_and_b32_e64 v137, s47, v137
v_pk_add_f16 v141, v141, 1.0 op_sel_hi:[1,0]
v_pk_add_f16 v143, v143, 1.0 op_sel_hi:[1,0]
v_rcp_f16_sdwa v141, v141 dst_sel:WORD_0 dst_unused:UNUSED_PRESERVE src0_sel:WORD_0
v_mfma_f32_32x32x16_bf16 v[160:175], v[8:11], v[184:187], v[160:175]
ds_read_u16 v139, v139
ds_read_u16 v137, v137
s_add_u32 s81, s81, 6592
s_cmp_eq_u32 s81, 65920
s_cselect_b32 s81, 0, s81
s_add_u32 s43, s81, s67
s_add_u32 m0, s43, 48
s_add_u32 s66, s66, 98304
buffer_load_dwordx4 v236, s[4:7], s66 offen lds
s_add_u32 m0, s43, 944
s_nop 0
buffer_load_dwordx4 v237, s[4:7], s66 offen lds
v_rcp_f16_sdwa v143, v143 dst_sel:WORD_0 dst_unused:UNUSED_PRESERVE src0_sel:WORD_0
v_rcp_f16_sdwa v141, v141 dst_sel:WORD_1 dst_unused:UNUSED_PRESERVE src0_sel:WORD_1
v_rcp_f16_sdwa v143, v143 dst_sel:WORD_1 dst_unused:UNUSED_PRESERVE src0_sel:WORD_1
v_mfma_f32_32x32x16_bf16 v[96:111], v[32:35], v[184:187], v[96:111]
ds_read_b128 v[180:183], v251 offset:1024
s_add_u32 s81, s81, 6592
s_cmp_eq_u32 s81, 65920
s_cselect_b32 s81, 0, s81
s_add_u32 s43, s81, s67
s_add_u32 m0, s43, 0
s_add_u32 s66, s66, 98304
buffer_load_dwordx4 v236, s[4:7], s66 offen lds
s_add_u32 m0, s43, 896
s_nop 0
buffer_load_dwordx4 v237, s[4:7], s66 offen lds
v_pk_mul_f16 v140, v140, v141
v_pk_mul_f16 v142, v142, v143
v_fma_mix_f32 v233, v140, v140, v233 op_sel_hi:[1,1,0]
v_cvt_pkrtz_f16_f32 v144, v144, v145
s_waitcnt lgkmcnt(7)
v_mfma_f32_32x32x16_bf16 v[160:175], v[12:15], v[188:191], v[160:175]
v_fma_mix_f32 v233, v142, v142, v233 op_sel_hi:[1,1,0]
v_cvt_pkrtz_f16_f32 v145, v146, v147
v_fma_mix_f32 v233, v140, v140, v233 op_sel:[1,1,0] op_sel_hi:[1,1,0]
v_lshrrev_b64 v[144:145], 2, v[144:145]
v_fma_mix_f32 v233, v142, v142, v233 op_sel:[1,1,0] op_sel_hi:[1,1,0]
v_and_b32_sdwa v146, s47, v144 dst_sel:DWORD dst_unused:UNUSED_PAD src0_sel:DWORD src1_sel:WORD_1
v_fma_mix_f32 v233, v128, v128, v233 op_sel_hi:[1,1,0]
v_and_b32 v144, s47, v144
v_fma_mix_f32 v233, v129, v129, v233 op_sel_hi:[1,1,0]
v_cvt_pk_f16_f32 v156, v156, v157
v_fma_mix_f32 v233, v130, v130, v233 op_sel_hi:[1,1,0]
v_cvt_pk_f16_f32 v158, v158, v159
v_fma_mix_f32 v233, v131, v131, v233 op_sel_hi:[1,1,0]
v_pk_fma_f16 v157, v156, v156, s48
v_mfma_f32_32x32x16_bf16 v[96:111], v[36:39], v[188:191], v[96:111]
ds_read_u16 v146, v146
ds_read_u16 v144, v144
v_fma_mix_f32 v233, v132, v132, v233 op_sel_hi:[1,1,0]
v_and_b32_sdwa v147, s47, v145 dst_sel:DWORD dst_unused:UNUSED_PAD src0_sel:DWORD src1_sel:WORD_1
s_waitcnt lgkmcnt(5)
v_fma_mix_f32 v233, v133, v133, v233 op_sel_hi:[1,1,0]
s_add_u32 s81, s81, 6592
s_cmp_eq_u32 s81, 65920
s_cselect_b32 s81, 0, s81
s_add_u32 s43, s81, s67
s_add_u32 m0, s43, 0
s_add_u32 s66, s66, 98304
buffer_load_dwordx4 v236, s[4:7], s66 offen lds
s_add_u32 m0, s43, 896
s_nop 0
buffer_load_dwordx4 v237, s[4:7], s66 offen lds
v_and_b32 v145, s47, v145
v_pk_fma_f16 v159, v158, v158, s48
v_pk_mul_f16 v157, v156, v157
v_pk_mul_f16 v159, v158, v159
v_fma_mix_f32 v233, v134, v134, v233 op_sel_hi:[1,1,0]
v_cvt_pkrtz_f16_f32 v148, v148, v149
v_fma_mix_f32 v233, v135, v135, v233 op_sel_hi:[1,1,0]
ds_read_u16 v147, v147
ds_read_u16 v145, v145
ds_read_b128 v[184:187], v251 offset:2048
v_cvt_pkrtz_f16_f32 v149, v150, v151
v_lshrrev_b64 v[148:149], 2, v[148:149]
v_and_b32_sdwa v150, s47, v148 dst_sel:DWORD dst_unused:UNUSED_PAD src0_sel:DWORD src1_sel:WORD_1
v_and_b32_e64 v148, s47, v148
v_exp_f16_sdwa v157, v157 dst_sel:WORD_0 dst_unused:UNUSED_PRESERVE src0_sel:WORD_0
v_mfma_f32_32x32x16_bf16 v[160:175], v[16:19], v[176:179], v[160:175]
ds_read_u16 v150, v150
ds_read_u16 v148, v148
v_fma_mix_f32 v233, v136, v136, v233 op_sel_hi:[1,1,0]
v_exp_f16_sdwa v159, v159 dst_sel:WORD_0 dst_unused:UNUSED_PRESERVE src0_sel:WORD_0
s_waitcnt lgkmcnt(7)
v_fma_mix_f32 v233, v137, v137, v233 op_sel_hi:[1,1,0]
v_and_b32_sdwa v151, s47, v149 dst_sel:DWORD dst_unused:UNUSED_PAD src0_sel:DWORD src1_sel:WORD_1
v_and_b32 v149, s47, v149
v_exp_f16_sdwa v157, v157 dst_sel:WORD_1 dst_unused:UNUSED_PRESERVE src0_sel:WORD_1
v_fma_mix_f32 v233, v138, v138, v233 op_sel_hi:[1,1,0]
v_cvt_pkrtz_f16_f32 v152, v152, v153
v_fma_mix_f32 v233, v139, v139, v233 op_sel_hi:[1,1,0]
v_cvt_pkrtz_f16_f32 v153, v154, v155
v_lshrrev_b64 v[152:153], 2, v[152:153]
ds_read_u16 v151, v151
ds_read_u16 v149, v149
v_and_b32_sdwa v154, s47, v152 dst_sel:DWORD dst_unused:UNUSED_PAD src0_sel:DWORD src1_sel:WORD_1
v_and_b32_e64 v152, s47, v152
v_exp_f16_sdwa v159, v159 dst_sel:WORD_1 dst_unused:UNUSED_PRESERVE src0_sel:WORD_1
v_mfma_f32_32x32x16_bf16 v[96:111], v[40:43], v[176:179], v[96:111]
ds_read_u16 v154, v154
ds_read_u16 v152, v152
ds_read_b128 v[188:191], v251 offset:3072
v_and_b32_sdwa v155, s47, v153 dst_sel:DWORD dst_unused:UNUSED_PAD src0_sel:DWORD src1_sel:WORD_1
v_and_b32_e64 v153, s47, v153
v_pk_add_f16 v157, v157, 1.0 op_sel_hi:[1,0]
v_pk_add_f16 v159, v159, 1.0 op_sel_hi:[1,0]
v_rcp_f16_sdwa v157, v157 dst_sel:WORD_0 dst_unused:UNUSED_PRESERVE src0_sel:WORD_0
v_mfma_f32_32x32x16_bf16 v[160:175], v[20:23], v[180:183], v[160:175]
ds_read_u16 v155, v155
ds_read_u16 v153, v153
v_rcp_f16_sdwa v159, v159 dst_sel:WORD_0 dst_unused:UNUSED_PRESERVE src0_sel:WORD_0
v_rcp_f16_sdwa v157, v157 dst_sel:WORD_1 dst_unused:UNUSED_PRESERVE src0_sel:WORD_1
v_rcp_f16_sdwa v159, v159 dst_sel:WORD_1 dst_unused:UNUSED_PRESERVE src0_sel:WORD_1
v_mfma_f32_32x32x16_bf16 v[96:111], v[44:47], v[180:183], v[96:111]
ds_read_b128 v[176:179], v251 offset:4096
v_pk_mul_f16 v156, v156, v157
v_pk_mul_f16 v158, v158, v159
v_fma_mix_f32 v233, v156, v156, v233 op_sel_hi:[1,1,0]
s_nop 1
v_cvt_pkrtz_f16_f32 v160, v160, v161
v_fma_mix_f32 v233, v158, v158, v233 op_sel_hi:[1,1,0]
s_waitcnt lgkmcnt(7)
v_mfma_f32_32x32x16_bf16 v[112:127], v[0:3], v[184:187], 0
v_fma_mix_f32 v233, v156, v156, v233 op_sel:[1,1,0] op_sel_hi:[1,1,0]
v_cvt_pkrtz_f16_f32 v161, v162, v163
v_fma_mix_f32 v233, v158, v158, v233 op_sel:[1,1,0] op_sel_hi:[1,1,0]
v_lshrrev_b64 v[160:161], 2, v[160:161]
v_fma_mix_f32 v233, v144, v144, v233 op_sel_hi:[1,1,0]
v_and_b32_sdwa v162, s47, v160 dst_sel:DWORD dst_unused:UNUSED_PAD src0_sel:DWORD src1_sel:WORD_1
v_fma_mix_f32 v233, v145, v145, v233 op_sel_hi:[1,1,0]
v_and_b32_e64 v160, s47, v160
v_fma_mix_f32 v233, v146, v146, v233 op_sel_hi:[1,1,0]
v_cvt_pk_f16_f32 v172, v172, v173
v_fma_mix_f32 v233, v147, v147, v233 op_sel_hi:[1,1,0]
v_cvt_pk_f16_f32 v174, v174, v175
v_pk_fma_f16 v173, v172, v172, s48
v_mfma_f32_32x32x16_bf16 v[128:143], v[24:27], v[184:187], 0
ds_read_u16 v162, v162
ds_read_u16 v160, v160
v_fma_mix_f32 v233, v148, v148, v233 op_sel_hi:[1,1,0]
v_and_b32_sdwa v163, s47, v161 dst_sel:DWORD dst_unused:UNUSED_PAD src0_sel:DWORD src1_sel:WORD_1
s_waitcnt lgkmcnt(5)
v_fma_mix_f32 v233, v149, v149, v233 op_sel_hi:[1,1,0]
v_and_b32 v161, s47, v161
v_pk_fma_f16 v175, v174, v174, s48
v_pk_mul_f16 v173, v172, v173
v_pk_mul_f16 v175, v174, v175
v_fma_mix_f32 v233, v150, v150, v233 op_sel_hi:[1,1,0]
v_cvt_pkrtz_f16_f32 v164, v164, v165
v_fma_mix_f32 v233, v151, v151, v233 op_sel_hi:[1,1,0]
ds_read_u16 v163, v163
ds_read_u16 v161, v161
ds_read_b128 v[180:183], v251 offset:5120
v_cvt_pkrtz_f16_f32 v165, v166, v167
v_lshrrev_b64 v[164:165], 2, v[164:165]
v_and_b32_sdwa v166, s47, v164 dst_sel:DWORD dst_unused:UNUSED_PAD src0_sel:DWORD src1_sel:WORD_1
v_and_b32_e64 v164, s47, v164
v_exp_f16_sdwa v173, v173 dst_sel:WORD_0 dst_unused:UNUSED_PRESERVE src0_sel:WORD_0
v_mfma_f32_32x32x16_bf16 v[112:127], v[4:7], v[188:191], v[112:127]
ds_read_u16 v166, v166
ds_read_u16 v164, v164
v_fma_mix_f32 v233, v152, v152, v233 op_sel_hi:[1,1,0]
v_exp_f16_sdwa v175, v175 dst_sel:WORD_0 dst_unused:UNUSED_PRESERVE src0_sel:WORD_0
s_waitcnt lgkmcnt(7)
v_fma_mix_f32 v233, v153, v153, v233 op_sel_hi:[1,1,0]
v_and_b32_sdwa v167, s47, v165 dst_sel:DWORD dst_unused:UNUSED_PAD src0_sel:DWORD src1_sel:WORD_1
v_and_b32 v165, s47, v165
v_exp_f16_sdwa v173, v173 dst_sel:WORD_1 dst_unused:UNUSED_PRESERVE src0_sel:WORD_1
v_fma_mix_f32 v233, v154, v154, v233 op_sel_hi:[1,1,0]
v_cvt_pkrtz_f16_f32 v168, v168, v169
v_fma_mix_f32 v233, v155, v155, v233 op_sel_hi:[1,1,0]
v_cvt_pkrtz_f16_f32 v169, v170, v171
v_lshrrev_b64 v[168:169], 2, v[168:169]
ds_read_u16 v167, v167
ds_read_u16 v165, v165
v_and_b32_sdwa v170, s47, v168 dst_sel:DWORD dst_unused:UNUSED_PAD src0_sel:DWORD src1_sel:WORD_1
v_and_b32_e64 v168, s47, v168
v_exp_f16_sdwa v175, v175 dst_sel:WORD_1 dst_unused:UNUSED_PRESERVE src0_sel:WORD_1
v_mfma_f32_32x32x16_bf16 v[128:143], v[28:31], v[188:191], v[128:143]
ds_read_u16 v170, v170
ds_read_u16 v168, v168
ds_read_b128 v[184:187], v251 offset:6144
v_and_b32_sdwa v171, s47, v169 dst_sel:DWORD dst_unused:UNUSED_PAD src0_sel:DWORD src1_sel:WORD_1
v_and_b32_e64 v169, s47, v169
v_pk_add_f16 v173, v173, 1.0 op_sel_hi:[1,0]
v_pk_add_f16 v175, v175, 1.0 op_sel_hi:[1,0]
v_rcp_f16_sdwa v173, v173 dst_sel:WORD_0 dst_unused:UNUSED_PRESERVE src0_sel:WORD_0
v_mfma_f32_32x32x16_bf16 v[112:127], v[8:11], v[176:179], v[112:127]
ds_read_u16 v171, v171
ds_read_u16 v169, v169
v_rcp_f16_sdwa v175, v175 dst_sel:WORD_0 dst_unused:UNUSED_PRESERVE src0_sel:WORD_0
v_rcp_f16_sdwa v173, v173 dst_sel:WORD_1 dst_unused:UNUSED_PRESERVE src0_sel:WORD_1
v_rcp_f16_sdwa v175, v175 dst_sel:WORD_1 dst_unused:UNUSED_PRESERVE src0_sel:WORD_1
v_mfma_f32_32x32x16_bf16 v[128:143], v[32:35], v[176:179], v[128:143]
ds_read_b128 v[188:191], v251 offset:7168
v_pk_mul_f16 v172, v172, v173
v_pk_mul_f16 v174, v174, v175
v_fma_mix_f32 v234, v172, v172, v234 op_sel_hi:[1,1,0]
v_cvt_pkrtz_f16_f32 v96, v96, v97
v_fma_mix_f32 v234, v174, v174, v234 op_sel_hi:[1,1,0]
s_waitcnt lgkmcnt(7)
v_mfma_f32_32x32x16_bf16 v[112:127], v[12:15], v[180:183], v[112:127]
v_fma_mix_f32 v234, v172, v172, v234 op_sel:[1,1,0] op_sel_hi:[1,1,0]
v_cvt_pkrtz_f16_f32 v97, v98, v99
v_fma_mix_f32 v234, v174, v174, v234 op_sel:[1,1,0] op_sel_hi:[1,1,0]
v_lshrrev_b64 v[96:97], 2, v[96:97]
v_fma_mix_f32 v234, v160, v160, v234 op_sel_hi:[1,1,0]
v_and_b32_sdwa v98, s47, v96 dst_sel:DWORD dst_unused:UNUSED_PAD src0_sel:DWORD src1_sel:WORD_1
v_fma_mix_f32 v234, v161, v161, v234 op_sel_hi:[1,1,0]
v_and_b32 v96, s47, v96
v_fma_mix_f32 v234, v162, v162, v234 op_sel_hi:[1,1,0]
v_cvt_pk_f16_f32 v108, v108, v109
v_fma_mix_f32 v234, v163, v163, v234 op_sel_hi:[1,1,0]
v_cvt_pk_f16_f32 v110, v110, v111
v_pk_fma_f16 v109, v108, v108, s48
v_mfma_f32_32x32x16_bf16 v[128:143], v[36:39], v[180:183], v[128:143]
ds_read_u16 v98, v98
ds_read_u16 v96, v96
v_fma_mix_f32 v234, v164, v164, v234 op_sel_hi:[1,1,0]
v_and_b32_sdwa v99, s47, v97 dst_sel:DWORD dst_unused:UNUSED_PAD src0_sel:DWORD src1_sel:WORD_1
s_waitcnt lgkmcnt(5)
v_fma_mix_f32 v234, v165, v165, v234 op_sel_hi:[1,1,0]
v_and_b32 v97, s47, v97
v_pk_fma_f16 v111, v110, v110, s48
v_pk_mul_f16 v109, v108, v109
v_pk_mul_f16 v111, v110, v111
v_fma_mix_f32 v234, v166, v166, v234 op_sel_hi:[1,1,0]
v_cvt_pkrtz_f16_f32 v100, v100, v101
v_fma_mix_f32 v234, v167, v167, v234 op_sel_hi:[1,1,0]
ds_read_u16 v99, v99
ds_read_u16 v97, v97
v_cvt_pkrtz_f16_f32 v101, v102, v103
v_lshrrev_b64 v[100:101], 2, v[100:101]
v_and_b32_sdwa v102, s47, v100 dst_sel:DWORD dst_unused:UNUSED_PAD src0_sel:DWORD src1_sel:WORD_1
v_and_b32_e64 v100, s47, v100
v_exp_f16_sdwa v109, v109 dst_sel:WORD_0 dst_unused:UNUSED_PRESERVE src0_sel:WORD_0
v_mfma_f32_32x32x16_bf16 v[112:127], v[16:19], v[184:187], v[112:127]
ds_read_u16 v102, v102
ds_read_u16 v100, v100
v_fma_mix_f32 v234, v168, v168, v234 op_sel_hi:[1,1,0]
v_exp_f16_sdwa v111, v111 dst_sel:WORD_0 dst_unused:UNUSED_PRESERVE src0_sel:WORD_0
s_waitcnt lgkmcnt(6)
v_fma_mix_f32 v234, v169, v169, v234 op_sel_hi:[1,1,0]
v_and_b32_sdwa v103, s47, v101 dst_sel:DWORD dst_unused:UNUSED_PAD src0_sel:DWORD src1_sel:WORD_1
v_and_b32 v101, s47, v101
v_exp_f16_sdwa v109, v109 dst_sel:WORD_1 dst_unused:UNUSED_PRESERVE src0_sel:WORD_1
v_fma_mix_f32 v234, v170, v170, v234 op_sel_hi:[1,1,0]
v_cvt_pkrtz_f16_f32 v104, v104, v105
v_fma_mix_f32 v234, v171, v171, v234 op_sel_hi:[1,1,0]
v_cvt_pkrtz_f16_f32 v105, v106, v107
v_lshrrev_b64 v[104:105], 2, v[104:105]
ds_read_u16 v103, v103
ds_read_u16 v101, v101
v_and_b32_sdwa v106, s47, v104 dst_sel:DWORD dst_unused:UNUSED_PAD src0_sel:DWORD src1_sel:WORD_1
v_and_b32_e64 v104, s47, v104
v_exp_f16_sdwa v111, v111 dst_sel:WORD_1 dst_unused:UNUSED_PRESERVE src0_sel:WORD_1
v_mfma_f32_32x32x16_bf16 v[128:143], v[40:43], v[184:187], v[128:143]
ds_read_u16 v106, v106
ds_read_u16 v104, v104
v_and_b32_sdwa v107, s47, v105 dst_sel:DWORD dst_unused:UNUSED_PAD src0_sel:DWORD src1_sel:WORD_1
v_and_b32_e64 v105, s47, v105
v_pk_add_f16 v109, v109, 1.0 op_sel_hi:[1,0]
v_pk_add_f16 v111, v111, 1.0 op_sel_hi:[1,0]
v_rcp_f16_sdwa v109, v109 dst_sel:WORD_0 dst_unused:UNUSED_PRESERVE src0_sel:WORD_0
v_mfma_f32_32x32x16_bf16 v[112:127], v[20:23], v[188:191], v[112:127]
ds_read_u16 v107, v107
ds_read_u16 v105, v105
v_rcp_f16_sdwa v111, v111 dst_sel:WORD_0 dst_unused:UNUSED_PRESERVE src0_sel:WORD_0
v_rcp_f16_sdwa v109, v109 dst_sel:WORD_1 dst_unused:UNUSED_PRESERVE src0_sel:WORD_1
v_rcp_f16_sdwa v111, v111 dst_sel:WORD_1 dst_unused:UNUSED_PRESERVE src0_sel:WORD_1
v_mfma_f32_32x32x16_bf16 v[128:143], v[44:47], v[188:191], v[128:143]
v_pk_mul_f16 v108, v108, v109
v_pk_mul_f16 v110, v110, v111
v_fma_mix_f32 v234, v108, v108, v234 op_sel_hi:[1,1,0]
s_nop 2
v_cvt_pkrtz_f16_f32 v112, v112, v113
v_fma_mix_f32 v234, v110, v110, v234 op_sel_hi:[1,1,0]
v_cvt_pkrtz_f16_f32 v113, v114, v115
v_fma_mix_f32 v234, v108, v108, v234 op_sel:[1,1,0] op_sel_hi:[1,1,0]
v_lshrrev_b64 v[112:113], 2, v[112:113]
v_fma_mix_f32 v234, v110, v110, v234 op_sel:[1,1,0] op_sel_hi:[1,1,0]
v_and_b32_sdwa v114, s47, v112 dst_sel:DWORD dst_unused:UNUSED_PAD src0_sel:DWORD src1_sel:WORD_1
s_waitcnt lgkmcnt(4)
v_fma_mix_f32 v234, v96, v96, v234 op_sel_hi:[1,1,0]
v_and_b32_e64 v112, s47, v112
v_fma_mix_f32 v234, v97, v97, v234 op_sel_hi:[1,1,0]
v_cvt_pk_f16_f32 v124, v124, v125
v_fma_mix_f32 v234, v98, v98, v234 op_sel_hi:[1,1,0]
v_cvt_pk_f16_f32 v126, v126, v127
v_fma_mix_f32 v234, v99, v99, v234 op_sel_hi:[1,1,0]
v_pk_fma_f16 v125, v124, v124, s48
v_fma_mix_f32 v234, v100, v100, v234 op_sel_hi:[1,1,0]
v_and_b32_sdwa v115, s47, v113 dst_sel:DWORD dst_unused:UNUSED_PAD src0_sel:DWORD src1_sel:WORD_1
v_fma_mix_f32 v234, v101, v101, v234 op_sel_hi:[1,1,0]
v_and_b32_e64 v113, s47, v113
v_pk_fma_f16 v127, v126, v126, s48
ds_read_u16 v114, v114
ds_read_u16 v112, v112
ds_read_u16 v115, v115
ds_read_u16 v113, v113
s_add_u32 s43, s81, 6592
v_add_u32_e64 v212, s43, v246
v_subrev_u32 v222, 65920, v212
v_min_u32_e64 v212, v212, v222
v_add_u32 v212, 90112, v212
v_add_u32_e64 v213, s43, v246
v_add_u32 v213, 6592, v213
v_subrev_u32 v222, 65920, v213
v_min_u32_e64 v213, v213, v222
v_add_u32 v213, 90112, v213
v_add_u32_e64 v214, s43, v246
v_add_u32 v214, 13184, v214
v_add_u32_e64 v222, 16, v214
v_bfi_b32 v214, 48, v222, v214
v_subrev_u32 v222, 65920, v214
v_min_u32_e64 v214, v214, v222
v_add_u32 v214, 90112, v214
v_add_u32_e64 v215, s43, v246
v_add_u32 v215, 19776, v215
v_add_u32_e64 v222, 16, v215
v_bfi_b32 v215, 48, v222, v215
v_subrev_u32 v222, 65920, v215
v_min_u32 v215, v215, v222
v_add_u32 v215, 90112, v215
v_max_u32 v240, v238, v239
v_bfe_u32 v241, v250, 4, 2
v_bfe_u32 v222, v250, 7, 1
v_lshl_add_u32 v243, v222, 2, v241
v_bfe_u32 v222, v250, 9, 1
v_mul_u32_u24 v222, 300, v222
v_add_u32_e64 v243, v243, v222
v_bfe_u32 v222, v250, 8, 1
v_bfe_u32 v223, v250, 6, 1
v_lshlrev_b32 v222, 1, v222
v_sub_u32 v223, v222, v223
v_lshl_add_u32 v243, v223, 3, v243
v_lshlrev_b32_e64 v243, 3, v243
v_add_u32 v243, 156040, v243
v_bfe_u32 v222, v250, 9, 1
v_mul_u32_u24 v222, 2400, v222
v_add_u32 v222, 156032, v222
v_cmp_ne_u32 vcc, -1, v223
s_nop 1
v_cndmask_b32 v240, v222, v243, vcc
v_add_u32_e64 v243, 64, v243
v_cmp_ne_u32 vcc, 2, v223
s_nop 1
v_cndmask_b32 v242, v222, v243, vcc
v_mul_u32_u24 v241, 21845, v241
v_xor_b32 v241, 17476, v241
v_pk_mul_f16 v125, v124, v125
v_pk_mul_f16 v127, v126, v127
v_fma_mix_f32 v234, v102, v102, v234 op_sel_hi:[1,1,0]
v_cvt_pkrtz_f16_f32 v116, v116, v117
v_fma_mix_f32 v234, v103, v103, v234 op_sel_hi:[1,1,0]
v_cvt_pkrtz_f16_f32 v117, v118, v119
v_lshrrev_b64 v[116:117], 2, v[116:117]
v_and_b32_sdwa v118, s47, v116 dst_sel:DWORD dst_unused:UNUSED_PAD src0_sel:DWORD src1_sel:WORD_1
v_and_b32 v116, s47, v116
v_exp_f16_sdwa v125, v125 dst_sel:WORD_0 dst_unused:UNUSED_PRESERVE src0_sel:WORD_0
s_waitcnt lgkmcnt(0)
v_fma_mix_f32 v234, v104, v104, v234 op_sel_hi:[1,1,0]
v_exp_f16_sdwa v127, v127 dst_sel:WORD_0 dst_unused:UNUSED_PRESERVE src0_sel:WORD_0
v_fma_mix_f32 v234, v105, v105, v234 op_sel_hi:[1,1,0]
v_and_b32_sdwa v119, s47, v117 dst_sel:DWORD dst_unused:UNUSED_PAD src0_sel:DWORD src1_sel:WORD_1
v_and_b32 v117, s47, v117
ds_read_u16 v118, v118
ds_read_u16 v116, v116
ds_read_u16 v119, v119
ds_read_u16 v117, v117
s_waitcnt vmcnt(0)
v_exp_f16_sdwa v125, v125 dst_sel:WORD_1 dst_unused:UNUSED_PRESERVE src0_sel:WORD_1
v_fma_mix_f32 v234, v106, v106, v234 op_sel_hi:[1,1,0]
v_cvt_pkrtz_f16_f32 v120, v120, v121
v_fma_mix_f32 v234, v107, v107, v234 op_sel_hi:[1,1,0]
v_cvt_pkrtz_f16_f32 v121, v122, v123
v_lshrrev_b64 v[120:121], 2, v[120:121]
v_and_b32_sdwa v122, s47, v120 dst_sel:DWORD dst_unused:UNUSED_PAD src0_sel:DWORD src1_sel:WORD_1
ds_read_b128 v[144:147], v212
ds_read_b64 v[208:209], v238
ds_read_b64 v[210:211], v239
v_and_b32_e64 v120, s47, v120
v_exp_f16_sdwa v127, v127 dst_sel:WORD_1 dst_unused:UNUSED_PRESERVE src0_sel:WORD_1
v_and_b32_sdwa v123, s47, v121 dst_sel:DWORD dst_unused:UNUSED_PAD src0_sel:DWORD src1_sel:WORD_1
v_and_b32_e64 v121, s47, v121
v_pk_add_f16 v125, v125, 1.0 op_sel_hi:[1,0]
v_pk_add_f16 v127, v127, 1.0 op_sel_hi:[1,0]
v_rcp_f16_sdwa v125, v125 dst_sel:WORD_0 dst_unused:UNUSED_PRESERVE src0_sel:WORD_0
ds_read_u16 v122, v122
ds_read_u16 v120, v120
ds_read_b128 v[148:151], v213
ds_read_b128 v[152:155], v214
ds_read_b128 v[156:159], v215
ds_read_b64 v[192:193], v240 offset:2400
ds_read_b64 v[194:195], v242 offset:2400
ds_read_u16 v123, v123
s_waitcnt lgkmcnt(14)
ds_read_u16 v121, v121
v_rcp_f16_sdwa v127, v127 dst_sel:WORD_0 dst_unused:UNUSED_PRESERVE src0_sel:WORD_0
v_rcp_f16_sdwa v125, v125 dst_sel:WORD_1 dst_unused:UNUSED_PRESERVE src0_sel:WORD_1
v_rcp_f16_sdwa v127, v127 dst_sel:WORD_1 dst_unused:UNUSED_PRESERVE src0_sel:WORD_1
v_pk_mul_f16 v124, v124, v125
v_pk_mul_f16 v126, v126, v127
v_fma_mix_f32 v235, v124, v124, v235 op_sel_hi:[1,1,0]
v_cvt_pkrtz_f16_f32 v128, v128, v129
v_fma_mix_f32 v235, v126, v126, v235 op_sel_hi:[1,1,0]
s_waitcnt lgkmcnt(14)
ds_read_b128 v[160:163], v212 offset:16
s_waitcnt lgkmcnt(14)
ds_read_b64 v[196:197], v238 offset:200
v_fma_mix_f32 v235, v124, v124, v235 op_sel:[1,1,0] op_sel_hi:[1,1,0]
v_cvt_pkrtz_f16_f32 v129, v130, v131
v_fma_mix_f32 v235, v126, v126, v235 op_sel:[1,1,0] op_sel_hi:[1,1,0]
v_lshrrev_b64 v[128:129], 2, v[128:129]
v_fma_mix_f32 v235, v112, v112, v235 op_sel_hi:[1,1,0]
s_waitcnt lgkmcnt(11)
v_mfma_f32_16x16x32_bf16 v[48:51], v[208:211], v[144:147], 0
ds_read_b64 v[198:199], v239 offset:200
ds_read_b128 v[164:167], v213 offset:16
ds_read_b128 v[168:171], v214 offset:16
v_fma_mix_f32 v235, v113, v113, v235 op_sel_hi:[1,1,0]
v_and_b32_sdwa v130, s47, v128 dst_sel:DWORD dst_unused:UNUSED_PAD src0_sel:DWORD src1_sel:WORD_1
v_fma_mix_f32 v235, v114, v114, v235 op_sel_hi:[1,1,0]
v_and_b32_e64 v128, s47, v128
v_fma_mix_f32 v235, v115, v115, v235 op_sel_hi:[1,1,0]
v_cvt_pk_f16_f32 v140, v140, v141
v_cvt_pk_f16_f32 v142, v142, v143
ds_read_b128 v[172:175], v215 offset:16
s_waitcnt lgkmcnt(14)
ds_read_b64 v[200:201], v240 offset:2600
v_pk_fma_f16 v141, v140, v140, s48
v_fma_mix_f32 v235, v116, v116, v235 op_sel_hi:[1,1,0]
s_waitcnt lgkmcnt(13)
v_mfma_f32_16x16x32_bf16 v[96:99], v[208:211], v[148:151], 0
ds_read_b64 v[202:203], v242 offset:2600
ds_read_b128 v[144:147], v212 offset:32
v_fma_mix_f32 v235, v117, v117, v235 op_sel_hi:[1,1,0]
v_and_b32_sdwa v131, s47, v129 dst_sel:DWORD dst_unused:UNUSED_PAD src0_sel:DWORD src1_sel:WORD_1
v_and_b32 v129, s47, v129
v_pk_fma_f16 v143, v142, v142, s48
v_pk_mul_f16 v141, v140, v141
v_pk_mul_f16 v143, v142, v143
s_waitcnt lgkmcnt(11)
v_smfmac_f32_16x16x64_bf16 v[48:51], v[192:195], v[148:155], v241
ds_read_b64 v[204:205], v238 offset:400
v_smfmac_f32_16x16x64_bf16 v[96:99], v[192:195], v[152:159], v241
ds_read_b64 v[206:207], v239 offset:400
ds_read_b128 v[148:151], v213 offset:32
ds_read_b128 v[152:155], v214 offset:32
v_fma_mix_f32 v235, v118, v118, v235 op_sel_hi:[1,1,0]
v_cvt_pkrtz_f16_f32 v132, v132, v133
v_fma_mix_f32 v235, v119, v119, v235 op_sel_hi:[1,1,0]
v_cvt_pkrtz_f16_f32 v133, v134, v135
v_lshrrev_b64 v[132:133], 2, v[132:133]
v_and_b32_sdwa v134, s47, v132 dst_sel:DWORD dst_unused:UNUSED_PAD src0_sel:DWORD src1_sel:WORD_1
v_and_b32_e64 v132, s47, v132
v_exp_f16_sdwa v141, v141 dst_sel:WORD_0 dst_unused:UNUSED_PRESERVE src0_sel:WORD_0
v_fma_mix_f32 v235, v120, v120, v235 op_sel_hi:[1,1,0]
s_waitcnt lgkmcnt(10)
v_mfma_f32_16x16x32_bf16 v[52:55], v[196:199], v[160:163], 0
ds_read_b128 v[156:159], v215 offset:32
ds_read_b64 v[208:209], v240 offset:2800
s_waitcnt lgkmcnt(11)
v_mfma_f32_16x16x32_bf16 v[100:103], v[196:199], v[164:167], 0
ds_read_b64 v[210:211], v242 offset:2800
ds_read_b128 v[160:163], v212 offset:48
ds_read_b64 v[192:193], v238 offset:600
ds_read_b64 v[194:195], v239 offset:600
v_fma_mix_f32 v235, v121, v121, v235 op_sel_hi:[1,1,0]
v_exp_f16_sdwa v143, v143 dst_sel:WORD_0 dst_unused:UNUSED_PRESERVE src0_sel:WORD_0
v_and_b32_sdwa v135, s47, v133 dst_sel:DWORD dst_unused:UNUSED_PAD src0_sel:DWORD src1_sel:WORD_1
v_and_b32 v133, s47, v133
s_waitcnt lgkmcnt(11)
v_smfmac_f32_16x16x64_bf16 v[52:55], v[200:203], v[164:171], v241
ds_read_u16 v130, v130
v_smfmac_f32_16x16x64_bf16 v[100:103], v[200:203], v[168:175], v241
ds_read_u16 v128, v128
s_waitcnt lgkmcnt(10)
v_mfma_f32_16x16x32_bf16 v[56:59], v[204:207], v[144:147], 0
ds_read_b128 v[164:167], v213 offset:48
ds_read_b128 v[168:171], v214 offset:48
s_waitcnt lgkmcnt(11)
v_mfma_f32_16x16x32_bf16 v[104:107], v[204:207], v[148:151], 0
ds_read_u16 v131, v131
ds_read_u16 v129, v129
ds_read_b128 v[172:175], v215 offset:48
ds_read_b64 v[196:197], v240 offset:3000
v_exp_f16_sdwa v141, v141 dst_sel:WORD_1 dst_unused:UNUSED_PRESERVE src0_sel:WORD_1
v_fma_mix_f32 v235, v122, v122, v235 op_sel_hi:[1,1,0]
v_cvt_pkrtz_f16_f32 v136, v136, v137
s_waitcnt lgkmcnt(11)
v_smfmac_f32_16x16x64_bf16 v[56:59], v[208:211], v[148:155], v241
ds_read_b64 v[198:199], v242 offset:3000
ds_read_u16 v134, v134
ds_read_u16 v132, v132
v_smfmac_f32_16x16x64_bf16 v[104:107], v[208:211], v[152:159], v241
ds_read_b128 v[144:147], v212 offset:64
s_waitcnt lgkmcnt(14)
ds_read_b64 v[200:201], v238 offset:800
s_waitcnt lgkmcnt(14)
ds_read_b64 v[202:203], v239 offset:800
s_waitcnt lgkmcnt(14)
v_mfma_f32_16x16x32_bf16 v[60:63], v[192:195], v[160:163], 0
ds_read_b128 v[148:151], v213 offset:64
v_fma_mix_f32 v235, v123, v123, v235 op_sel_hi:[1,1,0]
v_cvt_pkrtz_f16_f32 v137, v138, v139
v_lshrrev_b64 v[136:137], 2, v[136:137]
v_and_b32_sdwa v138, s47, v136 dst_sel:DWORD dst_unused:UNUSED_PAD src0_sel:DWORD src1_sel:WORD_1
v_and_b32_e64 v136, s47, v136
v_exp_f16_sdwa v143, v143 dst_sel:WORD_1 dst_unused:UNUSED_PRESERVE src0_sel:WORD_1
v_and_b32_sdwa v139, s47, v137 dst_sel:DWORD dst_unused:UNUSED_PAD src0_sel:DWORD src1_sel:WORD_1
v_and_b32_e64 v137, s47, v137
s_waitcnt lgkmcnt(12)
v_mfma_f32_16x16x32_bf16 v[108:111], v[192:195], v[164:167], 0
ds_read_u16 v135, v135
ds_read_u16 v133, v133
ds_read_b128 v[152:155], v214 offset:64
v_pk_add_f16 v141, v141, 1.0 op_sel_hi:[1,0]
v_pk_add_f16 v143, v143, 1.0 op_sel_hi:[1,0]
v_rcp_f16_sdwa v141, v141 dst_sel:WORD_0 dst_unused:UNUSED_PRESERVE src0_sel:WORD_0
v_rcp_f16_sdwa v143, v143 dst_sel:WORD_0 dst_unused:UNUSED_PRESERVE src0_sel:WORD_0
v_rcp_f16_sdwa v141, v141 dst_sel:WORD_1 dst_unused:UNUSED_PRESERVE src0_sel:WORD_1
v_rcp_f16_sdwa v143, v143 dst_sel:WORD_1 dst_unused:UNUSED_PRESERVE src0_sel:WORD_1
v_pk_mul_f16 v140, v140, v141
s_waitcnt lgkmcnt(14)
ds_read_b128 v[156:159], v215 offset:64
s_waitcnt lgkmcnt(14)
ds_read_b64 v[204:205], v240 offset:3200
s_waitcnt lgkmcnt(14)
ds_read_b64 v[206:207], v242 offset:3200
v_pk_mul_f16 v142, v142, v143
s_waitcnt lgkmcnt(14)
ds_read_u16 v138, v138
s_waitcnt lgkmcnt(13)
v_smfmac_f32_16x16x64_bf16 v[60:63], v[196:199], v[164:171], v241
ds_read_u16 v136, v136
v_smfmac_f32_16x16x64_bf16 v[108:111], v[196:199], v[168:175], v241
ds_read_b128 v[160:163], v212 offset:80
v_fma_mix_f32 v235, v140, v140, v235 op_sel_hi:[1,1,0]
s_nop 0
v_fma_mix_f32 v235, v142, v142, v235 op_sel_hi:[1,1,0]
s_waitcnt lgkmcnt(14)
ds_read_b64 v[208:209], v238 offset:1000
s_waitcnt lgkmcnt(14)
ds_read_b64 v[210:211], v239 offset:1000
v_fma_mix_f32 v235, v140, v140, v235 op_sel:[1,1,0] op_sel_hi:[1,1,0]
s_waitcnt lgkmcnt(14)
ds_read_u16 v139, v139
s_waitcnt lgkmcnt(14)
ds_read_u16 v137, v137
s_waitcnt lgkmcnt(14)
v_mfma_f32_16x16x32_bf16 v[64:67], v[200:203], v[144:147], 0
ds_read_b128 v[164:167], v213 offset:80
v_fma_mix_f32 v235, v142, v142, v235 op_sel:[1,1,0] op_sel_hi:[1,1,0]
s_waitcnt lgkmcnt(14)
v_mfma_f32_16x16x32_bf16 v[112:115], v[200:203], v[148:151], 0
v_fma_mix_f32 v235, v128, v128, v235 op_sel_hi:[1,1,0]
s_nop 0
v_fma_mix_f32 v235, v129, v129, v235 op_sel_hi:[1,1,0]
ds_read_b128 v[168:171], v214 offset:80
v_fma_mix_f32 v235, v130, v130, v235 op_sel_hi:[1,1,0]
s_nop 0
v_fma_mix_f32 v235, v131, v131, v235 op_sel_hi:[1,1,0]
s_waitcnt lgkmcnt(14)
ds_read_b128 v[172:175], v215 offset:80
s_waitcnt lgkmcnt(14)
ds_read_b64 v[192:193], v240 offset:3400
s_waitcnt lgkmcnt(14)
ds_read_b64 v[194:195], v242 offset:3400
s_waitcnt lgkmcnt(14)
ds_read_b128 v[144:147], v212 offset:96
s_waitcnt lgkmcnt(13)
v_smfmac_f32_16x16x64_bf16 v[64:67], v[204:207], v[148:155], v241
ds_read_b64 v[196:197], v238 offset:1200
v_smfmac_f32_16x16x64_bf16 v[112:115], v[204:207], v[152:159], v241
ds_read_b64 v[198:199], v239 offset:1200
v_fma_mix_f32 v235, v132, v132, v235 op_sel_hi:[1,1,0]
s_nop 0
v_fma_mix_f32 v235, v133, v133, v235 op_sel_hi:[1,1,0]
s_nop 0
v_fma_mix_f32 v235, v134, v134, v235 op_sel_hi:[1,1,0]
s_waitcnt lgkmcnt(14)
ds_read_b128 v[148:151], v213 offset:96
v_fma_mix_f32 v235, v135, v135, v235 op_sel_hi:[1,1,0]
s_waitcnt lgkmcnt(14)
ds_read_b128 v[152:155], v214 offset:96
s_waitcnt lgkmcnt(14)
ds_read_b128 v[156:159], v215 offset:96
s_waitcnt lgkmcnt(13)
v_mfma_f32_16x16x32_bf16 v[68:71], v[208:211], v[160:163], 0
ds_read_b64 v[200:201], v240 offset:3600
ds_read_b64 v[202:203], v242 offset:3600
s_waitcnt lgkmcnt(14)
ds_read_b128 v[160:163], v212 offset:112
s_waitcnt lgkmcnt(13)
v_mfma_f32_16x16x32_bf16 v[116:119], v[208:211], v[164:167], 0
ds_read_b64 v[204:205], v238 offset:1400
v_fma_mix_f32 v235, v136, v136, v235 op_sel_hi:[1,1,0]
ds_read_b64 v[206:207], v239 offset:1400
v_fma_mix_f32 v235, v137, v137, v235 op_sel_hi:[1,1,0]
s_waitcnt lgkmcnt(14)
ds_read_b64 v[208:209], v240 offset:3800
s_waitcnt lgkmcnt(14)
ds_read_b64 v[210:211], v242 offset:3800
s_waitcnt lgkmcnt(13)
v_smfmac_f32_16x16x64_bf16 v[68:71], v[192:195], v[164:171], v241
ds_read_b128 v[164:167], v213 offset:112
v_smfmac_f32_16x16x64_bf16 v[116:119], v[192:195], v[168:175], v241
ds_read_b128 v[168:171], v214 offset:112
s_waitcnt lgkmcnt(12)
v_mfma_f32_16x16x32_bf16 v[72:75], v[196:199], v[144:147], 0
ds_read_b128 v[172:175], v215 offset:112
ds_read_b128 v[144:147], v212 offset:128
s_waitcnt lgkmcnt(13)
v_mfma_f32_16x16x32_bf16 v[120:123], v[196:199], v[148:151], 0
ds_read_b64 v[192:193], v238 offset:1600
ds_read_b64 v[194:195], v239 offset:1600
v_fma_mix_f32 v235, v138, v138, v235 op_sel_hi:[1,1,0]
s_nop 0
v_fma_mix_f32 v235, v139, v139, v235 op_sel_hi:[1,1,0]
s_waitcnt lgkmcnt(14)
ds_read_b64 v[196:197], v240 offset:4000
s_waitcnt lgkmcnt(14)
ds_read_b64 v[198:199], v242 offset:4000
s_waitcnt lgkmcnt(13)
v_smfmac_f32_16x16x64_bf16 v[72:75], v[200:203], v[148:155], v241
ds_read_b128 v[148:151], v213 offset:128
v_smfmac_f32_16x16x64_bf16 v[120:123], v[200:203], v[152:159], v241
ds_read_b128 v[152:155], v214 offset:128
s_waitcnt lgkmcnt(12)
v_mfma_f32_16x16x32_bf16 v[76:79], v[204:207], v[160:163], 0
ds_read_b128 v[156:159], v215 offset:128
ds_read_b128 v[160:163], v212 offset:144
ds_read_b64 v[200:201], v238 offset:1800
s_waitcnt lgkmcnt(14)
ds_read_b64 v[202:203], v239 offset:1800
s_waitcnt lgkmcnt(13)
v_mfma_f32_16x16x32_bf16 v[124:127], v[204:207], v[164:167], 0
ds_read_b64 v[204:205], v240 offset:4200
ds_read_b64 v[206:207], v242 offset:4200
s_waitcnt lgkmcnt(14)
v_smfmac_f32_16x16x64_bf16 v[76:79], v[208:211], v[164:171], v241
ds_read_b128 v[164:167], v213 offset:144
s_waitcnt lgkmcnt(14)
v_smfmac_f32_16x16x64_bf16 v[124:127], v[208:211], v[168:175], v241
ds_read_b128 v[168:171], v214 offset:144
s_waitcnt lgkmcnt(14)
ds_read_b128 v[172:175], v215 offset:144
s_waitcnt lgkmcnt(13)
v_mfma_f32_16x16x32_bf16 v[80:83], v[192:195], v[144:147], 0
ds_read_b128 v[144:147], v212 offset:160
ds_read_b64 v[208:209], v238 offset:2000
s_waitcnt lgkmcnt(14)
ds_read_b64 v[210:211], v239 offset:2000
s_waitcnt lgkmcnt(13)
v_mfma_f32_16x16x32_bf16 v[128:131], v[192:195], v[148:151], 0
ds_read_b64 v[192:193], v240 offset:4400
ds_read_b64 v[194:195], v242 offset:4400
s_waitcnt lgkmcnt(14)
v_smfmac_f32_16x16x64_bf16 v[80:83], v[196:199], v[148:155], v241
ds_read_b128 v[148:151], v213 offset:160
s_waitcnt lgkmcnt(14)
v_smfmac_f32_16x16x64_bf16 v[128:131], v[196:199], v[152:159], v241
ds_read_b128 v[152:155], v214 offset:160
s_waitcnt lgkmcnt(14)
ds_read_b128 v[156:159], v215 offset:160
s_waitcnt lgkmcnt(13)
v_mfma_f32_16x16x32_bf16 v[84:87], v[200:203], v[160:163], 0
ds_read_b128 v[160:163], v212 offset:176
ds_read_b64 v[196:197], v238 offset:2200
s_waitcnt lgkmcnt(14)
ds_read_b64 v[198:199], v239 offset:2200
s_waitcnt lgkmcnt(13)
v_mfma_f32_16x16x32_bf16 v[132:135], v[200:203], v[164:167], 0
ds_read_b64 v[200:201], v240 offset:4600
ds_read_b64 v[202:203], v242 offset:4600
s_waitcnt lgkmcnt(14)
v_smfmac_f32_16x16x64_bf16 v[84:87], v[204:207], v[164:171], v241
ds_read_b128 v[164:167], v213 offset:176
s_waitcnt lgkmcnt(14)
v_smfmac_f32_16x16x64_bf16 v[132:135], v[204:207], v[168:175], v241
ds_read_b128 v[168:171], v214 offset:176
s_waitcnt lgkmcnt(14)
ds_read_b128 v[172:175], v215 offset:176
s_waitcnt lgkmcnt(13)
v_mfma_f32_16x16x32_bf16 v[88:91], v[208:211], v[144:147], 0
s_waitcnt lgkmcnt(10)
v_mfma_f32_16x16x32_bf16 v[136:139], v[208:211], v[148:151], 0
s_waitcnt lgkmcnt(9)
v_smfmac_f32_16x16x64_bf16 v[88:91], v[192:195], v[148:155], v241
s_waitcnt lgkmcnt(8)
v_smfmac_f32_16x16x64_bf16 v[136:139], v[192:195], v[152:159], v241
s_waitcnt lgkmcnt(5)
v_mfma_f32_16x16x32_bf16 v[92:95], v[196:199], v[160:163], 0
s_waitcnt lgkmcnt(2)
v_mfma_f32_16x16x32_bf16 v[140:143], v[196:199], v[164:167], 0
s_waitcnt lgkmcnt(1)
v_smfmac_f32_16x16x64_bf16 v[92:95], v[200:203], v[164:171], v241
s_waitcnt lgkmcnt(0)
v_smfmac_f32_16x16x64_bf16 v[140:143], v[200:203], v[168:175], v241
v_mov_b32 v223, 1
v_add_u32 v222, s83, v247
s_nop 7
s_mov_b64 exec, 1
ds_add_u32 v222, v223 offset:24
s_mov_b64 exec, -1
v_pk_mul_f32 v[242:243], v[48:49], v[48:49]
v_pk_add_f32 v[240:241], v[48:49], v[50:51]
v_pk_fma_f32 v[242:243], v[50:51], v[50:51], v[242:243]
v_pk_mul_f32 v[218:219], v[96:97], v[96:97]
v_pk_add_f32 v[216:217], v[96:97], v[98:99]
v_pk_fma_f32 v[218:219], v[98:99], v[98:99], v[218:219]
v_pk_fma_f32 v[242:243], v[52:53], v[52:53], v[242:243]
v_pk_add_f32 v[240:241], v[240:241], v[52:53]
v_pk_fma_f32 v[242:243], v[54:55], v[54:55], v[242:243]
v_pk_add_f32 v[240:241], v[240:241], v[54:55]
v_pk_fma_f32 v[218:219], v[100:101], v[100:101], v[218:219]
v_pk_add_f32 v[216:217], v[216:217], v[100:101]
v_pk_fma_f32 v[218:219], v[102:103], v[102:103], v[218:219]
v_pk_add_f32 v[216:217], v[216:217], v[102:103]
v_pk_fma_f32 v[242:243], v[56:57], v[56:57], v[242:243]
v_pk_add_f32 v[240:241], v[240:241], v[56:57]
v_pk_fma_f32 v[242:243], v[58:59], v[58:59], v[242:243]
v_pk_add_f32 v[240:241], v[240:241], v[58:59]
v_pk_fma_f32 v[218:219], v[104:105], v[104:105], v[218:219]
v_pk_add_f32 v[216:217], v[216:217], v[104:105]
v_pk_fma_f32 v[218:219], v[106:107], v[106:107], v[218:219]
v_pk_add_f32 v[216:217], v[216:217], v[106:107]
v_pk_fma_f32 v[242:243], v[60:61], v[60:61], v[242:243]
v_pk_add_f32 v[240:241], v[240:241], v[60:61]
v_pk_fma_f32 v[242:243], v[62:63], v[62:63], v[242:243]
v_pk_add_f32 v[240:241], v[240:241], v[62:63]
v_pk_fma_f32 v[218:219], v[108:109], v[108:109], v[218:219]
v_pk_add_f32 v[216:217], v[216:217], v[108:109]
v_pk_fma_f32 v[218:219], v[110:111], v[110:111], v[218:219]
v_pk_add_f32 v[216:217], v[216:217], v[110:111]
v_pk_fma_f32 v[242:243], v[64:65], v[64:65], v[242:243]
v_pk_add_f32 v[240:241], v[240:241], v[64:65]
v_pk_fma_f32 v[242:243], v[66:67], v[66:67], v[242:243]
v_pk_add_f32 v[240:241], v[240:241], v[66:67]
v_pk_fma_f32 v[218:219], v[112:113], v[112:113], v[218:219]
v_pk_add_f32 v[216:217], v[216:217], v[112:113]
v_pk_fma_f32 v[218:219], v[114:115], v[114:115], v[218:219]
v_pk_add_f32 v[216:217], v[216:217], v[114:115]
v_pk_fma_f32 v[242:243], v[68:69], v[68:69], v[242:243]
v_pk_add_f32 v[240:241], v[240:241], v[68:69]
v_pk_fma_f32 v[242:243], v[70:71], v[70:71], v[242:243]
v_pk_add_f32 v[240:241], v[240:241], v[70:71]
v_pk_fma_f32 v[218:219], v[116:117], v[116:117], v[218:219]
v_pk_add_f32 v[216:217], v[216:217], v[116:117]
v_pk_fma_f32 v[218:219], v[118:119], v[118:119], v[218:219]
v_pk_add_f32 v[216:217], v[216:217], v[118:119]
v_pk_fma_f32 v[242:243], v[72:73], v[72:73], v[242:243]
v_pk_add_f32 v[240:241], v[240:241], v[72:73]
v_pk_fma_f32 v[242:243], v[74:75], v[74:75], v[242:243]
v_pk_add_f32 v[240:241], v[240:241], v[74:75]
v_pk_fma_f32 v[218:219], v[120:121], v[120:121], v[218:219]
v_pk_add_f32 v[216:217], v[216:217], v[120:121]
v_pk_fma_f32 v[218:219], v[122:123], v[122:123], v[218:219]
v_pk_add_f32 v[216:217], v[216:217], v[122:123]
v_pk_fma_f32 v[242:243], v[76:77], v[76:77], v[242:243]
v_pk_add_f32 v[240:241], v[240:241], v[76:77]
v_pk_fma_f32 v[242:243], v[78:79], v[78:79], v[242:243]
v_pk_add_f32 v[240:241], v[240:241], v[78:79]
v_pk_fma_f32 v[218:219], v[124:125], v[124:125], v[218:219]
v_pk_add_f32 v[216:217], v[216:217], v[124:125]
v_pk_fma_f32 v[218:219], v[126:127], v[126:127], v[218:219]
v_pk_add_f32 v[216:217], v[216:217], v[126:127]
v_pk_fma_f32 v[242:243], v[80:81], v[80:81], v[242:243]
v_pk_add_f32 v[240:241], v[240:241], v[80:81]
v_pk_fma_f32 v[242:243], v[82:83], v[82:83], v[242:243]
v_pk_add_f32 v[240:241], v[240:241], v[82:83]
v_pk_fma_f32 v[218:219], v[128:129], v[128:129], v[218:219]
v_pk_add_f32 v[216:217], v[216:217], v[128:129]
v_pk_fma_f32 v[218:219], v[130:131], v[130:131], v[218:219]
v_pk_add_f32 v[216:217], v[216:217], v[130:131]
v_pk_fma_f32 v[242:243], v[84:85], v[84:85], v[242:243]
v_pk_add_f32 v[240:241], v[240:241], v[84:85]
v_pk_fma_f32 v[242:243], v[86:87], v[86:87], v[242:243]
v_pk_add_f32 v[240:241], v[240:241], v[86:87]
v_pk_fma_f32 v[218:219], v[132:133], v[132:133], v[218:219]
v_pk_add_f32 v[216:217], v[216:217], v[132:133]
v_pk_fma_f32 v[218:219], v[134:135], v[134:135], v[218:219]
v_pk_add_f32 v[216:217], v[216:217], v[134:135]
v_pk_fma_f32 v[242:243], v[88:89], v[88:89], v[242:243]
v_pk_add_f32 v[240:241], v[240:241], v[88:89]
v_pk_fma_f32 v[242:243], v[90:91], v[90:91], v[242:243]
v_pk_add_f32 v[240:241], v[240:241], v[90:91]
v_pk_fma_f32 v[218:219], v[136:137], v[136:137], v[218:219]
v_pk_add_f32 v[216:217], v[216:217], v[136:137]
v_pk_fma_f32 v[218:219], v[138:139], v[138:139], v[218:219]
v_pk_add_f32 v[216:217], v[216:217], v[138:139]
v_pk_fma_f32 v[242:243], v[92:93], v[92:93], v[242:243]
v_pk_add_f32 v[240:241], v[240:241], v[92:93]
v_pk_fma_f32 v[242:243], v[94:95], v[94:95], v[242:243]
v_pk_add_f32 v[240:241], v[240:241], v[94:95]
v_pk_fma_f32 v[218:219], v[140:141], v[140:141], v[218:219]
v_pk_add_f32 v[216:217], v[216:217], v[140:141]
v_pk_fma_f32 v[218:219], v[142:143], v[142:143], v[218:219]
v_pk_add_f32 v[216:217], v[216:217], v[142:143]
v_add_f32 v218, v218, v219
v_add_f32 v216, v216, v217
s_nop 1
v_permlane32_swap_b32 v216, v218
v_add_f32_e64 v216, v216, v218
v_mul_f32 v216, 1009429163, v216
v_mov_b32_e64 v218, v216
s_nop 1
v_permlane32_swap_b32 v216, v218
v_fma_f32 v218, -v216, v216, v218
v_max_f32_e64 v218, 0, v218
v_add_f32 v218, 925353388, v218
v_rsq_f32 v218, v218
v_add_f32 v240, v240, v241
v_mul_f32 v220, 3203396952, v218
v_mul_f32 v221, 3203396952, v218
v_mul_f32 v218, v216, v220
v_mul_f32 v219, v216, v220
v_add_f32 v242, v242, v243
s_nop 1
v_permlane32_swap_b32 v240, v242
v_add_f32 v240, v240, v242
v_mul_f32 v240, 1009429163, v240
v_mov_b32_e64 v242, v240
s_nop 1
v_permlane32_swap_b32 v240, v242
v_fma_f32 v242, -v240, v240, v242
v_max_f32_e64 v242, 0, v242
v_add_f32 v242, 925353388, v242
v_rsq_f32 v242, v242
s_nop 0
v_mul_f32 v244, 3203396952, v242
v_mul_f32 v245, 3203396952, v242
v_mul_f32 v242, v240, v244
v_mul_f32 v243, v240, v244
v_pk_fma_f32 v[48:49], v[48:49], v[244:245], v[242:243] neg_lo:[0,0,1] neg_hi:[0,0,1]
v_pk_fma_f32 v[50:51], v[50:51], v[244:245], v[242:243] neg_lo:[0,0,1] neg_hi:[0,0,1]
v_cvt_pk_bf16_f32 v48, v48, v49
v_cvt_pk_bf16_f32 v49, v50, v51
v_pk_fma_f32 v[52:53], v[52:53], v[244:245], v[242:243] neg_lo:[0,0,1] neg_hi:[0,0,1]
v_pk_fma_f32 v[54:55], v[54:55], v[244:245], v[242:243] neg_lo:[0,0,1] neg_hi:[0,0,1]
v_cvt_pk_bf16_f32 v50, v52, v53
v_cvt_pk_bf16_f32 v51, v54, v55
v_pk_fma_f32 v[56:57], v[56:57], v[244:245], v[242:243] neg_lo:[0,0,1] neg_hi:[0,0,1]
v_pk_fma_f32 v[58:59], v[58:59], v[244:245], v[242:243] neg_lo:[0,0,1] neg_hi:[0,0,1]
v_cvt_pk_bf16_f32 v52, v56, v57
v_cvt_pk_bf16_f32 v53, v58, v59
v_pk_fma_f32 v[60:61], v[60:61], v[244:245], v[242:243] neg_lo:[0,0,1] neg_hi:[0,0,1]
v_pk_fma_f32 v[62:63], v[62:63], v[244:245], v[242:243] neg_lo:[0,0,1] neg_hi:[0,0,1]
v_cvt_pk_bf16_f32 v54, v60, v61
v_cvt_pk_bf16_f32 v55, v62, v63
v_pk_fma_f32 v[64:65], v[64:65], v[244:245], v[242:243] neg_lo:[0,0,1] neg_hi:[0,0,1]
v_pk_fma_f32 v[66:67], v[66:67], v[244:245], v[242:243] neg_lo:[0,0,1] neg_hi:[0,0,1]
v_cvt_pk_bf16_f32 v56, v64, v65
v_cvt_pk_bf16_f32 v57, v66, v67
v_pk_fma_f32 v[68:69], v[68:69], v[244:245], v[242:243] neg_lo:[0,0,1] neg_hi:[0,0,1]
v_pk_fma_f32 v[70:71], v[70:71], v[244:245], v[242:243] neg_lo:[0,0,1] neg_hi:[0,0,1]
v_cvt_pk_bf16_f32 v58, v68, v69
v_cvt_pk_bf16_f32 v59, v70, v71
v_pk_fma_f32 v[72:73], v[72:73], v[244:245], v[242:243] neg_lo:[0,0,1] neg_hi:[0,0,1]
v_pk_fma_f32 v[74:75], v[74:75], v[244:245], v[242:243] neg_lo:[0,0,1] neg_hi:[0,0,1]
v_cvt_pk_bf16_f32 v60, v72, v73
v_cvt_pk_bf16_f32 v61, v74, v75
v_pk_fma_f32 v[76:77], v[76:77], v[244:245], v[242:243] neg_lo:[0,0,1] neg_hi:[0,0,1]
v_pk_fma_f32 v[78:79], v[78:79], v[244:245], v[242:243] neg_lo:[0,0,1] neg_hi:[0,0,1]
v_cvt_pk_bf16_f32 v62, v76, v77
v_cvt_pk_bf16_f32 v63, v78, v79
v_pk_fma_f32 v[80:81], v[80:81], v[244:245], v[242:243] neg_lo:[0,0,1] neg_hi:[0,0,1]
v_pk_fma_f32 v[82:83], v[82:83], v[244:245], v[242:243] neg_lo:[0,0,1] neg_hi:[0,0,1]
v_cvt_pk_bf16_f32 v64, v80, v81
v_cvt_pk_bf16_f32 v65, v82, v83
v_pk_fma_f32 v[84:85], v[84:85], v[244:245], v[242:243] neg_lo:[0,0,1] neg_hi:[0,0,1]
v_pk_fma_f32 v[86:87], v[86:87], v[244:245], v[242:243] neg_lo:[0,0,1] neg_hi:[0,0,1]
v_cvt_pk_bf16_f32 v66, v84, v85
v_cvt_pk_bf16_f32 v67, v86, v87
v_pk_fma_f32 v[88:89], v[88:89], v[244:245], v[242:243] neg_lo:[0,0,1] neg_hi:[0,0,1]
v_pk_fma_f32 v[90:91], v[90:91], v[244:245], v[242:243] neg_lo:[0,0,1] neg_hi:[0,0,1]
v_cvt_pk_bf16_f32 v68, v88, v89
v_cvt_pk_bf16_f32 v69, v90, v91
v_pk_fma_f32 v[92:93], v[92:93], v[244:245], v[242:243] neg_lo:[0,0,1] neg_hi:[0,0,1]
v_pk_fma_f32 v[94:95], v[94:95], v[244:245], v[242:243] neg_lo:[0,0,1] neg_hi:[0,0,1]
v_cvt_pk_bf16_f32 v70, v92, v93
v_cvt_pk_bf16_f32 v71, v94, v95
v_pk_fma_f32 v[96:97], v[96:97], v[220:221], v[218:219] neg_lo:[0,0,1] neg_hi:[0,0,1]
ds_read_b128 v[176:179], v250
v_cvt_pk_bf16_f32 v72, v96, v97
v_pk_fma_f32 v[98:99], v[98:99], v[220:221], v[218:219] neg_lo:[0,0,1] neg_hi:[0,0,1]
v_pk_fma_f32 v[100:101], v[100:101], v[220:221], v[218:219] neg_lo:[0,0,1] neg_hi:[0,0,1]
v_cvt_pk_bf16_f32 v73, v98, v99
v_cvt_pk_bf16_f32 v74, v100, v101
v_pk_fma_f32 v[102:103], v[102:103], v[220:221], v[218:219] neg_lo:[0,0,1] neg_hi:[0,0,1]
v_pk_fma_f32 v[104:105], v[104:105], v[220:221], v[218:219] neg_lo:[0,0,1] neg_hi:[0,0,1]
v_cvt_pk_bf16_f32 v75, v102, v103
v_cvt_pk_bf16_f32 v76, v104, v105
v_pk_fma_f32 v[106:107], v[106:107], v[220:221], v[218:219] neg_lo:[0,0,1] neg_hi:[0,0,1]
v_pk_fma_f32 v[108:109], v[108:109], v[220:221], v[218:219] neg_lo:[0,0,1] neg_hi:[0,0,1]
v_cvt_pk_bf16_f32 v77, v106, v107
v_cvt_pk_bf16_f32 v78, v108, v109
v_pk_fma_f32 v[110:111], v[110:111], v[220:221], v[218:219] neg_lo:[0,0,1] neg_hi:[0,0,1]
v_pk_fma_f32 v[112:113], v[112:113], v[220:221], v[218:219] neg_lo:[0,0,1] neg_hi:[0,0,1]
v_cvt_pk_bf16_f32 v79, v110, v111
v_cvt_pk_bf16_f32 v80, v112, v113
v_pk_fma_f32 v[114:115], v[114:115], v[220:221], v[218:219] neg_lo:[0,0,1] neg_hi:[0,0,1]
v_pk_fma_f32 v[116:117], v[116:117], v[220:221], v[218:219] neg_lo:[0,0,1] neg_hi:[0,0,1]
v_cvt_pk_bf16_f32 v81, v114, v115
v_cvt_pk_bf16_f32 v82, v116, v117
v_pk_fma_f32 v[118:119], v[118:119], v[220:221], v[218:219] neg_lo:[0,0,1] neg_hi:[0,0,1]
v_pk_fma_f32 v[120:121], v[120:121], v[220:221], v[218:219] neg_lo:[0,0,1] neg_hi:[0,0,1]
ds_read_b128 v[180:183], v250 offset:1024
v_cvt_pk_bf16_f32 v83, v118, v119
v_cvt_pk_bf16_f32 v84, v120, v121
v_pk_fma_f32 v[122:123], v[122:123], v[220:221], v[218:219] neg_lo:[0,0,1] neg_hi:[0,0,1]
v_pk_fma_f32 v[124:125], v[124:125], v[220:221], v[218:219] neg_lo:[0,0,1] neg_hi:[0,0,1]
v_cvt_pk_bf16_f32 v85, v122, v123
v_cvt_pk_bf16_f32 v86, v124, v125
v_pk_fma_f32 v[126:127], v[126:127], v[220:221], v[218:219] neg_lo:[0,0,1] neg_hi:[0,0,1]
v_pk_fma_f32 v[128:129], v[128:129], v[220:221], v[218:219] neg_lo:[0,0,1] neg_hi:[0,0,1]
v_cvt_pk_bf16_f32 v87, v126, v127
v_cvt_pk_bf16_f32 v88, v128, v129
v_pk_fma_f32 v[130:131], v[130:131], v[220:221], v[218:219] neg_lo:[0,0,1] neg_hi:[0,0,1]
v_pk_fma_f32 v[132:133], v[132:133], v[220:221], v[218:219] neg_lo:[0,0,1] neg_hi:[0,0,1]
v_cvt_pk_bf16_f32 v89, v130, v131
v_cvt_pk_bf16_f32 v90, v132, v133
v_pk_fma_f32 v[134:135], v[134:135], v[220:221], v[218:219] neg_lo:[0,0,1] neg_hi:[0,0,1]
v_pk_fma_f32 v[136:137], v[136:137], v[220:221], v[218:219] neg_lo:[0,0,1] neg_hi:[0,0,1]
v_cvt_pk_bf16_f32 v91, v134, v135
v_cvt_pk_bf16_f32 v92, v136, v137
v_pk_fma_f32 v[138:139], v[138:139], v[220:221], v[218:219] neg_lo:[0,0,1] neg_hi:[0,0,1]
v_pk_fma_f32 v[140:141], v[140:141], v[220:221], v[218:219] neg_lo:[0,0,1] neg_hi:[0,0,1]
v_cvt_pk_bf16_f32 v93, v138, v139
v_cvt_pk_bf16_f32 v94, v140, v141
v_pk_fma_f32 v[142:143], v[142:143], v[220:221], v[218:219] neg_lo:[0,0,1] neg_hi:[0,0,1]
ds_read_b128 v[184:187], v250 offset:2048
v_cvt_pk_bf16_f32 v95, v142, v143
v_cndmask_b32 v216, 0, v255, s[50:51]
v_and_b32 v216, 1006648320, v216
v_cndmask_b32 v217, 0, v255, s[52:53]
v_and_b32 v217, 1006648320, v217
v_cndmask_b32 v218, 0, v255, s[54:55]
v_and_b32 v218, 1006648320, v218
v_cndmask_b32 v219, 0, v255, s[56:57]
v_and_b32 v219, 1006648320, v219
v_cndmask_b32 v220, 0, v255, s[58:59]
v_and_b32 v220, 1006648320, v220
v_cndmask_b32 v221, 0, v255, s[60:61]
v_and_b32 v221, 1006648320, v221
v_cndmask_b32 v222, 0, v255, s[62:63]
v_and_b32 v222, 1006648320, v222
v_cndmask_b32 v223, 0, v255, s[64:65]
v_and_b32 v223, 1006648320, v223
s_waitcnt lgkmcnt(1)
v_mfma_f32_32x32x16_bf16 v[144:159], v[48:51], v[176:179], 0
s_cmp_lt_u32 s40, 4
s_cbranch_scc0 Lbk
s_setprio 2
Lbk:
ds_read_b128 v[188:191], v250 offset:3072
v_mfma_f32_32x32x16_bf16 v[160:175], v[72:75], v[176:179], 0
ds_read_b128 v[176:179], v250 offset:4096
v_mfma_f32_32x32x16_bf16 v[144:159], v[52:55], v[180:183], v[144:159]
v_mfma_f32_32x32x16_bf16 v[160:175], v[76:79], v[180:183], v[160:175]
ds_read_b128 v[180:183], v250 offset:5120
s_waitcnt lgkmcnt(3)
v_mfma_f32_32x32x16_bf16 v[144:159], v[56:59], v[184:187], v[144:159]
v_mfma_f32_32x32x16_bf16 v[160:175], v[80:83], v[184:187], v[160:175]
ds_read_b128 v[184:187], v250 offset:6144
s_waitcnt lgkmcnt(2)
v_mfma_f32_32x32x16_bf16 v[144:159], v[60:63], v[188:191], v[144:159]
v_mfma_f32_32x32x16_bf16 v[160:175], v[84:87], v[188:191], v[160:175]
ds_read_b128 v[188:191], v250 offset:7168
v_mfma_f32_32x32x16_bf16 v[144:159], v[64:67], v[176:179], v[144:159]
v_mfma_f32_32x32x16_bf16 v[160:175], v[88:91], v[176:179], v[160:175]
ds_read_b128 v[176:179], v250 offset:8192
s_waitcnt lgkmcnt(2)
v_mfma_f32_32x32x16_bf16 v[144:159], v[68:71], v[180:183], v[144:159]
v_mfma_f32_32x32x16_bf16 v[160:175], v[92:95], v[180:183], v[160:175]
ds_read_b128 v[180:183], v250 offset:9216
s_nop 9
v_cvt_pkrtz_f16_f32 v144, v144, v145
v_mfma_f32_32x32x16_bf16 v[112:127], v[48:51], v[184:187], 0
v_cvt_pkrtz_f16_f32 v145, v146, v147
v_lshrrev_b64 v[144:145], 2, v[144:145]
v_and_b32_sdwa v146, s47, v144 dst_sel:DWORD dst_unused:UNUSED_PAD src0_sel:DWORD src1_sel:WORD_1
v_and_b32_e64 v144, s47, v144
v_cvt_pk_f16_f32 v156, v156, v157
v_cvt_pk_f16_f32 v158, v158, v159
v_mfma_f32_32x32x16_bf16 v[128:143], v[72:75], v[184:187], 0
ds_read_u16 v146, v146
ds_read_u16 v144, v144
v_pk_fma_f16 v157, v156, v156, s48
v_and_b32_sdwa v147, s47, v145 dst_sel:DWORD dst_unused:UNUSED_PAD src0_sel:DWORD src1_sel:WORD_1
v_and_b32_e64 v145, s47, v145
v_pk_fma_f16 v159, v158, v158, s48
v_pk_mul_f16 v157, v156, v157
v_pk_mul_f16 v159, v158, v159
v_cvt_pkrtz_f16_f32 v148, v148, v149
v_cvt_pkrtz_f16_f32 v149, v150, v151
v_lshrrev_b64 v[148:149], 2, v[148:149]
ds_read_u16 v147, v147
ds_read_u16 v145, v145
v_and_b32_sdwa v150, s47, v148 dst_sel:DWORD dst_unused:UNUSED_PAD src0_sel:DWORD src1_sel:WORD_1
v_and_b32 v148, s47, v148
v_exp_f16_sdwa v157, v157 dst_sel:WORD_0 dst_unused:UNUSED_PRESERVE src0_sel:WORD_0
s_waitcnt lgkmcnt(4)
v_mfma_f32_32x32x16_bf16 v[112:127], v[52:55], v[188:191], v[112:127]
ds_read_u16 v150, v150
ds_read_u16 v148, v148
v_exp_f16_sdwa v159, v159 dst_sel:WORD_0 dst_unused:UNUSED_PRESERVE src0_sel:WORD_0
v_and_b32_sdwa v151, s47, v149 dst_sel:DWORD dst_unused:UNUSED_PAD src0_sel:DWORD src1_sel:WORD_1
v_and_b32_e64 v149, s47, v149
v_exp_f16_sdwa v157, v157 dst_sel:WORD_1 dst_unused:UNUSED_PRESERVE src0_sel:WORD_1
v_cvt_pkrtz_f16_f32 v152, v152, v153
v_cvt_pkrtz_f16_f32 v153, v154, v155
v_lshrrev_b64 v[152:153], 2, v[152:153]
v_and_b32_sdwa v154, s47, v152 dst_sel:DWORD dst_unused:UNUSED_PAD src0_sel:DWORD src1_sel:WORD_1
v_and_b32_e64 v152, s47, v152
ds_read_u16 v151, v151
ds_read_u16 v149, v149
ds_read_u16 v154, v154
ds_read_u16 v152, v152
v_mfma_f32_32x32x16_bf16 v[128:143], v[76:79], v[188:191], v[128:143]
v_exp_f16_sdwa v159, v159 dst_sel:WORD_1 dst_unused:UNUSED_PRESERVE src0_sel:WORD_1
v_and_b32_sdwa v155, s47, v153 dst_sel:DWORD dst_unused:UNUSED_PAD src0_sel:DWORD src1_sel:WORD_1
v_and_b32_e64 v153, s47, v153
v_pk_add_f16 v157, v157, 1.0 op_sel_hi:[1,0]
v_pk_add_f16 v159, v159, 1.0 op_sel_hi:[1,0]
v_rcp_f16_sdwa v157, v157 dst_sel:WORD_0 dst_unused:UNUSED_PRESERVE src0_sel:WORD_0
v_mfma_f32_32x32x16_bf16 v[112:127], v[56:59], v[176:179], v[112:127]
ds_read_b128 v[184:187], v250 offset:10240
ds_read_u16 v155, v155
ds_read_u16 v153, v153
v_rcp_f16_sdwa v159, v159 dst_sel:WORD_0 dst_unused:UNUSED_PRESERVE src0_sel:WORD_0
v_rcp_f16_sdwa v157, v157 dst_sel:WORD_1 dst_unused:UNUSED_PRESERVE src0_sel:WORD_1
v_mfma_f32_32x32x16_bf16 v[128:143], v[80:83], v[176:179], v[128:143]
v_rcp_f16_sdwa v159, v159 dst_sel:WORD_1 dst_unused:UNUSED_PRESERVE src0_sel:WORD_1
v_pk_mul_f16 v156, v156, v157
v_pk_mul_f16 v158, v158, v159
v_fma_mix_f32 v224, v156, v156, v224 op_sel_hi:[1,1,0]
v_mfma_f32_32x32x16_bf16 v[112:127], v[60:63], v[180:183], v[112:127]
ds_read_b128 v[188:191], v250 offset:11264
v_fma_mix_f32 v224, v158, v158, v224 op_sel_hi:[1,1,0]
v_cvt_pkrtz_f16_f32 v160, v160, v161
v_fma_mix_f32 v224, v156, v156, v224 op_sel:[1,1,0] op_sel_hi:[1,1,0]
v_cvt_pkrtz_f16_f32 v161, v162, v163
v_fma_mix_f32 v224, v158, v158, v224 op_sel:[1,1,0] op_sel_hi:[1,1,0]
v_lshrrev_b64 v[160:161], 2, v[160:161]
s_waitcnt lgkmcnt(7)
v_fma_mix_f32 v224, v144, v144, v224 op_sel_hi:[1,1,0]
v_and_b32_sdwa v162, s47, v160 dst_sel:DWORD dst_unused:UNUSED_PAD src0_sel:DWORD src1_sel:WORD_1
v_fma_mix_f32 v224, v145, v145, v224 op_sel_hi:[1,1,0]
v_and_b32 v160, s47, v160
v_fma_mix_f32 v224, v146, v146, v224 op_sel_hi:[1,1,0]
v_cvt_pk_f16_f32 v172, v172, v173
v_fma_mix_f32 v224, v147, v147, v224 op_sel_hi:[1,1,0]
v_cvt_pk_f16_f32 v174, v174, v175
v_mfma_f32_32x32x16_bf16 v[128:143], v[84:87], v[180:183], v[128:143]
ds_read_u16 v162, v162
ds_read_u16 v160, v160
v_pk_fma_f16 v173, v172, v172, s48
v_fma_mix_f32 v224, v148, v148, v224 op_sel_hi:[1,1,0]
v_and_b32_sdwa v163, s47, v161 dst_sel:DWORD dst_unused:UNUSED_PAD src0_sel:DWORD src1_sel:WORD_1
s_waitcnt lgkmcnt(6)
v_fma_mix_f32 v224, v149, v149, v224 op_sel_hi:[1,1,0]
v_and_b32 v161, s47, v161
v_pk_fma_f16 v175, v174, v174, s48
v_pk_mul_f16 v173, v172, v173
v_pk_mul_f16 v175, v174, v175
v_fma_mix_f32 v224, v150, v150, v224 op_sel_hi:[1,1,0]
v_cvt_pkrtz_f16_f32 v164, v164, v165
v_fma_mix_f32 v224, v151, v151, v224 op_sel_hi:[1,1,0]
ds_read_u16 v163, v163
ds_read_u16 v161, v161
ds_read_b128 v[176:179], v250 offset:12288
v_cvt_pkrtz_f16_f32 v165, v166, v167
v_lshrrev_b64 v[164:165], 2, v[164:165]
v_and_b32_sdwa v166, s47, v164 dst_sel:DWORD dst_unused:UNUSED_PAD src0_sel:DWORD src1_sel:WORD_1
v_and_b32 v164, s47, v164
v_exp_f16_sdwa v173, v173 dst_sel:WORD_0 dst_unused:UNUSED_PRESERVE src0_sel:WORD_0
s_waitcnt lgkmcnt(6)
v_mfma_f32_32x32x16_bf16 v[112:127], v[64:67], v[184:187], v[112:127]
ds_read_u16 v166, v166
ds_read_u16 v164, v164
v_fma_mix_f32 v224, v152, v152, v224 op_sel_hi:[1,1,0]
v_exp_f16_sdwa v175, v175 dst_sel:WORD_0 dst_unused:UNUSED_PRESERVE src0_sel:WORD_0
v_fma_mix_f32 v224, v153, v153, v224 op_sel_hi:[1,1,0]
v_and_b32_sdwa v167, s47, v165 dst_sel:DWORD dst_unused:UNUSED_PAD src0_sel:DWORD src1_sel:WORD_1
v_and_b32_e64 v165, s47, v165
v_exp_f16_sdwa v173, v173 dst_sel:WORD_1 dst_unused:UNUSED_PRESERVE src0_sel:WORD_1
v_fma_mix_f32 v224, v154, v154, v224 op_sel_hi:[1,1,0]
v_cvt_pkrtz_f16_f32 v168, v168, v169
v_fma_mix_f32 v224, v155, v155, v224 op_sel_hi:[1,1,0]
v_cvt_pkrtz_f16_f32 v169, v170, v171
v_lshrrev_b64 v[168:169], 2, v[168:169]
ds_read_u16 v167, v167
ds_read_u16 v165, v165
v_and_b32_sdwa v170, s47, v168 dst_sel:DWORD dst_unused:UNUSED_PAD src0_sel:DWORD src1_sel:WORD_1
v_and_b32_e64 v168, s47, v168
v_mfma_f32_32x32x16_bf16 v[128:143], v[88:91], v[184:187], v[128:143]
ds_read_u16 v170, v170
ds_read_u16 v168, v168
v_exp_f16_sdwa v175, v175 dst_sel:WORD_1 dst_unused:UNUSED_PRESERVE src0_sel:WORD_1
v_and_b32_sdwa v171, s47, v169 dst_sel:DWORD dst_unused:UNUSED_PAD src0_sel:DWORD src1_sel:WORD_1
v_and_b32 v169, s47, v169
v_pk_add_f16 v173, v173, 1.0 op_sel_hi:[1,0]
v_pk_add_f16 v175, v175, 1.0 op_sel_hi:[1,0]
v_rcp_f16_sdwa v173, v173 dst_sel:WORD_0 dst_unused:UNUSED_PRESERVE src0_sel:WORD_0
s_waitcnt lgkmcnt(6)
v_mfma_f32_32x32x16_bf16 v[112:127], v[68:71], v[188:191], v[112:127]
ds_read_b128 v[180:183], v250 offset:13312
ds_read_u16 v171, v171
ds_read_u16 v169, v169
v_rcp_f16_sdwa v175, v175 dst_sel:WORD_0 dst_unused:UNUSED_PRESERVE src0_sel:WORD_0
v_rcp_f16_sdwa v173, v173 dst_sel:WORD_1 dst_unused:UNUSED_PRESERVE src0_sel:WORD_1
v_mfma_f32_32x32x16_bf16 v[128:143], v[92:95], v[188:191], v[128:143]
v_rcp_f16_sdwa v175, v175 dst_sel:WORD_1 dst_unused:UNUSED_PRESERVE src0_sel:WORD_1
v_pk_mul_f16 v172, v172, v173
v_pk_mul_f16 v174, v174, v175
v_fma_mix_f32 v224, v172, v172, v224 op_sel_hi:[1,1,0]
v_mfma_f32_32x32x16_bf16 v[96:111], v[48:51], v[176:179], 0
ds_read_b128 v[184:187], v250 offset:14336
v_fma_mix_f32 v224, v174, v174, v224 op_sel_hi:[1,1,0]
v_cvt_pkrtz_f16_f32 v112, v112, v113
v_fma_mix_f32 v224, v172, v172, v224 op_sel:[1,1,0] op_sel_hi:[1,1,0]
v_cvt_pkrtz_f16_f32 v113, v114, v115
v_fma_mix_f32 v224, v174, v174, v224 op_sel:[1,1,0] op_sel_hi:[1,1,0]
v_lshrrev_b64 v[112:113], 2, v[112:113]
v_fma_mix_f32 v224, v160, v160, v224 op_sel_hi:[1,1,0]
v_and_b32_sdwa v114, s47, v112 dst_sel:DWORD dst_unused:UNUSED_PAD src0_sel:DWORD src1_sel:WORD_1
v_fma_mix_f32 v224, v161, v161, v224 op_sel_hi:[1,1,0]
v_and_b32_e64 v112, s47, v112
v_fma_mix_f32 v224, v162, v162, v224 op_sel_hi:[1,1,0]
v_cvt_pk_f16_f32 v124, v124, v125
v_fma_mix_f32 v224, v163, v163, v224 op_sel_hi:[1,1,0]
v_cvt_pk_f16_f32 v126, v126, v127
v_mfma_f32_32x32x16_bf16 v[144:159], v[176:179], v[72:75], 0
ds_read_u16 v114, v114
ds_read_u16 v112, v112
v_pk_fma_f16 v125, v124, v124, s48
s_waitcnt lgkmcnt(5)
v_fma_mix_f32 v224, v164, v164, v224 op_sel_hi:[1,1,0]
v_and_b32_sdwa v115, s47, v113 dst_sel:DWORD dst_unused:UNUSED_PAD src0_sel:DWORD src1_sel:WORD_1
v_fma_mix_f32 v224, v165, v165, v224 op_sel_hi:[1,1,0]
v_and_b32 v113, s47, v113
v_pk_fma_f16 v127, v126, v126, s48
v_pk_mul_f16 v125, v124, v125
v_pk_mul_f16 v127, v126, v127
v_fma_mix_f32 v224, v166, v166, v224 op_sel_hi:[1,1,0]
v_cvt_pkrtz_f16_f32 v116, v116, v117
v_fma_mix_f32 v224, v167, v167, v224 op_sel_hi:[1,1,0]
ds_read_u16 v115, v115
ds_read_u16 v113, v113
ds_read_b128 v[188:191], v250 offset:15360
v_cvt_pkrtz_f16_f32 v117, v118, v119
v_lshrrev_b64 v[116:117], 2, v[116:117]
v_and_b32_sdwa v118, s47, v116 dst_sel:DWORD dst_unused:UNUSED_PAD src0_sel:DWORD src1_sel:WORD_1
v_and_b32_e64 v116, s47, v116
v_exp_f16_sdwa v125, v125 dst_sel:WORD_0 dst_unused:UNUSED_PRESERVE src0_sel:WORD_0
v_mfma_f32_32x32x16_bf16 v[96:111], v[52:55], v[180:183], v[96:111]
ds_read_u16 v118, v118
ds_read_u16 v116, v116
v_fma_mix_f32 v224, v168, v168, v224 op_sel_hi:[1,1,0]
v_exp_f16_sdwa v127, v127 dst_sel:WORD_0 dst_unused:UNUSED_PRESERVE src0_sel:WORD_0
s_waitcnt lgkmcnt(7)
v_fma_mix_f32 v224, v169, v169, v224 op_sel_hi:[1,1,0]
v_and_b32_sdwa v119, s47, v117 dst_sel:DWORD dst_unused:UNUSED_PAD src0_sel:DWORD src1_sel:WORD_1
v_and_b32 v117, s47, v117
v_exp_f16_sdwa v125, v125 dst_sel:WORD_1 dst_unused:UNUSED_PRESERVE src0_sel:WORD_1
v_fma_mix_f32 v224, v170, v170, v224 op_sel_hi:[1,1,0]
v_cvt_pkrtz_f16_f32 v120, v120, v121
v_fma_mix_f32 v224, v171, v171, v224 op_sel_hi:[1,1,0]
v_cvt_pkrtz_f16_f32 v121, v122, v123
v_lshrrev_b64 v[120:121], 2, v[120:121]
ds_read_u16 v119, v119
ds_read_u16 v117, v117
v_and_b32_sdwa v122, s47, v120 dst_sel:DWORD dst_unused:UNUSED_PAD src0_sel:DWORD src1_sel:WORD_1
v_and_b32_e64 v120, s47, v120
v_mfma_f32_32x32x16_bf16 v[144:159], v[180:183], v[76:79], v[144:159]
ds_read_u16 v122, v122
ds_read_u16 v120, v120
v_exp_f16_sdwa v127, v127 dst_sel:WORD_1 dst_unused:UNUSED_PRESERVE src0_sel:WORD_1
v_and_b32_sdwa v123, s47, v121 dst_sel:DWORD dst_unused:UNUSED_PAD src0_sel:DWORD src1_sel:WORD_1
v_and_b32_e64 v121, s47, v121
v_pk_add_f16 v125, v125, 1.0 op_sel_hi:[1,0]
v_pk_add_f16 v127, v127, 1.0 op_sel_hi:[1,0]
v_rcp_f16_sdwa v125, v125 dst_sel:WORD_0 dst_unused:UNUSED_PRESERVE src0_sel:WORD_0
v_mfma_f32_32x32x16_bf16 v[96:111], v[56:59], v[184:187], v[96:111]
ds_read_b128 v[176:179], v250 offset:16384
ds_read_u16 v123, v123
ds_read_u16 v121, v121
v_rcp_f16_sdwa v127, v127 dst_sel:WORD_0 dst_unused:UNUSED_PRESERVE src0_sel:WORD_0
v_rcp_f16_sdwa v125, v125 dst_sel:WORD_1 dst_unused:UNUSED_PRESERVE src0_sel:WORD_1
v_mfma_f32_32x32x16_bf16 v[144:159], v[184:187], v[80:83], v[144:159]
v_rcp_f16_sdwa v127, v127 dst_sel:WORD_1 dst_unused:UNUSED_PRESERVE src0_sel:WORD_1
v_pk_mul_f16 v124, v124, v125
v_pk_mul_f16 v126, v126, v127
v_fma_mix_f32 v225, v124, v124, v225 op_sel_hi:[1,1,0]
s_waitcnt lgkmcnt(7)
v_mfma_f32_32x32x16_bf16 v[96:111], v[60:63], v[188:191], v[96:111]
ds_read_b128 v[180:183], v250 offset:17408
v_fma_mix_f32 v225, v126, v126, v225 op_sel_hi:[1,1,0]
v_cvt_pkrtz_f16_f32 v128, v128, v129
v_fma_mix_f32 v225, v124, v124, v225 op_sel:[1,1,0] op_sel_hi:[1,1,0]
v_cvt_pkrtz_f16_f32 v129, v130, v131
v_fma_mix_f32 v225, v126, v126, v225 op_sel:[1,1,0] op_sel_hi:[1,1,0]
v_lshrrev_b64 v[128:129], 2, v[128:129]
v_fma_mix_f32 v225, v112, v112, v225 op_sel_hi:[1,1,0]
v_and_b32_sdwa v130, s47, v128 dst_sel:DWORD dst_unused:UNUSED_PAD src0_sel:DWORD src1_sel:WORD_1
v_fma_mix_f32 v225, v113, v113, v225 op_sel_hi:[1,1,0]
v_and_b32 v128, s47, v128
v_fma_mix_f32 v225, v114, v114, v225 op_sel_hi:[1,1,0]
v_cvt_pk_f16_f32 v140, v140, v141
v_fma_mix_f32 v225, v115, v115, v225 op_sel_hi:[1,1,0]
v_cvt_pk_f16_f32 v142, v142, v143
v_mfma_f32_32x32x16_bf16 v[144:159], v[188:191], v[84:87], v[144:159]
ds_read_u16 v130, v130
ds_read_u16 v128, v128
v_pk_fma_f16 v141, v140, v140, s48
v_fma_mix_f32 v225, v116, v116, v225 op_sel_hi:[1,1,0]
v_and_b32_sdwa v131, s47, v129 dst_sel:DWORD dst_unused:UNUSED_PAD src0_sel:DWORD src1_sel:WORD_1
s_waitcnt lgkmcnt(5)
v_fma_mix_f32 v225, v117, v117, v225 op_sel_hi:[1,1,0]
v_and_b32 v129, s47, v129
v_pk_fma_f16 v143, v142, v142, s48
v_pk_mul_f16 v141, v140, v141
v_pk_mul_f16 v143, v142, v143
v_fma_mix_f32 v225, v118, v118, v225 op_sel_hi:[1,1,0]
v_cvt_pkrtz_f16_f32 v132, v132, v133
v_fma_mix_f32 v225, v119, v119, v225 op_sel_hi:[1,1,0]
ds_read_u16 v131, v131
ds_read_u16 v129, v129
ds_read_b128 v[184:187], v250 offset:18432
v_cvt_pkrtz_f16_f32 v133, v134, v135
v_lshrrev_b64 v[132:133], 2, v[132:133]
v_and_b32_sdwa v134, s47, v132 dst_sel:DWORD dst_unused:UNUSED_PAD src0_sel:DWORD src1_sel:WORD_1
v_and_b32_e64 v132, s47, v132
v_exp_f16_sdwa v141, v141 dst_sel:WORD_0 dst_unused:UNUSED_PRESERVE src0_sel:WORD_0
v_mfma_f32_32x32x16_bf16 v[96:111], v[64:67], v[176:179], v[96:111]
ds_read_u16 v134, v134
ds_read_u16 v132, v132
v_fma_mix_f32 v225, v120, v120, v225 op_sel_hi:[1,1,0]
v_exp_f16_sdwa v143, v143 dst_sel:WORD_0 dst_unused:UNUSED_PRESERVE src0_sel:WORD_0
s_waitcnt lgkmcnt(7)
v_fma_mix_f32 v225, v121, v121, v225 op_sel_hi:[1,1,0]
v_and_b32_sdwa v135, s47, v133 dst_sel:DWORD dst_unused:UNUSED_PAD src0_sel:DWORD src1_sel:WORD_1
v_and_b32 v133, s47, v133
v_exp_f16_sdwa v141, v141 dst_sel:WORD_1 dst_unused:UNUSED_PRESERVE src0_sel:WORD_1
v_fma_mix_f32 v225, v122, v122, v225 op_sel_hi:[1,1,0]
v_cvt_pkrtz_f16_f32 v136, v136, v137
v_fma_mix_f32 v225, v123, v123, v225 op_sel_hi:[1,1,0]
v_cvt_pkrtz_f16_f32 v137, v138, v139
v_lshrrev_b64 v[136:137], 2, v[136:137]
ds_read_u16 v135, v135
ds_read_u16 v133, v133
v_and_b32_sdwa v138, s47, v136 dst_sel:DWORD dst_unused:UNUSED_PAD src0_sel:DWORD src1_sel:WORD_1
v_and_b32_e64 v136, s47, v136
v_mfma_f32_32x32x16_bf16 v[144:159], v[176:179], v[88:91], v[144:159]
ds_read_u16 v138, v138
ds_read_u16 v136, v136
v_exp_f16_sdwa v143, v143 dst_sel:WORD_1 dst_unused:UNUSED_PRESERVE src0_sel:WORD_1
v_and_b32_sdwa v139, s47, v137 dst_sel:DWORD dst_unused:UNUSED_PAD src0_sel:DWORD src1_sel:WORD_1
v_and_b32_e64 v137, s47, v137
v_pk_add_f16 v141, v141, 1.0 op_sel_hi:[1,0]
v_pk_add_f16 v143, v143, 1.0 op_sel_hi:[1,0]
v_rcp_f16_sdwa v141, v141 dst_sel:WORD_0 dst_unused:UNUSED_PRESERVE src0_sel:WORD_0
v_mfma_f32_32x32x16_bf16 v[96:111], v[68:71], v[180:183], v[96:111]
ds_read_b128 v[188:191], v250 offset:19456
ds_read_u16 v139, v139
ds_read_u16 v137, v137
v_rcp_f16_sdwa v143, v143 dst_sel:WORD_0 dst_unused:UNUSED_PRESERVE src0_sel:WORD_0
v_rcp_f16_sdwa v141, v141 dst_sel:WORD_1 dst_unused:UNUSED_PRESERVE src0_sel:WORD_1
v_mfma_f32_32x32x16_bf16 v[144:159], v[180:183], v[92:95], v[144:159]
v_rcp_f16_sdwa v143, v143 dst_sel:WORD_1 dst_unused:UNUSED_PRESERVE src0_sel:WORD_1
v_pk_mul_f16 v140, v140, v141
v_pk_mul_f16 v142, v142, v143
v_fma_mix_f32 v225, v140, v140, v225 op_sel_hi:[1,1,0]
s_waitcnt lgkmcnt(7)
v_mfma_f32_32x32x16_bf16 v[160:175], v[48:51], v[184:187], 0
ds_read_b128 v[176:179], v250 offset:20480
v_fma_mix_f32 v225, v142, v142, v225 op_sel_hi:[1,1,0]
v_cvt_pkrtz_f16_f32 v96, v96, v97
v_fma_mix_f32 v225, v140, v140, v225 op_sel:[1,1,0] op_sel_hi:[1,1,0]
v_cvt_pkrtz_f16_f32 v97, v98, v99
v_fma_mix_f32 v225, v142, v142, v225 op_sel:[1,1,0] op_sel_hi:[1,1,0]
v_lshrrev_b64 v[96:97], 2, v[96:97]
v_fma_mix_f32 v225, v128, v128, v225 op_sel_hi:[1,1,0]
v_and_b32_sdwa v98, s47, v96 dst_sel:DWORD dst_unused:UNUSED_PAD src0_sel:DWORD src1_sel:WORD_1
v_fma_mix_f32 v225, v129, v129, v225 op_sel_hi:[1,1,0]
v_and_b32 v96, s47, v96
v_fma_mix_f32 v225, v130, v130, v225 op_sel_hi:[1,1,0]
v_cvt_pk_f16_f32 v108, v108, v109
v_fma_mix_f32 v225, v131, v131, v225 op_sel_hi:[1,1,0]
v_cvt_pk_f16_f32 v110, v110, v111
v_mfma_f32_32x32x16_bf16 v[112:127], v[184:187], v[72:75], 0
ds_read_u16 v98, v98
ds_read_u16 v96, v96
v_pk_fma_f16 v109, v108, v108, s48
v_fma_mix_f32 v225, v132, v132, v225 op_sel_hi:[1,1,0]
v_and_b32_sdwa v99, s47, v97 dst_sel:DWORD dst_unused:UNUSED_PAD src0_sel:DWORD src1_sel:WORD_1
s_waitcnt lgkmcnt(5)
v_fma_mix_f32 v225, v133, v133, v225 op_sel_hi:[1,1,0]
v_and_b32 v97, s47, v97
v_pk_fma_f16 v111, v110, v110, s48
v_pk_mul_f16 v109, v108, v109
v_pk_mul_f16 v111, v110, v111
v_fma_mix_f32 v225, v134, v134, v225 op_sel_hi:[1,1,0]
v_cvt_pkrtz_f16_f32 v100, v100, v101
v_fma_mix_f32 v225, v135, v135, v225 op_sel_hi:[1,1,0]
ds_read_u16 v99, v99
ds_read_u16 v97, v97
ds_read_b128 v[180:183], v250 offset:21504
v_cvt_pkrtz_f16_f32 v101, v102, v103
v_lshrrev_b64 v[100:101], 2, v[100:101]
v_and_b32_sdwa v102, s47, v100 dst_sel:DWORD dst_unused:UNUSED_PAD src0_sel:DWORD src1_sel:WORD_1
v_and_b32_e64 v100, s47, v100
v_exp_f16_sdwa v109, v109 dst_sel:WORD_0 dst_unused:UNUSED_PRESERVE src0_sel:WORD_0
v_mfma_f32_32x32x16_bf16 v[160:175], v[52:55], v[188:191], v[160:175]
ds_read_u16 v102, v102
ds_read_u16 v100, v100
v_fma_mix_f32 v225, v136, v136, v225 op_sel_hi:[1,1,0]
v_exp_f16_sdwa v111, v111 dst_sel:WORD_0 dst_unused:UNUSED_PRESERVE src0_sel:WORD_0
s_waitcnt lgkmcnt(7)
v_fma_mix_f32 v225, v137, v137, v225 op_sel_hi:[1,1,0]
v_and_b32_sdwa v103, s47, v101 dst_sel:DWORD dst_unused:UNUSED_PAD src0_sel:DWORD src1_sel:WORD_1
v_and_b32 v101, s47, v101
v_exp_f16_sdwa v109, v109 dst_sel:WORD_1 dst_unused:UNUSED_PRESERVE src0_sel:WORD_1
v_fma_mix_f32 v225, v138, v138, v225 op_sel_hi:[1,1,0]
v_cvt_pkrtz_f16_f32 v104, v104, v105
v_fma_mix_f32 v225, v139, v139, v225 op_sel_hi:[1,1,0]
v_cvt_pkrtz_f16_f32 v105, v106, v107
v_lshrrev_b64 v[104:105], 2, v[104:105]
ds_read_u16 v103, v103
ds_read_u16 v101, v101
v_and_b32_sdwa v106, s47, v104 dst_sel:DWORD dst_unused:UNUSED_PAD src0_sel:DWORD src1_sel:WORD_1
v_and_b32_e64 v104, s47, v104
v_mfma_f32_32x32x16_bf16 v[112:127], v[188:191], v[76:79], v[112:127]
ds_read_u16 v106, v106
ds_read_u16 v104, v104
v_exp_f16_sdwa v111, v111 dst_sel:WORD_1 dst_unused:UNUSED_PRESERVE src0_sel:WORD_1
v_and_b32_sdwa v107, s47, v105 dst_sel:DWORD dst_unused:UNUSED_PAD src0_sel:DWORD src1_sel:WORD_1
v_and_b32_e64 v105, s47, v105
v_pk_add_f16 v109, v109, 1.0 op_sel_hi:[1,0]
v_pk_add_f16 v111, v111, 1.0 op_sel_hi:[1,0]
v_rcp_f16_sdwa v109, v109 dst_sel:WORD_0 dst_unused:UNUSED_PRESERVE src0_sel:WORD_0
v_mfma_f32_32x32x16_bf16 v[160:175], v[56:59], v[176:179], v[160:175]
ds_read_b128 v[184:187], v250 offset:22528
ds_read_u16 v107, v107
ds_read_u16 v105, v105
v_rcp_f16_sdwa v111, v111 dst_sel:WORD_0 dst_unused:UNUSED_PRESERVE src0_sel:WORD_0
v_rcp_f16_sdwa v109, v109 dst_sel:WORD_1 dst_unused:UNUSED_PRESERVE src0_sel:WORD_1
v_mfma_f32_32x32x16_bf16 v[112:127], v[176:179], v[80:83], v[112:127]
v_rcp_f16_sdwa v111, v111 dst_sel:WORD_1 dst_unused:UNUSED_PRESERVE src0_sel:WORD_1
v_pk_mul_f16 v108, v108, v109
v_pk_mul_f16 v110, v110, v111
v_fma_mix_f32 v226, v108, v108, v226 op_sel_hi:[1,1,0]
s_waitcnt lgkmcnt(7)
v_mfma_f32_32x32x16_bf16 v[160:175], v[60:63], v[180:183], v[160:175]
ds_read_b128 v[188:191], v250 offset:23552
v_fma_mix_f32 v226, v110, v110, v226 op_sel_hi:[1,1,0]
v_cvt_pkrtz_f16_f32 v144, v144, v145
v_fma_mix_f32 v226, v108, v108, v226 op_sel:[1,1,0] op_sel_hi:[1,1,0]
v_cvt_pkrtz_f16_f32 v145, v146, v147
v_fma_mix_f32 v226, v110, v110, v226 op_sel:[1,1,0] op_sel_hi:[1,1,0]
v_lshrrev_b64 v[144:145], 2, v[144:145]
v_fma_mix_f32 v226, v96, v96, v226 op_sel_hi:[1,1,0]
v_and_b32_sdwa v146, s47, v144 dst_sel:DWORD dst_unused:UNUSED_PAD src0_sel:DWORD src1_sel:WORD_1
v_fma_mix_f32 v226, v97, v97, v226 op_sel_hi:[1,1,0]
v_and_b32 v144, s47, v144
v_fma_mix_f32 v226, v98, v98, v226 op_sel_hi:[1,1,0]
v_cvt_pk_f16_f32 v156, v156, v157
v_fma_mix_f32 v226, v99, v99, v226 op_sel_hi:[1,1,0]
v_cvt_pk_f16_f32 v158, v158, v159
v_mfma_f32_32x32x16_bf16 v[112:127], v[180:183], v[84:87], v[112:127]
ds_read_u16_d16_hi v146, v146
ds_read_u16 v144, v144
v_pk_fma_f16 v157, v156, v156, s48
v_fma_mix_f32 v226, v100, v100, v226 op_sel_hi:[1,1,0]
v_and_b32_sdwa v147, s47, v145 dst_sel:DWORD dst_unused:UNUSED_PAD src0_sel:DWORD src1_sel:WORD_1
s_waitcnt lgkmcnt(5)
v_fma_mix_f32 v226, v101, v101, v226 op_sel_hi:[1,1,0]
v_and_b32 v145, s47, v145
v_pk_fma_f16 v159, v158, v158, s48
v_pk_mul_f16 v157, v156, v157
v_fma_mix_f32 v226, v102, v102, v226 op_sel_hi:[1,1,0]
v_cvt_pkrtz_f16_f32 v148, v148, v149
v_fma_mix_f32 v226, v103, v103, v226 op_sel_hi:[1,1,0]
v_cvt_pkrtz_f16_f32 v149, v150, v151
ds_read_u16_d16_hi v147, v147
ds_read_u16 v145, v145
ds_read_b128 v[176:179], v250 offset:24576
v_lshrrev_b64 v[148:149], 2, v[148:149]
v_and_b32_sdwa v150, s47, v148 dst_sel:DWORD dst_unused:UNUSED_PAD src0_sel:DWORD src1_sel:WORD_1
v_and_b32_e64 v148, s47, v148
v_pk_mul_f16 v159, v158, v159
v_exp_f16_sdwa v157, v157 dst_sel:WORD_0 dst_unused:UNUSED_PRESERVE src0_sel:WORD_0
v_mfma_f32_32x32x16_bf16 v[160:175], v[64:67], v[184:187], v[160:175]
ds_read_u16_d16_hi v150, v150
ds_read_u16 v148, v148
v_fma_mix_f32 v226, v104, v104, v226 op_sel_hi:[1,1,0]
v_and_b32_sdwa v151, s47, v149 dst_sel:DWORD dst_unused:UNUSED_PAD src0_sel:DWORD src1_sel:WORD_1
s_waitcnt lgkmcnt(7)
v_fma_mix_f32 v226, v105, v105, v226 op_sel_hi:[1,1,0]
v_and_b32 v149, s47, v149
v_exp_f16_sdwa v159, v159 dst_sel:WORD_0 dst_unused:UNUSED_PRESERVE src0_sel:WORD_0
v_fma_mix_f32 v226, v106, v106, v226 op_sel_hi:[1,1,0]
v_cvt_pkrtz_f16_f32 v152, v152, v153
v_fma_mix_f32 v226, v107, v107, v226 op_sel_hi:[1,1,0]
v_cvt_pkrtz_f16_f32 v153, v154, v155
v_lshrrev_b64 v[152:153], 2, v[152:153]
ds_read_u16_d16_hi v151, v151
ds_read_u16 v149, v149
v_and_b32_sdwa v154, s47, v152 dst_sel:DWORD dst_unused:UNUSED_PAD src0_sel:DWORD src1_sel:WORD_1
v_and_b32_e64 v152, s47, v152
v_exp_f16_sdwa v157, v157 dst_sel:WORD_1 dst_unused:UNUSED_PRESERVE src0_sel:WORD_1
v_mfma_f32_32x32x16_bf16 v[112:127], v[184:187], v[88:91], v[112:127]
ds_read_u16_d16_hi v154, v154
ds_read_u16 v152, v152
ds_read_b128 v[180:183], v250 offset:25600
v_and_b32_sdwa v155, s47, v153 dst_sel:DWORD dst_unused:UNUSED_PAD src0_sel:DWORD src1_sel:WORD_1
v_and_b32_e64 v153, s47, v153
v_exp_f16_sdwa v159, v159 dst_sel:WORD_1 dst_unused:UNUSED_PRESERVE src0_sel:WORD_1
v_pk_add_f16 v157, v157, 1.0 op_sel_hi:[1,0]
v_mfma_f32_32x32x16_bf16 v[160:175], v[68:71], v[188:191], v[160:175]
ds_read_u16_d16_hi v155, v155
ds_read_u16 v153, v153
v_pk_add_f16 v159, v159, 1.0 op_sel_hi:[1,0]
v_rcp_f16_sdwa v157, v157 dst_sel:WORD_0 dst_unused:UNUSED_PRESERVE src0_sel:WORD_0
v_rcp_f16_sdwa v159, v159 dst_sel:WORD_0 dst_unused:UNUSED_PRESERVE src0_sel:WORD_0
v_mfma_f32_32x32x16_bf16 v[112:127], v[188:191], v[92:95], v[112:127]
ds_read_b128 v[184:187], v250 offset:26624
v_rcp_f16_sdwa v157, v157 dst_sel:WORD_1 dst_unused:UNUSED_PRESERVE src0_sel:WORD_1
v_rcp_f16_sdwa v159, v159 dst_sel:WORD_1 dst_unused:UNUSED_PRESERVE src0_sel:WORD_1
v_pk_mul_f16 v6, v156, v157
s_waitcnt lgkmcnt(8)
v_mfma_f32_32x32x16_bf16 v[128:143], v[48:51], v[176:179], 0
v_pk_mul_f16 v7, v158, v159
v_lshl_add_u64 v[0:1], v[144:145], 0, v[146:147]
v_cvt_pkrtz_f16_f32 v160, v160, v161
v_cvt_pkrtz_f16_f32 v161, v162, v163
v_lshrrev_b64 v[160:161], 2, v[160:161]
v_and_b32_sdwa v162, s47, v160 dst_sel:DWORD dst_unused:UNUSED_PAD src0_sel:DWORD src1_sel:WORD_1
v_and_b32 v160, s47, v160
v_cvt_pk_f16_f32 v172, v172, v173
v_cvt_pk_f16_f32 v174, v174, v175
v_mfma_f32_32x32x16_bf16 v[96:111], v[176:179], v[72:75], 0
ds_read_u16 v162, v162
ds_read_u16 v160, v160
v_pk_fma_f16 v173, v172, v172, s48
v_and_b32_sdwa v163, s47, v161 dst_sel:DWORD dst_unused:UNUSED_PAD src0_sel:DWORD src1_sel:WORD_1
v_and_b32 v161, s47, v161
v_pk_fma_f16 v175, v174, v174, s48
v_pk_mul_f16 v173, v172, v173
v_pk_mul_f16 v175, v174, v175
s_waitcnt lgkmcnt(6)
v_lshl_add_u64 v[4:5], v[148:149], 0, v[150:151]
v_cvt_pkrtz_f16_f32 v164, v164, v165
v_cvt_pkrtz_f16_f32 v165, v166, v167
ds_read_u16 v163, v163
ds_read_u16 v161, v161
ds_read_b128 v[188:191], v250 offset:27648
v_lshrrev_b64 v[164:165], 2, v[164:165]
v_and_b32_sdwa v166, s47, v164 dst_sel:DWORD dst_unused:UNUSED_PAD src0_sel:DWORD src1_sel:WORD_1
v_and_b32 v164, s47, v164
v_exp_f16_sdwa v173, v173 dst_sel:WORD_0 dst_unused:UNUSED_PRESERVE src0_sel:WORD_0
s_waitcnt lgkmcnt(7)
v_mfma_f32_32x32x16_bf16 v[128:143], v[52:55], v[180:183], v[128:143]
ds_read_u16 v166, v166
ds_read_u16 v164, v164
v_exp_f16_sdwa v175, v175 dst_sel:WORD_0 dst_unused:UNUSED_PRESERVE src0_sel:WORD_0
v_and_b32_sdwa v167, s47, v165 dst_sel:DWORD dst_unused:UNUSED_PAD src0_sel:DWORD src1_sel:WORD_1
v_and_b32 v165, s47, v165
v_exp_f16_sdwa v173, v173 dst_sel:WORD_1 dst_unused:UNUSED_PRESERVE src0_sel:WORD_1
s_waitcnt lgkmcnt(7)
v_lshl_add_u64 v[2:3], v[152:153], 0, v[154:155]
v_cvt_pkrtz_f16_f32 v168, v168, v169
v_cvt_pkrtz_f16_f32 v169, v170, v171
v_lshrrev_b64 v[168:169], 2, v[168:169]
v_and_b32_sdwa v170, s47, v168 dst_sel:DWORD dst_unused:UNUSED_PAD src0_sel:DWORD src1_sel:WORD_1
ds_read_u16 v167, v167
ds_read_u16 v165, v165
v_and_b32_e64 v168, s47, v168
v_mfma_f32_32x32x16_bf16 v[96:111], v[180:183], v[76:79], v[96:111]
ds_read_u16 v170, v170
ds_read_u16 v168, v168
v_exp_f16_sdwa v175, v175 dst_sel:WORD_1 dst_unused:UNUSED_PRESERVE src0_sel:WORD_1
v_and_b32_sdwa v171, s47, v169 dst_sel:DWORD dst_unused:UNUSED_PAD src0_sel:DWORD src1_sel:WORD_1
v_and_b32_e64 v169, s47, v169
v_mfma_f32_32x32x16_f16 v[144:159], v[0:3], v[216:219], 0
ds_read_b128 v[176:179], v250 offset:28672
ds_read_u16 v171, v171
ds_read_u16 v169, v169
v_pk_add_f16 v173, v173, 1.0 op_sel_hi:[1,0]
v_pk_add_f16 v175, v175, 1.0 op_sel_hi:[1,0]
v_rcp_f16_sdwa v173, v173 dst_sel:WORD_0 dst_unused:UNUSED_PRESERVE src0_sel:WORD_0
v_mfma_f32_32x32x16_f16 v[144:159], v[4:7], v[220:223], v[144:159]
v_permlane16_swap_b32 v0, v4
v_permlane16_swap_b32 v1, v5
v_permlane16_swap_b32 v2, v6
v_permlane16_swap_b32 v3, v7
v_rcp_f16_sdwa v175, v175 dst_sel:WORD_0 dst_unused:UNUSED_PRESERVE src0_sel:WORD_0
v_mfma_f32_32x32x16_bf16 v[128:143], v[56:59], v[184:187], v[128:143]
v_rcp_f16_sdwa v173, v173 dst_sel:WORD_1 dst_unused:UNUSED_PRESERVE src0_sel:WORD_1
v_rcp_f16_sdwa v175, v175 dst_sel:WORD_1 dst_unused:UNUSED_PRESERVE src0_sel:WORD_1
s_nop 3
v_fmac_f32 v226, v144, v144
v_mfma_f32_32x32x16_bf16 v[96:111], v[184:187], v[80:83], v[96:111]
ds_read_b128 v[180:183], v250 offset:29696
v_pk_mul_f16 v172, v172, v173
v_fmac_f32_e64 v226, v145, v145
v_pk_mul_f16 v174, v174, v175
v_fmac_f32 v226, v146, v146
v_fmac_f32 v226, v147, v147
v_fma_mix_f32 v227, v172, v172, v227 op_sel_hi:[1,1,0]
v_fmac_f32 v226, v148, v148
v_fmac_f32 v226, v149, v149
v_fma_mix_f32 v227, v174, v174, v227 op_sel_hi:[1,1,0]
s_waitcnt lgkmcnt(6)
v_mfma_f32_32x32x16_bf16 v[128:143], v[60:63], v[188:191], v[128:143]
v_fmac_f32 v226, v150, v150
v_fma_mix_f32 v227, v172, v172, v227 op_sel:[1,1,0] op_sel_hi:[1,1,0]
v_fmac_f32 v226, v151, v151
v_fmac_f32 v226, v152, v152
v_fma_mix_f32 v227, v174, v174, v227 op_sel:[1,1,0] op_sel_hi:[1,1,0]
v_fmac_f32_e64 v226, v153, v153
v_fma_mix_f32 v227, v160, v160, v227 op_sel_hi:[1,1,0]
v_fmac_f32_e64 v226, v154, v154
v_fma_mix_f32 v227, v161, v161, v227 op_sel_hi:[1,1,0]
v_cvt_pkrtz_f16_f32 v112, v112, v113
v_fma_mix_f32 v227, v162, v162, v227 op_sel_hi:[1,1,0]
v_cvt_pkrtz_f16_f32 v113, v114, v115
v_fma_mix_f32 v227, v163, v163, v227 op_sel_hi:[1,1,0]
v_lshrrev_b64 v[112:113], 2, v[112:113]
v_and_b32_sdwa v114, s47, v112 dst_sel:DWORD dst_unused:UNUSED_PAD src0_sel:DWORD src1_sel:WORD_1
v_and_b32_e64 v112, s47, v112
v_cvt_pk_f16_f32 v124, v124, v125
v_fmac_f32_e64 v226, v155, v155
v_cvt_pk_f16_f32 v126, v126, v127
v_fmac_f32 v226, v156, v156
v_fmac_f32 v226, v157, v157
v_mfma_f32_32x32x16_bf16 v[96:111], v[188:191], v[84:87], v[96:111]
ds_read_u16_d16_hi v114, v114
ds_read_u16 v112, v112
v_pk_fma_f16 v125, v124, v124, s48
v_fmac_f32_e64 v226, v158, v158
v_fma_mix_f32 v227, v164, v164, v227 op_sel_hi:[1,1,0]
v_and_b32_sdwa v115, s47, v113 dst_sel:DWORD dst_unused:UNUSED_PAD src0_sel:DWORD src1_sel:WORD_1
v_fma_mix_f32 v227, v165, v165, v227 op_sel_hi:[1,1,0]
v_and_b32 v113, s47, v113
v_fmac_f32 v226, v159, v159
v_pk_fma_f16 v127, v126, v126, s48
v_pk_mul_f16 v125, v124, v125
v_fma_mix_f32 v227, v166, v166, v227 op_sel_hi:[1,1,0]
v_cvt_pkrtz_f16_f32 v116, v116, v117
v_fma_mix_f32 v227, v167, v167, v227 op_sel_hi:[1,1,0]
ds_read_u16_d16_hi v115, v115
ds_read_u16 v113, v113
ds_read_b128 v[184:187], v250 offset:30720
v_cvt_pkrtz_f16_f32 v117, v118, v119
v_lshrrev_b64 v[116:117], 2, v[116:117]
v_and_b32_sdwa v118, s47, v116 dst_sel:DWORD dst_unused:UNUSED_PAD src0_sel:DWORD src1_sel:WORD_1
v_and_b32 v116, s47, v116
v_pk_mul_f16 v127, v126, v127
v_exp_f16_sdwa v125, v125 dst_sel:WORD_0 dst_unused:UNUSED_PRESERVE src0_sel:WORD_0
s_waitcnt lgkmcnt(5)
v_mfma_f32_32x32x16_bf16 v[128:143], v[64:67], v[176:179], v[128:143]
ds_read_u16_d16_hi v118, v118
ds_read_u16 v116, v116
v_fma_mix_f32 v227, v168, v168, v227 op_sel_hi:[1,1,0]
v_and_b32_sdwa v119, s47, v117 dst_sel:DWORD dst_unused:UNUSED_PAD src0_sel:DWORD src1_sel:WORD_1
v_fma_mix_f32 v227, v169, v169, v227 op_sel_hi:[1,1,0]
v_and_b32_e64 v117, s47, v117
v_exp_f16_sdwa v127, v127 dst_sel:WORD_0 dst_unused:UNUSED_PRESERVE src0_sel:WORD_0
v_fma_mix_f32 v227, v170, v170, v227 op_sel_hi:[1,1,0]
v_cvt_pkrtz_f16_f32 v120, v120, v121
v_fma_mix_f32 v227, v171, v171, v227 op_sel_hi:[1,1,0]
v_cvt_pkrtz_f16_f32 v121, v122, v123
v_lshrrev_b64 v[120:121], 2, v[120:121]
ds_read_u16_d16_hi v119, v119
ds_read_u16 v117, v117
v_and_b32_sdwa v122, s47, v120 dst_sel:DWORD dst_unused:UNUSED_PAD src0_sel:DWORD src1_sel:WORD_1
v_and_b32_e64 v120, s47, v120
v_exp_f16_sdwa v125, v125 dst_sel:WORD_1 dst_unused:UNUSED_PRESERVE src0_sel:WORD_1
v_mfma_f32_32x32x16_bf16 v[96:111], v[176:179], v[88:91], v[96:111]
ds_read_u16_d16_hi v122, v122
ds_read_u16 v120, v120
ds_read_b128 v[188:191], v250 offset:31744
v_and_b32_sdwa v123, s47, v121 dst_sel:DWORD dst_unused:UNUSED_PAD src0_sel:DWORD src1_sel:WORD_1
v_and_b32_e64 v121, s47, v121
v_exp_f16_sdwa v127, v127 dst_sel:WORD_1 dst_unused:UNUSED_PRESERVE src0_sel:WORD_1
v_pk_add_f16 v125, v125, 1.0 op_sel_hi:[1,0]
v_mfma_f32_32x32x16_bf16 v[128:143], v[68:71], v[180:183], v[128:143]
ds_read_u16_d16_hi v123, v123
ds_read_u16 v121, v121
v_pk_add_f16 v127, v127, 1.0 op_sel_hi:[1,0]
v_rcp_f16_sdwa v125, v125 dst_sel:WORD_0 dst_unused:UNUSED_PRESERVE src0_sel:WORD_0
v_rcp_f16_sdwa v127, v127 dst_sel:WORD_0 dst_unused:UNUSED_PRESERVE src0_sel:WORD_0
v_mfma_f32_32x32x16_bf16 v[96:111], v[180:183], v[92:95], v[96:111]
ds_read_b128 v[176:179], v250 offset:32768
v_rcp_f16_sdwa v125, v125 dst_sel:WORD_1 dst_unused:UNUSED_PRESERVE src0_sel:WORD_1
v_rcp_f16_sdwa v127, v127 dst_sel:WORD_1 dst_unused:UNUSED_PRESERVE src0_sel:WORD_1
s_cmp_lg_u32 s40, 0
s_cbranch_scc1 Lpix
v_and_b32 v244, 0x3ff, v250
buffer_load_dword v245, v244, s[28:31], 0 offen
buffer_load_dword v245, v244, s[24:27], 0 offen
v_mov_b32 v244, 0
Lpi:
buffer_load_dword v245, v244, s[36:39], 0 offen sc1
s_waitcnt vmcnt(0)
v_readfirstlane_b32 s43, v245
s_cmp_eq_u32 s76, 0
s_cbranch_scc1 Lpix
s_sub_u32 s76, s76, 1
s_cmp_lt_u32 s43, 256
s_cbranch_scc1 Lpi
Lpix:
s_waitcnt lgkmcnt(8)
v_mfma_f32_32x32x16_bf16 v[144:159], v[48:51], v[184:187], 0
v_pk_mul_f16 v14, v124, v125
v_pk_mul_f16 v15, v126, v127
v_lshl_add_u64 v[8:9], v[112:113], 0, v[114:115]
v_cvt_pkrtz_f16_f32 v128, v128, v129
v_cvt_pkrtz_f16_f32 v129, v130, v131
v_lshrrev_b64 v[128:129], 2, v[128:129]
v_and_b32_sdwa v130, s47, v128 dst_sel:DWORD dst_unused:UNUSED_PAD src0_sel:DWORD src1_sel:WORD_1
v_and_b32_e64 v128, s47, v128
v_cvt_pk_f16_f32 v140, v140, v141
v_cvt_pk_f16_f32 v142, v142, v143
v_mfma_f32_32x32x16_bf16 v[160:175], v[184:187], v[72:75], 0
ds_read_u16 v130, v130
ds_read_u16 v128, v128
v_pk_fma_f16 v141, v140, v140, s48
v_and_b32_sdwa v131, s47, v129 dst_sel:DWORD dst_unused:UNUSED_PAD src0_sel:DWORD src1_sel:WORD_1
v_and_b32 v129, s47, v129
v_pk_fma_f16 v143, v142, v142, s48
v_pk_mul_f16 v141, v140, v141
v_pk_mul_f16 v143, v142, v143
s_waitcnt lgkmcnt(6)
v_lshl_add_u64 v[12:13], v[116:117], 0, v[118:119]
v_cvt_pkrtz_f16_f32 v132, v132, v133
v_cvt_pkrtz_f16_f32 v133, v134, v135
ds_read_u16 v131, v131
ds_read_u16 v129, v129
ds_read_b128 v[180:183], v250 offset:33792
v_lshrrev_b64 v[132:133], 2, v[132:133]
v_and_b32_sdwa v134, s47, v132 dst_sel:DWORD dst_unused:UNUSED_PAD src0_sel:DWORD src1_sel:WORD_1
v_and_b32 v132, s47, v132
v_exp_f16_sdwa v141, v141 dst_sel:WORD_0 dst_unused:UNUSED_PRESERVE src0_sel:WORD_0
s_waitcnt lgkmcnt(7)
v_mfma_f32_32x32x16_bf16 v[144:159], v[52:55], v[188:191], v[144:159]
ds_read_u16 v134, v134
ds_read_u16 v132, v132
v_exp_f16_sdwa v143, v143 dst_sel:WORD_0 dst_unused:UNUSED_PRESERVE src0_sel:WORD_0
v_and_b32_sdwa v135, s47, v133 dst_sel:DWORD dst_unused:UNUSED_PAD src0_sel:DWORD src1_sel:WORD_1
v_and_b32 v133, s47, v133
v_exp_f16_sdwa v141, v141 dst_sel:WORD_1 dst_unused:UNUSED_PRESERVE src0_sel:WORD_1
s_waitcnt lgkmcnt(7)
v_lshl_add_u64 v[10:11], v[120:121], 0, v[122:123]
v_cvt_pkrtz_f16_f32 v136, v136, v137
v_cvt_pkrtz_f16_f32 v137, v138, v139
v_lshrrev_b64 v[136:137], 2, v[136:137]
v_and_b32_sdwa v138, s47, v136 dst_sel:DWORD dst_unused:UNUSED_PAD src0_sel:DWORD src1_sel:WORD_1
ds_read_u16 v135, v135
ds_read_u16 v133, v133
v_and_b32_e64 v136, s47, v136
v_mfma_f32_32x32x16_bf16 v[160:175], v[188:191], v[76:79], v[160:175]
ds_read_u16 v138, v138
ds_read_u16 v136, v136
v_exp_f16_sdwa v143, v143 dst_sel:WORD_1 dst_unused:UNUSED_PRESERVE src0_sel:WORD_1
v_and_b32_sdwa v139, s47, v137 dst_sel:DWORD dst_unused:UNUSED_PAD src0_sel:DWORD src1_sel:WORD_1
v_and_b32_e64 v137, s47, v137
v_mfma_f32_32x32x16_f16 v[112:127], v[8:11], v[216:219], 0
ds_read_b128 v[184:187], v250 offset:34816
ds_read_u16 v139, v139
ds_read_u16 v137, v137
v_pk_add_f16 v141, v141, 1.0 op_sel_hi:[1,0]
v_pk_add_f16 v143, v143, 1.0 op_sel_hi:[1,0]
v_rcp_f16_sdwa v141, v141 dst_sel:WORD_0 dst_unused:UNUSED_PRESERVE src0_sel:WORD_0
v_mfma_f32_32x32x16_f16 v[112:127], v[12:15], v[220:223], v[112:127]
v_permlane16_swap_b32 v8, v12
v_permlane16_swap_b32 v9, v13
v_permlane16_swap_b32 v10, v14
v_permlane16_swap_b32 v11, v15
v_rcp_f16_sdwa v143, v143 dst_sel:WORD_0 dst_unused:UNUSED_PRESERVE src0_sel:WORD_0
v_mfma_f32_32x32x16_bf16 v[144:159], v[56:59], v[176:179], v[144:159]
v_rcp_f16_sdwa v141, v141 dst_sel:WORD_1 dst_unused:UNUSED_PRESERVE src0_sel:WORD_1
v_rcp_f16_sdwa v143, v143 dst_sel:WORD_1 dst_unused:UNUSED_PRESERVE src0_sel:WORD_1
s_nop 3
v_fmac_f32 v227, v112, v112
v_mfma_f32_32x32x16_bf16 v[160:175], v[176:179], v[80:83], v[160:175]
ds_read_b128 v[188:191], v250 offset:35840
v_pk_mul_f16 v140, v140, v141
v_fmac_f32_e64 v227, v113, v113
v_pk_mul_f16 v142, v142, v143
v_fmac_f32 v227, v114, v114
v_fmac_f32 v227, v115, v115
v_fma_mix_f32 v228, v140, v140, v228 op_sel_hi:[1,1,0]
v_fmac_f32 v227, v116, v116
v_fmac_f32 v227, v117, v117
v_fma_mix_f32 v228, v142, v142, v228 op_sel_hi:[1,1,0]
s_waitcnt lgkmcnt(6)
v_mfma_f32_32x32x16_bf16 v[144:159], v[60:63], v[180:183], v[144:159]
v_fmac_f32 v227, v118, v118
v_fma_mix_f32 v228, v140, v140, v228 op_sel:[1,1,0] op_sel_hi:[1,1,0]
v_fmac_f32 v227, v119, v119
v_fmac_f32 v227, v120, v120
v_fma_mix_f32 v228, v142, v142, v228 op_sel:[1,1,0] op_sel_hi:[1,1,0]
v_fmac_f32_e64 v227, v121, v121
v_fma_mix_f32 v228, v128, v128, v228 op_sel_hi:[1,1,0]
v_fmac_f32_e64 v227, v122, v122
v_fma_mix_f32 v228, v129, v129, v228 op_sel_hi:[1,1,0]
v_cvt_pkrtz_f16_f32 v96, v96, v97
v_fma_mix_f32 v228, v130, v130, v228 op_sel_hi:[1,1,0]
v_cvt_pkrtz_f16_f32 v97, v98, v99
v_fma_mix_f32 v228, v131, v131, v228 op_sel_hi:[1,1,0]
v_lshrrev_b64 v[96:97], 2, v[96:97]
v_and_b32_sdwa v98, s47, v96 dst_sel:DWORD dst_unused:UNUSED_PAD src0_sel:DWORD src1_sel:WORD_1
v_and_b32_e64 v96, s47, v96
v_cvt_pk_f16_f32 v108, v108, v109
v_fmac_f32_e64 v227, v123, v123
v_cvt_pk_f16_f32 v110, v110, v111
v_fmac_f32 v227, v124, v124
v_fmac_f32 v227, v125, v125
v_mfma_f32_32x32x16_bf16 v[160:175], v[180:183], v[84:87], v[160:175]
ds_read_u16_d16_hi v98, v98
ds_read_u16 v96, v96
v_pk_fma_f16 v109, v108, v108, s48
v_fmac_f32_e64 v227, v126, v126
v_fma_mix_f32 v228, v132, v132, v228 op_sel_hi:[1,1,0]
v_and_b32_sdwa v99, s47, v97 dst_sel:DWORD dst_unused:UNUSED_PAD src0_sel:DWORD src1_sel:WORD_1
v_fma_mix_f32 v228, v133, v133, v228 op_sel_hi:[1,1,0]
v_and_b32 v97, s47, v97
v_fmac_f32 v227, v127, v127
v_pk_fma_f16 v111, v110, v110, s48
v_pk_mul_f16 v109, v108, v109
v_fma_mix_f32 v228, v134, v134, v228 op_sel_hi:[1,1,0]
v_cvt_pkrtz_f16_f32 v100, v100, v101
v_fma_mix_f32 v228, v135, v135, v228 op_sel_hi:[1,1,0]
ds_read_u16_d16_hi v99, v99
ds_read_u16 v97, v97
ds_read_b128 v[176:179], v250 offset:36864
v_cvt_pkrtz_f16_f32 v101, v102, v103
v_lshrrev_b64 v[100:101], 2, v[100:101]
v_and_b32_sdwa v102, s47, v100 dst_sel:DWORD dst_unused:UNUSED_PAD src0_sel:DWORD src1_sel:WORD_1
v_and_b32 v100, s47, v100
v_pk_mul_f16 v111, v110, v111
v_exp_f16_sdwa v109, v109 dst_sel:WORD_0 dst_unused:UNUSED_PRESERVE src0_sel:WORD_0
s_waitcnt lgkmcnt(5)
v_mfma_f32_32x32x16_bf16 v[144:159], v[64:67], v[184:187], v[144:159]
ds_read_u16_d16_hi v102, v102
ds_read_u16 v100, v100
v_fma_mix_f32 v228, v136, v136, v228 op_sel_hi:[1,1,0]
v_and_b32_sdwa v103, s47, v101 dst_sel:DWORD dst_unused:UNUSED_PAD src0_sel:DWORD src1_sel:WORD_1
v_fma_mix_f32 v228, v137, v137, v228 op_sel_hi:[1,1,0]
v_and_b32_e64 v101, s47, v101
v_exp_f16_sdwa v111, v111 dst_sel:WORD_0 dst_unused:UNUSED_PRESERVE src0_sel:WORD_0
v_fma_mix_f32 v228, v138, v138, v228 op_sel_hi:[1,1,0]
v_cvt_pkrtz_f16_f32 v104, v104, v105
v_fma_mix_f32 v228, v139, v139, v228 op_sel_hi:[1,1,0]
v_cvt_pkrtz_f16_f32 v105, v106, v107
v_lshrrev_b64 v[104:105], 2, v[104:105]
ds_read_u16_d16_hi v103, v103
ds_read_u16 v101, v101
v_and_b32_sdwa v106, s47, v104 dst_sel:DWORD dst_unused:UNUSED_PAD src0_sel:DWORD src1_sel:WORD_1
v_and_b32_e64 v104, s47, v104
v_exp_f16_sdwa v109, v109 dst_sel:WORD_1 dst_unused:UNUSED_PRESERVE src0_sel:WORD_1
v_mfma_f32_32x32x16_bf16 v[160:175], v[184:187], v[88:91], v[160:175]
ds_read_u16_d16_hi v106, v106
ds_read_u16 v104, v104
ds_read_b128 v[180:183], v250 offset:37888
v_and_b32_sdwa v107, s47, v105 dst_sel:DWORD dst_unused:UNUSED_PAD src0_sel:DWORD src1_sel:WORD_1
v_and_b32_e64 v105, s47, v105
v_exp_f16_sdwa v111, v111 dst_sel:WORD_1 dst_unused:UNUSED_PRESERVE src0_sel:WORD_1
v_pk_add_f16 v109, v109, 1.0 op_sel_hi:[1,0]
v_mfma_f32_32x32x16_bf16 v[144:159], v[68:71], v[188:191], v[144:159]
ds_read_u16_d16_hi v107, v107
ds_read_u16 v105, v105
v_pk_add_f16 v111, v111, 1.0 op_sel_hi:[1,0]
v_rcp_f16_sdwa v109, v109 dst_sel:WORD_0 dst_unused:UNUSED_PRESERVE src0_sel:WORD_0
v_rcp_f16_sdwa v111, v111 dst_sel:WORD_0 dst_unused:UNUSED_PRESERVE src0_sel:WORD_0
v_mfma_f32_32x32x16_bf16 v[160:175], v[188:191], v[92:95], v[160:175]
ds_read_b128 v[184:187], v250 offset:38912
v_rcp_f16_sdwa v109, v109 dst_sel:WORD_1 dst_unused:UNUSED_PRESERVE src0_sel:WORD_1
v_rcp_f16_sdwa v111, v111 dst_sel:WORD_1 dst_unused:UNUSED_PRESERVE src0_sel:WORD_1
v_pk_mul_f16 v22, v108, v109
s_waitcnt lgkmcnt(8)
v_mfma_f32_32x32x16_bf16 v[112:127], v[48:51], v[176:179], 0
v_pk_mul_f16 v23, v110, v111
v_lshl_add_u64 v[16:17], v[96:97], 0, v[98:99]
v_cvt_pkrtz_f16_f32 v144, v144, v145
v_cvt_pkrtz_f16_f32 v145, v146, v147
v_lshrrev_b64 v[144:145], 2, v[144:145]
v_and_b32_sdwa v146, s47, v144 dst_sel:DWORD dst_unused:UNUSED_PAD src0_sel:DWORD src1_sel:WORD_1
v_and_b32 v144, s47, v144
v_cvt_pk_f16_f32 v156, v156, v157
v_cvt_pk_f16_f32 v158, v158, v159
v_mfma_f32_32x32x16_bf16 v[128:143], v[176:179], v[72:75], 0
ds_read_u16 v146, v146
ds_read_u16 v144, v144
v_pk_fma_f16 v157, v156, v156, s48
v_and_b32_sdwa v147, s47, v145 dst_sel:DWORD dst_unused:UNUSED_PAD src0_sel:DWORD src1_sel:WORD_1
v_and_b32 v145, s47, v145
v_pk_fma_f16 v159, v158, v158, s48
v_pk_mul_f16 v157, v156, v157
v_pk_mul_f16 v159, v158, v159
s_waitcnt lgkmcnt(6)
v_lshl_add_u64 v[20:21], v[100:101], 0, v[102:103]
v_cvt_pkrtz_f16_f32 v148, v148, v149
v_cvt_pkrtz_f16_f32 v149, v150, v151
ds_read_u16 v147, v147
ds_read_u16 v145, v145
ds_read_b128 v[188:191], v250 offset:39936
v_lshrrev_b64 v[148:149], 2, v[148:149]
v_and_b32_sdwa v150, s47, v148 dst_sel:DWORD dst_unused:UNUSED_PAD src0_sel:DWORD src1_sel:WORD_1
v_and_b32 v148, s47, v148
v_exp_f16_sdwa v157, v157 dst_sel:WORD_0 dst_unused:UNUSED_PRESERVE src0_sel:WORD_0
s_waitcnt lgkmcnt(7)
v_mfma_f32_32x32x16_bf16 v[112:127], v[52:55], v[180:183], v[112:127]
ds_read_u16 v150, v150
ds_read_u16 v148, v148
v_exp_f16_sdwa v159, v159 dst_sel:WORD_0 dst_unused:UNUSED_PRESERVE src0_sel:WORD_0
v_and_b32_sdwa v151, s47, v149 dst_sel:DWORD dst_unused:UNUSED_PAD src0_sel:DWORD src1_sel:WORD_1
v_and_b32 v149, s47, v149
v_exp_f16_sdwa v157, v157 dst_sel:WORD_1 dst_unused:UNUSED_PRESERVE src0_sel:WORD_1
s_waitcnt lgkmcnt(7)
v_lshl_add_u64 v[18:19], v[104:105], 0, v[106:107]
v_cvt_pkrtz_f16_f32 v152, v152, v153
v_cvt_pkrtz_f16_f32 v153, v154, v155
v_lshrrev_b64 v[152:153], 2, v[152:153]
v_and_b32_sdwa v154, s47, v152 dst_sel:DWORD dst_unused:UNUSED_PAD src0_sel:DWORD src1_sel:WORD_1
ds_read_u16 v151, v151
ds_read_u16 v149, v149
v_and_b32_e64 v152, s47, v152
v_mfma_f32_32x32x16_bf16 v[128:143], v[180:183], v[76:79], v[128:143]
ds_read_u16 v154, v154
ds_read_u16 v152, v152
v_exp_f16_sdwa v159, v159 dst_sel:WORD_1 dst_unused:UNUSED_PRESERVE src0_sel:WORD_1
v_and_b32_sdwa v155, s47, v153 dst_sel:DWORD dst_unused:UNUSED_PAD src0_sel:DWORD src1_sel:WORD_1
v_and_b32_e64 v153, s47, v153
v_mfma_f32_32x32x16_f16 v[96:111], v[16:19], v[216:219], 0
ds_read_b128 v[176:179], v250 offset:40960
ds_read_u16 v155, v155
ds_read_u16 v153, v153
v_pk_add_f16 v157, v157, 1.0 op_sel_hi:[1,0]
v_pk_add_f16 v159, v159, 1.0 op_sel_hi:[1,0]
v_rcp_f16_sdwa v157, v157 dst_sel:WORD_0 dst_unused:UNUSED_PRESERVE src0_sel:WORD_0
v_mfma_f32_32x32x16_f16 v[96:111], v[20:23], v[220:223], v[96:111]
v_permlane16_swap_b32 v16, v20
v_permlane16_swap_b32 v17, v21
v_permlane16_swap_b32 v18, v22
v_permlane16_swap_b32 v19, v23
v_rcp_f16_sdwa v159, v159 dst_sel:WORD_0 dst_unused:UNUSED_PRESERVE src0_sel:WORD_0
v_mfma_f32_32x32x16_bf16 v[112:127], v[56:59], v[184:187], v[112:127]
v_rcp_f16_sdwa v157, v157 dst_sel:WORD_1 dst_unused:UNUSED_PRESERVE src0_sel:WORD_1
v_rcp_f16_sdwa v159, v159 dst_sel:WORD_1 dst_unused:UNUSED_PRESERVE src0_sel:WORD_1
s_nop 3
v_fmac_f32 v228, v96, v96
v_mfma_f32_32x32x16_bf16 v[128:143], v[184:187], v[80:83], v[128:143]
ds_read_b128 v[180:183], v250 offset:41984
v_pk_mul_f16 v156, v156, v157
v_fmac_f32_e64 v228, v97, v97
v_pk_mul_f16 v158, v158, v159
v_fmac_f32 v228, v98, v98
v_fmac_f32 v228, v99, v99
v_fma_mix_f32 v229, v156, v156, v229 op_sel_hi:[1,1,0]
v_fmac_f32 v228, v100, v100
v_fmac_f32 v228, v101, v101
v_fma_mix_f32 v229, v158, v158, v229 op_sel_hi:[1,1,0]
s_waitcnt lgkmcnt(6)
v_mfma_f32_32x32x16_bf16 v[112:127], v[60:63], v[188:191], v[112:127]
v_fmac_f32 v228, v102, v102
v_fma_mix_f32 v229, v156, v156, v229 op_sel:[1,1,0] op_sel_hi:[1,1,0]
v_fmac_f32 v228, v103, v103
v_fmac_f32 v228, v104, v104
v_fma_mix_f32 v229, v158, v158, v229 op_sel:[1,1,0] op_sel_hi:[1,1,0]
v_fmac_f32_e64 v228, v105, v105
v_fma_mix_f32 v229, v144, v144, v229 op_sel_hi:[1,1,0]
v_fmac_f32_e64 v228, v106, v106
v_fma_mix_f32 v229, v145, v145, v229 op_sel_hi:[1,1,0]
v_cvt_pkrtz_f16_f32 v160, v160, v161
v_fma_mix_f32 v229, v146, v146, v229 op_sel_hi:[1,1,0]
v_cvt_pkrtz_f16_f32 v161, v162, v163
v_fma_mix_f32 v229, v147, v147, v229 op_sel_hi:[1,1,0]
v_lshrrev_b64 v[160:161], 2, v[160:161]
v_and_b32_sdwa v162, s47, v160 dst_sel:DWORD dst_unused:UNUSED_PAD src0_sel:DWORD src1_sel:WORD_1
v_and_b32_e64 v160, s47, v160
v_cvt_pk_f16_f32 v172, v172, v173
v_fmac_f32_e64 v228, v107, v107
v_cvt_pk_f16_f32 v174, v174, v175
v_fmac_f32 v228, v108, v108
v_fmac_f32 v228, v109, v109
v_mfma_f32_32x32x16_bf16 v[128:143], v[188:191], v[84:87], v[128:143]
ds_read_u16_d16_hi v162, v162
ds_read_u16 v160, v160
v_pk_fma_f16 v173, v172, v172, s48
v_fmac_f32_e64 v228, v110, v110
v_fma_mix_f32 v229, v148, v148, v229 op_sel_hi:[1,1,0]
v_and_b32_sdwa v163, s47, v161 dst_sel:DWORD dst_unused:UNUSED_PAD src0_sel:DWORD src1_sel:WORD_1
v_fma_mix_f32 v229, v149, v149, v229 op_sel_hi:[1,1,0]
v_and_b32 v161, s47, v161
v_fmac_f32 v228, v111, v111
v_pk_fma_f16 v175, v174, v174, s48
v_pk_mul_f16 v173, v172, v173
v_fma_mix_f32 v229, v150, v150, v229 op_sel_hi:[1,1,0]
v_cvt_pkrtz_f16_f32 v164, v164, v165
v_fma_mix_f32 v229, v151, v151, v229 op_sel_hi:[1,1,0]
ds_read_u16_d16_hi v163, v163
ds_read_u16 v161, v161
ds_read_b128 v[184:187], v250 offset:43008
v_cvt_pkrtz_f16_f32 v165, v166, v167
v_lshrrev_b64 v[164:165], 2, v[164:165]
v_and_b32_sdwa v166, s47, v164 dst_sel:DWORD dst_unused:UNUSED_PAD src0_sel:DWORD src1_sel:WORD_1
v_and_b32 v164, s47, v164
v_pk_mul_f16 v175, v174, v175
v_exp_f16_sdwa v173, v173 dst_sel:WORD_0 dst_unused:UNUSED_PRESERVE src0_sel:WORD_0
s_waitcnt lgkmcnt(5)
v_mfma_f32_32x32x16_bf16 v[112:127], v[64:67], v[176:179], v[112:127]
ds_read_u16_d16_hi v166, v166
ds_read_u16 v164, v164
v_fma_mix_f32 v229, v152, v152, v229 op_sel_hi:[1,1,0]
v_and_b32_sdwa v167, s47, v165 dst_sel:DWORD dst_unused:UNUSED_PAD src0_sel:DWORD src1_sel:WORD_1
v_fma_mix_f32 v229, v153, v153, v229 op_sel_hi:[1,1,0]
v_and_b32_e64 v165, s47, v165
v_exp_f16_sdwa v175, v175 dst_sel:WORD_0 dst_unused:UNUSED_PRESERVE src0_sel:WORD_0
v_fma_mix_f32 v229, v154, v154, v229 op_sel_hi:[1,1,0]
v_cvt_pkrtz_f16_f32 v168, v168, v169
v_fma_mix_f32 v229, v155, v155, v229 op_sel_hi:[1,1,0]
v_cvt_pkrtz_f16_f32 v169, v170, v171
v_lshrrev_b64 v[168:169], 2, v[168:169]
ds_read_u16_d16_hi v167, v167
ds_read_u16 v165, v165
v_and_b32_sdwa v170, s47, v168 dst_sel:DWORD dst_unused:UNUSED_PAD src0_sel:DWORD src1_sel:WORD_1
v_and_b32_e64 v168, s47, v168
v_exp_f16_sdwa v173, v173 dst_sel:WORD_1 dst_unused:UNUSED_PRESERVE src0_sel:WORD_1
v_mfma_f32_32x32x16_bf16 v[128:143], v[176:179], v[88:91], v[128:143]
ds_read_u16_d16_hi v170, v170
ds_read_u16 v168, v168
ds_read_b128 v[188:191], v250 offset:44032
v_and_b32_sdwa v171, s47, v169 dst_sel:DWORD dst_unused:UNUSED_PAD src0_sel:DWORD src1_sel:WORD_1
v_and_b32_e64 v169, s47, v169
v_exp_f16_sdwa v175, v175 dst_sel:WORD_1 dst_unused:UNUSED_PRESERVE src0_sel:WORD_1
v_pk_add_f16 v173, v173, 1.0 op_sel_hi:[1,0]
v_mfma_f32_32x32x16_bf16 v[112:127], v[68:71], v[180:183], v[112:127]
ds_read_u16_d16_hi v171, v171
ds_read_u16 v169, v169
v_pk_add_f16 v175, v175, 1.0 op_sel_hi:[1,0]
v_rcp_f16_sdwa v173, v173 dst_sel:WORD_0 dst_unused:UNUSED_PRESERVE src0_sel:WORD_0
v_rcp_f16_sdwa v175, v175 dst_sel:WORD_0 dst_unused:UNUSED_PRESERVE src0_sel:WORD_0
v_mfma_f32_32x32x16_bf16 v[128:143], v[180:183], v[92:95], v[128:143]
ds_read_b128 v[176:179], v250 offset:45056
v_rcp_f16_sdwa v173, v173 dst_sel:WORD_1 dst_unused:UNUSED_PRESERVE src0_sel:WORD_1
v_rcp_f16_sdwa v175, v175 dst_sel:WORD_1 dst_unused:UNUSED_PRESERVE src0_sel:WORD_1
v_pk_mul_f16 v198, v172, v173
s_waitcnt lgkmcnt(8)
v_mfma_f32_32x32x16_bf16 v[96:111], v[48:51], v[184:187], 0
v_pk_mul_f16 v199, v174, v175
v_lshl_add_u64 v[192:193], v[160:161], 0, v[162:163]
v_cvt_pkrtz_f16_f32 v112, v112, v113
v_cvt_pkrtz_f16_f32 v113, v114, v115
v_lshrrev_b64 v[112:113], 2, v[112:113]
v_and_b32_sdwa v114, s47, v112 dst_sel:DWORD dst_unused:UNUSED_PAD src0_sel:DWORD src1_sel:WORD_1
v_and_b32 v112, s47, v112
v_cvt_pk_f16_f32 v124, v124, v125
v_cvt_pk_f16_f32 v126, v126, v127
v_mfma_f32_32x32x16_bf16 v[144:159], v[184:187], v[72:75], 0
ds_read_u16 v114, v114
ds_read_u16 v112, v112
v_pk_fma_f16 v125, v124, v124, s48
v_and_b32_sdwa v115, s47, v113 dst_sel:DWORD dst_unused:UNUSED_PAD src0_sel:DWORD src1_sel:WORD_1
v_and_b32 v113, s47, v113
v_pk_fma_f16 v127, v126, v126, s48
v_pk_mul_f16 v125, v124, v125
v_pk_mul_f16 v127, v126, v127
s_waitcnt lgkmcnt(6)
v_lshl_add_u64 v[196:197], v[164:165], 0, v[166:167]
v_cvt_pkrtz_f16_f32 v116, v116, v117
v_cvt_pkrtz_f16_f32 v117, v118, v119
ds_read_u16 v115, v115
ds_read_u16 v113, v113
ds_read_b128 v[180:183], v250 offset:46080
v_lshrrev_b64 v[116:117], 2, v[116:117]
v_and_b32_sdwa v118, s47, v116 dst_sel:DWORD dst_unused:UNUSED_PAD src0_sel:DWORD src1_sel:WORD_1
v_and_b32 v116, s47, v116
v_exp_f16_sdwa v125, v125 dst_sel:WORD_0 dst_unused:UNUSED_PRESERVE src0_sel:WORD_0
s_waitcnt lgkmcnt(7)
v_mfma_f32_32x32x16_bf16 v[96:111], v[52:55], v[188:191], v[96:111]
ds_read_u16 v118, v118
ds_read_u16 v116, v116
v_exp_f16_sdwa v127, v127 dst_sel:WORD_0 dst_unused:UNUSED_PRESERVE src0_sel:WORD_0
v_and_b32_sdwa v119, s47, v117 dst_sel:DWORD dst_unused:UNUSED_PAD src0_sel:DWORD src1_sel:WORD_1
v_and_b32 v117, s47, v117
v_exp_f16_sdwa v125, v125 dst_sel:WORD_1 dst_unused:UNUSED_PRESERVE src0_sel:WORD_1
s_waitcnt lgkmcnt(7)
v_lshl_add_u64 v[194:195], v[168:169], 0, v[170:171]
v_cvt_pkrtz_f16_f32 v120, v120, v121
v_cvt_pkrtz_f16_f32 v121, v122, v123
v_lshrrev_b64 v[120:121], 2, v[120:121]
v_and_b32_sdwa v122, s47, v120 dst_sel:DWORD dst_unused:UNUSED_PAD src0_sel:DWORD src1_sel:WORD_1
ds_read_u16 v119, v119
ds_read_u16 v117, v117
v_and_b32_e64 v120, s47, v120
v_mfma_f32_32x32x16_bf16 v[144:159], v[188:191], v[76:79], v[144:159]
ds_read_u16 v122, v122
ds_read_u16 v120, v120
v_exp_f16_sdwa v127, v127 dst_sel:WORD_1 dst_unused:UNUSED_PRESERVE src0_sel:WORD_1
v_and_b32_sdwa v123, s47, v121 dst_sel:DWORD dst_unused:UNUSED_PAD src0_sel:DWORD src1_sel:WORD_1
v_and_b32_e64 v121, s47, v121
v_mfma_f32_32x32x16_f16 v[160:175], v[192:195], v[216:219], 0
ds_read_b128 v[184:187], v250 offset:47104
ds_read_u16 v123, v123
ds_read_u16 v121, v121
v_pk_add_f16 v125, v125, 1.0 op_sel_hi:[1,0]
v_pk_add_f16 v127, v127, 1.0 op_sel_hi:[1,0]
v_rcp_f16_sdwa v125, v125 dst_sel:WORD_0 dst_unused:UNUSED_PRESERVE src0_sel:WORD_0
v_mfma_f32_32x32x16_f16 v[160:175], v[196:199], v[220:223], v[160:175]
v_permlane16_swap_b32 v192, v196
v_permlane16_swap_b32 v193, v197
v_permlane16_swap_b32 v194, v198
v_permlane16_swap_b32 v195, v199
v_rcp_f16_sdwa v127, v127 dst_sel:WORD_0 dst_unused:UNUSED_PRESERVE src0_sel:WORD_0
v_mfma_f32_32x32x16_bf16 v[96:111], v[56:59], v[176:179], v[96:111]
v_rcp_f16_sdwa v125, v125 dst_sel:WORD_1 dst_unused:UNUSED_PRESERVE src0_sel:WORD_1
v_rcp_f16_sdwa v127, v127 dst_sel:WORD_1 dst_unused:UNUSED_PRESERVE src0_sel:WORD_1
s_nop 3
v_fmac_f32 v229, v160, v160
v_mfma_f32_32x32x16_bf16 v[144:159], v[176:179], v[80:83], v[144:159]
ds_read_b128 v[188:191], v250 offset:48128
v_pk_mul_f16 v124, v124, v125
v_fmac_f32_e64 v229, v161, v161
v_pk_mul_f16 v126, v126, v127
v_fmac_f32 v229, v162, v162
v_fmac_f32 v229, v163, v163
v_fma_mix_f32 v230, v124, v124, v230 op_sel_hi:[1,1,0]
v_fmac_f32 v229, v164, v164
v_fmac_f32 v229, v165, v165
v_fma_mix_f32 v230, v126, v126, v230 op_sel_hi:[1,1,0]
s_waitcnt lgkmcnt(6)
v_mfma_f32_32x32x16_bf16 v[96:111], v[60:63], v[180:183], v[96:111]
v_fmac_f32 v229, v166, v166
v_fma_mix_f32 v230, v124, v124, v230 op_sel:[1,1,0] op_sel_hi:[1,1,0]
v_fmac_f32 v229, v167, v167
v_fmac_f32 v229, v168, v168
v_fma_mix_f32 v230, v126, v126, v230 op_sel:[1,1,0] op_sel_hi:[1,1,0]
v_fmac_f32_e64 v229, v169, v169
v_fma_mix_f32 v230, v112, v112, v230 op_sel_hi:[1,1,0]
v_fmac_f32_e64 v229, v170, v170
v_fma_mix_f32 v230, v113, v113, v230 op_sel_hi:[1,1,0]
v_cvt_pkrtz_f16_f32 v128, v128, v129
v_fma_mix_f32 v230, v114, v114, v230 op_sel_hi:[1,1,0]
v_cvt_pkrtz_f16_f32 v129, v130, v131
v_fma_mix_f32 v230, v115, v115, v230 op_sel_hi:[1,1,0]
v_lshrrev_b64 v[128:129], 2, v[128:129]
v_and_b32_sdwa v130, s47, v128 dst_sel:DWORD dst_unused:UNUSED_PAD src0_sel:DWORD src1_sel:WORD_1
v_and_b32_e64 v128, s47, v128
v_cvt_pk_f16_f32 v140, v140, v141
v_fmac_f32_e64 v229, v171, v171
v_cvt_pk_f16_f32 v142, v142, v143
v_fmac_f32 v229, v172, v172
v_fmac_f32 v229, v173, v173
v_mfma_f32_32x32x16_bf16 v[144:159], v[180:183], v[84:87], v[144:159]
ds_read_u16_d16_hi v130, v130
ds_read_u16 v128, v128
v_pk_fma_f16 v141, v140, v140, s48
v_fmac_f32_e64 v229, v174, v174
v_fma_mix_f32 v230, v116, v116, v230 op_sel_hi:[1,1,0]
v_and_b32_sdwa v131, s47, v129 dst_sel:DWORD dst_unused:UNUSED_PAD src0_sel:DWORD src1_sel:WORD_1
v_fma_mix_f32 v230, v117, v117, v230 op_sel_hi:[1,1,0]
v_and_b32 v129, s47, v129
v_fmac_f32 v229, v175, v175
v_pk_fma_f16 v143, v142, v142, s48
v_pk_mul_f16 v141, v140, v141
v_fma_mix_f32 v230, v118, v118, v230 op_sel_hi:[1,1,0]
v_cvt_pkrtz_f16_f32 v132, v132, v133
v_fma_mix_f32 v230, v119, v119, v230 op_sel_hi:[1,1,0]
ds_read_u16_d16_hi v131, v131
ds_read_u16 v129, v129
ds_read_b128 v[176:179], v250 offset:49152
v_cvt_pkrtz_f16_f32 v133, v134, v135
v_lshrrev_b64 v[132:133], 2, v[132:133]
v_and_b32_sdwa v134, s47, v132 dst_sel:DWORD dst_unused:UNUSED_PAD src0_sel:DWORD src1_sel:WORD_1
v_and_b32 v132, s47, v132
v_pk_mul_f16 v143, v142, v143
v_exp_f16_sdwa v141, v141 dst_sel:WORD_0 dst_unused:UNUSED_PRESERVE src0_sel:WORD_0
s_waitcnt lgkmcnt(5)
v_mfma_f32_32x32x16_bf16 v[96:111], v[64:67], v[184:187], v[96:111]
ds_read_u16_d16_hi v134, v134
ds_read_u16 v132, v132
v_fma_mix_f32 v230, v120, v120, v230 op_sel_hi:[1,1,0]
v_and_b32_sdwa v135, s47, v133 dst_sel:DWORD dst_unused:UNUSED_PAD src0_sel:DWORD src1_sel:WORD_1
v_fma_mix_f32 v230, v121, v121, v230 op_sel_hi:[1,1,0]
v_and_b32_e64 v133, s47, v133
v_exp_f16_sdwa v143, v143 dst_sel:WORD_0 dst_unused:UNUSED_PRESERVE src0_sel:WORD_0
v_fma_mix_f32 v230, v122, v122, v230 op_sel_hi:[1,1,0]
v_cvt_pkrtz_f16_f32 v136, v136, v137
v_fma_mix_f32 v230, v123, v123, v230 op_sel_hi:[1,1,0]
v_cvt_pkrtz_f16_f32 v137, v138, v139
v_lshrrev_b64 v[136:137], 2, v[136:137]
ds_read_u16_d16_hi v135, v135
ds_read_u16 v133, v133
v_and_b32_sdwa v138, s47, v136 dst_sel:DWORD dst_unused:UNUSED_PAD src0_sel:DWORD src1_sel:WORD_1
v_and_b32_e64 v136, s47, v136
v_exp_f16_sdwa v141, v141 dst_sel:WORD_1 dst_unused:UNUSED_PRESERVE src0_sel:WORD_1
v_mfma_f32_32x32x16_bf16 v[144:159], v[184:187], v[88:91], v[144:159]
ds_read_u16_d16_hi v138, v138
ds_read_u16 v136, v136
ds_read_b128 v[180:183], v250 offset:50176
v_and_b32_sdwa v139, s47, v137 dst_sel:DWORD dst_unused:UNUSED_PAD src0_sel:DWORD src1_sel:WORD_1
v_and_b32_e64 v137, s47, v137
v_exp_f16_sdwa v143, v143 dst_sel:WORD_1 dst_unused:UNUSED_PRESERVE src0_sel:WORD_1
v_pk_add_f16 v141, v141, 1.0 op_sel_hi:[1,0]
v_mfma_f32_32x32x16_bf16 v[96:111], v[68:71], v[188:191], v[96:111]
ds_read_u16_d16_hi v139, v139
ds_read_u16 v137, v137
v_pk_add_f16 v143, v143, 1.0 op_sel_hi:[1,0]
v_rcp_f16_sdwa v141, v141 dst_sel:WORD_0 dst_unused:UNUSED_PRESERVE src0_sel:WORD_0
v_rcp_f16_sdwa v143, v143 dst_sel:WORD_0 dst_unused:UNUSED_PRESERVE src0_sel:WORD_0
v_mfma_f32_32x32x16_bf16 v[144:159], v[188:191], v[92:95], v[144:159]
ds_read_b128 v[184:187], v250 offset:51200
v_rcp_f16_sdwa v141, v141 dst_sel:WORD_1 dst_unused:UNUSED_PRESERVE src0_sel:WORD_1
v_rcp_f16_sdwa v143, v143 dst_sel:WORD_1 dst_unused:UNUSED_PRESERVE src0_sel:WORD_1
v_mov_b32 v239, 0
s_branch Law5
Lax5:
s_sleep 2
Law5:
ds_read_b32 v239, v247 offset:28
s_sub_u32 s76, s76, 1
s_cselect_b32 s44, 4, 0
s_cselect_b32 s76, 0, s76
s_waitcnt lgkmcnt(0)
v_readfirstlane_b32 s43, v239
s_nop 1
s_max_u32 s43, s43, s44
s_cmp_lt_u32 s43, 4
s_cbranch_scc1 Lax5
v_bfe_u32 v237, v250, 4, 6
v_lshrrev_b32_e64 v246, 2, v237
v_mul_u32_u24 v246, 192, v246
v_and_b32_e64 v237, 3, v237
v_lshl_add_u32 v246, v237, 4, v246
v_mfma_f32_32x32x16_bf16 v[160:175], v[48:51], v[176:179], 0
v_permlane32_swap_b32 v224, v225
v_add_f32 v224, v224, v225
v_permlane32_swap_b32 v226, v227
v_add_f32 v226, v226, v227
v_permlane32_swap_b32 v228, v229
v_add_f32 v228, v228, v229
v_pk_mul_f16 v206, v140, v141
v_pk_mul_f16 v207, v142, v143
ds_write_b32 v248, v224 offset:5120
ds_write_b32 v248, v226 offset:5376
ds_write_b32 v248, v228 offset:5632
v_lshl_add_u64 v[200:201], v[128:129], 0, v[130:131]
v_cvt_pkrtz_f16_f32 v96, v96, v97
v_cvt_pkrtz_f16_f32 v97, v98, v99
v_lshrrev_b64 v[96:97], 2, v[96:97]
v_and_b32_sdwa v98, s47, v96 dst_sel:DWORD dst_unused:UNUSED_PAD src0_sel:DWORD src1_sel:WORD_1
v_and_b32_e64 v96, s47, v96
v_cvt_pk_f16_f32 v108, v108, v109
v_cvt_pk_f16_f32 v110, v110, v111
v_mfma_f32_32x32x16_bf16 v[112:127], v[176:179], v[72:75], 0
ds_read_u16 v98, v98
ds_read_u16 v96, v96
v_pk_fma_f16 v109, v108, v108, s48
v_and_b32_sdwa v99, s47, v97 dst_sel:DWORD dst_unused:UNUSED_PAD src0_sel:DWORD src1_sel:WORD_1
v_and_b32_e64 v97, s47, v97
v_pk_fma_f16 v111, v110, v110, s48
v_pk_mul_f16 v109, v108, v109
v_pk_mul_f16 v111, v110, v111
v_lshl_add_u64 v[204:205], v[132:133], 0, v[134:135]
v_cvt_pkrtz_f16_f32 v100, v100, v101
v_cvt_pkrtz_f16_f32 v101, v102, v103
ds_read_u16 v99, v99
ds_read_u16 v97, v97
ds_read_b128 v[188:191], v250 offset:52224
v_lshrrev_b64 v[100:101], 2, v[100:101]
v_and_b32_sdwa v102, s47, v100 dst_sel:DWORD dst_unused:UNUSED_PAD src0_sel:DWORD src1_sel:WORD_1
v_and_b32_e64 v100, s47, v100
v_exp_f16_sdwa v109, v109 dst_sel:WORD_0 dst_unused:UNUSED_PRESERVE src0_sel:WORD_0
v_mfma_f32_32x32x16_bf16 v[160:175], v[52:55], v[180:183], v[160:175]
ds_read_u16 v102, v102
ds_read_u16 v100, v100
s_add_u32 m0, s72, 0
s_add_u32 s43, s82, 0
buffer_load_dwordx4 v246, s[16:19], s43 offen lds
v_exp_f16_sdwa v111, v111 dst_sel:WORD_0 dst_unused:UNUSED_PRESERVE src0_sel:WORD_0
v_and_b32_sdwa v103, s47, v101 dst_sel:DWORD dst_unused:UNUSED_PAD src0_sel:DWORD src1_sel:WORD_1
v_and_b32_e64 v101, s47, v101
v_exp_f16_sdwa v109, v109 dst_sel:WORD_1 dst_unused:UNUSED_PRESERVE src0_sel:WORD_1
v_lshl_add_u64 v[202:203], v[136:137], 0, v[138:139]
v_cvt_pkrtz_f16_f32 v104, v104, v105
v_cvt_pkrtz_f16_f32 v105, v106, v107
v_lshrrev_b64 v[104:105], 2, v[104:105]
v_and_b32_sdwa v106, s47, v104 dst_sel:DWORD dst_unused:UNUSED_PAD src0_sel:DWORD src1_sel:WORD_1
ds_read_u16 v103, v103
ds_read_u16 v101, v101
v_and_b32_e64 v104, s47, v104
v_mfma_f32_32x32x16_bf16 v[112:127], v[180:183], v[76:79], v[112:127]
ds_read_u16 v106, v106
ds_read_u16 v104, v104
v_exp_f16_sdwa v111, v111 dst_sel:WORD_1 dst_unused:UNUSED_PRESERVE src0_sel:WORD_1
v_and_b32_sdwa v107, s47, v105 dst_sel:DWORD dst_unused:UNUSED_PAD src0_sel:DWORD src1_sel:WORD_1
v_and_b32 v105, s47, v105
v_mfma_f32_32x32x16_f16 v[128:143], v[200:203], v[216:219], 0
ds_read_b128 v[176:179], v250 offset:53248
s_waitcnt lgkmcnt(9)
ds_read_u16 v107, v107
ds_read_u16 v105, v105
v_pk_add_f16 v109, v109, 1.0 op_sel_hi:[1,0]
v_pk_add_f16 v111, v111, 1.0 op_sel_hi:[1,0]
v_rcp_f16_sdwa v109, v109 dst_sel:WORD_0 dst_unused:UNUSED_PRESERVE src0_sel:WORD_0
v_mfma_f32_32x32x16_f16 v[128:143], v[204:207], v[220:223], v[128:143]
v_permlane16_swap_b32 v200, v204
v_permlane16_swap_b32 v201, v205
v_permlane16_swap_b32 v202, v206
v_permlane16_swap_b32 v203, v207
v_rcp_f16_sdwa v111, v111 dst_sel:WORD_0 dst_unused:UNUSED_PRESERVE src0_sel:WORD_0
v_mfma_f32_32x32x16_bf16 v[160:175], v[56:59], v[184:187], v[160:175]
v_rcp_f16_sdwa v109, v109 dst_sel:WORD_1 dst_unused:UNUSED_PRESERVE src0_sel:WORD_1
s_add_u32 m0, s72, 1024
s_add_u32 s43, s82, 64
buffer_load_dwordx4 v246, s[16:19], s43 offen lds
v_rcp_f16_sdwa v111, v111 dst_sel:WORD_1 dst_unused:UNUSED_PRESERVE src0_sel:WORD_1
s_nop 0
v_fmac_f32_e64 v230, v128, v128
v_mfma_f32_32x32x16_bf16 v[112:127], v[184:187], v[80:83], v[112:127]
ds_read_b128 v[180:183], v250 offset:54272
v_pk_mul_f16 v108, v108, v109
v_fmac_f32_e64 v230, v129, v129
v_pk_mul_f16 v110, v110, v111
v_fmac_f32 v230, v130, v130
v_fmac_f32 v230, v131, v131
v_fma_mix_f32 v231, v108, v108, v231 op_sel_hi:[1,1,0]
v_fmac_f32 v230, v132, v132
v_fmac_f32 v230, v133, v133
v_fma_mix_f32 v231, v110, v110, v231 op_sel_hi:[1,1,0]
s_waitcnt lgkmcnt(6)
v_mfma_f32_32x32x16_bf16 v[160:175], v[60:63], v[188:191], v[160:175]
v_fmac_f32 v230, v134, v134
v_fma_mix_f32 v231, v108, v108, v231 op_sel:[1,1,0] op_sel_hi:[1,1,0]
v_fmac_f32 v230, v135, v135
v_fmac_f32 v230, v136, v136
v_fma_mix_f32 v231, v110, v110, v231 op_sel:[1,1,0] op_sel_hi:[1,1,0]
v_fmac_f32_e64 v230, v137, v137
v_fma_mix_f32 v231, v96, v96, v231 op_sel_hi:[1,1,0]
v_fmac_f32_e64 v230, v138, v138
v_fma_mix_f32 v231, v97, v97, v231 op_sel_hi:[1,1,0]
v_cvt_pkrtz_f16_f32 v144, v144, v145
v_fma_mix_f32 v231, v98, v98, v231 op_sel_hi:[1,1,0]
v_cvt_pkrtz_f16_f32 v145, v146, v147
v_fma_mix_f32 v231, v99, v99, v231 op_sel_hi:[1,1,0]
v_lshrrev_b64 v[144:145], 2, v[144:145]
v_and_b32_sdwa v146, s47, v144 dst_sel:DWORD dst_unused:UNUSED_PAD src0_sel:DWORD src1_sel:WORD_1
v_and_b32_e64 v144, s47, v144
v_cvt_pk_f16_f32 v156, v156, v157
v_fmac_f32_e64 v230, v139, v139
v_cvt_pk_f16_f32 v158, v158, v159
v_fmac_f32 v230, v140, v140
v_fmac_f32 v230, v141, v141
v_mfma_f32_32x32x16_bf16 v[112:127], v[188:191], v[84:87], v[112:127]
ds_read_u16_d16_hi v146, v146
ds_read_u16 v144, v144
v_pk_fma_f16 v157, v156, v156, s48
v_fmac_f32_e64 v230, v142, v142
v_fma_mix_f32 v231, v100, v100, v231 op_sel_hi:[1,1,0]
v_and_b32_sdwa v147, s47, v145 dst_sel:DWORD dst_unused:UNUSED_PAD src0_sel:DWORD src1_sel:WORD_1
v_fma_mix_f32 v231, v101, v101, v231 op_sel_hi:[1,1,0]
v_and_b32 v145, s47, v145
v_fmac_f32 v230, v143, v143
v_pk_fma_f16 v159, v158, v158, s48
v_pk_mul_f16 v157, v156, v157
v_fma_mix_f32 v231, v102, v102, v231 op_sel_hi:[1,1,0]
v_cvt_pkrtz_f16_f32 v148, v148, v149
v_fma_mix_f32 v231, v103, v103, v231 op_sel_hi:[1,1,0]
ds_read_u16_d16_hi v147, v147
ds_read_u16 v145, v145
ds_read_b128 v[184:187], v250 offset:55296
v_cvt_pkrtz_f16_f32 v149, v150, v151
v_lshrrev_b64 v[148:149], 2, v[148:149]
v_and_b32_sdwa v150, s47, v148 dst_sel:DWORD dst_unused:UNUSED_PAD src0_sel:DWORD src1_sel:WORD_1
v_and_b32 v148, s47, v148
v_pk_mul_f16 v159, v158, v159
v_exp_f16_sdwa v157, v157 dst_sel:WORD_0 dst_unused:UNUSED_PRESERVE src0_sel:WORD_0
s_waitcnt lgkmcnt(5)
v_mfma_f32_32x32x16_bf16 v[160:175], v[64:67], v[176:179], v[160:175]
ds_read_u16_d16_hi v150, v150
ds_read_u16 v148, v148
s_add_u32 m0, s72, 2048
s_add_u32 s43, s82, 128
buffer_load_dwordx4 v246, s[16:19], s43 offen lds
v_fma_mix_f32 v231, v104, v104, v231 op_sel_hi:[1,1,0]
v_and_b32_sdwa v151, s47, v149 dst_sel:DWORD dst_unused:UNUSED_PAD src0_sel:DWORD src1_sel:WORD_1
v_fma_mix_f32 v231, v105, v105, v231 op_sel_hi:[1,1,0]
v_and_b32_e64 v149, s47, v149
v_exp_f16_sdwa v159, v159 dst_sel:WORD_0 dst_unused:UNUSED_PRESERVE src0_sel:WORD_0
v_fma_mix_f32 v231, v106, v106, v231 op_sel_hi:[1,1,0]
v_cvt_pkrtz_f16_f32 v152, v152, v153
v_fma_mix_f32 v231, v107, v107, v231 op_sel_hi:[1,1,0]
v_cvt_pkrtz_f16_f32 v153, v154, v155
v_lshrrev_b64 v[152:153], 2, v[152:153]
ds_read_u16_d16_hi v151, v151
ds_read_u16 v149, v149
v_and_b32_sdwa v154, s47, v152 dst_sel:DWORD dst_unused:UNUSED_PAD src0_sel:DWORD src1_sel:WORD_1
v_and_b32_e64 v152, s47, v152
v_exp_f16_sdwa v157, v157 dst_sel:WORD_1 dst_unused:UNUSED_PRESERVE src0_sel:WORD_1
v_mfma_f32_32x32x16_bf16 v[112:127], v[176:179], v[88:91], v[112:127]
ds_read_u16_d16_hi v154, v154
ds_read_u16 v152, v152
ds_read_b128 v[188:191], v250 offset:56320
v_and_b32_sdwa v155, s47, v153 dst_sel:DWORD dst_unused:UNUSED_PAD src0_sel:DWORD src1_sel:WORD_1
v_and_b32_e64 v153, s47, v153
v_exp_f16_sdwa v159, v159 dst_sel:WORD_1 dst_unused:UNUSED_PRESERVE src0_sel:WORD_1
v_pk_add_f16 v157, v157, 1.0 op_sel_hi:[1,0]
v_mfma_f32_32x32x16_bf16 v[160:175], v[68:71], v[180:183], v[160:175]
ds_read_u16_d16_hi v155, v155
ds_read_u16 v153, v153
v_pk_add_f16 v159, v159, 1.0 op_sel_hi:[1,0]
v_rcp_f16_sdwa v157, v157 dst_sel:WORD_0 dst_unused:UNUSED_PRESERVE src0_sel:WORD_0
v_rcp_f16_sdwa v159, v159 dst_sel:WORD_0 dst_unused:UNUSED_PRESERVE src0_sel:WORD_0
s_add_u32 m0, s72, 3072
s_add_u32 s43, s82, 3072
buffer_load_dwordx4 v246, s[16:19], s43 offen lds
v_mfma_f32_32x32x16_bf16 v[112:127], v[180:183], v[92:95], v[112:127]
ds_read_b128 v[176:179], v250 offset:57344
v_rcp_f16_sdwa v157, v157 dst_sel:WORD_1 dst_unused:UNUSED_PRESERVE src0_sel:WORD_1
v_rcp_f16_sdwa v159, v159 dst_sel:WORD_1 dst_unused:UNUSED_PRESERVE src0_sel:WORD_1
v_pk_mul_f16 v214, v156, v157
s_waitcnt lgkmcnt(7)
v_mfma_f32_32x32x16_bf16 v[128:143], v[48:51], v[184:187], 0
v_pk_mul_f16 v215, v158, v159
v_lshl_add_u64 v[208:209], v[144:145], 0, v[146:147]
v_cvt_pkrtz_f16_f32 v160, v160, v161
v_cvt_pkrtz_f16_f32 v161, v162, v163
v_lshrrev_b64 v[160:161], 2, v[160:161]
v_and_b32_sdwa v162, s47, v160 dst_sel:DWORD dst_unused:UNUSED_PAD src0_sel:DWORD src1_sel:WORD_1
v_and_b32 v160, s47, v160
v_cvt_pk_f16_f32 v172, v172, v173
v_cvt_pk_f16_f32 v174, v174, v175
v_mfma_f32_32x32x16_bf16 v[96:111], v[72:75], v[184:187], 0
ds_read_u16 v162, v162
ds_read_u16 v160, v160
v_pk_fma_f16 v173, v172, v172, s48
v_and_b32_sdwa v163, s47, v161 dst_sel:DWORD dst_unused:UNUSED_PAD src0_sel:DWORD src1_sel:WORD_1
v_and_b32 v161, s47, v161
v_pk_fma_f16 v175, v174, v174, s48
v_pk_mul_f16 v173, v172, v173
v_pk_mul_f16 v175, v174, v175
s_waitcnt lgkmcnt(5)
v_lshl_add_u64 v[212:213], v[148:149], 0, v[150:151]
v_cvt_pkrtz_f16_f32 v164, v164, v165
v_cvt_pkrtz_f16_f32 v165, v166, v167
ds_read_u16 v163, v163
ds_read_u16 v161, v161
ds_read_b128 v[180:183], v250 offset:58368
v_lshrrev_b64 v[164:165], 2, v[164:165]
v_and_b32_sdwa v166, s47, v164 dst_sel:DWORD dst_unused:UNUSED_PAD src0_sel:DWORD src1_sel:WORD_1
v_and_b32_e64 v164, s47, v164
v_exp_f16_sdwa v173, v173 dst_sel:WORD_0 dst_unused:UNUSED_PRESERVE src0_sel:WORD_0
v_mfma_f32_32x32x16_bf16 v[128:143], v[52:55], v[188:191], v[128:143]
ds_read_u16 v166, v166
ds_read_u16 v164, v164
s_add_u32 m0, s72, 4096
s_add_u32 s43, s82, 3136
buffer_load_dwordx4 v246, s[16:19], s43 offen lds
v_exp_f16_sdwa v175, v175 dst_sel:WORD_0 dst_unused:UNUSED_PRESERVE src0_sel:WORD_0
v_and_b32_sdwa v167, s47, v165 dst_sel:DWORD dst_unused:UNUSED_PAD src0_sel:DWORD src1_sel:WORD_1
v_and_b32 v165, s47, v165
v_exp_f16_sdwa v173, v173 dst_sel:WORD_1 dst_unused:UNUSED_PRESERVE src0_sel:WORD_1
s_waitcnt lgkmcnt(7)
v_lshl_add_u64 v[210:211], v[152:153], 0, v[154:155]
v_cvt_pkrtz_f16_f32 v168, v168, v169
v_cvt_pkrtz_f16_f32 v169, v170, v171
v_lshrrev_b64 v[168:169], 2, v[168:169]
v_and_b32_sdwa v170, s47, v168 dst_sel:DWORD dst_unused:UNUSED_PAD src0_sel:DWORD src1_sel:WORD_1
ds_read_u16 v167, v167
ds_read_u16 v165, v165
v_and_b32_e64 v168, s47, v168
v_mfma_f32_32x32x16_bf16 v[96:111], v[76:79], v[188:191], v[96:111]
ds_read_u16 v170, v170
ds_read_u16 v168, v168
v_exp_f16_sdwa v175, v175 dst_sel:WORD_1 dst_unused:UNUSED_PRESERVE src0_sel:WORD_1
v_and_b32_sdwa v171, s47, v169 dst_sel:DWORD dst_unused:UNUSED_PAD src0_sel:DWORD src1_sel:WORD_1
v_and_b32_e64 v169, s47, v169
v_mfma_f32_32x32x16_f16 v[144:159], v[208:211], v[216:219], 0
ds_read_b128 v[184:187], v250 offset:59392
ds_read_u16 v171, v171
ds_read_u16 v169, v169
v_pk_add_f16 v173, v173, 1.0 op_sel_hi:[1,0]
v_pk_add_f16 v175, v175, 1.0 op_sel_hi:[1,0]
v_rcp_f16_sdwa v173, v173 dst_sel:WORD_0 dst_unused:UNUSED_PRESERVE src0_sel:WORD_0
v_mfma_f32_32x32x16_f16 v[144:159], v[212:215], v[220:223], v[144:159]
v_permlane16_swap_b32 v208, v212
v_permlane16_swap_b32 v209, v213
v_permlane16_swap_b32 v210, v214
v_permlane16_swap_b32 v211, v215
v_rcp_f16_sdwa v175, v175 dst_sel:WORD_0 dst_unused:UNUSED_PRESERVE src0_sel:WORD_0
v_mfma_f32_32x32x16_bf16 v[128:143], v[56:59], v[176:179], v[128:143]
v_rcp_f16_sdwa v173, v173 dst_sel:WORD_1 dst_unused:UNUSED_PRESERVE src0_sel:WORD_1
s_add_u32 m0, s72, 6144
s_add_u32 s43, s82, 6144
buffer_load_dwordx4 v246, s[16:19], s43 offen lds
v_rcp_f16_sdwa v175, v175 dst_sel:WORD_1 dst_unused:UNUSED_PRESERVE src0_sel:WORD_1
s_nop 0
v_fmac_f32 v231, v144, v144
v_mfma_f32_32x32x16_bf16 v[96:111], v[80:83], v[176:179], v[96:111]
ds_read_b128 v[188:191], v250 offset:60416
v_pk_mul_f16 v172, v172, v173
v_fmac_f32_e64 v231, v145, v145
v_pk_mul_f16 v174, v174, v175
v_fmac_f32 v231, v146, v146
v_fmac_f32 v231, v147, v147
v_fma_mix_f32 v232, v172, v172, v232 op_sel_hi:[1,1,0]
v_fmac_f32 v231, v148, v148
v_fmac_f32 v231, v149, v149
v_fma_mix_f32 v232, v174, v174, v232 op_sel_hi:[1,1,0]
s_waitcnt lgkmcnt(6)
v_mfma_f32_32x32x16_bf16 v[128:143], v[60:63], v[180:183], v[128:143]
v_fmac_f32 v231, v150, v150
v_fma_mix_f32 v232, v172, v172, v232 op_sel:[1,1,0] op_sel_hi:[1,1,0]
v_fmac_f32 v231, v151, v151
v_fmac_f32 v231, v152, v152
v_fma_mix_f32 v232, v174, v174, v232 op_sel:[1,1,0] op_sel_hi:[1,1,0]
v_fmac_f32_e64 v231, v153, v153
v_fma_mix_f32 v232, v160, v160, v232 op_sel_hi:[1,1,0]
v_fmac_f32_e64 v231, v154, v154
v_fma_mix_f32 v232, v161, v161, v232 op_sel_hi:[1,1,0]
v_cvt_pkrtz_f16_f32 v112, v112, v113
v_fma_mix_f32 v232, v162, v162, v232 op_sel_hi:[1,1,0]
v_cvt_pkrtz_f16_f32 v113, v114, v115
v_fma_mix_f32 v232, v163, v163, v232 op_sel_hi:[1,1,0]
v_lshrrev_b64 v[112:113], 2, v[112:113]
v_and_b32_sdwa v114, s47, v112 dst_sel:DWORD dst_unused:UNUSED_PAD src0_sel:DWORD src1_sel:WORD_1
v_and_b32_e64 v112, s47, v112
v_cvt_pk_f16_f32 v124, v124, v125
v_fmac_f32_e64 v231, v155, v155
v_cvt_pk_f16_f32 v126, v126, v127
v_fmac_f32 v231, v156, v156
v_fmac_f32 v231, v157, v157
v_mfma_f32_32x32x16_bf16 v[96:111], v[84:87], v[180:183], v[96:111]
ds_read_u16_d16_hi v114, v114
ds_read_u16 v112, v112
v_pk_fma_f16 v125, v124, v124, s48
v_fmac_f32_e64 v231, v158, v158
v_fma_mix_f32 v232, v164, v164, v232 op_sel_hi:[1,1,0]
v_and_b32_sdwa v115, s47, v113 dst_sel:DWORD dst_unused:UNUSED_PAD src0_sel:DWORD src1_sel:WORD_1
v_fma_mix_f32 v232, v165, v165, v232 op_sel_hi:[1,1,0]
v_and_b32 v113, s47, v113
v_fmac_f32 v231, v159, v159
s_nop 1
v_permlane32_swap_b32 v230, v231
v_add_f32_e64 v230, v230, v231
v_pk_fma_f16 v127, v126, v126, s48
v_pk_mul_f16 v125, v124, v125
v_fma_mix_f32 v232, v166, v166, v232 op_sel_hi:[1,1,0]
ds_read_u16_d16_hi v115, v115
ds_read_u16 v113, v113
ds_write_b32 v248, v230 offset:8192
ds_read_b128 v[176:179], v250 offset:61440
v_fma_mix_f32 v232, v167, v167, v232 op_sel_hi:[1,1,0]
v_cvt_pkrtz_f16_f32 v116, v116, v117
v_cvt_pkrtz_f16_f32 v117, v118, v119
v_lshrrev_b64 v[116:117], 2, v[116:117]
v_and_b32_sdwa v118, s47, v116 dst_sel:DWORD dst_unused:UNUSED_PAD src0_sel:DWORD src1_sel:WORD_1
v_and_b32 v116, s47, v116
v_pk_mul_f16 v127, v126, v127
v_exp_f16_sdwa v125, v125 dst_sel:WORD_0 dst_unused:UNUSED_PRESERVE src0_sel:WORD_0
s_waitcnt lgkmcnt(6)
v_mfma_f32_32x32x16_bf16 v[128:143], v[64:67], v[184:187], v[128:143]
ds_read_u16_d16_hi v118, v118
ds_read_u16 v116, v116
s_add_u32 m0, s72, 7168
s_add_u32 s43, s82, 6208
buffer_load_dwordx4 v246, s[16:19], s43 offen lds
v_fma_mix_f32 v232, v168, v168, v232 op_sel_hi:[1,1,0]
v_and_b32_sdwa v119, s47, v117 dst_sel:DWORD dst_unused:UNUSED_PAD src0_sel:DWORD src1_sel:WORD_1
v_fma_mix_f32 v232, v169, v169, v232 op_sel_hi:[1,1,0]
v_and_b32_e64 v117, s47, v117
v_exp_f16_sdwa v127, v127 dst_sel:WORD_0 dst_unused:UNUSED_PRESERVE src0_sel:WORD_0
v_fma_mix_f32 v232, v170, v170, v232 op_sel_hi:[1,1,0]
v_cvt_pkrtz_f16_f32 v120, v120, v121
v_fma_mix_f32 v232, v171, v171, v232 op_sel_hi:[1,1,0]
v_cvt_pkrtz_f16_f32 v121, v122, v123
v_lshrrev_b64 v[120:121], 2, v[120:121]
ds_read_u16_d16_hi v119, v119
ds_read_u16 v117, v117
v_and_b32_sdwa v122, s47, v120 dst_sel:DWORD dst_unused:UNUSED_PAD src0_sel:DWORD src1_sel:WORD_1
v_and_b32_e64 v120, s47, v120
v_exp_f16_sdwa v125, v125 dst_sel:WORD_1 dst_unused:UNUSED_PRESERVE src0_sel:WORD_1
v_mfma_f32_32x32x16_bf16 v[96:111], v[88:91], v[184:187], v[96:111]
ds_read_u16_d16_hi v122, v122
ds_read_u16 v120, v120
ds_read_b128 v[180:183], v250 offset:62464
v_and_b32_sdwa v123, s47, v121 dst_sel:DWORD dst_unused:UNUSED_PAD src0_sel:DWORD src1_sel:WORD_1
v_and_b32 v121, s47, v121
v_exp_f16_sdwa v127, v127 dst_sel:WORD_1 dst_unused:UNUSED_PRESERVE src0_sel:WORD_1
v_pk_add_f16 v125, v125, 1.0 op_sel_hi:[1,0]
v_mfma_f32_32x32x16_bf16 v[128:143], v[68:71], v[188:191], v[128:143]
ds_read_u16_d16_hi v123, v123
ds_read_u16 v121, v121
v_pk_add_f16 v127, v127, 1.0 op_sel_hi:[1,0]
v_rcp_f16_sdwa v125, v125 dst_sel:WORD_0 dst_unused:UNUSED_PRESERVE src0_sel:WORD_0
v_rcp_f16_sdwa v127, v127 dst_sel:WORD_0 dst_unused:UNUSED_PRESERVE src0_sel:WORD_0
v_mfma_f32_32x32x16_bf16 v[96:111], v[92:95], v[188:191], v[96:111]
s_waitcnt lgkmcnt(8)
ds_read_b128 v[184:187], v250 offset:63488
v_rcp_f16_sdwa v125, v125 dst_sel:WORD_1 dst_unused:UNUSED_PRESERVE src0_sel:WORD_1
v_rcp_f16_sdwa v127, v127 dst_sel:WORD_1 dst_unused:UNUSED_PRESERVE src0_sel:WORD_1
v_pk_mul_f16 v230, v124, v125
v_mfma_f32_32x32x16_bf16 v[144:159], v[48:51], v[176:179], 0
v_pk_mul_f16 v231, v126, v127
v_lshl_add_u64 v[224:225], v[112:113], 0, v[114:115]
v_cvt_pkrtz_f16_f32 v128, v128, v129
v_cvt_pkrtz_f16_f32 v129, v130, v131
v_lshrrev_b64 v[128:129], 2, v[128:129]
v_and_b32_sdwa v130, s47, v128 dst_sel:DWORD dst_unused:UNUSED_PAD src0_sel:DWORD src1_sel:WORD_1
v_and_b32_e64 v128, s47, v128
v_cvt_pk_f16_f32 v140, v140, v141
v_cvt_pk_f16_f32 v142, v142, v143
v_mfma_f32_32x32x16_bf16 v[160:175], v[176:179], v[72:75], 0
ds_read_u16 v130, v130
ds_read_u16 v128, v128
v_pk_fma_f16 v141, v140, v140, s48
v_and_b32_sdwa v131, s47, v129 dst_sel:DWORD dst_unused:UNUSED_PAD src0_sel:DWORD src1_sel:WORD_1
v_and_b32 v129, s47, v129
v_pk_fma_f16 v143, v142, v142, s48
v_pk_mul_f16 v141, v140, v141
v_pk_mul_f16 v143, v142, v143
s_waitcnt lgkmcnt(6)
v_lshl_add_u64 v[228:229], v[116:117], 0, v[118:119]
v_cvt_pkrtz_f16_f32 v132, v132, v133
v_cvt_pkrtz_f16_f32 v133, v134, v135
ds_read_u16 v131, v131
ds_read_u16 v129, v129
ds_read_b128 v[188:191], v250 offset:64512
v_lshrrev_b64 v[132:133], 2, v[132:133]
v_and_b32_sdwa v134, s47, v132 dst_sel:DWORD dst_unused:UNUSED_PAD src0_sel:DWORD src1_sel:WORD_1
v_and_b32 v132, s47, v132
v_exp_f16_sdwa v141, v141 dst_sel:WORD_0 dst_unused:UNUSED_PRESERVE src0_sel:WORD_0
s_waitcnt lgkmcnt(7)
v_mfma_f32_32x32x16_bf16 v[144:159], v[52:55], v[180:183], v[144:159]
ds_read_u16 v134, v134
ds_read_u16 v132, v132
v_exp_f16_sdwa v143, v143 dst_sel:WORD_0 dst_unused:UNUSED_PRESERVE src0_sel:WORD_0
v_and_b32_sdwa v135, s47, v133 dst_sel:DWORD dst_unused:UNUSED_PAD src0_sel:DWORD src1_sel:WORD_1
v_and_b32 v133, s47, v133
v_exp_f16_sdwa v141, v141 dst_sel:WORD_1 dst_unused:UNUSED_PRESERVE src0_sel:WORD_1
s_waitcnt lgkmcnt(7)
v_lshl_add_u64 v[226:227], v[120:121], 0, v[122:123]
v_cvt_pkrtz_f16_f32 v136, v136, v137
v_cvt_pkrtz_f16_f32 v137, v138, v139
v_lshrrev_b64 v[136:137], 2, v[136:137]
v_and_b32_sdwa v138, s47, v136 dst_sel:DWORD dst_unused:UNUSED_PAD src0_sel:DWORD src1_sel:WORD_1
ds_read_u16 v135, v135
ds_read_u16 v133, v133
v_and_b32_e64 v136, s47, v136
v_mfma_f32_32x32x16_bf16 v[160:175], v[180:183], v[76:79], v[160:175]
ds_read_u16 v138, v138
ds_read_u16 v136, v136
v_exp_f16_sdwa v143, v143 dst_sel:WORD_1 dst_unused:UNUSED_PRESERVE src0_sel:WORD_1
v_and_b32_sdwa v139, s47, v137 dst_sel:DWORD dst_unused:UNUSED_PAD src0_sel:DWORD src1_sel:WORD_1
v_and_b32_e64 v137, s47, v137
v_mfma_f32_32x32x16_f16 v[112:127], v[224:227], v[216:219], 0
ds_read_b128 v[176:179], v251
ds_read_u16 v139, v139
ds_read_u16 v137, v137
v_pk_add_f16 v141, v141, 1.0 op_sel_hi:[1,0]
v_pk_add_f16 v143, v143, 1.0 op_sel_hi:[1,0]
v_rcp_f16_sdwa v141, v141 dst_sel:WORD_0 dst_unused:UNUSED_PRESERVE src0_sel:WORD_0
v_mfma_f32_32x32x16_f16 v[112:127], v[228:231], v[220:223], v[112:127]
v_permlane16_swap_b32 v224, v228
v_permlane16_swap_b32 v225, v229
v_permlane16_swap_b32 v226, v230
v_permlane16_swap_b32 v227, v231
v_rcp_f16_sdwa v143, v143 dst_sel:WORD_0 dst_unused:UNUSED_PRESERVE src0_sel:WORD_0
v_mfma_f32_32x32x16_bf16 v[144:159], v[56:59], v[184:187], v[144:159]
v_rcp_f16_sdwa v141, v141 dst_sel:WORD_1 dst_unused:UNUSED_PRESERVE src0_sel:WORD_1
v_rcp_f16_sdwa v143, v143 dst_sel:WORD_1 dst_unused:UNUSED_PRESERVE src0_sel:WORD_1
s_nop 3
v_fmac_f32 v232, v112, v112
v_mfma_f32_32x32x16_bf16 v[160:175], v[184:187], v[80:83], v[160:175]
ds_read_b128 v[180:183], v251 offset:1024
v_pk_mul_f16 v140, v140, v141
v_fmac_f32_e64 v232, v113, v113
v_pk_mul_f16 v142, v142, v143
v_fmac_f32 v232, v114, v114
v_fmac_f32 v232, v115, v115
v_fma_mix_f32 v233, v140, v140, v233 op_sel_hi:[1,1,0]
v_fmac_f32 v232, v116, v116
v_fmac_f32 v232, v117, v117
v_fma_mix_f32 v233, v142, v142, v233 op_sel_hi:[1,1,0]
s_waitcnt lgkmcnt(6)
v_mfma_f32_32x32x16_bf16 v[144:159], v[60:63], v[188:191], v[144:159]
v_fmac_f32 v232, v118, v118
v_fma_mix_f32 v233, v140, v140, v233 op_sel:[1,1,0] op_sel_hi:[1,1,0]
v_fmac_f32 v232, v119, v119
v_fmac_f32 v232, v120, v120
v_fma_mix_f32 v233, v142, v142, v233 op_sel:[1,1,0] op_sel_hi:[1,1,0]
v_fmac_f32_e64 v232, v121, v121
v_fma_mix_f32 v233, v128, v128, v233 op_sel_hi:[1,1,0]
v_fmac_f32_e64 v232, v122, v122
v_fma_mix_f32 v233, v129, v129, v233 op_sel_hi:[1,1,0]
v_cvt_pkrtz_f16_f32 v96, v96, v97
v_fma_mix_f32 v233, v130, v130, v233 op_sel_hi:[1,1,0]
v_cvt_pkrtz_f16_f32 v97, v98, v99
v_fma_mix_f32 v233, v131, v131, v233 op_sel_hi:[1,1,0]
v_lshrrev_b64 v[96:97], 2, v[96:97]
v_and_b32_sdwa v98, s47, v96 dst_sel:DWORD dst_unused:UNUSED_PAD src0_sel:DWORD src1_sel:WORD_1
v_and_b32_e64 v96, s47, v96
v_cvt_pk_f16_f32 v108, v108, v109
v_fmac_f32_e64 v232, v123, v123
v_cvt_pk_f16_f32 v110, v110, v111
v_fmac_f32 v232, v124, v124
v_fmac_f32 v232, v125, v125
v_mfma_f32_32x32x16_bf16 v[160:175], v[188:191], v[84:87], v[160:175]
ds_read_u16 v98, v98
ds_read_u16 v96, v96
v_pk_fma_f16 v109, v108, v108, s48
v_fmac_f32_e64 v232, v126, v126
v_fma_mix_f32 v233, v132, v132, v233 op_sel_hi:[1,1,0]
v_and_b32_sdwa v99, s47, v97 dst_sel:DWORD dst_unused:UNUSED_PAD src0_sel:DWORD src1_sel:WORD_1
v_fma_mix_f32 v233, v133, v133, v233 op_sel_hi:[1,1,0]
v_and_b32 v97, s47, v97
v_fmac_f32 v232, v127, v127
v_pk_fma_f16 v111, v110, v110, s48
v_pk_mul_f16 v109, v108, v109
v_pk_mul_f16 v111, v110, v111
v_fma_mix_f32 v233, v134, v134, v233 op_sel_hi:[1,1,0]
v_cvt_pkrtz_f16_f32 v100, v100, v101
ds_read_u16 v99, v99
ds_read_u16 v97, v97
ds_read_b128 v[184:187], v251 offset:2048
v_fma_mix_f32 v233, v135, v135, v233 op_sel_hi:[1,1,0]
v_cvt_pkrtz_f16_f32 v101, v102, v103
v_lshrrev_b64 v[100:101], 2, v[100:101]
v_and_b32_sdwa v102, s47, v100 dst_sel:DWORD dst_unused:UNUSED_PAD src0_sel:DWORD src1_sel:WORD_1
v_and_b32 v100, s47, v100
v_exp_f16_sdwa v109, v109 dst_sel:WORD_0 dst_unused:UNUSED_PRESERVE src0_sel:WORD_0
s_waitcnt lgkmcnt(5)
v_mfma_f32_32x32x16_bf16 v[144:159], v[64:67], v[176:179], v[144:159]
ds_read_u16 v102, v102
ds_read_u16 v100, v100
v_fma_mix_f32 v233, v136, v136, v233 op_sel_hi:[1,1,0]
v_exp_f16_sdwa v111, v111 dst_sel:WORD_0 dst_unused:UNUSED_PRESERVE src0_sel:WORD_0
v_fma_mix_f32 v233, v137, v137, v233 op_sel_hi:[1,1,0]
v_and_b32_sdwa v103, s47, v101 dst_sel:DWORD dst_unused:UNUSED_PAD src0_sel:DWORD src1_sel:WORD_1
v_and_b32_e64 v101, s47, v101
v_exp_f16_sdwa v109, v109 dst_sel:WORD_1 dst_unused:UNUSED_PRESERVE src0_sel:WORD_1
v_fma_mix_f32 v233, v138, v138, v233 op_sel_hi:[1,1,0]
v_cvt_pkrtz_f16_f32 v104, v104, v105
v_fma_mix_f32 v233, v139, v139, v233 op_sel_hi:[1,1,0]
v_cvt_pkrtz_f16_f32 v105, v106, v107
v_lshrrev_b64 v[104:105], 2, v[104:105]
ds_read_u16 v103, v103
ds_read_u16 v101, v101
v_and_b32_sdwa v106, s47, v104 dst_sel:DWORD dst_unused:UNUSED_PAD src0_sel:DWORD src1_sel:WORD_1
v_and_b32_e64 v104, s47, v104
v_mfma_f32_32x32x16_bf16 v[160:175], v[176:179], v[88:91], v[160:175]
ds_read_u16 v106, v106
ds_read_u16 v104, v104
v_exp_f16_sdwa v111, v111 dst_sel:WORD_1 dst_unused:UNUSED_PRESERVE src0_sel:WORD_1
v_and_b32_sdwa v107, s47, v105 dst_sel:DWORD dst_unused:UNUSED_PAD src0_sel:DWORD src1_sel:WORD_1
v_and_b32_e64 v105, s47, v105
v_pk_add_f16 v109, v109, 1.0 op_sel_hi:[1,0]
v_pk_add_f16 v111, v111, 1.0 op_sel_hi:[1,0]
v_rcp_f16_sdwa v109, v109 dst_sel:WORD_0 dst_unused:UNUSED_PRESERVE src0_sel:WORD_0
v_mfma_f32_32x32x16_bf16 v[144:159], v[68:71], v[180:183], v[144:159]
ds_read_b128 v[188:191], v251 offset:3072
ds_read_u16 v107, v107
ds_read_u16 v105, v105
v_rcp_f16_sdwa v111, v111 dst_sel:WORD_0 dst_unused:UNUSED_PRESERVE src0_sel:WORD_0
v_rcp_f16_sdwa v109, v109 dst_sel:WORD_1 dst_unused:UNUSED_PRESERVE src0_sel:WORD_1
v_mfma_f32_32x32x16_bf16 v[160:175], v[180:183], v[92:95], v[160:175]
v_rcp_f16_sdwa v111, v111 dst_sel:WORD_1 dst_unused:UNUSED_PRESERVE src0_sel:WORD_1
v_pk_mul_f16 v108, v108, v109
v_pk_mul_f16 v110, v110, v111
v_fma_mix_f32 v233, v108, v108, v233 op_sel_hi:[1,1,0]
s_waitcnt lgkmcnt(6)
v_mfma_f32_32x32x16_bf16 v[112:127], v[48:51], v[184:187], 0
ds_read_b128 v[176:179], v251 offset:4096
v_fma_mix_f32 v233, v110, v110, v233 op_sel_hi:[1,1,0]
v_bfe_u32 v237, v250, 4, 6
v_min_u32 v237, 47, v237
v_lshlrev_b32_e64 v244, 5, v237
v_add_u32 v244, 95232, v244
v_add_u32 v245, 2304, v244
v_cmp_gt_u32 vcc, 24, v237
s_nop 1
v_cndmask_b32 v244, v245, v244, vcc
v_lshlrev_b32 v237, 13, v237
v_add_u32 v245, 4096, v237
v_fma_mix_f32 v233, v108, v108, v233 op_sel:[1,1,0] op_sel_hi:[1,1,0]
v_cvt_pkrtz_f16_f32 v144, v144, v145
v_fma_mix_f32 v233, v110, v110, v233 op_sel:[1,1,0] op_sel_hi:[1,1,0]
v_cvt_pkrtz_f16_f32 v145, v146, v147
v_fma_mix_f32 v233, v96, v96, v233 op_sel_hi:[1,1,0]
v_lshrrev_b64 v[144:145], 2, v[144:145]
v_fma_mix_f32 v233, v97, v97, v233 op_sel_hi:[1,1,0]
v_and_b32_sdwa v146, s47, v144 dst_sel:DWORD dst_unused:UNUSED_PAD src0_sel:DWORD src1_sel:WORD_1
v_fma_mix_f32 v233, v98, v98, v233 op_sel_hi:[1,1,0]
v_and_b32_e64 v144, s47, v144
v_fma_mix_f32 v233, v99, v99, v233 op_sel_hi:[1,1,0]
v_cvt_pk_f16_f32 v156, v156, v157
v_cvt_pk_f16_f32 v158, v158, v159
v_mfma_f32_32x32x16_bf16 v[128:143], v[184:187], v[72:75], 0
ds_read_u16 v146, v146
ds_read_u16 v144, v144
v_pk_fma_f16 v157, v156, v156, s48
v_fma_mix_f32 v233, v100, v100, v233 op_sel_hi:[1,1,0]
v_and_b32_sdwa v147, s47, v145 dst_sel:DWORD dst_unused:UNUSED_PAD src0_sel:DWORD src1_sel:WORD_1
s_waitcnt lgkmcnt(3)
v_fma_mix_f32 v233, v101, v101, v233 op_sel_hi:[1,1,0]
v_and_b32 v145, s47, v145
v_pk_fma_f16 v159, v158, v158, s48
v_pk_mul_f16 v157, v156, v157
v_pk_mul_f16 v159, v158, v159
v_fma_mix_f32 v233, v102, v102, v233 op_sel_hi:[1,1,0]
v_cvt_pkrtz_f16_f32 v148, v148, v149
v_fma_mix_f32 v233, v103, v103, v233 op_sel_hi:[1,1,0]
ds_read_u16 v147, v147
ds_read_u16 v145, v145
ds_read_b128 v[180:183], v251 offset:5120
v_cvt_pkrtz_f16_f32 v149, v150, v151
v_lshrrev_b64 v[148:149], 2, v[148:149]
v_and_b32_sdwa v150, s47, v148 dst_sel:DWORD dst_unused:UNUSED_PAD src0_sel:DWORD src1_sel:WORD_1
v_and_b32_e64 v148, s47, v148
v_exp_f16_sdwa v157, v157 dst_sel:WORD_0 dst_unused:UNUSED_PRESERVE src0_sel:WORD_0
v_mfma_f32_32x32x16_bf16 v[112:127], v[52:55], v[188:191], v[112:127]
ds_read_u16 v150, v150
ds_read_u16 v148, v148
v_fma_mix_f32 v233, v104, v104, v233 op_sel_hi:[1,1,0]
v_exp_f16_sdwa v159, v159 dst_sel:WORD_0 dst_unused:UNUSED_PRESERVE src0_sel:WORD_0
v_fma_mix_f32 v233, v105, v105, v233 op_sel_hi:[1,1,0]
v_and_b32_sdwa v151, s47, v149 dst_sel:DWORD dst_unused:UNUSED_PAD src0_sel:DWORD src1_sel:WORD_1
v_and_b32_e64 v149, s47, v149
v_exp_f16_sdwa v157, v157 dst_sel:WORD_1 dst_unused:UNUSED_PRESERVE src0_sel:WORD_1
v_fma_mix_f32 v233, v106, v106, v233 op_sel_hi:[1,1,0]
v_cvt_pkrtz_f16_f32 v152, v152, v153
v_fma_mix_f32 v233, v107, v107, v233 op_sel_hi:[1,1,0]
v_cvt_pkrtz_f16_f32 v153, v154, v155
v_lshrrev_b64 v[152:153], 2, v[152:153]
ds_read_u16 v151, v151
ds_read_u16 v149, v149
v_and_b32_sdwa v154, s47, v152 dst_sel:DWORD dst_unused:UNUSED_PAD src0_sel:DWORD src1_sel:WORD_1
v_and_b32_e64 v152, s47, v152
v_mfma_f32_32x32x16_bf16 v[128:143], v[188:191], v[76:79], v[128:143]
ds_read_u16 v154, v154
ds_read_u16 v152, v152
v_exp_f16_sdwa v159, v159 dst_sel:WORD_1 dst_unused:UNUSED_PRESERVE src0_sel:WORD_1
v_and_b32_sdwa v155, s47, v153 dst_sel:DWORD dst_unused:UNUSED_PAD src0_sel:DWORD src1_sel:WORD_1
v_and_b32 v153, s47, v153
v_pk_add_f16 v157, v157, 1.0 op_sel_hi:[1,0]
v_pk_add_f16 v159, v159, 1.0 op_sel_hi:[1,0]
v_rcp_f16_sdwa v157, v157 dst_sel:WORD_0 dst_unused:UNUSED_PRESERVE src0_sel:WORD_0
s_waitcnt lgkmcnt(6)
v_mfma_f32_32x32x16_bf16 v[112:127], v[56:59], v[176:179], v[112:127]
ds_read_b128 v[184:187], v251 offset:6144
ds_read_u16 v155, v155
ds_read_u16 v153, v153
v_rcp_f16_sdwa v159, v159 dst_sel:WORD_0 dst_unused:UNUSED_PRESERVE src0_sel:WORD_0
v_rcp_f16_sdwa v157, v157 dst_sel:WORD_1 dst_unused:UNUSED_PRESERVE src0_sel:WORD_1
v_mfma_f32_32x32x16_bf16 v[128:143], v[176:179], v[80:83], v[128:143]
v_rcp_f16_sdwa v159, v159 dst_sel:WORD_1 dst_unused:UNUSED_PRESERVE src0_sel:WORD_1
v_pk_mul_f16 v156, v156, v157
v_pk_mul_f16 v158, v158, v159
v_fma_mix_f32 v234, v156, v156, v234 op_sel_hi:[1,1,0]
v_mfma_f32_32x32x16_bf16 v[112:127], v[60:63], v[180:183], v[112:127]
ds_read_b128 v[188:191], v251 offset:7168
v_fma_mix_f32 v234, v158, v158, v234 op_sel_hi:[1,1,0]
v_permlane32_swap_b32 v232, v233
v_add_f32_e64 v232, v232, v233
s_setprio 1
ds_write_b32 v248, v232 offset:8448
v_fma_mix_f32 v234, v156, v156, v234 op_sel:[1,1,0] op_sel_hi:[1,1,0]
v_cvt_pkrtz_f16_f32 v160, v160, v161
v_fma_mix_f32 v234, v158, v158, v234 op_sel:[1,1,0] op_sel_hi:[1,1,0]
v_cvt_pkrtz_f16_f32 v161, v162, v163
v_fma_mix_f32 v234, v144, v144, v234 op_sel_hi:[1,1,0]
v_lshrrev_b64 v[160:161], 2, v[160:161]
v_fma_mix_f32 v234, v145, v145, v234 op_sel_hi:[1,1,0]
v_and_b32_sdwa v162, s47, v160 dst_sel:DWORD dst_unused:UNUSED_PAD src0_sel:DWORD src1_sel:WORD_1
v_fma_mix_f32 v234, v146, v146, v234 op_sel_hi:[1,1,0]
v_and_b32_e64 v160, s47, v160
v_fma_mix_f32 v234, v147, v147, v234 op_sel_hi:[1,1,0]
v_cvt_pk_f16_f32 v172, v172, v173
v_cvt_pk_f16_f32 v174, v174, v175
v_mfma_f32_32x32x16_bf16 v[128:143], v[180:183], v[84:87], v[128:143]
ds_read_u16_d16_hi v162, v162
ds_read_u16 v160, v160
v_pk_fma_f16 v173, v172, v172, s48
s_waitcnt lgkmcnt(6)
v_fma_mix_f32 v234, v148, v148, v234 op_sel_hi:[1,1,0]
v_and_b32_sdwa v163, s47, v161 dst_sel:DWORD dst_unused:UNUSED_PAD src0_sel:DWORD src1_sel:WORD_1
v_fma_mix_f32 v234, v149, v149, v234 op_sel_hi:[1,1,0]
v_and_b32 v161, s47, v161
v_pk_fma_f16 v175, v174, v174, s48
v_pk_mul_f16 v173, v172, v173
v_fma_mix_f32 v234, v150, v150, v234 op_sel_hi:[1,1,0]
v_cvt_pkrtz_f16_f32 v164, v164, v165
v_fma_mix_f32 v234, v151, v151, v234 op_sel_hi:[1,1,0]
v_cvt_pkrtz_f16_f32 v165, v166, v167
ds_read_u16_d16_hi v163, v163
ds_read_u16 v161, v161
v_lshrrev_b64 v[164:165], 2, v[164:165]
v_and_b32_sdwa v166, s47, v164 dst_sel:DWORD dst_unused:UNUSED_PAD src0_sel:DWORD src1_sel:WORD_1
v_and_b32_e64 v164, s47, v164
v_pk_mul_f16 v175, v174, v175
v_exp_f16_sdwa v173, v173 dst_sel:WORD_0 dst_unused:UNUSED_PRESERVE src0_sel:WORD_0
v_mfma_f32_32x32x16_bf16 v[112:127], v[64:67], v[184:187], v[112:127]
ds_read_u16_d16_hi v166, v166
ds_read_u16 v164, v164
v_fma_mix_f32 v234, v152, v152, v234 op_sel_hi:[1,1,0]
v_and_b32_sdwa v167, s47, v165 dst_sel:DWORD dst_unused:UNUSED_PAD src0_sel:DWORD src1_sel:WORD_1
s_waitcnt lgkmcnt(6)
v_fma_mix_f32 v234, v153, v153, v234 op_sel_hi:[1,1,0]
v_and_b32 v165, s47, v165
v_exp_f16_sdwa v175, v175 dst_sel:WORD_0 dst_unused:UNUSED_PRESERVE src0_sel:WORD_0
v_fma_mix_f32 v234, v154, v154, v234 op_sel_hi:[1,1,0]
v_cvt_pkrtz_f16_f32 v168, v168, v169
v_fma_mix_f32 v234, v155, v155, v234 op_sel_hi:[1,1,0]
v_cvt_pkrtz_f16_f32 v169, v170, v171
v_lshrrev_b64 v[168:169], 2, v[168:169]
ds_read_u16_d16_hi v167, v167
ds_read_u16 v165, v165
v_and_b32_sdwa v170, s47, v168 dst_sel:DWORD dst_unused:UNUSED_PAD src0_sel:DWORD src1_sel:WORD_1
v_and_b32_e64 v168, s47, v168
v_exp_f16_sdwa v173, v173 dst_sel:WORD_1 dst_unused:UNUSED_PRESERVE src0_sel:WORD_1
v_mfma_f32_32x32x16_bf16 v[128:143], v[184:187], v[88:91], v[128:143]
ds_read_u16_d16_hi v170, v170
ds_read_u16 v168, v168
v_and_b32_sdwa v171, s47, v169 dst_sel:DWORD dst_unused:UNUSED_PAD src0_sel:DWORD src1_sel:WORD_1
v_and_b32_e64 v169, s47, v169
v_exp_f16_sdwa v175, v175 dst_sel:WORD_1 dst_unused:UNUSED_PRESERVE src0_sel:WORD_1
v_pk_add_f16 v173, v173, 1.0 op_sel_hi:[1,0]
v_mfma_f32_32x32x16_bf16 v[112:127], v[68:71], v[188:191], v[112:127]
ds_read_u16_d16_hi v171, v171
ds_read_u16 v169, v169
v_pk_add_f16 v175, v175, 1.0 op_sel_hi:[1,0]
v_rcp_f16_sdwa v173, v173 dst_sel:WORD_0 dst_unused:UNUSED_PRESERVE src0_sel:WORD_0
v_rcp_f16_sdwa v175, v175 dst_sel:WORD_0 dst_unused:UNUSED_PRESERVE src0_sel:WORD_0
v_mfma_f32_32x32x16_bf16 v[128:143], v[188:191], v[92:95], v[128:143]
v_rcp_f16_sdwa v173, v173 dst_sel:WORD_1 dst_unused:UNUSED_PRESERVE src0_sel:WORD_1
v_rcp_f16_sdwa v175, v175 dst_sel:WORD_1 dst_unused:UNUSED_PRESERVE src0_sel:WORD_1
v_pk_mul_f16 v102, v172, v173
v_pk_mul_f16 v103, v174, v175
s_waitcnt lgkmcnt(5)
v_lshl_add_u64 v[96:97], v[160:161], 0, v[162:163]
s_waitcnt lgkmcnt(4)
v_lshl_add_u64 v[100:101], v[164:165], 0, v[166:167]
ds_read_b128 v[176:179], v250
ds_read_b128 v[180:183], v250 offset:1024
ds_read_b128 v[184:187], v250 offset:2048
s_nop 0
v_cvt_pkrtz_f16_f32 v128, v128, v129
v_cvt_pkrtz_f16_f32 v129, v130, v131
v_lshrrev_b64 v[128:129], 2, v[128:129]
v_and_b32_sdwa v130, s47, v128 dst_sel:DWORD dst_unused:UNUSED_PAD src0_sel:DWORD src1_sel:WORD_1
v_and_b32 v128, s47, v128
v_cvt_pk_f16_f32 v140, v140, v141
v_cvt_pk_f16_f32 v142, v142, v143
v_pk_fma_f16 v141, v140, v140, s48
v_and_b32_sdwa v131, s47, v129 dst_sel:DWORD dst_unused:UNUSED_PAD src0_sel:DWORD src1_sel:WORD_1
v_and_b32_e64 v129, s47, v129
v_pk_fma_f16 v143, v142, v142, s48
ds_read_u16_d16_hi v130, v130
ds_read_u16 v128, v128
ds_read_u16_d16_hi v131, v131
ds_read_u16 v129, v129
v_pk_mul_f16 v141, v140, v141
v_cvt_pkrtz_f16_f32 v132, v132, v133
v_cvt_pkrtz_f16_f32 v133, v134, v135
v_lshrrev_b64 v[132:133], 2, v[132:133]
v_and_b32_sdwa v134, s47, v132 dst_sel:DWORD dst_unused:UNUSED_PAD src0_sel:DWORD src1_sel:WORD_1
v_and_b32_e64 v132, s47, v132
v_pk_mul_f16 v143, v142, v143
v_exp_f16_sdwa v141, v141 dst_sel:WORD_0 dst_unused:UNUSED_PRESERVE src0_sel:WORD_0
v_and_b32_sdwa v135, s47, v133 dst_sel:DWORD dst_unused:UNUSED_PAD src0_sel:DWORD src1_sel:WORD_1
v_and_b32 v133, s47, v133
v_exp_f16_sdwa v143, v143 dst_sel:WORD_0 dst_unused:UNUSED_PRESERVE src0_sel:WORD_0
s_waitcnt lgkmcnt(6)
v_lshl_add_u64 v[98:99], v[168:169], 0, v[170:171]
ds_read_u16_d16_hi v134, v134
ds_read_u16 v132, v132
ds_read_u16_d16_hi v135, v135
ds_read_u16 v133, v133
v_cvt_pkrtz_f16_f32 v136, v136, v137
v_cvt_pkrtz_f16_f32 v137, v138, v139
v_lshrrev_b64 v[136:137], 2, v[136:137]
v_and_b32_sdwa v138, s47, v136 dst_sel:DWORD dst_unused:UNUSED_PAD src0_sel:DWORD src1_sel:WORD_1
v_and_b32_e64 v136, s47, v136
v_exp_f16_sdwa v141, v141 dst_sel:WORD_1 dst_unused:UNUSED_PRESERVE src0_sel:WORD_1
v_mfma_f32_32x32x16_f16 v[160:175], v[96:99], v[216:219], 0
ds_read_u16_d16_hi v138, v138
ds_read_u16 v136, v136
v_and_b32_sdwa v139, s47, v137 dst_sel:DWORD dst_unused:UNUSED_PAD src0_sel:DWORD src1_sel:WORD_1
v_and_b32_e64 v137, s47, v137
v_exp_f16_sdwa v143, v143 dst_sel:WORD_1 dst_unused:UNUSED_PRESERVE src0_sel:WORD_1
v_pk_add_f16 v141, v141, 1.0 op_sel_hi:[1,0]
v_mfma_f32_32x32x16_f16 v[160:175], v[100:103], v[220:223], v[160:175]
ds_read_u16_d16_hi v139, v139
ds_read_u16 v137, v137
v_pk_add_f16 v143, v143, 1.0 op_sel_hi:[1,0]
v_permlane16_swap_b32 v96, v100
v_permlane16_swap_b32 v97, v101
v_permlane16_swap_b32 v98, v102
v_permlane16_swap_b32 v99, v103
v_rcp_f16_sdwa v141, v141 dst_sel:WORD_0 dst_unused:UNUSED_PRESERVE src0_sel:WORD_0
v_rcp_f16_sdwa v143, v143 dst_sel:WORD_0 dst_unused:UNUSED_PRESERVE src0_sel:WORD_0
v_rcp_f16_sdwa v141, v141 dst_sel:WORD_1 dst_unused:UNUSED_PRESERVE src0_sel:WORD_1
s_nop 1
v_fmac_f32 v234, v160, v160
v_fmac_f32 v234, v161, v161
v_fmac_f32 v234, v162, v162
ds_read_b128 v[188:191], v250 offset:3072
v_rcp_f16_sdwa v143, v143 dst_sel:WORD_1 dst_unused:UNUSED_PRESERVE src0_sel:WORD_1
v_fmac_f32 v234, v163, v163
v_fmac_f32 v234, v164, v164
v_fmac_f32 v234, v165, v165
v_mfma_f32_32x32x16_bf16 v[144:159], v[176:179], v[72:75], 0
s_waitcnt lgkmcnt(7)
ds_read_b128 v[176:179], v250 offset:4096
v_fmac_f32_e64 v234, v166, v166
v_pk_mul_f16 v110, v140, v141
v_fmac_f32 v234, v167, v167
v_fmac_f32 v234, v168, v168
v_pk_mul_f16 v111, v142, v143
v_fmac_f32_e64 v234, v169, v169
v_lshl_add_u64 v[104:105], v[128:129], 0, v[130:131]
v_fmac_f32_e64 v234, v170, v170
v_cvt_pkrtz_f16_f32 v112, v112, v113
v_cvt_pkrtz_f16_f32 v113, v114, v115
v_lshrrev_b64 v[112:113], 2, v[112:113]
v_and_b32_sdwa v114, s47, v112 dst_sel:DWORD dst_unused:UNUSED_PAD src0_sel:DWORD src1_sel:WORD_1
v_and_b32_e64 v112, s47, v112
v_cvt_pk_f16_f32 v124, v124, v125
v_fmac_f32_e64 v234, v171, v171
v_cvt_pk_f16_f32 v126, v126, v127
v_fmac_f32 v234, v172, v172
v_fmac_f32 v234, v173, v173
v_mfma_f32_32x32x16_bf16 v[144:159], v[180:183], v[76:79], v[144:159]
ds_read_u16 v114, v114
ds_read_u16 v112, v112
ds_read_b128 v[180:183], v250 offset:5120
v_pk_fma_f16 v125, v124, v124, s48
v_fmac_f32_e64 v234, v174, v174
v_and_b32_sdwa v115, s47, v113 dst_sel:DWORD dst_unused:UNUSED_PAD src0_sel:DWORD src1_sel:WORD_1
v_and_b32_e64 v113, s47, v113
v_fmac_f32 v234, v175, v175
v_pk_fma_f16 v127, v126, v126, s48
v_pk_mul_f16 v125, v124, v125
v_pk_mul_f16 v127, v126, v127
s_waitcnt lgkmcnt(6)
v_lshl_add_u64 v[108:109], v[132:133], 0, v[134:135]
v_cvt_pkrtz_f16_f32 v116, v116, v117
ds_read_u16 v115, v115
ds_read_u16 v113, v113
v_cvt_pkrtz_f16_f32 v117, v118, v119
v_lshrrev_b64 v[116:117], 2, v[116:117]
v_and_b32_sdwa v118, s47, v116 dst_sel:DWORD dst_unused:UNUSED_PAD src0_sel:DWORD src1_sel:WORD_1
v_and_b32_e64 v116, s47, v116
v_exp_f16_sdwa v125, v125 dst_sel:WORD_0 dst_unused:UNUSED_PRESERVE src0_sel:WORD_0
v_mfma_f32_32x32x16_bf16 v[144:159], v[184:187], v[80:83], v[144:159]
ds_read_u16 v118, v118
ds_read_u16 v116, v116
ds_read_b128 v[184:187], v250 offset:6144
v_exp_f16_sdwa v127, v127 dst_sel:WORD_0 dst_unused:UNUSED_PRESERVE src0_sel:WORD_0
v_and_b32_sdwa v119, s47, v117 dst_sel:DWORD dst_unused:UNUSED_PAD src0_sel:DWORD src1_sel:WORD_1
v_and_b32 v117, s47, v117
v_exp_f16_sdwa v125, v125 dst_sel:WORD_1 dst_unused:UNUSED_PRESERVE src0_sel:WORD_1
s_waitcnt lgkmcnt(7)
v_lshl_add_u64 v[106:107], v[136:137], 0, v[138:139]
v_cvt_pkrtz_f16_f32 v120, v120, v121
v_cvt_pkrtz_f16_f32 v121, v122, v123
v_lshrrev_b64 v[120:121], 2, v[120:121]
v_and_b32_sdwa v122, s47, v120 dst_sel:DWORD dst_unused:UNUSED_PAD src0_sel:DWORD src1_sel:WORD_1
ds_read_u16 v119, v119
ds_read_u16 v117, v117
v_and_b32_e64 v120, s47, v120
v_mfma_f32_32x32x16_bf16 v[144:159], v[188:191], v[84:87], v[144:159]
ds_read_u16 v122, v122
ds_read_u16 v120, v120
ds_read_b128 v[188:191], v250 offset:7168
s_waitcnt vmcnt(0)
v_exp_f16_sdwa v127, v127 dst_sel:WORD_1 dst_unused:UNUSED_PRESERVE src0_sel:WORD_1
v_and_b32_sdwa v123, s47, v121 dst_sel:DWORD dst_unused:UNUSED_PAD src0_sel:DWORD src1_sel:WORD_1
v_mfma_f32_32x32x16_f16 v[128:143], v[104:107], v[216:219], 0
v_and_b32 v121, s47, v121
v_pk_add_f16 v125, v125, 1.0 op_sel_hi:[1,0]
v_pk_add_f16 v127, v127, 1.0 op_sel_hi:[1,0]
v_rcp_f16_sdwa v125, v125 dst_sel:WORD_0 dst_unused:UNUSED_PRESERVE src0_sel:WORD_0
v_mfma_f32_32x32x16_f16 v[128:143], v[108:111], v[220:223], v[128:143]
ds_read_u16 v123, v123
ds_read_u16 v121, v121
v_permlane16_swap_b32 v104, v108
v_permlane16_swap_b32 v105, v109
v_permlane16_swap_b32 v106, v110
v_permlane16_swap_b32 v107, v111
v_mfma_f32_32x32x16_bf16 v[144:159], v[176:179], v[88:91], v[144:159]
ds_read_b128 v[176:179], v250 offset:8192
v_rcp_f16_sdwa v127, v127 dst_sel:WORD_0 dst_unused:UNUSED_PRESERVE src0_sel:WORD_0
v_rcp_f16_sdwa v125, v125 dst_sel:WORD_1 dst_unused:UNUSED_PRESERVE src0_sel:WORD_1
v_rcp_f16_sdwa v127, v127 dst_sel:WORD_1 dst_unused:UNUSED_PRESERVE src0_sel:WORD_1
s_waitcnt lgkmcnt(8)
v_mfma_f32_32x32x16_bf16 v[144:159], v[180:183], v[92:95], v[144:159]
ds_read_b128 v[180:183], v250 offset:9216
v_fmac_f32 v235, v128, v128
v_pk_mul_f16 v124, v124, v125
v_fmac_f32_e64 v235, v129, v129
v_pk_mul_f16 v126, v126, v127
v_fmac_f32 v235, v130, v130
v_fmac_f32 v235, v131, v131
v_fmac_f32 v235, v132, v132
v_fmac_f32 v235, v133, v133
v_mfma_f32_32x32x16_bf16 v[160:175], v[184:187], v[72:75], 0
ds_read_b128 v[184:187], v250 offset:10240
v_permlane16_swap_b32 v48, v52
v_permlane16_swap_b32 v49, v53
v_permlane16_swap_b32 v50, v54
v_permlane16_swap_b32 v51, v55
v_permlane16_swap_b32 v56, v60
v_permlane16_swap_b32 v57, v61
v_permlane16_swap_b32 v58, v62
v_permlane16_swap_b32 v59, v63
v_permlane16_swap_b32 v64, v68
v_permlane16_swap_b32 v65, v69
v_permlane16_swap_b32 v66, v70
v_permlane16_swap_b32 v67, v71
v_permlane16_swap_b32 v24, v28
v_permlane16_swap_b32 v25, v29
v_permlane16_swap_b32 v26, v30
v_permlane16_swap_b32 v27, v31
v_permlane16_swap_b32 v32, v36
v_permlane16_swap_b32 v33, v37
v_permlane16_swap_b32 v34, v38
v_permlane16_swap_b32 v35, v39
v_permlane16_swap_b32 v40, v44
v_permlane16_swap_b32 v41, v45
v_permlane16_swap_b32 v42, v46
v_permlane16_swap_b32 v43, v47
v_fmac_f32 v235, v134, v134
v_fmac_f32 v235, v135, v135
v_fmac_f32 v235, v136, v136
v_fmac_f32 v235, v137, v137
v_fmac_f32_e64 v235, v138, v138
v_cvt_pkrtz_f16_f32 v144, v144, v145
v_cvt_pkrtz_f16_f32 v145, v146, v147
v_lshrrev_b64 v[144:145], 2, v[144:145]
v_and_b32_sdwa v146, s47, v144 dst_sel:DWORD dst_unused:UNUSED_PAD src0_sel:DWORD src1_sel:WORD_1
v_and_b32_e64 v144, s47, v144
v_cvt_pk_f16_f32 v156, v156, v157
v_fmac_f32_e64 v235, v139, v139
v_cvt_pk_f16_f32 v158, v158, v159
v_fmac_f32_e64 v235, v140, v140
v_fmac_f32 v235, v141, v141
s_waitcnt lgkmcnt(0)
v_mfma_f32_32x32x16_bf16 v[160:175], v[188:191], v[76:79], v[160:175]
ds_read_u16_d16_hi v146, v146
ds_read_u16 v144, v144
ds_read_b128 v[188:191], v250 offset:11264
v_pk_fma_f16 v157, v156, v156, s48
v_fmac_f32_e64 v235, v142, v142
v_and_b32_sdwa v147, s47, v145 dst_sel:DWORD dst_unused:UNUSED_PAD src0_sel:DWORD src1_sel:WORD_1
v_and_b32 v145, s47, v145
v_fmac_f32 v235, v143, v143
v_fma_mix_f32 v235, v124, v124, v235 op_sel_hi:[1,1,0]
v_pk_fma_f16 v159, v158, v158, s48
v_fma_mix_f32 v235, v126, v126, v235 op_sel_hi:[1,1,0]
v_pk_mul_f16 v157, v156, v157
v_fma_mix_f32 v235, v124, v124, v235 op_sel:[1,1,0] op_sel_hi:[1,1,0]
ds_read_u16_d16_hi v147, v147
ds_read_u16 v145, v145
v_fma_mix_f32 v235, v126, v126, v235 op_sel:[1,1,0] op_sel_hi:[1,1,0]
v_cvt_pkrtz_f16_f32 v148, v148, v149
v_fma_mix_f32 v235, v112, v112, v235 op_sel_hi:[1,1,0]
v_cvt_pkrtz_f16_f32 v149, v150, v151
v_fma_mix_f32 v235, v113, v113, v235 op_sel_hi:[1,1,0]
v_lshrrev_b64 v[148:149], 2, v[148:149]
v_fma_mix_f32 v235, v114, v114, v235 op_sel_hi:[1,1,0]
v_and_b32_sdwa v150, s47, v148 dst_sel:DWORD dst_unused:UNUSED_PAD src0_sel:DWORD src1_sel:WORD_1
v_fma_mix_f32 v235, v115, v115, v235 op_sel_hi:[1,1,0]
v_and_b32_e64 v148, s47, v148
v_fma_mix_f32 v235, v116, v116, v235 op_sel_hi:[1,1,0]
v_pk_mul_f16 v159, v158, v159
v_fma_mix_f32 v235, v117, v117, v235 op_sel_hi:[1,1,0]
v_exp_f16_sdwa v157, v157 dst_sel:WORD_0 dst_unused:UNUSED_PRESERVE src0_sel:WORD_0
v_fma_mix_f32 v235, v118, v118, v235 op_sel_hi:[1,1,0]
v_mfma_f32_32x32x16_bf16 v[160:175], v[176:179], v[80:83], v[160:175]
v_fma_mix_f32 v235, v119, v119, v235 op_sel_hi:[1,1,0]
v_and_b32_sdwa v151, s47, v149 dst_sel:DWORD dst_unused:UNUSED_PAD src0_sel:DWORD src1_sel:WORD_1
v_fma_mix_f32 v235, v120, v120, v235 op_sel_hi:[1,1,0]
v_and_b32_e64 v149, s47, v149
v_fma_mix_f32 v235, v121, v121, v235 op_sel_hi:[1,1,0]
v_exp_f16_sdwa v159, v159 dst_sel:WORD_0 dst_unused:UNUSED_PRESERVE src0_sel:WORD_0
v_fma_mix_f32 v235, v122, v122, v235 op_sel_hi:[1,1,0]
ds_read_u16_d16_hi v150, v150
ds_read_u16 v148, v148
ds_read_u16_d16_hi v151, v151
ds_read_u16 v149, v149
v_fma_mix_f32 v235, v123, v123, v235 op_sel_hi:[1,1,0]
v_cvt_pkrtz_f16_f32 v152, v152, v153
s_nop 0
v_permlane32_swap_b32 v234, v235
v_add_f32_e64 v234, v234, v235
v_cvt_pkrtz_f16_f32 v153, v154, v155
v_lshrrev_b64 v[152:153], 2, v[152:153]
v_and_b32_sdwa v154, s47, v152 dst_sel:DWORD dst_unused:UNUSED_PAD src0_sel:DWORD src1_sel:WORD_1
v_and_b32_e64 v152, s47, v152
v_exp_f16_sdwa v157, v157 dst_sel:WORD_1 dst_unused:UNUSED_PRESERVE src0_sel:WORD_1
v_mfma_f32_32x32x16_bf16 v[160:175], v[180:183], v[84:87], v[160:175]
ds_write_b32 v248, v234 offset:8704
s_setprio 3
v_mov_b32_e64 v238, 1
s_waitcnt lgkmcnt(0)
s_nop 9
s_mov_b64 exec, 1
ds_add_rtn_u32 v239, v247, v238 offset:0
s_mov_b64 exec, -1
s_waitcnt lgkmcnt(0)
v_readfirstlane_b32 s43, v239
s_nop 1
s_cmp_lg_u32 s43, 7
s_cbranch_scc1 Lnopub
ds_read_b128 v[128:131], v244
ds_read_b128 v[132:135], v244 offset:16
ds_read_b128 v[136:139], v244 offset:9216
ds_read_b128 v[140:143], v244 offset:9232
ds_read_b128 v[112:115], v244 offset:18432
ds_read_b128 v[116:119], v244 offset:18448
ds_read_b128 v[120:123], v244 offset:27648
ds_read_b128 v[124:127], v244 offset:27664
ds_read_b128 v[216:219], v244 offset:36864
ds_read_b128 v[220:223], v244 offset:36880
s_waitcnt lgkmcnt(7)
v_add_f32 v128, v128, v136
v_add_f32 v129, v129, v137
v_add_f32 v130, v130, v138
v_add_f32 v131, v131, v139
s_waitcnt lgkmcnt(6)
v_add_f32 v132, v132, v140
v_add_f32 v133, v133, v141
v_add_f32 v134, v134, v142
v_add_f32 v135, v135, v143
ds_read_b128 v[136:139], v244 offset:46080
ds_read_b128 v[140:143], v244 offset:46096
s_waitcnt lgkmcnt(7)
v_add_f32 v128, v128, v112
v_add_f32 v129, v129, v113
v_add_f32 v130, v130, v114
v_add_f32 v131, v131, v115
s_waitcnt lgkmcnt(6)
v_add_f32 v132, v132, v116
v_add_f32 v133, v133, v117
v_add_f32 v134, v134, v118
v_add_f32 v135, v135, v119
ds_read_b128 v[112:115], v244 offset:55296
ds_read_b128 v[116:119], v244 offset:55312
s_waitcnt lgkmcnt(7)
v_add_f32 v128, v128, v120
v_add_f32 v129, v129, v121
v_add_f32 v130, v130, v122
v_add_f32 v131, v131, v123
s_waitcnt lgkmcnt(6)
v_add_f32 v132, v132, v124
v_add_f32 v133, v133, v125
v_add_f32 v134, v134, v126
v_add_f32 v135, v135, v127
ds_read_b128 v[120:123], v244 offset:64512
ds_read_b128 v[124:127], v244 offset:64528
s_waitcnt lgkmcnt(7)
v_add_f32 v128, v128, v216
v_add_f32 v129, v129, v217
v_add_f32 v130, v130, v218
v_add_f32 v131, v131, v219
s_waitcnt lgkmcnt(6)
v_add_f32 v132, v132, v220
v_add_f32 v133, v133, v221
v_add_f32 v134, v134, v222
v_add_f32 v135, v135, v223
s_waitcnt lgkmcnt(5)
v_add_f32 v128, v128, v136
v_add_f32 v129, v129, v137
v_add_f32 v130, v130, v138
v_add_f32 v131, v131, v139
s_waitcnt lgkmcnt(4)
v_add_f32 v132, v132, v140
v_add_f32 v133, v133, v141
v_add_f32 v134, v134, v142
v_add_f32 v135, v135, v143
s_waitcnt lgkmcnt(3)
v_add_f32 v128, v128, v112
v_add_f32 v129, v129, v113
v_add_f32 v130, v130, v114
v_add_f32 v131, v131, v115
s_waitcnt lgkmcnt(2)
v_add_f32 v132, v132, v116
v_add_f32 v133, v133, v117
v_add_f32 v134, v134, v118
v_add_f32 v135, v135, v119
s_waitcnt lgkmcnt(1)
v_add_f32 v128, v128, v120
v_add_f32 v129, v129, v121
v_add_f32 v130, v130, v122
v_add_f32 v131, v131, v123
s_waitcnt lgkmcnt(0)
v_add_f32 v132, v132, v124
v_add_f32 v133, v133, v125
v_add_f32 v134, v134, v126
v_add_f32 v135, v135, v127
v_min_u32 v216, -2, v128
v_min_u32 v217, -2, v129
v_min_u32 v218, -2, v130
v_min_u32 v219, -2, v131
v_min_u32 v220, -2, v132
v_min_u32 v221, -2, v133
v_min_u32_e64 v222, -2, v134
v_min_u32 v223, -2, v135
s_lshl_b32 s43, s2, 4
buffer_store_dwordx4 v[216:219], v237, s[32:35], s43 offen sc1
buffer_store_dwordx4 v[220:223], v245, s[32:35], s43 offen sc1
ds_write_b32 v247, v238 offset:4
s_waitcnt lgkmcnt(0)
s_nop 1
Lnopub:
s_mov_b32 s77, 0
v_bfe_u32 v244, v250, 8, 2
v_lshlrev_b32 v244, 3, v244
s_cmp_lg_u32 s40, 0
s_cbranch_scc1 Lnorole
v_subrev_u32 v245, 16384, v250
v_lshrrev_b32_e64 v240, 1, v245
v_add_u32 v240, v240, v245
s_cmp_lt_u32 s2, 96
s_cselect_b32 s77, 1, 2
s_cbranch_scc1 Lred
s_and_b32 s44, s2, 7
s_lshl_b32 s44, s44, 11
s_add_u32 s44, s44, 393216
s_waitcnt lgkmcnt(0)
buffer_load_dwordx2 v[128:129], v240, s[32:35], s44 offen sc1
buffer_load_dwordx2 v[130:131], v240, s[32:35], s44 offen offset:8 sc1
buffer_load_dwordx2 v[132:133], v240, s[32:35], s44 offen offset:16 sc1
v_lshrrev_b32_e64 v241, 1, v240
buffer_load_dword v135, v241, s[24:27], 0 offen
buffer_load_dword v137, v241, s[24:27], 0 offen offset:4
buffer_load_dword v139, v241, s[24:27], 0 offen offset:8
s_branch Lnorole
Lred:
s_lshl_b32 s44, s2, 12
s_waitcnt vmcnt(4)
buffer_load_dwordx4 v[128:131], v245, s[32:35], s44 offen sc1
s_waitcnt vmcnt(3)
buffer_load_dwordx4 v[132:135], v245, s[32:35], s44 offen offset:1024 sc1
s_waitcnt vmcnt(2)
buffer_load_dwordx4 v[136:139], v245, s[32:35], s44 offen offset:2048 sc1
buffer_load_dwordx4 v[140:143], v245, s[32:35], s44 offen offset:3072 sc1
Lnorole:
s_setprio 0
ds_read_u16_d16_hi v154, v154
ds_read_u16 v152, v152
v_and_b32_sdwa v155, s47, v153 dst_sel:DWORD dst_unused:UNUSED_PAD src0_sel:DWORD src1_sel:WORD_1
v_and_b32_e64 v153, s47, v153
v_exp_f16_sdwa v159, v159 dst_sel:WORD_1 dst_unused:UNUSED_PRESERVE src0_sel:WORD_1
v_pk_add_f16 v157, v157, 1.0 op_sel_hi:[1,0]
v_mfma_f32_32x32x16_bf16 v[160:175], v[184:187], v[88:91], v[160:175]
ds_read_u16_d16_hi v155, v155
ds_read_u16 v153, v153
v_pk_add_f16 v159, v159, 1.0 op_sel_hi:[1,0]
v_rcp_f16_sdwa v157, v157 dst_sel:WORD_0 dst_unused:UNUSED_PRESERVE src0_sel:WORD_0
v_rcp_f16_sdwa v159, v159 dst_sel:WORD_0 dst_unused:UNUSED_PRESERVE src0_sel:WORD_0
v_mfma_f32_32x32x16_bf16 v[160:175], v[188:191], v[92:95], v[160:175]
ds_read_b128 v[176:179], v250 offset:55296
ds_read_b128 v[180:183], v250 offset:56320
ds_read_b128 v[184:187], v250 offset:57344
v_rcp_f16_sdwa v157, v157 dst_sel:WORD_1 dst_unused:UNUSED_PRESERVE src0_sel:WORD_1
v_rcp_f16_sdwa v159, v159 dst_sel:WORD_1 dst_unused:UNUSED_PRESERVE src0_sel:WORD_1
s_waitcnt lgkmcnt(7)
v_pk_mul_f16 v118, v156, v157
v_pk_mul_f16 v119, v158, v159
v_lshl_add_u64 v[112:113], v[144:145], 0, v[146:147]
v_lshl_add_u64 v[116:117], v[148:149], 0, v[150:151]
ds_read_b128 v[188:191], v250 offset:58368
s_nop 0
v_permlane16_swap_b32 v112, v116
v_cvt_pkrtz_f16_f32 v160, v160, v161
v_cvt_pkrtz_f16_f32 v161, v162, v163
v_lshrrev_b64 v[160:161], 2, v[160:161]
v_and_b32_sdwa v162, s47, v160 dst_sel:DWORD dst_unused:UNUSED_PAD src0_sel:DWORD src1_sel:WORD_1
v_and_b32 v160, s47, v160
v_cvt_pk_f16_f32 v172, v172, v173
v_cvt_pk_f16_f32 v174, v174, v175
v_pk_fma_f16 v173, v172, v172, s48
v_and_b32_sdwa v163, s47, v161 dst_sel:DWORD dst_unused:UNUSED_PAD src0_sel:DWORD src1_sel:WORD_1
v_and_b32_e64 v161, s47, v161
v_pk_fma_f16 v175, v174, v174, s48
ds_read_u16_d16_hi v162, v162
ds_read_u16 v160, v160
ds_read_u16_d16_hi v163, v163
ds_read_u16 v161, v161
v_pk_mul_f16 v173, v172, v173
s_cmp_eq_u32 s77, 0
s_cbranch_scc1 Lpp1
s_call_b64 s[78:79], Lpolln
Lpp1:
v_cvt_pkrtz_f16_f32 v164, v164, v165
v_cvt_pkrtz_f16_f32 v165, v166, v167
v_lshrrev_b64 v[164:165], 2, v[164:165]
v_and_b32_sdwa v166, s47, v164 dst_sel:DWORD dst_unused:UNUSED_PAD src0_sel:DWORD src1_sel:WORD_1
v_and_b32 v164, s47, v164
v_pk_mul_f16 v175, v174, v175
v_exp_f16_sdwa v173, v173 dst_sel:WORD_0 dst_unused:UNUSED_PRESERVE src0_sel:WORD_0
v_and_b32_sdwa v167, s47, v165 dst_sel:DWORD dst_unused:UNUSED_PAD src0_sel:DWORD src1_sel:WORD_1
v_and_b32 v165, s47, v165
v_exp_f16_sdwa v175, v175 dst_sel:WORD_0 dst_unused:UNUSED_PRESERVE src0_sel:WORD_0
s_waitcnt lgkmcnt(6)
v_lshl_add_u64 v[114:115], v[152:153], 0, v[154:155]
ds_read_u16_d16_hi v166, v166
ds_read_u16 v164, v164
ds_read_u16_d16_hi v167, v167
ds_read_u16 v165, v165
v_cvt_pkrtz_f16_f32 v168, v168, v169
v_cvt_pkrtz_f16_f32 v169, v170, v171
v_lshrrev_b64 v[168:169], 2, v[168:169]
v_and_b32_sdwa v170, s47, v168 dst_sel:DWORD dst_unused:UNUSED_PAD src0_sel:DWORD src1_sel:WORD_1
v_and_b32_e64 v168, s47, v168
v_exp_f16_sdwa v173, v173 dst_sel:WORD_1 dst_unused:UNUSED_PRESERVE src0_sel:WORD_1
v_mfma_f32_32x32x16_bf16 v[144:159], v[176:179], v[72:75], 0
ds_read_u16_d16_hi v170, v170
ds_read_u16 v168, v168
ds_read_b128 v[176:179], v250 offset:59392
v_permlane16_swap_b32 v113, v117
v_permlane16_swap_b32 v114, v118
v_permlane16_swap_b32 v115, v119
s_cmp_eq_u32 s77, 0
s_cbranch_scc1 Lpp2
s_call_b64 s[78:79], Lpolln
Lpp2:
v_and_b32_sdwa v171, s47, v169 dst_sel:DWORD dst_unused:UNUSED_PAD src0_sel:DWORD src1_sel:WORD_1
v_and_b32_e64 v169, s47, v169
v_exp_f16_sdwa v175, v175 dst_sel:WORD_1 dst_unused:UNUSED_PRESERVE src0_sel:WORD_1
v_mfma_f32_32x32x16_bf16 v[144:159], v[180:183], v[76:79], v[144:159]
ds_read_u16_d16_hi v171, v171
ds_read_u16 v169, v169
s_waitcnt lgkmcnt(10)
ds_read_b128 v[180:183], v250 offset:60416
v_pk_add_f16 v173, v173, 1.0 op_sel_hi:[1,0]
v_pk_add_f16 v175, v175, 1.0 op_sel_hi:[1,0]
v_rcp_f16_sdwa v173, v173 dst_sel:WORD_0 dst_unused:UNUSED_PRESERVE src0_sel:WORD_0
v_mfma_f32_32x32x16_bf16 v[144:159], v[184:187], v[80:83], v[144:159]
v_rcp_f16_sdwa v175, v175 dst_sel:WORD_0 dst_unused:UNUSED_PRESERVE src0_sel:WORD_0
v_rcp_f16_sdwa v173, v173 dst_sel:WORD_1 dst_unused:UNUSED_PRESERVE src0_sel:WORD_1
v_rcp_f16_sdwa v175, v175 dst_sel:WORD_1 dst_unused:UNUSED_PRESERVE src0_sel:WORD_1
v_mfma_f32_32x32x16_bf16 v[144:159], v[188:191], v[84:87], v[144:159]
v_pk_mul_f16 v222, v172, v173
v_pk_mul_f16 v223, v174, v175
s_waitcnt lgkmcnt(8)
v_lshl_add_u64 v[216:217], v[160:161], 0, v[162:163]
s_waitcnt lgkmcnt(6)
v_lshl_add_u64 v[220:221], v[164:165], 0, v[166:167]
s_waitcnt lgkmcnt(3)
v_mfma_f32_32x32x16_bf16 v[144:159], v[176:179], v[88:91], v[144:159]
s_cmp_eq_u32 s77, 0
s_cbranch_scc1 Lpp3
s_call_b64 s[78:79], Lpolln
Lpp3:
s_waitcnt lgkmcnt(0)
v_mfma_f32_32x32x16_bf16 v[144:159], v[180:183], v[92:95], v[144:159]
s_mul_i32 s43, s40, 96
buffer_load_dwordx2 v[176:177], v244, s[28:31], s43 offen
buffer_load_dwordx2 v[178:179], v244, s[28:31], s43 offen offset:32
buffer_load_dwordx2 v[180:181], v244, s[28:31], s43 offen offset:64
v_mov_b32 v249, 0
s_branch Law6
Lax6:
s_sleep 2
Law6:
ds_read_b32 v249, v247 offset:4
s_sub_u32 s76, s76, 1
s_cselect_b32 s44, 1, 0
s_cselect_b32 s76, 0, s76
s_waitcnt lgkmcnt(0)
v_readfirstlane_b32 s43, v249
s_nop 1
s_max_u32 s43, s43, s44
s_cmp_lt_u32 s43, 1
s_cbranch_scc1 Lax6
s_add_u32 m0, s72, 5120
s_add_u32 s43, s82, 3200
buffer_load_dwordx4 v246, s[16:19], s43 offen lds
s_mov_b32 s3, 0
s_add_u32 m0, s72, 8192
s_add_u32 s43, s82, 6272
buffer_load_dwordx4 v246, s[16:19], s43 offen lds
s_mov_b32 s3, 0
v_lshl_add_u64 v[218:219], v[168:169], 0, v[170:171]
v_cvt_pkrtz_f16_f32 v144, v144, v145
v_cvt_pkrtz_f16_f32 v145, v146, v147
v_lshrrev_b64 v[144:145], 2, v[144:145]
v_and_b32_sdwa v146, s47, v144 dst_sel:DWORD dst_unused:UNUSED_PAD src0_sel:DWORD src1_sel:WORD_1
v_and_b32_e64 v144, s47, v144
v_cvt_pk_f16_f32 v156, v156, v157
v_cvt_pk_f16_f32 v158, v158, v159
v_pk_fma_f16 v157, v156, v156, s48
v_and_b32_sdwa v147, s47, v145 dst_sel:DWORD dst_unused:UNUSED_PAD src0_sel:DWORD src1_sel:WORD_1
v_and_b32 v145, s47, v145
v_pk_fma_f16 v159, v158, v158, s48
ds_read_u16_d16_hi v146, v146
ds_read_u16 v144, v144
s_cmp_eq_u32 s77, 0
s_cbranch_scc1 Lpp4
s_call_b64 s[78:79], Lpolln
Lpp4:
ds_read_u16_d16_hi v147, v147
ds_read_u16 v145, v145
v_pk_mul_f16 v157, v156, v157
v_cvt_pkrtz_f16_f32 v148, v148, v149
v_cvt_pkrtz_f16_f32 v149, v150, v151
v_lshrrev_b64 v[148:149], 2, v[148:149]
v_and_b32_sdwa v150, s47, v148 dst_sel:DWORD dst_unused:UNUSED_PAD src0_sel:DWORD src1_sel:WORD_1
v_and_b32_e64 v148, s47, v148
v_pk_mul_f16 v159, v158, v159
v_exp_f16_sdwa v157, v157 dst_sel:WORD_0 dst_unused:UNUSED_PRESERVE src0_sel:WORD_0
v_and_b32_sdwa v151, s47, v149 dst_sel:DWORD dst_unused:UNUSED_PAD src0_sel:DWORD src1_sel:WORD_1
v_and_b32_e64 v149, s47, v149
v_exp_f16_sdwa v159, v159 dst_sel:WORD_0 dst_unused:UNUSED_PRESERVE src0_sel:WORD_0
v_cvt_pkrtz_f16_f32 v152, v152, v153
ds_read_u16_d16_hi v150, v150
ds_read_u16 v148, v148
ds_read_u16_d16_hi v151, v151
ds_read_u16 v149, v149
s_cmp_eq_u32 s77, 0
s_cbranch_scc1 Lpp5
s_call_b64 s[78:79], Lpolln
Lpp5:
s_setprio 3
v_cvt_pkrtz_f16_f32 v153, v154, v155
v_lshrrev_b64 v[152:153], 2, v[152:153]
v_and_b32_sdwa v154, s47, v152 dst_sel:DWORD dst_unused:UNUSED_PAD src0_sel:DWORD src1_sel:WORD_1
v_and_b32_e64 v152, s47, v152
v_exp_f16_sdwa v157, v157 dst_sel:WORD_1 dst_unused:UNUSED_PRESERVE src0_sel:WORD_1
v_permlane16_swap_b32 v216, v220
v_permlane16_swap_b32 v217, v221
v_permlane16_swap_b32 v218, v222
v_permlane16_swap_b32 v219, v223
v_and_b32_sdwa v155, s47, v153 dst_sel:DWORD dst_unused:UNUSED_PAD src0_sel:DWORD src1_sel:WORD_1
ds_read_u16_d16_hi v154, v154
ds_read_u16 v152, v152
v_and_b32_e64 v153, s47, v153
v_exp_f16_sdwa v159, v159 dst_sel:WORD_1 dst_unused:UNUSED_PRESERVE src0_sel:WORD_1
v_pk_add_f16 v157, v157, 1.0 op_sel_hi:[1,0]
v_pk_add_f16 v159, v159, 1.0 op_sel_hi:[1,0]
v_rcp_f16_sdwa v157, v157 dst_sel:WORD_0 dst_unused:UNUSED_PRESERVE src0_sel:WORD_0
v_rcp_f16_sdwa v159, v159 dst_sel:WORD_0 dst_unused:UNUSED_PRESERVE src0_sel:WORD_0
v_rcp_f16_sdwa v157, v157 dst_sel:WORD_1 dst_unused:UNUSED_PRESERVE src0_sel:WORD_1
ds_read_u16_d16_hi v155, v155
ds_read_u16 v153, v153
v_bfe_u32 v190, v250, 4, 6
v_lshl_add_u32 v186, v190, 4, s72
s_mul_i32 s43, s40, 3
s_add_u32 s43, s43, 0
s_and_b32 s44, s43, 1
s_mul_i32 s44, s44, 3064
s_mul_i32 s43, s43, 3072
s_sub_u32 s43, s43, s44
s_add_u32 s43, s43, 90112
v_lshl_add_u32 v173, v190, 4, s43
s_mul_i32 s43, s40, 3
s_add_u32 s43, s43, 1
s_and_b32 s44, s43, 1
s_mul_i32 s44, s44, 3064
s_mul_i32 s43, s43, 3072
s_sub_u32 s43, s43, s44
s_add_u32 s43, s43, 90112
v_lshl_add_u32 v174, v190, 4, s43
s_mul_i32 s43, s40, 3
s_add_u32 s43, s43, 2
s_and_b32 s44, s43, 1
s_mul_i32 s44, s44, 3064
s_mul_i32 s43, s43, 3072
s_sub_u32 s43, s43, s44
s_add_u32 s43, s43, 90112
v_lshl_add_u32 v175, v190, 4, s43
v_lshl_add_u32 v187, v244, 2, s72
v_and_b32_e64 v189, 3, v190
v_bfe_u32 v191, v190, 2, 1
v_lshl_add_u32 v189, v191, 3, v189
v_bfe_u32 v191, v190, 3, 1
v_lshl_add_u32 v189, v191, 2, v189
v_bfe_u32 v191, v190, 4, 1
v_lshl_add_u32 v189, v191, 6, v189
v_bfe_u32 v191, v190, 5, 1
v_lshl_add_u32 v189, v191, 5, v189
v_lshlrev_b32_e64 v189, 4, v189
v_add_u32 v248, 16384, v189
v_add_u32 v249, 53248, v189
v_min_u32 v189, 11, v190
s_mul_i32 s43, s40, 12
v_add_u32 v189, s43, v189
v_cmp_gt_u32 vcc, 64, v189
v_lshlrev_b32_e64 v189, 2, v189
v_add_u32 v172, 93312, v189
v_add_u32 v191, 16128, v189
v_add_u32 v189, 7680, v189
v_cndmask_b32 v189, v189, v191, vcc
v_add_u32 v188, s72, v244
v_lshrrev_b32 v191, 3, v190
v_mul_u32_u24 v191, 9120, v191
v_mul_u32_u24 v190, 12, v190
v_add_u32 v191, v191, v190
v_add_u32 v191, 93184, v191
ds_read_b64_tr_b16 v[72:73], v186
ds_read_b64_tr_b16 v[74:75], v186 offset:8
ds_read_b64_tr_b16 v[84:85], v186 offset:3072
s_waitcnt lgkmcnt(6)
ds_read_b64_tr_b16 v[86:87], v186 offset:3080
ds_read_b64_tr_b16 v[160:161], v186 offset:6144
ds_read_b64_tr_b16 v[162:163], v186 offset:6152
s_cmp_eq_u32 s77, 0
s_cbranch_scc1 Lpp6
s_call_b64 s[78:79], Lpolln
Lpp6:
s_cmp_eq_u32 s3, 1
s_cbranch_scc1 Lvw0
s_waitcnt vmcnt(2)
Lvw0:
ds_read_b64_tr_b16 v[76:77], v186 offset:1024
ds_read_b64_tr_b16 v[78:79], v186 offset:1032
ds_read_b64_tr_b16 v[88:89], v186 offset:4096
ds_read_b64_tr_b16 v[90:91], v186 offset:4104
ds_read_b64_tr_b16 v[164:165], v186 offset:7168
ds_read_b64_tr_b16 v[166:167], v186 offset:7176
v_rcp_f16_sdwa v159, v159 dst_sel:WORD_1 dst_unused:UNUSED_PRESERVE src0_sel:WORD_1
v_pk_mul_f16 v238, v156, v157
v_pk_mul_f16 v239, v158, v159
v_lshl_add_u64 v[232:233], v[144:145], 0, v[146:147]
v_lshl_add_u64 v[236:237], v[148:149], 0, v[150:151]
s_waitcnt lgkmcnt(12)
ds_read_b64_tr_b16 v[80:81], v186 offset:2048
ds_read_b64_tr_b16 v[82:83], v186 offset:2056
s_waitcnt lgkmcnt(13)
v_mfma_f32_16x16x16_bf16 v[120:123], v[72:73], v[176:177], 0
v_lshlrev_b32 v182, 16, v72
v_and_b32 v183, 4294901760, v72
s_waitcnt lgkmcnt(12)
v_mfma_f32_16x16x16_bf16 v[124:127], v[74:75], v[176:177], 0
v_cvt_pk_f16_f32 v72, v182, v183
v_lshlrev_b32 v184, 16, v73
s_waitcnt lgkmcnt(11)
v_mfma_f32_16x16x16_bf16 v[120:123], v[84:85], v[178:179], v[120:123]
v_and_b32 v185, 4294901760, v73
v_cvt_pk_f16_f32 v73, v184, v185
s_waitcnt lgkmcnt(10)
v_mfma_f32_16x16x16_bf16 v[124:127], v[86:87], v[178:179], v[124:127]
v_lshlrev_b32 v182, 16, v74
v_and_b32 v183, 4294901760, v74
s_waitcnt lgkmcnt(8)
v_mfma_f32_16x16x16_bf16 v[120:123], v[160:161], v[180:181], v[120:123]
v_cvt_pk_f16_f32 v74, v182, v183
v_lshlrev_b32 v184, 16, v75
v_mfma_f32_16x16x16_bf16 v[124:127], v[162:163], v[180:181], v[124:127]
s_setprio 2
s_cmp_eq_u32 s77, 0
s_cbranch_scc1 Lpp7
s_call_b64 s[78:79], Lpolln
Lpp7:
v_and_b32 v185, 4294901760, v75
v_cvt_pk_f16_f32 v75, v184, v185
v_lshlrev_b32_e64 v182, 16, v84
v_and_b32 v183, 4294901760, v84
v_lshlrev_b32 v184, 16, v85
v_and_b32 v185, 4294901760, v85
v_lshl_add_u64 v[234:235], v[152:153], 0, v[154:155]
v_permlane16_swap_b32 v232, v236
s_mov_b32 exec_lo, 65537
s_mov_b32 exec_hi, 65537
ds_write_b128 v187, v[120:123] offset:3200
ds_write_b128 v187, v[124:127] offset:3216
s_mov_b64 exec, -1
v_cvt_pk_f16_f32 v84, v182, v183
v_cvt_pk_f16_f32 v85, v184, v185
v_lshlrev_b32 v182, 16, v86
v_and_b32 v183, 4294901760, v86
v_cvt_pk_f16_f32 v86, v182, v183
v_lshlrev_b32_e64 v184, 16, v87
v_and_b32 v185, 4294901760, v87
v_cvt_pk_f16_f32 v87, v184, v185
v_lshlrev_b32_e64 v182, 16, v160
v_and_b32 v183, 4294901760, v160
v_cvt_pk_f16_f32 v160, v182, v183
v_lshlrev_b32_e64 v184, 16, v161
v_and_b32 v185, 4294901760, v161
v_cvt_pk_f16_f32 v161, v184, v185
v_lshlrev_b32_e64 v182, 16, v162
v_and_b32 v183, 4294901760, v162
v_cvt_pk_f16_f32 v162, v182, v183
s_cmp_eq_u32 s77, 0
s_cbranch_scc1 Lpp8
s_call_b64 s[78:79], Lpolln
Lpp8:
v_lshlrev_b32 v184, 16, v163
v_and_b32 v185, 4294901760, v163
v_cvt_pk_f16_f32 v163, v184, v185
s_waitcnt lgkmcnt(9)
v_mfma_f32_16x16x16_bf16 v[120:123], v[76:77], v[176:177], 0
v_lshlrev_b32_e64 v182, 16, v76
v_and_b32 v183, 4294901760, v76
s_waitcnt lgkmcnt(8)
v_mfma_f32_16x16x16_bf16 v[124:127], v[78:79], v[176:177], 0
v_cvt_pk_f16_f32 v76, v182, v183
v_lshlrev_b32 v184, 16, v77
s_waitcnt lgkmcnt(7)
v_mfma_f32_16x16x16_bf16 v[120:123], v[88:89], v[178:179], v[120:123]
v_and_b32 v185, 4294901760, v77
v_cvt_pk_f16_f32 v77, v184, v185
s_waitcnt lgkmcnt(6)
v_mfma_f32_16x16x16_bf16 v[124:127], v[90:91], v[178:179], v[124:127]
v_lshlrev_b32_e64 v182, 16, v78
v_and_b32 v183, 4294901760, v78
s_waitcnt lgkmcnt(5)
v_mfma_f32_16x16x16_bf16 v[120:123], v[164:165], v[180:181], v[120:123]
v_cvt_pk_f16_f32 v78, v182, v183
v_permlane16_swap_b32 v233, v237
s_waitcnt lgkmcnt(4)
v_mfma_f32_16x16x16_bf16 v[124:127], v[166:167], v[180:181], v[124:127]
s_setprio 1
v_permlane16_swap_b32 v234, v238
v_permlane16_swap_b32 v235, v239
v_lshlrev_b32 v184, 16, v79
v_and_b32 v185, 4294901760, v79
v_cvt_pk_f16_f32 v79, v184, v185
v_lshlrev_b32 v182, 16, v88
v_and_b32 v183, 4294901760, v88
v_cvt_pk_f16_f32 v88, v182, v183
s_nop 0
s_mov_b32 exec_lo, 65537
s_mov_b32 exec_hi, 65537
ds_write_b128 v187, v[120:123] offset:3328
ds_write_b128 v187, v[124:127] offset:3344
s_mov_b64 exec, -1
v_lshlrev_b32 v184, 16, v89
v_and_b32 v185, 4294901760, v89
v_cvt_pk_f16_f32 v89, v184, v185
s_cmp_eq_u32 s77, 0
s_cbranch_scc1 Lpp9
s_call_b64 s[78:79], Lpolln
Lpp9:
v_lshlrev_b32_e64 v182, 16, v90
v_and_b32 v183, 4294901760, v90
v_cvt_pk_f16_f32 v90, v182, v183
s_cmp_eq_u32 s3, 1
s_cbranch_scc1 Lvw1
s_waitcnt vmcnt(0)
Lvw1:
ds_read_b64_tr_b16 v[92:93], v186 offset:5120
ds_read_b64_tr_b16 v[94:95], v186 offset:5128
ds_read_b64_tr_b16 v[168:169], v186 offset:8192
ds_read_b64_tr_b16 v[170:171], v186 offset:8200
v_lshlrev_b32_e64 v184, 16, v91
v_and_b32 v185, 4294901760, v91
v_cvt_pk_f16_f32 v91, v184, v185
v_lshlrev_b32_e64 v182, 16, v164
v_and_b32 v183, 4294901760, v164
v_cvt_pk_f16_f32 v164, v182, v183
v_lshlrev_b32_e64 v184, 16, v165
v_and_b32 v185, 4294901760, v165
v_cvt_pk_f16_f32 v165, v184, v185
v_lshlrev_b32_e64 v182, 16, v166
v_and_b32 v183, 4294901760, v166
v_cvt_pk_f16_f32 v166, v182, v183
v_lshlrev_b32 v184, 16, v167
v_and_b32 v185, 4294901760, v167
v_cvt_pk_f16_f32 v167, v184, v185
s_waitcnt lgkmcnt(9)
v_mfma_f32_16x16x16_bf16 v[120:123], v[80:81], v[176:177], 0
v_lshlrev_b32 v182, 16, v80
v_and_b32 v183, 4294901760, v80
s_waitcnt lgkmcnt(8)
v_mfma_f32_16x16x16_bf16 v[124:127], v[82:83], v[176:177], 0
v_cvt_pk_f16_f32 v80, v182, v183
v_lshlrev_b32 v184, 16, v81
s_waitcnt lgkmcnt(3)
v_mfma_f32_16x16x16_bf16 v[120:123], v[92:93], v[178:179], v[120:123]
v_and_b32 v185, 4294901760, v81
v_cvt_pk_f16_f32 v81, v184, v185
s_waitcnt lgkmcnt(1)
v_mfma_f32_16x16x16_bf16 v[124:127], v[94:95], v[178:179], v[124:127]
v_lshlrev_b32 v182, 16, v82
v_and_b32 v183, 4294901760, v82
v_mfma_f32_16x16x16_bf16 v[120:123], v[168:169], v[180:181], v[120:123]
v_cvt_pk_f16_f32 v82, v182, v183
v_lshlrev_b32 v184, 16, v83
s_waitcnt lgkmcnt(0)
v_mfma_f32_16x16x16_bf16 v[124:127], v[170:171], v[180:181], v[124:127]
s_cmp_eq_u32 s77, 0
s_cbranch_scc1 Lpp10
s_call_b64 s[78:79], Lpolln
Lpp10:
s_setprio 0
v_and_b32 v185, 4294901760, v83
v_cvt_pk_f16_f32 v83, v184, v185
v_lshlrev_b32_e64 v182, 16, v92
v_and_b32 v183, 4294901760, v92
v_cvt_pk_f16_f32 v92, v182, v183
v_lshlrev_b32_e64 v184, 16, v93
v_and_b32 v185, 4294901760, v93
v_cvt_pk_f16_f32 v93, v184, v185
s_mov_b32 exec_lo, 65537
s_mov_b32 exec_hi, 65537
ds_write_b128 v187, v[120:123] offset:3456
ds_write_b128 v187, v[124:127] offset:3472
s_mov_b64 exec, -1
ds_read_b128 v[120:123], v248
ds_read_b128 v[124:127], v248 offset:2048
v_lshlrev_b32 v182, 16, v94
v_and_b32 v183, 4294901760, v94
v_cvt_pk_f16_f32 v94, v182, v183
v_lshlrev_b32_e64 v184, 16, v95
v_and_b32 v185, 4294901760, v95
v_cvt_pk_f16_f32 v95, v184, v185
s_cmp_eq_u32 s77, 0
s_cbranch_scc1 Lpp11
s_call_b64 s[78:79], Lpolln
Lpp11:
v_lshlrev_b32 v182, 16, v168
v_and_b32 v183, 4294901760, v168
v_cvt_pk_f16_f32 v168, v182, v183
v_lshlrev_b32_e64 v184, 16, v169
v_and_b32 v185, 4294901760, v169
v_cvt_pk_f16_f32 v169, v184, v185
v_lshlrev_b32_e64 v182, 16, v170
v_and_b32 v183, 4294901760, v170
v_cvt_pk_f16_f32 v170, v182, v183
v_lshlrev_b32_e64 v184, 16, v171
v_and_b32 v185, 4294901760, v171
v_cvt_pk_f16_f32 v171, v184, v185
s_cmp_eq_u32 s77, 0
s_cbranch_scc1 Lpp12
s_call_b64 s[78:79], Lpolln
Lpp12:
s_waitcnt lgkmcnt(0)
s_barrier
s_setprio 2
ds_read_b32 v176, v172
ds_read_b32 v177, v172 offset:9216
ds_read_b32 v178, v172 offset:18432
ds_read_b32 v179, v172 offset:27648
ds_read_b32 v180, v172 offset:36864
ds_read_b32 v181, v172 offset:46080
ds_read_b32 v182, v172 offset:55296
ds_read_b32 v183, v172 offset:64512
v_mfma_f32_16x16x32_bf16 v[144:147], v[120:123], v[48:51], 0
s_cmp_eq_u32 s77, 0
s_cbranch_scc1 Lpp13
s_call_b64 s[78:79], Lpolln
Lpp13:
v_mfma_f32_16x16x32_bf16 v[148:151], v[120:123], v[52:55], 0
v_mfma_f32_16x16x32_bf16 v[152:155], v[120:123], v[24:27], 0
ds_read_b128 v[120:123], v248 offset:4096
v_mfma_f32_16x16x32_bf16 v[144:147], v[124:127], v[56:59], v[144:147]
s_waitcnt lgkmcnt(7)
v_add_f32_e64 v176, v176, v177
v_mfma_f32_16x16x32_bf16 v[148:151], v[124:127], v[60:63], v[148:151]
s_waitcnt lgkmcnt(6)
v_add_f32 v176, v176, v178
s_waitcnt lgkmcnt(5)
v_add_f32 v176, v176, v179
s_cmp_eq_u32 s77, 0
s_cbranch_scc1 Lpp14
s_call_b64 s[78:79], Lpolln
Lpp14:
s_waitcnt lgkmcnt(4)
v_add_f32 v176, v176, v180
s_waitcnt lgkmcnt(3)
v_add_f32 v176, v176, v181
s_waitcnt lgkmcnt(2)
v_add_f32 v176, v176, v182
s_waitcnt lgkmcnt(1)
v_add_f32 v176, v176, v183
ds_write_b32 v189, v176
v_mfma_f32_16x16x32_bf16 v[152:155], v[124:127], v[32:35], v[152:155]
ds_read_b128 v[124:127], v248 offset:256
s_waitcnt lgkmcnt(2)
v_mfma_f32_16x16x32_bf16 v[144:147], v[120:123], v[64:67], v[144:147]
v_mfma_f32_16x16x32_bf16 v[148:151], v[120:123], v[68:71], v[148:151]
s_cmp_eq_u32 s77, 0
s_cbranch_scc1 Lpp15
s_call_b64 s[78:79], Lpolln
Lpp15:
v_mfma_f32_16x16x32_bf16 v[152:155], v[120:123], v[40:43], v[152:155]
ds_read_b128 v[120:123], v248 offset:2304
s_nop 2
v_cvt_pk_f16_f32 v144, v144, v145
v_cvt_pk_f16_f32 v146, v146, v147
v_pk_fma_f16 v145, v144, v144, s48
v_pk_fma_f16 v147, v146, v146, s48
v_cvt_pkrtz_f16_f32 v148, v148, v149
v_cvt_pkrtz_f16_f32 v149, v150, v151
v_lshrrev_b64 v[148:149], 2, v[148:149]
v_and_b32_sdwa v150, s47, v148 dst_sel:DWORD dst_unused:UNUSED_PAD src0_sel:DWORD src1_sel:WORD_1
v_and_b32 v148, s47, v148
s_waitcnt lgkmcnt(1)
v_mfma_f32_16x16x32_bf16 v[156:159], v[124:127], v[48:51], 0
ds_read_u16_d16_hi v150, v150
ds_read_u16 v148, v148
v_mfma_f32_16x16x32_bf16 v[176:179], v[124:127], v[52:55], 0
s_cmp_eq_u32 s77, 0
s_cbranch_scc1 Lpp16
s_call_b64 s[78:79], Lpolln
Lpp16:
v_and_b32_sdwa v151, s47, v149 dst_sel:DWORD dst_unused:UNUSED_PAD src0_sel:DWORD src1_sel:WORD_1
v_and_b32_e64 v149, s47, v149
v_mfma_f32_16x16x32_bf16 v[180:183], v[124:127], v[24:27], 0
ds_read_b128 v[124:127], v248 offset:4352
ds_read_u16_d16_hi v151, v151
s_waitcnt lgkmcnt(4)
v_mfma_f32_16x16x32_bf16 v[156:159], v[120:123], v[56:59], v[156:159]
ds_read_u16 v149, v149
v_pk_mul_f16 v145, v144, v145
v_mfma_f32_16x16x32_bf16 v[176:179], v[120:123], v[60:63], v[176:179]
v_pk_mul_f16 v147, v146, v147
v_cvt_pkrtz_f16_f32 v152, v152, v153
v_cvt_pkrtz_f16_f32 v153, v154, v155
v_lshrrev_b64 v[152:153], 2, v[152:153]
v_and_b32_sdwa v154, s47, v152 dst_sel:DWORD dst_unused:UNUSED_PAD src0_sel:DWORD src1_sel:WORD_1
v_and_b32_e64 v152, s47, v152
v_exp_f16_sdwa v145, v145 dst_sel:WORD_0 dst_unused:UNUSED_PRESERVE src0_sel:WORD_0
v_mfma_f32_16x16x32_bf16 v[180:183], v[120:123], v[32:35], v[180:183]
ds_read_u16_d16_hi v154, v154
ds_read_u16 v152, v152
s_cmp_eq_u32 s77, 0
s_cbranch_scc1 Lpp17
s_call_b64 s[78:79], Lpolln
Lpp17:
v_exp_f16_sdwa v147, v147 dst_sel:WORD_0 dst_unused:UNUSED_PRESERVE src0_sel:WORD_0
v_and_b32_sdwa v155, s47, v153 dst_sel:DWORD dst_unused:UNUSED_PAD src0_sel:DWORD src1_sel:WORD_1
v_and_b32 v153, s47, v153
v_exp_f16_sdwa v145, v145 dst_sel:WORD_1 dst_unused:UNUSED_PRESERVE src0_sel:WORD_1
s_waitcnt lgkmcnt(4)
v_mfma_f32_16x16x32_bf16 v[156:159], v[124:127], v[64:67], v[156:159]
ds_read_u16_d16_hi v155, v155
ds_read_u16 v153, v153
v_mfma_f32_16x16x32_bf16 v[176:179], v[124:127], v[68:71], v[176:179]
v_exp_f16_sdwa v147, v147 dst_sel:WORD_1 dst_unused:UNUSED_PRESERVE src0_sel:WORD_1
v_mfma_f32_16x16x32_bf16 v[180:183], v[124:127], v[40:43], v[180:183]
v_pk_add_f16 v145, v145, 1.0 op_sel_hi:[1,0]
v_pk_add_f16 v147, v147, 1.0 op_sel_hi:[1,0]
s_cmp_eq_u32 s77, 0
s_cbranch_scc1 Lpp18
s_call_b64 s[78:79], Lpolln
Lpp18:
v_rcp_f16_sdwa v145, v145 dst_sel:WORD_0 dst_unused:UNUSED_PRESERVE src0_sel:WORD_0
v_rcp_f16_sdwa v147, v147 dst_sel:WORD_0 dst_unused:UNUSED_PRESERVE src0_sel:WORD_0
v_cvt_pkrtz_f16_f32 v156, v156, v157
v_cvt_pkrtz_f16_f32 v157, v158, v159
v_lshrrev_b64 v[156:157], 2, v[156:157]
v_and_b32_sdwa v158, s47, v156 dst_sel:DWORD dst_unused:UNUSED_PAD src0_sel:DWORD src1_sel:WORD_1
v_and_b32_e64 v156, s47, v156
v_rcp_f16_sdwa v145, v145 dst_sel:WORD_1 dst_unused:UNUSED_PRESERVE src0_sel:WORD_1
v_and_b32_sdwa v159, s47, v157 dst_sel:DWORD dst_unused:UNUSED_PAD src0_sel:DWORD src1_sel:WORD_1
v_and_b32_e64 v157, s47, v157
v_rcp_f16_sdwa v147, v147 dst_sel:WORD_1 dst_unused:UNUSED_PRESERVE src0_sel:WORD_1
v_cvt_pkrtz_f16_f32 v176, v176, v177
v_cvt_pkrtz_f16_f32 v177, v178, v179
ds_read_u16_d16_hi v158, v158
ds_read_u16 v156, v156
ds_read_u16_d16_hi v159, v159
ds_read_u16 v157, v157
v_lshrrev_b64 v[176:177], 2, v[176:177]
v_and_b32_sdwa v178, s47, v176 dst_sel:DWORD dst_unused:UNUSED_PAD src0_sel:DWORD src1_sel:WORD_1
v_and_b32_e64 v176, s47, v176
v_pk_mul_f16 v144, v144, v145
v_and_b32_sdwa v179, s47, v177 dst_sel:DWORD dst_unused:UNUSED_PAD src0_sel:DWORD src1_sel:WORD_1
v_and_b32_e64 v177, s47, v177
v_pk_mul_f16 v145, v146, v147
s_waitcnt lgkmcnt(5)
v_lshl_add_u64 v[148:149], v[148:149], 0, v[150:151]
v_cvt_pkrtz_f16_f32 v180, v180, v181
ds_read_u16_d16_hi v178, v178
ds_read_u16 v176, v176
s_cmp_eq_u32 s77, 0
s_cbranch_scc1 Lpp19
s_call_b64 s[78:79], Lpolln
Lpp19:
ds_read_u16_d16_hi v179, v179
ds_read_u16 v177, v177
v_cvt_pkrtz_f16_f32 v181, v182, v183
v_lshrrev_b64 v[180:181], 2, v[180:181]
v_and_b32_sdwa v182, s47, v180 dst_sel:DWORD dst_unused:UNUSED_PAD src0_sel:DWORD src1_sel:WORD_1
v_and_b32_e64 v180, s47, v180
v_and_b32_sdwa v183, s47, v181 dst_sel:DWORD dst_unused:UNUSED_PAD src0_sel:DWORD src1_sel:WORD_1
v_and_b32 v181, s47, v181
s_waitcnt lgkmcnt(8)
v_lshl_add_u64 v[152:153], v[152:153], 0, v[154:155]
ds_read_u16_d16_hi v182, v182
ds_read_u16 v180, v180
ds_read_u16_d16_hi v183, v183
ds_read_u16 v181, v181
s_cmp_eq_u32 s77, 0
s_cbranch_scc1 Lpp20
s_call_b64 s[78:79], Lpolln
Lpp20:
s_cmp_eq_u32 s77, 0
s_cbranch_scc1 Lpp21
s_call_b64 s[78:79], Lpolln
Lpp21:
ds_read_b128 v[120:123], v248 offset:6144
s_waitcnt lgkmcnt(9)
v_lshl_add_u64 v[146:147], v[156:157], 0, v[158:159]
s_waitcnt lgkmcnt(5)
v_lshl_add_u64 v[150:151], v[176:177], 0, v[178:179]
s_waitcnt lgkmcnt(1)
v_lshl_add_u64 v[154:155], v[180:181], 0, v[182:183]
s_cmp_lg_u32 s40, 0
s_cbranch_scc1 Lspinx
s_setprio 3
Lspin:
s_cmp_eq_u32 s77, 0
s_cbranch_scc1 Lspiny
s_cmp_eq_u32 s76, 0
s_cbranch_scc1 Lspiny
s_sub_u32 s76, s76, 1
s_call_b64 s[78:79], Lpoll
s_branch Lspin
Lspiny:
ds_write_b32 v191, v128
ds_write_b32 v191, v129 offset:4
ds_write_b32 v191, v130 offset:8
s_waitcnt lgkmcnt(0)
Lspinx:
s_waitcnt lgkmcnt(0)
s_barrier
ds_read_b64 v[240:241], v188 offset:3072
ds_read_b64 v[242:243], v188 offset:3104
ds_read_b64 v[244:245], v188 offset:3136
ds_read_b128 v[128:131], v254 offset:8192
ds_read_b128 v[132:135], v254 offset:8208
ds_read_b128 v[136:139], v254 offset:8320
ds_read_b128 v[140:143], v254 offset:8336
s_waitcnt lgkmcnt(6)
v_pk_mul_f16 v72, v72, v240
v_pk_mul_f16 v73, v73, v241
v_and_b32 v72, s49, v72
v_and_b32 v73, s49, v73
s_waitcnt lgkmcnt(4)
v_pk_mul_f16 v74, v74, v240
v_pk_mul_f16 v75, v75, v241
v_and_b32 v74, s49, v74
v_and_b32 v75, s49, v75
v_pk_mul_f16 v76, v76, v240
v_pk_mul_f16 v77, v77, v241
v_and_b32 v76, s49, v76
v_and_b32 v77, s49, v77
v_pk_mul_f16 v78, v78, v240
v_pk_mul_f16 v79, v79, v241
ds_write_b64 v173, v[72:73]
ds_write_b64 v173, v[74:75] offset:3072
v_and_b32 v78, s49, v78
v_and_b32 v79, s49, v79
v_pk_mul_f16 v80, v80, v240
v_pk_mul_f16 v81, v81, v241
v_and_b32 v80, s49, v80
v_and_b32 v81, s49, v81
v_pk_mul_f16 v82, v82, v240
v_pk_mul_f16 v83, v83, v241
ds_write_b64 v173, v[76:77] offset:1024
ds_write_b64 v173, v[78:79] offset:4096
v_and_b32 v82, s49, v82
v_and_b32 v83, s49, v83
v_pk_mul_f16 v84, v84, v242
v_pk_mul_f16 v85, v85, v243
v_and_b32 v84, s49, v84
v_and_b32 v85, s49, v85
v_pk_mul_f16 v86, v86, v242
v_pk_mul_f16 v87, v87, v243
ds_write_b64 v173, v[80:81] offset:2048
ds_write_b64 v173, v[82:83] offset:5120
v_and_b32 v86, s49, v86
v_and_b32 v87, s49, v87
v_pk_mul_f16 v88, v88, v242
v_pk_mul_f16 v89, v89, v243
v_and_b32 v88, s49, v88
v_and_b32 v89, s49, v89
v_pk_mul_f16 v90, v90, v242
v_pk_mul_f16 v91, v91, v243
ds_write_b64 v174, v[84:85]
ds_write_b64 v174, v[86:87] offset:3072
v_and_b32 v90, s49, v90
v_and_b32 v91, s49, v91
v_pk_mul_f16 v92, v92, v242
v_pk_mul_f16 v93, v93, v243
v_and_b32 v92, s49, v92
v_and_b32 v93, s49, v93
v_pk_mul_f16 v94, v94, v242
v_pk_mul_f16 v95, v95, v243
ds_write_b64 v174, v[88:89] offset:1024
ds_write_b64 v174, v[90:91] offset:4096
v_and_b32 v94, s49, v94
v_and_b32 v95, s49, v95
v_pk_mul_f16 v160, v160, v244
v_pk_mul_f16 v161, v161, v245
v_and_b32 v160, s49, v160
v_and_b32 v161, s49, v161
v_pk_mul_f16 v162, v162, v244
v_pk_mul_f16 v163, v163, v245
ds_write_b64 v174, v[92:93] offset:2048
s_waitcnt lgkmcnt(6)
ds_write_b64 v174, v[94:95] offset:5120
v_and_b32 v162, s49, v162
v_and_b32_e64 v163, s49, v163
v_pk_mul_f16 v164, v164, v244
v_pk_mul_f16 v165, v165, v245
v_and_b32 v164, s49, v164
v_and_b32 v165, s49, v165
v_pk_mul_f16 v166, v166, v244
v_pk_mul_f16 v167, v167, v245
ds_write_b64 v175, v[160:161]
ds_write_b64 v175, v[162:163] offset:3072
v_and_b32 v166, s49, v166
v_and_b32 v167, s49, v167
v_pk_mul_f16 v168, v168, v244
v_pk_mul_f16 v169, v169, v245
v_and_b32 v168, s49, v168
v_and_b32 v169, s49, v169
v_pk_mul_f16 v170, v170, v244
v_pk_mul_f16 v171, v171, v245
ds_write_b64 v175, v[164:165] offset:1024
ds_write_b64 v175, v[166:167] offset:4096
v_and_b32_e64 v170, s49, v170
v_and_b32 v171, s49, v171
ds_write_b64 v175, v[168:169] offset:2048
ds_write_b64 v175, v[170:171] offset:5120
ds_read_b128 v[240:243], v254
ds_read_b128 v[244:247], v254 offset:16
s_waitcnt lgkmcnt(0)
s_barrier
ds_read_b128 v[124:127], v251 offset:20480
ds_read_b128 v[184:187], v251 offset:23552
ds_read_b128 v[188:191], v251 offset:21504
ds_read_b128 v[160:163], v251 offset:24576
buffer_load_dwordx4 v[164:167], v253, s[4:7], s71 offen
buffer_load_dwordx4 v[168:171], v253, s[4:7], s71 offen offset:64
v_mfma_f32_16x16x32_bf16 v[172:175], v[120:123], v[48:51], 0
s_setprio 3
v_mfma_f32_16x16x32_bf16 v[156:159], v[120:123], v[52:55], 0
v_mfma_f32_16x16x32_bf16 v[176:179], v[120:123], v[24:27], 0
ds_read_b128 v[120:123], v251 offset:22528
s_waitcnt lgkmcnt(4)
v_mfma_f32_16x16x32_f16 v[72:75], v[124:127], v[4:7], v[128:131]
v_mfma_f32_16x16x32_f16 v[128:131], v[124:127], v[0:3], v[128:131]
ds_read_b128 v[124:127], v248 offset:8192
s_waitcnt lgkmcnt(4)
v_mfma_f32_16x16x32_f16 v[76:79], v[184:187], v[4:7], v[132:135]
v_mfma_f32_16x16x32_f16 v[132:135], v[184:187], v[0:3], v[132:135]
ds_read_b128 v[184:187], v251 offset:25600
s_waitcnt lgkmcnt(4)
v_mfma_f32_16x16x32_f16 v[80:83], v[188:191], v[4:7], v[136:139]
v_mfma_f32_16x16x32_f16 v[136:139], v[188:191], v[0:3], v[136:139]
ds_read_b128 v[188:191], v251 offset:26624
s_waitcnt lgkmcnt(4)
v_mfma_f32_16x16x32_f16 v[84:87], v[160:163], v[4:7], v[140:143]
v_mfma_f32_16x16x32_f16 v[140:143], v[160:163], v[0:3], v[140:143]
ds_read_b128 v[160:163], v251 offset:29696
s_waitcnt lgkmcnt(4)
v_mfma_f32_16x16x32_f16 v[88:91], v[120:123], v[4:7], v[240:243]
s_waitcnt lgkmcnt(3)
v_mfma_f32_16x16x32_bf16 v[172:175], v[124:127], v[56:59], v[172:175]
v_mfma_f32_16x16x32_f16 v[240:243], v[120:123], v[0:3], v[240:243]
ds_read_b128 v[120:123], v251 offset:27648
s_waitcnt lgkmcnt(3)
v_mfma_f32_16x16x32_f16 v[92:95], v[184:187], v[4:7], v[244:247]
v_mfma_f32_16x16x32_f16 v[244:247], v[184:187], v[0:3], v[244:247]
ds_read_b128 v[184:187], v251 offset:30720
v_mfma_f32_16x16x32_bf16 v[156:159], v[124:127], v[60:63], v[156:159]
s_waitcnt lgkmcnt(3)
v_mfma_f32_16x16x32_f16 v[72:75], v[188:191], v[12:15], v[72:75]
v_mfma_f32_16x16x32_f16 v[128:131], v[188:191], v[8:11], v[128:131]
ds_read_b128 v[188:191], v251 offset:28672
s_waitcnt lgkmcnt(3)
v_mfma_f32_16x16x32_f16 v[76:79], v[160:163], v[12:15], v[76:79]
v_mfma_f32_16x16x32_bf16 v[176:179], v[124:127], v[32:35], v[176:179]
ds_read_b128 v[124:127], v248 offset:10240
v_mfma_f32_16x16x32_f16 v[132:135], v[160:163], v[8:11], v[132:135]
ds_read_b128 v[160:163], v251 offset:31744
s_waitcnt lgkmcnt(4)
v_mfma_f32_16x16x32_f16 v[80:83], v[120:123], v[12:15], v[80:83]
v_mfma_f32_16x16x32_f16 v[136:139], v[120:123], v[8:11], v[136:139]
ds_read_b128 v[120:123], v251 offset:32768
s_setprio 2
s_waitcnt lgkmcnt(4)
v_mfma_f32_16x16x32_f16 v[84:87], v[184:187], v[12:15], v[84:87]
v_mfma_f32_16x16x32_f16 v[140:143], v[184:187], v[8:11], v[140:143]
ds_read_b128 v[184:187], v248 offset:6400
s_waitcnt lgkmcnt(4)
v_mfma_f32_16x16x32_f16 v[88:91], v[188:191], v[12:15], v[88:91]
s_waitcnt lgkmcnt(3)
v_mfma_f32_16x16x32_bf16 v[172:175], v[124:127], v[64:67], v[172:175]
v_mfma_f32_16x16x32_bf16 v[156:159], v[124:127], v[68:71], v[156:159]
v_mfma_f32_16x16x32_f16 v[240:243], v[188:191], v[8:11], v[240:243]
ds_read_b128 v[188:191], v251 offset:33792
s_nop 4
v_cvt_pk_f16_f32 v172, v172, v173
s_waitcnt lgkmcnt(3)
v_mfma_f32_16x16x32_f16 v[92:95], v[160:163], v[12:15], v[92:95]
v_cvt_pk_f16_f32 v174, v174, v175
v_cvt_pkrtz_f16_f32 v156, v156, v157
v_mfma_f32_16x16x32_f16 v[244:247], v[160:163], v[8:11], v[244:247]
ds_read_b128 v[160:163], v251 offset:36864
v_cvt_pkrtz_f16_f32 v157, v158, v159
v_mfma_f32_16x16x32_bf16 v[176:179], v[124:127], v[40:43], v[176:179]
ds_read_b128 v[124:127], v251 offset:35840
v_lshrrev_b64 v[156:157], 2, v[156:157]
s_waitcnt lgkmcnt(3)
v_mfma_f32_16x16x32_f16 v[72:75], v[120:123], v[20:23], v[72:75]
v_and_b32_sdwa v158, s47, v156 dst_sel:DWORD dst_unused:UNUSED_PAD src0_sel:DWORD src1_sel:WORD_1
v_and_b32 v156, s47, v156
v_mfma_f32_16x16x32_f16 v[128:131], v[120:123], v[16:19], v[128:131]
ds_read_b128 v[120:123], v251 offset:34816
ds_read_u16_d16_hi v158, v158
v_mfma_f32_16x16x32_bf16 v[180:183], v[184:187], v[48:51], 0
ds_read_u16 v156, v156
v_pk_fma_f16 v173, v172, v172, s48
s_waitcnt lgkmcnt(5)
v_mfma_f32_16x16x32_f16 v[80:83], v[188:191], v[20:23], v[80:83]
v_and_b32_sdwa v159, s47, v157 dst_sel:DWORD dst_unused:UNUSED_PAD src0_sel:DWORD src1_sel:WORD_1
v_and_b32_e64 v157, s47, v157
v_mfma_f32_16x16x32_f16 v[136:139], v[188:191], v[16:19], v[136:139]
ds_read_b128 v[188:191], v252 offset:4096
ds_read_u16_d16_hi v159, v159
s_waitcnt lgkmcnt(5)
v_mfma_f32_16x16x32_f16 v[76:79], v[124:127], v[20:23], v[76:79]
ds_read_u16 v157, v157
v_pk_fma_f16 v175, v174, v174, s48
v_mfma_f32_16x16x32_f16 v[132:135], v[124:127], v[16:19], v[132:135]
ds_read_b128 v[124:127], v251 offset:37888
v_pk_mul_f16 v173, v172, v173
v_mfma_f32_16x16x32_bf16 v[0:3], v[184:187], v[52:55], 0
v_pk_mul_f16 v175, v174, v175
v_cvt_pkrtz_f16_f32 v176, v176, v177
v_mfma_f32_16x16x32_f16 v[84:87], v[160:163], v[20:23], v[84:87]
v_cvt_pkrtz_f16_f32 v177, v178, v179
v_lshrrev_b64 v[176:177], 2, v[176:177]
v_mfma_f32_16x16x32_f16 v[140:143], v[160:163], v[16:19], v[140:143]
ds_read_b128 v[160:163], v252 offset:7168
v_and_b32_sdwa v178, s47, v176 dst_sel:DWORD dst_unused:UNUSED_PAD src0_sel:DWORD src1_sel:WORD_1
s_waitcnt lgkmcnt(7)
v_mfma_f32_16x16x32_f16 v[88:91], v[120:123], v[20:23], v[88:91]
v_and_b32 v176, s47, v176
v_exp_f16_sdwa v173, v173 dst_sel:WORD_0 dst_unused:UNUSED_PRESERVE src0_sel:WORD_0
v_mfma_f32_16x16x32_bf16 v[4:7], v[184:187], v[24:27], 0
ds_read_b128 v[184:187], v248 offset:8448
ds_read_u16_d16_hi v178, v178
v_mfma_f32_16x16x32_f16 v[240:243], v[120:123], v[16:19], v[240:243]
ds_read_b128 v[120:123], v252 offset:5120
ds_read_u16 v176, v176
s_waitcnt lgkmcnt(8)
v_mfma_f32_16x16x32_f16 v[72:75], v[188:191], v[100:103], v[72:75]
s_setprio 1
v_exp_f16_sdwa v175, v175 dst_sel:WORD_0 dst_unused:UNUSED_PRESERVE src0_sel:WORD_0
v_mfma_f32_16x16x32_f16 v[128:131], v[188:191], v[96:99], v[128:131]
ds_read_b128 v[188:191], v252 offset:6144
v_and_b32_sdwa v179, s47, v177 dst_sel:DWORD dst_unused:UNUSED_PAD src0_sel:DWORD src1_sel:WORD_1
s_waitcnt lgkmcnt(6)
v_mfma_f32_16x16x32_f16 v[92:95], v[124:127], v[20:23], v[92:95]
v_mov_b32 v20, 0
v_mov_b32_e64 v21, 0
v_mfma_f32_16x16x32_f16 v[244:247], v[124:127], v[16:19], v[244:247]
ds_read_b128 v[124:127], v252 offset:8192
v_mov_b32 v16, 0
s_waitcnt lgkmcnt(5)
v_mfma_f32_16x16x32_bf16 v[180:183], v[184:187], v[56:59], v[180:183]
v_mov_b32_e64 v17, 0
v_cndmask_b32 v18, 0, v255, s[88:89]
v_cndmask_b32 v19, 0, v255, s[90:91]
v_mfma_f32_16x16x32_bf16 v[0:3], v[184:187], v[60:63], v[0:3]
v_and_b32 v177, s47, v177
v_exp_f16_sdwa v173, v173 dst_sel:WORD_1 dst_unused:UNUSED_PRESERVE src0_sel:WORD_1
v_mfma_f32_16x16x32_f16 v[76:79], v[160:163], v[100:103], v[76:79]
ds_read_u16_d16_hi v179, v179
ds_read_u16 v177, v177
v_mfma_f32_16x16x32_f16 v[132:135], v[160:163], v[96:99], v[132:135]
ds_read_b128 v[160:163], v252 offset:9216
v_exp_f16_sdwa v175, v175 dst_sel:WORD_1 dst_unused:UNUSED_PRESERVE src0_sel:WORD_1
s_waitcnt lgkmcnt(6)
v_mfma_f32_16x16x32_f16 v[80:83], v[120:123], v[100:103], v[80:83]
v_pk_add_f16 v173, v173, 1.0 op_sel_hi:[1,0]
v_pk_add_f16 v175, v175, 1.0 op_sel_hi:[1,0]
v_mfma_f32_16x16x32_bf16 v[4:7], v[184:187], v[32:35], v[4:7]
ds_read_b128 v[184:187], v248 offset:10496
v_rcp_f16_sdwa v173, v173 dst_sel:WORD_0 dst_unused:UNUSED_PRESERVE src0_sel:WORD_0
v_mfma_f32_16x16x32_f16 v[136:139], v[120:123], v[96:99], v[136:139]
ds_read_b128 v[120:123], v252 offset:10240
v_rcp_f16_sdwa v175, v175 dst_sel:WORD_0 dst_unused:UNUSED_PRESERVE src0_sel:WORD_0
s_waitcnt lgkmcnt(5)
v_mfma_f32_16x16x32_f16 v[84:87], v[124:127], v[100:103], v[84:87]
v_rcp_f16_sdwa v173, v173 dst_sel:WORD_1 dst_unused:UNUSED_PRESERVE src0_sel:WORD_1
v_mfma_f32_16x16x32_f16 v[140:143], v[124:127], v[96:99], v[140:143]
ds_read_b128 v[124:127], v252 offset:13312
v_rcp_f16_sdwa v175, v175 dst_sel:WORD_1 dst_unused:UNUSED_PRESERVE src0_sel:WORD_1
v_mfma_f32_16x16x32_f16 v[88:91], v[188:191], v[100:103], v[88:91]
v_mfma_f32_16x16x32_f16 v[240:243], v[188:191], v[96:99], v[240:243]
ds_read_b128 v[188:191], v248 offset:12288
s_waitcnt lgkmcnt(3)
v_mfma_f32_16x16x32_bf16 v[180:183], v[184:187], v[64:67], v[180:183]
v_mfma_f32_16x16x32_f16 v[92:95], v[160:163], v[100:103], v[92:95]
v_pk_mul_f16 v172, v172, v173
v_mfma_f32_16x16x32_bf16 v[0:3], v[184:187], v[68:71], v[0:3]
s_nop 4
v_cvt_pk_f16_f32 v180, v180, v181
v_mfma_f32_16x16x32_f16 v[244:247], v[160:163], v[96:99], v[244:247]
ds_read_b128 v[160:163], v252 offset:14336
v_cvt_pk_f16_f32 v182, v182, v183
s_waitcnt lgkmcnt(3)
v_mfma_f32_16x16x32_f16 v[72:75], v[120:123], v[108:111], v[72:75]
v_pk_fma_f16 v181, v180, v180, s48
v_cvt_pkrtz_f16_f32 v0, v0, v1
v_mfma_f32_16x16x32_f16 v[128:131], v[120:123], v[104:107], v[128:131]
ds_read_b128 v[120:123], v252 offset:12288
v_cvt_pkrtz_f16_f32 v1, v2, v3
v_mfma_f32_16x16x32_bf16 v[4:7], v[184:187], v[40:43], v[4:7]
ds_read_b128 v[184:187], v252 offset:11264
v_lshrrev_b64 v[0:1], 2, v[0:1]
s_waitcnt lgkmcnt(3)
v_mfma_f32_16x16x32_f16 v[76:79], v[124:127], v[108:111], v[76:79]
v_and_b32_sdwa v2, s47, v0 dst_sel:DWORD dst_unused:UNUSED_PAD src0_sel:DWORD src1_sel:WORD_1
v_and_b32 v0, s47, v0
v_mfma_f32_16x16x32_f16 v[132:135], v[124:127], v[104:107], v[132:135]
ds_read_b128 v[124:127], v252 offset:15360
s_setprio 0
ds_read_u16_d16_hi v2, v2
v_mfma_f32_16x16x32_bf16 v[8:11], v[188:191], v[48:51], 0
ds_read_u16 v0, v0
v_and_b32_sdwa v3, s47, v1 dst_sel:DWORD dst_unused:UNUSED_PAD src0_sel:DWORD src1_sel:WORD_1
s_waitcnt lgkmcnt(5)
v_mfma_f32_16x16x32_f16 v[84:87], v[160:163], v[108:111], v[84:87]
v_and_b32 v1, s47, v1
v_pk_fma_f16 v183, v182, v182, s48
v_mfma_f32_16x16x32_f16 v[140:143], v[160:163], v[104:107], v[140:143]
ds_read_b128 v[160:163], v251 offset:41984
ds_read_u16_d16_hi v3, v3
s_waitcnt lgkmcnt(5)
v_mfma_f32_16x16x32_f16 v[80:83], v[184:187], v[108:111], v[80:83]
ds_read_u16 v1, v1
v_pk_mul_f16 v181, v180, v181
v_mfma_f32_16x16x32_f16 v[136:139], v[184:187], v[104:107], v[136:139]
ds_read_b128 v[184:187], v251 offset:38912
v_pk_mul_f16 v183, v182, v183
v_mfma_f32_16x16x32_bf16 v[12:15], v[188:191], v[52:55], 0
v_cvt_pkrtz_f16_f32 v4, v4, v5
v_cvt_pkrtz_f16_f32 v5, v6, v7
v_mfma_f32_16x16x32_f16 v[88:91], v[120:123], v[108:111], v[88:91]
v_lshrrev_b64 v[4:5], 2, v[4:5]
v_and_b32_sdwa v6, s47, v4 dst_sel:DWORD dst_unused:UNUSED_PAD src0_sel:DWORD src1_sel:WORD_1
v_mfma_f32_16x16x32_f16 v[240:243], v[120:123], v[104:107], v[240:243]
ds_read_b128 v[120:123], v251 offset:39936
v_and_b32 v4, s47, v4
s_waitcnt lgkmcnt(7)
v_mfma_f32_16x16x32_f16 v[92:95], v[124:127], v[108:111], v[92:95]
ds_read_u16_d16_hi v6, v6
ds_read_u16 v4, v4
v_mfma_f32_16x16x32_bf16 v[96:99], v[188:191], v[24:27], 0
ds_read_b128 v[188:191], v248 offset:14336
v_pk_mul_f16 v173, v174, v175
v_mfma_f32_16x16x32_f16 v[244:247], v[124:127], v[104:107], v[244:247]
ds_read_b128 v[124:127], v251 offset:43008
buffer_load_dwordx4 v[100:103], v253, s[4:7], s71 offen offset:128
buffer_load_dwordx4 v[104:107], v253, s[4:7], s71 offen offset:192
s_waitcnt lgkmcnt(8)
v_mfma_f32_16x16x32_f16 v[76:79], v[160:163], v[196:199], v[76:79]
v_exp_f16_sdwa v181, v181 dst_sel:WORD_0 dst_unused:UNUSED_PRESERVE src0_sel:WORD_0
v_mfma_f32_16x16x32_f16 v[132:135], v[160:163], v[192:195], v[132:135]
ds_read_b128 v[160:163], v251 offset:44032
v_lshl_add_u64 v[156:157], v[156:157], 0, v[158:159]
s_waitcnt lgkmcnt(6)
v_mfma_f32_16x16x32_f16 v[72:75], v[184:187], v[196:199], v[72:75]
v_exp_f16_sdwa v183, v183 dst_sel:WORD_0 dst_unused:UNUSED_PRESERVE src0_sel:WORD_0
v_mfma_f32_16x16x32_f16 v[128:131], v[184:187], v[192:195], v[128:131]
ds_read_b128 v[184:187], v251 offset:40960
v_and_b32_sdwa v7, s47, v5 dst_sel:DWORD dst_unused:UNUSED_PAD src0_sel:DWORD src1_sel:WORD_1
s_waitcnt lgkmcnt(6)
v_mfma_f32_16x16x32_f16 v[80:83], v[120:123], v[196:199], v[80:83]
v_and_b32 v5, s47, v5
v_exp_f16_sdwa v181, v181 dst_sel:WORD_1 dst_unused:UNUSED_PRESERVE src0_sel:WORD_1
v_mfma_f32_16x16x32_f16 v[136:139], v[120:123], v[192:195], v[136:139]
ds_read_b128 v[120:123], v251 offset:45056
ds_read_u16_d16_hi v7, v7
ds_read_u16 v5, v5
s_waitcnt lgkmcnt(6)
v_mfma_f32_16x16x32_bf16 v[8:11], v[188:191], v[56:59], v[8:11]
v_lshl_add_u64 v[176:177], v[176:177], 0, v[178:179]
v_exp_f16_sdwa v183, v183 dst_sel:WORD_1 dst_unused:UNUSED_PRESERVE src0_sel:WORD_1
v_mfma_f32_16x16x32_bf16 v[12:15], v[188:191], v[60:63], v[12:15]
v_pk_add_f16 v181, v181, 1.0 op_sel_hi:[1,0]
v_pk_add_f16 v183, v183, 1.0 op_sel_hi:[1,0]
s_waitcnt lgkmcnt(5)
v_mfma_f32_16x16x32_f16 v[84:87], v[124:127], v[196:199], v[84:87]
v_rcp_f16_sdwa v181, v181 dst_sel:WORD_0 dst_unused:UNUSED_PRESERVE src0_sel:WORD_0
v_mfma_f32_16x16x32_f16 v[140:143], v[124:127], v[192:195], v[140:143]
ds_read_b128 v[124:127], v251 offset:48128
v_rcp_f16_sdwa v183, v183 dst_sel:WORD_0 dst_unused:UNUSED_PRESERVE src0_sel:WORD_0
v_mfma_f32_16x16x32_bf16 v[96:99], v[188:191], v[32:35], v[96:99]
ds_read_b128 v[188:191], v248 offset:16384
v_rcp_f16_sdwa v181, v181 dst_sel:WORD_1 dst_unused:UNUSED_PRESERVE src0_sel:WORD_1
s_waitcnt lgkmcnt(5)
v_mfma_f32_16x16x32_f16 v[88:91], v[184:187], v[196:199], v[88:91]
s_setprio 3
v_mfma_f32_16x16x32_f16 v[240:243], v[184:187], v[192:195], v[240:243]
ds_read_b128 v[184:187], v251 offset:46080
v_rcp_f16_sdwa v183, v183 dst_sel:WORD_1 dst_unused:UNUSED_PRESERVE src0_sel:WORD_1
v_mfma_f32_16x16x32_f16 v[92:95], v[160:163], v[196:199], v[92:95]
v_mfma_f32_16x16x32_f16 v[244:247], v[160:163], v[192:195], v[244:247]
ds_read_b128 v[160:163], v248 offset:12544
s_waitcnt lgkmcnt(4)
v_mfma_f32_16x16x32_f16 v[72:75], v[120:123], v[204:207], v[72:75]
s_waitcnt lgkmcnt(2)
v_mfma_f32_16x16x32_bf16 v[8:11], v[188:191], v[64:67], v[8:11]
v_pk_mul_f16 v174, v180, v181
v_mfma_f32_16x16x32_bf16 v[12:15], v[188:191], v[68:71], v[12:15]
v_mfma_f32_16x16x32_f16 v[128:131], v[120:123], v[200:203], v[128:131]
ds_read_b128 v[120:123], v251 offset:47104
v_pk_mul_f16 v175, v182, v183
v_mfma_f32_16x16x32_f16 v[76:79], v[124:127], v[204:207], v[76:79]
s_nop 1
v_cvt_pkrtz_f16_f32 v8, v8, v9
v_cvt_pkrtz_f16_f32 v9, v10, v11
v_mfma_f32_16x16x32_f16 v[132:135], v[124:127], v[200:203], v[132:135]
ds_read_b128 v[124:127], v251 offset:50176
v_lshrrev_b64 v[8:9], 2, v[8:9]
v_mfma_f32_16x16x32_bf16 v[96:99], v[188:191], v[40:43], v[96:99]
ds_read_b128 v[188:191], v251 offset:49152
v_and_b32_sdwa v10, s47, v8 dst_sel:DWORD dst_unused:UNUSED_PAD src0_sel:DWORD src1_sel:WORD_1
s_waitcnt lgkmcnt(3)
v_mfma_f32_16x16x32_f16 v[80:83], v[184:187], v[204:207], v[80:83]
v_and_b32_e64 v8, s47, v8
v_and_b32_sdwa v11, s47, v9 dst_sel:DWORD dst_unused:UNUSED_PAD src0_sel:DWORD src1_sel:WORD_1
v_mfma_f32_16x16x32_f16 v[136:139], v[184:187], v[200:203], v[136:139]
ds_read_b128 v[184:187], v251 offset:51200
ds_read_u16_d16_hi v10, v10
v_mfma_f32_16x16x32_bf16 v[108:111], v[160:163], v[48:51], 0
ds_read_u16 v8, v8
v_and_b32_e64 v9, s47, v9
s_waitcnt lgkmcnt(5)
v_mfma_f32_16x16x32_f16 v[88:91], v[120:123], v[204:207], v[88:91]
ds_read_u16_d16_hi v11, v11
ds_read_u16 v9, v9
v_mfma_f32_16x16x32_f16 v[240:243], v[120:123], v[200:203], v[240:243]
ds_read_b128 v[120:123], v251 offset:52224
v_cvt_pkrtz_f16_f32 v12, v12, v13
s_waitcnt lgkmcnt(6)
v_mfma_f32_16x16x32_f16 v[84:87], v[188:191], v[204:207], v[84:87]
v_cvt_pkrtz_f16_f32 v13, v14, v15
v_lshrrev_b64 v[12:13], 2, v[12:13]
v_mfma_f32_16x16x32_f16 v[140:143], v[188:191], v[200:203], v[140:143]
ds_read_b128 v[188:191], v251 offset:54272
v_and_b32_sdwa v14, s47, v12 dst_sel:DWORD dst_unused:UNUSED_PAD src0_sel:DWORD src1_sel:WORD_1
v_mfma_f32_16x16x32_bf16 v[192:195], v[160:163], v[52:55], 0
v_and_b32_e64 v12, s47, v12
v_and_b32_sdwa v15, s47, v13 dst_sel:DWORD dst_unused:UNUSED_PAD src0_sel:DWORD src1_sel:WORD_1
v_mfma_f32_16x16x32_f16 v[92:95], v[124:127], v[204:207], v[92:95]
ds_read_u16_d16_hi v14, v14
ds_read_u16 v12, v12
v_mfma_f32_16x16x32_f16 v[244:247], v[124:127], v[200:203], v[244:247]
ds_read_b128 v[124:127], v251 offset:55296
buffer_load_dwordx4 v[200:203], v253, s[4:7], s71 offen offset:256
buffer_load_dwordx4 v[204:207], v253, s[4:7], s71 offen offset:320
s_waitcnt lgkmcnt(9)
v_mfma_f32_16x16x32_f16 v[72:75], v[184:187], v[212:215], v[72:75]
v_and_b32 v13, s47, v13
v_lshl_add_u64 v[158:159], v[0:1], 0, v[2:3]
v_mfma_f32_16x16x32_bf16 v[196:199], v[160:163], v[24:27], 0
ds_read_b128 v[160:163], v248 offset:14592
ds_read_u16_d16_hi v15, v15
v_mfma_f32_16x16x32_f16 v[128:131], v[184:187], v[208:211], v[128:131]
ds_read_b128 v[184:187], v248 offset:16640
s_setprio 2
ds_read_u16 v13, v13
v_cvt_pkrtz_f16_f32 v96, v96, v97
v_cvt_pkrtz_f16_f32 v97, v98, v99
v_lshrrev_b64 v[96:97], 2, v[96:97]
s_waitcnt lgkmcnt(8)
v_mfma_f32_16x16x32_f16 v[80:83], v[120:123], v[212:215], v[80:83]
v_and_b32_sdwa v98, s47, v96 dst_sel:DWORD dst_unused:UNUSED_PAD src0_sel:DWORD src1_sel:WORD_1
v_and_b32 v96, s47, v96
s_waitcnt lgkmcnt(7)
v_mfma_f32_16x16x32_f16 v[76:79], v[188:191], v[212:215], v[76:79]
ds_read_u16_d16_hi v98, v98
ds_read_u16 v96, v96
v_mfma_f32_16x16x32_f16 v[132:135], v[188:191], v[208:211], v[132:135]
ds_read_b128 v[188:191], v251 offset:53248
v_and_b32_sdwa v99, s47, v97 dst_sel:DWORD dst_unused:UNUSED_PAD src0_sel:DWORD src1_sel:WORD_1
v_mfma_f32_16x16x32_f16 v[136:139], v[120:123], v[208:211], v[136:139]
ds_read_b128 v[120:123], v251 offset:57344
v_and_b32_e64 v97, s47, v97
v_lshl_add_u64 v[178:179], v[4:5], 0, v[6:7]
ds_read_u16_d16_hi v99, v99
ds_read_u16 v97, v97
s_waitcnt lgkmcnt(10)
v_mfma_f32_16x16x32_f16 v[84:87], v[124:127], v[212:215], v[84:87]
s_waitcnt lgkmcnt(9)
v_mfma_f32_16x16x32_bf16 v[108:111], v[160:163], v[56:59], v[108:111]
v_mfma_f32_16x16x32_bf16 v[192:195], v[160:163], v[60:63], v[192:195]
v_mfma_f32_16x16x32_bf16 v[196:199], v[160:163], v[32:35], v[196:199]
ds_read_b128 v[160:163], v251 offset:56320
v_mfma_f32_16x16x32_f16 v[140:143], v[124:127], v[208:211], v[140:143]
ds_read_b128 v[124:127], v248 offset:18432
s_waitcnt lgkmcnt(9)
v_mfma_f32_16x16x32_bf16 v[108:111], v[184:187], v[64:67], v[108:111]
v_mfma_f32_16x16x32_bf16 v[192:195], v[184:187], v[68:71], v[192:195]
v_mfma_f32_16x16x32_bf16 v[196:199], v[184:187], v[40:43], v[196:199]
ds_read_b128 v[184:187], v251 offset:60416
s_nop 4
v_cvt_pk_f16_f32 v108, v108, v109
v_cvt_pk_f16_f32 v110, v110, v111
v_pk_fma_f16 v109, v108, v108, s48
v_pk_fma_f16 v111, v110, v110, s48
v_cvt_pkrtz_f16_f32 v192, v192, v193
v_cvt_pkrtz_f16_f32 v193, v194, v195
s_waitcnt lgkmcnt(6)
v_mfma_f32_16x16x32_f16 v[88:91], v[188:191], v[212:215], v[88:91]
v_lshrrev_b64 v[192:193], 2, v[192:193]
v_and_b32_sdwa v194, s47, v192 dst_sel:DWORD dst_unused:UNUSED_PAD src0_sel:DWORD src1_sel:WORD_1
v_mfma_f32_16x16x32_f16 v[240:243], v[188:191], v[208:211], v[240:243]
ds_read_b128 v[188:191], v251 offset:58368
v_and_b32 v192, s47, v192
s_waitcnt lgkmcnt(6)
v_mfma_f32_16x16x32_f16 v[72:75], v[120:123], v[228:231], v[72:75]
s_setprio 1
ds_read_u16_d16_hi v194, v194
ds_read_u16 v192, v192
v_mfma_f32_16x16x32_f16 v[128:131], v[120:123], v[224:227], v[128:131]
ds_read_b128 v[120:123], v248 offset:20480
v_and_b32_sdwa v195, s47, v193 dst_sel:DWORD dst_unused:UNUSED_PAD src0_sel:DWORD src1_sel:WORD_1
v_and_b32 v193, s47, v193
v_pk_mul_f16 v109, v108, v109
v_pk_mul_f16 v111, v110, v111
s_waitcnt lgkmcnt(6)
v_mfma_f32_16x16x32_f16 v[92:95], v[160:163], v[212:215], v[92:95]
ds_read_u16_d16_hi v195, v195
ds_read_u16 v193, v193
v_mfma_f32_16x16x32_f16 v[244:247], v[160:163], v[208:211], v[244:247]
ds_read_b128 v[160:163], v251 offset:61440
v_cvt_pkrtz_f16_f32 v196, v196, v197
s_waitcnt lgkmcnt(8)
v_mfma_f32_16x16x32_bf16 v[208:211], v[124:127], v[48:51], 0
v_cvt_pkrtz_f16_f32 v197, v198, v199
v_lshrrev_b64 v[196:197], 2, v[196:197]
s_waitcnt lgkmcnt(7)
v_mfma_f32_16x16x32_f16 v[76:79], v[184:187], v[228:231], v[76:79]
v_and_b32_sdwa v198, s47, v196 dst_sel:DWORD dst_unused:UNUSED_PAD src0_sel:DWORD src1_sel:WORD_1
v_and_b32 v196, s47, v196
v_mfma_f32_16x16x32_bf16 v[212:215], v[124:127], v[52:55], 0
ds_read_u16_d16_hi v198, v198
ds_read_u16 v196, v196
v_mfma_f32_16x16x32_f16 v[132:135], v[184:187], v[224:227], v[132:135]
ds_read_b128 v[184:187], v251 offset:62464
v_lshl_add_u64 v[8:9], v[8:9], 0, v[10:11]
s_waitcnt lgkmcnt(9)
v_mfma_f32_16x16x32_f16 v[80:83], v[188:191], v[228:231], v[80:83]
v_exp_f16_sdwa v109, v109 dst_sel:WORD_0 dst_unused:UNUSED_PRESERVE src0_sel:WORD_0
v_mfma_f32_16x16x32_bf16 v[180:183], v[124:127], v[24:27], 0
ds_read_b128 v[124:127], v251 offset:59392
v_exp_f16_sdwa v111, v111 dst_sel:WORD_0 dst_unused:UNUSED_PRESERVE src0_sel:WORD_0
v_mfma_f32_16x16x32_f16 v[136:139], v[188:191], v[224:227], v[136:139]
ds_read_b128 v[188:191], v248 offset:22528
v_and_b32_sdwa v199, s47, v197 dst_sel:DWORD dst_unused:UNUSED_PAD src0_sel:DWORD src1_sel:WORD_1
s_waitcnt lgkmcnt(8)
v_mfma_f32_16x16x32_bf16 v[208:211], v[120:123], v[56:59], v[208:211]
v_and_b32 v197, s47, v197
v_lshl_add_u64 v[12:13], v[12:13], 0, v[14:15]
v_mfma_f32_16x16x32_bf16 v[212:215], v[120:123], v[60:63], v[212:215]
ds_read_u16_d16_hi v199, v199
ds_read_u16 v197, v197
s_waitcnt lgkmcnt(7)
v_mfma_f32_16x16x32_f16 v[84:87], v[160:163], v[228:231], v[84:87]
v_exp_f16_sdwa v109, v109 dst_sel:WORD_1 dst_unused:UNUSED_PRESERVE src0_sel:WORD_1
v_mfma_f32_16x16x32_f16 v[140:143], v[160:163], v[224:227], v[140:143]
ds_read_b128 v[160:163], v251 offset:8192
v_exp_f16_sdwa v111, v111 dst_sel:WORD_1 dst_unused:UNUSED_PRESERVE src0_sel:WORD_1
v_mfma_f32_16x16x32_bf16 v[180:183], v[120:123], v[32:35], v[180:183]
ds_read_b128 v[120:123], v251 offset:11264
v_lshl_add_u64 v[96:97], v[96:97], 0, v[98:99]
s_waitcnt lgkmcnt(6)
v_mfma_f32_16x16x32_f16 v[92:95], v[184:187], v[228:231], v[92:95]
s_setprio 0
v_pk_add_f16 v109, v109, 1.0 op_sel_hi:[1,0]
v_pk_add_f16 v111, v111, 1.0 op_sel_hi:[1,0]
s_waitcnt lgkmcnt(5)
v_mfma_f32_16x16x32_f16 v[88:91], v[124:127], v[228:231], v[88:91]
v_rcp_f16_sdwa v109, v109 dst_sel:WORD_0 dst_unused:UNUSED_PRESERVE src0_sel:WORD_0
v_mfma_f32_16x16x32_f16 v[240:243], v[124:127], v[224:227], v[240:243]
ds_read_b128 v[124:127], v251 offset:9216
v_rcp_f16_sdwa v111, v111 dst_sel:WORD_0 dst_unused:UNUSED_PRESERVE src0_sel:WORD_0
v_mfma_f32_16x16x32_f16 v[244:247], v[184:187], v[224:227], v[244:247]
ds_read_b128 v[184:187], v248 offset:18688
v_rcp_f16_sdwa v109, v109 dst_sel:WORD_1 dst_unused:UNUSED_PRESERVE src0_sel:WORD_1
s_waitcnt lgkmcnt(6)
v_mfma_f32_16x16x32_bf16 v[208:211], v[188:191], v[64:67], v[208:211]
v_rcp_f16_sdwa v111, v111 dst_sel:WORD_1 dst_unused:UNUSED_PRESERVE src0_sel:WORD_1
s_waitcnt lgkmcnt(3)
v_mfma_f32_16x16x32_f16 v[72:75], v[160:163], v[116:119], v[72:75]
v_mfma_f32_16x16x32_f16 v[128:131], v[160:163], v[112:115], v[128:131]
ds_read_b128 v[160:163], v251 offset:10240
s_nop 2
v_cvt_pk_f16_f32 v208, v208, v209
v_mfma_f32_16x16x32_bf16 v[212:215], v[188:191], v[68:71], v[212:215]
v_cvt_pk_f16_f32 v210, v210, v211
v_pk_fma_f16 v209, v208, v208, s48
s_waitcnt lgkmcnt(3)
v_mfma_f32_16x16x32_f16 v[76:79], v[120:123], v[116:119], v[76:79]
v_pk_fma_f16 v211, v210, v210, s48
v_pk_mul_f16 v209, v208, v209
v_mfma_f32_16x16x32_f16 v[132:135], v[120:123], v[112:115], v[132:135]
ds_read_b128 v[120:123], v251 offset:13312
v_cvt_pkrtz_f16_f32 v212, v212, v213
v_mfma_f32_16x16x32_bf16 v[180:183], v[188:191], v[40:43], v[180:183]
ds_read_b128 v[188:191], v251 offset:12288
v_cvt_pkrtz_f16_f32 v213, v214, v215
s_waitcnt lgkmcnt(3)
v_mfma_f32_16x16x32_f16 v[80:83], v[124:127], v[116:119], v[80:83]
v_lshrrev_b64 v[212:213], 2, v[212:213]
v_and_b32_sdwa v214, s47, v212 dst_sel:DWORD dst_unused:UNUSED_PAD src0_sel:DWORD src1_sel:WORD_1
v_mfma_f32_16x16x32_bf16 v[0:3], v[184:187], v[48:51], 0
v_and_b32 v212, s47, v212
v_and_b32_sdwa v215, s47, v213 dst_sel:DWORD dst_unused:UNUSED_PAD src0_sel:DWORD src1_sel:WORD_1
v_mfma_f32_16x16x32_f16 v[136:139], v[124:127], v[112:115], v[136:139]
ds_read_b128 v[124:127], v248 offset:20736
ds_read_u16_d16_hi v214, v214
v_mfma_f32_16x16x32_bf16 v[4:7], v[184:187], v[52:55], 0
ds_read_u16 v212, v212
v_and_b32 v213, s47, v213
s_waitcnt lgkmcnt(5)
v_mfma_f32_16x16x32_f16 v[88:91], v[160:163], v[116:119], v[88:91]
ds_read_u16_d16_hi v215, v215
ds_read_u16 v213, v213
s_waitcnt lgkmcnt(5)
v_mfma_f32_16x16x32_f16 v[84:87], v[188:191], v[116:119], v[84:87]
v_pk_mul_f16 v10, v108, v109
v_pk_mul_f16 v211, v210, v211
v_mfma_f32_16x16x32_f16 v[140:143], v[188:191], v[112:115], v[140:143]
ds_read_b128 v[188:191], v251 offset:17408
s_setprio 3
v_cvt_pkrtz_f16_f32 v180, v180, v181
v_mfma_f32_16x16x32_bf16 v[224:227], v[184:187], v[24:27], 0
ds_read_b128 v[184:187], v251 offset:14336
v_cvt_pkrtz_f16_f32 v181, v182, v183
v_mfma_f32_16x16x32_f16 v[240:243], v[160:163], v[112:115], v[240:243]
ds_read_b128 v[160:163], v248 offset:22784
v_lshrrev_b64 v[180:181], 2, v[180:181]
v_mfma_f32_16x16x32_f16 v[92:95], v[120:123], v[116:119], v[92:95]
v_and_b32_sdwa v182, s47, v180 dst_sel:DWORD dst_unused:UNUSED_PAD src0_sel:DWORD src1_sel:WORD_1
v_and_b32 v180, s47, v180
s_waitcnt lgkmcnt(7)
v_mfma_f32_16x16x32_bf16 v[0:3], v[124:127], v[56:59], v[0:3]
ds_read_u16_d16_hi v182, v182
ds_read_u16 v180, v180
v_mfma_f32_16x16x32_f16 v[244:247], v[120:123], v[112:115], v[244:247]
ds_read_b128 v[120:123], v251 offset:15360
v_pk_mul_f16 v11, v110, v111
s_waitcnt vmcnt(5)
v_mfma_f32_16x16x32_bf16 v[128:131], v[18:21], v[164:167], v[128:131]
v_exp_f16_sdwa v209, v209 dst_sel:WORD_0 dst_unused:UNUSED_PRESERVE src0_sel:WORD_0
v_mfma_f32_16x16x32_bf16 v[132:135], v[16:19], v[164:167], v[132:135]
v_lshl_add_u64 v[14:15], v[192:193], 0, v[194:195]
v_exp_f16_sdwa v211, v211 dst_sel:WORD_0 dst_unused:UNUSED_PRESERVE src0_sel:WORD_0
s_waitcnt vmcnt(4)
v_mfma_f32_16x16x32_bf16 v[136:139], v[18:21], v[168:171], v[136:139]
v_and_b32_sdwa v183, s47, v181 dst_sel:DWORD dst_unused:UNUSED_PAD src0_sel:DWORD src1_sel:WORD_1
v_and_b32 v181, s47, v181
v_mfma_f32_16x16x32_bf16 v[140:143], v[16:19], v[168:171], v[140:143]
ds_read_u16_d16_hi v183, v183
ds_read_u16 v181, v181
s_waitcnt lgkmcnt(6)
v_mfma_f32_16x16x32_f16 v[72:75], v[184:187], v[220:223], v[72:75]
v_exp_f16_sdwa v209, v209 dst_sel:WORD_1 dst_unused:UNUSED_PRESERVE src0_sel:WORD_1
v_mfma_f32_16x16x32_bf16 v[4:7], v[124:127], v[60:63], v[4:7]
v_lshl_add_u64 v[98:99], v[196:197], 0, v[198:199]
v_exp_f16_sdwa v211, v211 dst_sel:WORD_1 dst_unused:UNUSED_PRESERVE src0_sel:WORD_1
v_mfma_f32_16x16x32_f16 v[128:131], v[184:187], v[216:219], v[128:131]
ds_read_b128 v[184:187], v251 offset:16384
v_pk_add_f16 v209, v209, 1.0 op_sel_hi:[1,0]
v_mfma_f32_16x16x32_bf16 v[224:227], v[124:127], v[32:35], v[224:227]
ds_read_b128 v[124:127], v251 offset:18432
v_pk_add_f16 v211, v211, 1.0 op_sel_hi:[1,0]
v_mfma_f32_16x16x32_f16 v[76:79], v[188:191], v[220:223], v[76:79]
v_rcp_f16_sdwa v209, v209 dst_sel:WORD_0 dst_unused:UNUSED_PRESERVE src0_sel:WORD_0
v_mfma_f32_16x16x32_f16 v[132:135], v[188:191], v[216:219], v[132:135]
ds_read_b128 v[188:191], v248 offset:24576
v_rcp_f16_sdwa v211, v211 dst_sel:WORD_0 dst_unused:UNUSED_PRESERVE src0_sel:WORD_0
s_waitcnt lgkmcnt(5)
v_mfma_f32_16x16x32_bf16 v[0:3], v[160:163], v[64:67], v[0:3]
v_rcp_f16_sdwa v209, v209 dst_sel:WORD_1 dst_unused:UNUSED_PRESERVE src0_sel:WORD_1
v_mfma_f32_16x16x32_f16 v[80:83], v[120:123], v[220:223], v[80:83]
v_rcp_f16_sdwa v211, v211 dst_sel:WORD_1 dst_unused:UNUSED_PRESERVE src0_sel:WORD_1
v_mfma_f32_16x16x32_f16 v[136:139], v[120:123], v[216:219], v[136:139]
ds_read_b128 v[120:123], v251 offset:63488
s_nop 2
v_cvt_pkrtz_f16_f32 v0, v0, v1
v_mfma_f32_16x16x32_bf16 v[4:7], v[160:163], v[68:71], v[4:7]
v_cvt_pkrtz_f16_f32 v1, v2, v3
v_lshrrev_b64 v[0:1], 2, v[0:1]
s_waitcnt lgkmcnt(2)
v_mfma_f32_16x16x32_f16 v[84:87], v[124:127], v[220:223], v[84:87]
s_setprio 2
v_and_b32_sdwa v2, s47, v0 dst_sel:DWORD dst_unused:UNUSED_PAD src0_sel:DWORD src1_sel:WORD_1
v_and_b32_e64 v0, s47, v0
v_mfma_f32_16x16x32_f16 v[140:143], v[124:127], v[216:219], v[140:143]
ds_read_b128 v[124:127], v252 offset:1024
ds_read_u16_d16_hi v2, v2
v_mfma_f32_16x16x32_bf16 v[224:227], v[160:163], v[40:43], v[224:227]
ds_read_b128 v[160:163], v251 offset:19456
ds_read_u16 v0, v0
v_mfma_f32_16x16x32_f16 v[88:91], v[184:187], v[220:223], v[88:91]
v_and_b32_sdwa v3, s47, v1 dst_sel:DWORD dst_unused:UNUSED_PAD src0_sel:DWORD src1_sel:WORD_1
v_and_b32_e64 v1, s47, v1
v_mfma_f32_16x16x32_f16 v[240:243], v[184:187], v[216:219], v[240:243]
ds_read_b128 v[184:187], v248 offset:26624
ds_read_u16_d16_hi v3, v3
s_waitcnt lgkmcnt(7)
v_mfma_f32_16x16x32_bf16 v[228:231], v[188:191], v[48:51], 0
ds_read_u16 v1, v1
v_cvt_pkrtz_f16_f32 v4, v4, v5
v_mfma_f32_16x16x32_bf16 v[112:115], v[188:191], v[52:55], 0
v_cvt_pkrtz_f16_f32 v5, v6, v7
v_lshrrev_b64 v[4:5], 2, v[4:5]
s_waitcnt vmcnt(3)
v_mfma_f32_16x16x32_bf16 v[240:243], v[18:21], v[100:103], v[240:243]
v_and_b32_sdwa v6, s47, v4 dst_sel:DWORD dst_unused:UNUSED_PAD src0_sel:DWORD src1_sel:WORD_1
v_and_b32 v4, s47, v4
s_waitcnt vmcnt(2)
v_mfma_f32_16x16x32_bf16 v[72:75], v[18:21], v[104:107], v[72:75]
ds_read_u16_d16_hi v6, v6
ds_read_u16 v4, v4
v_mfma_f32_16x16x32_bf16 v[76:79], v[16:19], v[104:107], v[76:79]
v_pk_mul_f16 v208, v208, v209
v_and_b32_sdwa v7, s47, v5 dst_sel:DWORD dst_unused:UNUSED_PAD src0_sel:DWORD src1_sel:WORD_1
s_waitcnt lgkmcnt(6)
v_mfma_f32_16x16x32_f16 v[92:95], v[160:163], v[220:223], v[92:95]
v_and_b32 v5, s47, v5
v_pk_mul_f16 v209, v210, v211
v_mfma_f32_16x16x32_f16 v[244:247], v[160:163], v[216:219], v[244:247]
ds_read_b128 v[160:163], v252 offset:2048
ds_read_u16_d16_hi v7, v7
v_mfma_f32_16x16x32_bf16 v[244:247], v[16:19], v[100:103], v[244:247]
ds_read_u16 v5, v5
v_lshl_add_u64 v[212:213], v[212:213], 0, v[214:215]
v_mfma_f32_16x16x32_f16 v[72:75], v[120:123], v[236:239], v[72:75]
v_cvt_pkrtz_f16_f32 v224, v224, v225
v_cvt_pkrtz_f16_f32 v225, v226, v227
v_mfma_f32_16x16x32_bf16 v[116:119], v[188:191], v[24:27], 0
ds_read_b128 v[188:191], v251 offset:64512
v_lshrrev_b64 v[224:225], 2, v[224:225]
v_mfma_f32_16x16x32_f16 v[128:131], v[120:123], v[232:235], v[128:131]
ds_read_b128 v[120:123], v248 offset:28672
s_nop 0
v_cvt_pk_bf16_f32 v72, v72, v73
v_mfma_f32_16x16x32_f16 v[76:79], v[124:127], v[236:239], v[76:79]
v_cvt_pk_bf16_f32 v73, v74, v75
v_and_b32_sdwa v226, s47, v224 dst_sel:DWORD dst_unused:UNUSED_PAD src0_sel:DWORD src1_sel:WORD_1
s_waitcnt lgkmcnt(7)
v_mfma_f32_16x16x32_bf16 v[228:231], v[184:187], v[56:59], v[228:231]
v_and_b32_e64 v224, s47, v224
v_cvt_pk_bf16_f32 v128, v128, v129
v_mfma_f32_16x16x32_f16 v[132:135], v[124:127], v[232:235], v[132:135]
ds_read_b128 v[124:127], v252
v_cvt_pk_bf16_f32 v129, v130, v131
v_mfma_f32_16x16x32_bf16 v[112:115], v[184:187], v[60:63], v[112:115]
v_cvt_pk_bf16_f32 v74, v76, v77
v_cvt_pk_bf16_f32 v75, v78, v79
v_mfma_f32_16x16x32_bf16 v[116:119], v[184:187], v[32:35], v[116:119]
ds_read_b128 v[76:79], v254 offset:8208
s_nop 0
v_cvt_pk_bf16_f32 v130, v132, v133
v_cvt_pk_bf16_f32 v131, v134, v135
s_setprio 1
ds_read_b128 v[132:135], v254 offset:8192
ds_read_b128 v[184:187], v252 offset:3072
s_waitcnt lgkmcnt(8)
v_mfma_f32_16x16x32_f16 v[84:87], v[160:163], v[236:239], v[84:87]
ds_read_u16_d16_hi v226, v226
ds_read_u16 v224, v224
s_waitcnt lgkmcnt(7)
v_mfma_f32_16x16x32_f16 v[80:83], v[188:191], v[236:239], v[80:83]
v_and_b32_sdwa v227, s47, v225 dst_sel:DWORD dst_unused:UNUSED_PAD src0_sel:DWORD src1_sel:WORD_1
v_and_b32_e64 v225, s47, v225
v_mfma_f32_16x16x32_f16 v[136:139], v[188:191], v[232:235], v[136:139]
ds_read_b128 v[188:191], v251 offset:8192
ds_read_u16_d16_hi v227, v227
v_mfma_f32_16x16x32_f16 v[140:143], v[160:163], v[232:235], v[140:143]
ds_read_b128 v[160:163], v248 offset:24832
ds_read_u16 v225, v225
s_waitcnt lgkmcnt(10)
v_mfma_f32_16x16x32_bf16 v[228:231], v[120:123], v[64:67], v[228:231]
v_lshl_add_u64 v[180:181], v[180:181], 0, v[182:183]
v_cvt_pk_bf16_f32 v136, v136, v137
v_cvt_pk_bf16_f32 v137, v138, v139
s_waitcnt lgkmcnt(9)
v_mfma_f32_16x16x32_f16 v[88:91], v[124:127], v[236:239], v[88:91]
v_cvt_pk_bf16_f32 v138, v140, v141
v_cvt_pk_bf16_f32 v139, v142, v143
v_mfma_f32_16x16x32_f16 v[240:243], v[124:127], v[232:235], v[240:243]
ds_read_b128 v[140:143], v254 offset:8320
ds_read_b128 v[124:127], v248 offset:26880
v_mfma_f32_16x16x32_bf16 v[112:115], v[120:123], v[68:71], v[112:115]
v_cvt_pk_f16_f32 v228, v228, v229
v_cvt_pk_f16_f32 v230, v230, v231
s_waitcnt lgkmcnt(8)
v_mfma_f32_16x16x32_f16 v[92:95], v[184:187], v[236:239], v[92:95]
v_pk_fma_f16 v229, v228, v228, s48
v_cvt_pk_bf16_f32 v240, v240, v241
v_cvt_pk_bf16_f32 v241, v242, v243
v_mfma_f32_16x16x32_f16 v[244:247], v[184:187], v[232:235], v[244:247]
ds_read_b128 v[184:187], v251 offset:9216
v_cvt_pkrtz_f16_f32 v112, v112, v113
v_mfma_f32_16x16x32_bf16 v[116:119], v[120:123], v[40:43], v[116:119]
ds_read_b128 v[120:123], v251 offset:11264
v_cvt_pkrtz_f16_f32 v113, v114, v115
s_waitcnt vmcnt(1)
v_mfma_f32_16x16x32_bf16 v[80:83], v[18:21], v[200:203], v[80:83]
v_lshrrev_b64 v[112:113], 2, v[112:113]
v_cvt_pk_bf16_f32 v242, v244, v245
v_cvt_pk_bf16_f32 v243, v246, v247
v_mfma_f32_16x16x32_bf16 v[84:87], v[16:19], v[200:203], v[84:87]
ds_read_b128 v[244:247], v254
v_and_b32_sdwa v114, s47, v112 dst_sel:DWORD dst_unused:UNUSED_PAD src0_sel:DWORD src1_sel:WORD_1
s_waitcnt vmcnt(0)
v_mfma_f32_16x16x32_bf16 v[88:91], v[18:21], v[204:207], v[88:91]
v_cvt_pk_bf16_f32 v80, v80, v81
v_cvt_pk_bf16_f32 v81, v82, v83
v_mfma_f32_16x16x32_bf16 v[92:95], v[16:19], v[204:207], v[92:95]
v_and_b32_e64 v112, s47, v112
v_cvt_pk_bf16_f32 v82, v84, v85
v_cvt_pk_bf16_f32 v83, v86, v87
s_waitcnt lgkmcnt(5)
v_mfma_f32_16x16x32_f16 v[164:167], v[188:191], v[152:155], v[132:135]
ds_read_b128 v[84:87], v254 offset:8336
v_cvt_pk_bf16_f32 v88, v88, v89
v_cvt_pk_bf16_f32 v89, v90, v91
v_mfma_f32_16x16x32_bf16 v[108:111], v[160:163], v[48:51], 0
v_cvt_pk_bf16_f32 v90, v92, v93
v_cvt_pk_bf16_f32 v91, v94, v95
v_mfma_f32_16x16x32_f16 v[168:171], v[188:191], v[148:151], v[132:135]
ds_read_b128 v[92:95], v254 offset:16
buffer_store_dwordx4 v[128:131], v253, s[8:11], s71 offen sc1
buffer_store_dwordx4 v[136:139], v253, s[8:11], s71 offen offset:64 sc1
v_mfma_f32_16x16x32_f16 v[132:135], v[188:191], v[144:147], v[132:135]
ds_read_b128 v[188:191], v251 offset:12288
ds_read_u16_d16_hi v114, v114
v_mfma_f32_16x16x32_bf16 v[192:195], v[160:163], v[52:55], 0
ds_read_u16 v112, v112
v_and_b32_sdwa v115, s47, v113 dst_sel:DWORD dst_unused:UNUSED_PAD src0_sel:DWORD src1_sel:WORD_1
s_waitcnt lgkmcnt(5)
v_mfma_f32_16x16x32_f16 v[216:219], v[120:123], v[152:155], v[76:79]
s_setprio 0
v_and_b32_e64 v113, s47, v113
v_pk_fma_f16 v231, v230, v230, s48
v_mfma_f32_16x16x32_bf16 v[196:199], v[160:163], v[24:27], 0
ds_read_b128 v[160:163], v248 offset:28928
ds_read_u16_d16_hi v115, v115
v_mfma_f32_16x16x32_f16 v[220:223], v[120:123], v[148:151], v[76:79]
ds_read_u16 v113, v113
v_pk_mul_f16 v229, v228, v229
v_mfma_f32_16x16x32_f16 v[76:79], v[120:123], v[144:147], v[76:79]
ds_read_b128 v[120:123], v251 offset:10240
v_pk_mul_f16 v231, v230, v231
v_mfma_f32_16x16x32_bf16 v[108:111], v[124:127], v[56:59], v[108:111]
v_cvt_pkrtz_f16_f32 v116, v116, v117
v_cvt_pkrtz_f16_f32 v117, v118, v119
v_mfma_f32_16x16x32_f16 v[100:103], v[184:187], v[152:155], v[140:143]
v_lshrrev_b64 v[116:117], 2, v[116:117]
v_and_b32_sdwa v118, s47, v116 dst_sel:DWORD dst_unused:UNUSED_PAD src0_sel:DWORD src1_sel:WORD_1
v_mfma_f32_16x16x32_bf16 v[192:195], v[124:127], v[60:63], v[192:195]
v_and_b32_e64 v116, s47, v116
v_lshl_add_u64 v[210:211], v[0:1], 0, v[2:3]
v_mfma_f32_16x16x32_f16 v[104:107], v[184:187], v[148:151], v[140:143]
ds_read_u16_d16_hi v118, v118
ds_read_u16 v116, v116
v_exp_f16_sdwa v229, v229 dst_sel:WORD_0 dst_unused:UNUSED_PRESERVE src0_sel:WORD_0
v_mfma_f32_16x16x32_f16 v[140:143], v[184:187], v[144:147], v[140:143]
ds_read_b128 v[184:187], v251 offset:13312
v_exp_f16_sdwa v231, v231 dst_sel:WORD_0 dst_unused:UNUSED_PRESERVE src0_sel:WORD_0
v_mfma_f32_16x16x32_bf16 v[196:199], v[124:127], v[32:35], v[196:199]
ds_read_b128 v[124:127], v248 offset:30720
v_and_b32_sdwa v119, s47, v117 dst_sel:DWORD dst_unused:UNUSED_PAD src0_sel:DWORD src1_sel:WORD_1
s_waitcnt lgkmcnt(7)
v_mfma_f32_16x16x32_f16 v[232:235], v[188:191], v[152:155], v[84:87]
v_and_b32 v117, s47, v117
v_lshl_add_u64 v[214:215], v[4:5], 0, v[6:7]
v_mfma_f32_16x16x32_f16 v[236:239], v[188:191], v[148:151], v[84:87]
ds_read_u16_d16_hi v119, v119
ds_read_u16 v117, v117
v_mfma_f32_16x16x32_bf16 v[108:111], v[160:163], v[64:67], v[108:111]
v_exp_f16_sdwa v229, v229 dst_sel:WORD_1 dst_unused:UNUSED_PRESERVE src0_sel:WORD_1
v_mfma_f32_16x16x32_f16 v[84:87], v[188:191], v[144:147], v[84:87]
ds_read_b128 v[188:191], v251 offset:14336
v_exp_f16_sdwa v231, v231 dst_sel:WORD_1 dst_unused:UNUSED_PRESERVE src0_sel:WORD_1
v_mfma_f32_16x16x32_bf16 v[192:195], v[160:163], v[68:71], v[192:195]
v_lshl_add_u64 v[182:183], v[224:225], 0, v[226:227]
v_pk_add_f16 v229, v229, 1.0 op_sel_hi:[1,0]
s_waitcnt lgkmcnt(6)
v_mfma_f32_16x16x32_f16 v[200:203], v[120:123], v[152:155], v[244:247]
s_setprio 3
v_pk_add_f16 v231, v231, 1.0 op_sel_hi:[1,0]
v_rcp_f16_sdwa v229, v229 dst_sel:WORD_0 dst_unused:UNUSED_PRESERVE src0_sel:WORD_0
v_mfma_f32_16x16x32_f16 v[204:207], v[120:123], v[148:151], v[244:247]
v_rcp_f16_sdwa v231, v231 dst_sel:WORD_0 dst_unused:UNUSED_PRESERVE src0_sel:WORD_0
v_mfma_f32_16x16x32_bf16 v[196:199], v[160:163], v[40:43], v[196:199]
ds_read_b128 v[160:163], v248 offset:32768
v_cvt_pkrtz_f16_f32 v192, v192, v193
v_mfma_f32_16x16x32_f16 v[244:247], v[120:123], v[144:147], v[244:247]
ds_read_b128 v[120:123], v251 offset:17408
v_cvt_pkrtz_f16_f32 v193, v194, v195
s_waitcnt lgkmcnt(4)
v_mfma_f32_16x16x32_bf16 v[128:131], v[124:127], v[48:51], 0
v_lshrrev_b64 v[192:193], 2, v[192:193]
v_and_b32_sdwa v194, s47, v192 dst_sel:DWORD dst_unused:UNUSED_PAD src0_sel:DWORD src1_sel:WORD_1
v_mfma_f32_16x16x32_f16 v[4:7], v[184:187], v[152:155], v[92:95]
v_and_b32 v192, s47, v192
v_cvt_pk_f16_f32 v108, v108, v109
v_mfma_f32_16x16x32_f16 v[224:227], v[184:187], v[148:151], v[92:95]
ds_read_u16_d16_hi v194, v194
ds_read_u16 v192, v192
v_mfma_f32_16x16x32_bf16 v[136:139], v[124:127], v[52:55], 0
v_rcp_f16_sdwa v229, v229 dst_sel:WORD_1 dst_unused:UNUSED_PRESERVE src0_sel:WORD_1
v_mfma_f32_16x16x32_f16 v[92:95], v[184:187], v[144:147], v[92:95]
ds_read_b128 v[184:187], v251 offset:15360
v_cvt_pk_f16_f32 v110, v110, v111
v_mfma_f32_16x16x32_bf16 v[0:3], v[124:127], v[24:27], 0
ds_read_b128 v[124:127], v248 offset:34816
v_pk_fma_f16 v109, v108, v108, s48
s_waitcnt lgkmcnt(5)
v_mfma_f32_16x16x32_f16 v[164:167], v[188:191], v[176:179], v[164:167]
v_rcp_f16_sdwa v231, v231 dst_sel:WORD_1 dst_unused:UNUSED_PRESERVE src0_sel:WORD_1
v_mfma_f32_16x16x32_f16 v[168:171], v[188:191], v[156:159], v[168:171]
v_and_b32_sdwa v195, s47, v193 dst_sel:DWORD dst_unused:UNUSED_PAD src0_sel:DWORD src1_sel:WORD_1
v_and_b32 v193, s47, v193
v_mfma_f32_16x16x32_bf16 v[128:131], v[160:163], v[56:59], v[128:131]
ds_read_u16_d16_hi v195, v195
ds_read_u16 v193, v193
v_pk_fma_f16 v111, v110, v110, s48
v_mfma_f32_16x16x32_f16 v[132:135], v[188:191], v[172:175], v[132:135]
ds_read_b128 v[188:191], v251 offset:18432
v_pk_mul_f16 v109, v108, v109
v_pk_mul_f16 v228, v228, v229
v_mfma_f32_16x16x32_bf16 v[136:139], v[160:163], v[60:63], v[136:139]
v_pk_mul_f16 v111, v110, v111
v_cvt_pkrtz_f16_f32 v196, v196, v197
s_waitcnt lgkmcnt(6)
v_mfma_f32_16x16x32_f16 v[216:219], v[120:123], v[176:179], v[216:219]
v_cvt_pkrtz_f16_f32 v197, v198, v199
v_lshrrev_b64 v[196:197], 2, v[196:197]
v_and_b32_sdwa v198, s47, v196 dst_sel:DWORD dst_unused:UNUSED_PAD src0_sel:DWORD src1_sel:WORD_1
v_and_b32 v196, s47, v196
v_pk_mul_f16 v229, v230, v231
v_exp_f16_sdwa v109, v109 dst_sel:WORD_0 dst_unused:UNUSED_PRESERVE src0_sel:WORD_0
v_lshl_add_u64 v[112:113], v[112:113], 0, v[114:115]
v_mfma_f32_16x16x32_f16 v[220:223], v[120:123], v[156:159], v[220:223]
ds_read_u16_d16_hi v198, v198
ds_read_u16 v196, v196
s_setprio 2
v_mfma_f32_16x16x32_bf16 v[0:3], v[160:163], v[32:35], v[0:3]
ds_read_b128 v[160:163], v248 offset:30976
v_exp_f16_sdwa v111, v111 dst_sel:WORD_0 dst_unused:UNUSED_PRESERVE src0_sel:WORD_0
v_and_b32_sdwa v199, s47, v197 dst_sel:DWORD dst_unused:UNUSED_PAD src0_sel:DWORD src1_sel:WORD_1
v_and_b32_e64 v197, s47, v197
v_mfma_f32_16x16x32_f16 v[76:79], v[120:123], v[172:175], v[76:79]
ds_read_u16_d16_hi v199, v199
ds_read_u16 v197, v197
ds_read_b128 v[120:123], v251 offset:16384
s_waitcnt lgkmcnt(7)
v_mfma_f32_16x16x32_bf16 v[128:131], v[124:127], v[64:67], v[128:131]
v_exp_f16_sdwa v109, v109 dst_sel:WORD_1 dst_unused:UNUSED_PRESERVE src0_sel:WORD_1
v_mfma_f32_16x16x32_f16 v[100:103], v[184:187], v[176:179], v[100:103]
v_lshl_add_u64 v[116:117], v[116:117], 0, v[118:119]
v_exp_f16_sdwa v111, v111 dst_sel:WORD_1 dst_unused:UNUSED_PRESERVE src0_sel:WORD_1
v_mfma_f32_16x16x32_f16 v[104:107], v[184:187], v[156:159], v[104:107]
v_pk_add_f16 v109, v109, 1.0 op_sel_hi:[1,0]
v_pk_add_f16 v111, v111, 1.0 op_sel_hi:[1,0]
v_mfma_f32_16x16x32_bf16 v[136:139], v[124:127], v[68:71], v[136:139]
v_rcp_f16_sdwa v109, v109 dst_sel:WORD_0 dst_unused:UNUSED_PRESERVE src0_sel:WORD_0
v_mfma_f32_16x16x32_f16 v[140:143], v[184:187], v[172:175], v[140:143]
ds_read_b128 v[184:187], v251 offset:19456
v_rcp_f16_sdwa v111, v111 dst_sel:WORD_0 dst_unused:UNUSED_PRESERVE src0_sel:WORD_0
v_mfma_f32_16x16x32_bf16 v[0:3], v[124:127], v[40:43], v[0:3]
ds_read_b128 v[124:127], v248 offset:33024
v_cvt_pkrtz_f16_f32 v128, v128, v129
s_waitcnt lgkmcnt(6)
v_mfma_f32_16x16x32_f16 v[232:235], v[188:191], v[176:179], v[232:235]
v_cvt_pkrtz_f16_f32 v129, v130, v131
v_lshrrev_b64 v[128:129], 2, v[128:129]
v_mfma_f32_16x16x32_f16 v[236:239], v[188:191], v[156:159], v[236:239]
v_and_b32_sdwa v130, s47, v128 dst_sel:DWORD dst_unused:UNUSED_PAD src0_sel:DWORD src1_sel:WORD_1
v_and_b32_e64 v128, s47, v128
s_waitcnt lgkmcnt(4)
v_mfma_f32_16x16x32_bf16 v[144:147], v[160:163], v[48:51], 0
ds_read_u16_d16_hi v130, v130
ds_read_u16 v128, v128
v_mfma_f32_16x16x32_f16 v[84:87], v[188:191], v[172:175], v[84:87]
ds_read_b128 v[188:191], v248 offset:35072
v_rcp_f16_sdwa v109, v109 dst_sel:WORD_1 dst_unused:UNUSED_PRESERVE src0_sel:WORD_1
v_mfma_f32_16x16x32_bf16 v[148:151], v[160:163], v[52:55], 0
v_and_b32_sdwa v131, s47, v129 dst_sel:DWORD dst_unused:UNUSED_PAD src0_sel:DWORD src1_sel:WORD_1
v_and_b32_e64 v129, s47, v129
s_waitcnt lgkmcnt(5)
v_mfma_f32_16x16x32_f16 v[200:203], v[120:123], v[176:179], v[200:203]
s_setprio 1
buffer_store_dwordx4 v[240:243], v253, s[8:11], s71 offen offset:128 sc1
buffer_store_dwordx4 v[72:75], v253, s[8:11], s71 offen offset:192 sc1
ds_read_u16_d16_hi v131, v131
v_mfma_f32_16x16x32_f16 v[204:207], v[120:123], v[156:159], v[204:207]
ds_read_u16 v129, v129
v_rcp_f16_sdwa v111, v111 dst_sel:WORD_1 dst_unused:UNUSED_PRESERVE src0_sel:WORD_1
v_mfma_f32_16x16x32_bf16 v[152:155], v[160:163], v[24:27], 0
ds_read_b128 v[160:163], v251 offset:23552
v_cvt_pkrtz_f16_f32 v136, v136, v137
v_mfma_f32_16x16x32_f16 v[244:247], v[120:123], v[172:175], v[244:247]
ds_read_b128 v[120:123], v249
buffer_load_dwordx4 v[240:243], v253, s[4:7], s70 offen
buffer_load_dwordx4 v[72:75], v253, s[4:7], s70 offen offset:64
s_waitcnt lgkmcnt(7)
v_mfma_f32_16x16x32_bf16 v[144:147], v[124:127], v[56:59], v[144:147]
v_cvt_pkrtz_f16_f32 v137, v138, v139
v_lshrrev_b64 v[136:137], 2, v[136:137]
v_mfma_f32_16x16x32_f16 v[4:7], v[184:187], v[176:179], v[4:7]
ds_read_b128 v[176:179], v251 offset:20480
v_and_b32_sdwa v138, s47, v136 dst_sel:DWORD dst_unused:UNUSED_PAD src0_sel:DWORD src1_sel:WORD_1
v_and_b32 v136, s47, v136
v_mfma_f32_16x16x32_f16 v[224:227], v[184:187], v[156:159], v[224:227]
ds_read_u16_d16_hi v138, v138
ds_read_u16 v136, v136
v_pk_mul_f16 v230, v108, v109
v_mfma_f32_16x16x32_bf16 v[148:151], v[124:127], v[60:63], v[148:151]
v_and_b32_sdwa v139, s47, v137 dst_sel:DWORD dst_unused:UNUSED_PAD src0_sel:DWORD src1_sel:WORD_1
v_and_b32_e64 v137, s47, v137
v_pk_mul_f16 v231, v110, v111
v_mfma_f32_16x16x32_f16 v[92:95], v[184:187], v[172:175], v[92:95]
ds_read_u16_d16_hi v139, v139
ds_read_u16 v137, v137
ds_read_b128 v[184:187], v251 offset:24576
v_lshl_add_u64 v[114:115], v[192:193], 0, v[194:195]
v_mfma_f32_16x16x32_bf16 v[152:155], v[124:127], v[32:35], v[152:155]
ds_read_b128 v[124:127], v251 offset:21504
buffer_load_dwordx4 v[172:175], v253, s[4:7], s70 offen offset:128
buffer_load_dwordx4 v[156:159], v253, s[4:7], s70 offen offset:192
s_waitcnt lgkmcnt(6)
v_mfma_f32_16x16x32_f16 v[164:167], v[176:179], v[96:99], v[164:167]
v_cvt_pkrtz_f16_f32 v0, v0, v1
v_cvt_pkrtz_f16_f32 v1, v2, v3
v_lshrrev_b64 v[0:1], 2, v[0:1]
v_and_b32_sdwa v2, s47, v0 dst_sel:DWORD dst_unused:UNUSED_PAD src0_sel:DWORD src1_sel:WORD_1
v_and_b32 v0, s47, v0
v_mfma_f32_16x16x32_f16 v[168:171], v[176:179], v[12:15], v[168:171]
ds_read_u16_d16_hi v2, v2
ds_read_u16 v0, v0
v_and_b32_sdwa v3, s47, v1 dst_sel:DWORD dst_unused:UNUSED_PAD src0_sel:DWORD src1_sel:WORD_1
v_and_b32_e64 v1, s47, v1
v_mfma_f32_16x16x32_bf16 v[144:147], v[188:191], v[64:67], v[144:147]
ds_read_u16_d16_hi v3, v3
ds_read_u16 v1, v1
v_mfma_f32_16x16x32_f16 v[132:135], v[176:179], v[8:11], v[132:135]
ds_read_b128 v[176:179], v249 offset:2048
v_lshl_add_u64 v[118:119], v[196:197], 0, v[198:199]
v_mfma_f32_16x16x32_bf16 v[148:151], v[188:191], v[68:71], v[148:151]
s_nop 1
v_cvt_pk_f16_f32 v144, v144, v145
v_mfma_f32_16x16x32_f16 v[216:219], v[160:163], v[96:99], v[216:219]
s_setprio 0
v_cvt_pk_f16_f32 v146, v146, v147
v_pk_fma_f16 v145, v144, v144, s48
v_mfma_f32_16x16x32_f16 v[220:223], v[160:163], v[12:15], v[220:223]
v_cvt_pkrtz_f16_f32 v148, v148, v149
v_cvt_pkrtz_f16_f32 v149, v150, v151
v_mfma_f32_16x16x32_bf16 v[152:155], v[188:191], v[40:43], v[152:155]
ds_read_b128 v[188:191], v251 offset:22528
v_lshrrev_b64 v[148:149], 2, v[148:149]
v_mfma_f32_16x16x32_f16 v[76:79], v[160:163], v[8:11], v[76:79]
ds_read_b128 v[160:163], v251 offset:25600
v_and_b32_sdwa v150, s47, v148 dst_sel:DWORD dst_unused:UNUSED_PAD src0_sel:DWORD src1_sel:WORD_1
v_mfma_f32_16x16x32_bf16 v[108:111], v[120:123], v[48:51], 0
v_and_b32 v148, s47, v148
v_and_b32_sdwa v151, s47, v149 dst_sel:DWORD dst_unused:UNUSED_PAD src0_sel:DWORD src1_sel:WORD_1
s_waitcnt lgkmcnt(6)
v_mfma_f32_16x16x32_f16 v[100:103], v[124:127], v[96:99], v[100:103]
ds_read_u16_d16_hi v150, v150
ds_read_u16 v148, v148
v_mfma_f32_16x16x32_f16 v[104:107], v[124:127], v[12:15], v[104:107]
v_and_b32_e64 v149, s47, v149
v_pk_fma_f16 v147, v146, v146, s48
v_mfma_f32_16x16x32_bf16 v[192:195], v[120:123], v[52:55], 0
ds_read_u16_d16_hi v151, v151
ds_read_u16 v149, v149
v_mfma_f32_16x16x32_f16 v[140:143], v[124:127], v[8:11], v[140:143]
ds_read_b128 v[124:127], v251 offset:26624
v_pk_mul_f16 v145, v144, v145
v_mfma_f32_16x16x32_f16 v[232:235], v[184:187], v[96:99], v[232:235]
v_pk_mul_f16 v147, v146, v147
v_cvt_pkrtz_f16_f32 v152, v152, v153
v_mfma_f32_16x16x32_bf16 v[196:199], v[120:123], v[24:27], 0
ds_read_b128 v[120:123], v249 offset:4096
v_cvt_pkrtz_f16_f32 v153, v154, v155
v_mfma_f32_16x16x32_f16 v[236:239], v[184:187], v[12:15], v[236:239]
v_lshrrev_b64 v[152:153], 2, v[152:153]
v_and_b32_sdwa v154, s47, v152 dst_sel:DWORD dst_unused:UNUSED_PAD src0_sel:DWORD src1_sel:WORD_1
s_waitcnt lgkmcnt(7)
v_mfma_f32_16x16x32_bf16 v[108:111], v[176:179], v[56:59], v[108:111]
v_and_b32 v152, s47, v152
v_lshl_add_u64 v[128:129], v[128:129], 0, v[130:131]
v_mfma_f32_16x16x32_f16 v[84:87], v[184:187], v[8:11], v[84:87]
ds_read_b128 v[184:187], v249 offset:256
ds_read_u16_d16_hi v154, v154
v_mfma_f32_16x16x32_f16 v[200:203], v[188:191], v[96:99], v[200:203]
s_setprio 3
ds_read_u16 v152, v152
v_exp_f16_sdwa v145, v145 dst_sel:WORD_0 dst_unused:UNUSED_PRESERVE src0_sel:WORD_0
v_mfma_f32_16x16x32_bf16 v[192:195], v[176:179], v[60:63], v[192:195]
v_exp_f16_sdwa v147, v147 dst_sel:WORD_0 dst_unused:UNUSED_PRESERVE src0_sel:WORD_0
v_mfma_f32_16x16x32_f16 v[204:207], v[188:191], v[12:15], v[204:207]
v_and_b32_sdwa v155, s47, v153 dst_sel:DWORD dst_unused:UNUSED_PAD src0_sel:DWORD src1_sel:WORD_1
v_and_b32 v153, s47, v153
v_mfma_f32_16x16x32_bf16 v[196:199], v[176:179], v[32:35], v[196:199]
ds_read_b128 v[176:179], v251 offset:29696
ds_read_u16_d16_hi v155, v155
v_mfma_f32_16x16x32_f16 v[244:247], v[188:191], v[8:11], v[244:247]
ds_read_b128 v[188:191], v251 offset:27648
ds_read_u16 v153, v153
s_waitcnt lgkmcnt(8)
v_mfma_f32_16x16x32_f16 v[4:7], v[160:163], v[96:99], v[4:7]
v_lshl_add_u64 v[136:137], v[136:137], 0, v[138:139]
v_exp_f16_sdwa v145, v145 dst_sel:WORD_1 dst_unused:UNUSED_PRESERVE src0_sel:WORD_1
s_waitcnt lgkmcnt(7)
v_mfma_f32_16x16x32_bf16 v[108:111], v[120:123], v[64:67], v[108:111]
v_exp_f16_sdwa v147, v147 dst_sel:WORD_1 dst_unused:UNUSED_PRESERVE src0_sel:WORD_1
v_mfma_f32_16x16x32_f16 v[224:227], v[160:163], v[12:15], v[224:227]
v_lshl_add_u64 v[0:1], v[0:1], 0, v[2:3]
v_pk_add_f16 v145, v145, 1.0 op_sel_hi:[1,0]
v_mfma_f32_16x16x32_bf16 v[192:195], v[120:123], v[68:71], v[192:195]
v_pk_add_f16 v147, v147, 1.0 op_sel_hi:[1,0]
v_rcp_f16_sdwa v145, v145 dst_sel:WORD_0 dst_unused:UNUSED_PRESERVE src0_sel:WORD_0
v_mfma_f32_16x16x32_f16 v[92:95], v[160:163], v[8:11], v[92:95]
ds_read_b128 v[160:163], v249 offset:2304
v_rcp_f16_sdwa v147, v147 dst_sel:WORD_0 dst_unused:UNUSED_PRESERVE src0_sel:WORD_0
v_mfma_f32_16x16x32_f16 v[164:167], v[124:127], v[180:183], v[164:167]
s_nop 1
v_cvt_pkrtz_f16_f32 v192, v192, v193
v_cvt_pkrtz_f16_f32 v193, v194, v195
v_mfma_f32_16x16x32_bf16 v[196:199], v[120:123], v[40:43], v[196:199]
ds_read_b128 v[120:123], v251 offset:30720
v_lshrrev_b64 v[192:193], 2, v[192:193]
v_mfma_f32_16x16x32_f16 v[168:171], v[124:127], v[212:215], v[168:171]
v_and_b32_sdwa v194, s47, v192 dst_sel:DWORD dst_unused:UNUSED_PAD src0_sel:DWORD src1_sel:WORD_1
v_and_b32 v192, s47, v192
s_waitcnt lgkmcnt(3)
v_mfma_f32_16x16x32_bf16 v[8:11], v[184:187], v[48:51], 0
ds_read_u16_d16_hi v194, v194
ds_read_u16 v192, v192
v_mfma_f32_16x16x32_f16 v[132:135], v[124:127], v[208:211], v[132:135]
ds_read_b128 v[124:127], v249 offset:4352
s_setprio 2
v_cvt_pk_f16_f32 v108, v108, v109
v_mfma_f32_16x16x32_f16 v[216:219], v[176:179], v[180:183], v[216:219]
v_rcp_f16_sdwa v145, v145 dst_sel:WORD_1 dst_unused:UNUSED_PRESERVE src0_sel:WORD_1
v_mfma_f32_16x16x32_bf16 v[12:15], v[184:187], v[52:55], 0
v_cvt_pk_f16_f32 v110, v110, v111
v_pk_fma_f16 v109, v108, v108, s48
v_mfma_f32_16x16x32_f16 v[220:223], v[176:179], v[212:215], v[220:223]
v_rcp_f16_sdwa v147, v147 dst_sel:WORD_1 dst_unused:UNUSED_PRESERVE src0_sel:WORD_1
v_mfma_f32_16x16x32_bf16 v[96:99], v[184:187], v[24:27], 0
ds_read_b128 v[184:187], v251 offset:28672
v_and_b32_sdwa v195, s47, v193 dst_sel:DWORD dst_unused:UNUSED_PAD src0_sel:DWORD src1_sel:WORD_1
v_mfma_f32_16x16x32_f16 v[76:79], v[176:179], v[208:211], v[76:79]
ds_read_b128 v[176:179], v251 offset:31744
v_and_b32 v193, s47, v193
v_mfma_f32_16x16x32_f16 v[100:103], v[188:191], v[180:183], v[100:103]
buffer_store_dwordx4 v[80:83], v253, s[8:11], s71 offen offset:256 sc1
buffer_store_dwordx4 v[88:91], v253, s[8:11], s71 offen offset:320 sc1
buffer_load_dwordx4 v[80:83], v253, s[4:7], s70 offen offset:256
buffer_load_dwordx4 v[88:91], v253, s[4:7], s70 offen offset:320
s_waitcnt lgkmcnt(5)
v_mfma_f32_16x16x32_bf16 v[8:11], v[160:163], v[56:59], v[8:11]
ds_read_u16_d16_hi v195, v195
ds_read_u16 v193, v193
v_pk_fma_f16 v111, v110, v110, s48
v_mfma_f32_16x16x32_f16 v[104:107], v[188:191], v[212:215], v[104:107]
v_pk_mul_f16 v109, v108, v109
v_pk_mul_f16 v130, v144, v145
v_mfma_f32_16x16x32_bf16 v[12:15], v[160:163], v[60:63], v[12:15]
v_pk_mul_f16 v111, v110, v111
v_cvt_pkrtz_f16_f32 v196, v196, v197
v_mfma_f32_16x16x32_f16 v[140:143], v[188:191], v[208:211], v[140:143]
ds_read_b128 v[188:191], v249 offset:6144
v_cvt_pkrtz_f16_f32 v197, v198, v199
v_lshrrev_b64 v[196:197], 2, v[196:197]
v_and_b32_sdwa v198, s47, v196 dst_sel:DWORD dst_unused:UNUSED_PAD src0_sel:DWORD src1_sel:WORD_1
v_and_b32_e64 v196, s47, v196
v_pk_mul_f16 v131, v146, v147
v_exp_f16_sdwa v109, v109 dst_sel:WORD_0 dst_unused:UNUSED_PRESERVE src0_sel:WORD_0
v_mfma_f32_16x16x32_f16 v[232:235], v[120:123], v[180:183], v[232:235]
ds_read_u16_d16_hi v198, v198
ds_read_u16 v196, v196
v_lshl_add_u64 v[138:139], v[148:149], 0, v[150:151]
v_mfma_f32_16x16x32_bf16 v[96:99], v[160:163], v[32:35], v[96:99]
ds_read_b128 v[160:163], v251 offset:32768
v_exp_f16_sdwa v111, v111 dst_sel:WORD_0 dst_unused:UNUSED_PRESERVE src0_sel:WORD_0
v_mfma_f32_16x16x32_f16 v[236:239], v[120:123], v[212:215], v[236:239]
v_and_b32_sdwa v199, s47, v197 dst_sel:DWORD dst_unused:UNUSED_PAD src0_sel:DWORD src1_sel:WORD_1
v_and_b32_e64 v197, s47, v197
s_waitcnt lgkmcnt(5)
v_mfma_f32_16x16x32_bf16 v[8:11], v[124:127], v[64:67], v[8:11]
ds_read_u16_d16_hi v199, v199
ds_read_u16 v197, v197
v_mfma_f32_16x16x32_f16 v[84:87], v[120:123], v[208:211], v[84:87]
ds_read_b128 v[120:123], v249 offset:8192
v_exp_f16_sdwa v109, v109 dst_sel:WORD_1 dst_unused:UNUSED_PRESERVE src0_sel:WORD_1
s_setprio 1
v_mfma_f32_16x16x32_f16 v[200:203], v[184:187], v[180:183], v[200:203]
v_lshl_add_u64 v[2:3], v[152:153], 0, v[154:155]
v_exp_f16_sdwa v111, v111 dst_sel:WORD_1 dst_unused:UNUSED_PRESERVE src0_sel:WORD_1
v_mfma_f32_16x16x32_bf16 v[12:15], v[124:127], v[68:71], v[12:15]
v_pk_add_f16 v109, v109, 1.0 op_sel_hi:[1,0]
v_pk_add_f16 v111, v111, 1.0 op_sel_hi:[1,0]
v_mfma_f32_16x16x32_f16 v[204:207], v[184:187], v[212:215], v[204:207]
v_rcp_f16_sdwa v109, v109 dst_sel:WORD_0 dst_unused:UNUSED_PRESERVE src0_sel:WORD_0
v_mfma_f32_16x16x32_bf16 v[96:99], v[124:127], v[40:43], v[96:99]
ds_read_b128 v[124:127], v251 offset:35840
v_rcp_f16_sdwa v111, v111 dst_sel:WORD_0 dst_unused:UNUSED_PRESERVE src0_sel:WORD_0
v_mfma_f32_16x16x32_f16 v[244:247], v[184:187], v[208:211], v[244:247]
ds_read_b128 v[184:187], v251 offset:33792
v_cvt_pkrtz_f16_f32 v8, v8, v9
v_mfma_f32_16x16x32_f16 v[4:7], v[176:179], v[180:183], v[4:7]
v_cvt_pkrtz_f16_f32 v9, v10, v11
v_lshrrev_b64 v[8:9], 2, v[8:9]
s_waitcnt lgkmcnt(4)
v_mfma_f32_16x16x32_bf16 v[144:147], v[188:191], v[48:51], 0
v_and_b32_sdwa v10, s47, v8 dst_sel:DWORD dst_unused:UNUSED_PAD src0_sel:DWORD src1_sel:WORD_1
v_and_b32 v8, s47, v8
v_mfma_f32_16x16x32_f16 v[224:227], v[176:179], v[212:215], v[224:227]
ds_read_u16_d16_hi v10, v10
ds_read_u16 v8, v8
v_mfma_f32_16x16x32_bf16 v[148:151], v[188:191], v[52:55], 0
v_rcp_f16_sdwa v109, v109 dst_sel:WORD_1 dst_unused:UNUSED_PRESERVE src0_sel:WORD_1
v_mfma_f32_16x16x32_f16 v[92:95], v[176:179], v[208:211], v[92:95]
ds_read_b128 v[176:179], v249 offset:10240
v_and_b32_sdwa v11, s47, v9 dst_sel:DWORD dst_unused:UNUSED_PAD src0_sel:DWORD src1_sel:WORD_1
v_mfma_f32_16x16x32_f16 v[164:167], v[160:163], v[116:119], v[164:167]
v_and_b32_e64 v9, s47, v9
v_rcp_f16_sdwa v111, v111 dst_sel:WORD_1 dst_unused:UNUSED_PRESERVE src0_sel:WORD_1
v_mfma_f32_16x16x32_bf16 v[152:155], v[188:191], v[24:27], 0
ds_read_b128 v[188:191], v251 offset:36864
ds_read_u16_d16_hi v11, v11
v_mfma_f32_16x16x32_f16 v[168:171], v[160:163], v[112:115], v[168:171]
ds_read_u16 v9, v9
v_cvt_pkrtz_f16_f32 v12, v12, v13
s_waitcnt lgkmcnt(6)
v_mfma_f32_16x16x32_bf16 v[144:147], v[120:123], v[56:59], v[144:147]
v_cvt_pkrtz_f16_f32 v13, v14, v15
v_lshrrev_b64 v[12:13], 2, v[12:13]
v_mfma_f32_16x16x32_f16 v[132:135], v[160:163], v[228:231], v[132:135]
ds_read_b128 v[160:163], v249 offset:6400
v_and_b32_sdwa v14, s47, v12 dst_sel:DWORD dst_unused:UNUSED_PAD src0_sel:DWORD src1_sel:WORD_1
v_and_b32 v12, s47, v12
v_mfma_f32_16x16x32_f16 v[216:219], v[124:127], v[116:119], v[216:219]
ds_read_u16_d16_hi v14, v14
ds_read_u16 v12, v12
s_setprio 0
v_pk_mul_f16 v108, v108, v109
v_mfma_f32_16x16x32_bf16 v[148:151], v[120:123], v[60:63], v[148:151]
v_and_b32_sdwa v15, s47, v13 dst_sel:DWORD dst_unused:UNUSED_PAD src0_sel:DWORD src1_sel:WORD_1
v_and_b32 v13, s47, v13
v_pk_mul_f16 v109, v110, v111
v_mfma_f32_16x16x32_f16 v[220:223], v[124:127], v[112:115], v[220:223]
ds_read_u16_d16_hi v15, v15
ds_read_u16 v13, v13
v_lshl_add_u64 v[192:193], v[192:193], 0, v[194:195]
v_mfma_f32_16x16x32_bf16 v[152:155], v[120:123], v[32:35], v[152:155]
ds_read_b128 v[120:123], v251 offset:34816
v_cvt_pkrtz_f16_f32 v96, v96, v97
v_mfma_f32_16x16x32_f16 v[76:79], v[124:127], v[228:231], v[76:79]
ds_read_b128 v[124:127], v251 offset:37888
v_cvt_pkrtz_f16_f32 v97, v98, v99
v_lshrrev_b64 v[96:97], 2, v[96:97]
v_and_b32_sdwa v98, s47, v96 dst_sel:DWORD dst_unused:UNUSED_PAD src0_sel:DWORD src1_sel:WORD_1
v_and_b32_e64 v96, s47, v96
v_mfma_f32_16x16x32_f16 v[100:103], v[184:187], v[116:119], v[100:103]
ds_read_u16_d16_hi v98, v98
ds_read_u16 v96, v96
v_and_b32_sdwa v99, s47, v97 dst_sel:DWORD dst_unused:UNUSED_PAD src0_sel:DWORD src1_sel:WORD_1
v_and_b32 v97, s47, v97
s_waitcnt lgkmcnt(8)
v_mfma_f32_16x16x32_bf16 v[144:147], v[176:179], v[64:67], v[144:147]
ds_read_u16_d16_hi v99, v99
ds_read_u16 v97, v97
v_mfma_f32_16x16x32_f16 v[104:107], v[184:187], v[112:115], v[104:107]
v_lshl_add_u64 v[196:197], v[196:197], 0, v[198:199]
v_mfma_f32_16x16x32_f16 v[140:143], v[184:187], v[228:231], v[140:143]
ds_read_b128 v[184:187], v249 offset:8448
s_nop 1
v_cvt_pk_f16_f32 v144, v144, v145
v_mfma_f32_16x16x32_bf16 v[148:151], v[176:179], v[68:71], v[148:151]
v_cvt_pk_f16_f32 v146, v146, v147
v_pk_fma_f16 v145, v144, v144, s48
v_mfma_f32_16x16x32_f16 v[232:235], v[188:191], v[116:119], v[232:235]
v_pk_fma_f16 v147, v146, v146, s48
v_pk_mul_f16 v145, v144, v145
v_mfma_f32_16x16x32_bf16 v[152:155], v[176:179], v[40:43], v[152:155]
ds_read_b128 v[176:179], v251 offset:38912
s_nop 0
v_cvt_pkrtz_f16_f32 v148, v148, v149
v_mfma_f32_16x16x32_f16 v[236:239], v[188:191], v[112:115], v[236:239]
v_cvt_pkrtz_f16_f32 v149, v150, v151
v_lshrrev_b64 v[148:149], 2, v[148:149]
v_mfma_f32_16x16x32_f16 v[84:87], v[188:191], v[228:231], v[84:87]
ds_read_b128 v[188:191], v249 offset:10496
v_and_b32_sdwa v150, s47, v148 dst_sel:DWORD dst_unused:UNUSED_PAD src0_sel:DWORD src1_sel:WORD_1
v_mfma_f32_16x16x32_bf16 v[208:211], v[160:163], v[48:51], 0
s_setprio 3
v_and_b32_e64 v148, s47, v148
v_and_b32_sdwa v151, s47, v149 dst_sel:DWORD dst_unused:UNUSED_PAD src0_sel:DWORD src1_sel:WORD_1
s_waitcnt lgkmcnt(6)
v_mfma_f32_16x16x32_f16 v[200:203], v[120:123], v[116:119], v[200:203]
ds_read_u16_d16_hi v150, v150
ds_read_u16 v148, v148
v_mfma_f32_16x16x32_bf16 v[212:215], v[160:163], v[52:55], 0
v_and_b32_e64 v149, s47, v149
v_pk_mul_f16 v147, v146, v147
v_mfma_f32_16x16x32_f16 v[204:207], v[120:123], v[112:115], v[204:207]
ds_read_u16_d16_hi v151, v151
ds_read_u16 v149, v149
v_mfma_f32_16x16x32_f16 v[244:247], v[120:123], v[228:231], v[244:247]
ds_read_b128 v[120:123], v251 offset:39936
v_cvt_pkrtz_f16_f32 v152, v152, v153
v_mfma_f32_16x16x32_bf16 v[180:183], v[160:163], v[24:27], 0
ds_read_b128 v[160:163], v251 offset:41984
v_cvt_pkrtz_f16_f32 v153, v154, v155
v_mfma_f32_16x16x32_f16 v[4:7], v[124:127], v[116:119], v[4:7]
v_lshrrev_b64 v[152:153], 2, v[152:153]
v_and_b32_sdwa v154, s47, v152 dst_sel:DWORD dst_unused:UNUSED_PAD src0_sel:DWORD src1_sel:WORD_1
s_waitcnt lgkmcnt(7)
v_mfma_f32_16x16x32_bf16 v[208:211], v[184:187], v[56:59], v[208:211]
v_and_b32 v152, s47, v152
v_lshl_add_u64 v[110:111], v[8:9], 0, v[10:11]
v_mfma_f32_16x16x32_f16 v[224:227], v[124:127], v[112:115], v[224:227]
ds_read_u16_d16_hi v154, v154
ds_read_u16 v152, v152
v_mfma_f32_16x16x32_f16 v[92:95], v[124:127], v[228:231], v[92:95]
ds_read_b128 v[124:127], v249 offset:12288
v_exp_f16_sdwa v145, v145 dst_sel:WORD_0 dst_unused:UNUSED_PRESERVE src0_sel:WORD_0
v_mfma_f32_16x16x32_bf16 v[212:215], v[184:187], v[60:63], v[212:215]
v_exp_f16_sdwa v147, v147 dst_sel:WORD_0 dst_unused:UNUSED_PRESERVE src0_sel:WORD_0
s_waitcnt vmcnt(7)
v_mfma_f32_16x16x32_bf16 v[132:135], v[18:21], v[240:243], v[132:135]
v_and_b32_sdwa v155, s47, v153 dst_sel:DWORD dst_unused:UNUSED_PAD src0_sel:DWORD src1_sel:WORD_1
v_and_b32_e64 v153, s47, v153
v_mfma_f32_16x16x32_bf16 v[76:79], v[16:19], v[240:243], v[76:79]
ds_read_u16_d16_hi v155, v155
ds_read_u16 v153, v153
s_waitcnt vmcnt(6)
v_mfma_f32_16x16x32_bf16 v[140:143], v[18:21], v[72:75], v[140:143]
v_lshl_add_u64 v[194:195], v[12:13], 0, v[14:15]
v_exp_f16_sdwa v145, v145 dst_sel:WORD_1 dst_unused:UNUSED_PRESERVE src0_sel:WORD_1
v_mfma_f32_16x16x32_bf16 v[84:87], v[16:19], v[72:75], v[84:87]
buffer_load_dwordx4 v[228:231], v253, s[4:7], s69 offen
buffer_load_dwordx4 v[112:115], v253, s[4:7], s69 offen offset:64
v_exp_f16_sdwa v147, v147 dst_sel:WORD_1 dst_unused:UNUSED_PRESERVE src0_sel:WORD_1
v_mfma_f32_16x16x32_f16 v[164:167], v[176:179], v[0:3], v[164:167]
v_lshl_add_u64 v[198:199], v[96:97], 0, v[98:99]
v_pk_add_f16 v145, v145, 1.0 op_sel_hi:[1,0]
v_mfma_f32_16x16x32_bf16 v[180:183], v[184:187], v[32:35], v[180:183]
ds_read_b128 v[184:187], v251 offset:43008
v_pk_add_f16 v147, v147, 1.0 op_sel_hi:[1,0]
v_mfma_f32_16x16x32_f16 v[168:171], v[176:179], v[136:139], v[168:171]
v_rcp_f16_sdwa v145, v145 dst_sel:WORD_0 dst_unused:UNUSED_PRESERVE src0_sel:WORD_0
v_mfma_f32_16x16x32_f16 v[132:135], v[176:179], v[128:131], v[132:135]
ds_read_b128 v[176:179], v249 offset:14336
v_rcp_f16_sdwa v147, v147 dst_sel:WORD_0 dst_unused:UNUSED_PRESERVE src0_sel:WORD_0
s_waitcnt lgkmcnt(4)
v_mfma_f32_16x16x32_bf16 v[208:211], v[188:191], v[64:67], v[208:211]
s_setprio 2
v_rcp_f16_sdwa v145, v145 dst_sel:WORD_1 dst_unused:UNUSED_PRESERVE src0_sel:WORD_1
v_mfma_f32_16x16x32_f16 v[216:219], v[160:163], v[0:3], v[216:219]
v_rcp_f16_sdwa v147, v147 dst_sel:WORD_1 dst_unused:UNUSED_PRESERVE src0_sel:WORD_1
v_mfma_f32_16x16x32_bf16 v[212:215], v[188:191], v[68:71], v[212:215]
s_nop 2
v_cvt_pk_f16_f32 v208, v208, v209
v_cvt_pk_f16_f32 v210, v210, v211
v_mfma_f32_16x16x32_f16 v[220:223], v[160:163], v[136:139], v[220:223]
v_pk_fma_f16 v209, v208, v208, s48
v_pk_fma_f16 v211, v210, v210, s48
v_mfma_f32_16x16x32_f16 v[76:79], v[160:163], v[128:131], v[76:79]
ds_read_b128 v[160:163], v251 offset:44032
v_cvt_pkrtz_f16_f32 v212, v212, v213
v_mfma_f32_16x16x32_bf16 v[180:183], v[188:191], v[40:43], v[180:183]
ds_read_b128 v[188:191], v251 offset:40960
v_cvt_pkrtz_f16_f32 v213, v214, v215
v_mfma_f32_16x16x32_f16 v[100:103], v[120:123], v[0:3], v[100:103]
v_lshrrev_b64 v[212:213], 2, v[212:213]
v_and_b32_sdwa v214, s47, v212 dst_sel:DWORD dst_unused:UNUSED_PAD src0_sel:DWORD src1_sel:WORD_1
v_mfma_f32_16x16x32_bf16 v[116:119], v[124:127], v[48:51], 0
v_and_b32 v212, s47, v212
v_and_b32_sdwa v215, s47, v213 dst_sel:DWORD dst_unused:UNUSED_PAD src0_sel:DWORD src1_sel:WORD_1
v_mfma_f32_16x16x32_f16 v[104:107], v[120:123], v[136:139], v[104:107]
ds_read_u16_d16_hi v214, v214
ds_read_u16 v212, v212
v_mfma_f32_16x16x32_f16 v[140:143], v[120:123], v[128:131], v[140:143]
ds_read_b128 v[120:123], v249 offset:16384
v_and_b32 v213, s47, v213
v_mfma_f32_16x16x32_bf16 v[240:243], v[124:127], v[52:55], 0
ds_read_u16_d16_hi v215, v215
ds_read_u16 v213, v213
s_waitcnt lgkmcnt(7)
v_mfma_f32_16x16x32_f16 v[232:235], v[184:187], v[0:3], v[232:235]
v_pk_mul_f16 v209, v208, v209
v_pk_mul_f16 v144, v144, v145
v_mfma_f32_16x16x32_bf16 v[72:75], v[124:127], v[24:27], 0
ds_read_b128 v[124:127], v251 offset:45056
v_pk_mul_f16 v211, v210, v211
v_mfma_f32_16x16x32_f16 v[236:239], v[184:187], v[136:139], v[236:239]
v_cvt_pkrtz_f16_f32 v180, v180, v181
v_cvt_pkrtz_f16_f32 v181, v182, v183
v_mfma_f32_16x16x32_f16 v[84:87], v[184:187], v[128:131], v[84:87]
ds_read_b128 v[184:187], v249 offset:12544
v_lshrrev_b64 v[180:181], 2, v[180:181]
v_mfma_f32_16x16x32_bf16 v[116:119], v[176:179], v[56:59], v[116:119]
s_setprio 1
v_and_b32_sdwa v182, s47, v180 dst_sel:DWORD dst_unused:UNUSED_PAD src0_sel:DWORD src1_sel:WORD_1
v_and_b32_e64 v180, s47, v180
s_waitcnt lgkmcnt(7)
v_mfma_f32_16x16x32_f16 v[200:203], v[188:191], v[0:3], v[200:203]
ds_read_u16_d16_hi v182, v182
ds_read_u16 v180, v180
v_mfma_f32_16x16x32_bf16 v[240:243], v[176:179], v[60:63], v[240:243]
v_pk_mul_f16 v145, v146, v147
v_exp_f16_sdwa v209, v209 dst_sel:WORD_0 dst_unused:UNUSED_PRESERVE src0_sel:WORD_0
v_mfma_f32_16x16x32_f16 v[204:207], v[188:191], v[136:139], v[204:207]
v_lshl_add_u64 v[148:149], v[148:149], 0, v[150:151]
v_exp_f16_sdwa v211, v211 dst_sel:WORD_0 dst_unused:UNUSED_PRESERVE src0_sel:WORD_0
v_mfma_f32_16x16x32_f16 v[244:247], v[188:191], v[128:131], v[244:247]
ds_read_b128 v[188:191], v251 offset:46080
v_and_b32_sdwa v183, s47, v181 dst_sel:DWORD dst_unused:UNUSED_PAD src0_sel:DWORD src1_sel:WORD_1
v_mfma_f32_16x16x32_bf16 v[72:75], v[176:179], v[32:35], v[72:75]
ds_read_b128 v[176:179], v251 offset:48128
v_and_b32 v181, s47, v181
v_mfma_f32_16x16x32_f16 v[4:7], v[160:163], v[0:3], v[4:7]
ds_read_u16_d16_hi v183, v183
ds_read_u16 v181, v181
s_waitcnt lgkmcnt(8)
v_mfma_f32_16x16x32_bf16 v[116:119], v[120:123], v[64:67], v[116:119]
v_exp_f16_sdwa v209, v209 dst_sel:WORD_1 dst_unused:UNUSED_PRESERVE src0_sel:WORD_1
v_mfma_f32_16x16x32_f16 v[224:227], v[160:163], v[136:139], v[224:227]
v_lshl_add_u64 v[152:153], v[152:153], 0, v[154:155]
v_exp_f16_sdwa v211, v211 dst_sel:WORD_1 dst_unused:UNUSED_PRESERVE src0_sel:WORD_1
v_mfma_f32_16x16x32_f16 v[92:95], v[160:163], v[128:131], v[92:95]
ds_read_b128 v[160:163], v249 offset:14592
v_pk_add_f16 v209, v209, 1.0 op_sel_hi:[1,0]
v_mfma_f32_16x16x32_bf16 v[240:243], v[120:123], v[68:71], v[240:243]
v_pk_add_f16 v211, v211, 1.0 op_sel_hi:[1,0]
v_rcp_f16_sdwa v209, v209 dst_sel:WORD_0 dst_unused:UNUSED_PRESERVE src0_sel:WORD_0
s_waitcnt vmcnt(7)
v_mfma_f32_16x16x32_bf16 v[244:247], v[18:21], v[172:175], v[244:247]
v_rcp_f16_sdwa v211, v211 dst_sel:WORD_0 dst_unused:UNUSED_PRESERVE src0_sel:WORD_0
v_mfma_f32_16x16x32_bf16 v[92:95], v[16:19], v[172:175], v[92:95]
v_cvt_pkrtz_f16_f32 v116, v116, v117
v_cvt_pkrtz_f16_f32 v117, v118, v119
s_waitcnt vmcnt(6)
v_mfma_f32_16x16x32_bf16 v[168:171], v[18:21], v[156:159], v[168:171]
v_lshrrev_b64 v[116:117], 2, v[116:117]
v_and_b32_sdwa v118, s47, v116 dst_sel:DWORD dst_unused:UNUSED_PAD src0_sel:DWORD src1_sel:WORD_1
v_mfma_f32_16x16x32_bf16 v[220:223], v[16:19], v[156:159], v[220:223]
v_and_b32 v116, s47, v116
v_rcp_f16_sdwa v209, v209 dst_sel:WORD_1 dst_unused:UNUSED_PRESERVE src0_sel:WORD_1
s_waitcnt lgkmcnt(1)
v_mfma_f32_16x16x32_f16 v[164:167], v[124:127], v[196:199], v[164:167]
ds_read_u16_d16_hi v118, v118
ds_read_u16 v116, v116
v_mfma_f32_16x16x32_bf16 v[72:75], v[120:123], v[40:43], v[72:75]
ds_read_b128 v[120:123], v251 offset:49152
v_and_b32_sdwa v119, s47, v117 dst_sel:DWORD dst_unused:UNUSED_PAD src0_sel:DWORD src1_sel:WORD_1
v_mfma_f32_16x16x32_f16 v[168:171], v[124:127], v[192:195], v[168:171]
v_and_b32 v117, s47, v117
v_rcp_f16_sdwa v211, v211 dst_sel:WORD_1 dst_unused:UNUSED_PRESERVE src0_sel:WORD_1
v_mfma_f32_16x16x32_f16 v[132:135], v[124:127], v[108:111], v[132:135]
ds_read_b128 v[124:127], v249 offset:16640
ds_read_u16_d16_hi v119, v119
v_mfma_f32_16x16x32_bf16 v[8:11], v[184:187], v[48:51], 0
s_setprio 0
ds_read_u16 v117, v117
v_cvt_pkrtz_f16_f32 v240, v240, v241
v_mfma_f32_16x16x32_f16 v[216:219], v[176:179], v[196:199], v[216:219]
v_cvt_pkrtz_f16_f32 v241, v242, v243
v_lshrrev_b64 v[240:241], 2, v[240:241]
v_mfma_f32_16x16x32_bf16 v[12:15], v[184:187], v[52:55], 0
v_and_b32_sdwa v242, s47, v240 dst_sel:DWORD dst_unused:UNUSED_PAD src0_sel:DWORD src1_sel:WORD_1
v_and_b32_e64 v240, s47, v240
v_mfma_f32_16x16x32_f16 v[220:223], v[176:179], v[192:195], v[220:223]
ds_read_u16_d16_hi v242, v242
ds_read_u16 v240, v240
v_mfma_f32_16x16x32_f16 v[76:79], v[176:179], v[108:111], v[76:79]
ds_read_b128 v[176:179], v251 offset:50176
v_pk_mul_f16 v146, v208, v209
v_mfma_f32_16x16x32_bf16 v[96:99], v[184:187], v[24:27], 0
ds_read_b128 v[184:187], v251 offset:47104
v_and_b32_sdwa v243, s47, v241 dst_sel:DWORD dst_unused:UNUSED_PAD src0_sel:DWORD src1_sel:WORD_1
v_mfma_f32_16x16x32_f16 v[100:103], v[188:191], v[196:199], v[100:103]
v_and_b32 v241, s47, v241
v_pk_mul_f16 v147, v210, v211
v_mfma_f32_16x16x32_f16 v[104:107], v[188:191], v[192:195], v[104:107]
ds_read_u16_d16_hi v243, v243
ds_read_u16 v241, v241
s_waitcnt lgkmcnt(8)
v_mfma_f32_16x16x32_bf16 v[8:11], v[160:163], v[56:59], v[8:11]
v_lshl_add_u64 v[150:151], v[212:213], 0, v[214:215]
v_cvt_pkrtz_f16_f32 v72, v72, v73
v_mfma_f32_16x16x32_f16 v[140:143], v[188:191], v[108:111], v[140:143]
ds_read_b128 v[188:191], v249 offset:18432
v_cvt_pkrtz_f16_f32 v73, v74, v75
v_mfma_f32_16x16x32_bf16 v[12:15], v[160:163], v[60:63], v[12:15]
v_lshrrev_b64 v[72:73], 2, v[72:73]
v_and_b32_sdwa v74, s47, v72 dst_sel:DWORD dst_unused:UNUSED_PAD src0_sel:DWORD src1_sel:WORD_1
v_mfma_f32_16x16x32_f16 v[232:235], v[120:123], v[196:199], v[232:235]
v_and_b32_e64 v72, s47, v72
v_and_b32_sdwa v75, s47, v73 dst_sel:DWORD dst_unused:UNUSED_PAD src0_sel:DWORD src1_sel:WORD_1
v_mfma_f32_16x16x32_f16 v[236:239], v[120:123], v[192:195], v[236:239]
ds_read_u16_d16_hi v74, v74
ds_read_u16 v72, v72
v_mfma_f32_16x16x32_bf16 v[96:99], v[160:163], v[32:35], v[96:99]
ds_read_b128 v[160:163], v251 offset:51200
v_and_b32_e64 v73, s47, v73
v_mfma_f32_16x16x32_f16 v[84:87], v[120:123], v[108:111], v[84:87]
ds_read_b128 v[120:123], v249 offset:20480
ds_read_u16_d16_hi v75, v75
ds_read_u16 v73, v73
s_setprio 3
v_mfma_f32_16x16x32_bf16 v[8:11], v[124:127], v[64:67], v[8:11]
v_lshl_add_u64 v[154:155], v[180:181], 0, v[182:183]
s_waitcnt lgkmcnt(9)
v_mfma_f32_16x16x32_f16 v[200:203], v[184:187], v[196:199], v[200:203]
v_mfma_f32_16x16x32_f16 v[204:207], v[184:187], v[192:195], v[204:207]
s_nop 3
v_cvt_pk_f16_f32 v8, v8, v9
v_mfma_f32_16x16x32_bf16 v[12:15], v[124:127], v[68:71], v[12:15]
v_cvt_pk_f16_f32 v10, v10, v11
v_pk_fma_f16 v9, v8, v8, s48
v_mfma_f32_16x16x32_f16 v[244:247], v[184:187], v[108:111], v[244:247]
ds_read_b128 v[184:187], v249 offset:22528
v_pk_fma_f16 v11, v10, v10, s48
v_mfma_f32_16x16x32_bf16 v[96:99], v[124:127], v[40:43], v[96:99]
ds_read_b128 v[124:127], v251 offset:54272
s_nop 0
v_cvt_pkrtz_f16_f32 v12, v12, v13
v_mfma_f32_16x16x32_f16 v[4:7], v[176:179], v[196:199], v[4:7]
v_cvt_pkrtz_f16_f32 v13, v14, v15
v_lshrrev_b64 v[12:13], 2, v[12:13]
v_mfma_f32_16x16x32_f16 v[224:227], v[176:179], v[192:195], v[224:227]
buffer_load_dwordx4 v[128:131], v250, s[32:35], s80 offen
s_add_u32 s46, s80, 2097152
buffer_load_dwordx4 v[136:139], v250, s[32:35], s46 offen
v_and_b32_sdwa v14, s47, v12 dst_sel:DWORD dst_unused:UNUSED_PAD src0_sel:DWORD src1_sel:WORD_1
s_waitcnt lgkmcnt(5)
v_mfma_f32_16x16x32_bf16 v[0:3], v[188:191], v[48:51], 0
v_and_b32 v12, s47, v12
v_and_b32_sdwa v15, s47, v13 dst_sel:DWORD dst_unused:UNUSED_PAD src0_sel:DWORD src1_sel:WORD_1
v_mfma_f32_16x16x32_f16 v[92:95], v[176:179], v[108:111], v[92:95]
ds_read_b128 v[176:179], v251 offset:52224
ds_read_u16_d16_hi v14, v14
v_mfma_f32_16x16x32_bf16 v[172:175], v[188:191], v[52:55], 0
ds_read_u16 v12, v12
v_and_b32_e64 v13, s47, v13
v_mfma_f32_16x16x32_f16 v[164:167], v[160:163], v[152:155], v[164:167]
ds_read_u16_d16_hi v15, v15
ds_read_u16 v13, v13
v_mfma_f32_16x16x32_bf16 v[156:159], v[188:191], v[24:27], 0
ds_read_b128 v[188:191], v249 offset:18688
v_pk_mul_f16 v9, v8, v9
v_mfma_f32_16x16x32_f16 v[168:171], v[160:163], v[148:151], v[168:171]
s_setprio 2
v_pk_mul_f16 v11, v10, v11
v_cvt_pkrtz_f16_f32 v96, v96, v97
s_waitcnt lgkmcnt(6)
v_mfma_f32_16x16x32_bf16 v[0:3], v[120:123], v[56:59], v[0:3]
v_cvt_pkrtz_f16_f32 v97, v98, v99
v_lshrrev_b64 v[96:97], 2, v[96:97]
v_mfma_f32_16x16x32_f16 v[132:135], v[160:163], v[144:147], v[132:135]
ds_read_b128 v[160:163], v251 offset:55296
v_and_b32_sdwa v98, s47, v96 dst_sel:DWORD dst_unused:UNUSED_PAD src0_sel:DWORD src1_sel:WORD_1
v_mfma_f32_16x16x32_bf16 v[172:175], v[120:123], v[60:63], v[172:175]
v_and_b32_e64 v96, s47, v96
v_lshl_add_u64 v[116:117], v[116:117], 0, v[118:119]
v_mfma_f32_16x16x32_f16 v[216:219], v[124:127], v[152:155], v[216:219]
ds_read_u16_d16_hi v98, v98
ds_read_u16 v96, v96
v_exp_f16_sdwa v9, v9 dst_sel:WORD_0 dst_unused:UNUSED_PRESERVE src0_sel:WORD_0
v_mfma_f32_16x16x32_bf16 v[156:159], v[120:123], v[32:35], v[156:159]
ds_read_b128 v[120:123], v249 offset:20736
v_exp_f16_sdwa v11, v11 dst_sel:WORD_0 dst_unused:UNUSED_PRESERVE src0_sel:WORD_0
v_mfma_f32_16x16x32_f16 v[220:223], v[124:127], v[148:151], v[220:223]
v_and_b32_sdwa v99, s47, v97 dst_sel:DWORD dst_unused:UNUSED_PAD src0_sel:DWORD src1_sel:WORD_1
v_and_b32_e64 v97, s47, v97
v_mfma_f32_16x16x32_bf16 v[0:3], v[184:187], v[64:67], v[0:3]
ds_read_u16_d16_hi v99, v99
ds_read_u16 v97, v97
v_lshl_add_u64 v[240:241], v[240:241], 0, v[242:243]
v_mfma_f32_16x16x32_f16 v[76:79], v[124:127], v[144:147], v[76:79]
ds_read_b128 v[124:127], v251 offset:53248
v_exp_f16_sdwa v9, v9 dst_sel:WORD_1 dst_unused:UNUSED_PRESERVE src0_sel:WORD_1
v_mfma_f32_16x16x32_bf16 v[172:175], v[184:187], v[68:71], v[172:175]
v_exp_f16_sdwa v11, v11 dst_sel:WORD_1 dst_unused:UNUSED_PRESERVE src0_sel:WORD_1
s_waitcnt lgkmcnt(7)
v_mfma_f32_16x16x32_f16 v[100:103], v[176:179], v[152:155], v[100:103]
v_lshl_add_u64 v[72:73], v[72:73], 0, v[74:75]
v_pk_add_f16 v9, v9, 1.0 op_sel_hi:[1,0]
v_mfma_f32_16x16x32_bf16 v[156:159], v[184:187], v[40:43], v[156:159]
ds_read_b128 v[184:187], v249 offset:22784
v_pk_add_f16 v11, v11, 1.0 op_sel_hi:[1,0]
v_mfma_f32_16x16x32_f16 v[104:107], v[176:179], v[148:151], v[104:107]
s_setprio 1
v_rcp_f16_sdwa v9, v9 dst_sel:WORD_0 dst_unused:UNUSED_PRESERVE src0_sel:WORD_0
v_mfma_f32_16x16x32_bf16 v[208:211], v[188:191], v[48:51], 0
v_rcp_f16_sdwa v11, v11 dst_sel:WORD_0 dst_unused:UNUSED_PRESERVE src0_sel:WORD_0
v_mfma_f32_16x16x32_f16 v[140:143], v[176:179], v[144:147], v[140:143]
ds_read_b128 v[176:179], v251 offset:56320
v_cvt_pkrtz_f16_f32 v172, v172, v173
v_mfma_f32_16x16x32_bf16 v[212:215], v[188:191], v[52:55], 0
v_cvt_pkrtz_f16_f32 v173, v174, v175
v_lshrrev_b64 v[172:173], 2, v[172:173]
s_waitcnt lgkmcnt(4)
v_mfma_f32_16x16x32_f16 v[232:235], v[160:163], v[152:155], v[232:235]
v_and_b32_sdwa v174, s47, v172 dst_sel:DWORD dst_unused:UNUSED_PAD src0_sel:DWORD src1_sel:WORD_1
v_and_b32 v172, s47, v172
v_cvt_pk_f16_f32 v0, v0, v1
v_mfma_f32_16x16x32_bf16 v[180:183], v[188:191], v[24:27], 0
ds_read_u16_d16_hi v174, v174
ds_read_u16 v172, v172
ds_read_b128 v[188:191], v249 offset:24576
v_rcp_f16_sdwa v9, v9 dst_sel:WORD_1 dst_unused:UNUSED_PRESERVE src0_sel:WORD_1
v_mfma_f32_16x16x32_f16 v[236:239], v[160:163], v[148:151], v[236:239]
v_cvt_pk_f16_f32 v2, v2, v3
v_pk_fma_f16 v1, v0, v0, s48
v_rcp_f16_sdwa v11, v11 dst_sel:WORD_1 dst_unused:UNUSED_PRESERVE src0_sel:WORD_1
s_add_u32 s46, s80, 4194304
buffer_load_dwordx4 v[108:111], v250, s[32:35], s46 offen
s_add_u32 s46, s80, 6291456
buffer_load_dwordx4 v[192:195], v250, s[32:35], s46 offen
v_mfma_f32_16x16x32_bf16 v[208:211], v[120:123], v[56:59], v[208:211]
v_and_b32_sdwa v175, s47, v173 dst_sel:DWORD dst_unused:UNUSED_PAD src0_sel:DWORD src1_sel:WORD_1
v_and_b32_e64 v173, s47, v173
v_pk_fma_f16 v3, v2, v2, s48
v_mfma_f32_16x16x32_f16 v[84:87], v[160:163], v[144:147], v[84:87]
ds_read_u16_d16_hi v175, v175
ds_read_u16 v173, v173
ds_read_b128 v[160:163], v251 offset:57344
v_pk_mul_f16 v1, v0, v1
v_pk_mul_f16 v118, v8, v9
v_mfma_f32_16x16x32_bf16 v[212:215], v[120:123], v[60:63], v[212:215]
v_pk_mul_f16 v3, v2, v3
buffer_load_dwordx4 v[196:199], v253, s[4:7], s69 offen offset:128
s_waitcnt lgkmcnt(6)
v_mfma_f32_16x16x32_f16 v[200:203], v[124:127], v[152:155], v[200:203]
v_cvt_pkrtz_f16_f32 v156, v156, v157
v_cvt_pkrtz_f16_f32 v157, v158, v159
v_lshrrev_b64 v[156:157], 2, v[156:157]
v_and_b32_sdwa v158, s47, v156 dst_sel:DWORD dst_unused:UNUSED_PAD src0_sel:DWORD src1_sel:WORD_1
v_and_b32 v156, s47, v156
v_pk_mul_f16 v119, v10, v11
v_exp_f16_sdwa v1, v1 dst_sel:WORD_0 dst_unused:UNUSED_PRESERVE src0_sel:WORD_0
v_lshl_add_u64 v[242:243], v[12:13], 0, v[14:15]
v_mfma_f32_16x16x32_bf16 v[180:183], v[120:123], v[32:35], v[180:183]
ds_read_u16_d16_hi v158, v158
ds_read_u16 v156, v156
ds_read_b128 v[120:123], v249 offset:26624
v_mfma_f32_16x16x32_f16 v[204:207], v[124:127], v[148:151], v[204:207]
v_exp_f16_sdwa v3, v3 dst_sel:WORD_0 dst_unused:UNUSED_PRESERVE src0_sel:WORD_0
v_and_b32_sdwa v159, s47, v157 dst_sel:DWORD dst_unused:UNUSED_PAD src0_sel:DWORD src1_sel:WORD_1
v_and_b32 v157, s47, v157
v_mfma_f32_16x16x32_bf16 v[208:211], v[184:187], v[64:67], v[208:211]
ds_read_u16_d16_hi v159, v159
ds_read_u16 v157, v157
s_setprio 0
v_mfma_f32_16x16x32_f16 v[244:247], v[124:127], v[144:147], v[244:247]
ds_read_b128 v[124:127], v251 offset:60416
v_exp_f16_sdwa v1, v1 dst_sel:WORD_1 dst_unused:UNUSED_PRESERVE src0_sel:WORD_1
v_mfma_f32_16x16x32_bf16 v[212:215], v[184:187], v[68:71], v[212:215]
v_lshl_add_u64 v[74:75], v[96:97], 0, v[98:99]
v_exp_f16_sdwa v3, v3 dst_sel:WORD_1 dst_unused:UNUSED_PRESERVE src0_sel:WORD_1
v_mfma_f32_16x16x32_f16 v[4:7], v[176:179], v[152:155], v[4:7]
v_pk_add_f16 v1, v1, 1.0 op_sel_hi:[1,0]
v_pk_add_f16 v3, v3, 1.0 op_sel_hi:[1,0]
v_mfma_f32_16x16x32_bf16 v[180:183], v[184:187], v[40:43], v[180:183]
ds_read_b128 v[184:187], v249 offset:28672
v_rcp_f16_sdwa v1, v1 dst_sel:WORD_0 dst_unused:UNUSED_PRESERVE src0_sel:WORD_0
v_mfma_f32_16x16x32_f16 v[224:227], v[176:179], v[148:151], v[224:227]
v_rcp_f16_sdwa v3, v3 dst_sel:WORD_0 dst_unused:UNUSED_PRESERVE src0_sel:WORD_0
s_waitcnt lgkmcnt(6)
v_mfma_f32_16x16x32_bf16 v[8:11], v[188:191], v[48:51], 0
v_cvt_pkrtz_f16_f32 v208, v208, v209
v_cvt_pkrtz_f16_f32 v209, v210, v211
v_mfma_f32_16x16x32_f16 v[92:95], v[176:179], v[144:147], v[92:95]
ds_read_b128 v[176:179], v251 offset:58368
v_lshrrev_b64 v[208:209], 2, v[208:209]
s_waitcnt vmcnt(8)
v_mfma_f32_16x16x32_bf16 v[104:107], v[18:21], v[80:83], v[104:107]
v_and_b32_sdwa v210, s47, v208 dst_sel:DWORD dst_unused:UNUSED_PAD src0_sel:DWORD src1_sel:WORD_1
v_and_b32 v208, s47, v208
v_mfma_f32_16x16x32_bf16 v[236:239], v[16:19], v[80:83], v[236:239]
ds_read_u16_d16_hi v210, v210
ds_read_u16 v208, v208
s_waitcnt vmcnt(7)
v_mfma_f32_16x16x32_bf16 v[204:207], v[18:21], v[88:91], v[204:207]
v_rcp_f16_sdwa v1, v1 dst_sel:WORD_1 dst_unused:UNUSED_PRESERVE src0_sel:WORD_1
v_mfma_f32_16x16x32_bf16 v[224:227], v[16:19], v[88:91], v[224:227]
v_and_b32_sdwa v211, s47, v209 dst_sel:DWORD dst_unused:UNUSED_PAD src0_sel:DWORD src1_sel:WORD_1
v_and_b32_e64 v209, s47, v209
v_mfma_f32_16x16x32_bf16 v[12:15], v[188:191], v[52:55], 0
ds_read_u16_d16_hi v211, v211
ds_read_u16 v209, v209
v_mfma_f32_16x16x32_f16 v[164:167], v[160:163], v[72:75], v[164:167]
v_rcp_f16_sdwa v3, v3 dst_sel:WORD_1 dst_unused:UNUSED_PRESERVE src0_sel:WORD_1
v_mfma_f32_16x16x32_bf16 v[96:99], v[188:191], v[24:27], 0
ds_read_b128 v[188:191], v249 offset:24832
v_cvt_pkrtz_f16_f32 v212, v212, v213
v_mfma_f32_16x16x32_f16 v[168:171], v[160:163], v[240:243], v[168:171]
s_setprio 3
v_cvt_pkrtz_f16_f32 v213, v214, v215
v_lshrrev_b64 v[212:213], 2, v[212:213]
s_waitcnt lgkmcnt(5)
v_mfma_f32_16x16x32_bf16 v[8:11], v[120:123], v[56:59], v[8:11]
v_and_b32_sdwa v214, s47, v212 dst_sel:DWORD dst_unused:UNUSED_PAD src0_sel:DWORD src1_sel:WORD_1
v_and_b32_e64 v212, s47, v212
v_mfma_f32_16x16x32_f16 v[132:135], v[160:163], v[116:119], v[132:135]
ds_read_b128 v[160:163], v251 offset:61440
ds_read_u16_d16_hi v214, v214
ds_read_u16 v212, v212
v_pk_mul_f16 v0, v0, v1
v_mfma_f32_16x16x32_bf16 v[12:15], v[120:123], v[60:63], v[12:15]
v_and_b32_sdwa v215, s47, v213 dst_sel:DWORD dst_unused:UNUSED_PAD src0_sel:DWORD src1_sel:WORD_1
v_and_b32_e64 v213, s47, v213
v_mfma_f32_16x16x32_f16 v[216:219], v[124:127], v[72:75], v[216:219]
ds_read_u16_d16_hi v215, v215
ds_read_u16 v213, v213
v_pk_mul_f16 v1, v2, v3
v_lshl_add_u64 v[172:173], v[172:173], 0, v[174:175]
v_mfma_f32_16x16x32_bf16 v[96:99], v[120:123], v[32:35], v[96:99]
ds_read_b128 v[120:123], v249 offset:26880
v_cvt_pkrtz_f16_f32 v180, v180, v181
v_cvt_pkrtz_f16_f32 v181, v182, v183
v_lshrrev_b64 v[180:181], 2, v[180:181]
v_and_b32_sdwa v182, s47, v180 dst_sel:DWORD dst_unused:UNUSED_PAD src0_sel:DWORD src1_sel:WORD_1
v_and_b32_e64 v180, s47, v180
v_mfma_f32_16x16x32_f16 v[220:223], v[124:127], v[240:243], v[220:223]
ds_read_u16_d16_hi v182, v182
ds_read_u16 v180, v180
v_and_b32_sdwa v183, s47, v181 dst_sel:DWORD dst_unused:UNUSED_PAD src0_sel:DWORD src1_sel:WORD_1
v_and_b32 v181, s47, v181
v_mfma_f32_16x16x32_bf16 v[8:11], v[184:187], v[64:67], v[8:11]
ds_read_u16_d16_hi v183, v183
ds_read_u16 v181, v181
s_add_u32 s46, s80, 8388608
buffer_load_dwordx4 v[144:147], v250, s[32:35], s46 offen
s_add_u32 s46, s80, 10485760
buffer_load_dwordx4 v[148:151], v250, s[32:35], s46 offen
v_mfma_f32_16x16x32_f16 v[76:79], v[124:127], v[116:119], v[76:79]
s_waitcnt lgkmcnt(9)
ds_read_b128 v[124:127], v251 offset:59392
v_lshl_add_u64 v[156:157], v[156:157], 0, v[158:159]
v_mfma_f32_16x16x32_bf16 v[12:15], v[184:187], v[68:71], v[12:15]
v_cvt_pk_f16_f32 v8, v8, v9
v_cvt_pk_f16_f32 v10, v10, v11
v_mfma_f32_16x16x32_f16 v[100:103], v[176:179], v[72:75], v[100:103]
v_pk_fma_f16 v9, v8, v8, s48
v_pk_fma_f16 v11, v10, v10, s48
v_mfma_f32_16x16x32_bf16 v[96:99], v[184:187], v[40:43], v[96:99]
ds_read_b128 v[184:187], v249 offset:28928
s_nop 0
v_cvt_pkrtz_f16_f32 v12, v12, v13
v_mfma_f32_16x16x32_f16 v[104:107], v[176:179], v[240:243], v[104:107]
s_setprio 2
v_cvt_pkrtz_f16_f32 v13, v14, v15
v_lshrrev_b64 v[12:13], 2, v[12:13]
v_mfma_f32_16x16x32_bf16 v[152:155], v[188:191], v[48:51], 0
v_and_b32_sdwa v14, s47, v12 dst_sel:DWORD dst_unused:UNUSED_PAD src0_sel:DWORD src1_sel:WORD_1
v_and_b32_e64 v12, s47, v12
v_mfma_f32_16x16x32_f16 v[140:143], v[176:179], v[116:119], v[140:143]
ds_read_b128 v[176:179], v251 offset:62464
ds_read_u16_d16_hi v14, v14
v_mfma_f32_16x16x32_bf16 v[80:83], v[188:191], v[52:55], 0
ds_read_u16 v12, v12
v_and_b32_sdwa v15, s47, v13 dst_sel:DWORD dst_unused:UNUSED_PAD src0_sel:DWORD src1_sel:WORD_1
v_mfma_f32_16x16x32_f16 v[232:235], v[160:163], v[72:75], v[232:235]
v_and_b32 v13, s47, v13
v_pk_mul_f16 v9, v8, v9
v_mfma_f32_16x16x32_bf16 v[88:91], v[188:191], v[24:27], 0
ds_read_b128 v[188:191], v249 offset:30720
s_waitcnt lgkmcnt(8)
ds_read_u16_d16_hi v15, v15
v_mfma_f32_16x16x32_f16 v[236:239], v[160:163], v[240:243], v[236:239]
ds_read_u16 v13, v13
v_pk_mul_f16 v11, v10, v11
v_mfma_f32_16x16x32_bf16 v[152:155], v[120:123], v[56:59], v[152:155]
v_cvt_pkrtz_f16_f32 v96, v96, v97
v_cvt_pkrtz_f16_f32 v97, v98, v99
v_mfma_f32_16x16x32_f16 v[84:87], v[160:163], v[116:119], v[84:87]
ds_read_b128 v[160:163], v251 offset:63488
v_lshrrev_b64 v[96:97], 2, v[96:97]
v_mfma_f32_16x16x32_bf16 v[80:83], v[120:123], v[60:63], v[80:83]
v_and_b32_sdwa v98, s47, v96 dst_sel:DWORD dst_unused:UNUSED_PAD src0_sel:DWORD src1_sel:WORD_1
v_and_b32 v96, s47, v96
s_waitcnt lgkmcnt(7)
v_mfma_f32_16x16x32_f16 v[200:203], v[124:127], v[72:75], v[200:203]
ds_read_u16_d16_hi v98, v98
ds_read_u16 v96, v96
v_lshl_add_u64 v[2:3], v[208:209], 0, v[210:211]
v_exp_f16_sdwa v9, v9 dst_sel:WORD_0 dst_unused:UNUSED_PRESERVE src0_sel:WORD_0
v_mfma_f32_16x16x32_bf16 v[88:91], v[120:123], v[32:35], v[88:91]
ds_read_b128 v[120:123], v249 offset:32768
v_exp_f16_sdwa v11, v11 dst_sel:WORD_0 dst_unused:UNUSED_PRESERVE src0_sel:WORD_0
v_mfma_f32_16x16x32_f16 v[204:207], v[124:127], v[240:243], v[204:207]
s_setprio 1
v_and_b32_sdwa v99, s47, v97 dst_sel:DWORD dst_unused:UNUSED_PAD src0_sel:DWORD src1_sel:WORD_1
v_and_b32_e64 v97, s47, v97
v_mfma_f32_16x16x32_bf16 v[152:155], v[184:187], v[64:67], v[152:155]
ds_read_u16_d16_hi v99, v99
ds_read_u16 v97, v97
v_lshl_add_u64 v[174:175], v[212:213], 0, v[214:215]
v_mfma_f32_16x16x32_f16 v[244:247], v[124:127], v[116:119], v[244:247]
ds_read_b128 v[124:127], v252 offset:1024
v_exp_f16_sdwa v9, v9 dst_sel:WORD_1 dst_unused:UNUSED_PRESERVE src0_sel:WORD_1
v_mfma_f32_16x16x32_bf16 v[80:83], v[184:187], v[68:71], v[80:83]
v_exp_f16_sdwa v11, v11 dst_sel:WORD_1 dst_unused:UNUSED_PRESERVE src0_sel:WORD_1
s_waitcnt lgkmcnt(7)
v_mfma_f32_16x16x32_f16 v[4:7], v[176:179], v[72:75], v[4:7]
v_lshl_add_u64 v[158:159], v[180:181], 0, v[182:183]
v_pk_add_f16 v9, v9, 1.0 op_sel_hi:[1,0]
v_mfma_f32_16x16x32_bf16 v[88:91], v[184:187], v[40:43], v[88:91]
ds_read_b128 v[184:187], v249 offset:34816
v_pk_add_f16 v11, v11, 1.0 op_sel_hi:[1,0]
v_mfma_f32_16x16x32_f16 v[224:227], v[176:179], v[240:243], v[224:227]
v_rcp_f16_sdwa v9, v9 dst_sel:WORD_0 dst_unused:UNUSED_PRESERVE src0_sel:WORD_0
v_mfma_f32_16x16x32_bf16 v[208:211], v[188:191], v[48:51], 0
v_rcp_f16_sdwa v11, v11 dst_sel:WORD_0 dst_unused:UNUSED_PRESERVE src0_sel:WORD_0
v_mfma_f32_16x16x32_f16 v[92:95], v[176:179], v[116:119], v[92:95]
ds_read_b128 v[176:179], v251 offset:64512
v_cvt_pkrtz_f16_f32 v80, v80, v81
v_mfma_f32_16x16x32_bf16 v[212:215], v[188:191], v[52:55], 0
v_cvt_pkrtz_f16_f32 v81, v82, v83
v_lshrrev_b64 v[80:81], 2, v[80:81]
s_waitcnt lgkmcnt(5)
v_mfma_f32_16x16x32_f16 v[164:167], v[160:163], v[156:159], v[164:167]
v_and_b32_sdwa v82, s47, v80 dst_sel:DWORD dst_unused:UNUSED_PAD src0_sel:DWORD src1_sel:WORD_1
v_and_b32 v80, s47, v80
v_cvt_pk_f16_f32 v152, v152, v153
v_mfma_f32_16x16x32_bf16 v[180:183], v[188:191], v[24:27], 0
ds_read_u16_d16_hi v82, v82
ds_read_u16 v80, v80
ds_read_b128 v[188:191], v249 offset:30976
v_rcp_f16_sdwa v9, v9 dst_sel:WORD_1 dst_unused:UNUSED_PRESERVE src0_sel:WORD_1
s_setprio 0
v_mfma_f32_16x16x32_f16 v[168:171], v[160:163], v[172:175], v[168:171]
v_cvt_pk_f16_f32 v154, v154, v155
v_pk_fma_f16 v153, v152, v152, s48
v_rcp_f16_sdwa v11, v11 dst_sel:WORD_1 dst_unused:UNUSED_PRESERVE src0_sel:WORD_1
v_mfma_f32_16x16x32_bf16 v[208:211], v[120:123], v[56:59], v[208:211]
v_and_b32_sdwa v83, s47, v81 dst_sel:DWORD dst_unused:UNUSED_PAD src0_sel:DWORD src1_sel:WORD_1
v_and_b32 v81, s47, v81
v_pk_fma_f16 v155, v154, v154, s48
v_mfma_f32_16x16x32_f16 v[132:135], v[160:163], v[0:3], v[132:135]
ds_read_u16_d16_hi v83, v83
ds_read_u16 v81, v81
ds_read_b128 v[160:163], v252 offset:2048
v_pk_mul_f16 v153, v152, v153
v_pk_mul_f16 v8, v8, v9
v_mfma_f32_16x16x32_bf16 v[212:215], v[120:123], v[60:63], v[212:215]
v_pk_mul_f16 v155, v154, v155
v_cvt_pkrtz_f16_f32 v88, v88, v89
s_waitcnt lgkmcnt(6)
v_mfma_f32_16x16x32_f16 v[216:219], v[124:127], v[156:159], v[216:219]
v_cvt_pkrtz_f16_f32 v89, v90, v91
v_lshrrev_b64 v[88:89], 2, v[88:89]
v_and_b32_sdwa v90, s47, v88 dst_sel:DWORD dst_unused:UNUSED_PAD src0_sel:DWORD src1_sel:WORD_1
v_and_b32 v88, s47, v88
v_pk_mul_f16 v9, v10, v11
v_exp_f16_sdwa v153, v153 dst_sel:WORD_0 dst_unused:UNUSED_PRESERVE src0_sel:WORD_0
v_lshl_add_u64 v[12:13], v[12:13], 0, v[14:15]
v_mfma_f32_16x16x32_bf16 v[180:183], v[120:123], v[32:35], v[180:183]
ds_read_u16_d16_hi v90, v90
ds_read_u16 v88, v88
v_mfma_f32_16x16x32_f16 v[220:223], v[124:127], v[172:175], v[220:223]
ds_read_b128 v[120:123], v249 offset:35072
v_exp_f16_sdwa v155, v155 dst_sel:WORD_0 dst_unused:UNUSED_PRESERVE src0_sel:WORD_0
v_and_b32_sdwa v91, s47, v89 dst_sel:DWORD dst_unused:UNUSED_PAD src0_sel:DWORD src1_sel:WORD_1
v_and_b32_e64 v89, s47, v89
v_mfma_f32_16x16x32_bf16 v[208:211], v[184:187], v[64:67], v[208:211]
ds_read_u16_d16_hi v91, v91
ds_read_u16 v89, v89
s_waitcnt vmcnt(5)
v_permlane16_swap_b32 v128, v136
v_permlane16_swap_b32 v129, v137
v_permlane16_swap_b32 v130, v138
v_permlane16_swap_b32 v131, v139
s_waitcnt vmcnt(3)
v_permlane16_swap_b32 v108, v192
v_permlane16_swap_b32 v109, v193
v_permlane16_swap_b32 v110, v194
v_permlane16_swap_b32 v111, v195
v_mfma_f32_16x16x32_f16 v[76:79], v[124:127], v[0:3], v[76:79]
v_exp_f16_sdwa v153, v153 dst_sel:WORD_1 dst_unused:UNUSED_PRESERVE src0_sel:WORD_1
v_mfma_f32_16x16x32_bf16 v[212:215], v[184:187], v[68:71], v[212:215]
ds_read_b128 v[124:127], v252 offset:3072
v_lshl_add_u64 v[96:97], v[96:97], 0, v[98:99]
v_mfma_f32_16x16x32_f16 v[100:103], v[176:179], v[156:159], v[100:103]
v_exp_f16_sdwa v155, v155 dst_sel:WORD_1 dst_unused:UNUSED_PRESERVE src0_sel:WORD_1
v_mfma_f32_16x16x32_bf16 v[180:183], v[184:187], v[40:43], v[180:183]
s_setprio 3
v_pk_add_f16 v153, v153, 1.0 op_sel_hi:[1,0]
v_pk_add_f16 v155, v155, 1.0 op_sel_hi:[1,0]
v_mfma_f32_16x16x32_f16 v[104:107], v[176:179], v[172:175], v[104:107]
ds_read_b128 v[184:187], v248
v_rcp_f16_sdwa v153, v153 dst_sel:WORD_0 dst_unused:UNUSED_PRESERVE src0_sel:WORD_0
s_waitcnt lgkmcnt(4)
v_mfma_f32_16x16x32_bf16 v[116:119], v[188:191], v[48:51], 0
ds_read_b128 v[48:51], v252
v_rcp_f16_sdwa v155, v155 dst_sel:WORD_0 dst_unused:UNUSED_PRESERVE src0_sel:WORD_0
v_mfma_f32_16x16x32_f16 v[140:143], v[176:179], v[0:3], v[140:143]
ds_read_b128 v[176:179], v252 offset:4096
v_cvt_pkrtz_f16_f32 v208, v208, v209
v_mfma_f32_16x16x32_bf16 v[240:243], v[188:191], v[52:55], 0
ds_read_b128 v[52:55], v249 offset:33024
v_cvt_pkrtz_f16_f32 v209, v210, v211
v_mfma_f32_16x16x32_f16 v[232:235], v[160:163], v[156:159], v[232:235]
v_lshrrev_b64 v[208:209], 2, v[208:209]
v_and_b32_sdwa v210, s47, v208 dst_sel:DWORD dst_unused:UNUSED_PAD src0_sel:DWORD src1_sel:WORD_1
v_and_b32_e64 v208, s47, v208
v_mfma_f32_16x16x32_bf16 v[72:75], v[188:191], v[24:27], 0
ds_read_u16_d16_hi v210, v210
ds_read_u16 v208, v208
v_rcp_f16_sdwa v153, v153 dst_sel:WORD_1 dst_unused:UNUSED_PRESERVE src0_sel:WORD_1
v_mfma_f32_16x16x32_f16 v[236:239], v[160:163], v[172:175], v[236:239]
ds_read_b128 v[188:191], v248 offset:2048
v_and_b32_sdwa v211, s47, v209 dst_sel:DWORD dst_unused:UNUSED_PAD src0_sel:DWORD src1_sel:WORD_1
v_and_b32_e64 v209, s47, v209
v_rcp_f16_sdwa v155, v155 dst_sel:WORD_1 dst_unused:UNUSED_PRESERVE src0_sel:WORD_1
ds_read_u16_d16_hi v211, v211
ds_read_u16 v209, v209
s_waitcnt lgkmcnt(5)
v_mfma_f32_16x16x32_bf16 v[116:119], v[52:55], v[56:59], v[116:119]
s_waitcnt vmcnt(0)
v_permlane16_swap_b32 v144, v148
v_permlane16_swap_b32 v145, v149
v_permlane16_swap_b32 v146, v150
v_permlane16_swap_b32 v147, v151
v_mfma_f32_16x16x32_f16 v[84:87], v[160:163], v[0:3], v[84:87]
v_cvt_pkrtz_f16_f32 v212, v212, v213
v_cvt_pkrtz_f16_f32 v213, v214, v215
v_lshrrev_b64 v[212:213], 2, v[212:213]
v_and_b32_sdwa v214, s47, v212 dst_sel:DWORD dst_unused:UNUSED_PAD src0_sel:DWORD src1_sel:WORD_1
v_and_b32_e64 v212, s47, v212
v_pk_mul_f16 v10, v152, v153
v_mfma_f32_16x16x32_bf16 v[240:243], v[52:55], v[60:63], v[240:243]
ds_read_u16_d16_hi v214, v214
ds_read_u16 v212, v212
ds_read_b128 v[160:163], v252 offset:7168
v_mfma_f32_16x16x32_f16 v[200:203], v[48:51], v[156:159], v[200:203]
v_and_b32_sdwa v215, s47, v213 dst_sel:DWORD dst_unused:UNUSED_PAD src0_sel:DWORD src1_sel:WORD_1
v_and_b32_e64 v213, s47, v213
v_pk_mul_f16 v11, v154, v155
v_lshl_add_u64 v[14:15], v[80:81], 0, v[82:83]
v_mfma_f32_16x16x32_bf16 v[72:75], v[52:55], v[32:35], v[72:75]
ds_read_u16_d16_hi v215, v215
ds_read_u16 v213, v213
s_setprio 2
v_cvt_pkrtz_f16_f32 v180, v180, v181
v_cvt_pkrtz_f16_f32 v181, v182, v183
v_lshrrev_b64 v[180:181], 2, v[180:181]
v_and_b32_sdwa v182, s47, v180 dst_sel:DWORD dst_unused:UNUSED_PAD src0_sel:DWORD src1_sel:WORD_1
v_and_b32 v180, s47, v180
v_mfma_f32_16x16x32_f16 v[204:207], v[48:51], v[172:175], v[204:207]
ds_read_u16_d16_hi v182, v182
ds_read_u16 v180, v180
ds_read_b128 v[52:55], v248 offset:4096
v_and_b32_sdwa v183, s47, v181 dst_sel:DWORD dst_unused:UNUSED_PAD src0_sel:DWORD src1_sel:WORD_1
v_and_b32_e64 v181, s47, v181
v_mfma_f32_16x16x32_bf16 v[116:119], v[120:123], v[64:67], v[116:119]
ds_read_u16_d16_hi v183, v183
ds_read_u16 v181, v181
v_mfma_f32_16x16x32_f16 v[244:247], v[48:51], v[0:3], v[244:247]
s_waitcnt lgkmcnt(10)
ds_read_b128 v[48:51], v252 offset:5120
v_lshl_add_u64 v[98:99], v[88:89], 0, v[90:91]
v_mfma_f32_16x16x32_bf16 v[240:243], v[120:123], v[68:71], v[240:243]
s_nop 0
v_cvt_pk_f16_f32 v116, v116, v117
v_mfma_f32_16x16x32_f16 v[4:7], v[124:127], v[156:159], v[4:7]
v_cvt_pk_f16_f32 v118, v118, v119
v_pk_fma_f16 v117, v116, v116, s48
v_mfma_f32_16x16x32_bf16 v[72:75], v[120:123], v[40:43], v[72:75]
ds_read_b128 v[120:123], v248 offset:256
s_nop 0
v_cvt_pkrtz_f16_f32 v240, v240, v241
v_mfma_f32_16x16x32_f16 v[224:227], v[124:127], v[172:175], v[224:227]
v_cvt_pkrtz_f16_f32 v241, v242, v243
v_lshrrev_b64 v[240:241], 2, v[240:241]
v_mfma_f32_16x16x32_bf16 v[24:27], v[184:187], v[28:31], 0
v_and_b32_sdwa v242, s47, v240 dst_sel:DWORD dst_unused:UNUSED_PAD src0_sel:DWORD src1_sel:WORD_1
v_and_b32 v240, s47, v240
v_mfma_f32_16x16x32_f16 v[92:95], v[124:127], v[0:3], v[92:95]
ds_read_b128 v[124:127], v252 offset:8192
ds_read_u16_d16_hi v242, v242
v_mfma_f32_16x16x32_bf16 v[164:167], v[18:21], v[228:231], v[164:167]
ds_read_u16 v240, v240
v_and_b32_sdwa v243, s47, v241 dst_sel:DWORD dst_unused:UNUSED_PAD src0_sel:DWORD src1_sel:WORD_1
v_mfma_f32_16x16x32_bf16 v[216:219], v[16:19], v[228:231], v[216:219]
v_and_b32 v241, s47, v241
v_pk_fma_f16 v119, v118, v118, s48
v_mfma_f32_16x16x32_bf16 v[100:103], v[18:21], v[112:115], v[100:103]
s_waitcnt lgkmcnt(8)
ds_read_u16_d16_hi v243, v243
ds_read_u16 v241, v241
v_mfma_f32_16x16x32_bf16 v[232:235], v[16:19], v[112:115], v[232:235]
v_pk_mul_f16 v117, v116, v117
v_pk_mul_f16 v119, v118, v119
v_mfma_f32_16x16x32_bf16 v[56:59], v[184:187], v[128:131], 0
v_cvt_pkrtz_f16_f32 v72, v72, v73
v_cvt_pkrtz_f16_f32 v73, v74, v75
v_mfma_f32_16x16x32_f16 v[164:167], v[176:179], v[96:99], v[164:167]
s_setprio 1
v_lshrrev_b64 v[72:73], 2, v[72:73]
v_and_b32_sdwa v74, s47, v72 dst_sel:DWORD dst_unused:UNUSED_PAD src0_sel:DWORD src1_sel:WORD_1
v_mfma_f32_16x16x32_bf16 v[60:63], v[184:187], v[136:139], 0
ds_read_b128 v[184:187], v248 offset:2304
v_and_b32 v72, s47, v72
v_mfma_f32_16x16x32_f16 v[168:171], v[176:179], v[12:15], v[168:171]
ds_read_u16_d16_hi v74, v74
ds_read_u16 v72, v72
v_mfma_f32_16x16x32_bf16 v[24:27], v[188:191], v[36:39], v[24:27]
v_lshl_add_u64 v[208:209], v[208:209], 0, v[210:211]
v_exp_f16_sdwa v117, v117 dst_sel:WORD_0 dst_unused:UNUSED_PRESERVE src0_sel:WORD_0
v_mfma_f32_16x16x32_f16 v[132:135], v[176:179], v[8:11], v[132:135]
ds_read_b128 v[176:179], v252 offset:6144
v_exp_f16_sdwa v119, v119 dst_sel:WORD_0 dst_unused:UNUSED_PRESERVE src0_sel:WORD_0
v_mfma_f32_16x16x32_bf16 v[56:59], v[188:191], v[108:111], v[56:59]
v_and_b32_sdwa v75, s47, v73 dst_sel:DWORD dst_unused:UNUSED_PAD src0_sel:DWORD src1_sel:WORD_1
v_and_b32 v73, s47, v73
v_mfma_f32_16x16x32_f16 v[216:219], v[160:163], v[96:99], v[216:219]
ds_read_u16_d16_hi v75, v75
s_waitcnt lgkmcnt(7)
ds_read_u16 v73, v73
v_mfma_f32_16x16x32_bf16 v[60:63], v[188:191], v[192:195], v[60:63]
ds_read_b128 v[188:191], v248 offset:4352
v_lshl_add_u64 v[212:213], v[212:213], 0, v[214:215]
v_mfma_f32_16x16x32_f16 v[220:223], v[160:163], v[12:15], v[220:223]
v_exp_f16_sdwa v117, v117 dst_sel:WORD_1 dst_unused:UNUSED_PRESERVE src0_sel:WORD_1
v_mfma_f32_16x16x32_bf16 v[24:27], v[52:55], v[44:47], v[24:27]
v_exp_f16_sdwa v119, v119 dst_sel:WORD_1 dst_unused:UNUSED_PRESERVE src0_sel:WORD_1
v_mfma_f32_16x16x32_f16 v[76:79], v[160:163], v[8:11], v[76:79]
ds_read_b128 v[160:163], v252 offset:9216
v_lshl_add_u64 v[180:181], v[180:181], 0, v[182:183]
v_mfma_f32_16x16x32_bf16 v[56:59], v[52:55], v[144:147], v[56:59]
v_pk_add_f16 v117, v117, 1.0 op_sel_hi:[1,0]
v_pk_add_f16 v119, v119, 1.0 op_sel_hi:[1,0]
v_mfma_f32_16x16x32_f16 v[100:103], v[48:51], v[96:99], v[100:103]
s_setprio 0
v_rcp_f16_sdwa v117, v117 dst_sel:WORD_0 dst_unused:UNUSED_PRESERVE src0_sel:WORD_0
v_mfma_f32_16x16x32_bf16 v[60:63], v[52:55], v[148:151], v[60:63]
ds_read_b128 v[52:55], v248 offset:6144
v_rcp_f16_sdwa v119, v119 dst_sel:WORD_0 dst_unused:UNUSED_PRESERVE src0_sel:WORD_0
v_mfma_f32_16x16x32_f16 v[104:107], v[48:51], v[12:15], v[104:107]
v_cvt_pkrtz_f16_f32 v24, v24, v25
v_cvt_pkrtz_f16_f32 v25, v26, v27
v_mfma_f32_16x16x32_bf16 v[32:35], v[120:123], v[28:31], 0
v_lshrrev_b64 v[24:25], 2, v[24:25]
v_and_b32_sdwa v26, s47, v24 dst_sel:DWORD dst_unused:UNUSED_PAD src0_sel:DWORD src1_sel:WORD_1
v_mfma_f32_16x16x32_f16 v[140:143], v[48:51], v[8:11], v[140:143]
ds_read_b128 v[48:51], v252 offset:10240
v_and_b32 v24, s47, v24
v_mfma_f32_16x16x32_bf16 v[152:155], v[120:123], v[128:131], 0
ds_read_u16_d16_hi v26, v26
ds_read_u16 v24, v24
v_mfma_f32_16x16x32_f16 v[232:235], v[124:127], v[96:99], v[232:235]
v_rcp_f16_sdwa v117, v117 dst_sel:WORD_1 dst_unused:UNUSED_PRESERVE src0_sel:WORD_1
v_mfma_f32_16x16x32_bf16 v[80:83], v[120:123], v[136:139], 0
ds_read_b128 v[120:123], v248 offset:8192
v_and_b32_sdwa v27, s47, v25 dst_sel:DWORD dst_unused:UNUSED_PAD src0_sel:DWORD src1_sel:WORD_1
v_mfma_f32_16x16x32_f16 v[236:239], v[124:127], v[12:15], v[236:239]
v_and_b32 v25, s47, v25
v_rcp_f16_sdwa v119, v119 dst_sel:WORD_1 dst_unused:UNUSED_PRESERVE src0_sel:WORD_1
s_waitcnt lgkmcnt(4)
v_mfma_f32_16x16x32_bf16 v[32:35], v[184:187], v[36:39], v[32:35]
ds_read_u16_d16_hi v27, v27
ds_read_u16 v25, v25
v_mfma_f32_16x16x32_f16 v[84:87], v[124:127], v[8:11], v[84:87]
v_cvt_pkrtz_f16_f32 v56, v56, v57
v_cvt_pkrtz_f16_f32 v57, v58, v59
v_lshrrev_b64 v[56:57], 2, v[56:57]
v_and_b32_sdwa v58, s47, v56 dst_sel:DWORD dst_unused:UNUSED_PAD src0_sel:DWORD src1_sel:WORD_1
v_and_b32_e64 v56, s47, v56
v_pk_mul_f16 v210, v116, v117
v_mfma_f32_16x16x32_bf16 v[152:155], v[184:187], v[108:111], v[152:155]
ds_read_u16_d16_hi v58, v58
ds_read_u16 v56, v56
ds_read_b128 v[124:127], v252 offset:13312
v_mfma_f32_16x16x32_f16 v[200:203], v[176:179], v[96:99], v[200:203]
v_and_b32_sdwa v59, s47, v57 dst_sel:DWORD dst_unused:UNUSED_PAD src0_sel:DWORD src1_sel:WORD_1
v_and_b32_e64 v57, s47, v57
v_pk_mul_f16 v211, v118, v119
v_lshl_add_u64 v[214:215], v[240:241], 0, v[242:243]
v_mfma_f32_16x16x32_bf16 v[80:83], v[184:187], v[192:195], v[80:83]
ds_read_u16_d16_hi v59, v59
ds_read_u16 v57, v57
s_setprio 3
v_cvt_pkrtz_f16_f32 v60, v60, v61
v_cvt_pkrtz_f16_f32 v61, v62, v63
v_lshrrev_b64 v[60:61], 2, v[60:61]
v_and_b32_sdwa v62, s47, v60 dst_sel:DWORD dst_unused:UNUSED_PAD src0_sel:DWORD src1_sel:WORD_1
v_and_b32 v60, s47, v60
v_mfma_f32_16x16x32_f16 v[204:207], v[176:179], v[12:15], v[204:207]
ds_read_u16_d16_hi v62, v62
ds_read_u16 v60, v60
ds_read_b128 v[184:187], v248 offset:10240
v_and_b32_sdwa v63, s47, v61 dst_sel:DWORD dst_unused:UNUSED_PAD src0_sel:DWORD src1_sel:WORD_1
v_and_b32 v61, s47, v61
v_mfma_f32_16x16x32_bf16 v[32:35], v[188:191], v[44:47], v[32:35]
ds_read_u16_d16_hi v63, v63
s_waitcnt lgkmcnt(9)
ds_read_u16 v61, v61
v_mfma_f32_16x16x32_f16 v[244:247], v[176:179], v[8:11], v[244:247]
ds_read_b128 v[176:179], v252 offset:11264
v_lshl_add_u64 v[182:183], v[72:73], 0, v[74:75]
v_mfma_f32_16x16x32_bf16 v[152:155], v[188:191], v[144:147], v[152:155]
s_nop 0
v_cvt_pk_f16_f32 v32, v32, v33
v_mfma_f32_16x16x32_f16 v[4:7], v[160:163], v[96:99], v[4:7]
v_cvt_pk_f16_f32 v34, v34, v35
v_pk_fma_f16 v33, v32, v32, s48
v_mfma_f32_16x16x32_bf16 v[80:83], v[188:191], v[148:151], v[80:83]
ds_read_b128 v[188:191], v248 offset:6400
s_nop 0
v_cvt_pkrtz_f16_f32 v152, v152, v153
v_mfma_f32_16x16x32_f16 v[224:227], v[160:163], v[12:15], v[224:227]
v_cvt_pkrtz_f16_f32 v153, v154, v155
v_lshrrev_b64 v[152:153], 2, v[152:153]
v_mfma_f32_16x16x32_bf16 v[88:91], v[52:55], v[28:31], 0
v_and_b32_sdwa v154, s47, v152 dst_sel:DWORD dst_unused:UNUSED_PAD src0_sel:DWORD src1_sel:WORD_1
v_and_b32_e64 v152, s47, v152
v_mfma_f32_16x16x32_f16 v[92:95], v[160:163], v[8:11], v[92:95]
ds_read_b128 v[160:163], v252 offset:14336
ds_read_u16_d16_hi v154, v154
v_mfma_f32_16x16x32_bf16 v[64:67], v[52:55], v[128:131], 0
ds_read_u16 v152, v152
v_and_b32_sdwa v155, s47, v153 dst_sel:DWORD dst_unused:UNUSED_PAD src0_sel:DWORD src1_sel:WORD_1
v_mfma_f32_16x16x32_f16 v[164:167], v[48:51], v[180:183], v[164:167]
s_setprio 2
v_and_b32_e64 v153, s47, v153
v_pk_fma_f16 v35, v34, v34, s48
v_mfma_f32_16x16x32_bf16 v[68:71], v[52:55], v[136:139], 0
s_waitcnt lgkmcnt(8)
ds_read_b128 v[52:55], v248 offset:8448
ds_read_u16_d16_hi v155, v155
v_mfma_f32_16x16x32_f16 v[168:171], v[48:51], v[212:215], v[168:171]
ds_read_u16 v153, v153
v_pk_mul_f16 v33, v32, v33
v_mfma_f32_16x16x32_bf16 v[88:91], v[120:123], v[36:39], v[88:91]
v_pk_mul_f16 v35, v34, v35
v_cvt_pkrtz_f16_f32 v80, v80, v81
v_mfma_f32_16x16x32_f16 v[132:135], v[48:51], v[208:211], v[132:135]
ds_read_b128 v[48:51], v252 offset:12288
v_cvt_pkrtz_f16_f32 v81, v82, v83
v_mfma_f32_16x16x32_bf16 v[64:67], v[120:123], v[108:111], v[64:67]
v_lshrrev_b64 v[80:81], 2, v[80:81]
v_and_b32_sdwa v82, s47, v80 dst_sel:DWORD dst_unused:UNUSED_PAD src0_sel:DWORD src1_sel:WORD_1
v_mfma_f32_16x16x32_f16 v[216:219], v[124:127], v[180:183], v[216:219]
v_and_b32_e64 v80, s47, v80
v_lshl_add_u64 v[24:25], v[24:25], 0, v[26:27]
v_exp_f16_sdwa v33, v33 dst_sel:WORD_0 dst_unused:UNUSED_PRESERVE src0_sel:WORD_0
v_mfma_f32_16x16x32_bf16 v[68:71], v[120:123], v[192:195], v[68:71]
ds_read_u16_d16_hi v82, v82
ds_read_u16 v80, v80
v_mfma_f32_16x16x32_f16 v[220:223], v[124:127], v[212:215], v[220:223]
ds_read_b128 v[120:123], v248 offset:10496
v_exp_f16_sdwa v35, v35 dst_sel:WORD_0 dst_unused:UNUSED_PRESERVE src0_sel:WORD_0
v_and_b32_sdwa v83, s47, v81 dst_sel:DWORD dst_unused:UNUSED_PAD src0_sel:DWORD src1_sel:WORD_1
v_and_b32_e64 v81, s47, v81
s_waitcnt lgkmcnt(8)
v_mfma_f32_16x16x32_bf16 v[88:91], v[184:187], v[44:47], v[88:91]
ds_read_u16_d16_hi v83, v83
ds_read_u16 v81, v81
v_lshl_add_u64 v[56:57], v[56:57], 0, v[58:59]
v_mfma_f32_16x16x32_f16 v[76:79], v[124:127], v[208:211], v[76:79]
v_exp_f16_sdwa v33, v33 dst_sel:WORD_1 dst_unused:UNUSED_PRESERVE src0_sel:WORD_1
v_mfma_f32_16x16x32_bf16 v[64:67], v[184:187], v[144:147], v[64:67]
ds_read_b128 v[124:127], v252 offset:15360
s_setprio 1
v_exp_f16_sdwa v35, v35 dst_sel:WORD_1 dst_unused:UNUSED_PRESERVE src0_sel:WORD_1
v_mfma_f32_16x16x32_f16 v[100:103], v[176:179], v[180:183], v[100:103]
v_lshl_add_u64 v[60:61], v[60:61], 0, v[62:63]
v_pk_add_f16 v33, v33, 1.0 op_sel_hi:[1,0]
v_mfma_f32_16x16x32_bf16 v[68:71], v[184:187], v[148:151], v[68:71]
ds_read_b128 v[184:187], v248 offset:12288
v_pk_add_f16 v35, v35, 1.0 op_sel_hi:[1,0]
v_mfma_f32_16x16x32_f16 v[104:107], v[176:179], v[212:215], v[104:107]
v_rcp_f16_sdwa v33, v33 dst_sel:WORD_0 dst_unused:UNUSED_PRESERVE src0_sel:WORD_0
v_mfma_f32_16x16x32_bf16 v[40:43], v[188:191], v[28:31], 0
v_rcp_f16_sdwa v35, v35 dst_sel:WORD_0 dst_unused:UNUSED_PRESERVE src0_sel:WORD_0
v_mfma_f32_16x16x32_f16 v[140:143], v[176:179], v[208:211], v[140:143]
ds_read_b128 v[176:179], v251 offset:8192
v_cvt_pkrtz_f16_f32 v64, v64, v65
v_mfma_f32_16x16x32_bf16 v[0:3], v[188:191], v[128:131], 0
v_cvt_pkrtz_f16_f32 v65, v66, v67
v_lshrrev_b64 v[64:65], 2, v[64:65]
v_mfma_f32_16x16x32_f16 v[232:235], v[160:163], v[180:183], v[232:235]
v_and_b32_sdwa v66, s47, v64 dst_sel:DWORD dst_unused:UNUSED_PAD src0_sel:DWORD src1_sel:WORD_1
v_and_b32_e64 v64, s47, v64
v_cvt_pk_f16_f32 v88, v88, v89
v_mfma_f32_16x16x32_bf16 v[172:175], v[188:191], v[136:139], 0
ds_read_u16_d16_hi v66, v66
ds_read_u16 v64, v64
v_rcp_f16_sdwa v33, v33 dst_sel:WORD_1 dst_unused:UNUSED_PRESERVE src0_sel:WORD_1
v_mfma_f32_16x16x32_f16 v[236:239], v[160:163], v[212:215], v[236:239]
v_cvt_pk_f16_f32 v90, v90, v91
v_pk_fma_f16 v89, v88, v88, s48
v_rcp_f16_sdwa v35, v35 dst_sel:WORD_1 dst_unused:UNUSED_PRESERVE src0_sel:WORD_1
s_waitcnt lgkmcnt(3)
v_mfma_f32_16x16x32_bf16 v[40:43], v[52:55], v[36:39], v[40:43]
ds_read_b128 v[188:191], v248 offset:14336
v_and_b32_sdwa v67, s47, v65 dst_sel:DWORD dst_unused:UNUSED_PAD src0_sel:DWORD src1_sel:WORD_1
v_and_b32 v65, s47, v65
v_pk_fma_f16 v91, v90, v90, s48
v_mfma_f32_16x16x32_f16 v[84:87], v[160:163], v[208:211], v[84:87]
ds_read_u16_d16_hi v67, v67
ds_read_u16 v65, v65
ds_read_b128 v[160:163], v251 offset:11264
v_pk_mul_f16 v89, v88, v89
v_pk_mul_f16 v26, v32, v33
v_mfma_f32_16x16x32_bf16 v[0:3], v[52:55], v[108:111], v[0:3]
s_setprio 0
v_pk_mul_f16 v91, v90, v91
v_cvt_pkrtz_f16_f32 v68, v68, v69
v_mfma_f32_16x16x32_f16 v[200:203], v[48:51], v[180:183], v[200:203]
v_cvt_pkrtz_f16_f32 v69, v70, v71
v_lshrrev_b64 v[68:69], 2, v[68:69]
v_and_b32_sdwa v70, s47, v68 dst_sel:DWORD dst_unused:UNUSED_PAD src0_sel:DWORD src1_sel:WORD_1
v_and_b32 v68, s47, v68
v_pk_mul_f16 v27, v34, v35
v_exp_f16_sdwa v89, v89 dst_sel:WORD_0 dst_unused:UNUSED_PRESERVE src0_sel:WORD_0
v_lshl_add_u64 v[58:59], v[152:153], 0, v[154:155]
v_mfma_f32_16x16x32_bf16 v[172:175], v[52:55], v[192:195], v[172:175]
ds_read_u16_d16_hi v70, v70
ds_read_u16 v68, v68
v_mfma_f32_16x16x32_f16 v[204:207], v[48:51], v[212:215], v[204:207]
ds_read_b128 v[52:55], v248 offset:16384
v_exp_f16_sdwa v91, v91 dst_sel:WORD_0 dst_unused:UNUSED_PRESERVE src0_sel:WORD_0
v_and_b32_sdwa v71, s47, v69 dst_sel:DWORD dst_unused:UNUSED_PAD src0_sel:DWORD src1_sel:WORD_1
v_and_b32_e64 v69, s47, v69
v_mfma_f32_16x16x32_bf16 v[40:43], v[120:123], v[44:47], v[40:43]
ds_read_u16_d16_hi v71, v71
ds_read_u16 v69, v69
v_mfma_f32_16x16x32_f16 v[244:247], v[48:51], v[208:211], v[244:247]
v_cvt_pk_bf16_f32 v132, v132, v133
v_cvt_pk_bf16_f32 v133, v134, v135
v_cvt_pk_bf16_f32 v134, v76, v77
v_cvt_pk_bf16_f32 v135, v78, v79
v_cvt_pk_bf16_f32 v168, v168, v169
v_cvt_pk_bf16_f32 v169, v170, v171
v_cvt_pk_bf16_f32 v170, v220, v221
v_cvt_pk_bf16_f32 v171, v222, v223
v_cvt_pk_bf16_f32 v164, v164, v165
v_cvt_pk_bf16_f32 v165, v166, v167
v_cvt_pk_bf16_f32 v166, v216, v217
v_cvt_pk_bf16_f32 v167, v218, v219
v_exp_f16_sdwa v89, v89 dst_sel:WORD_1 dst_unused:UNUSED_PRESERVE src0_sel:WORD_1
v_cvt_pk_bf16_f32 v140, v140, v141
v_cvt_pk_bf16_f32 v141, v142, v143
v_cvt_pk_bf16_f32 v142, v84, v85
v_cvt_pk_bf16_f32 v143, v86, v87
v_cvt_pk_bf16_f32 v104, v104, v105
ds_read_b128 v[76:79], v254 offset:8192
ds_read_b128 v[220:223], v254 offset:8208
ds_read_b128 v[48:51], v251 offset:9216
v_cvt_pk_bf16_f32 v105, v106, v107
v_cvt_pk_bf16_f32 v106, v236, v237
v_cvt_pk_bf16_f32 v107, v238, v239
v_cvt_pk_bf16_f32 v100, v100, v101
v_cvt_pk_bf16_f32 v101, v102, v103
v_cvt_pk_bf16_f32 v102, v232, v233
v_cvt_pk_bf16_f32 v103, v234, v235
v_mfma_f32_16x16x32_bf16 v[0:3], v[120:123], v[144:147], v[0:3]
s_waitcnt lgkmcnt(5)
ds_read_b128 v[84:87], v254 offset:8320
ds_read_b128 v[236:239], v254 offset:8336
v_mfma_f32_16x16x32_f16 v[4:7], v[124:127], v[180:183], v[4:7]
v_lshl_add_u64 v[62:63], v[80:81], 0, v[82:83]
v_exp_f16_sdwa v91, v91 dst_sel:WORD_1 dst_unused:UNUSED_PRESERVE src0_sel:WORD_1
v_cvt_pk_bf16_f32 v244, v244, v245
v_cvt_pk_bf16_f32 v245, v246, v247
v_cvt_pk_bf16_f32 v204, v204, v205
v_cvt_pk_bf16_f32 v205, v206, v207
v_mfma_f32_16x16x32_bf16 v[172:175], v[120:123], v[148:151], v[172:175]
v_pk_add_f16 v89, v89, 1.0 op_sel_hi:[1,0]
v_pk_add_f16 v91, v91, 1.0 op_sel_hi:[1,0]
v_mfma_f32_16x16x32_f16 v[224:227], v[124:127], v[212:215], v[224:227]
ds_read_b128 v[120:123], v248 offset:12544
v_rcp_f16_sdwa v89, v89 dst_sel:WORD_0 dst_unused:UNUSED_PRESERVE src0_sel:WORD_0
v_mfma_f32_16x16x32_bf16 v[156:159], v[184:187], v[28:31], 0
v_rcp_f16_sdwa v91, v91 dst_sel:WORD_0 dst_unused:UNUSED_PRESERVE src0_sel:WORD_0
v_mfma_f32_16x16x32_f16 v[92:95], v[124:127], v[208:211], v[92:95]
s_nop 2
v_cvt_pk_bf16_f32 v206, v224, v225
v_cvt_pk_bf16_f32 v207, v226, v227
v_mfma_f32_16x16x32_bf16 v[200:203], v[18:21], v[196:199], v[200:203]
ds_read_b128 v[224:227], v254 offset:16
ds_read_b128 v[124:127], v251 offset:12288
v_mfma_f32_16x16x32_bf16 v[4:7], v[16:19], v[196:199], v[4:7]
v_cvt_pkrtz_f16_f32 v40, v40, v41
v_cvt_pk_bf16_f32 v246, v92, v93
v_cvt_pk_bf16_f32 v247, v94, v95
v_mfma_f32_16x16x32_bf16 v[228:231], v[184:187], v[128:131], 0
ds_read_b128 v[92:95], v254
v_cvt_pk_bf16_f32 v200, v200, v201
v_cvt_pk_bf16_f32 v201, v202, v203
s_setprio 3
v_cvt_pk_bf16_f32 v202, v4, v5
v_cvt_pk_bf16_f32 v203, v6, v7
s_waitcnt lgkmcnt(4)
v_mfma_f32_16x16x32_f16 v[116:119], v[176:179], v[60:63], v[76:79]
v_cvt_pkrtz_f16_f32 v41, v42, v43
v_lshrrev_b64 v[40:41], 2, v[40:41]
v_and_b32_sdwa v42, s47, v40 dst_sel:DWORD dst_unused:UNUSED_PAD src0_sel:DWORD src1_sel:WORD_1
v_and_b32_e64 v40, s47, v40
v_mfma_f32_16x16x32_bf16 v[112:115], v[184:187], v[136:139], 0
ds_read_u16_d16_hi v42, v42
ds_read_u16 v40, v40
v_rcp_f16_sdwa v89, v89 dst_sel:WORD_1 dst_unused:UNUSED_PRESERVE src0_sel:WORD_1
buffer_store_dwordx4 v[132:135], v253, s[8:11], s70 offen sc1
buffer_store_dwordx4 v[140:143], v253, s[8:11], s70 offen offset:64 sc1
v_mfma_f32_16x16x32_f16 v[240:243], v[176:179], v[56:59], v[76:79]
ds_read_b128 v[184:187], v248 offset:14592
v_and_b32_sdwa v43, s47, v41 dst_sel:DWORD dst_unused:UNUSED_PAD src0_sel:DWORD src1_sel:WORD_1
v_and_b32_e64 v41, s47, v41
v_rcp_f16_sdwa v91, v91 dst_sel:WORD_1 dst_unused:UNUSED_PRESERVE src0_sel:WORD_1
v_mfma_f32_16x16x32_bf16 v[156:159], v[188:191], v[36:39], v[156:159]
ds_read_u16_d16_hi v43, v43
ds_read_u16 v41, v41
v_mfma_f32_16x16x32_f16 v[76:79], v[176:179], v[24:27], v[76:79]
v_cvt_pkrtz_f16_f32 v0, v0, v1
v_cvt_pkrtz_f16_f32 v1, v2, v3
v_lshrrev_b64 v[0:1], 2, v[0:1]
v_and_b32_sdwa v2, s47, v0 dst_sel:DWORD dst_unused:UNUSED_PAD src0_sel:DWORD src1_sel:WORD_1
v_and_b32_e64 v0, s47, v0
v_pk_mul_f16 v88, v88, v89
v_mfma_f32_16x16x32_bf16 v[228:231], v[188:191], v[108:111], v[228:231]
ds_read_u16_d16_hi v2, v2
ds_read_u16 v0, v0
ds_read_b128 v[176:179], v251 offset:10240
v_mfma_f32_16x16x32_f16 v[72:75], v[160:163], v[60:63], v[220:223]
v_and_b32_sdwa v3, s47, v1 dst_sel:DWORD dst_unused:UNUSED_PAD src0_sel:DWORD src1_sel:WORD_1
v_and_b32_e64 v1, s47, v1
v_pk_mul_f16 v89, v90, v91
v_lshl_add_u64 v[64:65], v[64:65], 0, v[66:67]
v_mfma_f32_16x16x32_bf16 v[112:115], v[188:191], v[192:195], v[112:115]
ds_read_u16_d16_hi v3, v3
ds_read_u16 v1, v1
v_cvt_pkrtz_f16_f32 v172, v172, v173
v_cvt_pkrtz_f16_f32 v173, v174, v175
v_lshrrev_b64 v[172:173], 2, v[172:173]
v_and_b32_sdwa v174, s47, v172 dst_sel:DWORD dst_unused:UNUSED_PAD src0_sel:DWORD src1_sel:WORD_1
v_and_b32 v172, s47, v172
v_mfma_f32_16x16x32_f16 v[8:11], v[160:163], v[56:59], v[220:223]
ds_read_u16_d16_hi v174, v174
s_waitcnt lgkmcnt(7)
ds_read_u16 v172, v172
ds_read_b128 v[188:191], v248 offset:16640
v_and_b32_sdwa v175, s47, v173 dst_sel:DWORD dst_unused:UNUSED_PAD src0_sel:DWORD src1_sel:WORD_1
v_and_b32_e64 v173, s47, v173
v_mfma_f32_16x16x32_bf16 v[156:159], v[52:55], v[44:47], v[156:159]
ds_read_u16_d16_hi v175, v175
ds_read_u16 v173, v173
v_mfma_f32_16x16x32_f16 v[220:223], v[160:163], v[24:27], v[220:223]
ds_read_b128 v[160:163], v251 offset:13312
s_setprio 2
v_lshl_add_u64 v[68:69], v[68:69], 0, v[70:71]
v_mfma_f32_16x16x32_bf16 v[228:231], v[52:55], v[144:147], v[228:231]
s_nop 0
v_cvt_pk_f16_f32 v156, v156, v157
v_mfma_f32_16x16x32_f16 v[12:15], v[48:51], v[60:63], v[84:87]
v_cvt_pk_f16_f32 v158, v158, v159
v_pk_fma_f16 v157, v156, v156, s48
v_mfma_f32_16x16x32_bf16 v[112:115], v[52:55], v[148:151], v[112:115]
ds_read_b128 v[52:55], v248 offset:18432
s_nop 0
v_cvt_pkrtz_f16_f32 v228, v228, v229
v_mfma_f32_16x16x32_f16 v[96:99], v[48:51], v[56:59], v[84:87]
v_cvt_pkrtz_f16_f32 v229, v230, v231
v_lshrrev_b64 v[228:229], 2, v[228:229]
v_mfma_f32_16x16x32_bf16 v[32:35], v[120:123], v[28:31], 0
v_and_b32_sdwa v230, s47, v228 dst_sel:DWORD dst_unused:UNUSED_PAD src0_sel:DWORD src1_sel:WORD_1
v_and_b32 v228, s47, v228
v_mfma_f32_16x16x32_f16 v[84:87], v[48:51], v[24:27], v[84:87]
ds_read_b128 v[48:51], v251 offset:14336
ds_read_u16_d16_hi v230, v230
v_mfma_f32_16x16x32_bf16 v[152:155], v[120:123], v[128:131], 0
s_waitcnt lgkmcnt(9)
ds_read_u16 v228, v228
v_and_b32_sdwa v231, s47, v229 dst_sel:DWORD dst_unused:UNUSED_PAD src0_sel:DWORD src1_sel:WORD_1
v_mfma_f32_16x16x32_f16 v[208:211], v[124:127], v[60:63], v[236:239]
v_and_b32 v229, s47, v229
v_pk_fma_f16 v159, v158, v158, s48
v_mfma_f32_16x16x32_bf16 v[80:83], v[120:123], v[136:139], 0
ds_read_b128 v[120:123], v248 offset:20480
ds_read_u16_d16_hi v231, v231
v_mfma_f32_16x16x32_f16 v[212:215], v[124:127], v[56:59], v[236:239]
ds_read_u16 v229, v229
v_pk_mul_f16 v157, v156, v157
v_mfma_f32_16x16x32_bf16 v[32:35], v[184:187], v[36:39], v[32:35]
v_pk_mul_f16 v159, v158, v159
v_cvt_pkrtz_f16_f32 v112, v112, v113
v_mfma_f32_16x16x32_f16 v[236:239], v[124:127], v[24:27], v[236:239]
ds_read_b128 v[124:127], v251 offset:17408
s_setprio 1
v_cvt_pkrtz_f16_f32 v113, v114, v115
v_mfma_f32_16x16x32_bf16 v[152:155], v[184:187], v[108:111], v[152:155]
v_lshrrev_b64 v[112:113], 2, v[112:113]
v_and_b32_sdwa v114, s47, v112 dst_sel:DWORD dst_unused:UNUSED_PAD src0_sel:DWORD src1_sel:WORD_1
v_mfma_f32_16x16x32_f16 v[180:183], v[176:179], v[60:63], v[92:95]
v_and_b32 v112, s47, v112
v_lshl_add_u64 v[90:91], v[40:41], 0, v[42:43]
v_exp_f16_sdwa v157, v157 dst_sel:WORD_0 dst_unused:UNUSED_PRESERVE src0_sel:WORD_0
v_mfma_f32_16x16x32_bf16 v[80:83], v[184:187], v[192:195], v[80:83]
ds_read_u16_d16_hi v114, v114
s_waitcnt lgkmcnt(7)
ds_read_u16 v112, v112
v_mfma_f32_16x16x32_f16 v[196:199], v[176:179], v[56:59], v[92:95]
ds_read_b128 v[184:187], v248 offset:22528
v_exp_f16_sdwa v159, v159 dst_sel:WORD_0 dst_unused:UNUSED_PRESERVE src0_sel:WORD_0
v_and_b32_sdwa v115, s47, v113 dst_sel:DWORD dst_unused:UNUSED_PAD src0_sel:DWORD src1_sel:WORD_1
v_and_b32 v113, s47, v113
v_mfma_f32_16x16x32_bf16 v[32:35], v[188:191], v[44:47], v[32:35]
ds_read_u16_d16_hi v115, v115
ds_read_u16 v113, v113
v_lshl_add_u64 v[66:67], v[0:1], 0, v[2:3]
v_mfma_f32_16x16x32_f16 v[92:95], v[176:179], v[24:27], v[92:95]
v_exp_f16_sdwa v157, v157 dst_sel:WORD_1 dst_unused:UNUSED_PRESERVE src0_sel:WORD_1
v_mfma_f32_16x16x32_bf16 v[152:155], v[188:191], v[144:147], v[152:155]
ds_read_b128 v[176:179], v251 offset:15360
v_exp_f16_sdwa v159, v159 dst_sel:WORD_1 dst_unused:UNUSED_PRESERVE src0_sel:WORD_1
v_mfma_f32_16x16x32_f16 v[216:219], v[160:163], v[60:63], v[224:227]
v_lshl_add_u64 v[70:71], v[172:173], 0, v[174:175]
v_pk_add_f16 v157, v157, 1.0 op_sel_hi:[1,0]
v_mfma_f32_16x16x32_bf16 v[80:83], v[188:191], v[148:151], v[80:83]
ds_read_b128 v[188:191], v248 offset:18688
v_pk_add_f16 v159, v159, 1.0 op_sel_hi:[1,0]
v_mfma_f32_16x16x32_f16 v[232:235], v[160:163], v[56:59], v[224:227]
v_rcp_f16_sdwa v157, v157 dst_sel:WORD_0 dst_unused:UNUSED_PRESERVE src0_sel:WORD_0
v_mfma_f32_16x16x32_bf16 v[4:7], v[52:55], v[28:31], 0
v_rcp_f16_sdwa v159, v159 dst_sel:WORD_0 dst_unused:UNUSED_PRESERVE src0_sel:WORD_0
v_mfma_f32_16x16x32_f16 v[224:227], v[160:163], v[24:27], v[224:227]
s_setprio 0
ds_read_b128 v[160:163], v251 offset:18432
v_cvt_pkrtz_f16_f32 v152, v152, v153
v_mfma_f32_16x16x32_bf16 v[132:135], v[52:55], v[128:131], 0
v_cvt_pkrtz_f16_f32 v153, v154, v155
v_lshrrev_b64 v[152:153], 2, v[152:153]
v_mfma_f32_16x16x32_f16 v[116:119], v[48:51], v[68:71], v[116:119]
v_and_b32_sdwa v154, s47, v152 dst_sel:DWORD dst_unused:UNUSED_PAD src0_sel:DWORD src1_sel:WORD_1
v_and_b32_e64 v152, s47, v152
v_cvt_pk_f16_f32 v32, v32, v33
v_mfma_f32_16x16x32_bf16 v[140:143], v[52:55], v[136:139], 0
ds_read_u16_d16_hi v154, v154
s_waitcnt lgkmcnt(5)
ds_read_u16 v152, v152
v_rcp_f16_sdwa v157, v157 dst_sel:WORD_1 dst_unused:UNUSED_PRESERVE src0_sel:WORD_1
v_mfma_f32_16x16x32_f16 v[240:243], v[48:51], v[64:67], v[240:243]
v_cvt_pk_f16_f32 v34, v34, v35
v_pk_fma_f16 v33, v32, v32, s48
v_rcp_f16_sdwa v159, v159 dst_sel:WORD_1 dst_unused:UNUSED_PRESERVE src0_sel:WORD_1
v_mfma_f32_16x16x32_bf16 v[4:7], v[120:123], v[36:39], v[4:7]
ds_read_b128 v[52:55], v248 offset:20736
v_and_b32_sdwa v155, s47, v153 dst_sel:DWORD dst_unused:UNUSED_PAD src0_sel:DWORD src1_sel:WORD_1
v_and_b32_e64 v153, s47, v153
v_pk_fma_f16 v35, v34, v34, s48
v_mfma_f32_16x16x32_f16 v[76:79], v[48:51], v[88:91], v[76:79]
ds_read_u16_d16_hi v155, v155
ds_read_u16 v153, v153
buffer_store_dwordx4 v[244:247], v253, s[8:11], s70 offen offset:128 sc1
buffer_store_dwordx4 v[168:171], v253, s[8:11], s70 offen offset:192 sc1
ds_read_b128 v[48:51], v251 offset:16384
v_pk_mul_f16 v33, v32, v33
v_pk_mul_f16 v156, v156, v157
v_mfma_f32_16x16x32_bf16 v[132:135], v[120:123], v[108:111], v[132:135]
v_pk_mul_f16 v35, v34, v35
v_cvt_pkrtz_f16_f32 v80, v80, v81
v_mfma_f32_16x16x32_f16 v[72:75], v[124:127], v[68:71], v[72:75]
v_cvt_pkrtz_f16_f32 v81, v82, v83
v_lshrrev_b64 v[80:81], 2, v[80:81]
v_and_b32_sdwa v82, s47, v80 dst_sel:DWORD dst_unused:UNUSED_PAD src0_sel:DWORD src1_sel:WORD_1
v_and_b32_e64 v80, s47, v80
v_pk_mul_f16 v157, v158, v159
v_exp_f16_sdwa v33, v33 dst_sel:WORD_0 dst_unused:UNUSED_PRESERVE src0_sel:WORD_0
v_lshl_add_u64 v[228:229], v[228:229], 0, v[230:231]
v_mfma_f32_16x16x32_bf16 v[140:143], v[120:123], v[192:195], v[140:143]
ds_read_u16_d16_hi v82, v82
ds_read_u16 v80, v80
v_mfma_f32_16x16x32_f16 v[8:11], v[124:127], v[64:67], v[8:11]
ds_read_b128 v[120:123], v248 offset:22784
v_exp_f16_sdwa v35, v35 dst_sel:WORD_0 dst_unused:UNUSED_PRESERVE src0_sel:WORD_0
v_and_b32_sdwa v83, s47, v81 dst_sel:DWORD dst_unused:UNUSED_PAD src0_sel:DWORD src1_sel:WORD_1
v_and_b32_e64 v81, s47, v81
v_mfma_f32_16x16x32_bf16 v[4:7], v[184:187], v[44:47], v[4:7]
ds_read_u16_d16_hi v83, v83
ds_read_u16 v81, v81
v_mfma_f32_16x16x32_f16 v[220:223], v[124:127], v[88:91], v[220:223]
v_exp_f16_sdwa v33, v33 dst_sel:WORD_1 dst_unused:UNUSED_PRESERVE src0_sel:WORD_1
s_setprio 3
s_waitcnt lgkmcnt(6)
ds_read_b128 v[124:127], v251 offset:19456
v_mfma_f32_16x16x32_bf16 v[132:135], v[184:187], v[144:147], v[132:135]
v_lshl_add_u64 v[112:113], v[112:113], 0, v[114:115]
v_exp_f16_sdwa v35, v35 dst_sel:WORD_1 dst_unused:UNUSED_PRESERVE src0_sel:WORD_1
v_mfma_f32_16x16x32_f16 v[12:15], v[176:179], v[68:71], v[12:15]
v_pk_add_f16 v33, v33, 1.0 op_sel_hi:[1,0]
v_pk_add_f16 v35, v35, 1.0 op_sel_hi:[1,0]
v_mfma_f32_16x16x32_bf16 v[140:143], v[184:187], v[148:151], v[140:143]
ds_read_b128 v[184:187], v248 offset:24576
v_rcp_f16_sdwa v33, v33 dst_sel:WORD_0 dst_unused:UNUSED_PRESERVE src0_sel:WORD_0
v_mfma_f32_16x16x32_f16 v[96:99], v[176:179], v[64:67], v[96:99]
v_rcp_f16_sdwa v35, v35 dst_sel:WORD_0 dst_unused:UNUSED_PRESERVE src0_sel:WORD_0
v_mfma_f32_16x16x32_bf16 v[40:43], v[188:191], v[28:31], 0
v_cvt_pkrtz_f16_f32 v4, v4, v5
v_cvt_pkrtz_f16_f32 v5, v6, v7
v_mfma_f32_16x16x32_f16 v[84:87], v[176:179], v[88:91], v[84:87]
ds_read_b128 v[176:179], v251 offset:20480
v_lshrrev_b64 v[4:5], 2, v[4:5]
v_mfma_f32_16x16x32_bf16 v[0:3], v[188:191], v[128:131], 0
v_and_b32_sdwa v6, s47, v4 dst_sel:DWORD dst_unused:UNUSED_PAD src0_sel:DWORD src1_sel:WORD_1
v_and_b32_e64 v4, s47, v4
v_mfma_f32_16x16x32_f16 v[208:211], v[160:163], v[68:71], v[208:211]
ds_read_u16_d16_hi v6, v6
ds_read_u16 v4, v4
v_mfma_f32_16x16x32_bf16 v[172:175], v[188:191], v[136:139], 0
v_rcp_f16_sdwa v33, v33 dst_sel:WORD_1 dst_unused:UNUSED_PRESERVE src0_sel:WORD_1
v_mfma_f32_16x16x32_f16 v[212:215], v[160:163], v[64:67], v[212:215]
ds_read_b128 v[188:191], v248 offset:26624
v_and_b32_sdwa v7, s47, v5 dst_sel:DWORD dst_unused:UNUSED_PAD src0_sel:DWORD src1_sel:WORD_1
v_and_b32 v5, s47, v5
v_rcp_f16_sdwa v35, v35 dst_sel:WORD_1 dst_unused:UNUSED_PRESERVE src0_sel:WORD_1
v_mfma_f32_16x16x32_bf16 v[40:43], v[52:55], v[36:39], v[40:43]
ds_read_u16_d16_hi v7, v7
ds_read_u16 v5, v5
v_mfma_f32_16x16x32_f16 v[236:239], v[160:163], v[88:91], v[236:239]
s_setprio 2
v_cvt_pkrtz_f16_f32 v132, v132, v133
v_cvt_pkrtz_f16_f32 v133, v134, v135
v_lshrrev_b64 v[132:133], 2, v[132:133]
v_and_b32_sdwa v134, s47, v132 dst_sel:DWORD dst_unused:UNUSED_PAD src0_sel:DWORD src1_sel:WORD_1
v_and_b32 v132, s47, v132
v_pk_mul_f16 v158, v32, v33
v_mfma_f32_16x16x32_bf16 v[0:3], v[52:55], v[108:111], v[0:3]
ds_read_u16_d16_hi v134, v134
s_waitcnt lgkmcnt(6)
ds_read_u16 v132, v132
ds_read_b128 v[160:163], v251 offset:23552
v_mfma_f32_16x16x32_f16 v[180:183], v[48:51], v[68:71], v[180:183]
v_and_b32_sdwa v135, s47, v133 dst_sel:DWORD dst_unused:UNUSED_PAD src0_sel:DWORD src1_sel:WORD_1
v_and_b32_e64 v133, s47, v133
v_pk_mul_f16 v159, v34, v35
v_lshl_add_u64 v[230:231], v[152:153], 0, v[154:155]
v_mfma_f32_16x16x32_bf16 v[172:175], v[52:55], v[192:195], v[172:175]
ds_read_u16_d16_hi v135, v135
ds_read_u16 v133, v133
v_cvt_pkrtz_f16_f32 v140, v140, v141
v_cvt_pkrtz_f16_f32 v141, v142, v143
v_lshrrev_b64 v[140:141], 2, v[140:141]
v_and_b32_sdwa v142, s47, v140 dst_sel:DWORD dst_unused:UNUSED_PAD src0_sel:DWORD src1_sel:WORD_1
v_and_b32_e64 v140, s47, v140
v_mfma_f32_16x16x32_f16 v[196:199], v[48:51], v[64:67], v[196:199]
ds_read_u16_d16_hi v142, v142
ds_read_u16 v140, v140
ds_read_b128 v[52:55], v248 offset:28672
v_and_b32_sdwa v143, s47, v141 dst_sel:DWORD dst_unused:UNUSED_PAD src0_sel:DWORD src1_sel:WORD_1
v_and_b32_e64 v141, s47, v141
v_mfma_f32_16x16x32_bf16 v[40:43], v[120:123], v[44:47], v[40:43]
ds_read_u16_d16_hi v143, v143
ds_read_u16 v141, v141
v_mfma_f32_16x16x32_f16 v[92:95], v[48:51], v[88:91], v[92:95]
s_waitcnt lgkmcnt(10)
ds_read_b128 v[48:51], v251 offset:21504
v_lshl_add_u64 v[114:115], v[80:81], 0, v[82:83]
v_mfma_f32_16x16x32_bf16 v[0:3], v[120:123], v[144:147], v[0:3]
s_nop 0
v_cvt_pk_f16_f32 v40, v40, v41
v_mfma_f32_16x16x32_f16 v[216:219], v[124:127], v[68:71], v[216:219]
v_cvt_pk_f16_f32 v42, v42, v43
v_pk_fma_f16 v41, v40, v40, s48
v_mfma_f32_16x16x32_bf16 v[172:175], v[120:123], v[148:151], v[172:175]
ds_read_b128 v[120:123], v248 offset:24832
s_nop 0
v_cvt_pkrtz_f16_f32 v0, v0, v1
v_mfma_f32_16x16x32_f16 v[232:235], v[124:127], v[64:67], v[232:235]
v_cvt_pkrtz_f16_f32 v1, v2, v3
v_lshrrev_b64 v[0:1], 2, v[0:1]
v_mfma_f32_16x16x32_bf16 v[24:27], v[184:187], v[28:31], 0
s_setprio 1
v_and_b32_sdwa v2, s47, v0 dst_sel:DWORD dst_unused:UNUSED_PAD src0_sel:DWORD src1_sel:WORD_1
v_and_b32_e64 v0, s47, v0
v_mfma_f32_16x16x32_f16 v[224:227], v[124:127], v[88:91], v[224:227]
ds_read_b128 v[124:127], v251 offset:24576
ds_read_u16_d16_hi v2, v2
v_mfma_f32_16x16x32_bf16 v[56:59], v[184:187], v[128:131], 0
ds_read_u16 v0, v0
v_and_b32_sdwa v3, s47, v1 dst_sel:DWORD dst_unused:UNUSED_PAD src0_sel:DWORD src1_sel:WORD_1
v_mfma_f32_16x16x32_f16 v[116:119], v[176:179], v[112:115], v[116:119]
v_and_b32 v1, s47, v1
v_pk_fma_f16 v43, v42, v42, s48
v_mfma_f32_16x16x32_bf16 v[60:63], v[184:187], v[136:139], 0
s_waitcnt lgkmcnt(8)
ds_read_b128 v[184:187], v248 offset:26880
ds_read_u16_d16_hi v3, v3
v_mfma_f32_16x16x32_f16 v[240:243], v[176:179], v[228:231], v[240:243]
ds_read_u16 v1, v1
v_pk_mul_f16 v41, v40, v41
v_mfma_f32_16x16x32_bf16 v[24:27], v[188:191], v[36:39], v[24:27]
v_pk_mul_f16 v43, v42, v43
v_cvt_pkrtz_f16_f32 v172, v172, v173
v_mfma_f32_16x16x32_f16 v[76:79], v[176:179], v[156:159], v[76:79]
ds_read_b128 v[176:179], v251 offset:22528
v_cvt_pkrtz_f16_f32 v173, v174, v175
v_mfma_f32_16x16x32_bf16 v[56:59], v[188:191], v[108:111], v[56:59]
v_lshrrev_b64 v[172:173], 2, v[172:173]
v_and_b32_sdwa v174, s47, v172 dst_sel:DWORD dst_unused:UNUSED_PAD src0_sel:DWORD src1_sel:WORD_1
v_mfma_f32_16x16x32_f16 v[72:75], v[160:163], v[112:115], v[72:75]
v_and_b32_e64 v172, s47, v172
v_lshl_add_u64 v[4:5], v[4:5], 0, v[6:7]
v_exp_f16_sdwa v41, v41 dst_sel:WORD_0 dst_unused:UNUSED_PRESERVE src0_sel:WORD_0
v_mfma_f32_16x16x32_bf16 v[60:63], v[188:191], v[192:195], v[60:63]
ds_read_u16_d16_hi v174, v174
ds_read_u16 v172, v172
buffer_store_dwordx4 v[104:107], v253, s[8:11], s70 offen offset:256 sc1
buffer_store_dwordx4 v[204:207], v253, s[8:11], s70 offen offset:320 sc1
v_mfma_f32_16x16x32_f16 v[8:11], v[160:163], v[228:231], v[8:11]
ds_read_b128 v[188:191], v248 offset:28928
v_exp_f16_sdwa v43, v43 dst_sel:WORD_0 dst_unused:UNUSED_PRESERVE src0_sel:WORD_0
v_and_b32_sdwa v175, s47, v173 dst_sel:DWORD dst_unused:UNUSED_PAD src0_sel:DWORD src1_sel:WORD_1
v_and_b32_e64 v173, s47, v173
s_waitcnt lgkmcnt(8)
v_mfma_f32_16x16x32_bf16 v[24:27], v[52:55], v[44:47], v[24:27]
ds_read_u16_d16_hi v175, v175
ds_read_u16 v173, v173
s_setprio 0
v_lshl_add_u64 v[132:133], v[132:133], 0, v[134:135]
v_mfma_f32_16x16x32_f16 v[220:223], v[160:163], v[156:159], v[220:223]
v_exp_f16_sdwa v41, v41 dst_sel:WORD_1 dst_unused:UNUSED_PRESERVE src0_sel:WORD_1
v_mfma_f32_16x16x32_bf16 v[56:59], v[52:55], v[144:147], v[56:59]
ds_read_b128 v[160:163], v251 offset:25600
v_exp_f16_sdwa v43, v43 dst_sel:WORD_1 dst_unused:UNUSED_PRESERVE src0_sel:WORD_1
v_mfma_f32_16x16x32_f16 v[12:15], v[48:51], v[112:115], v[12:15]
v_lshl_add_u64 v[140:141], v[140:141], 0, v[142:143]
v_pk_add_f16 v41, v41, 1.0 op_sel_hi:[1,0]
v_mfma_f32_16x16x32_bf16 v[60:63], v[52:55], v[148:151], v[60:63]
ds_read_b128 v[52:55], v248 offset:30720
v_pk_add_f16 v43, v43, 1.0 op_sel_hi:[1,0]
v_mfma_f32_16x16x32_f16 v[96:99], v[48:51], v[228:231], v[96:99]
v_rcp_f16_sdwa v41, v41 dst_sel:WORD_0 dst_unused:UNUSED_PRESERVE src0_sel:WORD_0
v_mfma_f32_16x16x32_bf16 v[244:247], v[120:123], v[28:31], 0
v_rcp_f16_sdwa v43, v43 dst_sel:WORD_0 dst_unused:UNUSED_PRESERVE src0_sel:WORD_0
v_mfma_f32_16x16x32_f16 v[84:87], v[48:51], v[156:159], v[84:87]
ds_read_b128 v[48:51], v251 offset:26624
v_cvt_pkrtz_f16_f32 v56, v56, v57
v_mfma_f32_16x16x32_bf16 v[168:171], v[120:123], v[128:131], 0
v_cvt_pkrtz_f16_f32 v57, v58, v59
v_lshrrev_b64 v[56:57], 2, v[56:57]
v_mfma_f32_16x16x32_f16 v[208:211], v[124:127], v[112:115], v[208:211]
v_and_b32_sdwa v58, s47, v56 dst_sel:DWORD dst_unused:UNUSED_PAD src0_sel:DWORD src1_sel:WORD_1
v_and_b32_e64 v56, s47, v56
v_cvt_pk_f16_f32 v24, v24, v25
v_mfma_f32_16x16x32_bf16 v[32:35], v[120:123], v[136:139], 0
ds_read_u16_d16_hi v58, v58
ds_read_u16 v56, v56
v_rcp_f16_sdwa v41, v41 dst_sel:WORD_1 dst_unused:UNUSED_PRESERVE src0_sel:WORD_1
v_mfma_f32_16x16x32_f16 v[212:215], v[124:127], v[228:231], v[212:215]
v_cvt_pk_f16_f32 v26, v26, v27
v_pk_fma_f16 v25, v24, v24, s48
v_rcp_f16_sdwa v43, v43 dst_sel:WORD_1 dst_unused:UNUSED_PRESERVE src0_sel:WORD_1
s_waitcnt lgkmcnt(3)
v_mfma_f32_16x16x32_bf16 v[244:247], v[184:187], v[36:39], v[244:247]
ds_read_b128 v[120:123], v248 offset:32768
s_setprio 3
v_and_b32_sdwa v59, s47, v57 dst_sel:DWORD dst_unused:UNUSED_PAD src0_sel:DWORD src1_sel:WORD_1
v_and_b32_e64 v57, s47, v57
v_pk_fma_f16 v27, v26, v26, s48
v_mfma_f32_16x16x32_f16 v[236:239], v[124:127], v[156:159], v[236:239]
ds_read_u16_d16_hi v59, v59
ds_read_u16 v57, v57
ds_read_b128 v[124:127], v251 offset:29696
v_pk_mul_f16 v25, v24, v25
v_pk_mul_f16 v6, v40, v41
v_mfma_f32_16x16x32_bf16 v[168:171], v[184:187], v[108:111], v[168:171]
v_pk_mul_f16 v27, v26, v27
buffer_load_dwordx4 v[152:155], v253, s[4:7], s69 offen offset:192
v_mfma_f32_16x16x32_f16 v[180:183], v[176:179], v[112:115], v[180:183]
v_cvt_pkrtz_f16_f32 v60, v60, v61
v_cvt_pkrtz_f16_f32 v61, v62, v63
v_lshrrev_b64 v[60:61], 2, v[60:61]
v_and_b32_sdwa v62, s47, v60 dst_sel:DWORD dst_unused:UNUSED_PAD src0_sel:DWORD src1_sel:WORD_1
v_and_b32_e64 v60, s47, v60
v_pk_mul_f16 v7, v42, v43
v_exp_f16_sdwa v25, v25 dst_sel:WORD_0 dst_unused:UNUSED_PRESERVE src0_sel:WORD_0
v_lshl_add_u64 v[134:135], v[0:1], 0, v[2:3]
v_mfma_f32_16x16x32_bf16 v[32:35], v[184:187], v[192:195], v[32:35]
ds_read_u16_d16_hi v62, v62
ds_read_u16 v60, v60
v_mfma_f32_16x16x32_f16 v[196:199], v[176:179], v[228:231], v[196:199]
ds_read_b128 v[184:187], v248 offset:34816
v_exp_f16_sdwa v27, v27 dst_sel:WORD_0 dst_unused:UNUSED_PRESERVE src0_sel:WORD_0
v_and_b32_sdwa v63, s47, v61 dst_sel:DWORD dst_unused:UNUSED_PAD src0_sel:DWORD src1_sel:WORD_1
v_and_b32_e64 v61, s47, v61
v_mfma_f32_16x16x32_bf16 v[244:247], v[188:191], v[44:47], v[244:247]
ds_read_u16_d16_hi v63, v63
ds_read_u16 v61, v61
v_mfma_f32_16x16x32_f16 v[92:95], v[176:179], v[156:159], v[92:95]
v_exp_f16_sdwa v25, v25 dst_sel:WORD_1 dst_unused:UNUSED_PRESERVE src0_sel:WORD_1
v_mfma_f32_16x16x32_bf16 v[168:171], v[188:191], v[144:147], v[168:171]
ds_read_b128 v[176:179], v251 offset:27648
v_lshl_add_u64 v[142:143], v[172:173], 0, v[174:175]
v_mfma_f32_16x16x32_f16 v[216:219], v[160:163], v[112:115], v[216:219]
v_exp_f16_sdwa v27, v27 dst_sel:WORD_1 dst_unused:UNUSED_PRESERVE src0_sel:WORD_1
v_mfma_f32_16x16x32_bf16 v[32:35], v[188:191], v[148:151], v[32:35]
v_pk_add_f16 v25, v25, 1.0 op_sel_hi:[1,0]
v_pk_add_f16 v27, v27, 1.0 op_sel_hi:[1,0]
v_mfma_f32_16x16x32_f16 v[232:235], v[160:163], v[228:231], v[232:235]
ds_read_b128 v[188:191], v248 offset:30976
s_setprio 2
v_rcp_f16_sdwa v25, v25 dst_sel:WORD_0 dst_unused:UNUSED_PRESERVE src0_sel:WORD_0
v_mfma_f32_16x16x32_bf16 v[80:83], v[52:55], v[28:31], 0
v_rcp_f16_sdwa v27, v27 dst_sel:WORD_0 dst_unused:UNUSED_PRESERVE src0_sel:WORD_0
v_mfma_f32_16x16x32_f16 v[224:227], v[160:163], v[156:159], v[224:227]
ds_read_b128 v[160:163], v251 offset:30720
v_cvt_pkrtz_f16_f32 v244, v244, v245
v_mfma_f32_16x16x32_bf16 v[88:91], v[52:55], v[128:131], 0
v_cvt_pkrtz_f16_f32 v245, v246, v247
v_lshrrev_b64 v[244:245], 2, v[244:245]
s_waitcnt lgkmcnt(4)
v_mfma_f32_16x16x32_f16 v[116:119], v[48:51], v[140:143], v[116:119]
v_and_b32_sdwa v246, s47, v244 dst_sel:DWORD dst_unused:UNUSED_PAD src0_sel:DWORD src1_sel:WORD_1
v_and_b32_e64 v244, s47, v244
v_mfma_f32_16x16x32_bf16 v[64:67], v[52:55], v[136:139], 0
ds_read_u16_d16_hi v246, v246
ds_read_u16 v244, v244
v_rcp_f16_sdwa v25, v25 dst_sel:WORD_1 dst_unused:UNUSED_PRESERVE src0_sel:WORD_1
v_mfma_f32_16x16x32_f16 v[240:243], v[48:51], v[132:135], v[240:243]
ds_read_b128 v[52:55], v248 offset:33024
v_and_b32_sdwa v247, s47, v245 dst_sel:DWORD dst_unused:UNUSED_PAD src0_sel:DWORD src1_sel:WORD_1
v_and_b32_e64 v245, s47, v245
v_rcp_f16_sdwa v27, v27 dst_sel:WORD_1 dst_unused:UNUSED_PRESERVE src0_sel:WORD_1
v_mfma_f32_16x16x32_bf16 v[80:83], v[120:123], v[36:39], v[80:83]
ds_read_u16_d16_hi v247, v247
ds_read_u16 v245, v245
v_mfma_f32_16x16x32_f16 v[76:79], v[48:51], v[4:7], v[76:79]
v_cvt_pkrtz_f16_f32 v168, v168, v169
v_cvt_pkrtz_f16_f32 v169, v170, v171
v_lshrrev_b64 v[168:169], 2, v[168:169]
v_and_b32_sdwa v170, s47, v168 dst_sel:DWORD dst_unused:UNUSED_PAD src0_sel:DWORD src1_sel:WORD_1
v_and_b32_e64 v168, s47, v168
v_pk_mul_f16 v24, v24, v25
v_mfma_f32_16x16x32_bf16 v[88:91], v[120:123], v[108:111], v[88:91]
ds_read_u16_d16_hi v170, v170
ds_read_u16 v168, v168
ds_read_b128 v[48:51], v251 offset:28672
v_mfma_f32_16x16x32_f16 v[72:75], v[124:127], v[140:143], v[72:75]
v_and_b32_sdwa v171, s47, v169 dst_sel:DWORD dst_unused:UNUSED_PAD src0_sel:DWORD src1_sel:WORD_1
v_and_b32_e64 v169, s47, v169
v_pk_mul_f16 v25, v26, v27
v_lshl_add_u64 v[56:57], v[56:57], 0, v[58:59]
v_mfma_f32_16x16x32_bf16 v[64:67], v[120:123], v[192:195], v[64:67]
ds_read_u16_d16_hi v171, v171
ds_read_u16 v169, v169
v_cvt_pkrtz_f16_f32 v32, v32, v33
v_cvt_pkrtz_f16_f32 v33, v34, v35
v_lshrrev_b64 v[32:33], 2, v[32:33]
v_and_b32_sdwa v34, s47, v32 dst_sel:DWORD dst_unused:UNUSED_PAD src0_sel:DWORD src1_sel:WORD_1
v_and_b32_e64 v32, s47, v32
v_mfma_f32_16x16x32_f16 v[8:11], v[124:127], v[132:135], v[8:11]
ds_read_u16_d16_hi v34, v34
s_waitcnt lgkmcnt(8)
ds_read_u16 v32, v32
ds_read_b128 v[120:123], v248 offset:35072
s_setprio 1
buffer_store_dwordx4 v[164:167], v253, s[8:11], s69 offen sc1
buffer_store_dwordx4 v[100:103], v253, s[8:11], s69 offen offset:64 sc1
v_and_b32_sdwa v35, s47, v33 dst_sel:DWORD dst_unused:UNUSED_PAD src0_sel:DWORD src1_sel:WORD_1
v_and_b32 v33, s47, v33
v_mfma_f32_16x16x32_bf16 v[80:83], v[184:187], v[44:47], v[80:83]
ds_read_u16_d16_hi v35, v35
ds_read_u16 v33, v33
v_mfma_f32_16x16x32_f16 v[220:223], v[124:127], v[4:7], v[220:223]
ds_read_b128 v[124:127], v251 offset:31744
v_lshl_add_u64 v[60:61], v[60:61], 0, v[62:63]
v_mfma_f32_16x16x32_bf16 v[88:91], v[184:187], v[144:147], v[88:91]
s_nop 1
v_cvt_pk_f16_f32 v80, v80, v81
v_mfma_f32_16x16x32_f16 v[12:15], v[176:179], v[140:143], v[12:15]
v_cvt_pk_f16_f32 v82, v82, v83
v_pk_fma_f16 v81, v80, v80, s48
v_mfma_f32_16x16x32_bf16 v[64:67], v[184:187], v[148:151], v[64:67]
ds_read_b128 v[184:187], v249
v_cvt_pkrtz_f16_f32 v88, v88, v89
v_mfma_f32_16x16x32_f16 v[96:99], v[176:179], v[132:135], v[96:99]
v_cvt_pkrtz_f16_f32 v89, v90, v91
v_lshrrev_b64 v[88:89], 2, v[88:89]
v_mfma_f32_16x16x32_bf16 v[68:71], v[188:191], v[28:31], 0
v_and_b32_sdwa v90, s47, v88 dst_sel:DWORD dst_unused:UNUSED_PAD src0_sel:DWORD src1_sel:WORD_1
v_and_b32 v88, s47, v88
v_mfma_f32_16x16x32_f16 v[84:87], v[176:179], v[4:7], v[84:87]
ds_read_b128 v[176:179], v251 offset:32768
s_waitcnt lgkmcnt(8)
ds_read_u16_d16_hi v90, v90
v_mfma_f32_16x16x32_bf16 v[104:107], v[188:191], v[128:131], 0
ds_read_u16 v88, v88
v_and_b32_sdwa v91, s47, v89 dst_sel:DWORD dst_unused:UNUSED_PAD src0_sel:DWORD src1_sel:WORD_1
v_mfma_f32_16x16x32_f16 v[208:211], v[160:163], v[140:143], v[208:211]
v_and_b32 v89, s47, v89
v_pk_fma_f16 v83, v82, v82, s48
v_mfma_f32_16x16x32_bf16 v[204:207], v[188:191], v[136:139], 0
ds_read_b128 v[188:191], v249 offset:2048
ds_read_u16_d16_hi v91, v91
v_mfma_f32_16x16x32_f16 v[212:215], v[160:163], v[132:135], v[212:215]
s_setprio 0
ds_read_u16 v89, v89
v_pk_mul_f16 v81, v80, v81
v_mfma_f32_16x16x32_bf16 v[68:71], v[52:55], v[36:39], v[68:71]
v_pk_mul_f16 v83, v82, v83
v_cvt_pkrtz_f16_f32 v64, v64, v65
v_mfma_f32_16x16x32_f16 v[236:239], v[160:163], v[4:7], v[236:239]
ds_read_b128 v[160:163], v251 offset:35840
v_cvt_pkrtz_f16_f32 v65, v66, v67
v_mfma_f32_16x16x32_bf16 v[104:107], v[52:55], v[108:111], v[104:107]
buffer_load_dwordx4 v[40:43], v253, s[4:7], s69 offen offset:256
buffer_load_dwordx4 v[0:3], v253, s[4:7], s69 offen offset:320
v_lshrrev_b64 v[64:65], 2, v[64:65]
v_mfma_f32_16x16x32_f16 v[180:183], v[48:51], v[140:143], v[180:183]
v_and_b32_sdwa v66, s47, v64 dst_sel:DWORD dst_unused:UNUSED_PAD src0_sel:DWORD src1_sel:WORD_1
v_and_b32 v64, s47, v64
v_lshl_add_u64 v[26:27], v[244:245], 0, v[246:247]
v_exp_f16_sdwa v81, v81 dst_sel:WORD_0 dst_unused:UNUSED_PRESERVE src0_sel:WORD_0
v_mfma_f32_16x16x32_bf16 v[204:207], v[52:55], v[192:195], v[204:207]
ds_read_u16_d16_hi v66, v66
s_waitcnt lgkmcnt(7)
ds_read_u16 v64, v64
v_mfma_f32_16x16x32_f16 v[196:199], v[48:51], v[132:135], v[196:199]
ds_read_b128 v[52:55], v249 offset:4096
v_exp_f16_sdwa v83, v83 dst_sel:WORD_0 dst_unused:UNUSED_PRESERVE src0_sel:WORD_0
v_and_b32_sdwa v67, s47, v65 dst_sel:DWORD dst_unused:UNUSED_PAD src0_sel:DWORD src1_sel:WORD_1
v_and_b32_e64 v65, s47, v65
v_mfma_f32_16x16x32_bf16 v[68:71], v[120:123], v[44:47], v[68:71]
ds_read_u16_d16_hi v67, v67
ds_read_u16 v65, v65
v_lshl_add_u64 v[58:59], v[168:169], 0, v[170:171]
v_mfma_f32_16x16x32_f16 v[92:95], v[48:51], v[4:7], v[92:95]
v_exp_f16_sdwa v81, v81 dst_sel:WORD_1 dst_unused:UNUSED_PRESERVE src0_sel:WORD_1
v_mfma_f32_16x16x32_bf16 v[104:107], v[120:123], v[144:147], v[104:107]
ds_read_b128 v[48:51], v251 offset:33792
v_exp_f16_sdwa v83, v83 dst_sel:WORD_1 dst_unused:UNUSED_PRESERVE src0_sel:WORD_1
v_mfma_f32_16x16x32_f16 v[216:219], v[124:127], v[140:143], v[216:219]
v_lshl_add_u64 v[62:63], v[32:33], 0, v[34:35]
v_pk_add_f16 v81, v81, 1.0 op_sel_hi:[1,0]
v_mfma_f32_16x16x32_bf16 v[204:207], v[120:123], v[148:151], v[204:207]
ds_read_b128 v[120:123], v249 offset:256
v_pk_add_f16 v83, v83, 1.0 op_sel_hi:[1,0]
v_mfma_f32_16x16x32_f16 v[232:235], v[124:127], v[132:135], v[232:235]
s_setprio 3
v_rcp_f16_sdwa v81, v81 dst_sel:WORD_0 dst_unused:UNUSED_PRESERVE src0_sel:WORD_0
v_mfma_f32_16x16x32_bf16 v[172:175], v[184:187], v[28:31], 0
v_rcp_f16_sdwa v83, v83 dst_sel:WORD_0 dst_unused:UNUSED_PRESERVE src0_sel:WORD_0
v_mfma_f32_16x16x32_f16 v[224:227], v[124:127], v[4:7], v[224:227]
ds_read_b128 v[124:127], v251 offset:36864
v_cvt_pkrtz_f16_f32 v104, v104, v105
v_mfma_f32_16x16x32_bf16 v[156:159], v[184:187], v[128:131], 0
v_cvt_pkrtz_f16_f32 v105, v106, v107
v_lshrrev_b64 v[104:105], 2, v[104:105]
v_mfma_f32_16x16x32_f16 v[116:119], v[176:179], v[60:63], v[116:119]
v_and_b32_sdwa v106, s47, v104 dst_sel:DWORD dst_unused:UNUSED_PAD src0_sel:DWORD src1_sel:WORD_1
v_and_b32_e64 v104, s47, v104
v_cvt_pk_f16_f32 v68, v68, v69
v_mfma_f32_16x16x32_bf16 v[228:231], v[184:187], v[136:139], 0
ds_read_u16_d16_hi v106, v106
s_waitcnt lgkmcnt(5)
ds_read_u16 v104, v104
v_rcp_f16_sdwa v81, v81 dst_sel:WORD_1 dst_unused:UNUSED_PRESERVE src0_sel:WORD_1
v_mfma_f32_16x16x32_f16 v[240:243], v[176:179], v[56:59], v[240:243]
v_cvt_pk_f16_f32 v70, v70, v71
v_pk_fma_f16 v69, v68, v68, s48
v_rcp_f16_sdwa v83, v83 dst_sel:WORD_1 dst_unused:UNUSED_PRESERVE src0_sel:WORD_1
v_mfma_f32_16x16x32_bf16 v[172:175], v[188:191], v[36:39], v[172:175]
ds_read_b128 v[184:187], v249 offset:2304
v_and_b32_sdwa v107, s47, v105 dst_sel:DWORD dst_unused:UNUSED_PAD src0_sel:DWORD src1_sel:WORD_1
v_and_b32_e64 v105, s47, v105
v_pk_fma_f16 v71, v70, v70, s48
v_mfma_f32_16x16x32_f16 v[76:79], v[176:179], v[24:27], v[76:79]
ds_read_u16_d16_hi v107, v107
ds_read_u16 v105, v105
ds_read_b128 v[176:179], v251 offset:34816
v_pk_mul_f16 v69, v68, v69
v_pk_mul_f16 v80, v80, v81
v_mfma_f32_16x16x32_bf16 v[156:159], v[188:191], v[108:111], v[156:159]
v_pk_mul_f16 v71, v70, v71
v_cvt_pkrtz_f16_f32 v204, v204, v205
v_mfma_f32_16x16x32_f16 v[72:75], v[160:163], v[60:63], v[72:75]
v_cvt_pkrtz_f16_f32 v205, v206, v207
v_lshrrev_b64 v[204:205], 2, v[204:205]
v_and_b32_sdwa v206, s47, v204 dst_sel:DWORD dst_unused:UNUSED_PAD src0_sel:DWORD src1_sel:WORD_1
v_and_b32_e64 v204, s47, v204
v_pk_mul_f16 v81, v82, v83
v_exp_f16_sdwa v69, v69 dst_sel:WORD_0 dst_unused:UNUSED_PRESERVE src0_sel:WORD_0
v_lshl_add_u64 v[88:89], v[88:89], 0, v[90:91]
v_mfma_f32_16x16x32_bf16 v[228:231], v[188:191], v[192:195], v[228:231]
ds_read_u16_d16_hi v206, v206
ds_read_u16 v204, v204
v_mfma_f32_16x16x32_f16 v[8:11], v[160:163], v[56:59], v[8:11]
s_setprio 2
ds_read_b128 v[188:191], v249 offset:4352
v_exp_f16_sdwa v71, v71 dst_sel:WORD_0 dst_unused:UNUSED_PRESERVE src0_sel:WORD_0
v_and_b32_sdwa v207, s47, v205 dst_sel:DWORD dst_unused:UNUSED_PAD src0_sel:DWORD src1_sel:WORD_1
v_and_b32_e64 v205, s47, v205
v_mfma_f32_16x16x32_bf16 v[172:175], v[52:55], v[44:47], v[172:175]
ds_read_u16_d16_hi v207, v207
ds_read_u16 v205, v205
v_mfma_f32_16x16x32_f16 v[220:223], v[160:163], v[24:27], v[220:223]
v_exp_f16_sdwa v69, v69 dst_sel:WORD_1 dst_unused:UNUSED_PRESERVE src0_sel:WORD_1
v_mfma_f32_16x16x32_bf16 v[156:159], v[52:55], v[144:147], v[156:159]
s_waitcnt lgkmcnt(6)
ds_read_b128 v[160:163], v251 offset:37888
buffer_store_dwordx4 v[200:203], v253, s[8:11], s69 offen offset:128 sc1
v_lshl_add_u64 v[64:65], v[64:65], 0, v[66:67]
v_mfma_f32_16x16x32_f16 v[12:15], v[48:51], v[60:63], v[12:15]
v_exp_f16_sdwa v71, v71 dst_sel:WORD_1 dst_unused:UNUSED_PRESERVE src0_sel:WORD_1
v_mfma_f32_16x16x32_bf16 v[228:231], v[52:55], v[148:151], v[228:231]
v_pk_add_f16 v69, v69, 1.0 op_sel_hi:[1,0]
v_pk_add_f16 v71, v71, 1.0 op_sel_hi:[1,0]
v_mfma_f32_16x16x32_f16 v[96:99], v[48:51], v[56:59], v[96:99]
ds_read_b128 v[52:55], v249 offset:6144
v_rcp_f16_sdwa v69, v69 dst_sel:WORD_0 dst_unused:UNUSED_PRESERVE src0_sel:WORD_0
v_mfma_f32_16x16x32_bf16 v[112:115], v[120:123], v[28:31], 0
v_rcp_f16_sdwa v71, v71 dst_sel:WORD_0 dst_unused:UNUSED_PRESERVE src0_sel:WORD_0
v_mfma_f32_16x16x32_f16 v[84:87], v[48:51], v[24:27], v[84:87]
ds_read_b128 v[48:51], v251 offset:38912
v_cvt_pkrtz_f16_f32 v172, v172, v173
v_mfma_f32_16x16x32_bf16 v[164:167], v[120:123], v[128:131], 0
v_cvt_pkrtz_f16_f32 v173, v174, v175
v_lshrrev_b64 v[172:173], 2, v[172:173]
v_mfma_f32_16x16x32_f16 v[208:211], v[124:127], v[60:63], v[208:211]
v_and_b32_sdwa v174, s47, v172 dst_sel:DWORD dst_unused:UNUSED_PAD src0_sel:DWORD src1_sel:WORD_1
v_and_b32_e64 v172, s47, v172
v_mfma_f32_16x16x32_bf16 v[100:103], v[120:123], v[136:139], 0
ds_read_u16_d16_hi v174, v174
ds_read_u16 v172, v172
v_rcp_f16_sdwa v69, v69 dst_sel:WORD_1 dst_unused:UNUSED_PRESERVE src0_sel:WORD_1
s_setprio 1
v_mfma_f32_16x16x32_f16 v[212:215], v[124:127], v[56:59], v[212:215]
ds_read_b128 v[120:123], v249 offset:8192
v_and_b32_sdwa v175, s47, v173 dst_sel:DWORD dst_unused:UNUSED_PAD src0_sel:DWORD src1_sel:WORD_1
v_and_b32 v173, s47, v173
v_rcp_f16_sdwa v71, v71 dst_sel:WORD_1 dst_unused:UNUSED_PRESERVE src0_sel:WORD_1
v_mfma_f32_16x16x32_bf16 v[112:115], v[184:187], v[36:39], v[112:115]
ds_read_u16_d16_hi v175, v175
ds_read_u16 v173, v173
v_mfma_f32_16x16x32_f16 v[236:239], v[124:127], v[24:27], v[236:239]
v_cvt_pkrtz_f16_f32 v156, v156, v157
v_cvt_pkrtz_f16_f32 v157, v158, v159
v_lshrrev_b64 v[156:157], 2, v[156:157]
v_and_b32_sdwa v158, s47, v156 dst_sel:DWORD dst_unused:UNUSED_PAD src0_sel:DWORD src1_sel:WORD_1
v_and_b32 v156, s47, v156
v_pk_mul_f16 v82, v68, v69
v_mfma_f32_16x16x32_bf16 v[164:167], v[184:187], v[108:111], v[164:167]
ds_read_u16_d16_hi v158, v158
s_waitcnt lgkmcnt(6)
ds_read_u16 v156, v156
ds_read_b128 v[124:127], v251 offset:41984
buffer_load_dwordx4 v[244:247], v253, s[4:7], s68 offen
buffer_load_dwordx4 v[168:171], v253, s[4:7], s68 offen offset:64
v_mfma_f32_16x16x32_f16 v[180:183], v[176:179], v[60:63], v[180:183]
v_and_b32_sdwa v159, s47, v157 dst_sel:DWORD dst_unused:UNUSED_PAD src0_sel:DWORD src1_sel:WORD_1
v_and_b32_e64 v157, s47, v157
v_pk_mul_f16 v83, v70, v71
v_lshl_add_u64 v[90:91], v[104:105], 0, v[106:107]
v_mfma_f32_16x16x32_bf16 v[100:103], v[184:187], v[192:195], v[100:103]
ds_read_u16_d16_hi v159, v159
ds_read_u16 v157, v157
v_cvt_pkrtz_f16_f32 v228, v228, v229
v_cvt_pkrtz_f16_f32 v229, v230, v231
v_lshrrev_b64 v[228:229], 2, v[228:229]
v_and_b32_sdwa v230, s47, v228 dst_sel:DWORD dst_unused:UNUSED_PAD src0_sel:DWORD src1_sel:WORD_1
v_and_b32_e64 v228, s47, v228
v_mfma_f32_16x16x32_f16 v[196:199], v[176:179], v[56:59], v[196:199]
ds_read_u16_d16_hi v230, v230
ds_read_u16 v228, v228
ds_read_b128 v[184:187], v249 offset:10240
v_and_b32_sdwa v231, s47, v229 dst_sel:DWORD dst_unused:UNUSED_PAD src0_sel:DWORD src1_sel:WORD_1
v_and_b32 v229, s47, v229
v_mfma_f32_16x16x32_bf16 v[112:115], v[188:191], v[44:47], v[112:115]
ds_read_u16_d16_hi v231, v231
ds_read_u16 v229, v229
v_mfma_f32_16x16x32_f16 v[92:95], v[176:179], v[24:27], v[92:95]
s_waitcnt lgkmcnt(10)
ds_read_b128 v[176:179], v251 offset:39936
v_lshl_add_u64 v[66:67], v[204:205], 0, v[206:207]
v_mfma_f32_16x16x32_bf16 v[164:167], v[188:191], v[144:147], v[164:167]
s_nop 0
v_cvt_pk_f16_f32 v112, v112, v113
v_mfma_f32_16x16x32_f16 v[216:219], v[160:163], v[60:63], v[216:219]
v_cvt_pk_f16_f32 v114, v114, v115
v_pk_fma_f16 v113, v112, v112, s48
v_mfma_f32_16x16x32_bf16 v[100:103], v[188:191], v[148:151], v[100:103]
s_setprio 0
ds_read_b128 v[188:191], v249 offset:6400
v_cvt_pkrtz_f16_f32 v164, v164, v165
v_mfma_f32_16x16x32_f16 v[232:235], v[160:163], v[56:59], v[232:235]
v_cvt_pkrtz_f16_f32 v165, v166, v167
v_lshrrev_b64 v[164:165], 2, v[164:165]
v_mfma_f32_16x16x32_bf16 v[32:35], v[52:55], v[28:31], 0
v_and_b32_sdwa v166, s47, v164 dst_sel:DWORD dst_unused:UNUSED_PAD src0_sel:DWORD src1_sel:WORD_1
v_and_b32_e64 v164, s47, v164
v_mfma_f32_16x16x32_f16 v[224:227], v[160:163], v[24:27], v[224:227]
ds_read_b128 v[160:163], v251 offset:43008
ds_read_u16_d16_hi v166, v166
v_mfma_f32_16x16x32_bf16 v[4:7], v[52:55], v[128:131], 0
ds_read_u16 v164, v164
v_and_b32_sdwa v167, s47, v165 dst_sel:DWORD dst_unused:UNUSED_PAD src0_sel:DWORD src1_sel:WORD_1
v_mfma_f32_16x16x32_f16 v[116:119], v[48:51], v[64:67], v[116:119]
v_and_b32 v165, s47, v165
v_pk_fma_f16 v115, v114, v114, s48
v_mfma_f32_16x16x32_bf16 v[132:135], v[52:55], v[136:139], 0
s_waitcnt lgkmcnt(8)
ds_read_b128 v[52:55], v249 offset:8448
ds_read_u16_d16_hi v167, v167
v_mfma_f32_16x16x32_f16 v[240:243], v[48:51], v[88:91], v[240:243]
ds_read_u16 v165, v165
v_pk_mul_f16 v113, v112, v113
v_mfma_f32_16x16x32_bf16 v[32:35], v[120:123], v[36:39], v[32:35]
v_pk_mul_f16 v115, v114, v115
v_cvt_pkrtz_f16_f32 v100, v100, v101
v_mfma_f32_16x16x32_f16 v[76:79], v[48:51], v[80:83], v[76:79]
ds_read_b128 v[48:51], v251 offset:40960
v_cvt_pkrtz_f16_f32 v101, v102, v103
v_mfma_f32_16x16x32_bf16 v[4:7], v[120:123], v[108:111], v[4:7]
v_lshrrev_b64 v[100:101], 2, v[100:101]
v_and_b32_sdwa v102, s47, v100 dst_sel:DWORD dst_unused:UNUSED_PAD src0_sel:DWORD src1_sel:WORD_1
v_mfma_f32_16x16x32_f16 v[72:75], v[124:127], v[64:67], v[72:75]
v_and_b32 v100, s47, v100
v_lshl_add_u64 v[172:173], v[172:173], 0, v[174:175]
v_exp_f16_sdwa v113, v113 dst_sel:WORD_0 dst_unused:UNUSED_PRESERVE src0_sel:WORD_0
v_mfma_f32_16x16x32_bf16 v[132:135], v[120:123], v[192:195], v[132:135]
ds_read_u16_d16_hi v102, v102
ds_read_u16 v100, v100
s_setprio 3
v_mfma_f32_16x16x32_f16 v[8:11], v[124:127], v[88:91], v[8:11]
ds_read_b128 v[120:123], v249 offset:10496
v_exp_f16_sdwa v115, v115 dst_sel:WORD_0 dst_unused:UNUSED_PRESERVE src0_sel:WORD_0
v_and_b32_sdwa v103, s47, v101 dst_sel:DWORD dst_unused:UNUSED_PAD src0_sel:DWORD src1_sel:WORD_1
v_and_b32 v101, s47, v101
s_waitcnt lgkmcnt(8)
v_mfma_f32_16x16x32_bf16 v[32:35], v[184:187], v[44:47], v[32:35]
ds_read_u16_d16_hi v103, v103
ds_read_u16 v101, v101
v_lshl_add_u64 v[156:157], v[156:157], 0, v[158:159]
v_mfma_f32_16x16x32_f16 v[220:223], v[124:127], v[80:83], v[220:223]
v_exp_f16_sdwa v113, v113 dst_sel:WORD_1 dst_unused:UNUSED_PRESERVE src0_sel:WORD_1
v_mfma_f32_16x16x32_bf16 v[4:7], v[184:187], v[144:147], v[4:7]
ds_read_b128 v[124:127], v251 offset:44032
v_exp_f16_sdwa v115, v115 dst_sel:WORD_1 dst_unused:UNUSED_PRESERVE src0_sel:WORD_1
v_mfma_f32_16x16x32_f16 v[12:15], v[176:179], v[64:67], v[12:15]
v_lshl_add_u64 v[228:229], v[228:229], 0, v[230:231]
v_pk_add_f16 v113, v113, 1.0 op_sel_hi:[1,0]
v_mfma_f32_16x16x32_bf16 v[132:135], v[184:187], v[148:151], v[132:135]
ds_read_b128 v[184:187], v249 offset:12288
v_pk_add_f16 v115, v115, 1.0 op_sel_hi:[1,0]
v_mfma_f32_16x16x32_f16 v[96:99], v[176:179], v[88:91], v[96:99]
v_rcp_f16_sdwa v113, v113 dst_sel:WORD_0 dst_unused:UNUSED_PRESERVE src0_sel:WORD_0
v_mfma_f32_16x16x32_bf16 v[140:143], v[188:191], v[28:31], 0
v_rcp_f16_sdwa v115, v115 dst_sel:WORD_0 dst_unused:UNUSED_PRESERVE src0_sel:WORD_0
v_mfma_f32_16x16x32_f16 v[84:87], v[176:179], v[80:83], v[84:87]
ds_read_b128 v[176:179], v251 offset:45056
v_cvt_pkrtz_f16_f32 v4, v4, v5
v_mfma_f32_16x16x32_bf16 v[200:203], v[188:191], v[128:131], 0
v_cvt_pkrtz_f16_f32 v5, v6, v7
v_lshrrev_b64 v[4:5], 2, v[4:5]
v_mfma_f32_16x16x32_f16 v[208:211], v[160:163], v[64:67], v[208:211]
v_and_b32_sdwa v6, s47, v4 dst_sel:DWORD dst_unused:UNUSED_PAD src0_sel:DWORD src1_sel:WORD_1
v_and_b32 v4, s47, v4
v_cvt_pk_f16_f32 v32, v32, v33
s_setprio 2
ds_read_u16_d16_hi v6, v6
ds_read_u16 v4, v4
v_mfma_f32_16x16x32_bf16 v[68:71], v[188:191], v[136:139], 0
v_rcp_f16_sdwa v113, v113 dst_sel:WORD_1 dst_unused:UNUSED_PRESERVE src0_sel:WORD_1
v_mfma_f32_16x16x32_f16 v[212:215], v[160:163], v[88:91], v[212:215]
v_cvt_pk_f16_f32 v34, v34, v35
v_pk_fma_f16 v33, v32, v32, s48
v_rcp_f16_sdwa v115, v115 dst_sel:WORD_1 dst_unused:UNUSED_PRESERVE src0_sel:WORD_1
s_waitcnt lgkmcnt(4)
v_mfma_f32_16x16x32_bf16 v[140:143], v[52:55], v[36:39], v[140:143]
ds_read_b128 v[188:191], v249 offset:14336
v_and_b32_sdwa v7, s47, v5 dst_sel:DWORD dst_unused:UNUSED_PAD src0_sel:DWORD src1_sel:WORD_1
v_and_b32 v5, s47, v5
v_pk_fma_f16 v35, v34, v34, s48
v_mfma_f32_16x16x32_f16 v[236:239], v[160:163], v[80:83], v[236:239]
ds_read_u16_d16_hi v7, v7
ds_read_u16 v5, v5
ds_read_b128 v[160:163], v251 offset:48128
v_pk_mul_f16 v33, v32, v33
v_pk_mul_f16 v174, v112, v113
v_mfma_f32_16x16x32_bf16 v[200:203], v[52:55], v[108:111], v[200:203]
v_pk_mul_f16 v35, v34, v35
buffer_load_dwordx4 v[104:107], v253, s[4:7], s68 offen offset:128
buffer_load_dwordx4 v[204:207], v253, s[4:7], s68 offen offset:192
v_mfma_f32_16x16x32_f16 v[180:183], v[48:51], v[64:67], v[180:183]
v_cvt_pkrtz_f16_f32 v132, v132, v133
v_cvt_pkrtz_f16_f32 v133, v134, v135
v_lshrrev_b64 v[132:133], 2, v[132:133]
v_and_b32_sdwa v134, s47, v132 dst_sel:DWORD dst_unused:UNUSED_PAD src0_sel:DWORD src1_sel:WORD_1
v_and_b32_e64 v132, s47, v132
v_pk_mul_f16 v175, v114, v115
v_exp_f16_sdwa v33, v33 dst_sel:WORD_0 dst_unused:UNUSED_PRESERVE src0_sel:WORD_0
v_lshl_add_u64 v[158:159], v[164:165], 0, v[166:167]
v_mfma_f32_16x16x32_bf16 v[68:71], v[52:55], v[192:195], v[68:71]
ds_read_u16_d16_hi v134, v134
ds_read_u16 v132, v132
v_mfma_f32_16x16x32_f16 v[196:199], v[48:51], v[88:91], v[196:199]
ds_read_b128 v[52:55], v249 offset:16384
v_exp_f16_sdwa v35, v35 dst_sel:WORD_0 dst_unused:UNUSED_PRESERVE src0_sel:WORD_0
v_and_b32_sdwa v135, s47, v133 dst_sel:DWORD dst_unused:UNUSED_PAD src0_sel:DWORD src1_sel:WORD_1
v_and_b32_e64 v133, s47, v133
v_mfma_f32_16x16x32_bf16 v[140:143], v[120:123], v[44:47], v[140:143]
ds_read_u16_d16_hi v135, v135
ds_read_u16 v133, v133
v_mfma_f32_16x16x32_f16 v[92:95], v[48:51], v[80:83], v[92:95]
v_exp_f16_sdwa v33, v33 dst_sel:WORD_1 dst_unused:UNUSED_PRESERVE src0_sel:WORD_1
v_mfma_f32_16x16x32_bf16 v[200:203], v[120:123], v[144:147], v[200:203]
ds_read_b128 v[48:51], v251 offset:46080
v_lshl_add_u64 v[230:231], v[100:101], 0, v[102:103]
v_mfma_f32_16x16x32_f16 v[216:219], v[124:127], v[64:67], v[216:219]
v_exp_f16_sdwa v35, v35 dst_sel:WORD_1 dst_unused:UNUSED_PRESERVE src0_sel:WORD_1
s_setprio 1
v_mfma_f32_16x16x32_bf16 v[68:71], v[120:123], v[148:151], v[68:71]
v_pk_add_f16 v33, v33, 1.0 op_sel_hi:[1,0]
v_pk_add_f16 v35, v35, 1.0 op_sel_hi:[1,0]
v_mfma_f32_16x16x32_f16 v[232:235], v[124:127], v[88:91], v[232:235]
ds_read_b128 v[120:123], v249 offset:12544
v_rcp_f16_sdwa v33, v33 dst_sel:WORD_0 dst_unused:UNUSED_PRESERVE src0_sel:WORD_0
s_waitcnt lgkmcnt(6)
v_mfma_f32_16x16x32_bf16 v[24:27], v[184:187], v[28:31], 0
v_rcp_f16_sdwa v35, v35 dst_sel:WORD_0 dst_unused:UNUSED_PRESERVE src0_sel:WORD_0
v_mfma_f32_16x16x32_f16 v[224:227], v[124:127], v[80:83], v[224:227]
ds_read_b128 v[124:127], v251 offset:49152
v_cvt_pkrtz_f16_f32 v140, v140, v141
v_mfma_f32_16x16x32_bf16 v[56:59], v[184:187], v[128:131], 0
v_cvt_pkrtz_f16_f32 v141, v142, v143
v_lshrrev_b64 v[140:141], 2, v[140:141]
v_mfma_f32_16x16x32_f16 v[116:119], v[176:179], v[228:231], v[116:119]
v_and_b32_sdwa v142, s47, v140 dst_sel:DWORD dst_unused:UNUSED_PAD src0_sel:DWORD src1_sel:WORD_1
v_and_b32_e64 v140, s47, v140
v_mfma_f32_16x16x32_bf16 v[60:63], v[184:187], v[136:139], 0
ds_read_u16_d16_hi v142, v142
ds_read_u16 v140, v140
v_rcp_f16_sdwa v33, v33 dst_sel:WORD_1 dst_unused:UNUSED_PRESERVE src0_sel:WORD_1
v_mfma_f32_16x16x32_f16 v[240:243], v[176:179], v[156:159], v[240:243]
ds_read_b128 v[184:187], v249 offset:14592
v_and_b32_sdwa v143, s47, v141 dst_sel:DWORD dst_unused:UNUSED_PAD src0_sel:DWORD src1_sel:WORD_1
v_and_b32_e64 v141, s47, v141
v_rcp_f16_sdwa v35, v35 dst_sel:WORD_1 dst_unused:UNUSED_PRESERVE src0_sel:WORD_1
v_mfma_f32_16x16x32_bf16 v[24:27], v[188:191], v[36:39], v[24:27]
ds_read_u16_d16_hi v143, v143
ds_read_u16 v141, v141
v_mfma_f32_16x16x32_f16 v[76:79], v[176:179], v[172:175], v[76:79]
v_cvt_pkrtz_f16_f32 v200, v200, v201
v_cvt_pkrtz_f16_f32 v201, v202, v203
v_lshrrev_b64 v[200:201], 2, v[200:201]
v_and_b32_sdwa v202, s47, v200 dst_sel:DWORD dst_unused:UNUSED_PAD src0_sel:DWORD src1_sel:WORD_1
v_and_b32_e64 v200, s47, v200
v_pk_mul_f16 v32, v32, v33
v_mfma_f32_16x16x32_bf16 v[56:59], v[188:191], v[108:111], v[56:59]
ds_read_u16_d16_hi v202, v202
ds_read_u16 v200, v200
ds_read_b128 v[176:179], v251 offset:47104
v_mfma_f32_16x16x32_f16 v[72:75], v[160:163], v[228:231], v[72:75]
v_and_b32_sdwa v203, s47, v201 dst_sel:DWORD dst_unused:UNUSED_PAD src0_sel:DWORD src1_sel:WORD_1
v_and_b32_e64 v201, s47, v201
v_pk_mul_f16 v33, v34, v35
v_lshl_add_u64 v[4:5], v[4:5], 0, v[6:7]
v_mfma_f32_16x16x32_bf16 v[60:63], v[188:191], v[192:195], v[60:63]
s_waitcnt lgkmcnt(7)
ds_read_u16_d16_hi v203, v203
ds_read_u16 v201, v201
s_setprio 0
v_cvt_pkrtz_f16_f32 v68, v68, v69
v_cvt_pkrtz_f16_f32 v69, v70, v71
v_lshrrev_b64 v[68:69], 2, v[68:69]
v_and_b32_sdwa v70, s47, v68 dst_sel:DWORD dst_unused:UNUSED_PAD src0_sel:DWORD src1_sel:WORD_1
v_and_b32_e64 v68, s47, v68
v_mfma_f32_16x16x32_f16 v[8:11], v[160:163], v[156:159], v[8:11]
ds_read_u16_d16_hi v70, v70
ds_read_u16 v68, v68
ds_read_b128 v[188:191], v249 offset:16640
v_and_b32_sdwa v71, s47, v69 dst_sel:DWORD dst_unused:UNUSED_PAD src0_sel:DWORD src1_sel:WORD_1
v_and_b32_e64 v69, s47, v69
v_mfma_f32_16x16x32_bf16 v[24:27], v[52:55], v[44:47], v[24:27]
ds_read_u16_d16_hi v71, v71
ds_read_u16 v69, v69
v_mfma_f32_16x16x32_f16 v[220:223], v[160:163], v[172:175], v[220:223]
ds_read_b128 v[160:163], v251 offset:50176
v_lshl_add_u64 v[132:133], v[132:133], 0, v[134:135]
v_mfma_f32_16x16x32_bf16 v[56:59], v[52:55], v[144:147], v[56:59]
s_nop 1
v_cvt_pk_f16_f32 v24, v24, v25
v_mfma_f32_16x16x32_f16 v[12:15], v[48:51], v[228:231], v[12:15]
v_cvt_pk_f16_f32 v26, v26, v27
v_pk_fma_f16 v25, v24, v24, s48
v_mfma_f32_16x16x32_bf16 v[60:63], v[52:55], v[148:151], v[60:63]
s_waitcnt lgkmcnt(9)
ds_read_b128 v[52:55], v249 offset:18432
v_cvt_pkrtz_f16_f32 v56, v56, v57
v_mfma_f32_16x16x32_f16 v[96:99], v[48:51], v[156:159], v[96:99]
v_cvt_pkrtz_f16_f32 v57, v58, v59
v_lshrrev_b64 v[56:57], 2, v[56:57]
v_mfma_f32_16x16x32_bf16 v[112:115], v[120:123], v[28:31], 0
v_and_b32_sdwa v58, s47, v56 dst_sel:DWORD dst_unused:UNUSED_PAD src0_sel:DWORD src1_sel:WORD_1
v_and_b32_e64 v56, s47, v56
v_mfma_f32_16x16x32_f16 v[84:87], v[48:51], v[172:175], v[84:87]
ds_read_b128 v[48:51], v251 offset:51200
ds_read_u16_d16_hi v58, v58
v_mfma_f32_16x16x32_bf16 v[164:167], v[120:123], v[128:131], 0
ds_read_u16 v56, v56
v_and_b32_sdwa v59, s47, v57 dst_sel:DWORD dst_unused:UNUSED_PAD src0_sel:DWORD src1_sel:WORD_1
v_mfma_f32_16x16x32_f16 v[208:211], v[124:127], v[228:231], v[208:211]
s_setprio 3
v_and_b32_e64 v57, s47, v57
v_pk_fma_f16 v27, v26, v26, s48
v_mfma_f32_16x16x32_bf16 v[100:103], v[120:123], v[136:139], 0
ds_read_b128 v[120:123], v249 offset:20480
ds_read_u16_d16_hi v59, v59
v_mfma_f32_16x16x32_f16 v[212:215], v[124:127], v[156:159], v[212:215]
s_waitcnt lgkmcnt(10)
ds_read_u16 v57, v57
v_pk_mul_f16 v25, v24, v25
v_mfma_f32_16x16x32_bf16 v[112:115], v[184:187], v[36:39], v[112:115]
v_pk_mul_f16 v27, v26, v27
v_cvt_pkrtz_f16_f32 v60, v60, v61
v_mfma_f32_16x16x32_f16 v[236:239], v[124:127], v[172:175], v[236:239]
ds_read_b128 v[124:127], v251 offset:54272
v_cvt_pkrtz_f16_f32 v61, v62, v63
v_mfma_f32_16x16x32_bf16 v[164:167], v[184:187], v[108:111], v[164:167]
buffer_load_dwordx4 v[80:83], v253, s[4:7], s68 offen offset:256
buffer_load_dwordx4 v[88:91], v253, s[4:7], s68 offen offset:320
v_lshrrev_b64 v[60:61], 2, v[60:61]
v_mfma_f32_16x16x32_f16 v[180:183], v[176:179], v[228:231], v[180:183]
v_and_b32_sdwa v62, s47, v60 dst_sel:DWORD dst_unused:UNUSED_PAD src0_sel:DWORD src1_sel:WORD_1
v_and_b32_e64 v60, s47, v60
v_lshl_add_u64 v[34:35], v[140:141], 0, v[142:143]
v_exp_f16_sdwa v25, v25 dst_sel:WORD_0 dst_unused:UNUSED_PRESERVE src0_sel:WORD_0
v_mfma_f32_16x16x32_bf16 v[100:103], v[184:187], v[192:195], v[100:103]
ds_read_u16_d16_hi v62, v62
ds_read_u16 v60, v60
v_mfma_f32_16x16x32_f16 v[196:199], v[176:179], v[156:159], v[196:199]
ds_read_b128 v[184:187], v249 offset:22528
v_exp_f16_sdwa v27, v27 dst_sel:WORD_0 dst_unused:UNUSED_PRESERVE src0_sel:WORD_0
v_and_b32_sdwa v63, s47, v61 dst_sel:DWORD dst_unused:UNUSED_PAD src0_sel:DWORD src1_sel:WORD_1
v_and_b32 v61, s47, v61
s_waitcnt lgkmcnt(8)
v_mfma_f32_16x16x32_bf16 v[112:115], v[188:191], v[44:47], v[112:115]
ds_read_u16_d16_hi v63, v63
ds_read_u16 v61, v61
v_lshl_add_u64 v[6:7], v[200:201], 0, v[202:203]
v_mfma_f32_16x16x32_f16 v[92:95], v[176:179], v[172:175], v[92:95]
v_exp_f16_sdwa v25, v25 dst_sel:WORD_1 dst_unused:UNUSED_PRESERVE src0_sel:WORD_1
v_mfma_f32_16x16x32_bf16 v[164:167], v[188:191], v[144:147], v[164:167]
ds_read_b128 v[176:179], v251 offset:52224
v_exp_f16_sdwa v27, v27 dst_sel:WORD_1 dst_unused:UNUSED_PRESERVE src0_sel:WORD_1
v_mfma_f32_16x16x32_f16 v[216:219], v[160:163], v[228:231], v[216:219]
s_setprio 2
v_lshl_add_u64 v[134:135], v[68:69], 0, v[70:71]
v_pk_add_f16 v25, v25, 1.0 op_sel_hi:[1,0]
v_mfma_f32_16x16x32_bf16 v[100:103], v[188:191], v[148:151], v[100:103]
ds_read_b128 v[188:191], v249 offset:18688
v_pk_add_f16 v27, v27, 1.0 op_sel_hi:[1,0]
v_mfma_f32_16x16x32_f16 v[232:235], v[160:163], v[156:159], v[232:235]
v_rcp_f16_sdwa v25, v25 dst_sel:WORD_0 dst_unused:UNUSED_PRESERVE src0_sel:WORD_0
v_mfma_f32_16x16x32_bf16 v[64:67], v[52:55], v[28:31], 0
v_rcp_f16_sdwa v27, v27 dst_sel:WORD_0 dst_unused:UNUSED_PRESERVE src0_sel:WORD_0
v_mfma_f32_16x16x32_f16 v[224:227], v[160:163], v[172:175], v[224:227]
ds_read_b128 v[160:163], v251 offset:55296
v_cvt_pkrtz_f16_f32 v164, v164, v165
s_waitcnt vmcnt(11)
v_mfma_f32_16x16x32_bf16 v[76:79], v[18:21], v[152:155], v[76:79]
v_cvt_pkrtz_f16_f32 v165, v166, v167
v_lshrrev_b64 v[164:165], 2, v[164:165]
v_mfma_f32_16x16x32_bf16 v[220:223], v[16:19], v[152:155], v[220:223]
v_and_b32_sdwa v166, s47, v164 dst_sel:DWORD dst_unused:UNUSED_PAD src0_sel:DWORD src1_sel:WORD_1
v_and_b32_e64 v164, s47, v164
v_mfma_f32_16x16x32_bf16 v[140:143], v[52:55], v[128:131], 0
ds_read_u16_d16_hi v166, v166
ds_read_u16 v164, v164
v_mfma_f32_16x16x32_f16 v[116:119], v[48:51], v[132:135], v[116:119]
v_cvt_pk_f16_f32 v112, v112, v113
v_rcp_f16_sdwa v25, v25 dst_sel:WORD_1 dst_unused:UNUSED_PRESERVE src0_sel:WORD_1
v_mfma_f32_16x16x32_bf16 v[200:203], v[52:55], v[136:139], 0
v_cvt_pk_f16_f32 v114, v114, v115
v_pk_fma_f16 v113, v112, v112, s48
v_mfma_f32_16x16x32_f16 v[240:243], v[48:51], v[4:7], v[240:243]
s_waitcnt lgkmcnt(3)
ds_read_b128 v[52:55], v249 offset:20736
v_rcp_f16_sdwa v27, v27 dst_sel:WORD_1 dst_unused:UNUSED_PRESERVE src0_sel:WORD_1
v_mfma_f32_16x16x32_bf16 v[64:67], v[120:123], v[36:39], v[64:67]
v_and_b32_sdwa v167, s47, v165 dst_sel:DWORD dst_unused:UNUSED_PAD src0_sel:DWORD src1_sel:WORD_1
v_and_b32 v165, s47, v165
v_pk_fma_f16 v115, v114, v114, s48
v_mfma_f32_16x16x32_f16 v[76:79], v[48:51], v[32:35], v[76:79]
ds_read_u16_d16_hi v167, v167
ds_read_u16 v165, v165
ds_read_b128 v[48:51], v251 offset:53248
v_pk_mul_f16 v113, v112, v113
v_pk_mul_f16 v24, v24, v25
v_mfma_f32_16x16x32_bf16 v[140:143], v[120:123], v[108:111], v[140:143]
v_pk_mul_f16 v115, v114, v115
s_setprio 1
v_cvt_pkrtz_f16_f32 v100, v100, v101
v_mfma_f32_16x16x32_f16 v[72:75], v[124:127], v[132:135], v[72:75]
v_cvt_pkrtz_f16_f32 v101, v102, v103
v_lshrrev_b64 v[100:101], 2, v[100:101]
v_and_b32_sdwa v102, s47, v100 dst_sel:DWORD dst_unused:UNUSED_PAD src0_sel:DWORD src1_sel:WORD_1
v_and_b32 v100, s47, v100
v_pk_mul_f16 v25, v26, v27
v_exp_f16_sdwa v113, v113 dst_sel:WORD_0 dst_unused:UNUSED_PRESERVE src0_sel:WORD_0
v_lshl_add_u64 v[56:57], v[56:57], 0, v[58:59]
v_mfma_f32_16x16x32_bf16 v[200:203], v[120:123], v[192:195], v[200:203]
ds_read_u16_d16_hi v102, v102
ds_read_u16 v100, v100
v_mfma_f32_16x16x32_f16 v[8:11], v[124:127], v[4:7], v[8:11]
ds_read_b128 v[120:123], v249 offset:22784
v_exp_f16_sdwa v115, v115 dst_sel:WORD_0 dst_unused:UNUSED_PRESERVE src0_sel:WORD_0
v_and_b32_sdwa v103, s47, v101 dst_sel:DWORD dst_unused:UNUSED_PAD src0_sel:DWORD src1_sel:WORD_1
v_and_b32_e64 v101, s47, v101
v_mfma_f32_16x16x32_bf16 v[64:67], v[184:187], v[44:47], v[64:67]
ds_read_u16_d16_hi v103, v103
ds_read_u16 v101, v101
v_mfma_f32_16x16x32_f16 v[220:223], v[124:127], v[32:35], v[220:223]
v_exp_f16_sdwa v113, v113 dst_sel:WORD_1 dst_unused:UNUSED_PRESERVE src0_sel:WORD_1
v_mfma_f32_16x16x32_bf16 v[140:143], v[184:187], v[144:147], v[140:143]
ds_read_b128 v[124:127], v251 offset:56320
v_lshl_add_u64 v[60:61], v[60:61], 0, v[62:63]
v_mfma_f32_16x16x32_f16 v[12:15], v[176:179], v[132:135], v[12:15]
v_exp_f16_sdwa v115, v115 dst_sel:WORD_1 dst_unused:UNUSED_PRESERVE src0_sel:WORD_1
v_mfma_f32_16x16x32_bf16 v[200:203], v[184:187], v[148:151], v[200:203]
v_pk_add_f16 v113, v113, 1.0 op_sel_hi:[1,0]
v_pk_add_f16 v115, v115, 1.0 op_sel_hi:[1,0]
v_mfma_f32_16x16x32_f16 v[96:99], v[176:179], v[4:7], v[96:99]
ds_read_b128 v[184:187], v249 offset:24576
v_rcp_f16_sdwa v113, v113 dst_sel:WORD_0 dst_unused:UNUSED_PRESERVE src0_sel:WORD_0
v_mfma_f32_16x16x32_bf16 v[68:71], v[188:191], v[28:31], 0
v_rcp_f16_sdwa v115, v115 dst_sel:WORD_0 dst_unused:UNUSED_PRESERVE src0_sel:WORD_0
v_mfma_f32_16x16x32_f16 v[84:87], v[176:179], v[32:35], v[84:87]
ds_read_b128 v[176:179], v251 offset:57344
v_cvt_pkrtz_f16_f32 v64, v64, v65
v_mfma_f32_16x16x32_bf16 v[172:175], v[188:191], v[128:131], 0
s_setprio 0
v_cvt_pkrtz_f16_f32 v65, v66, v67
v_lshrrev_b64 v[64:65], 2, v[64:65]
s_waitcnt lgkmcnt(4)
v_mfma_f32_16x16x32_f16 v[208:211], v[160:163], v[132:135], v[208:211]
v_and_b32_sdwa v66, s47, v64 dst_sel:DWORD dst_unused:UNUSED_PAD src0_sel:DWORD src1_sel:WORD_1
v_and_b32_e64 v64, s47, v64
v_mfma_f32_16x16x32_bf16 v[156:159], v[188:191], v[136:139], 0
ds_read_u16_d16_hi v66, v66
ds_read_u16 v64, v64
v_rcp_f16_sdwa v113, v113 dst_sel:WORD_1 dst_unused:UNUSED_PRESERVE src0_sel:WORD_1
v_mfma_f32_16x16x32_f16 v[212:215], v[160:163], v[4:7], v[212:215]
ds_read_b128 v[188:191], v249 offset:26624
v_and_b32_sdwa v67, s47, v65 dst_sel:DWORD dst_unused:UNUSED_PAD src0_sel:DWORD src1_sel:WORD_1
v_and_b32_e64 v65, s47, v65
v_rcp_f16_sdwa v115, v115 dst_sel:WORD_1 dst_unused:UNUSED_PRESERVE src0_sel:WORD_1
v_mfma_f32_16x16x32_bf16 v[68:71], v[52:55], v[36:39], v[68:71]
ds_read_u16_d16_hi v67, v67
ds_read_u16 v65, v65
v_mfma_f32_16x16x32_f16 v[236:239], v[160:163], v[32:35], v[236:239]
v_cvt_pkrtz_f16_f32 v140, v140, v141
v_cvt_pkrtz_f16_f32 v141, v142, v143
v_lshrrev_b64 v[140:141], 2, v[140:141]
v_and_b32_sdwa v142, s47, v140 dst_sel:DWORD dst_unused:UNUSED_PAD src0_sel:DWORD src1_sel:WORD_1
v_and_b32_e64 v140, s47, v140
v_pk_mul_f16 v26, v112, v113
v_mfma_f32_16x16x32_bf16 v[172:175], v[52:55], v[108:111], v[172:175]
ds_read_u16_d16_hi v142, v142
ds_read_u16 v140, v140
ds_read_b128 v[160:163], v251 offset:60416
v_mfma_f32_16x16x32_f16 v[180:183], v[48:51], v[132:135], v[180:183]
v_and_b32_sdwa v143, s47, v141 dst_sel:DWORD dst_unused:UNUSED_PAD src0_sel:DWORD src1_sel:WORD_1
v_and_b32_e64 v141, s47, v141
v_pk_mul_f16 v27, v114, v115
v_lshl_add_u64 v[58:59], v[164:165], 0, v[166:167]
v_mfma_f32_16x16x32_bf16 v[156:159], v[52:55], v[192:195], v[156:159]
ds_read_u16_d16_hi v143, v143
ds_read_u16 v141, v141
v_cvt_pkrtz_f16_f32 v200, v200, v201
v_cvt_pkrtz_f16_f32 v201, v202, v203
v_lshrrev_b64 v[200:201], 2, v[200:201]
v_and_b32_sdwa v202, s47, v200 dst_sel:DWORD dst_unused:UNUSED_PAD src0_sel:DWORD src1_sel:WORD_1
v_and_b32 v200, s47, v200
v_mfma_f32_16x16x32_f16 v[196:199], v[48:51], v[4:7], v[196:199]
ds_read_u16_d16_hi v202, v202
s_waitcnt lgkmcnt(8)
ds_read_u16 v200, v200
ds_read_b128 v[52:55], v249 offset:28672
v_and_b32_sdwa v203, s47, v201 dst_sel:DWORD dst_unused:UNUSED_PAD src0_sel:DWORD src1_sel:WORD_1
v_and_b32_e64 v201, s47, v201
v_mfma_f32_16x16x32_bf16 v[68:71], v[120:123], v[44:47], v[68:71]
ds_read_u16_d16_hi v203, v203
ds_read_u16 v201, v201
v_mfma_f32_16x16x32_f16 v[92:95], v[48:51], v[32:35], v[92:95]
ds_read_b128 v[48:51], v251 offset:58368
s_setprio 3
v_lshl_add_u64 v[62:63], v[100:101], 0, v[102:103]
v_mfma_f32_16x16x32_bf16 v[172:175], v[120:123], v[144:147], v[172:175]
s_nop 0
v_cvt_pk_f16_f32 v68, v68, v69
v_mfma_f32_16x16x32_f16 v[216:219], v[124:127], v[132:135], v[216:219]
v_cvt_pk_f16_f32 v70, v70, v71
v_pk_fma_f16 v69, v68, v68, s48
v_mfma_f32_16x16x32_bf16 v[156:159], v[120:123], v[148:151], v[156:159]
ds_read_b128 v[120:123], v249 offset:24832
s_nop 0
v_cvt_pkrtz_f16_f32 v172, v172, v173
v_mfma_f32_16x16x32_f16 v[232:235], v[124:127], v[4:7], v[232:235]
v_cvt_pkrtz_f16_f32 v173, v174, v175
v_lshrrev_b64 v[172:173], 2, v[172:173]
v_mfma_f32_16x16x32_bf16 v[228:231], v[184:187], v[28:31], 0
v_and_b32_sdwa v174, s47, v172 dst_sel:DWORD dst_unused:UNUSED_PAD src0_sel:DWORD src1_sel:WORD_1
v_and_b32 v172, s47, v172
v_mfma_f32_16x16x32_f16 v[224:227], v[124:127], v[32:35], v[224:227]
ds_read_b128 v[124:127], v251 offset:61440
s_waitcnt lgkmcnt(8)
ds_read_u16_d16_hi v174, v174
s_waitcnt vmcnt(8)
v_mfma_f32_16x16x32_bf16 v[84:87], v[18:21], v[40:43], v[84:87]
ds_read_u16 v172, v172
v_and_b32_sdwa v175, s47, v173 dst_sel:DWORD dst_unused:UNUSED_PAD src0_sel:DWORD src1_sel:WORD_1
v_mfma_f32_16x16x32_bf16 v[236:239], v[16:19], v[40:43], v[236:239]
v_and_b32 v173, s47, v173
v_pk_fma_f16 v71, v70, v70, s48
s_waitcnt vmcnt(7)
v_mfma_f32_16x16x32_bf16 v[92:95], v[18:21], v[0:3], v[92:95]
ds_read_u16_d16_hi v175, v175
ds_read_u16 v173, v173
v_mfma_f32_16x16x32_bf16 v[224:227], v[16:19], v[0:3], v[224:227]
v_pk_mul_f16 v69, v68, v69
v_pk_mul_f16 v71, v70, v71
v_mfma_f32_16x16x32_bf16 v[152:155], v[184:187], v[128:131], 0
v_cvt_pkrtz_f16_f32 v156, v156, v157
v_cvt_pkrtz_f16_f32 v157, v158, v159
v_mfma_f32_16x16x32_f16 v[116:119], v[176:179], v[60:63], v[116:119]
v_lshrrev_b64 v[156:157], 2, v[156:157]
v_and_b32_sdwa v158, s47, v156 dst_sel:DWORD dst_unused:UNUSED_PAD src0_sel:DWORD src1_sel:WORD_1
v_mfma_f32_16x16x32_bf16 v[112:115], v[184:187], v[136:139], 0
ds_read_b128 v[184:187], v249 offset:26880
v_and_b32_e64 v156, s47, v156
v_mfma_f32_16x16x32_f16 v[240:243], v[176:179], v[56:59], v[240:243]
ds_read_u16_d16_hi v158, v158
ds_read_u16 v156, v156
v_mfma_f32_16x16x32_bf16 v[228:231], v[188:191], v[36:39], v[228:231]
v_lshl_add_u64 v[64:65], v[64:65], 0, v[66:67]
v_exp_f16_sdwa v69, v69 dst_sel:WORD_0 dst_unused:UNUSED_PRESERVE src0_sel:WORD_0
v_mfma_f32_16x16x32_f16 v[76:79], v[176:179], v[24:27], v[76:79]
s_waitcnt lgkmcnt(7)
ds_read_b128 v[176:179], v251 offset:59392
s_setprio 2
v_exp_f16_sdwa v71, v71 dst_sel:WORD_0 dst_unused:UNUSED_PRESERVE src0_sel:WORD_0
v_mfma_f32_16x16x32_bf16 v[152:155], v[188:191], v[108:111], v[152:155]
v_and_b32_sdwa v159, s47, v157 dst_sel:DWORD dst_unused:UNUSED_PAD src0_sel:DWORD src1_sel:WORD_1
v_and_b32_e64 v157, s47, v157
v_mfma_f32_16x16x32_f16 v[72:75], v[160:163], v[60:63], v[72:75]
ds_read_u16_d16_hi v159, v159
ds_read_u16 v157, v157
v_mfma_f32_16x16x32_bf16 v[112:115], v[188:191], v[192:195], v[112:115]
ds_read_b128 v[188:191], v249 offset:28928
v_lshl_add_u64 v[140:141], v[140:141], 0, v[142:143]
v_mfma_f32_16x16x32_f16 v[8:11], v[160:163], v[56:59], v[8:11]
v_exp_f16_sdwa v69, v69 dst_sel:WORD_1 dst_unused:UNUSED_PRESERVE src0_sel:WORD_1
v_mfma_f32_16x16x32_bf16 v[228:231], v[52:55], v[44:47], v[228:231]
v_exp_f16_sdwa v71, v71 dst_sel:WORD_1 dst_unused:UNUSED_PRESERVE src0_sel:WORD_1
v_mfma_f32_16x16x32_f16 v[220:223], v[160:163], v[24:27], v[220:223]
ds_read_b128 v[160:163], v251 offset:62464
v_lshl_add_u64 v[200:201], v[200:201], 0, v[202:203]
v_mfma_f32_16x16x32_bf16 v[152:155], v[52:55], v[144:147], v[152:155]
v_pk_add_f16 v69, v69, 1.0 op_sel_hi:[1,0]
v_pk_add_f16 v71, v71, 1.0 op_sel_hi:[1,0]
v_mfma_f32_16x16x32_f16 v[12:15], v[48:51], v[60:63], v[12:15]
v_rcp_f16_sdwa v69, v69 dst_sel:WORD_0 dst_unused:UNUSED_PRESERVE src0_sel:WORD_0
v_mfma_f32_16x16x32_bf16 v[112:115], v[52:55], v[148:151], v[112:115]
ds_read_b128 v[52:55], v249 offset:30720
v_rcp_f16_sdwa v71, v71 dst_sel:WORD_0 dst_unused:UNUSED_PRESERVE src0_sel:WORD_0
v_mfma_f32_16x16x32_f16 v[96:99], v[48:51], v[56:59], v[96:99]
v_cvt_pkrtz_f16_f32 v152, v152, v153
v_cvt_pkrtz_f16_f32 v153, v154, v155
v_mfma_f32_16x16x32_bf16 v[164:167], v[120:123], v[28:31], 0
v_lshrrev_b64 v[152:153], 2, v[152:153]
v_and_b32_sdwa v154, s47, v152 dst_sel:DWORD dst_unused:UNUSED_PAD src0_sel:DWORD src1_sel:WORD_1
v_mfma_f32_16x16x32_f16 v[84:87], v[48:51], v[24:27], v[84:87]
ds_read_b128 v[48:51], v251 offset:63488
s_setprio 1
v_and_b32_e64 v152, s47, v152
v_mfma_f32_16x16x32_bf16 v[100:103], v[120:123], v[128:131], 0
ds_read_u16_d16_hi v154, v154
s_waitcnt lgkmcnt(5)
ds_read_u16 v152, v152
v_mfma_f32_16x16x32_f16 v[208:211], v[124:127], v[60:63], v[208:211]
v_cvt_pk_f16_f32 v228, v228, v229
v_rcp_f16_sdwa v69, v69 dst_sel:WORD_1 dst_unused:UNUSED_PRESERVE src0_sel:WORD_1
v_mfma_f32_16x16x32_bf16 v[32:35], v[120:123], v[136:139], 0
v_cvt_pk_f16_f32 v230, v230, v231
v_pk_fma_f16 v229, v228, v228, s48
v_mfma_f32_16x16x32_f16 v[212:215], v[124:127], v[56:59], v[212:215]
ds_read_b128 v[120:123], v249 offset:32768
v_rcp_f16_sdwa v71, v71 dst_sel:WORD_1 dst_unused:UNUSED_PRESERVE src0_sel:WORD_1
v_mfma_f32_16x16x32_bf16 v[164:167], v[184:187], v[36:39], v[164:167]
v_and_b32_sdwa v155, s47, v153 dst_sel:DWORD dst_unused:UNUSED_PAD src0_sel:DWORD src1_sel:WORD_1
v_and_b32_e64 v153, s47, v153
v_pk_fma_f16 v231, v230, v230, s48
v_mfma_f32_16x16x32_f16 v[236:239], v[124:127], v[24:27], v[236:239]
ds_read_u16_d16_hi v155, v155
ds_read_u16 v153, v153
ds_read_b128 v[124:127], v252 offset:1024
v_pk_mul_f16 v229, v228, v229
v_pk_mul_f16 v66, v68, v69
v_mfma_f32_16x16x32_bf16 v[100:103], v[184:187], v[108:111], v[100:103]
v_pk_mul_f16 v231, v230, v231
v_cvt_pkrtz_f16_f32 v112, v112, v113
v_mfma_f32_16x16x32_f16 v[180:183], v[176:179], v[60:63], v[180:183]
v_cvt_pkrtz_f16_f32 v113, v114, v115
v_lshrrev_b64 v[112:113], 2, v[112:113]
v_and_b32_sdwa v114, s47, v112 dst_sel:DWORD dst_unused:UNUSED_PAD src0_sel:DWORD src1_sel:WORD_1
v_and_b32_e64 v112, s47, v112
v_pk_mul_f16 v67, v70, v71
v_exp_f16_sdwa v229, v229 dst_sel:WORD_0 dst_unused:UNUSED_PRESERVE src0_sel:WORD_0
v_lshl_add_u64 v[142:143], v[172:173], 0, v[174:175]
v_mfma_f32_16x16x32_bf16 v[32:35], v[184:187], v[192:195], v[32:35]
ds_read_u16_d16_hi v114, v114
ds_read_u16 v112, v112
v_mfma_f32_16x16x32_f16 v[196:199], v[176:179], v[56:59], v[196:199]
ds_read_b128 v[184:187], v249 offset:34816
v_exp_f16_sdwa v231, v231 dst_sel:WORD_0 dst_unused:UNUSED_PRESERVE src0_sel:WORD_0
v_and_b32_sdwa v115, s47, v113 dst_sel:DWORD dst_unused:UNUSED_PAD src0_sel:DWORD src1_sel:WORD_1
v_and_b32_e64 v113, s47, v113
s_waitcnt lgkmcnt(6)
v_mfma_f32_16x16x32_bf16 v[164:167], v[188:191], v[44:47], v[164:167]
ds_read_u16_d16_hi v115, v115
ds_read_u16 v113, v113
v_mfma_f32_16x16x32_f16 v[92:95], v[176:179], v[24:27], v[92:95]
v_exp_f16_sdwa v229, v229 dst_sel:WORD_1 dst_unused:UNUSED_PRESERVE src0_sel:WORD_1
s_setprio 0
ds_read_b128 v[176:179], v251 offset:64512
v_mfma_f32_16x16x32_bf16 v[100:103], v[188:191], v[144:147], v[100:103]
v_lshl_add_u64 v[202:203], v[156:157], 0, v[158:159]
v_exp_f16_sdwa v231, v231 dst_sel:WORD_1 dst_unused:UNUSED_PRESERVE src0_sel:WORD_1
v_mfma_f32_16x16x32_f16 v[216:219], v[160:163], v[60:63], v[216:219]
v_pk_add_f16 v229, v229, 1.0 op_sel_hi:[1,0]
v_pk_add_f16 v231, v231, 1.0 op_sel_hi:[1,0]
v_mfma_f32_16x16x32_bf16 v[32:35], v[188:191], v[148:151], v[32:35]
ds_read_b128 v[188:191], v249 offset:30976
v_rcp_f16_sdwa v229, v229 dst_sel:WORD_0 dst_unused:UNUSED_PRESERVE src0_sel:WORD_0
v_mfma_f32_16x16x32_f16 v[232:235], v[160:163], v[56:59], v[232:235]
v_rcp_f16_sdwa v231, v231 dst_sel:WORD_0 dst_unused:UNUSED_PRESERVE src0_sel:WORD_0
v_mfma_f32_16x16x32_bf16 v[4:7], v[52:55], v[28:31], 0
v_cvt_pkrtz_f16_f32 v164, v164, v165
v_cvt_pkrtz_f16_f32 v165, v166, v167
v_mfma_f32_16x16x32_f16 v[224:227], v[160:163], v[24:27], v[224:227]
ds_read_b128 v[160:163], v252 offset:2048
v_lshrrev_b64 v[164:165], 2, v[164:165]
s_waitcnt vmcnt(5)
v_mfma_f32_16x16x32_bf16 v[240:243], v[18:21], v[244:247], v[240:243]
v_and_b32_sdwa v166, s47, v164 dst_sel:DWORD dst_unused:UNUSED_PAD src0_sel:DWORD src1_sel:WORD_1
v_and_b32_e64 v164, s47, v164
v_mfma_f32_16x16x32_bf16 v[8:11], v[16:19], v[244:247], v[8:11]
ds_read_u16_d16_hi v166, v166
ds_read_u16 v164, v164
s_waitcnt vmcnt(4)
v_mfma_f32_16x16x32_bf16 v[96:99], v[18:21], v[168:171], v[96:99]
v_rcp_f16_sdwa v229, v229 dst_sel:WORD_1 dst_unused:UNUSED_PRESERVE src0_sel:WORD_1
v_mfma_f32_16x16x32_bf16 v[212:215], v[16:19], v[168:171], v[212:215]
v_and_b32_sdwa v167, s47, v165 dst_sel:DWORD dst_unused:UNUSED_PAD src0_sel:DWORD src1_sel:WORD_1
v_and_b32 v165, s47, v165
v_mfma_f32_16x16x32_bf16 v[132:135], v[52:55], v[128:131], 0
ds_read_u16_d16_hi v167, v167
ds_read_u16 v165, v165
v_mfma_f32_16x16x32_f16 v[116:119], v[48:51], v[200:203], v[116:119]
v_rcp_f16_sdwa v231, v231 dst_sel:WORD_1 dst_unused:UNUSED_PRESERVE src0_sel:WORD_1
v_mfma_f32_16x16x32_bf16 v[40:43], v[52:55], v[136:139], 0
s_waitcnt lgkmcnt(5)
ds_read_b128 v[52:55], v249 offset:33024
v_cvt_pkrtz_f16_f32 v100, v100, v101
v_mfma_f32_16x16x32_f16 v[240:243], v[48:51], v[140:143], v[240:243]
v_cvt_pkrtz_f16_f32 v101, v102, v103
v_lshrrev_b64 v[100:101], 2, v[100:101]
v_mfma_f32_16x16x32_bf16 v[4:7], v[120:123], v[36:39], v[4:7]
v_and_b32_sdwa v102, s47, v100 dst_sel:DWORD dst_unused:UNUSED_PAD src0_sel:DWORD src1_sel:WORD_1
v_and_b32 v100, s47, v100
v_mfma_f32_16x16x32_f16 v[76:79], v[48:51], v[64:67], v[76:79]
s_setprio 3
ds_read_u16_d16_hi v102, v102
ds_read_u16 v100, v100
ds_read_b128 v[48:51], v252
v_pk_mul_f16 v228, v228, v229
v_mfma_f32_16x16x32_bf16 v[132:135], v[120:123], v[108:111], v[132:135]
v_and_b32_sdwa v103, s47, v101 dst_sel:DWORD dst_unused:UNUSED_PAD src0_sel:DWORD src1_sel:WORD_1
v_and_b32_e64 v101, s47, v101
v_mfma_f32_16x16x32_f16 v[72:75], v[124:127], v[200:203], v[72:75]
ds_read_u16_d16_hi v103, v103
ds_read_u16 v101, v101
v_pk_mul_f16 v229, v230, v231
v_lshl_add_u64 v[152:153], v[152:153], 0, v[154:155]
v_mfma_f32_16x16x32_bf16 v[40:43], v[120:123], v[192:195], v[40:43]
v_cvt_pkrtz_f16_f32 v32, v32, v33
v_cvt_pkrtz_f16_f32 v33, v34, v35
v_lshrrev_b64 v[32:33], 2, v[32:33]
v_and_b32_sdwa v34, s47, v32 dst_sel:DWORD dst_unused:UNUSED_PAD src0_sel:DWORD src1_sel:WORD_1
v_and_b32_e64 v32, s47, v32
v_mfma_f32_16x16x32_f16 v[8:11], v[124:127], v[140:143], v[8:11]
ds_read_u16_d16_hi v34, v34
ds_read_u16 v32, v32
ds_read_b128 v[120:123], v249 offset:35072
v_and_b32_sdwa v35, s47, v33 dst_sel:DWORD dst_unused:UNUSED_PAD src0_sel:DWORD src1_sel:WORD_1
v_and_b32 v33, s47, v33
v_mfma_f32_16x16x32_bf16 v[4:7], v[184:187], v[44:47], v[4:7]
ds_read_u16_d16_hi v35, v35
s_waitcnt lgkmcnt(9)
ds_read_u16 v33, v33
v_mfma_f32_16x16x32_f16 v[220:223], v[124:127], v[64:67], v[220:223]
ds_read_b128 v[124:127], v252 offset:3072
v_lshl_add_u64 v[112:113], v[112:113], 0, v[114:115]
v_mfma_f32_16x16x32_bf16 v[132:135], v[184:187], v[144:147], v[132:135]
s_nop 0
v_cvt_pk_f16_f32 v4, v4, v5
v_mfma_f32_16x16x32_f16 v[12:15], v[176:179], v[200:203], v[12:15]
v_cvt_pk_f16_f32 v6, v6, v7
v_pk_fma_f16 v5, v4, v4, s48
v_mfma_f32_16x16x32_bf16 v[40:43], v[184:187], v[148:151], v[40:43]
ds_read_b128 v[184:187], v252 offset:4096
s_nop 0
v_cvt_pkrtz_f16_f32 v132, v132, v133
v_mfma_f32_16x16x32_f16 v[96:99], v[176:179], v[140:143], v[96:99]
v_cvt_pkrtz_f16_f32 v133, v134, v135
v_lshrrev_b64 v[132:133], 2, v[132:133]
v_mfma_f32_16x16x32_bf16 v[0:3], v[188:191], v[28:31], 0
v_and_b32_sdwa v134, s47, v132 dst_sel:DWORD dst_unused:UNUSED_PAD src0_sel:DWORD src1_sel:WORD_1
v_and_b32 v132, s47, v132
v_mfma_f32_16x16x32_f16 v[84:87], v[176:179], v[64:67], v[84:87]
s_setprio 2
ds_read_u16_d16_hi v134, v134
ds_read_u16 v132, v132
v_mfma_f32_16x16x32_bf16 v[68:71], v[188:191], v[128:131], 0
v_and_b32_sdwa v135, s47, v133 dst_sel:DWORD dst_unused:UNUSED_PAD src0_sel:DWORD src1_sel:WORD_1
v_and_b32 v133, s47, v133
v_mfma_f32_16x16x32_f16 v[208:211], v[160:163], v[200:203], v[208:211]
ds_read_u16_d16_hi v135, v135
s_waitcnt lgkmcnt(8)
ds_read_u16 v133, v133
v_mfma_f32_16x16x32_bf16 v[172:175], v[188:191], v[136:139], 0
v_pk_fma_f16 v7, v6, v6, s48
v_pk_mul_f16 v5, v4, v5
v_mfma_f32_16x16x32_f16 v[212:215], v[160:163], v[140:143], v[212:215]
ds_read_b128 v[176:179], v252 offset:7168
v_pk_mul_f16 v7, v6, v7
v_mfma_f32_16x16x32_bf16 v[0:3], v[52:55], v[36:39], v[0:3]
v_cvt_pkrtz_f16_f32 v40, v40, v41
v_cvt_pkrtz_f16_f32 v41, v42, v43
v_mfma_f32_16x16x32_f16 v[236:239], v[160:163], v[64:67], v[236:239]
v_lshrrev_b64 v[40:41], 2, v[40:41]
v_and_b32_sdwa v42, s47, v40 dst_sel:DWORD dst_unused:UNUSED_PAD src0_sel:DWORD src1_sel:WORD_1
v_mfma_f32_16x16x32_bf16 v[68:71], v[52:55], v[108:111], v[68:71]
v_and_b32_e64 v40, s47, v40
v_lshl_add_u64 v[230:231], v[164:165], 0, v[166:167]
v_mfma_f32_16x16x32_f16 v[180:183], v[48:51], v[200:203], v[180:183]
ds_read_u16_d16_hi v42, v42
ds_read_u16 v40, v40
v_exp_f16_sdwa v5, v5 dst_sel:WORD_0 dst_unused:UNUSED_PRESERVE src0_sel:WORD_0
v_mfma_f32_16x16x32_bf16 v[172:175], v[52:55], v[192:195], v[172:175]
v_exp_f16_sdwa v7, v7 dst_sel:WORD_0 dst_unused:UNUSED_PRESERVE src0_sel:WORD_0
v_mfma_f32_16x16x32_f16 v[196:199], v[48:51], v[140:143], v[196:199]
v_and_b32_sdwa v43, s47, v41 dst_sel:DWORD dst_unused:UNUSED_PAD src0_sel:DWORD src1_sel:WORD_1
v_and_b32_e64 v41, s47, v41
s_waitcnt lgkmcnt(5)
v_mfma_f32_16x16x32_bf16 v[0:3], v[120:123], v[44:47], v[0:3]
ds_read_u16_d16_hi v43, v43
ds_read_u16 v41, v41
v_lshl_add_u64 v[154:155], v[100:101], 0, v[102:103]
s_setprio 1
v_mfma_f32_16x16x32_f16 v[92:95], v[48:51], v[64:67], v[92:95]
v_exp_f16_sdwa v5, v5 dst_sel:WORD_1 dst_unused:UNUSED_PRESERVE src0_sel:WORD_1
v_mfma_f32_16x16x32_bf16 v[68:71], v[120:123], v[144:147], v[68:71]
ds_read_b128 v[188:191], v252 offset:5120
v_exp_f16_sdwa v7, v7 dst_sel:WORD_1 dst_unused:UNUSED_PRESERVE src0_sel:WORD_1
v_mfma_f32_16x16x32_f16 v[216:219], v[124:127], v[200:203], v[216:219]
v_lshl_add_u64 v[114:115], v[32:33], 0, v[34:35]
v_pk_add_f16 v5, v5, 1.0 op_sel_hi:[1,0]
v_mfma_f32_16x16x32_bf16 v[172:175], v[120:123], v[148:151], v[172:175]
v_pk_add_f16 v7, v7, 1.0 op_sel_hi:[1,0]
v_rcp_f16_sdwa v5, v5 dst_sel:WORD_0 dst_unused:UNUSED_PRESERVE src0_sel:WORD_0
v_mfma_f32_16x16x32_f16 v[232:235], v[124:127], v[140:143], v[232:235]
ds_read_b128 v[160:163], v252 offset:8192
v_rcp_f16_sdwa v7, v7 dst_sel:WORD_0 dst_unused:UNUSED_PRESERVE src0_sel:WORD_0
v_mfma_f32_16x16x32_f16 v[224:227], v[124:127], v[64:67], v[224:227]
v_cvt_pkrtz_f16_f32 v68, v68, v69
v_cvt_pkrtz_f16_f32 v69, v70, v71
s_waitcnt vmcnt(3)
v_mfma_f32_16x16x32_bf16 v[196:199], v[18:21], v[104:107], v[196:199]
v_lshrrev_b64 v[68:69], 2, v[68:69]
v_and_b32_sdwa v70, s47, v68 dst_sel:DWORD dst_unused:UNUSED_PAD src0_sel:DWORD src1_sel:WORD_1
v_mfma_f32_16x16x32_bf16 v[232:235], v[16:19], v[104:107], v[232:235]
v_and_b32_e64 v68, s47, v68
v_cvt_pk_f16_f32 v0, v0, v1
s_waitcnt vmcnt(2)
v_mfma_f32_16x16x32_bf16 v[116:119], v[18:21], v[204:207], v[116:119]
ds_read_u16_d16_hi v70, v70
ds_read_u16 v68, v68
v_mfma_f32_16x16x32_bf16 v[72:75], v[16:19], v[204:207], v[72:75]
v_rcp_f16_sdwa v5, v5 dst_sel:WORD_1 dst_unused:UNUSED_PRESERVE src0_sel:WORD_1
v_mfma_f32_16x16x32_f16 v[116:119], v[184:187], v[112:115], v[116:119]
v_cvt_pk_f16_f32 v2, v2, v3
v_pk_fma_f16 v1, v0, v0, s48
v_mfma_f32_16x16x32_f16 v[240:243], v[184:187], v[152:155], v[240:243]
v_rcp_f16_sdwa v7, v7 dst_sel:WORD_1 dst_unused:UNUSED_PRESERVE src0_sel:WORD_1
s_setprio 0
v_and_b32_sdwa v71, s47, v69 dst_sel:DWORD dst_unused:UNUSED_PAD src0_sel:DWORD src1_sel:WORD_1
v_and_b32 v69, s47, v69
v_pk_fma_f16 v3, v2, v2, s48
v_mfma_f32_16x16x32_f16 v[76:79], v[184:187], v[228:231], v[76:79]
ds_read_u16_d16_hi v71, v71
ds_read_u16 v69, v69
ds_read_b128 v[52:55], v252 offset:6144
v_pk_mul_f16 v1, v0, v1
v_pk_mul_f16 v4, v4, v5
v_pk_mul_f16 v3, v2, v3
s_waitcnt lgkmcnt(5)
v_mfma_f32_16x16x32_f16 v[72:75], v[176:179], v[112:115], v[72:75]
v_cvt_pkrtz_f16_f32 v172, v172, v173
v_cvt_pkrtz_f16_f32 v173, v174, v175
v_lshrrev_b64 v[172:173], 2, v[172:173]
v_and_b32_sdwa v174, s47, v172 dst_sel:DWORD dst_unused:UNUSED_PAD src0_sel:DWORD src1_sel:WORD_1
v_and_b32 v172, s47, v172
v_pk_mul_f16 v5, v6, v7
v_exp_f16_sdwa v1, v1 dst_sel:WORD_0 dst_unused:UNUSED_PRESERVE src0_sel:WORD_0
v_lshl_add_u64 v[132:133], v[132:133], 0, v[134:135]
v_mfma_f32_16x16x32_f16 v[8:11], v[176:179], v[152:155], v[8:11]
ds_read_u16_d16_hi v174, v174
ds_read_u16 v172, v172
v_exp_f16_sdwa v3, v3 dst_sel:WORD_0 dst_unused:UNUSED_PRESERVE src0_sel:WORD_0
v_and_b32_sdwa v175, s47, v173 dst_sel:DWORD dst_unused:UNUSED_PAD src0_sel:DWORD src1_sel:WORD_1
v_and_b32 v173, s47, v173
v_mfma_f32_16x16x32_f16 v[220:223], v[176:179], v[228:231], v[220:223]
ds_read_u16_d16_hi v175, v175
ds_read_u16 v173, v173
v_exp_f16_sdwa v1, v1 dst_sel:WORD_1 dst_unused:UNUSED_PRESERVE src0_sel:WORD_1
v_mfma_f32_16x16x32_f16 v[12:15], v[188:191], v[112:115], v[12:15]
ds_read_b128 v[48:51], v252 offset:9216
v_lshl_add_u64 v[40:41], v[40:41], 0, v[42:43]
v_exp_f16_sdwa v3, v3 dst_sel:WORD_1 dst_unused:UNUSED_PRESERVE src0_sel:WORD_1
v_mfma_f32_16x16x32_f16 v[96:99], v[188:191], v[152:155], v[96:99]
v_pk_add_f16 v1, v1, 1.0 op_sel_hi:[1,0]
v_pk_add_f16 v3, v3, 1.0 op_sel_hi:[1,0]
s_setprio 3
v_rcp_f16_sdwa v1, v1 dst_sel:WORD_0 dst_unused:UNUSED_PRESERVE src0_sel:WORD_0
v_mfma_f32_16x16x32_f16 v[84:87], v[188:191], v[228:231], v[84:87]
ds_read_b128 v[120:123], v252 offset:10240
v_rcp_f16_sdwa v3, v3 dst_sel:WORD_0 dst_unused:UNUSED_PRESERVE src0_sel:WORD_0
v_mfma_f32_16x16x32_f16 v[208:211], v[160:163], v[112:115], v[208:211]
ds_read_b128 v[124:127], v252 offset:13312
v_rcp_f16_sdwa v1, v1 dst_sel:WORD_1 dst_unused:UNUSED_PRESERVE src0_sel:WORD_1
v_mfma_f32_16x16x32_f16 v[212:215], v[160:163], v[152:155], v[212:215]
v_rcp_f16_sdwa v3, v3 dst_sel:WORD_1 dst_unused:UNUSED_PRESERVE src0_sel:WORD_1
v_mfma_f32_16x16x32_f16 v[236:239], v[160:163], v[228:231], v[236:239]
ds_read_b128 v[184:187], v252 offset:11264
v_pk_mul_f16 v6, v0, v1
s_waitcnt lgkmcnt(6)
v_mfma_f32_16x16x32_f16 v[180:183], v[52:55], v[112:115], v[180:183]
v_pk_mul_f16 v7, v2, v3
v_lshl_add_u64 v[134:135], v[68:69], 0, v[70:71]
v_mfma_f32_16x16x32_f16 v[196:199], v[52:55], v[152:155], v[196:199]
ds_read_b128 v[176:179], v252 offset:14336
s_setprio 2
ds_read_b128 v[188:191], v252 offset:12288
v_mfma_f32_16x16x32_f16 v[92:95], v[52:55], v[228:231], v[92:95]
s_waitcnt lgkmcnt(5)
v_lshl_add_u64 v[42:43], v[172:173], 0, v[174:175]
ds_read_b128 v[160:163], v252 offset:15360
v_mfma_f32_16x16x32_f16 v[216:219], v[48:51], v[112:115], v[216:219]
v_mfma_f32_16x16x32_f16 v[232:235], v[48:51], v[152:155], v[232:235]
v_mfma_f32_16x16x32_f16 v[224:227], v[48:51], v[228:231], v[224:227]
s_waitcnt vmcnt(1)
v_mfma_f32_16x16x32_bf16 v[12:15], v[18:21], v[80:83], v[12:15]
v_mfma_f32_16x16x32_bf16 v[208:211], v[16:19], v[80:83], v[208:211]
s_waitcnt vmcnt(0)
v_mfma_f32_16x16x32_bf16 v[180:183], v[18:21], v[88:91], v[180:183]
v_mfma_f32_16x16x32_bf16 v[216:219], v[16:19], v[88:91], v[216:219]
s_waitcnt lgkmcnt(2)
v_mfma_f32_16x16x32_f16 v[116:119], v[120:123], v[40:43], v[116:119]
v_mfma_f32_16x16x32_f16 v[240:243], v[120:123], v[132:135], v[240:243]
v_mfma_f32_16x16x32_f16 v[76:79], v[120:123], v[4:7], v[76:79]
s_nop 5
v_cvt_pk_bf16_f32 v116, v116, v117
v_mfma_f32_16x16x32_f16 v[72:75], v[124:127], v[40:43], v[72:75]
s_setprio 1
v_cvt_pk_bf16_f32 v117, v118, v119
v_cvt_pk_bf16_f32 v240, v240, v241
v_mfma_f32_16x16x32_f16 v[8:11], v[124:127], v[132:135], v[8:11]
v_cvt_pk_bf16_f32 v76, v76, v77
v_cvt_pk_bf16_f32 v77, v78, v79
v_mfma_f32_16x16x32_f16 v[220:223], v[124:127], v[4:7], v[220:223]
v_cvt_pk_bf16_f32 v241, v242, v243
v_cvt_pk_bf16_f32 v118, v72, v73
v_mfma_f32_16x16x32_f16 v[12:15], v[184:187], v[40:43], v[12:15]
s_nop 1
v_cvt_pk_bf16_f32 v242, v8, v9
v_cvt_pk_bf16_f32 v243, v10, v11
v_mfma_f32_16x16x32_f16 v[96:99], v[184:187], v[132:135], v[96:99]
v_cvt_pk_bf16_f32 v78, v220, v221
v_cvt_pk_bf16_f32 v79, v222, v223
v_mfma_f32_16x16x32_f16 v[84:87], v[184:187], v[4:7], v[84:87]
v_cvt_pk_bf16_f32 v119, v74, v75
v_cvt_pk_bf16_f32 v12, v12, v13
v_mfma_f32_16x16x32_f16 v[208:211], v[176:179], v[40:43], v[208:211]
s_nop 1
v_cvt_pk_bf16_f32 v96, v96, v97
v_cvt_pk_bf16_f32 v97, v98, v99
v_mfma_f32_16x16x32_f16 v[212:215], v[176:179], v[132:135], v[212:215]
v_cvt_pk_bf16_f32 v84, v84, v85
v_cvt_pk_bf16_f32 v85, v86, v87
v_mfma_f32_16x16x32_f16 v[236:239], v[176:179], v[4:7], v[236:239]
v_cvt_pk_bf16_f32 v13, v14, v15
v_cvt_pk_bf16_f32 v14, v208, v209
v_cvt_pk_bf16_f32 v15, v210, v211
s_waitcnt lgkmcnt(0)
v_mfma_f32_16x16x32_f16 v[180:183], v[188:191], v[40:43], v[180:183]
v_cvt_pk_bf16_f32 v98, v212, v213
v_cvt_pk_bf16_f32 v99, v214, v215
v_mfma_f32_16x16x32_f16 v[196:199], v[188:191], v[132:135], v[196:199]
v_cvt_pk_bf16_f32 v86, v236, v237
v_cvt_pk_bf16_f32 v87, v238, v239
v_mfma_f32_16x16x32_f16 v[92:95], v[188:191], v[4:7], v[92:95]
s_nop 1
v_cvt_pk_bf16_f32 v180, v180, v181
v_cvt_pk_bf16_f32 v181, v182, v183
v_mfma_f32_16x16x32_f16 v[216:219], v[160:163], v[40:43], v[216:219]
v_cvt_pk_bf16_f32 v196, v196, v197
v_cvt_pk_bf16_f32 v197, v198, v199
v_mfma_f32_16x16x32_f16 v[232:235], v[160:163], v[132:135], v[232:235]
v_cvt_pk_bf16_f32 v92, v92, v93
v_cvt_pk_bf16_f32 v93, v94, v95
s_setprio 0
v_mfma_f32_16x16x32_f16 v[224:227], v[160:163], v[4:7], v[224:227]
s_nop 0
v_cvt_pk_bf16_f32 v182, v216, v217
v_cvt_pk_bf16_f32 v183, v218, v219
s_nop 0
v_cvt_pk_bf16_f32 v198, v232, v233
v_cvt_pk_bf16_f32 v199, v234, v235
s_nop 1
v_cvt_pk_bf16_f32 v94, v224, v225
v_cvt_pk_bf16_f32 v95, v226, v227
buffer_store_dwordx4 v[76:79], v253, s[8:11], s69 offen offset:192 sc1
buffer_store_dwordx4 v[84:87], v253, s[8:11], s69 offen offset:256 sc1
buffer_store_dwordx4 v[92:95], v253, s[8:11], s69 offen offset:320 sc1
buffer_store_dwordx4 v[240:243], v253, s[8:11], s68 offen sc1
buffer_store_dwordx4 v[96:99], v253, s[8:11], s68 offen offset:64 sc1
buffer_store_dwordx4 v[196:199], v253, s[8:11], s68 offen offset:128 sc1
buffer_store_dwordx4 v[116:119], v253, s[8:11], s68 offen offset:192 sc1
buffer_store_dwordx4 v[12:15], v253, s[8:11], s68 offen offset:256 sc1
buffer_store_dwordx4 v[180:183], v253, s[8:11], s68 offen offset:320 sc1
s_endpgm
Lpolln:
s_getreg_b32 s43, hwreg(HW_REG_IB_STS, 0, 4)
s_cmp_eq_u32 s43, 0
s_cbranch_scc1 Lpoll
s_setpc_b64 s[78:79]
Lpoll:
s_waitcnt vmcnt(0)
s_mov_b32 s3, 1
s_cmp_eq_u32 s77, 2
s_cbranch_scc1 LpollC
v_max_u32 v241, v128, v129
v_max3_u32 v241, v241, v130, v131
v_max3_u32 v241, v241, v132, v133
v_max3_u32 v241, v241, v134, v135
v_max3_u32 v241, v241, v136, v137
v_max3_u32 v241, v241, v138, v139
v_max3_u32 v241, v241, v140, v141
v_max3_u32 v241, v241, v142, v143
v_cmp_eq_u32 vcc, -1, v241
s_nop 4
s_cbranch_vccz LpollR
s_lshl_b32 s44, s2, 12
buffer_load_dwordx4 v[128:131], v245, s[32:35], s44 offen sc1
buffer_load_dwordx4 v[132:135], v245, s[32:35], s44 offen offset:1024 sc1
buffer_load_dwordx4 v[136:139], v245, s[32:35], s44 offen offset:2048 sc1
buffer_load_dwordx4 v[140:143], v245, s[32:35], s44 offen offset:3072 sc1
s_setpc_b64 s[78:79]
LpollR:
v_add_f32 v128, v128, v132
v_add_f32 v140, v136, v140
v_add_f32 v140, v128, v140
v_add_f32 v129, v129, v133
v_add_f32 v141, v137, v141
v_add_f32 v141, v129, v141
v_add_f32 v130, v130, v134
v_add_f32 v142, v138, v142
v_add_f32 v142, v130, v142
v_add_f32 v131, v131, v135
v_add_f32 v143, v139, v143
v_add_f32 v143, v131, v143
v_permlane32_swap_b32 v140, v141
s_nop 0
v_permlane32_swap_b32 v142, v143
v_add_f32 v140, v140, v141
v_add_f32 v142, v142, v143
v_bfe_u32 v241, v245, 4, 4
v_lshlrev_b32 v241, 11, v241
v_permlane16_swap_b32 v140, v142
v_add_f32 v140, v140, v142
v_bfe_u32 v242, v245, 8, 1
v_lshl_add_u32 v241, v242, 3, v241
v_add_f32_dpp v140, v140, v140 row_ror:8 row_mask:0xf bank_mask:0xf
v_bfe_u32 v242, v245, 9, 1
v_lshl_add_u32 v241, v242, 2, v241
v_add_f32_dpp v140, v140, v140 row_ror:4 row_mask:0xf bank_mask:0xf
s_lshl_b32 s44, s2, 4
s_add_u32 s44, s44, 393216
v_add_f32_dpp v140, v140, v140 row_ror:2 row_mask:0xf bank_mask:0xf
s_mov_b32 s43, 1083289508
v_mov_b32 v242, 897988541
v_add_f32_dpp v140, v140, v140 row_ror:1 row_mask:0xf bank_mask:0xf
v_fma_f32 v140, v140, s43, v242
v_sqrt_f32_e64 v140, v140
s_mov_b32 exec_lo, 16711935
s_mov_b32 exec_hi, 16711935
v_min_u32_e64 v140, -2, v140
buffer_store_dword v140, v241, s[32:35], s44 offen sc1
s_mov_b64 exec, -1
s_mov_b32 s77, 2
s_and_b32 s44, s2, 7
s_lshl_b32 s44, s44, 11
s_add_u32 s44, s44, 393216
buffer_load_dwordx2 v[128:129], v240, s[32:35], s44 offen sc1
buffer_load_dwordx2 v[130:131], v240, s[32:35], s44 offen offset:8 sc1
buffer_load_dwordx2 v[132:133], v240, s[32:35], s44 offen offset:16 sc1
v_lshrrev_b32 v241, 1, v240
buffer_load_dword v135, v241, s[24:27], 0 offen
buffer_load_dword v137, v241, s[24:27], 0 offen offset:4
buffer_load_dword v139, v241, s[24:27], 0 offen offset:8
s_setpc_b64 s[78:79]
LpollC:
v_max3_u32 v241, v128, v129, v130
v_max3_u32 v241, v241, v131, v132
v_max_u32 v241, v241, v133
v_cmp_eq_u32 vcc, -1, v241
s_nop 4
s_cbranch_vccz LpollS
s_and_b32 s44, s2, 7
s_lshl_b32 s44, s44, 11
s_add_u32 s44, s44, 393216
buffer_load_dwordx2 v[128:129], v240, s[32:35], s44 offen sc1
buffer_load_dwordx2 v[130:131], v240, s[32:35], s44 offen offset:8 sc1
buffer_load_dwordx2 v[132:133], v240, s[32:35], s44 offen offset:16 sc1
s_setpc_b64 s[78:79]
LpollS:
v_add_f32 v243, v128, v129
v_add_f32 v243, v243, v130
v_add_f32 v243, v243, v131
v_add_f32 v243, v243, v132
v_add_f32 v243, v243, v133
v_lshlrev_b32_e64 v134, 16, v135
v_and_b32 v135, 4294901760, v135
v_add_f32_dpp v243, v243, v243 row_ror:8 row_mask:0xf bank_mask:0xf
v_lshlrev_b32_e64 v136, 16, v137
v_and_b32 v137, 4294901760, v137
v_add_f32_dpp v243, v243, v243 row_ror:4 row_mask:0xf bank_mask:0xf
v_lshlrev_b32_e64 v138, 16, v139
v_and_b32 v139, 4294901760, v139
v_add_f32_dpp v243, v243, v243 row_ror:2 row_mask:0xf bank_mask:0xf
v_mul_f32 v128, v128, v134
v_mul_f32 v129, v129, v135
v_add_f32_dpp v243, v243, v243 row_ror:1 row_mask:0xf bank_mask:0xf
v_mov_b32 v241, v243
v_mul_f32 v130, v130, v136
v_mul_f32 v131, v131, v137
v_permlane16_swap_b32 v243, v241
v_add_f32 v243, v243, v241
v_mov_b32 v241, v243
v_mul_f32 v132, v132, v138
v_mul_f32 v133, v133, v139
v_permlane32_swap_b32 v243, v241
v_add_f32 v243, v243, v241
v_mov_b32 v242, 3036348137
s_mov_b32 s43, 3131020332
v_fma_f32 v243, v243, s43, v242
v_rcp_f32_e64 v243, v243
s_mov_b32 s43, 3221808330
v_fma_f32 v128, v128, v243, s43
v_fma_f32 v129, v129, v243, s43
v_fma_f32 v130, v130, v243, s43
v_fma_f32 v131, v131, v243, s43
v_fma_f32 v132, v132, v243, s43
v_fma_f32 v133, v133, v243, s43
v_cvt_pk_f16_f32 v128, v128, v129
v_cvt_pk_f16_f32 v129, v130, v131
v_cvt_pk_f16_f32 v130, v132, v133
s_mov_b32 s77, 0
s_nop 1
s_setpc_b64 s[78:79]
Lend:
s_endpgm

.section .rodata,"a"
.p2align 6
.amdhsa_kernel standalone__modern_conv_block_convnext_v2__vision_kernel
  .amdhsa_next_free_vgpr 256
  .amdhsa_next_free_sgpr 102
  .amdhsa_accum_offset 256
  .amdhsa_group_segment_fixed_size 0
  .amdhsa_kernarg_size 72
  .amdhsa_user_sgpr_count 2
  .amdhsa_user_sgpr_kernarg_segment_ptr 1
  .amdhsa_system_sgpr_workgroup_id_x 1
.end_amdhsa_kernel
```
